```python
import torch

def _softmax(x, axis=-1):
    return torch.softmax(x, dim=axis)
def _gelu(x):
    return torch.nn.functional.gelu(x, approximate="tanh")
def _silu(x):
    return torch.nn.functional.silu(x)
def _sigmoid(x):
    return torch.sigmoid(x)
def _layernorm(x, axis=-1, eps=1e-5):
    m = x.mean(dim=axis, keepdim=True)
    v = x.var(dim=axis, keepdim=True, unbiased=False)
    return (x - m) / torch.sqrt(v + eps)
def _scatter_add(tgt, idx, src, axis=0):
    return tgt.clone().index_add_(axis, idx, src)
def _segment_sum(src, seg, n):
    out = torch.zeros((n,) + src.shape[1:], dtype=src.dtype)
    return out.index_add_(0, seg, src)
def _pad(x, pw):
    flat = tuple(v for pair in reversed(pw) for v in pair)
    return torch.nn.functional.pad(x, flat)

kernel_name = 'recurrent_scan__mha_block_cached__dense_activation_relu__prompt'

def setup_inputs():

    _w = (lambda a: (lambda t: t.to(torch.bfloat16) if t.is_floating_point() else t)(torch.as_tensor(a)))
    def _A_setup():
        B, Sq, D = 1, 2048, 576
        H, Sk, Dh = 32, 2048, 128
        return {
            "x": _w((lambda *s: torch.randn(*s, dtype=torch.bfloat16) * 0.05)(B, Sq, D)),
            "k_cache": _w((lambda *s: torch.randn(*s, dtype=torch.bfloat16) * 0.8)(B, H, Sk, Dh)),
            "v_cache": _w((lambda *s: torch.randn(*s, dtype=torch.bfloat16) * 0.2)(B, H, Sk, Dh)),
            "wq": _w((lambda *s: torch.randn(*s, dtype=torch.bfloat16) * 0.8)(D, H * Dh) * (D ** -0.5)),
            "wo": _w((lambda *s: torch.randn(*s, dtype=torch.bfloat16) * 0.2)(H * Dh, D) * ((H * Dh) ** -0.5)),
        }
    _A_in = _A_setup()

    def _B_setup():
        B, S, D, Dff = 1, 2048, 576, 4608
        return {
            "x": _w((lambda *s: torch.randn(*s, dtype=torch.bfloat16) * 0.05)(B, S, D)),
            "w1": _w((lambda *s: torch.randn(*s, dtype=torch.bfloat16) * 0.1)(D, Dff)),
            "w2": _w((lambda *s: torch.randn(*s, dtype=torch.bfloat16) * 0.1)(Dff, D)),
        }
    _B_in = _B_setup()

    return {
        "A_x": _A_in["x"],
        "A_k_cache": _A_in["k_cache"],
        "A_v_cache": _A_in["v_cache"],
        "A_wq": _A_in["wq"],
        "A_wo": _A_in["wo"],
        "B_x": _B_in["x"],
        "B_w1": _B_in["w1"],
        "B_w2": _B_in["w2"],
    }

def reference(A_x, A_k_cache, A_v_cache, A_wq, A_wo, B_x, B_w1, B_w2):
    def _A_ref(x, k_cache, v_cache, wq, wo):
        B, Sq, D = x.shape
        H, Dh = 32, 128
        q = (lambda x, *d: x.permute(*d))((x @ wq).reshape(B, Sq, H, Dh), 0, 2, 1, 3)
        scores = torch.einsum("bhqd,bhkd->bhqk", q, k_cache) * (Dh ** -0.5)
        p = _softmax(scores, axis=-1)
        o = torch.einsum("bhqk,bhkd->bhqd", p, v_cache)
        return (lambda x, *d: x.permute(*d))(o, 0, 2, 1, 3).reshape(B, Sq, H * Dh) @ wo

    def _B_ref(x, w1, w2):
        h = torch.einsum("bsd,df->bsf", x, w1)
        zero = torch.zeros_like(h)
        h = torch.maximum(h, zero)
        return torch.einsum("bsf,fd->bsd", h, w2)

    x = A_x
    xn = _layernorm(x, axis=-1)
    s = _A_ref(xn, A_k_cache, A_v_cache, A_wq, A_wo)
    g = _silu(_B_ref(xn, B_w1, B_w2))
    return x + s * g
```

```asm
; @launch grid=(256,1,1) block=(256,1,1) lds=163840
.amdgcn_target "amdgcn-amd-amdhsa--gfx950"
.text
.globl recurrent_scan__mha_block_cached__dense_activation_relu__prompt_kernel
.p2align 8
.type recurrent_scan__mha_block_cached__dense_activation_relu__prompt_kernel,@function
recurrent_scan__mha_block_cached__dense_activation_relu__prompt_kernel:
s_cmp_ge_u32 s2, 256
s_cbranch_scc1 M_done
s_load_dwordx2 s[60:61], s[0:1], 0
s_load_dwordx2 s[28:29], s[0:1], 24
s_load_dwordx2 s[32:33], s[0:1], 48
s_load_dwordx2 s[16:17], s[0:1], 80
s_load_dwordx4 s[4:7], s[0:1], 8
s_load_dwordx2 s[56:57], s[0:1], 72
s_load_dwordx2 s[62:63], s[0:1], 64
v_lshrrev_b32 v1, 6, v0
v_and_b32 v0, 63, v0
v_lshlrev_b32 v7, 4, v0
v_readfirstlane_b32 s23, v1
s_and_b32 s51, s2, 3
s_bfe_u32 s52, s2, 0x30003
s_lshl_b32 s25, s51, 3
s_add_u32 s25, s25, s52
s_lshr_b32 s26, s2, 6
s_lshl_b32 s26, s26, 1
s_bfe_u32 s54, s2, 0x10002
s_add_u32 s26, s26, s54
v_and_b32 v2, 7, v0
v_lshrrev_b32 v3, 3, v0
v_mul_u32_u24 v4, 1152, v2
v_lshl_add_u32 v4, v3, 4, v4
s_lshl_b32 s46, s26, 5
s_add_u32 s46, s46, s25
s_mul_i32 s47, s46, 9216
s_lshl_b32 s48, s23, 7
s_add_u32 s47, s47, s48
s_mov_b32 s10, 2359296
s_mov_b32 s11, 0x20000
s_lshl_b32 s27, s25, 8
s_sub_u32 s30, 4718592, s27
s_sub_u32 s34, 5308416, s27
s_mov_b32 s31, 0x20000
s_mov_b32 s35, 0x20000
s_mov_b32 s18, 268435456
s_mov_b32 s19, 0x20000
s_mul_i32 s48, s26, 32
v_lshrrev_b32 v5, 1, v0
v_min_u32 v5, 31, v5
v_add_u32 v5, s48, v5
v_and_b32 v6, 1, v0
v_lshlrev_b32 v6, 7, v6
v_lshl_add_u32 v57, v5, 13, v6
v_mul_u32_u24 v5, 9216, v5
v_add_u32 v58, v5, v6
s_mul_i32 s48, s25, 224
s_sub_u32 s48, 8192, s48
v_add_u32 v59, s48, v5
s_cmp_eq_u32 s23, 3
s_cbranch_scc1 M_w3a
s_waitcnt lgkmcnt(0)
s_mov_b64 s[8:9], s[60:61]
buffer_load_dwordx4 v[64:67], v4, s[8:11], s47 offen offset:0
buffer_load_dwordx4 v[68:71], v4, s[8:11], s47 offen offset:384
buffer_load_dwordx4 v[72:75], v4, s[8:11], s47 offen offset:768
s_add_u32 s28, s28, s27
s_addc_u32 s29, s29, 0
s_add_u32 s32, s32, s27
s_addc_u32 s33, s33, 0
s_branch M_w3a_b
M_w3a:
s_getpc_b64 s[64:65]
M_pc:
s_sub_u32 s64, s64, M_pc-recurrent_scan__mha_block_cached__dense_activation_relu__prompt_kernel
s_subb_u32 s65, s65, 0
s_lshr_b32 s47, s2, 3
s_lshl_b32 s47, s47, 12
v_lshl_add_u32 v5, v0, 6, s47
v_min_u32 v5, M_end-recurrent_scan__mha_block_cached__dense_activation_relu__prompt_kernel-4, v5
s_mov_b32 s58, 256
s_mov_b32 s59, 0x20000
v_lshlrev_b32 v6, 8, v0
s_lshl_b32 s49, s26, 5
s_lshl_b32 s47, s25, 8
s_add_u32 s47, s47, s49
s_waitcnt lgkmcnt(0)
s_add_u32 s28, s28, s27
s_addc_u32 s29, s29, 0
s_add_u32 s32, s32, s27
s_addc_u32 s33, s33, 0
s_mov_b32 s67, s47
s_lshl_b32 s66, s26, 12
s_add_u32 s66, s66, 2883584
s_cmp_eq_u32 s25, 0
s_cselect_b32 s66, s66, s18
v_lshrrev_b32 v61, 5, v0
v_lshlrev_b32 v61, 2, v61
v_lshl_add_u32 v61, v0, 6, v61
buffer_load_dword v61, v61, s[16:19], s66 offen sc1
global_load_dword v60, v5, s[64:65]
s_mov_b32 s47, 0
buffer_load_dword v48, v57, s[28:31], s47 offen
s_mov_b32 s47, 0
buffer_load_dword v49, v58, s[32:35], s47 offen
buffer_load_dword v50, v59, s[32:35], s47 offen
s_waitcnt vmcnt(4)
v_lshrrev_b32 v61, v0, v61
v_and_b32 v61, 1, v61
v_cmp_eq_u32 vcc, 0, v61
v_mov_b32 v53, 1
v_mov_b32 v55, 1
v_mov_b32 v52, vcc_lo
v_mov_b32 v54, vcc_hi
buffer_store_dwordx4 v[52:55], v6, s[56:59], s67 offen sc1
M_w3a_b:
s_lshl_b32 s48, s23, 6
v_lshlrev_b32 v107, 3, v2
v_add_u32 v106, s48, v107
v_lshrrev_b32 v5, 2, v3
v_mul_u32_u24 v5, 16384, v5
v_and_b32 v6, 3, v3
v_lshl_add_u32 v5, v6, 8, v5
v_lshl_add_u32 v114, v2, 4, v5
s_bfe_u32 s47, s25, 0x20001
s_lshl_b32 s47, s47, 10
s_and_b32 s46, s46, 1
s_lshl_b32 s46, s46, 7
s_add_u32 s46, s46, s47
s_mul_i32 s47, s51, 4096
s_add_u32 s46, s46, s47
s_mul_i32 s47, s23, 32768
s_add_u32 s46, s46, s47
s_mul_i32 s47, s26, 294912
s_add_u32 s46, s46, s47
s_add_u32 s46, s46, 4096
v_and_b32 v2, 15, v0
v_lshrrev_b32 v3, 4, v0
s_lshl_b32 s24, s23, 12
s_lshl_b32 s39, s23, 10
s_lshr_b32 s48, s23, 1
s_lshl_b32 s48, s48, 5
s_and_b32 s47, s23, 1
s_lshl_b32 s47, s47, 2
s_add_u32 s48, s48, s47
v_add_u32 v4, s48, v3
v_lshlrev_b32 v5, 1, v3
v_xor_b32 v5, v5, v2
v_lshlrev_b32 v5, 4, v5
v_xor_b32 v6, 128, v5
v_lshl_add_u32 v21, v4, 13, v5
v_lshl_add_u32 v22, v4, 13, v6
v_mul_u32_u24 v4, 9216, v4
v_add_u32 v25, v4, v5
v_add_u32 v26, v4, v6
v_add_u32 v23, 129024, v21
v_add_u32 v24, 193536, v22
v_add_u32 v22, 64512, v22
v_add_u32 v27, 145408, v25
v_add_u32 v28, 218112, v26
v_add_u32 v26, 72704, v26
s_mul_i32 s38, s26, 294912
s_mul_i32 s49, s23, 4096
s_add_u32 s38, s38, s49
s_add_u32 s38, s38, 4096
s_mul_i32 s41, s26, 4456448
s_mul_i32 s49, s23, 4096
s_add_u32 s41, s41, s49
s_mov_b32 s36, 0
s_mov_b32 s37, 0
v_lshlrev_b32 v4, 3, v3
v_bfe_u32 v1, v0, 2, 2
v_add_u32 v4, v4, v1
v_add_u32 v4, s48, v4
v_mul_u32_u24 v4, 9216, v4
v_and_b32 v1, 1, v3
v_lshlrev_b32 v1, 1, v1
v_and_b32 v29, 3, v0
v_xor_b32 v1, v1, v29
v_lshl_add_u32 v4, v1, 4, v4
s_lshl_b32 s43, s51, 2
s_and_b32 s47, s52, 3
s_add_u32 s43, s43, s47
s_lshl_b32 s47, s43, 6
s_add_u32 s47, s47, 8192
s_lshl_b32 s49, s25, 8
s_sub_u32 s47, s47, s49
v_add_u32 v29, s47, v4
s_lshl_b32 s27, s25, 19
s_add_u32 s8, s4, s27
s_addc_u32 s9, s5, 0
s_mov_b32 s10, 524288
s_mov_b32 s11, 0x20000
s_add_u32 s12, s6, s27
s_addc_u32 s13, s7, 0
s_mov_b32 s14, 524288
s_mov_b32 s15, 0x20000
s_mov_b32 s58, 256
s_mov_b32 s59, 0x20000
s_mov_b32 s20, 0
s_mov_b32 s21, 0
s_mov_b32 s50, 0
s_lshl_b32 s5, s26, 2
s_add_u32 s5, s5, s51
s_lshl_b32 s5, s5, 2
s_add_u32 s5, s5, s23
s_lshl_b32 s5, s5, 10
s_add_u32 s5, s5, 2621440
s_lshl_b32 s4, s52, 7
s_add_u32 s4, s4, s5
s_lshr_b32 s54, s52, 2
s_and_b32 s7, s52, 4
s_add_u32 s51, s51, s7
s_and_b32 s52, s52, 3
s_lshl_b32 s55, s26, 2
s_add_u32 s55, s55, s52
s_lshl_b32 s6, s55, 2
s_add_u32 s6, s6, s23
s_lshl_b32 s6, s6, 3
s_add_u32 s6, s6, s51
s_lshl_b32 s6, s6, 7
s_add_u32 s6, s6, 2752512
v_add_u32 v4, 0, v3
v_xor_b32 v4, v4, v2
v_lshlrev_b32 v4, 4, v4
v_lshl_add_u32 v30, v3, 8, v4
v_add_u32 v30, s24, v30
v_lshl_add_u32 v36, v2, 8, v4
v_add_u32 v4, 4, v3
v_xor_b32 v4, v4, v2
v_lshlrev_b32 v4, 4, v4
v_lshl_add_u32 v31, v3, 8, v4
v_add_u32 v31, s24, v31
v_lshl_add_u32 v37, v2, 8, v4
v_add_u32 v4, 8, v3
v_xor_b32 v4, v4, v2
v_lshlrev_b32 v4, 4, v4
v_lshl_add_u32 v32, v3, 8, v4
v_add_u32 v32, s24, v32
v_lshl_add_u32 v38, v2, 8, v4
v_add_u32 v4, 12, v3
v_xor_b32 v4, v4, v2
v_lshlrev_b32 v4, 4, v4
v_lshl_add_u32 v33, v3, 8, v4
v_add_u32 v33, s24, v33
v_lshl_add_u32 v39, v2, 8, v4
v_lshl_add_u32 v34, v3, 8, v5
v_add_u32 v34, s24, v34
v_lshl_add_u32 v35, v3, 8, v6
v_add_u32 v35, s24, v35
s_cmp_eq_u32 s23, 3
s_cbranch_scc1 M_w3b
s_waitcnt vmcnt(0)
v_lshlrev_b32 v80, 16, v64
v_and_b32 v81, 0xffff0000, v64
v_lshlrev_b32 v82, 16, v65
v_and_b32 v83, 0xffff0000, v65
v_lshlrev_b32 v84, 16, v66
v_and_b32 v85, 0xffff0000, v66
v_lshlrev_b32 v86, 16, v67
v_and_b32 v87, 0xffff0000, v67
v_lshlrev_b32 v88, 16, v68
v_and_b32 v89, 0xffff0000, v68
v_lshlrev_b32 v90, 16, v69
v_and_b32 v91, 0xffff0000, v69
v_lshlrev_b32 v92, 16, v70
v_and_b32 v93, 0xffff0000, v70
v_lshlrev_b32 v94, 16, v71
v_and_b32 v95, 0xffff0000, v71
v_lshlrev_b32 v96, 16, v72
v_and_b32 v97, 0xffff0000, v72
v_lshlrev_b32 v98, 16, v73
v_and_b32 v99, 0xffff0000, v73
v_lshlrev_b32 v100, 16, v74
v_and_b32 v101, 0xffff0000, v74
v_lshlrev_b32 v102, 16, v75
v_and_b32 v103, 0xffff0000, v75
v_pk_add_f32 v[76:77], v[80:81], v[82:83]
v_pk_add_f32 v[78:79], v[84:85], v[86:87]
v_pk_add_f32 v[76:77], v[76:77], v[88:89]
v_pk_add_f32 v[78:79], v[78:79], v[90:91]
v_pk_add_f32 v[76:77], v[76:77], v[92:93]
v_pk_add_f32 v[78:79], v[78:79], v[94:95]
v_pk_add_f32 v[76:77], v[76:77], v[96:97]
v_pk_add_f32 v[78:79], v[78:79], v[98:99]
v_pk_add_f32 v[76:77], v[76:77], v[100:101]
v_pk_add_f32 v[78:79], v[78:79], v[102:103]
v_pk_add_f32 v[76:77], v[76:77], v[78:79]
v_add_f32 v76, v76, v77
s_nop 1
v_add_f32_dpp v76, v76, v76 row_ror:8 row_mask:0xf bank_mask:0xf
v_mov_b32 v78, v76
s_nop 1
v_permlane16_swap_b32 v76, v78
s_nop 1
v_add_f32 v76, v76, v78
v_mov_b32 v78, v76
s_nop 1
v_permlane32_swap_b32 v76, v78
s_nop 1
v_add_f32 v76, v76, v78
v_mul_f32 v76, 0x3baaaaab, v76
v_pk_add_f32 v[116:117], v[80:81], v[76:77] op_sel_hi:[1,0] neg_lo:[0,1] neg_hi:[0,1]
v_pk_add_f32 v[118:119], v[82:83], v[76:77] op_sel_hi:[1,0] neg_lo:[0,1] neg_hi:[0,1]
v_pk_add_f32 v[120:121], v[84:85], v[76:77] op_sel_hi:[1,0] neg_lo:[0,1] neg_hi:[0,1]
v_pk_add_f32 v[122:123], v[86:87], v[76:77] op_sel_hi:[1,0] neg_lo:[0,1] neg_hi:[0,1]
v_pk_add_f32 v[124:125], v[88:89], v[76:77] op_sel_hi:[1,0] neg_lo:[0,1] neg_hi:[0,1]
v_pk_add_f32 v[126:127], v[90:91], v[76:77] op_sel_hi:[1,0] neg_lo:[0,1] neg_hi:[0,1]
v_pk_add_f32 v[128:129], v[92:93], v[76:77] op_sel_hi:[1,0] neg_lo:[0,1] neg_hi:[0,1]
v_pk_add_f32 v[130:131], v[94:95], v[76:77] op_sel_hi:[1,0] neg_lo:[0,1] neg_hi:[0,1]
v_pk_add_f32 v[132:133], v[96:97], v[76:77] op_sel_hi:[1,0] neg_lo:[0,1] neg_hi:[0,1]
v_pk_add_f32 v[134:135], v[98:99], v[76:77] op_sel_hi:[1,0] neg_lo:[0,1] neg_hi:[0,1]
v_pk_add_f32 v[136:137], v[100:101], v[76:77] op_sel_hi:[1,0] neg_lo:[0,1] neg_hi:[0,1]
v_pk_add_f32 v[138:139], v[102:103], v[76:77] op_sel_hi:[1,0] neg_lo:[0,1] neg_hi:[0,1]
v_pk_mul_f32 v[104:105], v[116:117], v[116:117]
v_pk_mul_f32 v[78:79], v[118:119], v[118:119]
v_pk_fma_f32 v[104:105], v[120:121], v[120:121], v[104:105]
v_pk_fma_f32 v[78:79], v[122:123], v[122:123], v[78:79]
v_pk_fma_f32 v[104:105], v[124:125], v[124:125], v[104:105]
v_pk_fma_f32 v[78:79], v[126:127], v[126:127], v[78:79]
v_pk_fma_f32 v[104:105], v[128:129], v[128:129], v[104:105]
v_pk_fma_f32 v[78:79], v[130:131], v[130:131], v[78:79]
v_pk_fma_f32 v[104:105], v[132:133], v[132:133], v[104:105]
v_pk_fma_f32 v[78:79], v[134:135], v[134:135], v[78:79]
v_pk_fma_f32 v[104:105], v[136:137], v[136:137], v[104:105]
v_pk_fma_f32 v[78:79], v[138:139], v[138:139], v[78:79]
v_pk_add_f32 v[104:105], v[104:105], v[78:79]
v_add_f32 v77, v104, v105
s_nop 1
v_add_f32_dpp v77, v77, v77 row_ror:8 row_mask:0xf bank_mask:0xf
v_mov_b32 v78, v77
s_nop 1
v_permlane16_swap_b32 v77, v78
s_nop 1
v_add_f32 v77, v77, v78
v_mov_b32 v78, v77
s_nop 1
v_permlane32_swap_b32 v77, v78
s_nop 1
v_add_f32 v77, v77, v78
ds_write_b64 v106, v[76:77]
s_waitcnt lgkmcnt(0)
s_barrier
ds_read_b64 v[108:109], v107
ds_read_b64 v[110:111], v107 offset:64
ds_read_b64 v[112:113], v107 offset:128
s_waitcnt lgkmcnt(0)
v_add_f32 v76, v108, v110
v_add_f32 v76, v76, v112
v_mul_f32 v76, 0x3eaaaaab, v76
v_add_f32 v77, v109, v111
v_add_f32 v77, v77, v113
v_sub_f32 v108, v108, v76
v_sub_f32 v110, v110, v76
v_sub_f32 v112, v112, v76
v_mul_f32 v78, v108, v108
v_fmac_f32 v78, v110, v110
v_fmac_f32 v78, v112, v112
v_mul_f32 v77, 0x3ae38e39, v77
v_fmac_f32 v77, 0x3eaaaaab, v78
v_cvt_pk_bf16_f32 v76, v76, v77
v_and_b32 v77, 0xffff0000, v76
v_lshlrev_b32 v76, 16, v76
v_add_f32 v77, 0x3727c5ac, v77
v_cvt_pk_bf16_f32 v77, v77, v77
v_lshlrev_b32 v77, 16, v77
v_sqrt_f32 v77, v77
s_nop 0
v_cvt_pk_bf16_f32 v77, v77, v77
v_lshlrev_b32 v77, 16, v77
v_rcp_f32 v77, v77
s_nop 0
v_pk_add_f32 v[80:81], v[80:81], v[76:77] op_sel_hi:[1,0] neg_lo:[0,1] neg_hi:[0,1]
v_pk_add_f32 v[82:83], v[82:83], v[76:77] op_sel_hi:[1,0] neg_lo:[0,1] neg_hi:[0,1]
v_pk_add_f32 v[84:85], v[84:85], v[76:77] op_sel_hi:[1,0] neg_lo:[0,1] neg_hi:[0,1]
v_pk_add_f32 v[86:87], v[86:87], v[76:77] op_sel_hi:[1,0] neg_lo:[0,1] neg_hi:[0,1]
v_pk_add_f32 v[88:89], v[88:89], v[76:77] op_sel_hi:[1,0] neg_lo:[0,1] neg_hi:[0,1]
v_pk_add_f32 v[90:91], v[90:91], v[76:77] op_sel_hi:[1,0] neg_lo:[0,1] neg_hi:[0,1]
v_pk_add_f32 v[92:93], v[92:93], v[76:77] op_sel_hi:[1,0] neg_lo:[0,1] neg_hi:[0,1]
v_pk_add_f32 v[94:95], v[94:95], v[76:77] op_sel_hi:[1,0] neg_lo:[0,1] neg_hi:[0,1]
v_pk_add_f32 v[96:97], v[96:97], v[76:77] op_sel_hi:[1,0] neg_lo:[0,1] neg_hi:[0,1]
v_pk_add_f32 v[98:99], v[98:99], v[76:77] op_sel_hi:[1,0] neg_lo:[0,1] neg_hi:[0,1]
v_pk_add_f32 v[100:101], v[100:101], v[76:77] op_sel_hi:[1,0] neg_lo:[0,1] neg_hi:[0,1]
v_pk_add_f32 v[102:103], v[102:103], v[76:77] op_sel_hi:[1,0] neg_lo:[0,1] neg_hi:[0,1]
v_cvt_pk_bf16_f32 v64, v80, v81
v_cvt_pk_bf16_f32 v65, v82, v83
v_cvt_pk_bf16_f32 v66, v84, v85
v_cvt_pk_bf16_f32 v67, v86, v87
v_cvt_pk_bf16_f32 v68, v88, v89
v_cvt_pk_bf16_f32 v69, v90, v91
v_cvt_pk_bf16_f32 v70, v92, v93
v_cvt_pk_bf16_f32 v71, v94, v95
v_cvt_pk_bf16_f32 v72, v96, v97
v_cvt_pk_bf16_f32 v73, v98, v99
v_cvt_pk_bf16_f32 v74, v100, v101
v_cvt_pk_bf16_f32 v75, v102, v103
v_lshlrev_b32 v80, 16, v64
v_and_b32 v81, 0xffff0000, v64
v_lshlrev_b32 v82, 16, v65
v_and_b32 v83, 0xffff0000, v65
v_lshlrev_b32 v84, 16, v66
v_and_b32 v85, 0xffff0000, v66
v_lshlrev_b32 v86, 16, v67
v_and_b32 v87, 0xffff0000, v67
v_pk_mul_f32 v[80:81], v[80:81], v[76:77] op_sel:[0,1] op_sel_hi:[1,1]
v_pk_mul_f32 v[82:83], v[82:83], v[76:77] op_sel:[0,1] op_sel_hi:[1,1]
v_pk_mul_f32 v[84:85], v[84:85], v[76:77] op_sel:[0,1] op_sel_hi:[1,1]
v_pk_mul_f32 v[86:87], v[86:87], v[76:77] op_sel:[0,1] op_sel_hi:[1,1]
v_cvt_pk_bf16_f32 v64, v80, v81
v_cvt_pk_bf16_f32 v65, v82, v83
v_cvt_pk_bf16_f32 v66, v84, v85
v_cvt_pk_bf16_f32 v67, v86, v87
s_add_u32 s47, s46, 0
buffer_store_dwordx4 v[64:67], v114, s[16:19], s47 offen sc1
v_lshlrev_b32 v88, 16, v68
v_and_b32 v89, 0xffff0000, v68
v_lshlrev_b32 v90, 16, v69
v_and_b32 v91, 0xffff0000, v69
v_lshlrev_b32 v92, 16, v70
v_and_b32 v93, 0xffff0000, v70
v_lshlrev_b32 v94, 16, v71
v_and_b32 v95, 0xffff0000, v71
v_pk_mul_f32 v[88:89], v[88:89], v[76:77] op_sel:[0,1] op_sel_hi:[1,1]
v_pk_mul_f32 v[90:91], v[90:91], v[76:77] op_sel:[0,1] op_sel_hi:[1,1]
v_pk_mul_f32 v[92:93], v[92:93], v[76:77] op_sel:[0,1] op_sel_hi:[1,1]
v_pk_mul_f32 v[94:95], v[94:95], v[76:77] op_sel:[0,1] op_sel_hi:[1,1]
v_cvt_pk_bf16_f32 v68, v88, v89
v_cvt_pk_bf16_f32 v69, v90, v91
v_cvt_pk_bf16_f32 v70, v92, v93
v_cvt_pk_bf16_f32 v71, v94, v95
s_add_u32 s47, s46, 98304
buffer_store_dwordx4 v[68:71], v114, s[16:19], s47 offen sc1
v_lshlrev_b32 v96, 16, v72
v_and_b32 v97, 0xffff0000, v72
v_lshlrev_b32 v98, 16, v73
v_and_b32 v99, 0xffff0000, v73
v_lshlrev_b32 v100, 16, v74
v_and_b32 v101, 0xffff0000, v74
v_lshlrev_b32 v102, 16, v75
v_and_b32 v103, 0xffff0000, v75
v_pk_mul_f32 v[96:97], v[96:97], v[76:77] op_sel:[0,1] op_sel_hi:[1,1]
v_pk_mul_f32 v[98:99], v[98:99], v[76:77] op_sel:[0,1] op_sel_hi:[1,1]
v_pk_mul_f32 v[100:101], v[100:101], v[76:77] op_sel:[0,1] op_sel_hi:[1,1]
v_pk_mul_f32 v[102:103], v[102:103], v[76:77] op_sel:[0,1] op_sel_hi:[1,1]
v_cvt_pk_bf16_f32 v72, v96, v97
v_cvt_pk_bf16_f32 v73, v98, v99
v_cvt_pk_bf16_f32 v74, v100, v101
v_cvt_pk_bf16_f32 v75, v102, v103
s_add_u32 s47, s46, 196608
buffer_store_dwordx4 v[72:75], v114, s[16:19], s47 offen sc1
v_mov_b32 v1, 0
s_lshl_b32 s49, s26, 5
s_mov_b32 s3, 0x80000
M_np:
buffer_load_dwordx4 v[52:55], v1, s[56:59], s49 offen sc1
s_waitcnt vmcnt(0)
v_and_b32 v53, v53, v55
v_cmp_ne_u32 vcc, 0, v53
s_sub_u32 s3, s3, 1
s_cbranch_scc1 M_ng
s_cbranch_vccz M_np
M_ng:
ds_write2_b32 v1, v52, v54 offset0:128 offset1:129
s_waitcnt lgkmcnt(0)
s_branch M_w3b_b
M_w3b:
s_barrier
M_w3b_b:
s_barrier
v_mov_b32 v1, 0
ds_read_b64 v[2:3], v1 offset:512
v_or_b32 v1, s23, v0
v_min_u32 v1, 1, v1
v_lshlrev_b32 v1, 28, v1
s_lshl_b32 s48, s26, 12
s_add_u32 s48, s48, 2883584
s_lshl_b32 s47, s25, 7
s_add_u32 s47, s47, s48
s_waitcnt lgkmcnt(0)
buffer_store_dwordx2 v[2:3], v1, s[16:19], s47 offen sc1
v_readfirstlane_b32 s66, v2
v_readfirstlane_b32 s67, v3
s_add_u32 m0, s24, 32768
s_nop 0
buffer_load_dwordx4 v21, s[28:31], s36 offen offset:0 lds
buffer_load_dwordx4 v22, s[28:31], s36 offen offset:1024 lds
buffer_load_dwordx4 v23, s[28:31], s36 offen offset:2048 lds
buffer_load_dwordx4 v24, s[28:31], s36 offen offset:3072 lds
s_add_u32 s36, s36, 524288
s_add_u32 m0, s24, 114688
s_nop 0
buffer_load_dwordx4 v25, s[32:35], s37 offen offset:0 lds
buffer_load_dwordx4 v26, s[32:35], s37 offen offset:1024 lds
buffer_load_dwordx4 v27, s[32:35], s37 offen offset:2048 lds
buffer_load_dwordx4 v28, s[32:35], s37 offen offset:3072 lds
s_add_u32 m0, s39, 98304
s_nop 0
buffer_load_dwordx4 v29, s[32:35], s37 offen lds
s_add_u32 s37, s37, 589824
s_add_u32 m0, s24, 49152
s_nop 0
buffer_load_dwordx4 v21, s[28:31], s36 offen offset:0 lds
buffer_load_dwordx4 v22, s[28:31], s36 offen offset:1024 lds
buffer_load_dwordx4 v23, s[28:31], s36 offen offset:2048 lds
buffer_load_dwordx4 v24, s[28:31], s36 offen offset:3072 lds
s_add_u32 s36, s36, 524288
v_lshrrev_b32 v1, 2, v0
v_and_b32 v2, 7, v1
v_lshlrev_b32 v2, 1, v2
v_bfe_u32 v3, v0, 1, 1
v_and_b32 v4, 1, v0
v_lshlrev_b32 v4, 3, v4
v_lshl_add_u32 v4, v1, 8, v4
v_add_u32 v4, 65536, v4
v_add_u32 v5, 0, v3
v_xor_b32 v5, v5, v2
v_lshl_add_u32 v40, v5, 4, v4
v_add_u32 v8, 49152, v40
v_add_u32 v5, 2, v3
v_xor_b32 v5, v5, v2
v_lshl_add_u32 v41, v5, 4, v4
v_add_u32 v9, 49152, v41
v_add_u32 v5, 4, v3
v_xor_b32 v5, v5, v2
v_lshl_add_u32 v42, v5, 4, v4
v_add_u32 v10, 49152, v42
v_add_u32 v5, 6, v3
v_xor_b32 v5, v5, v2
v_lshl_add_u32 v43, v5, 4, v4
v_add_u32 v11, 49152, v43
v_add_u32 v5, 8, v3
v_xor_b32 v5, v5, v2
v_lshl_add_u32 v44, v5, 4, v4
v_add_u32 v12, 49152, v44
v_add_u32 v5, 10, v3
v_xor_b32 v5, v5, v2
v_lshl_add_u32 v45, v5, 4, v4
v_add_u32 v13, 49152, v45
v_add_u32 v5, 12, v3
v_xor_b32 v5, v5, v2
v_lshl_add_u32 v46, v5, 4, v4
v_add_u32 v14, 49152, v46
v_add_u32 v5, 14, v3
v_xor_b32 v5, v5, v2
v_lshl_add_u32 v47, v5, 4, v4
v_add_u32 v15, 49152, v47
v_and_b32 v3, 3, v0
v_lshlrev_b32 v4, 8, v1
v_add_u32 v4, 32768, v4
v_add_u32 v5, 0, v3
v_xor_b32 v5, v5, v2
v_lshl_add_u32 v16, v5, 4, v4
v_add_u32 v5, 4, v3
v_xor_b32 v5, v5, v2
v_lshl_add_u32 v17, v5, 4, v4
v_add_u32 v5, 8, v3
v_xor_b32 v5, v5, v2
v_lshl_add_u32 v18, v5, 4, v4
v_add_u32 v5, 12, v3
v_xor_b32 v5, v5, v2
v_lshl_add_u32 v19, v5, 4, v4
v_lshlrev_b32 v4, 6, v1
v_lshl_add_u32 v4, v3, 3, v4
v_bfe_u32 v5, v0, 4, 1
v_lshl_add_u32 v4, v5, 5, v4
v_add_u32 v20, 98304, v4
v_xor_b32 v6, 32, v20
s_mul_i32 s53, s25, 65536
s_add_u32 s53, s53, s41
s_add_u32 s53, s53, 23068672
s_add_u32 s42, s53, 2097152
s_add_u32 s43, s43, 256
s_mul_i32 s43, s43, 16384
s_add_u32 s43, s43, s41
s_add_u32 s43, s43, 23068672
s_mov_b32 s45, 0x3e0293ee
v_and_b32 v1, 31, v0
v_lshlrev_b32 v1, 7, v1
s_mov_b32 s3, 0x80000
M_lnp:
buffer_load_dwordx2 v[2:3], v1, s[16:19], s48 offen sc1
s_waitcnt vmcnt(0)
v_cmp_eq_u64 vcc, s[66:67], v[2:3]
s_sub_u32 s3, s3, 1
s_cbranch_scc1 M_lng
s_cmp_eq_u64 vcc, exec
s_cbranch_scc0 M_lnp
M_lng:
buffer_load_dwordx4 a[112:115], v7, s[16:19], s38 offen offset:0 sc1
buffer_load_dwordx4 a[116:119], v7, s[16:19], s38 offen offset:1024 sc1
buffer_load_dwordx4 a[120:123], v7, s[16:19], s38 offen offset:2048 sc1
buffer_load_dwordx4 a[124:127], v7, s[16:19], s38 offen offset:3072 sc1
s_add_u32 s38, s38, 16384
buffer_load_dwordx4 a[128:131], v7, s[16:19], s38 offen offset:0 sc1
buffer_load_dwordx4 a[132:135], v7, s[16:19], s38 offen offset:1024 sc1
buffer_load_dwordx4 a[136:139], v7, s[16:19], s38 offen offset:2048 sc1
buffer_load_dwordx4 a[140:143], v7, s[16:19], s38 offen offset:3072 sc1
s_add_u32 s38, s38, 16384
buffer_load_dwordx4 a[144:147], v7, s[16:19], s38 offen offset:0 sc1
buffer_load_dwordx4 a[148:151], v7, s[16:19], s38 offen offset:1024 sc1
buffer_load_dwordx4 a[152:155], v7, s[16:19], s38 offen offset:2048 sc1
buffer_load_dwordx4 a[156:159], v7, s[16:19], s38 offen offset:3072 sc1
s_add_u32 s38, s38, 16384
buffer_load_dwordx4 a[160:163], v7, s[16:19], s38 offen offset:0 sc1
buffer_load_dwordx4 a[164:167], v7, s[16:19], s38 offen offset:1024 sc1
buffer_load_dwordx4 a[168:171], v7, s[16:19], s38 offen offset:2048 sc1
buffer_load_dwordx4 a[172:175], v7, s[16:19], s38 offen offset:3072 sc1
s_add_u32 s38, s38, 16384
s_cmp_eq_u32 s54, 0
s_cbranch_scc1 M_p1f
s_waitcnt vmcnt(26)
s_barrier
ds_read_b64_tr_b16 a[80:81], v16 offset:0
ds_read_b64_tr_b16 a[82:83], v16 offset:4096
ds_read_b64_tr_b16 a[84:85], v16 offset:8192
ds_read_b64_tr_b16 a[86:87], v16 offset:12288
ds_read_b64_tr_b16 a[88:89], v16 offset:8
ds_read_b64_tr_b16 a[90:91], v16 offset:4104
ds_read_b64_tr_b16 a[92:93], v16 offset:8200
ds_read_b64_tr_b16 a[94:95], v16 offset:12296
s_waitcnt vmcnt(8) lgkmcnt(4)
v_mfma_f32_16x16x32_bf16 v[128:131], a[80:83], a[112:115], 0
s_add_u32 m0, s24, 131072
buffer_load_dwordx4 a[176:179], v7, s[16:19], s38 offen offset:0 sc1
v_mfma_f32_16x16x32_bf16 v[128:131], a[84:87], a[128:131], v[128:131]
ds_read_b64_tr_b16 a[96:97], v17 offset:0
ds_read_b64_tr_b16 a[98:99], v17 offset:4096
v_mfma_f32_16x16x32_bf16 v[136:139], a[84:87], a[132:135], 0
ds_read_b64_tr_b16 a[100:101], v17 offset:8192
ds_read_b64_tr_b16 a[102:103], v17 offset:12288
v_mfma_f32_16x16x32_bf16 v[136:139], a[80:83], a[116:119], v[136:139]
v_mfma_f32_16x16x32_bf16 v[144:147], a[80:83], a[120:123], 0
v_mfma_f32_16x16x32_bf16 v[144:147], a[84:87], a[136:139], v[144:147]
buffer_load_dwordx4 v25, s[32:35], s37 offen offset:0 lds
v_mfma_f32_16x16x32_bf16 v[152:155], a[84:87], a[140:143], 0
v_mfma_f32_16x16x32_bf16 v[152:155], a[80:83], a[124:127], v[152:155]
s_waitcnt lgkmcnt(4)
v_mfma_f32_16x16x32_bf16 v[156:159], a[88:91], a[124:127], 0
ds_read_b64_tr_b16 a[104:105], v17 offset:8
ds_read_b64_tr_b16 a[106:107], v17 offset:4104
v_mfma_f32_16x16x32_bf16 v[156:159], a[92:95], a[140:143], v[156:159]
ds_read_b64_tr_b16 a[108:109], v17 offset:8200
ds_read_b64_tr_b16 a[110:111], v17 offset:12296
v_mfma_f32_16x16x32_bf16 v[148:151], a[92:95], a[136:139], 0
buffer_load_dwordx4 v26, s[32:35], s37 offen offset:1024 lds
v_mfma_f32_16x16x32_bf16 v[148:151], a[88:91], a[120:123], v[148:151]
v_mfma_f32_16x16x32_bf16 v[140:143], a[88:91], a[116:119], 0
v_mfma_f32_16x16x32_bf16 v[140:143], a[92:95], a[132:135], v[140:143]
v_mfma_f32_16x16x32_bf16 v[132:135], a[92:95], a[128:131], 0
v_mfma_f32_16x16x32_bf16 v[132:135], a[88:91], a[112:115], v[132:135]
s_waitcnt lgkmcnt(4)
buffer_load_dwordx4 v27, s[32:35], s37 offen offset:2048 lds
v_mfma_f32_16x16x32_bf16 v[160:163], a[96:99], a[112:115], 0
ds_read_b64_tr_b16 a[240:241], v18 offset:0
ds_read_b64_tr_b16 a[242:243], v18 offset:4096
v_mfma_f32_16x16x32_bf16 v[160:163], a[100:103], a[128:131], v[160:163]
ds_read_b64_tr_b16 a[244:245], v18 offset:8192
ds_read_b64_tr_b16 a[246:247], v18 offset:12288
v_mfma_f32_16x16x32_bf16 v[168:171], a[100:103], a[132:135], 0
v_mfma_f32_16x16x32_bf16 v[168:171], a[96:99], a[116:119], v[168:171]
v_mfma_f32_16x16x32_bf16 v[176:179], a[96:99], a[120:123], 0
buffer_load_dwordx4 v28, s[32:35], s37 offen offset:3072 lds
v_mfma_f32_16x16x32_bf16 v[176:179], a[100:103], a[136:139], v[176:179]
s_add_u32 m0, s39, 102400
v_mfma_f32_16x16x32_bf16 v[184:187], a[100:103], a[140:143], 0
v_mfma_f32_16x16x32_bf16 v[184:187], a[96:99], a[124:127], v[184:187]
s_waitcnt lgkmcnt(4)
v_mfma_f32_16x16x32_bf16 v[188:191], a[104:107], a[124:127], 0
ds_read_b64_tr_b16 a[248:249], v18 offset:8
ds_read_b64_tr_b16 a[250:251], v18 offset:4104
v_mfma_f32_16x16x32_bf16 v[188:191], a[108:111], a[140:143], v[188:191]
buffer_load_dwordx4 v29, s[32:35], s37 offen lds
v_mfma_f32_16x16x32_bf16 v[180:183], a[108:111], a[136:139], 0
s_add_u32 s37, s37, 589824
s_add_u32 m0, s24, 65536
ds_read_b64_tr_b16 a[252:253], v18 offset:8200
v_mfma_f32_16x16x32_bf16 v[180:183], a[104:107], a[120:123], v[180:183]
ds_read_b64_tr_b16 a[254:255], v18 offset:12296
v_mfma_f32_16x16x32_bf16 v[172:175], a[104:107], a[116:119], 0
v_mfma_f32_16x16x32_bf16 v[172:175], a[108:111], a[132:135], v[172:175]
v_mfma_f32_16x16x32_bf16 v[164:167], a[108:111], a[128:131], 0
buffer_load_dwordx4 a[180:183], v7, s[16:19], s38 offen offset:1024 sc1
v_mfma_f32_16x16x32_bf16 v[164:167], a[104:107], a[112:115], v[164:167]
s_waitcnt lgkmcnt(4)
v_mfma_f32_16x16x32_bf16 v[192:195], a[240:243], a[112:115], 0
ds_read_b64_tr_b16 a[80:81], v19 offset:0
ds_read_b64_tr_b16 a[82:83], v19 offset:4096
v_mfma_f32_16x16x32_bf16 v[192:195], a[244:247], a[128:131], v[192:195]
ds_read_b64_tr_b16 a[84:85], v19 offset:8192
ds_read_b64_tr_b16 a[86:87], v19 offset:12288
v_mfma_f32_16x16x32_bf16 v[200:203], a[244:247], a[132:135], 0
v_mfma_f32_16x16x32_bf16 v[200:203], a[240:243], a[116:119], v[200:203]
buffer_load_dwordx4 a[184:187], v7, s[16:19], s38 offen offset:2048 sc1
v_mfma_f32_16x16x32_bf16 v[208:211], a[240:243], a[120:123], 0
v_mfma_f32_16x16x32_bf16 v[208:211], a[244:247], a[136:139], v[208:211]
v_mfma_f32_16x16x32_bf16 v[216:219], a[244:247], a[140:143], 0
v_mfma_f32_16x16x32_bf16 v[216:219], a[240:243], a[124:127], v[216:219]
s_waitcnt lgkmcnt(4)
v_mfma_f32_16x16x32_bf16 v[220:223], a[248:251], a[124:127], 0
buffer_load_dwordx4 a[188:191], v7, s[16:19], s38 offen offset:3072 sc1
v_mfma_f32_16x16x32_bf16 v[220:223], a[252:255], a[140:143], v[220:223]
s_add_u32 s38, s38, 16384
ds_read_b64_tr_b16 a[88:89], v19 offset:8
ds_read_b64_tr_b16 a[90:91], v19 offset:4104
v_mfma_f32_16x16x32_bf16 v[212:215], a[252:255], a[136:139], 0
ds_read_b64_tr_b16 a[92:93], v19 offset:8200
ds_read_b64_tr_b16 a[94:95], v19 offset:12296
v_mfma_f32_16x16x32_bf16 v[212:215], a[248:251], a[120:123], v[212:215]
v_mfma_f32_16x16x32_bf16 v[204:207], a[248:251], a[116:119], 0
v_mfma_f32_16x16x32_bf16 v[204:207], a[252:255], a[132:135], v[204:207]
buffer_load_dwordx4 v21, s[28:31], s36 offen offset:0 lds
v_mfma_f32_16x16x32_bf16 v[196:199], a[252:255], a[128:131], 0
v_mfma_f32_16x16x32_bf16 v[196:199], a[248:251], a[112:115], v[196:199]
s_waitcnt lgkmcnt(4)
v_mfma_f32_16x16x32_bf16 v[224:227], a[80:83], a[112:115], 0
s_waitcnt vmcnt(18) lgkmcnt(0)
s_barrier
ds_read_b64_tr_b16 a[96:97], v20 offset:0
v_mfma_f32_16x16x32_bf16 v[224:227], a[84:87], a[128:131], v[224:227]
ds_read_b64_tr_b16 a[98:99], v20 offset:1024
ds_read_b64_tr_b16 a[100:101], v20 offset:2048
v_mfma_f32_16x16x32_bf16 v[232:235], a[84:87], a[132:135], 0
buffer_load_dwordx4 a[192:195], v7, s[16:19], s38 offen offset:0 sc1
v_mfma_f32_16x16x32_bf16 v[232:235], a[80:83], a[116:119], v[232:235]
ds_read_b64_tr_b16 a[102:103], v20 offset:3072
v_mfma_f32_16x16x32_bf16 v[240:243], a[80:83], a[120:123], 0
v_mfma_f32_16x16x32_bf16 v[240:243], a[84:87], a[136:139], v[240:243]
v_mfma_f32_16x16x32_bf16 v[248:251], a[84:87], a[140:143], 0
v_mfma_f32_16x16x32_bf16 v[248:251], a[80:83], a[124:127], v[248:251]
s_waitcnt lgkmcnt(4)
buffer_load_dwordx4 v22, s[28:31], s36 offen offset:1024 lds
v_mfma_f32_16x16x32_bf16 v[252:255], a[88:91], a[124:127], 0
ds_read_b64_tr_b16 a[104:105], v6 offset:0
ds_read_b64_tr_b16 a[106:107], v6 offset:1024
v_mfma_f32_16x16x32_bf16 v[252:255], a[92:95], a[140:143], v[252:255]
ds_read_b64_tr_b16 a[108:109], v6 offset:2048
ds_read_b64_tr_b16 a[110:111], v6 offset:3072
v_mfma_f32_16x16x32_bf16 v[244:247], a[92:95], a[136:139], 0
v_mfma_f32_16x16x32_bf16 v[244:247], a[88:91], a[120:123], v[244:247]
v_mfma_f32_16x16x32_bf16 v[236:239], a[88:91], a[116:119], 0
buffer_load_dwordx4 a[196:199], v7, s[16:19], s38 offen offset:1024 sc1
v_mfma_f32_16x16x32_bf16 v[236:239], a[92:95], a[132:135], v[236:239]
v_mfma_f32_16x16x32_bf16 v[228:231], a[92:95], a[128:131], 0
v_mfma_f32_16x16x32_bf16 v[228:231], a[88:91], a[112:115], v[228:231]
s_waitcnt lgkmcnt(4)
v_mfma_f32_16x16x32_bf16 a[64:67], a[96:99], a[112:115], 0
ds_read_b64_tr_b16 a[240:241], v8 offset:0
ds_read_b64_tr_b16 a[242:243], v8 offset:4096
v_mfma_f32_16x16x32_bf16 a[64:67], a[100:103], a[128:131], a[64:67]
buffer_load_dwordx4 v23, s[28:31], s36 offen offset:2048 lds
v_mfma_f32_16x16x32_bf16 a[68:71], a[100:103], a[132:135], 0
ds_read_b64_tr_b16 a[244:245], v8 offset:8192
ds_read_b64_tr_b16 a[246:247], v8 offset:12288
v_mfma_f32_16x16x32_bf16 a[68:71], a[96:99], a[116:119], a[68:71]
v_mfma_f32_16x16x32_bf16 a[72:75], a[96:99], a[120:123], 0
v_mfma_f32_16x16x32_bf16 a[72:75], a[100:103], a[136:139], a[72:75]
v_mfma_f32_16x16x32_bf16 a[76:79], a[100:103], a[140:143], 0
buffer_load_dwordx4 a[200:203], v7, s[16:19], s38 offen offset:2048 sc1
v_mfma_f32_16x16x32_bf16 a[76:79], a[96:99], a[124:127], a[76:79]
s_waitcnt lgkmcnt(4)
v_mfma_f32_16x16x32_bf16 v[60:63], a[104:107], a[124:127], 0
ds_read_b64_tr_b16 a[248:249], v9 offset:0
ds_read_b64_tr_b16 a[250:251], v9 offset:4096
v_mfma_f32_16x16x32_bf16 v[60:63], a[108:111], a[140:143], v[60:63]
ds_read_b64_tr_b16 a[252:253], v9 offset:8192
ds_read_b64_tr_b16 a[254:255], v9 offset:12288
v_mfma_f32_16x16x32_bf16 v[56:59], a[108:111], a[136:139], 0
v_mfma_f32_16x16x32_bf16 v[56:59], a[104:107], a[120:123], v[56:59]
buffer_load_dwordx4 v24, s[28:31], s36 offen offset:3072 lds
v_mfma_f32_16x16x32_bf16 v[52:55], a[104:107], a[116:119], 0
s_add_u32 s36, s36, 524288
s_add_u32 m0, s24, 147456
v_mfma_f32_16x16x32_bf16 v[52:55], a[108:111], a[132:135], v[52:55]
v_mfma_f32_16x16x32_bf16 v[48:51], a[108:111], a[128:131], 0
v_mfma_f32_16x16x32_bf16 v[48:51], a[104:107], a[112:115], v[48:51]
s_waitcnt lgkmcnt(4)
v_mfma_f32_16x16x32_bf16 v[64:67], a[240:243], a[112:115], 0
buffer_load_dwordx4 a[204:207], v7, s[16:19], s38 offen offset:3072 sc1
v_mfma_f32_16x16x32_bf16 v[64:67], a[244:247], a[128:131], v[64:67]
s_add_u32 s38, s38, 16384
ds_read_b64_tr_b16 a[80:81], v10 offset:0
ds_read_b64_tr_b16 a[82:83], v10 offset:4096
v_mfma_f32_16x16x32_bf16 v[72:75], a[244:247], a[132:135], 0
ds_read_b64_tr_b16 a[84:85], v10 offset:8192
ds_read_b64_tr_b16 a[86:87], v10 offset:12288
v_mfma_f32_16x16x32_bf16 v[72:75], a[240:243], a[116:119], v[72:75]
v_mfma_f32_16x16x32_bf16 v[80:83], a[240:243], a[120:123], 0
v_mfma_f32_16x16x32_bf16 v[80:83], a[244:247], a[136:139], v[80:83]
buffer_load_dwordx4 v25, s[32:35], s37 offen offset:0 lds
v_mfma_f32_16x16x32_bf16 v[88:91], a[244:247], a[140:143], 0
v_mfma_f32_16x16x32_bf16 v[88:91], a[240:243], a[124:127], v[88:91]
s_waitcnt lgkmcnt(4)
v_mfma_f32_16x16x32_bf16 v[92:95], a[248:251], a[124:127], 0
ds_read_b64_tr_b16 a[88:89], v11 offset:0
ds_read_b64_tr_b16 a[90:91], v11 offset:4096
v_mfma_f32_16x16x32_bf16 v[92:95], a[252:255], a[140:143], v[92:95]
ds_read_b64_tr_b16 a[92:93], v11 offset:8192
ds_read_b64_tr_b16 a[94:95], v11 offset:12288
v_mfma_f32_16x16x32_bf16 v[84:87], a[252:255], a[136:139], 0
buffer_load_dwordx4 v26, s[32:35], s37 offen offset:1024 lds
v_mfma_f32_16x16x32_bf16 v[84:87], a[248:251], a[120:123], v[84:87]
v_mfma_f32_16x16x32_bf16 v[76:79], a[248:251], a[116:119], 0
v_mfma_f32_16x16x32_bf16 v[76:79], a[252:255], a[132:135], v[76:79]
v_mfma_f32_16x16x32_bf16 v[68:71], a[252:255], a[128:131], 0
v_mfma_f32_16x16x32_bf16 v[68:71], a[248:251], a[112:115], v[68:71]
s_waitcnt lgkmcnt(4)
buffer_load_dwordx4 v27, s[32:35], s37 offen offset:2048 lds
v_mfma_f32_16x16x32_bf16 a[0:3], a[80:83], a[112:115], 0
ds_read_b64_tr_b16 a[96:97], v12 offset:0
ds_read_b64_tr_b16 a[98:99], v12 offset:4096
v_mfma_f32_16x16x32_bf16 a[0:3], a[84:87], a[128:131], a[0:3]
ds_read_b64_tr_b16 a[100:101], v12 offset:8192
ds_read_b64_tr_b16 a[102:103], v12 offset:12288
v_mfma_f32_16x16x32_bf16 a[8:11], a[84:87], a[132:135], 0
v_mfma_f32_16x16x32_bf16 a[8:11], a[80:83], a[116:119], a[8:11]
v_mfma_f32_16x16x32_bf16 a[16:19], a[80:83], a[120:123], 0
buffer_load_dwordx4 v28, s[32:35], s37 offen offset:3072 lds
v_mfma_f32_16x16x32_bf16 a[16:19], a[84:87], a[136:139], a[16:19]
s_add_u32 m0, s39, 106496
v_mfma_f32_16x16x32_bf16 a[24:27], a[84:87], a[140:143], 0
v_mfma_f32_16x16x32_bf16 a[24:27], a[80:83], a[124:127], a[24:27]
s_waitcnt lgkmcnt(4)
v_mfma_f32_16x16x32_bf16 a[28:31], a[88:91], a[124:127], 0
ds_read_b64_tr_b16 a[104:105], v13 offset:0
ds_read_b64_tr_b16 a[106:107], v13 offset:4096
v_mfma_f32_16x16x32_bf16 a[28:31], a[92:95], a[140:143], a[28:31]
buffer_load_dwordx4 v29, s[32:35], s37 offen lds
v_mfma_f32_16x16x32_bf16 a[20:23], a[92:95], a[136:139], 0
s_add_u32 s37, s37, 589824
s_add_u32 m0, s24, 32768
ds_read_b64_tr_b16 a[108:109], v13 offset:8192
v_mfma_f32_16x16x32_bf16 a[20:23], a[88:91], a[120:123], a[20:23]
ds_read_b64_tr_b16 a[110:111], v13 offset:12288
v_mfma_f32_16x16x32_bf16 a[12:15], a[88:91], a[116:119], 0
v_mfma_f32_16x16x32_bf16 a[12:15], a[92:95], a[132:135], a[12:15]
v_mfma_f32_16x16x32_bf16 a[4:7], a[92:95], a[128:131], 0
buffer_load_dwordx4 a[208:211], v7, s[16:19], s38 offen offset:0 sc1
v_mfma_f32_16x16x32_bf16 a[4:7], a[88:91], a[112:115], a[4:7]
s_waitcnt lgkmcnt(4)
v_mfma_f32_16x16x32_bf16 a[32:35], a[96:99], a[112:115], 0
ds_read_b64_tr_b16 a[240:241], v14 offset:0
ds_read_b64_tr_b16 a[242:243], v14 offset:4096
v_mfma_f32_16x16x32_bf16 a[32:35], a[100:103], a[128:131], a[32:35]
ds_read_b64_tr_b16 a[244:245], v14 offset:8192
ds_read_b64_tr_b16 a[246:247], v14 offset:12288
v_mfma_f32_16x16x32_bf16 a[40:43], a[100:103], a[132:135], 0
v_mfma_f32_16x16x32_bf16 a[40:43], a[96:99], a[116:119], a[40:43]
buffer_load_dwordx4 a[212:215], v7, s[16:19], s38 offen offset:1024 sc1
v_mfma_f32_16x16x32_bf16 a[48:51], a[96:99], a[120:123], 0
v_mfma_f32_16x16x32_bf16 a[48:51], a[100:103], a[136:139], a[48:51]
v_mfma_f32_16x16x32_bf16 a[56:59], a[100:103], a[140:143], 0
v_mfma_f32_16x16x32_bf16 a[56:59], a[96:99], a[124:127], a[56:59]
s_waitcnt lgkmcnt(4)
v_mfma_f32_16x16x32_bf16 a[60:63], a[104:107], a[124:127], 0
buffer_load_dwordx4 a[216:219], v7, s[16:19], s38 offen offset:2048 sc1
v_mfma_f32_16x16x32_bf16 a[60:63], a[108:111], a[140:143], a[60:63]
ds_read_b64_tr_b16 a[248:249], v15 offset:0
ds_read_b64_tr_b16 a[250:251], v15 offset:4096
v_mfma_f32_16x16x32_bf16 a[52:55], a[108:111], a[136:139], 0
ds_read_b64_tr_b16 a[252:253], v15 offset:8192
ds_read_b64_tr_b16 a[254:255], v15 offset:12288
v_mfma_f32_16x16x32_bf16 a[52:55], a[104:107], a[120:123], a[52:55]
v_mfma_f32_16x16x32_bf16 a[44:47], a[104:107], a[116:119], 0
v_mfma_f32_16x16x32_bf16 a[44:47], a[108:111], a[132:135], a[44:47]
buffer_load_dwordx4 a[220:223], v7, s[16:19], s38 offen offset:3072 sc1
v_mfma_f32_16x16x32_bf16 a[36:39], a[108:111], a[128:131], 0
s_add_u32 s38, s38, 16384
v_mfma_f32_16x16x32_bf16 a[36:39], a[104:107], a[112:115], a[36:39]
s_waitcnt lgkmcnt(4)
v_mfma_f32_16x16x32_bf16 v[96:99], a[240:243], a[112:115], 0
s_waitcnt vmcnt(26) lgkmcnt(0)
s_barrier
ds_read_b64_tr_b16 a[80:81], v16 offset:16384
v_mfma_f32_16x16x32_bf16 v[96:99], a[244:247], a[128:131], v[96:99]
ds_read_b64_tr_b16 a[82:83], v16 offset:20480
ds_read_b64_tr_b16 a[84:85], v16 offset:24576
v_mfma_f32_16x16x32_bf16 v[104:107], a[244:247], a[132:135], 0
buffer_load_dwordx4 v21, s[28:31], s36 offen offset:0 lds
v_mfma_f32_16x16x32_bf16 v[104:107], a[240:243], a[116:119], v[104:107]
ds_read_b64_tr_b16 a[86:87], v16 offset:28672
v_mfma_f32_16x16x32_bf16 v[112:115], a[240:243], a[120:123], 0
v_mfma_f32_16x16x32_bf16 v[112:115], a[244:247], a[136:139], v[112:115]
v_mfma_f32_16x16x32_bf16 v[120:123], a[244:247], a[140:143], 0
v_mfma_f32_16x16x32_bf16 v[120:123], a[240:243], a[124:127], v[120:123]
s_waitcnt lgkmcnt(4)
buffer_load_dwordx4 a[224:227], v7, s[16:19], s38 offen offset:0 sc1
v_mfma_f32_16x16x32_bf16 v[124:127], a[248:251], a[124:127], 0
ds_read_b64_tr_b16 a[88:89], v16 offset:16392
ds_read_b64_tr_b16 a[90:91], v16 offset:20488
v_mfma_f32_16x16x32_bf16 v[124:127], a[252:255], a[140:143], v[124:127]
ds_read_b64_tr_b16 a[92:93], v16 offset:24584
ds_read_b64_tr_b16 a[94:95], v16 offset:28680
v_mfma_f32_16x16x32_bf16 v[116:119], a[252:255], a[136:139], 0
v_mfma_f32_16x16x32_bf16 v[116:119], a[248:251], a[120:123], v[116:119]
v_mfma_f32_16x16x32_bf16 v[108:111], a[248:251], a[116:119], 0
buffer_load_dwordx4 v22, s[28:31], s36 offen offset:1024 lds
v_mfma_f32_16x16x32_bf16 v[108:111], a[252:255], a[132:135], v[108:111]
v_mfma_f32_16x16x32_bf16 v[100:103], a[252:255], a[128:131], 0
v_mfma_f32_16x16x32_bf16 v[100:103], a[248:251], a[112:115], v[100:103]
s_waitcnt lgkmcnt(4)
v_mfma_f32_16x16x32_bf16 v[128:131], a[80:83], a[144:147], v[128:131]
ds_read_b64_tr_b16 a[96:97], v17 offset:16384
ds_read_b64_tr_b16 a[98:99], v17 offset:20480
v_mfma_f32_16x16x32_bf16 v[128:131], a[84:87], a[160:163], v[128:131]
buffer_load_dwordx4 a[228:231], v7, s[16:19], s38 offen offset:1024 sc1
v_mfma_f32_16x16x32_bf16 v[136:139], a[84:87], a[164:167], v[136:139]
ds_read_b64_tr_b16 a[100:101], v17 offset:24576
ds_read_b64_tr_b16 a[102:103], v17 offset:28672
v_mfma_f32_16x16x32_bf16 v[136:139], a[80:83], a[148:151], v[136:139]
v_mfma_f32_16x16x32_bf16 v[144:147], a[80:83], a[152:155], v[144:147]
v_mfma_f32_16x16x32_bf16 v[144:147], a[84:87], a[168:171], v[144:147]
v_mfma_f32_16x16x32_bf16 v[152:155], a[84:87], a[172:175], v[152:155]
buffer_load_dwordx4 v23, s[28:31], s36 offen offset:2048 lds
v_mfma_f32_16x16x32_bf16 v[152:155], a[80:83], a[156:159], v[152:155]
s_waitcnt lgkmcnt(4)
v_mfma_f32_16x16x32_bf16 v[156:159], a[88:91], a[156:159], v[156:159]
ds_read_b64_tr_b16 a[104:105], v17 offset:16392
ds_read_b64_tr_b16 a[106:107], v17 offset:20488
v_mfma_f32_16x16x32_bf16 v[156:159], a[92:95], a[172:175], v[156:159]
ds_read_b64_tr_b16 a[108:109], v17 offset:24584
ds_read_b64_tr_b16 a[110:111], v17 offset:28680
v_mfma_f32_16x16x32_bf16 v[148:151], a[92:95], a[168:171], v[148:151]
v_mfma_f32_16x16x32_bf16 v[148:151], a[88:91], a[152:155], v[148:151]
buffer_load_dwordx4 a[232:235], v7, s[16:19], s38 offen offset:2048 sc1
v_mfma_f32_16x16x32_bf16 v[140:143], a[88:91], a[148:151], v[140:143]
v_mfma_f32_16x16x32_bf16 v[140:143], a[92:95], a[164:167], v[140:143]
v_mfma_f32_16x16x32_bf16 v[132:135], a[92:95], a[160:163], v[132:135]
v_mfma_f32_16x16x32_bf16 v[132:135], a[88:91], a[144:147], v[132:135]
s_waitcnt lgkmcnt(4)
v_mfma_f32_16x16x32_bf16 v[160:163], a[96:99], a[144:147], v[160:163]
buffer_load_dwordx4 v24, s[28:31], s36 offen offset:3072 lds
v_mfma_f32_16x16x32_bf16 v[160:163], a[100:103], a[160:163], v[160:163]
s_add_u32 s36, s36, 524288
s_add_u32 m0, s24, 114688
ds_read_b64_tr_b16 a[240:241], v18 offset:16384
v_mfma_f32_16x16x32_bf16 v[168:171], a[100:103], a[164:167], v[168:171]
ds_read_b64_tr_b16 a[242:243], v18 offset:20480
ds_read_b64_tr_b16 a[244:245], v18 offset:24576
v_mfma_f32_16x16x32_bf16 v[168:171], a[96:99], a[148:151], v[168:171]
ds_read_b64_tr_b16 a[246:247], v18 offset:28672
v_mfma_f32_16x16x32_bf16 v[176:179], a[96:99], a[152:155], v[176:179]
v_mfma_f32_16x16x32_bf16 v[176:179], a[100:103], a[168:171], v[176:179]
buffer_load_dwordx4 a[236:239], v7, s[16:19], s38 offen offset:3072 sc1
v_mfma_f32_16x16x32_bf16 v[184:187], a[100:103], a[172:175], v[184:187]
s_add_u32 s38, s38, 16384
v_mfma_f32_16x16x32_bf16 v[184:187], a[96:99], a[156:159], v[184:187]
s_waitcnt lgkmcnt(4)
v_mfma_f32_16x16x32_bf16 v[188:191], a[104:107], a[156:159], v[188:191]
ds_read_b64_tr_b16 a[248:249], v18 offset:16392
ds_read_b64_tr_b16 a[250:251], v18 offset:20488
v_mfma_f32_16x16x32_bf16 v[188:191], a[108:111], a[172:175], v[188:191]
ds_read_b64_tr_b16 a[252:253], v18 offset:24584
ds_read_b64_tr_b16 a[254:255], v18 offset:28680
v_mfma_f32_16x16x32_bf16 v[180:183], a[108:111], a[168:171], v[180:183]
buffer_load_dwordx4 v25, s[32:35], s37 offen offset:0 lds
v_mfma_f32_16x16x32_bf16 v[180:183], a[104:107], a[152:155], v[180:183]
v_mfma_f32_16x16x32_bf16 v[172:175], a[104:107], a[148:151], v[172:175]
v_mfma_f32_16x16x32_bf16 v[172:175], a[108:111], a[164:167], v[172:175]
v_mfma_f32_16x16x32_bf16 v[164:167], a[108:111], a[160:163], v[164:167]
v_mfma_f32_16x16x32_bf16 v[164:167], a[104:107], a[144:147], v[164:167]
s_waitcnt lgkmcnt(4)
buffer_load_dwordx4 v26, s[32:35], s37 offen offset:1024 lds
v_mfma_f32_16x16x32_bf16 v[192:195], a[240:243], a[144:147], v[192:195]
ds_read_b64_tr_b16 a[80:81], v19 offset:16384
ds_read_b64_tr_b16 a[82:83], v19 offset:20480
v_mfma_f32_16x16x32_bf16 v[192:195], a[244:247], a[160:163], v[192:195]
ds_read_b64_tr_b16 a[84:85], v19 offset:24576
ds_read_b64_tr_b16 a[86:87], v19 offset:28672
v_mfma_f32_16x16x32_bf16 v[200:203], a[244:247], a[164:167], v[200:203]
v_mfma_f32_16x16x32_bf16 v[200:203], a[240:243], a[148:151], v[200:203]
v_mfma_f32_16x16x32_bf16 v[208:211], a[240:243], a[152:155], v[208:211]
buffer_load_dwordx4 v27, s[32:35], s37 offen offset:2048 lds
v_mfma_f32_16x16x32_bf16 v[208:211], a[244:247], a[168:171], v[208:211]
v_mfma_f32_16x16x32_bf16 v[216:219], a[244:247], a[172:175], v[216:219]
v_mfma_f32_16x16x32_bf16 v[216:219], a[240:243], a[156:159], v[216:219]
s_waitcnt lgkmcnt(4)
v_mfma_f32_16x16x32_bf16 v[220:223], a[248:251], a[156:159], v[220:223]
ds_read_b64_tr_b16 a[88:89], v19 offset:16392
ds_read_b64_tr_b16 a[90:91], v19 offset:20488
v_mfma_f32_16x16x32_bf16 v[220:223], a[252:255], a[172:175], v[220:223]
buffer_load_dwordx4 v28, s[32:35], s37 offen offset:3072 lds
v_mfma_f32_16x16x32_bf16 v[212:215], a[252:255], a[168:171], v[212:215]
s_add_u32 m0, s39, 110592
ds_read_b64_tr_b16 a[92:93], v19 offset:24584
ds_read_b64_tr_b16 a[94:95], v19 offset:28680
v_mfma_f32_16x16x32_bf16 v[212:215], a[248:251], a[152:155], v[212:215]
v_mfma_f32_16x16x32_bf16 v[204:207], a[248:251], a[148:151], v[204:207]
v_mfma_f32_16x16x32_bf16 v[204:207], a[252:255], a[164:167], v[204:207]
v_mfma_f32_16x16x32_bf16 v[196:199], a[252:255], a[160:163], v[196:199]
buffer_load_dwordx4 v29, s[32:35], s37 offen lds
v_mfma_f32_16x16x32_bf16 v[196:199], a[248:251], a[144:147], v[196:199]
s_waitcnt lgkmcnt(4)
s_add_u32 s37, s37, 589824
v_mfma_f32_16x16x32_bf16 v[224:227], a[80:83], a[144:147], v[224:227]
s_waitcnt vmcnt(33) lgkmcnt(0)
s_barrier
ds_read_b64_tr_b16 a[96:97], v20 offset:4096
v_mfma_f32_16x16x32_bf16 v[224:227], a[84:87], a[160:163], v[224:227]
s_add_u32 m0, s24, 49152
ds_read_b64_tr_b16 a[98:99], v20 offset:5120
ds_read_b64_tr_b16 a[100:101], v20 offset:6144
v_mfma_f32_16x16x32_bf16 v[232:235], a[84:87], a[164:167], v[232:235]
ds_read_b64_tr_b16 a[102:103], v20 offset:7168
v_mfma_f32_16x16x32_bf16 v[232:235], a[80:83], a[148:151], v[232:235]
buffer_load_dwordx4 a[112:115], v7, s[16:19], s38 offen offset:0 sc1
v_mfma_f32_16x16x32_bf16 v[240:243], a[80:83], a[152:155], v[240:243]
v_mfma_f32_16x16x32_bf16 v[240:243], a[84:87], a[168:171], v[240:243]
v_mfma_f32_16x16x32_bf16 v[248:251], a[84:87], a[172:175], v[248:251]
v_mfma_f32_16x16x32_bf16 v[248:251], a[80:83], a[156:159], v[248:251]
s_waitcnt lgkmcnt(4)
v_mfma_f32_16x16x32_bf16 v[252:255], a[88:91], a[156:159], v[252:255]
buffer_load_dwordx4 a[116:119], v7, s[16:19], s38 offen offset:1024 sc1
v_mfma_f32_16x16x32_bf16 v[252:255], a[92:95], a[172:175], v[252:255]
ds_read_b64_tr_b16 a[104:105], v6 offset:4096
ds_read_b64_tr_b16 a[106:107], v6 offset:5120
v_mfma_f32_16x16x32_bf16 v[244:247], a[92:95], a[168:171], v[244:247]
ds_read_b64_tr_b16 a[108:109], v6 offset:6144
ds_read_b64_tr_b16 a[110:111], v6 offset:7168
v_mfma_f32_16x16x32_bf16 v[244:247], a[88:91], a[152:155], v[244:247]
v_mfma_f32_16x16x32_bf16 v[236:239], a[88:91], a[148:151], v[236:239]
v_mfma_f32_16x16x32_bf16 v[236:239], a[92:95], a[164:167], v[236:239]
buffer_load_dwordx4 a[120:123], v7, s[16:19], s38 offen offset:2048 sc1
v_mfma_f32_16x16x32_bf16 v[228:231], a[92:95], a[160:163], v[228:231]
v_mfma_f32_16x16x32_bf16 v[228:231], a[88:91], a[144:147], v[228:231]
s_waitcnt lgkmcnt(4)
v_mfma_f32_16x16x32_bf16 a[64:67], a[96:99], a[144:147], a[64:67]
ds_read_b64_tr_b16 a[240:241], v8 offset:16384
ds_read_b64_tr_b16 a[242:243], v8 offset:20480
v_mfma_f32_16x16x32_bf16 a[64:67], a[100:103], a[160:163], a[64:67]
ds_read_b64_tr_b16 a[244:245], v8 offset:24576
ds_read_b64_tr_b16 a[246:247], v8 offset:28672
v_mfma_f32_16x16x32_bf16 a[68:71], a[100:103], a[164:167], a[68:71]
buffer_load_dwordx4 a[124:127], v7, s[16:19], s38 offen offset:3072 sc1
v_mfma_f32_16x16x32_bf16 a[68:71], a[96:99], a[148:151], a[68:71]
s_add_u32 s38, s38, 16384
v_mfma_f32_16x16x32_bf16 a[72:75], a[96:99], a[152:155], a[72:75]
v_mfma_f32_16x16x32_bf16 a[72:75], a[100:103], a[168:171], a[72:75]
v_mfma_f32_16x16x32_bf16 a[76:79], a[100:103], a[172:175], a[76:79]
v_mfma_f32_16x16x32_bf16 a[76:79], a[96:99], a[156:159], a[76:79]
s_waitcnt lgkmcnt(4)
buffer_load_dwordx4 v21, s[28:31], s36 offen offset:0 lds
v_mfma_f32_16x16x32_bf16 v[60:63], a[104:107], a[156:159], v[60:63]
ds_read_b64_tr_b16 a[248:249], v9 offset:16384
ds_read_b64_tr_b16 a[250:251], v9 offset:20480
v_mfma_f32_16x16x32_bf16 v[60:63], a[108:111], a[172:175], v[60:63]
ds_read_b64_tr_b16 a[252:253], v9 offset:24576
ds_read_b64_tr_b16 a[254:255], v9 offset:28672
v_mfma_f32_16x16x32_bf16 v[56:59], a[108:111], a[168:171], v[56:59]
v_mfma_f32_16x16x32_bf16 v[56:59], a[104:107], a[152:155], v[56:59]
v_mfma_f32_16x16x32_bf16 v[52:55], a[104:107], a[148:151], v[52:55]
buffer_load_dwordx4 a[128:131], v7, s[16:19], s38 offen offset:0 sc1
v_mfma_f32_16x16x32_bf16 v[52:55], a[108:111], a[164:167], v[52:55]
v_mfma_f32_16x16x32_bf16 v[48:51], a[108:111], a[160:163], v[48:51]
v_mfma_f32_16x16x32_bf16 v[48:51], a[104:107], a[144:147], v[48:51]
s_waitcnt lgkmcnt(4)
v_mfma_f32_16x16x32_bf16 v[64:67], a[240:243], a[144:147], v[64:67]
ds_read_b64_tr_b16 a[80:81], v10 offset:16384
ds_read_b64_tr_b16 a[82:83], v10 offset:20480
v_mfma_f32_16x16x32_bf16 v[64:67], a[244:247], a[160:163], v[64:67]
buffer_load_dwordx4 v22, s[28:31], s36 offen offset:1024 lds
v_mfma_f32_16x16x32_bf16 v[72:75], a[244:247], a[164:167], v[72:75]
ds_read_b64_tr_b16 a[84:85], v10 offset:24576
ds_read_b64_tr_b16 a[86:87], v10 offset:28672
v_mfma_f32_16x16x32_bf16 v[72:75], a[240:243], a[148:151], v[72:75]
v_mfma_f32_16x16x32_bf16 v[80:83], a[240:243], a[152:155], v[80:83]
v_mfma_f32_16x16x32_bf16 v[80:83], a[244:247], a[168:171], v[80:83]
v_mfma_f32_16x16x32_bf16 v[88:91], a[244:247], a[172:175], v[88:91]
buffer_load_dwordx4 a[132:135], v7, s[16:19], s38 offen offset:1024 sc1
v_mfma_f32_16x16x32_bf16 v[88:91], a[240:243], a[156:159], v[88:91]
s_waitcnt lgkmcnt(4)
v_mfma_f32_16x16x32_bf16 v[92:95], a[248:251], a[156:159], v[92:95]
ds_read_b64_tr_b16 a[88:89], v11 offset:16384
ds_read_b64_tr_b16 a[90:91], v11 offset:20480
v_mfma_f32_16x16x32_bf16 v[92:95], a[252:255], a[172:175], v[92:95]
ds_read_b64_tr_b16 a[92:93], v11 offset:24576
ds_read_b64_tr_b16 a[94:95], v11 offset:28672
v_mfma_f32_16x16x32_bf16 v[84:87], a[252:255], a[168:171], v[84:87]
v_mfma_f32_16x16x32_bf16 v[84:87], a[248:251], a[152:155], v[84:87]
buffer_load_dwordx4 v23, s[28:31], s36 offen offset:2048 lds
v_mfma_f32_16x16x32_bf16 v[76:79], a[248:251], a[148:151], v[76:79]
v_mfma_f32_16x16x32_bf16 v[76:79], a[252:255], a[164:167], v[76:79]
v_mfma_f32_16x16x32_bf16 v[68:71], a[252:255], a[160:163], v[68:71]
v_mfma_f32_16x16x32_bf16 v[68:71], a[248:251], a[144:147], v[68:71]
s_waitcnt lgkmcnt(4)
v_mfma_f32_16x16x32_bf16 a[0:3], a[80:83], a[144:147], a[0:3]
buffer_load_dwordx4 a[136:139], v7, s[16:19], s38 offen offset:2048 sc1
v_mfma_f32_16x16x32_bf16 a[0:3], a[84:87], a[160:163], a[0:3]
ds_read_b64_tr_b16 a[96:97], v12 offset:16384
ds_read_b64_tr_b16 a[98:99], v12 offset:20480
v_mfma_f32_16x16x32_bf16 a[8:11], a[84:87], a[164:167], a[8:11]
ds_read_b64_tr_b16 a[100:101], v12 offset:24576
ds_read_b64_tr_b16 a[102:103], v12 offset:28672
v_mfma_f32_16x16x32_bf16 a[8:11], a[80:83], a[148:151], a[8:11]
v_mfma_f32_16x16x32_bf16 a[16:19], a[80:83], a[152:155], a[16:19]
v_mfma_f32_16x16x32_bf16 a[16:19], a[84:87], a[168:171], a[16:19]
buffer_load_dwordx4 v24, s[28:31], s36 offen offset:3072 lds
v_mfma_f32_16x16x32_bf16 a[24:27], a[84:87], a[172:175], a[24:27]
s_add_u32 s36, s36, 524288
v_mfma_f32_16x16x32_bf16 a[24:27], a[80:83], a[156:159], a[24:27]
s_waitcnt lgkmcnt(4)
v_mfma_f32_16x16x32_bf16 a[28:31], a[88:91], a[156:159], a[28:31]
ds_read_b64_tr_b16 a[104:105], v13 offset:16384
ds_read_b64_tr_b16 a[106:107], v13 offset:20480
v_mfma_f32_16x16x32_bf16 a[28:31], a[92:95], a[172:175], a[28:31]
ds_read_b64_tr_b16 a[108:109], v13 offset:24576
ds_read_b64_tr_b16 a[110:111], v13 offset:28672
v_mfma_f32_16x16x32_bf16 a[20:23], a[92:95], a[168:171], a[20:23]
buffer_load_dwordx4 a[140:143], v7, s[16:19], s38 offen offset:3072 sc1
v_mfma_f32_16x16x32_bf16 a[20:23], a[88:91], a[152:155], a[20:23]
s_add_u32 s38, s38, 16384
v_mfma_f32_16x16x32_bf16 a[12:15], a[88:91], a[148:151], a[12:15]
v_mfma_f32_16x16x32_bf16 a[12:15], a[92:95], a[164:167], a[12:15]
v_mfma_f32_16x16x32_bf16 a[4:7], a[92:95], a[160:163], a[4:7]
v_mfma_f32_16x16x32_bf16 a[4:7], a[88:91], a[144:147], a[4:7]
s_waitcnt lgkmcnt(4)
v_mfma_f32_16x16x32_bf16 a[32:35], a[96:99], a[144:147], a[32:35]
ds_read_b64_tr_b16 a[240:241], v14 offset:16384
ds_read_b64_tr_b16 a[242:243], v14 offset:20480
v_mfma_f32_16x16x32_bf16 a[32:35], a[100:103], a[160:163], a[32:35]
ds_read_b64_tr_b16 a[244:245], v14 offset:24576
ds_read_b64_tr_b16 a[246:247], v14 offset:28672
v_mfma_f32_16x16x32_bf16 a[40:43], a[100:103], a[164:167], a[40:43]
v_mfma_f32_16x16x32_bf16 a[40:43], a[96:99], a[148:151], a[40:43]
v_mfma_f32_16x16x32_bf16 a[48:51], a[96:99], a[152:155], a[48:51]
v_mfma_f32_16x16x32_bf16 a[48:51], a[100:103], a[168:171], a[48:51]
v_mfma_f32_16x16x32_bf16 a[56:59], a[100:103], a[172:175], a[56:59]
v_mfma_f32_16x16x32_bf16 a[56:59], a[96:99], a[156:159], a[56:59]
s_waitcnt lgkmcnt(4)
v_mfma_f32_16x16x32_bf16 a[60:63], a[104:107], a[156:159], a[60:63]
ds_read_b64_tr_b16 a[248:249], v15 offset:16384
ds_read_b64_tr_b16 a[250:251], v15 offset:20480
v_mfma_f32_16x16x32_bf16 a[60:63], a[108:111], a[172:175], a[60:63]
ds_read_b64_tr_b16 a[252:253], v15 offset:24576
ds_read_b64_tr_b16 a[254:255], v15 offset:28672
v_mfma_f32_16x16x32_bf16 a[52:55], a[108:111], a[168:171], a[52:55]
v_mfma_f32_16x16x32_bf16 a[52:55], a[104:107], a[152:155], a[52:55]
v_mfma_f32_16x16x32_bf16 a[44:47], a[104:107], a[148:151], a[44:47]
v_mfma_f32_16x16x32_bf16 a[44:47], a[108:111], a[164:167], a[44:47]
v_mfma_f32_16x16x32_bf16 a[36:39], a[108:111], a[160:163], a[36:39]
v_mfma_f32_16x16x32_bf16 a[36:39], a[104:107], a[144:147], a[36:39]
s_waitcnt lgkmcnt(4)
v_mfma_f32_16x16x32_bf16 v[96:99], a[240:243], a[144:147], v[96:99]
s_waitcnt vmcnt(34) lgkmcnt(0)
s_barrier
ds_read_b64_tr_b16 a[80:81], v16 offset:32768
v_mfma_f32_16x16x32_bf16 v[96:99], a[244:247], a[160:163], v[96:99]
s_add_u32 m0, s24, 131072
ds_read_b64_tr_b16 a[82:83], v16 offset:36864
ds_read_b64_tr_b16 a[84:85], v16 offset:40960
v_mfma_f32_16x16x32_bf16 v[104:107], a[244:247], a[164:167], v[104:107]
buffer_load_dwordx4 v25, s[32:35], s37 offen offset:0 lds
v_mfma_f32_16x16x32_bf16 v[104:107], a[240:243], a[148:151], v[104:107]
ds_read_b64_tr_b16 a[86:87], v16 offset:45056
v_mfma_f32_16x16x32_bf16 v[112:115], a[240:243], a[152:155], v[112:115]
v_mfma_f32_16x16x32_bf16 v[112:115], a[244:247], a[168:171], v[112:115]
v_mfma_f32_16x16x32_bf16 v[120:123], a[244:247], a[172:175], v[120:123]
buffer_load_dwordx4 v26, s[32:35], s37 offen offset:1024 lds
v_mfma_f32_16x16x32_bf16 v[120:123], a[240:243], a[156:159], v[120:123]
s_waitcnt lgkmcnt(4)
v_mfma_f32_16x16x32_bf16 v[124:127], a[248:251], a[156:159], v[124:127]
ds_read_b64_tr_b16 a[88:89], v16 offset:32776
ds_read_b64_tr_b16 a[90:91], v16 offset:36872
v_mfma_f32_16x16x32_bf16 v[124:127], a[252:255], a[172:175], v[124:127]
ds_read_b64_tr_b16 a[92:93], v16 offset:40968
ds_read_b64_tr_b16 a[94:95], v16 offset:45064
v_mfma_f32_16x16x32_bf16 v[116:119], a[252:255], a[168:171], v[116:119]
v_mfma_f32_16x16x32_bf16 v[116:119], a[248:251], a[152:155], v[116:119]
buffer_load_dwordx4 v27, s[32:35], s37 offen offset:2048 lds
v_mfma_f32_16x16x32_bf16 v[108:111], a[248:251], a[148:151], v[108:111]
v_mfma_f32_16x16x32_bf16 v[108:111], a[252:255], a[164:167], v[108:111]
v_mfma_f32_16x16x32_bf16 v[100:103], a[252:255], a[160:163], v[100:103]
v_mfma_f32_16x16x32_bf16 v[100:103], a[248:251], a[144:147], v[100:103]
s_waitcnt lgkmcnt(4)
v_mfma_f32_16x16x32_bf16 v[128:131], a[80:83], a[176:179], v[128:131]
buffer_load_dwordx4 v28, s[32:35], s37 offen offset:3072 lds
v_mfma_f32_16x16x32_bf16 v[128:131], a[84:87], a[192:195], v[128:131]
s_add_u32 m0, s39, 98304
ds_read_b64_tr_b16 a[96:97], v17 offset:32768
ds_read_b64_tr_b16 a[98:99], v17 offset:36864
v_mfma_f32_16x16x32_bf16 v[136:139], a[84:87], a[196:199], v[136:139]
ds_read_b64_tr_b16 a[100:101], v17 offset:40960
ds_read_b64_tr_b16 a[102:103], v17 offset:45056
v_mfma_f32_16x16x32_bf16 v[136:139], a[80:83], a[180:183], v[136:139]
v_mfma_f32_16x16x32_bf16 v[144:147], a[80:83], a[184:187], v[144:147]
v_mfma_f32_16x16x32_bf16 v[144:147], a[84:87], a[200:203], v[144:147]
buffer_load_dwordx4 v29, s[32:35], s37 offen lds
v_mfma_f32_16x16x32_bf16 v[152:155], a[84:87], a[204:207], v[152:155]
s_add_u32 s37, s37, 589824
v_mfma_f32_16x16x32_bf16 v[152:155], a[80:83], a[188:191], v[152:155]
s_waitcnt lgkmcnt(4)
v_mfma_f32_16x16x32_bf16 v[156:159], a[88:91], a[188:191], v[156:159]
ds_read_b64_tr_b16 a[104:105], v17 offset:32776
ds_read_b64_tr_b16 a[106:107], v17 offset:36872
v_mfma_f32_16x16x32_bf16 v[156:159], a[92:95], a[204:207], v[156:159]
ds_read_b64_tr_b16 a[108:109], v17 offset:40968
ds_read_b64_tr_b16 a[110:111], v17 offset:45064
v_mfma_f32_16x16x32_bf16 v[148:151], a[92:95], a[200:203], v[148:151]
buffer_load_dwordx4 a[144:147], v7, s[16:19], s38 offen offset:0 sc1
v_mfma_f32_16x16x32_bf16 v[148:151], a[88:91], a[184:187], v[148:151]
v_mfma_f32_16x16x32_bf16 v[140:143], a[88:91], a[180:183], v[140:143]
v_mfma_f32_16x16x32_bf16 v[140:143], a[92:95], a[196:199], v[140:143]
v_mfma_f32_16x16x32_bf16 v[132:135], a[92:95], a[192:195], v[132:135]
v_mfma_f32_16x16x32_bf16 v[132:135], a[88:91], a[176:179], v[132:135]
s_waitcnt lgkmcnt(4)
buffer_load_dwordx4 a[148:151], v7, s[16:19], s38 offen offset:1024 sc1
v_mfma_f32_16x16x32_bf16 v[160:163], a[96:99], a[176:179], v[160:163]
ds_read_b64_tr_b16 a[240:241], v18 offset:32768
ds_read_b64_tr_b16 a[242:243], v18 offset:36864
v_mfma_f32_16x16x32_bf16 v[160:163], a[100:103], a[192:195], v[160:163]
ds_read_b64_tr_b16 a[244:245], v18 offset:40960
ds_read_b64_tr_b16 a[246:247], v18 offset:45056
v_mfma_f32_16x16x32_bf16 v[168:171], a[100:103], a[196:199], v[168:171]
v_mfma_f32_16x16x32_bf16 v[168:171], a[96:99], a[180:183], v[168:171]
v_mfma_f32_16x16x32_bf16 v[176:179], a[96:99], a[184:187], v[176:179]
buffer_load_dwordx4 a[152:155], v7, s[16:19], s38 offen offset:2048 sc1
v_mfma_f32_16x16x32_bf16 v[176:179], a[100:103], a[200:203], v[176:179]
v_mfma_f32_16x16x32_bf16 v[184:187], a[100:103], a[204:207], v[184:187]
v_mfma_f32_16x16x32_bf16 v[184:187], a[96:99], a[188:191], v[184:187]
s_waitcnt lgkmcnt(4)
v_mfma_f32_16x16x32_bf16 v[188:191], a[104:107], a[188:191], v[188:191]
ds_read_b64_tr_b16 a[248:249], v18 offset:32776
ds_read_b64_tr_b16 a[250:251], v18 offset:36872
v_mfma_f32_16x16x32_bf16 v[188:191], a[108:111], a[204:207], v[188:191]
buffer_load_dwordx4 a[156:159], v7, s[16:19], s38 offen offset:3072 sc1
v_mfma_f32_16x16x32_bf16 v[180:183], a[108:111], a[200:203], v[180:183]
s_add_u32 s38, s38, 16384
ds_read_b64_tr_b16 a[252:253], v18 offset:40968
ds_read_b64_tr_b16 a[254:255], v18 offset:45064
v_mfma_f32_16x16x32_bf16 v[180:183], a[104:107], a[184:187], v[180:183]
v_mfma_f32_16x16x32_bf16 v[172:175], a[104:107], a[180:183], v[172:175]
v_mfma_f32_16x16x32_bf16 v[172:175], a[108:111], a[196:199], v[172:175]
v_mfma_f32_16x16x32_bf16 v[164:167], a[108:111], a[192:195], v[164:167]
buffer_load_dwordx4 a[160:163], v7, s[16:19], s38 offen offset:0 sc1
v_mfma_f32_16x16x32_bf16 v[164:167], a[104:107], a[176:179], v[164:167]
s_waitcnt lgkmcnt(4)
v_mfma_f32_16x16x32_bf16 v[192:195], a[240:243], a[176:179], v[192:195]
ds_read_b64_tr_b16 a[80:81], v19 offset:32768
ds_read_b64_tr_b16 a[82:83], v19 offset:36864
v_mfma_f32_16x16x32_bf16 v[192:195], a[244:247], a[192:195], v[192:195]
ds_read_b64_tr_b16 a[84:85], v19 offset:40960
ds_read_b64_tr_b16 a[86:87], v19 offset:45056
v_mfma_f32_16x16x32_bf16 v[200:203], a[244:247], a[196:199], v[200:203]
v_mfma_f32_16x16x32_bf16 v[200:203], a[240:243], a[180:183], v[200:203]
buffer_load_dwordx4 a[164:167], v7, s[16:19], s38 offen offset:1024 sc1
v_mfma_f32_16x16x32_bf16 v[208:211], a[240:243], a[184:187], v[208:211]
v_mfma_f32_16x16x32_bf16 v[208:211], a[244:247], a[200:203], v[208:211]
v_mfma_f32_16x16x32_bf16 v[216:219], a[244:247], a[204:207], v[216:219]
v_mfma_f32_16x16x32_bf16 v[216:219], a[240:243], a[188:191], v[216:219]
s_waitcnt lgkmcnt(4)
v_mfma_f32_16x16x32_bf16 v[220:223], a[248:251], a[188:191], v[220:223]
buffer_load_dwordx4 a[168:171], v7, s[16:19], s38 offen offset:2048 sc1
v_mfma_f32_16x16x32_bf16 v[220:223], a[252:255], a[204:207], v[220:223]
ds_read_b64_tr_b16 a[88:89], v19 offset:32776
ds_read_b64_tr_b16 a[90:91], v19 offset:36872
v_mfma_f32_16x16x32_bf16 v[212:215], a[252:255], a[200:203], v[212:215]
ds_read_b64_tr_b16 a[92:93], v19 offset:40968
ds_read_b64_tr_b16 a[94:95], v19 offset:45064
v_mfma_f32_16x16x32_bf16 v[212:215], a[248:251], a[184:187], v[212:215]
v_mfma_f32_16x16x32_bf16 v[204:207], a[248:251], a[180:183], v[204:207]
v_mfma_f32_16x16x32_bf16 v[204:207], a[252:255], a[196:199], v[204:207]
buffer_load_dwordx4 a[172:175], v7, s[16:19], s38 offen offset:3072 sc1
v_mfma_f32_16x16x32_bf16 v[196:199], a[252:255], a[192:195], v[196:199]
s_add_u32 s38, s38, 16384
v_mfma_f32_16x16x32_bf16 v[196:199], a[248:251], a[176:179], v[196:199]
s_waitcnt lgkmcnt(4)
v_mfma_f32_16x16x32_bf16 v[224:227], a[80:83], a[176:179], v[224:227]
s_waitcnt vmcnt(42) lgkmcnt(0)
s_barrier
ds_read_b64_tr_b16 a[96:97], v20 offset:8192
v_mfma_f32_16x16x32_bf16 v[224:227], a[84:87], a[192:195], v[224:227]
s_add_u32 m0, s24, 65536
ds_read_b64_tr_b16 a[98:99], v20 offset:9216
ds_read_b64_tr_b16 a[100:101], v20 offset:10240
v_mfma_f32_16x16x32_bf16 v[232:235], a[84:87], a[196:199], v[232:235]
buffer_load_dwordx4 v21, s[28:31], s36 offen offset:0 lds
v_mfma_f32_16x16x32_bf16 v[232:235], a[80:83], a[180:183], v[232:235]
ds_read_b64_tr_b16 a[102:103], v20 offset:11264
v_mfma_f32_16x16x32_bf16 v[240:243], a[80:83], a[184:187], v[240:243]
v_mfma_f32_16x16x32_bf16 v[240:243], a[84:87], a[200:203], v[240:243]
v_mfma_f32_16x16x32_bf16 v[248:251], a[84:87], a[204:207], v[248:251]
v_mfma_f32_16x16x32_bf16 v[248:251], a[80:83], a[188:191], v[248:251]
s_waitcnt lgkmcnt(4)
buffer_load_dwordx4 v22, s[28:31], s36 offen offset:1024 lds
v_mfma_f32_16x16x32_bf16 v[252:255], a[88:91], a[188:191], v[252:255]
ds_read_b64_tr_b16 a[104:105], v6 offset:8192
ds_read_b64_tr_b16 a[106:107], v6 offset:9216
v_mfma_f32_16x16x32_bf16 v[252:255], a[92:95], a[204:207], v[252:255]
ds_read_b64_tr_b16 a[108:109], v6 offset:10240
ds_read_b64_tr_b16 a[110:111], v6 offset:11264
v_mfma_f32_16x16x32_bf16 v[244:247], a[92:95], a[200:203], v[244:247]
v_mfma_f32_16x16x32_bf16 v[244:247], a[88:91], a[184:187], v[244:247]
v_mfma_f32_16x16x32_bf16 v[236:239], a[88:91], a[180:183], v[236:239]
buffer_load_dwordx4 v23, s[28:31], s36 offen offset:2048 lds
v_mfma_f32_16x16x32_bf16 v[236:239], a[92:95], a[196:199], v[236:239]
v_mfma_f32_16x16x32_bf16 v[228:231], a[92:95], a[192:195], v[228:231]
v_mfma_f32_16x16x32_bf16 v[228:231], a[88:91], a[176:179], v[228:231]
s_waitcnt lgkmcnt(4)
v_mfma_f32_16x16x32_bf16 a[64:67], a[96:99], a[176:179], a[64:67]
ds_read_b64_tr_b16 a[240:241], v8 offset:32768
ds_read_b64_tr_b16 a[242:243], v8 offset:36864
v_mfma_f32_16x16x32_bf16 a[64:67], a[100:103], a[192:195], a[64:67]
buffer_load_dwordx4 v24, s[28:31], s36 offen offset:3072 lds
v_mfma_f32_16x16x32_bf16 a[68:71], a[100:103], a[196:199], a[68:71]
s_add_u32 s36, s36, 524288
ds_read_b64_tr_b16 a[244:245], v8 offset:40960
ds_read_b64_tr_b16 a[246:247], v8 offset:45056
v_mfma_f32_16x16x32_bf16 a[68:71], a[96:99], a[180:183], a[68:71]
v_mfma_f32_16x16x32_bf16 a[72:75], a[96:99], a[184:187], a[72:75]
v_mfma_f32_16x16x32_bf16 a[72:75], a[100:103], a[200:203], a[72:75]
v_mfma_f32_16x16x32_bf16 a[76:79], a[100:103], a[204:207], a[76:79]
v_mfma_f32_16x16x32_bf16 a[76:79], a[96:99], a[188:191], a[76:79]
s_waitcnt lgkmcnt(4)
v_mfma_f32_16x16x32_bf16 v[60:63], a[104:107], a[188:191], v[60:63]
ds_read_b64_tr_b16 a[248:249], v9 offset:32768
ds_read_b64_tr_b16 a[250:251], v9 offset:36864
v_mfma_f32_16x16x32_bf16 v[60:63], a[108:111], a[204:207], v[60:63]
ds_read_b64_tr_b16 a[252:253], v9 offset:40960
ds_read_b64_tr_b16 a[254:255], v9 offset:45056
v_mfma_f32_16x16x32_bf16 v[56:59], a[108:111], a[200:203], v[56:59]
v_mfma_f32_16x16x32_bf16 v[56:59], a[104:107], a[184:187], v[56:59]
v_mfma_f32_16x16x32_bf16 v[52:55], a[104:107], a[180:183], v[52:55]
v_mfma_f32_16x16x32_bf16 v[52:55], a[108:111], a[196:199], v[52:55]
v_mfma_f32_16x16x32_bf16 v[48:51], a[108:111], a[192:195], v[48:51]
v_mfma_f32_16x16x32_bf16 v[48:51], a[104:107], a[176:179], v[48:51]
s_waitcnt lgkmcnt(4)
v_mfma_f32_16x16x32_bf16 v[64:67], a[240:243], a[176:179], v[64:67]
ds_read_b64_tr_b16 a[80:81], v10 offset:32768
ds_read_b64_tr_b16 a[82:83], v10 offset:36864
v_mfma_f32_16x16x32_bf16 v[64:67], a[244:247], a[192:195], v[64:67]
ds_read_b64_tr_b16 a[84:85], v10 offset:40960
ds_read_b64_tr_b16 a[86:87], v10 offset:45056
v_mfma_f32_16x16x32_bf16 v[72:75], a[244:247], a[196:199], v[72:75]
v_mfma_f32_16x16x32_bf16 v[72:75], a[240:243], a[180:183], v[72:75]
v_mfma_f32_16x16x32_bf16 v[80:83], a[240:243], a[184:187], v[80:83]
v_mfma_f32_16x16x32_bf16 v[80:83], a[244:247], a[200:203], v[80:83]
v_mfma_f32_16x16x32_bf16 v[88:91], a[244:247], a[204:207], v[88:91]
v_mfma_f32_16x16x32_bf16 v[88:91], a[240:243], a[188:191], v[88:91]
s_waitcnt lgkmcnt(4)
v_mfma_f32_16x16x32_bf16 v[92:95], a[248:251], a[188:191], v[92:95]
ds_read_b64_tr_b16 a[88:89], v11 offset:32768
ds_read_b64_tr_b16 a[90:91], v11 offset:36864
v_mfma_f32_16x16x32_bf16 v[92:95], a[252:255], a[204:207], v[92:95]
ds_read_b64_tr_b16 a[92:93], v11 offset:40960
ds_read_b64_tr_b16 a[94:95], v11 offset:45056
v_mfma_f32_16x16x32_bf16 v[84:87], a[252:255], a[200:203], v[84:87]
v_mfma_f32_16x16x32_bf16 v[84:87], a[248:251], a[184:187], v[84:87]
v_mfma_f32_16x16x32_bf16 v[76:79], a[248:251], a[180:183], v[76:79]
v_mfma_f32_16x16x32_bf16 v[76:79], a[252:255], a[196:199], v[76:79]
v_mfma_f32_16x16x32_bf16 v[68:71], a[252:255], a[192:195], v[68:71]
v_mfma_f32_16x16x32_bf16 v[68:71], a[248:251], a[176:179], v[68:71]
s_waitcnt lgkmcnt(4)
v_mfma_f32_16x16x32_bf16 a[0:3], a[80:83], a[176:179], a[0:3]
ds_read_b64_tr_b16 a[96:97], v12 offset:32768
ds_read_b64_tr_b16 a[98:99], v12 offset:36864
v_mfma_f32_16x16x32_bf16 a[0:3], a[84:87], a[192:195], a[0:3]
ds_read_b64_tr_b16 a[100:101], v12 offset:40960
ds_read_b64_tr_b16 a[102:103], v12 offset:45056
v_mfma_f32_16x16x32_bf16 a[8:11], a[84:87], a[196:199], a[8:11]
v_mfma_f32_16x16x32_bf16 a[8:11], a[80:83], a[180:183], a[8:11]
v_mfma_f32_16x16x32_bf16 a[16:19], a[80:83], a[184:187], a[16:19]
v_mfma_f32_16x16x32_bf16 a[16:19], a[84:87], a[200:203], a[16:19]
v_mfma_f32_16x16x32_bf16 a[24:27], a[84:87], a[204:207], a[24:27]
v_mfma_f32_16x16x32_bf16 a[24:27], a[80:83], a[188:191], a[24:27]
s_waitcnt lgkmcnt(4)
v_mfma_f32_16x16x32_bf16 a[28:31], a[88:91], a[188:191], a[28:31]
ds_read_b64_tr_b16 a[104:105], v13 offset:32768
ds_read_b64_tr_b16 a[106:107], v13 offset:36864
v_mfma_f32_16x16x32_bf16 a[28:31], a[92:95], a[204:207], a[28:31]
ds_read_b64_tr_b16 a[108:109], v13 offset:40960
ds_read_b64_tr_b16 a[110:111], v13 offset:45056
v_mfma_f32_16x16x32_bf16 a[20:23], a[92:95], a[200:203], a[20:23]
v_mfma_f32_16x16x32_bf16 a[20:23], a[88:91], a[184:187], a[20:23]
v_mfma_f32_16x16x32_bf16 a[12:15], a[88:91], a[180:183], a[12:15]
v_mfma_f32_16x16x32_bf16 a[12:15], a[92:95], a[196:199], a[12:15]
v_mfma_f32_16x16x32_bf16 a[4:7], a[92:95], a[192:195], a[4:7]
v_mfma_f32_16x16x32_bf16 a[4:7], a[88:91], a[176:179], a[4:7]
s_waitcnt lgkmcnt(4)
v_mfma_f32_16x16x32_bf16 a[32:35], a[96:99], a[176:179], a[32:35]
ds_read_b64_tr_b16 a[240:241], v14 offset:32768
ds_read_b64_tr_b16 a[242:243], v14 offset:36864
v_mfma_f32_16x16x32_bf16 a[32:35], a[100:103], a[192:195], a[32:35]
ds_read_b64_tr_b16 a[244:245], v14 offset:40960
ds_read_b64_tr_b16 a[246:247], v14 offset:45056
v_mfma_f32_16x16x32_bf16 a[40:43], a[100:103], a[196:199], a[40:43]
v_mfma_f32_16x16x32_bf16 a[40:43], a[96:99], a[180:183], a[40:43]
v_mfma_f32_16x16x32_bf16 a[48:51], a[96:99], a[184:187], a[48:51]
v_mfma_f32_16x16x32_bf16 a[48:51], a[100:103], a[200:203], a[48:51]
v_mfma_f32_16x16x32_bf16 a[56:59], a[100:103], a[204:207], a[56:59]
v_mfma_f32_16x16x32_bf16 a[56:59], a[96:99], a[188:191], a[56:59]
s_waitcnt lgkmcnt(4)
v_mfma_f32_16x16x32_bf16 a[60:63], a[104:107], a[188:191], a[60:63]
ds_read_b64_tr_b16 a[248:249], v15 offset:32768
ds_read_b64_tr_b16 a[250:251], v15 offset:36864
v_mfma_f32_16x16x32_bf16 a[60:63], a[108:111], a[204:207], a[60:63]
ds_read_b64_tr_b16 a[252:253], v15 offset:40960
ds_read_b64_tr_b16 a[254:255], v15 offset:45056
v_mfma_f32_16x16x32_bf16 a[52:55], a[108:111], a[200:203], a[52:55]
v_mfma_f32_16x16x32_bf16 a[52:55], a[104:107], a[184:187], a[52:55]
v_mfma_f32_16x16x32_bf16 a[44:47], a[104:107], a[180:183], a[44:47]
v_mfma_f32_16x16x32_bf16 a[44:47], a[108:111], a[196:199], a[44:47]
v_mfma_f32_16x16x32_bf16 a[36:39], a[108:111], a[192:195], a[36:39]
v_mfma_f32_16x16x32_bf16 a[36:39], a[104:107], a[176:179], a[36:39]
s_waitcnt lgkmcnt(4)
v_mfma_f32_16x16x32_bf16 v[96:99], a[240:243], a[176:179], v[96:99]
s_waitcnt vmcnt(34) lgkmcnt(0)
s_barrier
ds_read_b64_tr_b16 a[80:81], v16 offset:0
v_mfma_f32_16x16x32_bf16 v[96:99], a[244:247], a[192:195], v[96:99]
s_add_u32 m0, s24, 147456
ds_read_b64_tr_b16 a[82:83], v16 offset:4096
ds_read_b64_tr_b16 a[84:85], v16 offset:8192
v_mfma_f32_16x16x32_bf16 v[104:107], a[244:247], a[196:199], v[104:107]
buffer_load_dwordx4 v25, s[32:35], s37 offen offset:0 lds
v_mfma_f32_16x16x32_bf16 v[104:107], a[240:243], a[180:183], v[104:107]
ds_read_b64_tr_b16 a[86:87], v16 offset:12288
v_mfma_f32_16x16x32_bf16 v[112:115], a[240:243], a[184:187], v[112:115]
v_mfma_f32_16x16x32_bf16 v[112:115], a[244:247], a[200:203], v[112:115]
v_mfma_f32_16x16x32_bf16 v[120:123], a[244:247], a[204:207], v[120:123]
buffer_load_dwordx4 v26, s[32:35], s37 offen offset:1024 lds
v_mfma_f32_16x16x32_bf16 v[120:123], a[240:243], a[188:191], v[120:123]
s_waitcnt lgkmcnt(4)
v_mfma_f32_16x16x32_bf16 v[124:127], a[248:251], a[188:191], v[124:127]
ds_read_b64_tr_b16 a[88:89], v16 offset:8
ds_read_b64_tr_b16 a[90:91], v16 offset:4104
v_mfma_f32_16x16x32_bf16 v[124:127], a[252:255], a[204:207], v[124:127]
ds_read_b64_tr_b16 a[92:93], v16 offset:8200
ds_read_b64_tr_b16 a[94:95], v16 offset:12296
v_mfma_f32_16x16x32_bf16 v[116:119], a[252:255], a[200:203], v[116:119]
v_mfma_f32_16x16x32_bf16 v[116:119], a[248:251], a[184:187], v[116:119]
buffer_load_dwordx4 v27, s[32:35], s37 offen offset:2048 lds
v_mfma_f32_16x16x32_bf16 v[108:111], a[248:251], a[180:183], v[108:111]
v_mfma_f32_16x16x32_bf16 v[108:111], a[252:255], a[196:199], v[108:111]
v_mfma_f32_16x16x32_bf16 v[100:103], a[252:255], a[192:195], v[100:103]
v_mfma_f32_16x16x32_bf16 v[100:103], a[248:251], a[176:179], v[100:103]
s_waitcnt lgkmcnt(4)
v_mfma_f32_16x16x32_bf16 v[128:131], a[80:83], a[208:211], v[128:131]
buffer_load_dwordx4 v28, s[32:35], s37 offen offset:3072 lds
v_mfma_f32_16x16x32_bf16 v[128:131], a[84:87], a[224:227], v[128:131]
s_add_u32 m0, s39, 102400
ds_read_b64_tr_b16 a[96:97], v17 offset:0
ds_read_b64_tr_b16 a[98:99], v17 offset:4096
v_mfma_f32_16x16x32_bf16 v[136:139], a[84:87], a[228:231], v[136:139]
ds_read_b64_tr_b16 a[100:101], v17 offset:8192
ds_read_b64_tr_b16 a[102:103], v17 offset:12288
v_mfma_f32_16x16x32_bf16 v[136:139], a[80:83], a[212:215], v[136:139]
v_mfma_f32_16x16x32_bf16 v[144:147], a[80:83], a[216:219], v[144:147]
v_mfma_f32_16x16x32_bf16 v[144:147], a[84:87], a[232:235], v[144:147]
buffer_load_dwordx4 v29, s[32:35], s37 offen lds
v_mfma_f32_16x16x32_bf16 v[152:155], a[84:87], a[236:239], v[152:155]
s_add_u32 s37, s37, 589824
v_mfma_f32_16x16x32_bf16 v[152:155], a[80:83], a[220:223], v[152:155]
s_waitcnt lgkmcnt(4)
v_mfma_f32_16x16x32_bf16 v[156:159], a[88:91], a[220:223], v[156:159]
ds_read_b64_tr_b16 a[104:105], v17 offset:8
ds_read_b64_tr_b16 a[106:107], v17 offset:4104
v_mfma_f32_16x16x32_bf16 v[156:159], a[92:95], a[236:239], v[156:159]
ds_read_b64_tr_b16 a[108:109], v17 offset:8200
ds_read_b64_tr_b16 a[110:111], v17 offset:12296
v_mfma_f32_16x16x32_bf16 v[148:151], a[92:95], a[232:235], v[148:151]
buffer_load_dwordx4 a[176:179], v7, s[16:19], s38 offen offset:0 sc1
v_mfma_f32_16x16x32_bf16 v[148:151], a[88:91], a[216:219], v[148:151]
v_mfma_f32_16x16x32_bf16 v[140:143], a[88:91], a[212:215], v[140:143]
v_mfma_f32_16x16x32_bf16 v[140:143], a[92:95], a[228:231], v[140:143]
v_mfma_f32_16x16x32_bf16 v[132:135], a[92:95], a[224:227], v[132:135]
v_mfma_f32_16x16x32_bf16 v[132:135], a[88:91], a[208:211], v[132:135]
s_waitcnt lgkmcnt(4)
buffer_load_dwordx4 a[180:183], v7, s[16:19], s38 offen offset:1024 sc1
v_mfma_f32_16x16x32_bf16 v[160:163], a[96:99], a[208:211], v[160:163]
ds_read_b64_tr_b16 a[240:241], v18 offset:0
ds_read_b64_tr_b16 a[242:243], v18 offset:4096
v_mfma_f32_16x16x32_bf16 v[160:163], a[100:103], a[224:227], v[160:163]
ds_read_b64_tr_b16 a[244:245], v18 offset:8192
ds_read_b64_tr_b16 a[246:247], v18 offset:12288
v_mfma_f32_16x16x32_bf16 v[168:171], a[100:103], a[228:231], v[168:171]
v_mfma_f32_16x16x32_bf16 v[168:171], a[96:99], a[212:215], v[168:171]
v_mfma_f32_16x16x32_bf16 v[176:179], a[96:99], a[216:219], v[176:179]
buffer_load_dwordx4 a[184:187], v7, s[16:19], s38 offen offset:2048 sc1
v_mfma_f32_16x16x32_bf16 v[176:179], a[100:103], a[232:235], v[176:179]
v_mfma_f32_16x16x32_bf16 v[184:187], a[100:103], a[236:239], v[184:187]
v_mfma_f32_16x16x32_bf16 v[184:187], a[96:99], a[220:223], v[184:187]
s_waitcnt lgkmcnt(4)
v_mfma_f32_16x16x32_bf16 v[188:191], a[104:107], a[220:223], v[188:191]
ds_read_b64_tr_b16 a[248:249], v18 offset:8
ds_read_b64_tr_b16 a[250:251], v18 offset:4104
v_mfma_f32_16x16x32_bf16 v[188:191], a[108:111], a[236:239], v[188:191]
buffer_load_dwordx4 a[188:191], v7, s[16:19], s38 offen offset:3072 sc1
v_mfma_f32_16x16x32_bf16 v[180:183], a[108:111], a[232:235], v[180:183]
s_add_u32 s38, s38, 16384
ds_read_b64_tr_b16 a[252:253], v18 offset:8200
ds_read_b64_tr_b16 a[254:255], v18 offset:12296
v_mfma_f32_16x16x32_bf16 v[180:183], a[104:107], a[216:219], v[180:183]
v_mfma_f32_16x16x32_bf16 v[172:175], a[104:107], a[212:215], v[172:175]
v_mfma_f32_16x16x32_bf16 v[172:175], a[108:111], a[228:231], v[172:175]
v_mfma_f32_16x16x32_bf16 v[164:167], a[108:111], a[224:227], v[164:167]
buffer_load_dwordx4 a[192:195], v7, s[16:19], s38 offen offset:0 sc1
v_mfma_f32_16x16x32_bf16 v[164:167], a[104:107], a[208:211], v[164:167]
s_waitcnt lgkmcnt(4)
v_mfma_f32_16x16x32_bf16 v[192:195], a[240:243], a[208:211], v[192:195]
ds_read_b64_tr_b16 a[80:81], v19 offset:0
ds_read_b64_tr_b16 a[82:83], v19 offset:4096
v_mfma_f32_16x16x32_bf16 v[192:195], a[244:247], a[224:227], v[192:195]
ds_read_b64_tr_b16 a[84:85], v19 offset:8192
ds_read_b64_tr_b16 a[86:87], v19 offset:12288
v_mfma_f32_16x16x32_bf16 v[200:203], a[244:247], a[228:231], v[200:203]
v_mfma_f32_16x16x32_bf16 v[200:203], a[240:243], a[212:215], v[200:203]
buffer_load_dwordx4 a[196:199], v7, s[16:19], s38 offen offset:1024 sc1
v_mfma_f32_16x16x32_bf16 v[208:211], a[240:243], a[216:219], v[208:211]
v_mfma_f32_16x16x32_bf16 v[208:211], a[244:247], a[232:235], v[208:211]
v_mfma_f32_16x16x32_bf16 v[216:219], a[244:247], a[236:239], v[216:219]
v_mfma_f32_16x16x32_bf16 v[216:219], a[240:243], a[220:223], v[216:219]
s_waitcnt lgkmcnt(4)
v_mfma_f32_16x16x32_bf16 v[220:223], a[248:251], a[220:223], v[220:223]
buffer_load_dwordx4 a[200:203], v7, s[16:19], s38 offen offset:2048 sc1
v_mfma_f32_16x16x32_bf16 v[220:223], a[252:255], a[236:239], v[220:223]
ds_read_b64_tr_b16 a[88:89], v19 offset:8
ds_read_b64_tr_b16 a[90:91], v19 offset:4104
v_mfma_f32_16x16x32_bf16 v[212:215], a[252:255], a[232:235], v[212:215]
ds_read_b64_tr_b16 a[92:93], v19 offset:8200
ds_read_b64_tr_b16 a[94:95], v19 offset:12296
v_mfma_f32_16x16x32_bf16 v[212:215], a[248:251], a[216:219], v[212:215]
v_mfma_f32_16x16x32_bf16 v[204:207], a[248:251], a[212:215], v[204:207]
v_mfma_f32_16x16x32_bf16 v[204:207], a[252:255], a[228:231], v[204:207]
buffer_load_dwordx4 a[204:207], v7, s[16:19], s38 offen offset:3072 sc1
v_mfma_f32_16x16x32_bf16 v[196:199], a[252:255], a[224:227], v[196:199]
s_add_u32 s38, s38, 16384
v_mfma_f32_16x16x32_bf16 v[196:199], a[248:251], a[208:211], v[196:199]
s_waitcnt lgkmcnt(4)
v_mfma_f32_16x16x32_bf16 v[224:227], a[80:83], a[208:211], v[224:227]
s_waitcnt vmcnt(42) lgkmcnt(0)
s_barrier
ds_read_b64_tr_b16 a[96:97], v20 offset:12288
v_mfma_f32_16x16x32_bf16 v[224:227], a[84:87], a[224:227], v[224:227]
s_add_u32 m0, s24, 32768
ds_read_b64_tr_b16 a[98:99], v20 offset:13312
ds_read_b64_tr_b16 a[100:101], v20 offset:14336
v_mfma_f32_16x16x32_bf16 v[232:235], a[84:87], a[228:231], v[232:235]
buffer_load_dwordx4 v21, s[28:31], s36 offen offset:0 lds
v_mfma_f32_16x16x32_bf16 v[232:235], a[80:83], a[212:215], v[232:235]
ds_read_b64_tr_b16 a[102:103], v20 offset:15360
v_mfma_f32_16x16x32_bf16 v[240:243], a[80:83], a[216:219], v[240:243]
v_mfma_f32_16x16x32_bf16 v[240:243], a[84:87], a[232:235], v[240:243]
v_mfma_f32_16x16x32_bf16 v[248:251], a[84:87], a[236:239], v[248:251]
v_mfma_f32_16x16x32_bf16 v[248:251], a[80:83], a[220:223], v[248:251]
s_waitcnt lgkmcnt(4)
buffer_load_dwordx4 v22, s[28:31], s36 offen offset:1024 lds
v_mfma_f32_16x16x32_bf16 v[252:255], a[88:91], a[220:223], v[252:255]
ds_read_b64_tr_b16 a[104:105], v6 offset:12288
ds_read_b64_tr_b16 a[106:107], v6 offset:13312
v_mfma_f32_16x16x32_bf16 v[252:255], a[92:95], a[236:239], v[252:255]
ds_read_b64_tr_b16 a[108:109], v6 offset:14336
ds_read_b64_tr_b16 a[110:111], v6 offset:15360
v_mfma_f32_16x16x32_bf16 v[244:247], a[92:95], a[232:235], v[244:247]
v_mfma_f32_16x16x32_bf16 v[244:247], a[88:91], a[216:219], v[244:247]
v_mfma_f32_16x16x32_bf16 v[236:239], a[88:91], a[212:215], v[236:239]
buffer_load_dwordx4 v23, s[28:31], s36 offen offset:2048 lds
v_mfma_f32_16x16x32_bf16 v[236:239], a[92:95], a[228:231], v[236:239]
v_mfma_f32_16x16x32_bf16 v[228:231], a[92:95], a[224:227], v[228:231]
v_mfma_f32_16x16x32_bf16 v[228:231], a[88:91], a[208:211], v[228:231]
s_waitcnt lgkmcnt(4)
v_mfma_f32_16x16x32_bf16 a[64:67], a[96:99], a[208:211], a[64:67]
ds_read_b64_tr_b16 a[240:241], v8 offset:0
ds_read_b64_tr_b16 a[242:243], v8 offset:4096
v_mfma_f32_16x16x32_bf16 a[64:67], a[100:103], a[224:227], a[64:67]
buffer_load_dwordx4 v24, s[28:31], s36 offen offset:3072 lds
v_mfma_f32_16x16x32_bf16 a[68:71], a[100:103], a[228:231], a[68:71]
s_add_u32 s36, s36, 524288
ds_read_b64_tr_b16 a[244:245], v8 offset:8192
ds_read_b64_tr_b16 a[246:247], v8 offset:12288
v_mfma_f32_16x16x32_bf16 a[68:71], a[96:99], a[212:215], a[68:71]
v_mfma_f32_16x16x32_bf16 a[72:75], a[96:99], a[216:219], a[72:75]
v_mfma_f32_16x16x32_bf16 a[72:75], a[100:103], a[232:235], a[72:75]
v_mfma_f32_16x16x32_bf16 a[76:79], a[100:103], a[236:239], a[76:79]
v_mfma_f32_16x16x32_bf16 a[76:79], a[96:99], a[220:223], a[76:79]
s_waitcnt lgkmcnt(4)
v_mfma_f32_16x16x32_bf16 v[60:63], a[104:107], a[220:223], v[60:63]
ds_read_b64_tr_b16 a[248:249], v9 offset:0
ds_read_b64_tr_b16 a[250:251], v9 offset:4096
v_mfma_f32_16x16x32_bf16 v[60:63], a[108:111], a[236:239], v[60:63]
ds_read_b64_tr_b16 a[252:253], v9 offset:8192
ds_read_b64_tr_b16 a[254:255], v9 offset:12288
v_mfma_f32_16x16x32_bf16 v[56:59], a[108:111], a[232:235], v[56:59]
v_mfma_f32_16x16x32_bf16 v[56:59], a[104:107], a[216:219], v[56:59]
v_mfma_f32_16x16x32_bf16 v[52:55], a[104:107], a[212:215], v[52:55]
v_mfma_f32_16x16x32_bf16 v[52:55], a[108:111], a[228:231], v[52:55]
v_mfma_f32_16x16x32_bf16 v[48:51], a[108:111], a[224:227], v[48:51]
v_mfma_f32_16x16x32_bf16 v[48:51], a[104:107], a[208:211], v[48:51]
s_waitcnt lgkmcnt(4)
v_mfma_f32_16x16x32_bf16 v[64:67], a[240:243], a[208:211], v[64:67]
ds_read_b64_tr_b16 a[80:81], v10 offset:0
ds_read_b64_tr_b16 a[82:83], v10 offset:4096
v_mfma_f32_16x16x32_bf16 v[64:67], a[244:247], a[224:227], v[64:67]
ds_read_b64_tr_b16 a[84:85], v10 offset:8192
ds_read_b64_tr_b16 a[86:87], v10 offset:12288
v_mfma_f32_16x16x32_bf16 v[72:75], a[244:247], a[228:231], v[72:75]
v_mfma_f32_16x16x32_bf16 v[72:75], a[240:243], a[212:215], v[72:75]
v_mfma_f32_16x16x32_bf16 v[80:83], a[240:243], a[216:219], v[80:83]
v_mfma_f32_16x16x32_bf16 v[80:83], a[244:247], a[232:235], v[80:83]
v_mfma_f32_16x16x32_bf16 v[88:91], a[244:247], a[236:239], v[88:91]
v_mfma_f32_16x16x32_bf16 v[88:91], a[240:243], a[220:223], v[88:91]
s_waitcnt lgkmcnt(4)
v_mfma_f32_16x16x32_bf16 v[92:95], a[248:251], a[220:223], v[92:95]
ds_read_b64_tr_b16 a[88:89], v11 offset:0
ds_read_b64_tr_b16 a[90:91], v11 offset:4096
v_mfma_f32_16x16x32_bf16 v[92:95], a[252:255], a[236:239], v[92:95]
ds_read_b64_tr_b16 a[92:93], v11 offset:8192
ds_read_b64_tr_b16 a[94:95], v11 offset:12288
v_mfma_f32_16x16x32_bf16 v[84:87], a[252:255], a[232:235], v[84:87]
v_mfma_f32_16x16x32_bf16 v[84:87], a[248:251], a[216:219], v[84:87]
v_mfma_f32_16x16x32_bf16 v[76:79], a[248:251], a[212:215], v[76:79]
v_mfma_f32_16x16x32_bf16 v[76:79], a[252:255], a[228:231], v[76:79]
v_mfma_f32_16x16x32_bf16 v[68:71], a[252:255], a[224:227], v[68:71]
v_mfma_f32_16x16x32_bf16 v[68:71], a[248:251], a[208:211], v[68:71]
s_waitcnt lgkmcnt(4)
v_mfma_f32_16x16x32_bf16 a[0:3], a[80:83], a[208:211], a[0:3]
s_add_u32 m0, s24, 0
ds_read_b64_tr_b16 a[96:97], v12 offset:0
ds_read_b64_tr_b16 a[98:99], v12 offset:4096
v_mfma_f32_16x16x32_bf16 a[0:3], a[84:87], a[224:227], a[0:3]
buffer_load_dwordx4 v30, s[8:11], s20 offen offset:0 lds
v_mfma_f32_16x16x32_bf16 a[8:11], a[84:87], a[228:231], a[8:11]
ds_read_b64_tr_b16 a[100:101], v12 offset:8192
ds_read_b64_tr_b16 a[102:103], v12 offset:12288
v_mfma_f32_16x16x32_bf16 a[8:11], a[80:83], a[212:215], a[8:11]
v_mfma_f32_16x16x32_bf16 a[16:19], a[80:83], a[216:219], a[16:19]
v_mfma_f32_16x16x32_bf16 a[16:19], a[84:87], a[232:235], a[16:19]
buffer_load_dwordx4 v31, s[8:11], s20 offen offset:1024 lds
v_mfma_f32_16x16x32_bf16 a[24:27], a[84:87], a[236:239], a[24:27]
v_mfma_f32_16x16x32_bf16 a[24:27], a[80:83], a[220:223], a[24:27]
s_waitcnt lgkmcnt(4)
v_mfma_f32_16x16x32_bf16 a[28:31], a[88:91], a[220:223], a[28:31]
ds_read_b64_tr_b16 a[104:105], v13 offset:0
ds_read_b64_tr_b16 a[106:107], v13 offset:4096
v_mfma_f32_16x16x32_bf16 a[28:31], a[92:95], a[236:239], a[28:31]
ds_read_b64_tr_b16 a[108:109], v13 offset:8192
ds_read_b64_tr_b16 a[110:111], v13 offset:12288
v_mfma_f32_16x16x32_bf16 a[20:23], a[92:95], a[232:235], a[20:23]
buffer_load_dwordx4 v32, s[8:11], s20 offen offset:2048 lds
v_mfma_f32_16x16x32_bf16 a[20:23], a[88:91], a[216:219], a[20:23]
v_mfma_f32_16x16x32_bf16 a[12:15], a[88:91], a[212:215], a[12:15]
v_mfma_f32_16x16x32_bf16 a[12:15], a[92:95], a[228:231], a[12:15]
v_mfma_f32_16x16x32_bf16 a[4:7], a[92:95], a[224:227], a[4:7]
v_mfma_f32_16x16x32_bf16 a[4:7], a[88:91], a[208:211], a[4:7]
s_waitcnt lgkmcnt(4)
buffer_load_dwordx4 v33, s[8:11], s20 offen offset:3072 lds
v_mfma_f32_16x16x32_bf16 a[32:35], a[96:99], a[208:211], a[32:35]
s_add_u32 s20, s20, 16384
ds_read_b64_tr_b16 a[240:241], v14 offset:0
ds_read_b64_tr_b16 a[242:243], v14 offset:4096
v_mfma_f32_16x16x32_bf16 a[32:35], a[100:103], a[224:227], a[32:35]
ds_read_b64_tr_b16 a[244:245], v14 offset:8192
ds_read_b64_tr_b16 a[246:247], v14 offset:12288
v_mfma_f32_16x16x32_bf16 a[40:43], a[100:103], a[228:231], a[40:43]
v_mfma_f32_16x16x32_bf16 a[40:43], a[96:99], a[212:215], a[40:43]
v_mfma_f32_16x16x32_bf16 a[48:51], a[96:99], a[216:219], a[48:51]
v_mfma_f32_16x16x32_bf16 a[48:51], a[100:103], a[232:235], a[48:51]
v_mfma_f32_16x16x32_bf16 a[56:59], a[100:103], a[236:239], a[56:59]
v_mfma_f32_16x16x32_bf16 a[56:59], a[96:99], a[220:223], a[56:59]
s_waitcnt lgkmcnt(4)
v_mfma_f32_16x16x32_bf16 a[60:63], a[104:107], a[220:223], a[60:63]
ds_read_b64_tr_b16 a[248:249], v15 offset:0
ds_read_b64_tr_b16 a[250:251], v15 offset:4096
v_mfma_f32_16x16x32_bf16 a[60:63], a[108:111], a[236:239], a[60:63]
ds_read_b64_tr_b16 a[252:253], v15 offset:8192
ds_read_b64_tr_b16 a[254:255], v15 offset:12288
v_mfma_f32_16x16x32_bf16 a[52:55], a[108:111], a[232:235], a[52:55]
v_mfma_f32_16x16x32_bf16 a[52:55], a[104:107], a[216:219], a[52:55]
v_mfma_f32_16x16x32_bf16 a[44:47], a[104:107], a[212:215], a[44:47]
v_mfma_f32_16x16x32_bf16 a[44:47], a[108:111], a[228:231], a[44:47]
v_mfma_f32_16x16x32_bf16 a[36:39], a[108:111], a[224:227], a[36:39]
v_mfma_f32_16x16x32_bf16 a[36:39], a[104:107], a[208:211], a[36:39]
s_waitcnt lgkmcnt(4)
v_mfma_f32_16x16x32_bf16 v[96:99], a[240:243], a[208:211], v[96:99]
s_waitcnt vmcnt(38) lgkmcnt(0)
s_barrier
ds_read_b64_tr_b16 a[80:81], v16 offset:16384
v_mfma_f32_16x16x32_bf16 v[96:99], a[244:247], a[224:227], v[96:99]
s_add_u32 m0, s24, 114688
ds_read_b64_tr_b16 a[82:83], v16 offset:20480
ds_read_b64_tr_b16 a[84:85], v16 offset:24576
v_mfma_f32_16x16x32_bf16 v[104:107], a[244:247], a[228:231], v[104:107]
buffer_load_dwordx4 v25, s[32:35], s37 offen offset:0 lds
v_mfma_f32_16x16x32_bf16 v[104:107], a[240:243], a[212:215], v[104:107]
ds_read_b64_tr_b16 a[86:87], v16 offset:28672
v_mov_b32 v1, 0
v_mfma_f32_16x16x32_bf16 v[112:115], a[240:243], a[216:219], v[112:115]
v_min_u32 v2, 1, v0
v_lshlrev_b32 v2, 28, v2
v_mfma_f32_16x16x32_bf16 v[112:115], a[244:247], a[232:235], v[112:115]
v_mfma_f32_16x16x32_bf16 v[120:123], a[244:247], a[236:239], v[120:123]
buffer_store_dword v1, v2, s[16:19], s4 offen sc1
v_mfma_f32_16x16x32_bf16 v[120:123], a[240:243], a[220:223], v[120:123]
s_waitcnt lgkmcnt(4)
v_mfma_f32_16x16x32_bf16 v[124:127], a[248:251], a[220:223], v[124:127]
buffer_store_dword v1, v2, s[16:19], s6 offen sc1
v_mfma_f32_16x16x32_bf16 v[124:127], a[252:255], a[236:239], v[124:127]
s_or_b32 s49, s25, s23
ds_read_b64_tr_b16 a[88:89], v16 offset:16392
ds_read_b64_tr_b16 a[90:91], v16 offset:20488
v_mfma_f32_16x16x32_bf16 v[116:119], a[252:255], a[232:235], v[116:119]
s_lshl_b32 s49, s49, 3
buffer_load_dwordx4 v26, s[32:35], s37 offen offset:1024 lds
v_mfma_f32_16x16x32_bf16 v[116:119], a[248:251], a[216:219], v[116:119]
s_add_u32 s49, s49, s26
ds_read_b64_tr_b16 a[92:93], v16 offset:24584
ds_read_b64_tr_b16 a[94:95], v16 offset:28680
v_mfma_f32_16x16x32_bf16 v[108:111], a[248:251], a[212:215], v[108:111]
s_lshl_b32 s49, s49, 5
v_mfma_f32_16x16x32_bf16 v[108:111], a[252:255], a[228:231], v[108:111]
v_mfma_f32_16x16x32_bf16 v[100:103], a[252:255], a[224:227], v[100:103]
v_mfma_f32_16x16x32_bf16 v[100:103], a[248:251], a[208:211], v[100:103]
s_waitcnt lgkmcnt(4)
buffer_store_dword v1, v2, s[56:59], s49 offen offset:4 sc1
v_mfma_f32_16x16x32_bf16 v[128:131], a[80:83], a[112:115], v[128:131]
ds_read_b64_tr_b16 a[96:97], v17 offset:16384
ds_read_b64_tr_b16 a[98:99], v17 offset:20480
v_mfma_f32_16x16x32_bf16 v[128:131], a[84:87], a[128:131], v[128:131]
buffer_load_dwordx4 a[208:211], v7, s[16:19], s38 offen offset:0 sc1
v_mfma_f32_16x16x32_bf16 v[136:139], a[84:87], a[132:135], v[136:139]
ds_read_b64_tr_b16 a[100:101], v17 offset:24576
ds_read_b64_tr_b16 a[102:103], v17 offset:28672
v_mfma_f32_16x16x32_bf16 v[136:139], a[80:83], a[116:119], v[136:139]
v_mfma_f32_16x16x32_bf16 v[144:147], a[80:83], a[120:123], v[144:147]
v_mfma_f32_16x16x32_bf16 v[144:147], a[84:87], a[136:139], v[144:147]
v_mfma_f32_16x16x32_bf16 v[152:155], a[84:87], a[140:143], v[152:155]
buffer_load_dwordx4 a[212:215], v7, s[16:19], s38 offen offset:1024 sc1
v_mfma_f32_16x16x32_bf16 v[152:155], a[80:83], a[124:127], v[152:155]
s_waitcnt lgkmcnt(4)
v_mfma_f32_16x16x32_bf16 v[156:159], a[88:91], a[124:127], v[156:159]
ds_read_b64_tr_b16 a[104:105], v17 offset:16392
ds_read_b64_tr_b16 a[106:107], v17 offset:20488
v_mfma_f32_16x16x32_bf16 v[156:159], a[92:95], a[140:143], v[156:159]
ds_read_b64_tr_b16 a[108:109], v17 offset:24584
ds_read_b64_tr_b16 a[110:111], v17 offset:28680
v_mfma_f32_16x16x32_bf16 v[148:151], a[92:95], a[136:139], v[148:151]
v_mfma_f32_16x16x32_bf16 v[148:151], a[88:91], a[120:123], v[148:151]
buffer_load_dwordx4 a[216:219], v7, s[16:19], s38 offen offset:2048 sc1
v_mfma_f32_16x16x32_bf16 v[140:143], a[88:91], a[116:119], v[140:143]
v_mfma_f32_16x16x32_bf16 v[140:143], a[92:95], a[132:135], v[140:143]
v_mfma_f32_16x16x32_bf16 v[132:135], a[92:95], a[128:131], v[132:135]
v_mfma_f32_16x16x32_bf16 v[132:135], a[88:91], a[112:115], v[132:135]
s_waitcnt lgkmcnt(4)
v_mfma_f32_16x16x32_bf16 v[160:163], a[96:99], a[112:115], v[160:163]
buffer_load_dwordx4 a[220:223], v7, s[16:19], s38 offen offset:3072 sc1
v_mfma_f32_16x16x32_bf16 v[160:163], a[100:103], a[128:131], v[160:163]
s_add_u32 s38, s38, 16384
ds_read_b64_tr_b16 a[240:241], v18 offset:16384
ds_read_b64_tr_b16 a[242:243], v18 offset:20480
v_mfma_f32_16x16x32_bf16 v[168:171], a[100:103], a[132:135], v[168:171]
ds_read_b64_tr_b16 a[244:245], v18 offset:24576
ds_read_b64_tr_b16 a[246:247], v18 offset:28672
v_mfma_f32_16x16x32_bf16 v[168:171], a[96:99], a[116:119], v[168:171]
v_mfma_f32_16x16x32_bf16 v[176:179], a[96:99], a[120:123], v[176:179]
v_mfma_f32_16x16x32_bf16 v[176:179], a[100:103], a[136:139], v[176:179]
buffer_load_dwordx4 a[224:227], v7, s[16:19], s38 offen offset:0 sc1
v_mfma_f32_16x16x32_bf16 v[184:187], a[100:103], a[140:143], v[184:187]
v_mfma_f32_16x16x32_bf16 v[184:187], a[96:99], a[124:127], v[184:187]
s_waitcnt lgkmcnt(4)
v_mfma_f32_16x16x32_bf16 v[188:191], a[104:107], a[124:127], v[188:191]
ds_read_b64_tr_b16 a[248:249], v18 offset:16392
ds_read_b64_tr_b16 a[250:251], v18 offset:20488
v_mfma_f32_16x16x32_bf16 v[188:191], a[108:111], a[140:143], v[188:191]
ds_read_b64_tr_b16 a[252:253], v18 offset:24584
ds_read_b64_tr_b16 a[254:255], v18 offset:28680
v_mfma_f32_16x16x32_bf16 v[180:183], a[108:111], a[136:139], v[180:183]
buffer_load_dwordx4 a[228:231], v7, s[16:19], s38 offen offset:1024 sc1
v_mfma_f32_16x16x32_bf16 v[180:183], a[104:107], a[120:123], v[180:183]
v_mfma_f32_16x16x32_bf16 v[172:175], a[104:107], a[116:119], v[172:175]
v_mfma_f32_16x16x32_bf16 v[172:175], a[108:111], a[132:135], v[172:175]
v_mfma_f32_16x16x32_bf16 v[164:167], a[108:111], a[128:131], v[164:167]
v_mfma_f32_16x16x32_bf16 v[164:167], a[104:107], a[112:115], v[164:167]
s_waitcnt lgkmcnt(4)
buffer_load_dwordx4 a[232:235], v7, s[16:19], s38 offen offset:2048 sc1
v_mfma_f32_16x16x32_bf16 v[192:195], a[240:243], a[112:115], v[192:195]
ds_read_b64_tr_b16 a[80:81], v19 offset:16384
ds_read_b64_tr_b16 a[82:83], v19 offset:20480
v_mfma_f32_16x16x32_bf16 v[192:195], a[244:247], a[128:131], v[192:195]
ds_read_b64_tr_b16 a[84:85], v19 offset:24576
ds_read_b64_tr_b16 a[86:87], v19 offset:28672
v_mfma_f32_16x16x32_bf16 v[200:203], a[244:247], a[132:135], v[200:203]
v_mfma_f32_16x16x32_bf16 v[200:203], a[240:243], a[116:119], v[200:203]
v_mfma_f32_16x16x32_bf16 v[208:211], a[240:243], a[120:123], v[208:211]
buffer_load_dwordx4 a[236:239], v7, s[16:19], s38 offen offset:3072 sc1
v_mfma_f32_16x16x32_bf16 v[208:211], a[244:247], a[136:139], v[208:211]
s_add_u32 s38, s38, 16384
v_mfma_f32_16x16x32_bf16 v[216:219], a[244:247], a[140:143], v[216:219]
v_mfma_f32_16x16x32_bf16 v[216:219], a[240:243], a[124:127], v[216:219]
s_waitcnt lgkmcnt(4)
v_mfma_f32_16x16x32_bf16 v[220:223], a[248:251], a[124:127], v[220:223]
ds_read_b64_tr_b16 a[88:89], v19 offset:16392
ds_read_b64_tr_b16 a[90:91], v19 offset:20488
v_mfma_f32_16x16x32_bf16 v[220:223], a[252:255], a[140:143], v[220:223]
buffer_load_dwordx4 v27, s[32:35], s37 offen offset:2048 lds
v_mfma_f32_16x16x32_bf16 v[212:215], a[252:255], a[136:139], v[212:215]
ds_read_b64_tr_b16 a[92:93], v19 offset:24584
ds_read_b64_tr_b16 a[94:95], v19 offset:28680
v_mfma_f32_16x16x32_bf16 v[212:215], a[248:251], a[120:123], v[212:215]
v_mfma_f32_16x16x32_bf16 v[204:207], a[248:251], a[116:119], v[204:207]
v_mfma_f32_16x16x32_bf16 v[204:207], a[252:255], a[132:135], v[204:207]
v_mfma_f32_16x16x32_bf16 v[196:199], a[252:255], a[128:131], v[196:199]
buffer_load_dwordx4 v28, s[32:35], s37 offen offset:3072 lds
v_mfma_f32_16x16x32_bf16 v[196:199], a[248:251], a[112:115], v[196:199]
s_waitcnt lgkmcnt(4)
s_add_u32 m0, s39, 106496
v_mfma_f32_16x16x32_bf16 v[224:227], a[80:83], a[112:115], v[224:227]
s_waitcnt vmcnt(48) lgkmcnt(0)
s_barrier
ds_read_b64_tr_b16 a[96:97], v20 offset:0
v_mfma_f32_16x16x32_bf16 v[224:227], a[84:87], a[128:131], v[224:227]
ds_read_b64_tr_b16 a[98:99], v20 offset:1024
ds_read_b64_tr_b16 a[100:101], v20 offset:2048
v_mfma_f32_16x16x32_bf16 v[232:235], a[84:87], a[132:135], v[232:235]
ds_read_b64_tr_b16 a[102:103], v20 offset:3072
v_mfma_f32_16x16x32_bf16 v[232:235], a[80:83], a[116:119], v[232:235]
buffer_load_dwordx4 v29, s[32:35], s37 offen lds
v_mfma_f32_16x16x32_bf16 v[240:243], a[80:83], a[120:123], v[240:243]
s_add_u32 s37, s37, 589824
s_add_u32 m0, s24, 49152
v_mfma_f32_16x16x32_bf16 v[240:243], a[84:87], a[136:139], v[240:243]
v_mfma_f32_16x16x32_bf16 v[248:251], a[84:87], a[140:143], v[248:251]
v_mfma_f32_16x16x32_bf16 v[248:251], a[80:83], a[124:127], v[248:251]
s_waitcnt lgkmcnt(4)
v_mfma_f32_16x16x32_bf16 v[252:255], a[88:91], a[124:127], v[252:255]
buffer_load_dwordx4 v21, s[28:31], s36 offen offset:0 lds
v_mfma_f32_16x16x32_bf16 v[252:255], a[92:95], a[140:143], v[252:255]
ds_read_b64_tr_b16 a[104:105], v6 offset:0
ds_read_b64_tr_b16 a[106:107], v6 offset:1024
v_mfma_f32_16x16x32_bf16 v[244:247], a[92:95], a[136:139], v[244:247]
ds_read_b64_tr_b16 a[108:109], v6 offset:2048
ds_read_b64_tr_b16 a[110:111], v6 offset:3072
v_mfma_f32_16x16x32_bf16 v[244:247], a[88:91], a[120:123], v[244:247]
v_mfma_f32_16x16x32_bf16 v[236:239], a[88:91], a[116:119], v[236:239]
v_mfma_f32_16x16x32_bf16 v[236:239], a[92:95], a[132:135], v[236:239]
buffer_load_dwordx4 v22, s[28:31], s36 offen offset:1024 lds
v_mfma_f32_16x16x32_bf16 v[228:231], a[92:95], a[128:131], v[228:231]
v_mfma_f32_16x16x32_bf16 v[228:231], a[88:91], a[112:115], v[228:231]
s_waitcnt lgkmcnt(4)
v_mfma_f32_16x16x32_bf16 a[64:67], a[96:99], a[112:115], a[64:67]
ds_read_b64_tr_b16 a[240:241], v8 offset:16384
ds_read_b64_tr_b16 a[242:243], v8 offset:20480
v_mfma_f32_16x16x32_bf16 a[64:67], a[100:103], a[128:131], a[64:67]
ds_read_b64_tr_b16 a[244:245], v8 offset:24576
ds_read_b64_tr_b16 a[246:247], v8 offset:28672
v_mfma_f32_16x16x32_bf16 a[68:71], a[100:103], a[132:135], a[68:71]
buffer_load_dwordx4 v23, s[28:31], s36 offen offset:2048 lds
v_mfma_f32_16x16x32_bf16 a[68:71], a[96:99], a[116:119], a[68:71]
v_mfma_f32_16x16x32_bf16 a[72:75], a[96:99], a[120:123], a[72:75]
v_mfma_f32_16x16x32_bf16 a[72:75], a[100:103], a[136:139], a[72:75]
v_mfma_f32_16x16x32_bf16 a[76:79], a[100:103], a[140:143], a[76:79]
v_mfma_f32_16x16x32_bf16 a[76:79], a[96:99], a[124:127], a[76:79]
s_waitcnt lgkmcnt(4)
buffer_load_dwordx4 v24, s[28:31], s36 offen offset:3072 lds
v_mfma_f32_16x16x32_bf16 v[60:63], a[104:107], a[124:127], v[60:63]
s_add_u32 s36, s36, 524288
ds_read_b64_tr_b16 a[248:249], v9 offset:16384
ds_read_b64_tr_b16 a[250:251], v9 offset:20480
v_mfma_f32_16x16x32_bf16 v[60:63], a[108:111], a[140:143], v[60:63]
ds_read_b64_tr_b16 a[252:253], v9 offset:24576
ds_read_b64_tr_b16 a[254:255], v9 offset:28672
v_mfma_f32_16x16x32_bf16 v[56:59], a[108:111], a[136:139], v[56:59]
v_mfma_f32_16x16x32_bf16 v[56:59], a[104:107], a[120:123], v[56:59]
v_mfma_f32_16x16x32_bf16 v[52:55], a[104:107], a[116:119], v[52:55]
v_mfma_f32_16x16x32_bf16 v[52:55], a[108:111], a[132:135], v[52:55]
v_mfma_f32_16x16x32_bf16 v[48:51], a[108:111], a[128:131], v[48:51]
v_mfma_f32_16x16x32_bf16 v[48:51], a[104:107], a[112:115], v[48:51]
s_waitcnt lgkmcnt(4)
s_add_u32 m0, s24, 16384
v_mfma_f32_16x16x32_bf16 v[64:67], a[240:243], a[112:115], v[64:67]
buffer_load_dwordx4 v30, s[8:11], s20 offen offset:0 lds
v_mfma_f32_16x16x32_bf16 v[64:67], a[244:247], a[128:131], v[64:67]
ds_read_b64_tr_b16 a[80:81], v10 offset:16384
ds_read_b64_tr_b16 a[82:83], v10 offset:20480
v_mfma_f32_16x16x32_bf16 v[72:75], a[244:247], a[132:135], v[72:75]
ds_read_b64_tr_b16 a[84:85], v10 offset:24576
ds_read_b64_tr_b16 a[86:87], v10 offset:28672
v_mfma_f32_16x16x32_bf16 v[72:75], a[240:243], a[116:119], v[72:75]
v_mfma_f32_16x16x32_bf16 v[80:83], a[240:243], a[120:123], v[80:83]
buffer_load_dwordx4 v31, s[8:11], s20 offen offset:1024 lds
v_mfma_f32_16x16x32_bf16 v[80:83], a[244:247], a[136:139], v[80:83]
v_mfma_f32_16x16x32_bf16 v[88:91], a[244:247], a[140:143], v[88:91]
v_mfma_f32_16x16x32_bf16 v[88:91], a[240:243], a[124:127], v[88:91]
s_waitcnt lgkmcnt(4)
v_mfma_f32_16x16x32_bf16 v[92:95], a[248:251], a[124:127], v[92:95]
ds_read_b64_tr_b16 a[88:89], v11 offset:16384
ds_read_b64_tr_b16 a[90:91], v11 offset:20480
v_mfma_f32_16x16x32_bf16 v[92:95], a[252:255], a[140:143], v[92:95]
buffer_load_dwordx4 v32, s[8:11], s20 offen offset:2048 lds
v_mfma_f32_16x16x32_bf16 v[84:87], a[252:255], a[136:139], v[84:87]
ds_read_b64_tr_b16 a[92:93], v11 offset:24576
ds_read_b64_tr_b16 a[94:95], v11 offset:28672
v_mfma_f32_16x16x32_bf16 v[84:87], a[248:251], a[120:123], v[84:87]
v_mfma_f32_16x16x32_bf16 v[76:79], a[248:251], a[116:119], v[76:79]
v_mfma_f32_16x16x32_bf16 v[76:79], a[252:255], a[132:135], v[76:79]
v_mfma_f32_16x16x32_bf16 v[68:71], a[252:255], a[128:131], v[68:71]
buffer_load_dwordx4 v33, s[8:11], s20 offen offset:3072 lds
v_mfma_f32_16x16x32_bf16 v[68:71], a[248:251], a[112:115], v[68:71]
s_waitcnt lgkmcnt(4)
s_add_u32 s20, s20, 16384
v_mfma_f32_16x16x32_bf16 a[0:3], a[80:83], a[112:115], a[0:3]
ds_read_b64_tr_b16 a[96:97], v12 offset:16384
ds_read_b64_tr_b16 a[98:99], v12 offset:20480
v_mfma_f32_16x16x32_bf16 a[0:3], a[84:87], a[128:131], a[0:3]
ds_read_b64_tr_b16 a[100:101], v12 offset:24576
ds_read_b64_tr_b16 a[102:103], v12 offset:28672
v_mfma_f32_16x16x32_bf16 a[8:11], a[84:87], a[132:135], a[8:11]
v_mfma_f32_16x16x32_bf16 a[8:11], a[80:83], a[116:119], a[8:11]
v_mfma_f32_16x16x32_bf16 a[16:19], a[80:83], a[120:123], a[16:19]
v_mfma_f32_16x16x32_bf16 a[16:19], a[84:87], a[136:139], a[16:19]
v_mfma_f32_16x16x32_bf16 a[24:27], a[84:87], a[140:143], a[24:27]
v_mfma_f32_16x16x32_bf16 a[24:27], a[80:83], a[124:127], a[24:27]
s_waitcnt lgkmcnt(4)
v_mfma_f32_16x16x32_bf16 a[28:31], a[88:91], a[124:127], a[28:31]
ds_read_b64_tr_b16 a[104:105], v13 offset:16384
ds_read_b64_tr_b16 a[106:107], v13 offset:20480
v_mfma_f32_16x16x32_bf16 a[28:31], a[92:95], a[140:143], a[28:31]
ds_read_b64_tr_b16 a[108:109], v13 offset:24576
ds_read_b64_tr_b16 a[110:111], v13 offset:28672
v_mfma_f32_16x16x32_bf16 a[20:23], a[92:95], a[136:139], a[20:23]
v_mfma_f32_16x16x32_bf16 a[20:23], a[88:91], a[120:123], a[20:23]
v_mfma_f32_16x16x32_bf16 a[12:15], a[88:91], a[116:119], a[12:15]
v_mfma_f32_16x16x32_bf16 a[12:15], a[92:95], a[132:135], a[12:15]
v_mfma_f32_16x16x32_bf16 a[4:7], a[92:95], a[128:131], a[4:7]
v_mfma_f32_16x16x32_bf16 a[4:7], a[88:91], a[112:115], a[4:7]
s_waitcnt lgkmcnt(4)
v_mfma_f32_16x16x32_bf16 a[32:35], a[96:99], a[112:115], a[32:35]
ds_read_b64_tr_b16 a[240:241], v14 offset:16384
ds_read_b64_tr_b16 a[242:243], v14 offset:20480
v_mfma_f32_16x16x32_bf16 a[32:35], a[100:103], a[128:131], a[32:35]
ds_read_b64_tr_b16 a[244:245], v14 offset:24576
ds_read_b64_tr_b16 a[246:247], v14 offset:28672
v_mfma_f32_16x16x32_bf16 a[40:43], a[100:103], a[132:135], a[40:43]
v_mfma_f32_16x16x32_bf16 a[40:43], a[96:99], a[116:119], a[40:43]
v_mfma_f32_16x16x32_bf16 a[48:51], a[96:99], a[120:123], a[48:51]
v_mfma_f32_16x16x32_bf16 a[48:51], a[100:103], a[136:139], a[48:51]
v_mfma_f32_16x16x32_bf16 a[56:59], a[100:103], a[140:143], a[56:59]
v_mfma_f32_16x16x32_bf16 a[56:59], a[96:99], a[124:127], a[56:59]
s_waitcnt lgkmcnt(4)
v_mfma_f32_16x16x32_bf16 a[60:63], a[104:107], a[124:127], a[60:63]
ds_read_b64_tr_b16 a[248:249], v15 offset:16384
ds_read_b64_tr_b16 a[250:251], v15 offset:20480
v_mfma_f32_16x16x32_bf16 a[60:63], a[108:111], a[140:143], a[60:63]
ds_read_b64_tr_b16 a[252:253], v15 offset:24576
ds_read_b64_tr_b16 a[254:255], v15 offset:28672
v_mfma_f32_16x16x32_bf16 a[52:55], a[108:111], a[136:139], a[52:55]
v_mfma_f32_16x16x32_bf16 a[52:55], a[104:107], a[120:123], a[52:55]
v_mfma_f32_16x16x32_bf16 a[44:47], a[104:107], a[116:119], a[44:47]
v_mfma_f32_16x16x32_bf16 a[44:47], a[108:111], a[132:135], a[44:47]
v_mfma_f32_16x16x32_bf16 a[36:39], a[108:111], a[128:131], a[36:39]
v_mfma_f32_16x16x32_bf16 a[36:39], a[104:107], a[112:115], a[36:39]
s_waitcnt lgkmcnt(4)
v_mfma_f32_16x16x32_bf16 v[96:99], a[240:243], a[112:115], v[96:99]
s_waitcnt vmcnt(45) lgkmcnt(0)
s_barrier
ds_read_b64_tr_b16 a[80:81], v16 offset:32768
v_mfma_f32_16x16x32_bf16 v[96:99], a[244:247], a[128:131], v[96:99]
s_add_u32 m0, s24, 131072
ds_read_b64_tr_b16 a[82:83], v16 offset:36864
ds_read_b64_tr_b16 a[84:85], v16 offset:40960
v_mfma_f32_16x16x32_bf16 v[104:107], a[244:247], a[132:135], v[104:107]
buffer_load_dwordx4 v25, s[32:35], s37 offen offset:0 lds
v_mfma_f32_16x16x32_bf16 v[104:107], a[240:243], a[116:119], v[104:107]
ds_read_b64_tr_b16 a[86:87], v16 offset:45056
v_mfma_f32_16x16x32_bf16 v[112:115], a[240:243], a[120:123], v[112:115]
v_mfma_f32_16x16x32_bf16 v[112:115], a[244:247], a[136:139], v[112:115]
v_mfma_f32_16x16x32_bf16 v[120:123], a[244:247], a[140:143], v[120:123]
buffer_load_dwordx4 v26, s[32:35], s37 offen offset:1024 lds
v_mfma_f32_16x16x32_bf16 v[120:123], a[240:243], a[124:127], v[120:123]
s_waitcnt lgkmcnt(4)
v_mfma_f32_16x16x32_bf16 v[124:127], a[248:251], a[124:127], v[124:127]
ds_read_b64_tr_b16 a[88:89], v16 offset:32776
ds_read_b64_tr_b16 a[90:91], v16 offset:36872
v_mfma_f32_16x16x32_bf16 v[124:127], a[252:255], a[140:143], v[124:127]
ds_read_b64_tr_b16 a[92:93], v16 offset:40968
ds_read_b64_tr_b16 a[94:95], v16 offset:45064
v_mfma_f32_16x16x32_bf16 v[116:119], a[252:255], a[136:139], v[116:119]
v_mfma_f32_16x16x32_bf16 v[116:119], a[248:251], a[120:123], v[116:119]
buffer_load_dwordx4 v27, s[32:35], s37 offen offset:2048 lds
v_mfma_f32_16x16x32_bf16 v[108:111], a[248:251], a[116:119], v[108:111]
v_mfma_f32_16x16x32_bf16 v[108:111], a[252:255], a[132:135], v[108:111]
v_mfma_f32_16x16x32_bf16 v[100:103], a[252:255], a[128:131], v[100:103]
v_mfma_f32_16x16x32_bf16 v[100:103], a[248:251], a[112:115], v[100:103]
s_waitcnt lgkmcnt(4)
v_mfma_f32_16x16x32_bf16 v[128:131], a[80:83], a[144:147], v[128:131]
buffer_load_dwordx4 a[112:115], v7, s[16:19], s38 offen offset:0 sc1
v_mfma_f32_16x16x32_bf16 v[128:131], a[84:87], a[160:163], v[128:131]
ds_read_b64_tr_b16 a[96:97], v17 offset:32768
ds_read_b64_tr_b16 a[98:99], v17 offset:36864
v_mfma_f32_16x16x32_bf16 v[136:139], a[84:87], a[164:167], v[136:139]
ds_read_b64_tr_b16 a[100:101], v17 offset:40960
ds_read_b64_tr_b16 a[102:103], v17 offset:45056
v_mfma_f32_16x16x32_bf16 v[136:139], a[80:83], a[148:151], v[136:139]
v_mfma_f32_16x16x32_bf16 v[144:147], a[80:83], a[152:155], v[144:147]
v_mfma_f32_16x16x32_bf16 v[144:147], a[84:87], a[168:171], v[144:147]
buffer_load_dwordx4 a[116:119], v7, s[16:19], s38 offen offset:1024 sc1
v_mfma_f32_16x16x32_bf16 v[152:155], a[84:87], a[172:175], v[152:155]
v_mfma_f32_16x16x32_bf16 v[152:155], a[80:83], a[156:159], v[152:155]
s_waitcnt lgkmcnt(4)
v_mfma_f32_16x16x32_bf16 v[156:159], a[88:91], a[156:159], v[156:159]
ds_read_b64_tr_b16 a[104:105], v17 offset:32776
ds_read_b64_tr_b16 a[106:107], v17 offset:36872
v_mfma_f32_16x16x32_bf16 v[156:159], a[92:95], a[172:175], v[156:159]
ds_read_b64_tr_b16 a[108:109], v17 offset:40968
ds_read_b64_tr_b16 a[110:111], v17 offset:45064
v_mfma_f32_16x16x32_bf16 v[148:151], a[92:95], a[168:171], v[148:151]
buffer_load_dwordx4 a[120:123], v7, s[16:19], s38 offen offset:2048 sc1
v_mfma_f32_16x16x32_bf16 v[148:151], a[88:91], a[152:155], v[148:151]
v_mfma_f32_16x16x32_bf16 v[140:143], a[88:91], a[148:151], v[140:143]
v_mfma_f32_16x16x32_bf16 v[140:143], a[92:95], a[164:167], v[140:143]
v_mfma_f32_16x16x32_bf16 v[132:135], a[92:95], a[160:163], v[132:135]
v_mfma_f32_16x16x32_bf16 v[132:135], a[88:91], a[144:147], v[132:135]
s_waitcnt lgkmcnt(4)
buffer_load_dwordx4 a[124:127], v7, s[16:19], s38 offen offset:3072 sc1
v_mfma_f32_16x16x32_bf16 v[160:163], a[96:99], a[144:147], v[160:163]
s_add_u32 s38, s38, 16384
ds_read_b64_tr_b16 a[240:241], v18 offset:32768
ds_read_b64_tr_b16 a[242:243], v18 offset:36864
v_mfma_f32_16x16x32_bf16 v[160:163], a[100:103], a[160:163], v[160:163]
ds_read_b64_tr_b16 a[244:245], v18 offset:40960
ds_read_b64_tr_b16 a[246:247], v18 offset:45056
v_mfma_f32_16x16x32_bf16 v[168:171], a[100:103], a[164:167], v[168:171]
v_mfma_f32_16x16x32_bf16 v[168:171], a[96:99], a[148:151], v[168:171]
v_mfma_f32_16x16x32_bf16 v[176:179], a[96:99], a[152:155], v[176:179]
buffer_load_dwordx4 v28, s[32:35], s37 offen offset:3072 lds
v_mfma_f32_16x16x32_bf16 v[176:179], a[100:103], a[168:171], v[176:179]
s_add_u32 m0, s39, 110592
v_mfma_f32_16x16x32_bf16 v[184:187], a[100:103], a[172:175], v[184:187]
v_mfma_f32_16x16x32_bf16 v[184:187], a[96:99], a[156:159], v[184:187]
s_waitcnt lgkmcnt(4)
v_mfma_f32_16x16x32_bf16 v[188:191], a[104:107], a[156:159], v[188:191]
ds_read_b64_tr_b16 a[248:249], v18 offset:32776
ds_read_b64_tr_b16 a[250:251], v18 offset:36872
v_mfma_f32_16x16x32_bf16 v[188:191], a[108:111], a[172:175], v[188:191]
buffer_load_dwordx4 v29, s[32:35], s37 offen lds
v_mfma_f32_16x16x32_bf16 v[180:183], a[108:111], a[168:171], v[180:183]
s_add_u32 s37, s37, 589824
ds_read_b64_tr_b16 a[252:253], v18 offset:40968
ds_read_b64_tr_b16 a[254:255], v18 offset:45064
v_mfma_f32_16x16x32_bf16 v[180:183], a[104:107], a[152:155], v[180:183]
v_mfma_f32_16x16x32_bf16 v[172:175], a[104:107], a[148:151], v[172:175]
v_mfma_f32_16x16x32_bf16 v[172:175], a[108:111], a[164:167], v[172:175]
v_mfma_f32_16x16x32_bf16 v[164:167], a[108:111], a[160:163], v[164:167]
buffer_load_dwordx4 a[128:131], v7, s[16:19], s38 offen offset:0 sc1
v_mfma_f32_16x16x32_bf16 v[164:167], a[104:107], a[144:147], v[164:167]
s_waitcnt lgkmcnt(4)
v_mfma_f32_16x16x32_bf16 v[192:195], a[240:243], a[144:147], v[192:195]
ds_read_b64_tr_b16 a[80:81], v19 offset:32768
ds_read_b64_tr_b16 a[82:83], v19 offset:36864
v_mfma_f32_16x16x32_bf16 v[192:195], a[244:247], a[160:163], v[192:195]
ds_read_b64_tr_b16 a[84:85], v19 offset:40960
ds_read_b64_tr_b16 a[86:87], v19 offset:45056
v_mfma_f32_16x16x32_bf16 v[200:203], a[244:247], a[164:167], v[200:203]
v_mfma_f32_16x16x32_bf16 v[200:203], a[240:243], a[148:151], v[200:203]
buffer_load_dwordx4 a[132:135], v7, s[16:19], s38 offen offset:1024 sc1
v_mfma_f32_16x16x32_bf16 v[208:211], a[240:243], a[152:155], v[208:211]
v_mfma_f32_16x16x32_bf16 v[208:211], a[244:247], a[168:171], v[208:211]
v_mfma_f32_16x16x32_bf16 v[216:219], a[244:247], a[172:175], v[216:219]
v_mfma_f32_16x16x32_bf16 v[216:219], a[240:243], a[156:159], v[216:219]
s_waitcnt lgkmcnt(4)
v_mfma_f32_16x16x32_bf16 v[220:223], a[248:251], a[156:159], v[220:223]
buffer_load_dwordx4 a[136:139], v7, s[16:19], s38 offen offset:2048 sc1
v_mfma_f32_16x16x32_bf16 v[220:223], a[252:255], a[172:175], v[220:223]
ds_read_b64_tr_b16 a[88:89], v19 offset:32776
ds_read_b64_tr_b16 a[90:91], v19 offset:36872
v_mfma_f32_16x16x32_bf16 v[212:215], a[252:255], a[168:171], v[212:215]
ds_read_b64_tr_b16 a[92:93], v19 offset:40968
ds_read_b64_tr_b16 a[94:95], v19 offset:45064
v_mfma_f32_16x16x32_bf16 v[212:215], a[248:251], a[152:155], v[212:215]
v_mfma_f32_16x16x32_bf16 v[204:207], a[248:251], a[148:151], v[204:207]
v_mfma_f32_16x16x32_bf16 v[204:207], a[252:255], a[164:167], v[204:207]
buffer_load_dwordx4 a[140:143], v7, s[16:19], s38 offen offset:3072 sc1
v_mfma_f32_16x16x32_bf16 v[196:199], a[252:255], a[160:163], v[196:199]
s_add_u32 s38, s38, 16384
v_mfma_f32_16x16x32_bf16 v[196:199], a[248:251], a[144:147], v[196:199]
s_waitcnt lgkmcnt(4)
v_mfma_f32_16x16x32_bf16 v[224:227], a[80:83], a[144:147], v[224:227]
s_waitcnt vmcnt(53) lgkmcnt(0)
s_barrier
ds_read_b64_tr_b16 a[96:97], v20 offset:4096
v_mfma_f32_16x16x32_bf16 v[224:227], a[84:87], a[160:163], v[224:227]
s_add_u32 m0, s24, 65536
ds_read_b64_tr_b16 a[98:99], v20 offset:5120
ds_read_b64_tr_b16 a[100:101], v20 offset:6144
v_mfma_f32_16x16x32_bf16 v[232:235], a[84:87], a[164:167], v[232:235]
buffer_load_dwordx4 v21, s[28:31], s36 offen offset:0 lds
v_mfma_f32_16x16x32_bf16 v[232:235], a[80:83], a[148:151], v[232:235]
ds_read_b64_tr_b16 a[102:103], v20 offset:7168
v_mfma_f32_16x16x32_bf16 v[240:243], a[80:83], a[152:155], v[240:243]
v_mfma_f32_16x16x32_bf16 v[240:243], a[84:87], a[168:171], v[240:243]
v_mfma_f32_16x16x32_bf16 v[248:251], a[84:87], a[172:175], v[248:251]
v_mfma_f32_16x16x32_bf16 v[248:251], a[80:83], a[156:159], v[248:251]
s_waitcnt lgkmcnt(4)
buffer_load_dwordx4 v22, s[28:31], s36 offen offset:1024 lds
v_mfma_f32_16x16x32_bf16 v[252:255], a[88:91], a[156:159], v[252:255]
ds_read_b64_tr_b16 a[104:105], v6 offset:4096
ds_read_b64_tr_b16 a[106:107], v6 offset:5120
v_mfma_f32_16x16x32_bf16 v[252:255], a[92:95], a[172:175], v[252:255]
ds_read_b64_tr_b16 a[108:109], v6 offset:6144
ds_read_b64_tr_b16 a[110:111], v6 offset:7168
v_mfma_f32_16x16x32_bf16 v[244:247], a[92:95], a[168:171], v[244:247]
v_mfma_f32_16x16x32_bf16 v[244:247], a[88:91], a[152:155], v[244:247]
v_mfma_f32_16x16x32_bf16 v[236:239], a[88:91], a[148:151], v[236:239]
buffer_load_dwordx4 v23, s[28:31], s36 offen offset:2048 lds
v_mfma_f32_16x16x32_bf16 v[236:239], a[92:95], a[164:167], v[236:239]
v_mfma_f32_16x16x32_bf16 v[228:231], a[92:95], a[160:163], v[228:231]
v_mfma_f32_16x16x32_bf16 v[228:231], a[88:91], a[144:147], v[228:231]
s_waitcnt lgkmcnt(4)
v_mfma_f32_16x16x32_bf16 a[64:67], a[96:99], a[144:147], a[64:67]
ds_read_b64_tr_b16 a[240:241], v8 offset:32768
ds_read_b64_tr_b16 a[242:243], v8 offset:36864
v_mfma_f32_16x16x32_bf16 a[64:67], a[100:103], a[160:163], a[64:67]
buffer_load_dwordx4 v24, s[28:31], s36 offen offset:3072 lds
v_mfma_f32_16x16x32_bf16 a[68:71], a[100:103], a[164:167], a[68:71]
s_add_u32 s36, s36, 524288
s_add_u32 m0, s24, 81920
ds_read_b64_tr_b16 a[244:245], v8 offset:40960
v_mfma_f32_16x16x32_bf16 a[68:71], a[96:99], a[148:151], a[68:71]
ds_read_b64_tr_b16 a[246:247], v8 offset:45056
v_mfma_f32_16x16x32_bf16 a[72:75], a[96:99], a[152:155], a[72:75]
v_mfma_f32_16x16x32_bf16 a[72:75], a[100:103], a[168:171], a[72:75]
v_mfma_f32_16x16x32_bf16 a[76:79], a[100:103], a[172:175], a[76:79]
buffer_load_dwordx4 v34, s[12:15], s21 offen offset:0 lds
v_mfma_f32_16x16x32_bf16 a[76:79], a[96:99], a[156:159], a[76:79]
s_waitcnt lgkmcnt(4)
v_mfma_f32_16x16x32_bf16 v[60:63], a[104:107], a[156:159], v[60:63]
ds_read_b64_tr_b16 a[248:249], v9 offset:32768
ds_read_b64_tr_b16 a[250:251], v9 offset:36864
v_mfma_f32_16x16x32_bf16 v[60:63], a[108:111], a[172:175], v[60:63]
ds_read_b64_tr_b16 a[252:253], v9 offset:40960
ds_read_b64_tr_b16 a[254:255], v9 offset:45056
v_mfma_f32_16x16x32_bf16 v[56:59], a[108:111], a[168:171], v[56:59]
v_mfma_f32_16x16x32_bf16 v[56:59], a[104:107], a[152:155], v[56:59]
buffer_load_dwordx4 v35, s[12:15], s21 offen offset:1024 lds
v_mfma_f32_16x16x32_bf16 v[52:55], a[104:107], a[148:151], v[52:55]
v_mfma_f32_16x16x32_bf16 v[52:55], a[108:111], a[164:167], v[52:55]
v_mfma_f32_16x16x32_bf16 v[48:51], a[108:111], a[160:163], v[48:51]
v_mfma_f32_16x16x32_bf16 v[48:51], a[104:107], a[144:147], v[48:51]
s_waitcnt lgkmcnt(4)
v_mfma_f32_16x16x32_bf16 v[64:67], a[240:243], a[144:147], v[64:67]
buffer_load_dwordx4 v34, s[12:15], s21 offen offset:2048 lds
v_mfma_f32_16x16x32_bf16 v[64:67], a[244:247], a[160:163], v[64:67]
ds_read_b64_tr_b16 a[80:81], v10 offset:32768
ds_read_b64_tr_b16 a[82:83], v10 offset:36864
v_mfma_f32_16x16x32_bf16 v[72:75], a[244:247], a[164:167], v[72:75]
ds_read_b64_tr_b16 a[84:85], v10 offset:40960
ds_read_b64_tr_b16 a[86:87], v10 offset:45056
v_mfma_f32_16x16x32_bf16 v[72:75], a[240:243], a[148:151], v[72:75]
v_mfma_f32_16x16x32_bf16 v[80:83], a[240:243], a[152:155], v[80:83]
v_mfma_f32_16x16x32_bf16 v[80:83], a[244:247], a[168:171], v[80:83]
buffer_load_dwordx4 v35, s[12:15], s21 offen offset:3072 lds
v_mfma_f32_16x16x32_bf16 v[88:91], a[244:247], a[172:175], v[88:91]
s_add_u32 s21, s21, 16384
v_mfma_f32_16x16x32_bf16 v[88:91], a[240:243], a[156:159], v[88:91]
s_waitcnt lgkmcnt(4)
v_mfma_f32_16x16x32_bf16 v[92:95], a[248:251], a[156:159], v[92:95]
ds_read_b64_tr_b16 a[88:89], v11 offset:32768
ds_read_b64_tr_b16 a[90:91], v11 offset:36864
v_mfma_f32_16x16x32_bf16 v[92:95], a[252:255], a[172:175], v[92:95]
ds_read_b64_tr_b16 a[92:93], v11 offset:40960
ds_read_b64_tr_b16 a[94:95], v11 offset:45056
v_mfma_f32_16x16x32_bf16 v[84:87], a[252:255], a[168:171], v[84:87]
v_mfma_f32_16x16x32_bf16 v[84:87], a[248:251], a[152:155], v[84:87]
v_mfma_f32_16x16x32_bf16 v[76:79], a[248:251], a[148:151], v[76:79]
v_mfma_f32_16x16x32_bf16 v[76:79], a[252:255], a[164:167], v[76:79]
v_mfma_f32_16x16x32_bf16 v[68:71], a[252:255], a[160:163], v[68:71]
v_mfma_f32_16x16x32_bf16 v[68:71], a[248:251], a[144:147], v[68:71]
s_waitcnt lgkmcnt(4)
v_mfma_f32_16x16x32_bf16 a[0:3], a[80:83], a[144:147], a[0:3]
ds_read_b64_tr_b16 a[96:97], v12 offset:32768
ds_read_b64_tr_b16 a[98:99], v12 offset:36864
v_mfma_f32_16x16x32_bf16 a[0:3], a[84:87], a[160:163], a[0:3]
ds_read_b64_tr_b16 a[100:101], v12 offset:40960
ds_read_b64_tr_b16 a[102:103], v12 offset:45056
v_mfma_f32_16x16x32_bf16 a[8:11], a[84:87], a[164:167], a[8:11]
v_mfma_f32_16x16x32_bf16 a[8:11], a[80:83], a[148:151], a[8:11]
v_mfma_f32_16x16x32_bf16 a[16:19], a[80:83], a[152:155], a[16:19]
v_mfma_f32_16x16x32_bf16 a[16:19], a[84:87], a[168:171], a[16:19]
v_mfma_f32_16x16x32_bf16 a[24:27], a[84:87], a[172:175], a[24:27]
v_mfma_f32_16x16x32_bf16 a[24:27], a[80:83], a[156:159], a[24:27]
s_waitcnt lgkmcnt(4)
v_mfma_f32_16x16x32_bf16 a[28:31], a[88:91], a[156:159], a[28:31]
ds_read_b64_tr_b16 a[104:105], v13 offset:32768
ds_read_b64_tr_b16 a[106:107], v13 offset:36864
v_mfma_f32_16x16x32_bf16 a[28:31], a[92:95], a[172:175], a[28:31]
ds_read_b64_tr_b16 a[108:109], v13 offset:40960
ds_read_b64_tr_b16 a[110:111], v13 offset:45056
v_mfma_f32_16x16x32_bf16 a[20:23], a[92:95], a[168:171], a[20:23]
v_mfma_f32_16x16x32_bf16 a[20:23], a[88:91], a[152:155], a[20:23]
v_mfma_f32_16x16x32_bf16 a[12:15], a[88:91], a[148:151], a[12:15]
v_mfma_f32_16x16x32_bf16 a[12:15], a[92:95], a[164:167], a[12:15]
v_mfma_f32_16x16x32_bf16 a[4:7], a[92:95], a[160:163], a[4:7]
v_mfma_f32_16x16x32_bf16 a[4:7], a[88:91], a[144:147], a[4:7]
s_waitcnt lgkmcnt(4)
v_mfma_f32_16x16x32_bf16 a[32:35], a[96:99], a[144:147], a[32:35]
ds_read_b64_tr_b16 a[240:241], v14 offset:32768
ds_read_b64_tr_b16 a[242:243], v14 offset:36864
v_mfma_f32_16x16x32_bf16 a[32:35], a[100:103], a[160:163], a[32:35]
ds_read_b64_tr_b16 a[244:245], v14 offset:40960
ds_read_b64_tr_b16 a[246:247], v14 offset:45056
v_mfma_f32_16x16x32_bf16 a[40:43], a[100:103], a[164:167], a[40:43]
v_mfma_f32_16x16x32_bf16 a[40:43], a[96:99], a[148:151], a[40:43]
v_mfma_f32_16x16x32_bf16 a[48:51], a[96:99], a[152:155], a[48:51]
v_mfma_f32_16x16x32_bf16 a[48:51], a[100:103], a[168:171], a[48:51]
v_mfma_f32_16x16x32_bf16 a[56:59], a[100:103], a[172:175], a[56:59]
v_mfma_f32_16x16x32_bf16 a[56:59], a[96:99], a[156:159], a[56:59]
s_waitcnt lgkmcnt(4)
v_mfma_f32_16x16x32_bf16 a[60:63], a[104:107], a[156:159], a[60:63]
ds_read_b64_tr_b16 a[248:249], v15 offset:32768
ds_read_b64_tr_b16 a[250:251], v15 offset:36864
v_mfma_f32_16x16x32_bf16 a[60:63], a[108:111], a[172:175], a[60:63]
ds_read_b64_tr_b16 a[252:253], v15 offset:40960
ds_read_b64_tr_b16 a[254:255], v15 offset:45056
v_mfma_f32_16x16x32_bf16 a[52:55], a[108:111], a[168:171], a[52:55]
v_mfma_f32_16x16x32_bf16 a[52:55], a[104:107], a[152:155], a[52:55]
v_mfma_f32_16x16x32_bf16 a[44:47], a[104:107], a[148:151], a[44:47]
v_mfma_f32_16x16x32_bf16 a[44:47], a[108:111], a[164:167], a[44:47]
v_mfma_f32_16x16x32_bf16 a[36:39], a[108:111], a[160:163], a[36:39]
v_mfma_f32_16x16x32_bf16 a[36:39], a[104:107], a[144:147], a[36:39]
s_waitcnt lgkmcnt(4)
v_mfma_f32_16x16x32_bf16 v[96:99], a[240:243], a[144:147], v[96:99]
s_waitcnt vmcnt(49) lgkmcnt(0)
s_barrier
ds_read_b64_tr_b16 a[80:81], v16 offset:0
v_mfma_f32_16x16x32_bf16 v[96:99], a[244:247], a[160:163], v[96:99]
s_add_u32 m0, s24, 147456
ds_read_b64_tr_b16 a[82:83], v16 offset:4096
ds_read_b64_tr_b16 a[84:85], v16 offset:8192
v_mfma_f32_16x16x32_bf16 v[104:107], a[244:247], a[164:167], v[104:107]
buffer_load_dwordx4 v25, s[32:35], s37 offen offset:0 lds
v_mfma_f32_16x16x32_bf16 v[104:107], a[240:243], a[148:151], v[104:107]
ds_read_b64_tr_b16 a[86:87], v16 offset:12288
v_mfma_f32_16x16x32_bf16 v[112:115], a[240:243], a[152:155], v[112:115]
v_mfma_f32_16x16x32_bf16 v[112:115], a[244:247], a[168:171], v[112:115]
v_mfma_f32_16x16x32_bf16 v[120:123], a[244:247], a[172:175], v[120:123]
buffer_load_dwordx4 v26, s[32:35], s37 offen offset:1024 lds
v_mfma_f32_16x16x32_bf16 v[120:123], a[240:243], a[156:159], v[120:123]
s_waitcnt lgkmcnt(4)
v_mfma_f32_16x16x32_bf16 v[124:127], a[248:251], a[156:159], v[124:127]
ds_read_b64_tr_b16 a[88:89], v16 offset:8
ds_read_b64_tr_b16 a[90:91], v16 offset:4104
v_mfma_f32_16x16x32_bf16 v[124:127], a[252:255], a[172:175], v[124:127]
ds_read_b64_tr_b16 a[92:93], v16 offset:8200
ds_read_b64_tr_b16 a[94:95], v16 offset:12296
v_mfma_f32_16x16x32_bf16 v[116:119], a[252:255], a[168:171], v[116:119]
v_mfma_f32_16x16x32_bf16 v[116:119], a[248:251], a[152:155], v[116:119]
buffer_load_dwordx4 v27, s[32:35], s37 offen offset:2048 lds
v_mfma_f32_16x16x32_bf16 v[108:111], a[248:251], a[148:151], v[108:111]
v_mfma_f32_16x16x32_bf16 v[108:111], a[252:255], a[164:167], v[108:111]
v_mfma_f32_16x16x32_bf16 v[100:103], a[252:255], a[160:163], v[100:103]
v_mfma_f32_16x16x32_bf16 v[100:103], a[248:251], a[144:147], v[100:103]
s_waitcnt lgkmcnt(4)
v_mfma_f32_16x16x32_bf16 v[128:131], a[80:83], a[176:179], v[128:131]
buffer_load_dwordx4 v28, s[32:35], s37 offen offset:3072 lds
v_mfma_f32_16x16x32_bf16 v[128:131], a[84:87], a[192:195], v[128:131]
s_add_u32 m0, s39, 98304
ds_read_b64_tr_b16 a[96:97], v17 offset:0
ds_read_b64_tr_b16 a[98:99], v17 offset:4096
v_mfma_f32_16x16x32_bf16 v[136:139], a[84:87], a[196:199], v[136:139]
ds_read_b64_tr_b16 a[100:101], v17 offset:8192
ds_read_b64_tr_b16 a[102:103], v17 offset:12288
v_mfma_f32_16x16x32_bf16 v[136:139], a[80:83], a[180:183], v[136:139]
s_lshr_b32 s46, s26, 1
s_lshl_b32 s46, s46, 2
s_add_u32 s46, s46, s23
v_mfma_f32_16x16x32_bf16 v[144:147], a[80:83], a[184:187], v[144:147]
s_lshl_b32 s46, s46, 11
s_add_u32 s46, s46, 32768
v_and_b32 v3, 15, v0
v_mfma_f32_16x16x32_bf16 v[144:147], a[84:87], a[200:203], v[144:147]
buffer_load_dwordx4 v29, s[32:35], s37 offen lds
v_mfma_f32_16x16x32_bf16 v[152:155], a[84:87], a[204:207], v[152:155]
s_add_u32 s37, s37, 589824
v_lshlrev_b32 v3, 7, v3
v_mfma_f32_16x16x32_bf16 v[152:155], a[80:83], a[188:191], v[152:155]
s_waitcnt lgkmcnt(4)
v_mfma_f32_16x16x32_bf16 v[156:159], a[88:91], a[188:191], v[156:159]
ds_read_b64_tr_b16 a[104:105], v17 offset:8
ds_read_b64_tr_b16 a[106:107], v17 offset:4104
v_mfma_f32_16x16x32_bf16 v[156:159], a[92:95], a[204:207], v[156:159]
ds_read_b64_tr_b16 a[108:109], v17 offset:8200
ds_read_b64_tr_b16 a[110:111], v17 offset:12296
v_mfma_f32_16x16x32_bf16 v[148:151], a[92:95], a[200:203], v[148:151]
buffer_load_dword v4, v3, s[8:11], s46 offen
v_mfma_f32_16x16x32_bf16 v[148:151], a[88:91], a[184:187], v[148:151]
s_sub_u32 s46, s46, 32768
v_mfma_f32_16x16x32_bf16 v[140:143], a[88:91], a[180:183], v[140:143]
buffer_load_dword v5, v3, s[12:15], s46 offen
v_mfma_f32_16x16x32_bf16 v[140:143], a[92:95], a[196:199], v[140:143]
v_mfma_f32_16x16x32_bf16 v[132:135], a[92:95], a[192:195], v[132:135]
v_mfma_f32_16x16x32_bf16 v[132:135], a[88:91], a[176:179], v[132:135]
s_waitcnt lgkmcnt(4)
v_mfma_f32_16x16x32_bf16 v[160:163], a[96:99], a[176:179], v[160:163]
ds_read_b64_tr_b16 a[240:241], v18 offset:0
ds_read_b64_tr_b16 a[242:243], v18 offset:4096
v_mfma_f32_16x16x32_bf16 v[160:163], a[100:103], a[192:195], v[160:163]
ds_read_b64_tr_b16 a[244:245], v18 offset:8192
ds_read_b64_tr_b16 a[246:247], v18 offset:12288
v_mfma_f32_16x16x32_bf16 v[168:171], a[100:103], a[196:199], v[168:171]
v_mfma_f32_16x16x32_bf16 v[168:171], a[96:99], a[180:183], v[168:171]
v_mfma_f32_16x16x32_bf16 v[176:179], a[96:99], a[184:187], v[176:179]
v_mfma_f32_16x16x32_bf16 v[176:179], a[100:103], a[200:203], v[176:179]
v_mfma_f32_16x16x32_bf16 v[184:187], a[100:103], a[204:207], v[184:187]
v_mfma_f32_16x16x32_bf16 v[184:187], a[96:99], a[188:191], v[184:187]
s_waitcnt lgkmcnt(4)
v_mfma_f32_16x16x32_bf16 v[188:191], a[104:107], a[188:191], v[188:191]
ds_read_b64_tr_b16 a[248:249], v18 offset:8
ds_read_b64_tr_b16 a[250:251], v18 offset:4104
v_mfma_f32_16x16x32_bf16 v[188:191], a[108:111], a[204:207], v[188:191]
ds_read_b64_tr_b16 a[252:253], v18 offset:8200
ds_read_b64_tr_b16 a[254:255], v18 offset:12296
v_mfma_f32_16x16x32_bf16 v[180:183], a[108:111], a[200:203], v[180:183]
v_mfma_f32_16x16x32_bf16 v[180:183], a[104:107], a[184:187], v[180:183]
v_mfma_f32_16x16x32_bf16 v[172:175], a[104:107], a[180:183], v[172:175]
v_mfma_f32_16x16x32_bf16 v[172:175], a[108:111], a[196:199], v[172:175]
v_mfma_f32_16x16x32_bf16 v[164:167], a[108:111], a[192:195], v[164:167]
v_mfma_f32_16x16x32_bf16 v[164:167], a[104:107], a[176:179], v[164:167]
s_waitcnt lgkmcnt(4)
v_mfma_f32_16x16x32_bf16 v[192:195], a[240:243], a[176:179], v[192:195]
ds_read_b64_tr_b16 a[80:81], v19 offset:0
ds_read_b64_tr_b16 a[82:83], v19 offset:4096
v_mfma_f32_16x16x32_bf16 v[192:195], a[244:247], a[192:195], v[192:195]
ds_read_b64_tr_b16 a[84:85], v19 offset:8192
ds_read_b64_tr_b16 a[86:87], v19 offset:12288
v_mfma_f32_16x16x32_bf16 v[200:203], a[244:247], a[196:199], v[200:203]
v_mfma_f32_16x16x32_bf16 v[200:203], a[240:243], a[180:183], v[200:203]
v_mfma_f32_16x16x32_bf16 v[208:211], a[240:243], a[184:187], v[208:211]
v_mfma_f32_16x16x32_bf16 v[208:211], a[244:247], a[200:203], v[208:211]
v_mfma_f32_16x16x32_bf16 v[216:219], a[244:247], a[204:207], v[216:219]
v_mfma_f32_16x16x32_bf16 v[216:219], a[240:243], a[188:191], v[216:219]
s_waitcnt lgkmcnt(4)
v_mfma_f32_16x16x32_bf16 v[220:223], a[248:251], a[188:191], v[220:223]
ds_read_b64_tr_b16 a[88:89], v19 offset:8
ds_read_b64_tr_b16 a[90:91], v19 offset:4104
v_mfma_f32_16x16x32_bf16 v[220:223], a[252:255], a[204:207], v[220:223]
ds_read_b64_tr_b16 a[92:93], v19 offset:8200
ds_read_b64_tr_b16 a[94:95], v19 offset:12296
v_mfma_f32_16x16x32_bf16 v[212:215], a[252:255], a[200:203], v[212:215]
v_mfma_f32_16x16x32_bf16 v[212:215], a[248:251], a[184:187], v[212:215]
v_mfma_f32_16x16x32_bf16 v[204:207], a[248:251], a[180:183], v[204:207]
v_mfma_f32_16x16x32_bf16 v[204:207], a[252:255], a[196:199], v[204:207]
v_mfma_f32_16x16x32_bf16 v[196:199], a[252:255], a[192:195], v[196:199]
s_waitcnt vmcnt(11) lgkmcnt(0)
s_barrier
ds_read_b64_tr_b16 a[96:97], v16 offset:16384
v_mfma_f32_16x16x32_bf16 v[196:199], a[248:251], a[176:179], v[196:199]
s_waitcnt lgkmcnt(5)
ds_read_b64_tr_b16 a[98:99], v16 offset:20480
ds_read_b64_tr_b16 a[100:101], v16 offset:24576
v_mfma_f32_16x16x32_bf16 v[224:227], a[80:83], a[176:179], v[224:227]
ds_read_b64_tr_b16 a[102:103], v16 offset:28672
ds_read_b64_tr_b16 a[104:105], v16 offset:32768
v_mfma_f32_16x16x32_bf16 v[224:227], a[84:87], a[192:195], v[224:227]
ds_read_b64_tr_b16 a[106:107], v16 offset:36864
ds_read_b64_tr_b16 a[108:109], v16 offset:40960
v_mfma_f32_16x16x32_bf16 v[232:235], a[84:87], a[196:199], v[232:235]
ds_read_b64_tr_b16 a[110:111], v16 offset:45056
v_mfma_f32_16x16x32_bf16 v[232:235], a[80:83], a[180:183], v[232:235]
v_mfma_f32_16x16x32_bf16 v[240:243], a[80:83], a[184:187], v[240:243]
v_mfma_f32_16x16x32_bf16 v[240:243], a[84:87], a[200:203], v[240:243]
v_mfma_f32_16x16x32_bf16 v[248:251], a[84:87], a[204:207], v[248:251]
v_mfma_f32_16x16x32_bf16 v[248:251], a[80:83], a[188:191], v[248:251]
s_waitcnt lgkmcnt(8)
v_mfma_f32_16x16x32_bf16 v[252:255], a[88:91], a[188:191], v[252:255]
v_mfma_f32_16x16x32_bf16 v[252:255], a[92:95], a[204:207], v[252:255]
v_mfma_f32_16x16x32_bf16 v[244:247], a[92:95], a[200:203], v[244:247]
v_mfma_f32_16x16x32_bf16 v[244:247], a[88:91], a[184:187], v[244:247]
v_mfma_f32_16x16x32_bf16 v[236:239], a[88:91], a[180:183], v[236:239]
v_mfma_f32_16x16x32_bf16 v[236:239], a[92:95], a[196:199], v[236:239]
v_mfma_f32_16x16x32_bf16 v[228:231], a[92:95], a[192:195], v[228:231]
ds_read_b64_tr_b16 a[240:241], v16 offset:16392
ds_read_b64_tr_b16 a[242:243], v16 offset:20488
v_mfma_f32_16x16x32_bf16 v[228:231], a[88:91], a[176:179], v[228:231]
s_waitcnt lgkmcnt(2)
ds_read_b64_tr_b16 a[244:245], v16 offset:24584
ds_read_b64_tr_b16 a[246:247], v16 offset:28680
v_mfma_f32_16x16x32_bf16 v[128:131], a[96:99], a[208:211], v[128:131]
ds_read_b64_tr_b16 a[248:249], v16 offset:32776
ds_read_b64_tr_b16 a[250:251], v16 offset:36872
v_mfma_f32_16x16x32_bf16 v[128:131], a[100:103], a[224:227], v[128:131]
ds_read_b64_tr_b16 a[252:253], v16 offset:40968
ds_read_b64_tr_b16 a[254:255], v16 offset:45064
v_mfma_f32_16x16x32_bf16 v[128:131], a[104:107], a[112:115], v[128:131]
v_mfma_f32_16x16x32_bf16 v[128:131], a[108:111], a[128:131], v[128:131]
v_mfma_f32_16x16x32_bf16 v[136:139], a[108:111], a[132:135], v[136:139]
v_mfma_f32_16x16x32_bf16 v[136:139], a[104:107], a[116:119], v[136:139]
v_mfma_f32_16x16x32_bf16 v[136:139], a[100:103], a[228:231], v[136:139]
v_mfma_f32_16x16x32_bf16 v[136:139], a[96:99], a[212:215], v[136:139]
v_mfma_f32_16x16x32_bf16 v[144:147], a[96:99], a[216:219], v[144:147]
v_mfma_f32_16x16x32_bf16 v[144:147], a[100:103], a[232:235], v[144:147]
v_mfma_f32_16x16x32_bf16 v[144:147], a[104:107], a[120:123], v[144:147]
v_mfma_f32_16x16x32_bf16 v[144:147], a[108:111], a[136:139], v[144:147]
v_mfma_f32_16x16x32_bf16 v[152:155], a[108:111], a[140:143], v[152:155]
v_mfma_f32_16x16x32_bf16 v[152:155], a[104:107], a[124:127], v[152:155]
v_mfma_f32_16x16x32_bf16 v[152:155], a[100:103], a[236:239], v[152:155]
ds_read_b64_tr_b16 a[80:81], v17 offset:16384
ds_read_b64_tr_b16 a[82:83], v17 offset:20480
v_mfma_f32_16x16x32_bf16 v[152:155], a[96:99], a[220:223], v[152:155]
s_waitcnt lgkmcnt(2)
ds_read_b64_tr_b16 a[84:85], v17 offset:24576
ds_read_b64_tr_b16 a[86:87], v17 offset:28672
v_mfma_f32_16x16x32_bf16 v[156:159], a[240:243], a[220:223], v[156:159]
ds_read_b64_tr_b16 a[88:89], v17 offset:32768
ds_read_b64_tr_b16 a[90:91], v17 offset:36864
v_mfma_f32_16x16x32_bf16 v[156:159], a[244:247], a[236:239], v[156:159]
ds_read_b64_tr_b16 a[92:93], v17 offset:40960
ds_read_b64_tr_b16 a[94:95], v17 offset:45056
v_mfma_f32_16x16x32_bf16 v[156:159], a[248:251], a[124:127], v[156:159]
v_mfma_f32_16x16x32_bf16 v[156:159], a[252:255], a[140:143], v[156:159]
v_mfma_f32_16x16x32_bf16 v[148:151], a[252:255], a[136:139], v[148:151]
v_mfma_f32_16x16x32_bf16 v[148:151], a[248:251], a[120:123], v[148:151]
v_mfma_f32_16x16x32_bf16 v[148:151], a[244:247], a[232:235], v[148:151]
v_mfma_f32_16x16x32_bf16 v[148:151], a[240:243], a[216:219], v[148:151]
v_mfma_f32_16x16x32_bf16 v[140:143], a[240:243], a[212:215], v[140:143]
v_mfma_f32_16x16x32_bf16 v[140:143], a[244:247], a[228:231], v[140:143]
v_mfma_f32_16x16x32_bf16 v[140:143], a[248:251], a[116:119], v[140:143]
v_mfma_f32_16x16x32_bf16 v[140:143], a[252:255], a[132:135], v[140:143]
v_mfma_f32_16x16x32_bf16 v[132:135], a[252:255], a[128:131], v[132:135]
v_mfma_f32_16x16x32_bf16 v[132:135], a[248:251], a[112:115], v[132:135]
v_mfma_f32_16x16x32_bf16 v[132:135], a[244:247], a[224:227], v[132:135]
ds_read_b64_tr_b16 a[96:97], v17 offset:16392
ds_read_b64_tr_b16 a[98:99], v17 offset:20488
v_mfma_f32_16x16x32_bf16 v[132:135], a[240:243], a[208:211], v[132:135]
s_waitcnt lgkmcnt(2)
ds_read_b64_tr_b16 a[100:101], v17 offset:24584
ds_read_b64_tr_b16 a[102:103], v17 offset:28680
v_mfma_f32_16x16x32_bf16 v[160:163], a[80:83], a[208:211], v[160:163]
ds_read_b64_tr_b16 a[104:105], v17 offset:32776
ds_read_b64_tr_b16 a[106:107], v17 offset:36872
v_mfma_f32_16x16x32_bf16 v[160:163], a[84:87], a[224:227], v[160:163]
ds_read_b64_tr_b16 a[108:109], v17 offset:40968
ds_read_b64_tr_b16 a[110:111], v17 offset:45064
v_mfma_f32_16x16x32_bf16 v[160:163], a[88:91], a[112:115], v[160:163]
v_mfma_f32_16x16x32_bf16 v[160:163], a[92:95], a[128:131], v[160:163]
v_mfma_f32_16x16x32_bf16 v[168:171], a[92:95], a[132:135], v[168:171]
v_mul_f32 v128, s45, v128
v_mul_f32 v129, s45, v129
v_mfma_f32_16x16x32_bf16 v[168:171], a[88:91], a[116:119], v[168:171]
v_mul_f32 v130, s45, v130
v_mul_f32 v131, s45, v131
v_mfma_f32_16x16x32_bf16 v[168:171], a[84:87], a[228:231], v[168:171]
v_mul_f32 v132, s45, v132
v_mul_f32 v133, s45, v133
v_mfma_f32_16x16x32_bf16 v[168:171], a[80:83], a[212:215], v[168:171]
v_mul_f32 v134, s45, v134
v_mul_f32 v135, s45, v135
v_mfma_f32_16x16x32_bf16 v[176:179], a[80:83], a[216:219], v[176:179]
v_cvt_pk_bf16_f32 v128, v128, v129
v_cvt_pk_bf16_f32 v129, v130, v131
v_mfma_f32_16x16x32_bf16 v[176:179], a[84:87], a[232:235], v[176:179]
v_cvt_pk_bf16_f32 v130, v132, v133
v_cvt_pk_bf16_f32 v131, v134, v135
v_mfma_f32_16x16x32_bf16 v[176:179], a[88:91], a[120:123], v[176:179]
v_mul_f32 v136, s45, v136
v_mul_f32 v137, s45, v137
v_mfma_f32_16x16x32_bf16 v[176:179], a[92:95], a[136:139], v[176:179]
v_mul_f32 v138, s45, v138
v_mul_f32 v139, s45, v139
v_mfma_f32_16x16x32_bf16 v[184:187], a[92:95], a[140:143], v[184:187]
v_mul_f32 v140, s45, v140
v_mul_f32 v141, s45, v141
v_mfma_f32_16x16x32_bf16 v[184:187], a[88:91], a[124:127], v[184:187]
v_mul_f32 v142, s45, v142
v_mul_f32 v143, s45, v143
v_mfma_f32_16x16x32_bf16 v[184:187], a[84:87], a[236:239], v[184:187]
ds_read_b64_tr_b16 a[240:241], v18 offset:16384
ds_read_b64_tr_b16 a[242:243], v18 offset:20480
v_mfma_f32_16x16x32_bf16 v[184:187], a[80:83], a[220:223], v[184:187]
s_waitcnt lgkmcnt(2)
ds_read_b64_tr_b16 a[244:245], v18 offset:24576
ds_read_b64_tr_b16 a[246:247], v18 offset:28672
v_mfma_f32_16x16x32_bf16 v[188:191], a[96:99], a[220:223], v[188:191]
ds_read_b64_tr_b16 a[248:249], v18 offset:32768
ds_read_b64_tr_b16 a[250:251], v18 offset:36864
v_mfma_f32_16x16x32_bf16 v[188:191], a[100:103], a[236:239], v[188:191]
ds_read_b64_tr_b16 a[252:253], v18 offset:40960
ds_read_b64_tr_b16 a[254:255], v18 offset:45056
v_mfma_f32_16x16x32_bf16 v[188:191], a[104:107], a[124:127], v[188:191]
v_cvt_pk_bf16_f32 v132, v136, v137
v_cvt_pk_bf16_f32 v133, v138, v139
v_mfma_f32_16x16x32_bf16 v[188:191], a[108:111], a[140:143], v[188:191]
v_cvt_pk_bf16_f32 v134, v140, v141
v_cvt_pk_bf16_f32 v135, v142, v143
v_mfma_f32_16x16x32_bf16 v[180:183], a[108:111], a[136:139], v[180:183]
v_mul_f32 v144, s45, v144
v_mul_f32 v145, s45, v145
v_mfma_f32_16x16x32_bf16 v[180:183], a[104:107], a[120:123], v[180:183]
v_mul_f32 v146, s45, v146
v_mul_f32 v147, s45, v147
v_mfma_f32_16x16x32_bf16 v[180:183], a[100:103], a[232:235], v[180:183]
v_mul_f32 v148, s45, v148
v_mul_f32 v149, s45, v149
v_mfma_f32_16x16x32_bf16 v[180:183], a[96:99], a[216:219], v[180:183]
v_mul_f32 v150, s45, v150
v_mul_f32 v151, s45, v151
v_mfma_f32_16x16x32_bf16 v[172:175], a[96:99], a[212:215], v[172:175]
v_cvt_pk_bf16_f32 v136, v144, v145
v_cvt_pk_bf16_f32 v137, v146, v147
v_mfma_f32_16x16x32_bf16 v[172:175], a[100:103], a[228:231], v[172:175]
v_cvt_pk_bf16_f32 v138, v148, v149
v_cvt_pk_bf16_f32 v139, v150, v151
v_mfma_f32_16x16x32_bf16 v[172:175], a[104:107], a[116:119], v[172:175]
v_mul_f32 v152, s45, v152
v_mul_f32 v153, s45, v153
v_mfma_f32_16x16x32_bf16 v[172:175], a[108:111], a[132:135], v[172:175]
v_mul_f32 v154, s45, v154
v_mul_f32 v155, s45, v155
v_mfma_f32_16x16x32_bf16 v[164:167], a[108:111], a[128:131], v[164:167]
v_mul_f32 v156, s45, v156
v_mul_f32 v157, s45, v157
v_mfma_f32_16x16x32_bf16 v[164:167], a[104:107], a[112:115], v[164:167]
v_mul_f32 v158, s45, v158
v_mul_f32 v159, s45, v159
v_mfma_f32_16x16x32_bf16 v[164:167], a[100:103], a[224:227], v[164:167]
ds_read_b64_tr_b16 a[80:81], v18 offset:16392
ds_read_b64_tr_b16 a[82:83], v18 offset:20488
v_mfma_f32_16x16x32_bf16 v[164:167], a[96:99], a[208:211], v[164:167]
s_waitcnt lgkmcnt(2)
ds_read_b64_tr_b16 a[84:85], v18 offset:24584
ds_read_b64_tr_b16 a[86:87], v18 offset:28680
v_mfma_f32_16x16x32_bf16 v[192:195], a[240:243], a[208:211], v[192:195]
ds_read_b64_tr_b16 a[88:89], v18 offset:32776
ds_read_b64_tr_b16 a[90:91], v18 offset:36872
v_mfma_f32_16x16x32_bf16 v[192:195], a[244:247], a[224:227], v[192:195]
ds_read_b64_tr_b16 a[92:93], v18 offset:40968
ds_read_b64_tr_b16 a[94:95], v18 offset:45064
v_mfma_f32_16x16x32_bf16 v[192:195], a[248:251], a[112:115], v[192:195]
v_cvt_pk_bf16_f32 v140, v152, v153
v_cvt_pk_bf16_f32 v141, v154, v155
v_mfma_f32_16x16x32_bf16 v[192:195], a[252:255], a[128:131], v[192:195]
v_cvt_pk_bf16_f32 v142, v156, v157
v_cvt_pk_bf16_f32 v143, v158, v159
v_mfma_f32_16x16x32_bf16 v[200:203], a[252:255], a[132:135], v[200:203]
v_mul_f32 v160, s45, v160
v_mul_f32 v161, s45, v161
v_mfma_f32_16x16x32_bf16 v[200:203], a[248:251], a[116:119], v[200:203]
v_mul_f32 v162, s45, v162
v_mul_f32 v163, s45, v163
v_mfma_f32_16x16x32_bf16 v[200:203], a[244:247], a[228:231], v[200:203]
v_mul_f32 v164, s45, v164
v_mul_f32 v165, s45, v165
v_mfma_f32_16x16x32_bf16 v[200:203], a[240:243], a[212:215], v[200:203]
v_mul_f32 v166, s45, v166
v_mul_f32 v167, s45, v167
v_mfma_f32_16x16x32_bf16 v[208:211], a[240:243], a[216:219], v[208:211]
v_cvt_pk_bf16_f32 v144, v160, v161
v_cvt_pk_bf16_f32 v145, v162, v163
v_mfma_f32_16x16x32_bf16 v[208:211], a[244:247], a[232:235], v[208:211]
v_cvt_pk_bf16_f32 v146, v164, v165
v_cvt_pk_bf16_f32 v147, v166, v167
v_mfma_f32_16x16x32_bf16 v[208:211], a[248:251], a[120:123], v[208:211]
v_mul_f32 v168, s45, v168
v_mul_f32 v169, s45, v169
v_mfma_f32_16x16x32_bf16 v[208:211], a[252:255], a[136:139], v[208:211]
v_mul_f32 v170, s45, v170
v_mul_f32 v171, s45, v171
v_mfma_f32_16x16x32_bf16 v[216:219], a[252:255], a[140:143], v[216:219]
v_mul_f32 v172, s45, v172
v_mul_f32 v173, s45, v173
v_mfma_f32_16x16x32_bf16 v[216:219], a[248:251], a[124:127], v[216:219]
v_mul_f32 v174, s45, v174
v_mul_f32 v175, s45, v175
v_mfma_f32_16x16x32_bf16 v[216:219], a[244:247], a[236:239], v[216:219]
ds_read_b64_tr_b16 a[96:97], v19 offset:16384
ds_read_b64_tr_b16 a[98:99], v19 offset:20480
v_mfma_f32_16x16x32_bf16 v[216:219], a[240:243], a[220:223], v[216:219]
s_waitcnt lgkmcnt(2)
ds_read_b64_tr_b16 a[100:101], v19 offset:24576
ds_read_b64_tr_b16 a[102:103], v19 offset:28672
v_mfma_f32_16x16x32_bf16 v[220:223], a[80:83], a[220:223], v[220:223]
ds_read_b64_tr_b16 a[104:105], v19 offset:32768
ds_read_b64_tr_b16 a[106:107], v19 offset:36864
v_mfma_f32_16x16x32_bf16 v[220:223], a[84:87], a[236:239], v[220:223]
ds_read_b64_tr_b16 a[108:109], v19 offset:40960
ds_read_b64_tr_b16 a[110:111], v19 offset:45056
v_mfma_f32_16x16x32_bf16 v[220:223], a[88:91], a[124:127], v[220:223]
v_cvt_pk_bf16_f32 v148, v168, v169
v_cvt_pk_bf16_f32 v149, v170, v171
v_mfma_f32_16x16x32_bf16 v[220:223], a[92:95], a[140:143], v[220:223]
v_cvt_pk_bf16_f32 v150, v172, v173
v_cvt_pk_bf16_f32 v151, v174, v175
v_mfma_f32_16x16x32_bf16 v[212:215], a[92:95], a[136:139], v[212:215]
v_mul_f32 v176, s45, v176
v_mul_f32 v177, s45, v177
v_mfma_f32_16x16x32_bf16 v[212:215], a[88:91], a[120:123], v[212:215]
v_mul_f32 v178, s45, v178
v_mul_f32 v179, s45, v179
v_mfma_f32_16x16x32_bf16 v[212:215], a[84:87], a[232:235], v[212:215]
v_mul_f32 v180, s45, v180
v_mul_f32 v181, s45, v181
v_mfma_f32_16x16x32_bf16 v[212:215], a[80:83], a[216:219], v[212:215]
v_mul_f32 v182, s45, v182
v_mul_f32 v183, s45, v183
v_mfma_f32_16x16x32_bf16 v[204:207], a[80:83], a[212:215], v[204:207]
v_cvt_pk_bf16_f32 v152, v176, v177
v_cvt_pk_bf16_f32 v153, v178, v179
v_mfma_f32_16x16x32_bf16 v[204:207], a[84:87], a[228:231], v[204:207]
v_cvt_pk_bf16_f32 v154, v180, v181
v_cvt_pk_bf16_f32 v155, v182, v183
v_mfma_f32_16x16x32_bf16 v[204:207], a[88:91], a[116:119], v[204:207]
v_mul_f32 v184, s45, v184
v_mul_f32 v185, s45, v185
v_mfma_f32_16x16x32_bf16 v[204:207], a[92:95], a[132:135], v[204:207]
v_mul_f32 v186, s45, v186
v_mul_f32 v187, s45, v187
v_mfma_f32_16x16x32_bf16 v[196:199], a[92:95], a[128:131], v[196:199]
v_mul_f32 v188, s45, v188
v_mul_f32 v189, s45, v189
v_mfma_f32_16x16x32_bf16 v[196:199], a[88:91], a[112:115], v[196:199]
v_mul_f32 v190, s45, v190
v_mul_f32 v191, s45, v191
v_mfma_f32_16x16x32_bf16 v[196:199], a[84:87], a[224:227], v[196:199]
ds_read_b64_tr_b16 a[240:241], v19 offset:16392
ds_read_b64_tr_b16 a[242:243], v19 offset:20488
v_mfma_f32_16x16x32_bf16 v[196:199], a[80:83], a[208:211], v[196:199]
s_waitcnt lgkmcnt(2)
ds_read_b64_tr_b16 a[244:245], v19 offset:24584
ds_read_b64_tr_b16 a[246:247], v19 offset:28680
v_mfma_f32_16x16x32_bf16 v[224:227], a[96:99], a[208:211], v[224:227]
ds_read_b64_tr_b16 a[248:249], v19 offset:32776
ds_read_b64_tr_b16 a[250:251], v19 offset:36872
v_mfma_f32_16x16x32_bf16 v[224:227], a[100:103], a[224:227], v[224:227]
ds_read_b64_tr_b16 a[252:253], v19 offset:40968
ds_read_b64_tr_b16 a[254:255], v19 offset:45064
v_mfma_f32_16x16x32_bf16 v[224:227], a[104:107], a[112:115], v[224:227]
v_cvt_pk_bf16_f32 v156, v184, v185
v_cvt_pk_bf16_f32 v157, v186, v187
v_mfma_f32_16x16x32_bf16 v[224:227], a[108:111], a[128:131], v[224:227]
v_cvt_pk_bf16_f32 v158, v188, v189
v_cvt_pk_bf16_f32 v159, v190, v191
v_mfma_f32_16x16x32_bf16 v[232:235], a[108:111], a[132:135], v[232:235]
v_mul_f32 v192, s45, v192
v_mul_f32 v193, s45, v193
v_mfma_f32_16x16x32_bf16 v[232:235], a[104:107], a[116:119], v[232:235]
v_mul_f32 v194, s45, v194
v_mul_f32 v195, s45, v195
v_mfma_f32_16x16x32_bf16 v[232:235], a[100:103], a[228:231], v[232:235]
v_mul_f32 v196, s45, v196
v_mul_f32 v197, s45, v197
v_mfma_f32_16x16x32_bf16 v[232:235], a[96:99], a[212:215], v[232:235]
v_mul_f32 v198, s45, v198
v_mul_f32 v199, s45, v199
v_mfma_f32_16x16x32_bf16 v[240:243], a[96:99], a[216:219], v[240:243]
v_cvt_pk_bf16_f32 v160, v192, v193
v_cvt_pk_bf16_f32 v161, v194, v195
v_mfma_f32_16x16x32_bf16 v[240:243], a[100:103], a[232:235], v[240:243]
v_cvt_pk_bf16_f32 v162, v196, v197
v_cvt_pk_bf16_f32 v163, v198, v199
v_mfma_f32_16x16x32_bf16 v[240:243], a[104:107], a[120:123], v[240:243]
v_mul_f32 v200, s45, v200
v_mul_f32 v201, s45, v201
v_mfma_f32_16x16x32_bf16 v[240:243], a[108:111], a[136:139], v[240:243]
v_mul_f32 v202, s45, v202
v_mul_f32 v203, s45, v203
v_mfma_f32_16x16x32_bf16 v[248:251], a[108:111], a[140:143], v[248:251]
v_mul_f32 v204, s45, v204
v_mul_f32 v205, s45, v205
v_mfma_f32_16x16x32_bf16 v[248:251], a[104:107], a[124:127], v[248:251]
v_mul_f32 v206, s45, v206
v_mul_f32 v207, s45, v207
v_mfma_f32_16x16x32_bf16 v[248:251], a[100:103], a[236:239], v[248:251]
v_cvt_pk_bf16_f32 v164, v200, v201
v_cvt_pk_bf16_f32 v165, v202, v203
v_mfma_f32_16x16x32_bf16 v[248:251], a[96:99], a[220:223], v[248:251]
s_waitcnt lgkmcnt(0)
s_waitcnt vmcnt(2) lgkmcnt(0)
s_barrier
v_mfma_f32_16x16x32_bf16 v[252:255], a[240:243], a[220:223], v[252:255]
s_add_u32 m0, s24, 32768
ds_read_b64_tr_b16 a[80:81], v20 offset:8192
ds_read_b64_tr_b16 a[82:83], v20 offset:9216
v_mfma_f32_16x16x32_bf16 v[252:255], a[244:247], a[236:239], v[252:255]
buffer_load_dwordx4 v30, s[8:11], s20 offen offset:0 lds
v_mfma_f32_16x16x32_bf16 v[252:255], a[248:251], a[124:127], v[252:255]
ds_read_b64_tr_b16 a[84:85], v20 offset:10240
ds_read_b64_tr_b16 a[86:87], v20 offset:11264
v_mfma_f32_16x16x32_bf16 v[252:255], a[252:255], a[140:143], v[252:255]
ds_read_b64_tr_b16 a[88:89], v20 offset:12288
ds_read_b64_tr_b16 a[90:91], v20 offset:13312
v_mfma_f32_16x16x32_bf16 v[244:247], a[252:255], a[136:139], v[244:247]
ds_read_b64_tr_b16 a[92:93], v20 offset:14336
ds_read_b64_tr_b16 a[94:95], v20 offset:15360
v_mfma_f32_16x16x32_bf16 v[244:247], a[248:251], a[120:123], v[244:247]
buffer_load_dwordx4 v31, s[8:11], s20 offen offset:1024 lds
v_mfma_f32_16x16x32_bf16 v[244:247], a[244:247], a[232:235], v[244:247]
ds_read_b64_tr_b16 a[96:97], v20 offset:0
ds_read_b64_tr_b16 a[98:99], v20 offset:1024
v_mfma_f32_16x16x32_bf16 v[244:247], a[240:243], a[216:219], v[244:247]
ds_read_b64_tr_b16 a[100:101], v20 offset:2048
ds_read_b64_tr_b16 a[102:103], v20 offset:3072
v_mfma_f32_16x16x32_bf16 v[236:239], a[240:243], a[212:215], v[236:239]
v_cvt_pk_bf16_f32 v166, v204, v205
v_cvt_pk_bf16_f32 v167, v206, v207
v_mfma_f32_16x16x32_bf16 v[236:239], a[244:247], a[228:231], v[236:239]
v_mul_f32 v208, s45, v208
v_mul_f32 v209, s45, v209
v_mfma_f32_16x16x32_bf16 v[236:239], a[248:251], a[116:119], v[236:239]
buffer_load_dwordx4 v32, s[8:11], s20 offen offset:2048 lds
v_mfma_f32_16x16x32_bf16 v[236:239], a[252:255], a[132:135], v[236:239]
v_mul_f32 v210, s45, v210
v_mul_f32 v211, s45, v211
v_mfma_f32_16x16x32_bf16 v[228:231], a[252:255], a[128:131], v[228:231]
v_mul_f32 v212, s45, v212
v_mul_f32 v213, s45, v213
v_mfma_f32_16x16x32_bf16 v[228:231], a[248:251], a[112:115], v[228:231]
v_mul_f32 v214, s45, v214
v_mul_f32 v215, s45, v215
v_mfma_f32_16x16x32_bf16 v[228:231], a[244:247], a[224:227], v[228:231]
v_cvt_pk_bf16_f32 v168, v208, v209
v_cvt_pk_bf16_f32 v169, v210, v211
v_mfma_f32_16x16x32_bf16 v[228:231], a[240:243], a[208:211], v[228:231]
s_waitcnt lgkmcnt(0)
buffer_load_dwordx4 v33, s[8:11], s20 offen offset:3072 lds
v_mfma_f32_16x16x32_bf16 a[64:67], a[80:83], a[176:179], a[64:67]
s_add_u32 s20, s20, 16384
s_add_u32 m0, s24, 65536
v_cvt_pk_bf16_f32 v170, v212, v213
v_mfma_f32_16x16x32_bf16 a[64:67], a[84:87], a[192:195], a[64:67]
v_cvt_pk_bf16_f32 v171, v214, v215
v_mul_f32 v216, s45, v216
v_mfma_f32_16x16x32_bf16 a[64:67], a[88:91], a[208:211], a[64:67]
v_mul_f32 v217, s45, v217
v_mul_f32 v218, s45, v218
v_mfma_f32_16x16x32_bf16 a[64:67], a[92:95], a[224:227], a[64:67]
v_mul_f32 v219, s45, v219
v_mul_f32 v220, s45, v220
v_mfma_f32_16x16x32_bf16 a[64:67], a[96:99], a[112:115], a[64:67]
buffer_load_dwordx4 v34, s[12:15], s21 offen offset:0 lds
v_mfma_f32_16x16x32_bf16 a[64:67], a[100:103], a[128:131], a[64:67]
ds_read_b64_tr_b16 a[104:105], v6 offset:8192
ds_read_b64_tr_b16 a[106:107], v6 offset:9216
v_mfma_f32_16x16x32_bf16 a[68:71], a[100:103], a[132:135], a[68:71]
ds_read_b64_tr_b16 a[108:109], v6 offset:10240
ds_read_b64_tr_b16 a[110:111], v6 offset:11264
v_mfma_f32_16x16x32_bf16 a[68:71], a[96:99], a[116:119], a[68:71]
ds_read_b64_tr_b16 a[240:241], v6 offset:12288
ds_read_b64_tr_b16 a[242:243], v6 offset:13312
v_mfma_f32_16x16x32_bf16 a[68:71], a[92:95], a[228:231], a[68:71]
ds_read_b64_tr_b16 a[244:245], v6 offset:14336
ds_read_b64_tr_b16 a[246:247], v6 offset:15360
v_mfma_f32_16x16x32_bf16 a[68:71], a[88:91], a[212:215], a[68:71]
buffer_load_dwordx4 v35, s[12:15], s21 offen offset:1024 lds
v_mfma_f32_16x16x32_bf16 a[68:71], a[84:87], a[196:199], a[68:71]
ds_read_b64_tr_b16 a[248:249], v6 offset:0
ds_read_b64_tr_b16 a[250:251], v6 offset:1024
v_mfma_f32_16x16x32_bf16 a[68:71], a[80:83], a[180:183], a[68:71]
ds_read_b64_tr_b16 a[252:253], v6 offset:2048
ds_read_b64_tr_b16 a[254:255], v6 offset:3072
v_mfma_f32_16x16x32_bf16 a[72:75], a[80:83], a[184:187], a[72:75]
v_mul_f32 v221, s45, v221
v_mul_f32 v222, s45, v222
v_mfma_f32_16x16x32_bf16 a[72:75], a[84:87], a[200:203], a[72:75]
v_mul_f32 v223, s45, v223
v_cvt_pk_bf16_f32 v172, v216, v217
v_mfma_f32_16x16x32_bf16 a[72:75], a[88:91], a[216:219], a[72:75]
buffer_load_dwordx4 v34, s[12:15], s21 offen offset:2048 lds
v_mfma_f32_16x16x32_bf16 a[72:75], a[92:95], a[232:235], a[72:75]
v_cvt_pk_bf16_f32 v173, v218, v219
v_cvt_pk_bf16_f32 v174, v220, v221
v_mfma_f32_16x16x32_bf16 a[72:75], a[96:99], a[120:123], a[72:75]
v_cvt_pk_bf16_f32 v175, v222, v223
v_mul_f32 v224, s45, v224
v_mfma_f32_16x16x32_bf16 a[72:75], a[100:103], a[136:139], a[72:75]
v_mul_f32 v225, s45, v225
v_mul_f32 v226, s45, v226
v_mfma_f32_16x16x32_bf16 a[76:79], a[100:103], a[140:143], a[76:79]
v_mul_f32 v227, s45, v227
v_mul_f32 v228, s45, v228
v_mfma_f32_16x16x32_bf16 a[76:79], a[96:99], a[124:127], a[76:79]
buffer_load_dwordx4 v35, s[12:15], s21 offen offset:3072 lds
v_mfma_f32_16x16x32_bf16 a[76:79], a[92:95], a[236:239], a[76:79]
s_add_u32 s21, s21, 16384
s_add_u32 m0, s24, 49152
v_mul_f32 v229, s45, v229
v_mfma_f32_16x16x32_bf16 a[76:79], a[88:91], a[220:223], a[76:79]
v_mul_f32 v230, s45, v230
v_mul_f32 v231, s45, v231
v_mfma_f32_16x16x32_bf16 a[76:79], a[84:87], a[204:207], a[76:79]
v_cvt_pk_bf16_f32 v176, v224, v225
v_cvt_pk_bf16_f32 v177, v226, v227
v_mfma_f32_16x16x32_bf16 a[76:79], a[80:83], a[188:191], a[76:79]
s_waitcnt lgkmcnt(0)
v_cvt_pk_bf16_f32 v178, v228, v229
v_cvt_pk_bf16_f32 v179, v230, v231
v_mfma_f32_16x16x32_bf16 v[60:63], a[104:107], a[188:191], v[60:63]
buffer_load_dwordx4 v30, s[8:11], s20 offen offset:0 lds
v_mfma_f32_16x16x32_bf16 v[60:63], a[108:111], a[204:207], v[60:63]
v_mul_f32 v232, s45, v232
v_mul_f32 v233, s45, v233
v_mfma_f32_16x16x32_bf16 v[60:63], a[240:243], a[220:223], v[60:63]
v_mul_f32 v234, s45, v234
v_mul_f32 v235, s45, v235
v_mfma_f32_16x16x32_bf16 v[60:63], a[244:247], a[236:239], v[60:63]
v_mul_f32 v236, s45, v236
v_mul_f32 v237, s45, v237
v_mfma_f32_16x16x32_bf16 v[60:63], a[248:251], a[124:127], v[60:63]
ds_read_b64_tr_b16 a[80:81], v8 offset:0
ds_read_b64_tr_b16 a[82:83], v8 offset:4096
v_mfma_f32_16x16x32_bf16 v[60:63], a[252:255], a[140:143], v[60:63]
buffer_load_dwordx4 v31, s[8:11], s20 offen offset:1024 lds
v_mfma_f32_16x16x32_bf16 v[56:59], a[252:255], a[136:139], v[56:59]
ds_read_b64_tr_b16 a[84:85], v8 offset:8192
ds_read_b64_tr_b16 a[86:87], v8 offset:12288
v_mfma_f32_16x16x32_bf16 v[56:59], a[248:251], a[120:123], v[56:59]
ds_read_b64_tr_b16 a[88:89], v8 offset:16384
ds_read_b64_tr_b16 a[90:91], v8 offset:20480
v_mfma_f32_16x16x32_bf16 v[56:59], a[244:247], a[232:235], v[56:59]
ds_read_b64_tr_b16 a[92:93], v8 offset:24576
ds_read_b64_tr_b16 a[94:95], v8 offset:28672
v_mfma_f32_16x16x32_bf16 v[56:59], a[240:243], a[216:219], v[56:59]
ds_read_b64_tr_b16 a[96:97], v8 offset:32768
ds_read_b64_tr_b16 a[98:99], v8 offset:36864
v_mfma_f32_16x16x32_bf16 v[56:59], a[108:111], a[200:203], v[56:59]
buffer_load_dwordx4 v32, s[8:11], s20 offen offset:2048 lds
v_mfma_f32_16x16x32_bf16 v[56:59], a[104:107], a[184:187], v[56:59]
ds_read_b64_tr_b16 a[100:101], v8 offset:40960
ds_read_b64_tr_b16 a[102:103], v8 offset:45056
v_mfma_f32_16x16x32_bf16 v[52:55], a[104:107], a[180:183], v[52:55]
v_mul_f32 v238, s45, v238
v_mul_f32 v239, s45, v239
v_mfma_f32_16x16x32_bf16 v[52:55], a[108:111], a[196:199], v[52:55]
v_cvt_pk_bf16_f32 v180, v232, v233
v_cvt_pk_bf16_f32 v181, v234, v235
v_mfma_f32_16x16x32_bf16 v[52:55], a[240:243], a[212:215], v[52:55]
v_cvt_pk_bf16_f32 v182, v236, v237
v_cvt_pk_bf16_f32 v183, v238, v239
v_mfma_f32_16x16x32_bf16 v[52:55], a[244:247], a[228:231], v[52:55]
buffer_load_dwordx4 v33, s[8:11], s20 offen offset:3072 lds
v_mfma_f32_16x16x32_bf16 v[52:55], a[248:251], a[116:119], v[52:55]
s_add_u32 s20, s20, 16384
v_mul_f32 v240, s45, v240
v_mul_f32 v241, s45, v241
v_mfma_f32_16x16x32_bf16 v[52:55], a[252:255], a[132:135], v[52:55]
v_mul_f32 v242, s45, v242
v_mul_f32 v243, s45, v243
v_mfma_f32_16x16x32_bf16 v[48:51], a[252:255], a[128:131], v[48:51]
ds_read_b128 a[144:147], v36 offset:0
v_mul_f32 v244, s45, v244
v_mfma_f32_16x16x32_bf16 v[48:51], a[248:251], a[112:115], v[48:51]
ds_read_b128 a[148:151], v37 offset:0
v_mul_f32 v245, s45, v245
v_mfma_f32_16x16x32_bf16 v[48:51], a[244:247], a[224:227], v[48:51]
ds_read_b128 a[152:155], v38 offset:0
v_mul_f32 v246, s45, v246
v_mfma_f32_16x16x32_bf16 v[48:51], a[240:243], a[208:211], v[48:51]
ds_read_b128 a[156:159], v39 offset:0
v_mul_f32 v247, s45, v247
v_mfma_f32_16x16x32_bf16 v[48:51], a[108:111], a[192:195], v[48:51]
ds_read_b128 a[160:163], v36 offset:4096
v_cvt_pk_bf16_f32 v184, v240, v241
v_mfma_f32_16x16x32_bf16 v[48:51], a[104:107], a[176:179], v[48:51]
s_waitcnt lgkmcnt(5)
ds_read_b128 a[164:167], v37 offset:4096
v_cvt_pk_bf16_f32 v185, v242, v243
v_mfma_f32_16x16x32_bf16 v[64:67], a[80:83], a[176:179], v[64:67]
ds_read_b128 a[168:171], v38 offset:4096
v_cvt_pk_bf16_f32 v186, v244, v245
v_mfma_f32_16x16x32_bf16 v[64:67], a[84:87], a[192:195], v[64:67]
ds_read_b128 a[172:175], v39 offset:4096
v_cvt_pk_bf16_f32 v187, v246, v247
v_mfma_f32_16x16x32_bf16 v[64:67], a[88:91], a[208:211], v[64:67]
v_mul_f32 v248, s45, v248
v_mul_f32 v249, s45, v249
v_mfma_f32_16x16x32_bf16 v[64:67], a[92:95], a[224:227], v[64:67]
v_mul_f32 v250, s45, v250
v_mul_f32 v251, s45, v251
v_mfma_f32_16x16x32_bf16 v[64:67], a[96:99], a[112:115], v[64:67]
v_mul_f32 v252, s45, v252
v_mul_f32 v253, s45, v253
v_mfma_f32_16x16x32_bf16 v[64:67], a[100:103], a[128:131], v[64:67]
v_mul_f32 v254, s45, v254
v_mul_f32 v255, s45, v255
v_mfma_f32_16x16x32_bf16 v[72:75], a[100:103], a[132:135], v[72:75]
v_cvt_pk_bf16_f32 v188, v248, v249
v_cvt_pk_bf16_f32 v189, v250, v251
v_mfma_f32_16x16x32_bf16 v[72:75], a[96:99], a[116:119], v[72:75]
v_cvt_pk_bf16_f32 v190, v252, v253
v_cvt_pk_bf16_f32 v191, v254, v255
v_mfma_f32_16x16x32_bf16 v[72:75], a[92:95], a[228:231], v[72:75]
v_accvgpr_read_b32 v21, a64
v_accvgpr_read_b32 v22, a65
v_mfma_f32_16x16x32_bf16 v[72:75], a[88:91], a[212:215], v[72:75]
v_accvgpr_read_b32 v23, a66
v_accvgpr_read_b32 v24, a67
v_mfma_f32_16x16x32_bf16 v[72:75], a[84:87], a[196:199], v[72:75]
v_cvt_pk_bf16_f32 v51, v50, v51
v_cvt_pk_bf16_f32 v50, v48, v49
v_mfma_f32_16x16x32_bf16 v[72:75], a[80:83], a[180:183], v[72:75]
v_cvt_pk_bf16_f32 v48, v21, v22
v_cvt_pk_bf16_f32 v49, v23, v24
v_mfma_f32_16x16x32_bf16 v[80:83], a[80:83], a[184:187], v[80:83]
v_pk_max_i16 v48, v48, 0
v_pk_max_i16 v49, v49, 0
v_mfma_f32_16x16x32_bf16 v[80:83], a[84:87], a[200:203], v[80:83]
v_pk_max_i16 v50, v50, 0
v_pk_max_i16 v51, v51, 0
v_mfma_f32_16x16x32_bf16 v[80:83], a[88:91], a[216:219], v[80:83]
buffer_store_dwordx4 v[48:51], v7, s[16:19], s43 offen offset:0 sc1
v_mfma_f32_16x16x32_bf16 v[80:83], a[92:95], a[232:235], v[80:83]
v_accvgpr_read_b32 v21, a68
v_accvgpr_read_b32 v22, a69
v_mfma_f32_16x16x32_bf16 v[80:83], a[96:99], a[120:123], v[80:83]
v_accvgpr_read_b32 v23, a70
v_accvgpr_read_b32 v24, a71
v_mfma_f32_16x16x32_bf16 v[80:83], a[100:103], a[136:139], v[80:83]
v_cvt_pk_bf16_f32 v55, v54, v55
v_cvt_pk_bf16_f32 v54, v52, v53
v_mfma_f32_16x16x32_bf16 v[88:91], a[100:103], a[140:143], v[88:91]
v_cvt_pk_bf16_f32 v52, v21, v22
v_cvt_pk_bf16_f32 v53, v23, v24
v_mfma_f32_16x16x32_bf16 v[88:91], a[96:99], a[124:127], v[88:91]
v_pk_max_i16 v52, v52, 0
v_pk_max_i16 v53, v53, 0
v_mfma_f32_16x16x32_bf16 v[88:91], a[92:95], a[236:239], v[88:91]
v_pk_max_i16 v54, v54, 0
v_pk_max_i16 v55, v55, 0
v_mfma_f32_16x16x32_bf16 v[88:91], a[88:91], a[220:223], v[88:91]
buffer_store_dwordx4 v[52:55], v7, s[16:19], s43 offen offset:1024 sc1
v_mfma_f32_16x16x32_bf16 v[88:91], a[84:87], a[204:207], v[88:91]
v_accvgpr_read_b32 v21, a72
v_accvgpr_read_b32 v22, a73
v_mfma_f32_16x16x32_bf16 v[88:91], a[80:83], a[188:191], v[88:91]
s_waitcnt lgkmcnt(0)
v_accvgpr_read_b32 v23, a74
v_accvgpr_read_b32 v24, a75
v_mfma_f32_16x16x32_bf16 v[192:195], a[144:147], v[128:131], 0
v_cvt_pk_bf16_f32 v59, v58, v59
v_cvt_pk_bf16_f32 v58, v56, v57
v_mfma_f32_16x16x32_bf16 v[192:195], a[148:151], v[144:147], v[192:195]
v_cvt_pk_bf16_f32 v56, v21, v22
v_cvt_pk_bf16_f32 v57, v23, v24
v_mfma_f32_16x16x32_bf16 v[192:195], a[152:155], v[160:163], v[192:195]
v_pk_max_i16 v56, v56, 0
v_pk_max_i16 v57, v57, 0
v_mfma_f32_16x16x32_bf16 v[192:195], a[156:159], v[176:179], v[192:195]
v_pk_max_i16 v58, v58, 0
v_pk_max_i16 v59, v59, 0
v_mfma_f32_16x16x32_bf16 v[200:203], a[156:159], v[180:183], 0
buffer_store_dwordx4 v[56:59], v7, s[16:19], s43 offen offset:2048 sc1
v_mfma_f32_16x16x32_bf16 v[200:203], a[152:155], v[164:167], v[200:203]
v_accvgpr_read_b32 v21, a76
v_accvgpr_read_b32 v22, a77
v_mfma_f32_16x16x32_bf16 v[200:203], a[148:151], v[148:151], v[200:203]
v_accvgpr_read_b32 v23, a78
v_accvgpr_read_b32 v24, a79
v_mfma_f32_16x16x32_bf16 v[200:203], a[144:147], v[132:135], v[200:203]
v_cvt_pk_bf16_f32 v63, v62, v63
v_cvt_pk_bf16_f32 v62, v60, v61
v_mfma_f32_16x16x32_bf16 v[208:211], a[144:147], v[136:139], 0
v_cvt_pk_bf16_f32 v60, v21, v22
v_cvt_pk_bf16_f32 v61, v23, v24
v_mfma_f32_16x16x32_bf16 v[208:211], a[148:151], v[152:155], v[208:211]
v_pk_max_i16 v60, v60, 0
v_pk_max_i16 v61, v61, 0
v_mfma_f32_16x16x32_bf16 v[208:211], a[152:155], v[168:171], v[208:211]
v_pk_max_i16 v62, v62, 0
v_pk_max_i16 v63, v63, 0
v_mfma_f32_16x16x32_bf16 v[208:211], a[156:159], v[184:187], v[208:211]
buffer_store_dwordx4 v[60:63], v7, s[16:19], s43 offen offset:3072 sc1
v_mfma_f32_16x16x32_bf16 v[216:219], a[156:159], v[188:191], 0
ds_read_b64_tr_b16 a[104:105], v9 offset:0
ds_read_b64_tr_b16 a[106:107], v9 offset:4096
v_mfma_f32_16x16x32_bf16 v[216:219], a[152:155], v[172:175], v[216:219]
ds_read_b64_tr_b16 a[108:109], v9 offset:8192
ds_read_b64_tr_b16 a[110:111], v9 offset:12288
v_mfma_f32_16x16x32_bf16 v[216:219], a[148:151], v[156:159], v[216:219]
ds_read_b64_tr_b16 a[240:241], v9 offset:16384
ds_read_b64_tr_b16 a[242:243], v9 offset:20480
v_mfma_f32_16x16x32_bf16 v[216:219], a[144:147], v[140:143], v[216:219]
ds_read_b64_tr_b16 a[244:245], v9 offset:24576
ds_read_b64_tr_b16 a[246:247], v9 offset:28672
v_mfma_f32_16x16x32_bf16 v[220:223], a[160:163], v[140:143], 0
ds_read_b64_tr_b16 a[248:249], v9 offset:32768
ds_read_b64_tr_b16 a[250:251], v9 offset:36864
v_mfma_f32_16x16x32_bf16 v[220:223], a[164:167], v[156:159], v[220:223]
ds_read_b64_tr_b16 a[252:253], v9 offset:40960
ds_read_b64_tr_b16 a[254:255], v9 offset:45056
v_mfma_f32_16x16x32_bf16 v[220:223], a[168:171], v[172:175], v[220:223]
v_mfma_f32_16x16x32_bf16 v[220:223], a[172:175], v[188:191], v[220:223]
v_mfma_f32_16x16x32_bf16 v[212:215], a[172:175], v[184:187], 0
v_mfma_f32_16x16x32_bf16 v[212:215], a[168:171], v[168:171], v[212:215]
v_mfma_f32_16x16x32_bf16 v[212:215], a[164:167], v[152:155], v[212:215]
v_mfma_f32_16x16x32_bf16 v[212:215], a[160:163], v[136:139], v[212:215]
v_mfma_f32_16x16x32_bf16 v[204:207], a[160:163], v[132:135], 0
v_mfma_f32_16x16x32_bf16 v[204:207], a[164:167], v[148:151], v[204:207]
v_mfma_f32_16x16x32_bf16 v[204:207], a[168:171], v[164:167], v[204:207]
v_mfma_f32_16x16x32_bf16 v[204:207], a[172:175], v[180:183], v[204:207]
v_mfma_f32_16x16x32_bf16 v[196:199], a[172:175], v[176:179], 0
v_mfma_f32_16x16x32_bf16 v[196:199], a[168:171], v[160:163], v[196:199]
v_mfma_f32_16x16x32_bf16 v[196:199], a[164:167], v[144:147], v[196:199]
v_mfma_f32_16x16x32_bf16 v[196:199], a[160:163], v[128:131], v[196:199]
s_waitcnt lgkmcnt(0)
v_mfma_f32_16x16x32_bf16 v[92:95], a[104:107], a[188:191], v[92:95]
ds_read_b128 a[144:147], v36 offset:8192
v_mfma_f32_16x16x32_bf16 v[92:95], a[108:111], a[204:207], v[92:95]
ds_read_b128 a[148:151], v37 offset:8192
v_mfma_f32_16x16x32_bf16 v[92:95], a[240:243], a[220:223], v[92:95]
ds_read_b128 a[152:155], v38 offset:8192
v_mfma_f32_16x16x32_bf16 v[92:95], a[244:247], a[236:239], v[92:95]
ds_read_b128 a[156:159], v39 offset:8192
v_mfma_f32_16x16x32_bf16 v[92:95], a[248:251], a[124:127], v[92:95]
ds_read_b64_tr_b16 a[80:81], v10 offset:0
ds_read_b64_tr_b16 a[82:83], v10 offset:4096
v_mfma_f32_16x16x32_bf16 v[92:95], a[252:255], a[140:143], v[92:95]
ds_read_b64_tr_b16 a[84:85], v10 offset:8192
ds_read_b64_tr_b16 a[86:87], v10 offset:12288
v_mfma_f32_16x16x32_bf16 v[84:87], a[252:255], a[136:139], v[84:87]
ds_read_b64_tr_b16 a[88:89], v10 offset:16384
ds_read_b64_tr_b16 a[90:91], v10 offset:20480
v_mfma_f32_16x16x32_bf16 v[84:87], a[248:251], a[120:123], v[84:87]
ds_read_b64_tr_b16 a[92:93], v10 offset:24576
ds_read_b64_tr_b16 a[94:95], v10 offset:28672
v_mfma_f32_16x16x32_bf16 v[84:87], a[244:247], a[232:235], v[84:87]
ds_read_b64_tr_b16 a[96:97], v10 offset:32768
ds_read_b64_tr_b16 a[98:99], v10 offset:36864
v_mfma_f32_16x16x32_bf16 v[84:87], a[240:243], a[216:219], v[84:87]
ds_read_b64_tr_b16 a[100:101], v10 offset:40960
ds_read_b64_tr_b16 a[102:103], v10 offset:45056
v_mfma_f32_16x16x32_bf16 v[84:87], a[108:111], a[200:203], v[84:87]
ds_read_b128 a[160:163], v36 offset:12288
ds_read_b128 a[164:167], v37 offset:12288
v_mfma_f32_16x16x32_bf16 v[84:87], a[104:107], a[184:187], v[84:87]
ds_read_b128 a[168:171], v38 offset:12288
ds_read_b128 a[172:175], v39 offset:12288
v_mfma_f32_16x16x32_bf16 v[76:79], a[104:107], a[180:183], v[76:79]
v_max3_f32 v21, v192, v193, v194
v_max3_f32 v22, v200, v201, v202
v_mfma_f32_16x16x32_bf16 v[76:79], a[108:111], a[196:199], v[76:79]
v_max3_f32 v23, v208, v209, v210
v_max3_f32 v24, v216, v217, v218
v_mfma_f32_16x16x32_bf16 v[76:79], a[240:243], a[212:215], v[76:79]
v_max3_f32 v21, v21, v195, v196
v_max3_f32 v22, v22, v203, v204
v_mfma_f32_16x16x32_bf16 v[76:79], a[244:247], a[228:231], v[76:79]
v_max3_f32 v23, v23, v211, v212
v_max3_f32 v24, v24, v219, v220
v_mfma_f32_16x16x32_bf16 v[76:79], a[248:251], a[116:119], v[76:79]
v_max3_f32 v21, v21, v197, v198
v_max3_f32 v22, v22, v205, v206
v_mfma_f32_16x16x32_bf16 v[76:79], a[252:255], a[132:135], v[76:79]
v_max3_f32 v23, v23, v213, v214
v_max3_f32 v24, v24, v221, v222
v_mfma_f32_16x16x32_bf16 v[68:71], a[252:255], a[128:131], v[68:71]
v_max_f32 v21, v21, v199
v_max_f32 v22, v22, v207
v_mfma_f32_16x16x32_bf16 v[68:71], a[248:251], a[112:115], v[68:71]
v_max_f32 v23, v23, v215
v_max_f32 v24, v24, v223
v_mfma_f32_16x16x32_bf16 v[68:71], a[244:247], a[224:227], v[68:71]
v_mov_b32 v25, v21
v_mov_b32 v26, v22
v_mfma_f32_16x16x32_bf16 v[68:71], a[240:243], a[208:211], v[68:71]
v_mov_b32 v27, v23
v_mov_b32 v28, v24
v_mfma_f32_16x16x32_bf16 v[68:71], a[108:111], a[192:195], v[68:71]
v_permlane32_swap_b32 v21, v25
v_permlane32_swap_b32 v22, v26
v_mfma_f32_16x16x32_bf16 v[68:71], a[104:107], a[176:179], v[68:71]
s_waitcnt lgkmcnt(4)
v_permlane32_swap_b32 v23, v27
v_permlane32_swap_b32 v24, v28
v_mfma_f32_16x16x32_bf16 a[0:3], a[80:83], a[176:179], a[0:3]
v_max_f32 v21, v21, v25
v_max_f32 v22, v22, v26
v_mfma_f32_16x16x32_bf16 a[0:3], a[84:87], a[192:195], a[0:3]
v_max_f32 v23, v23, v27
v_max_f32 v24, v24, v28
v_mfma_f32_16x16x32_bf16 a[0:3], a[88:91], a[208:211], a[0:3]
v_mov_b32 v25, v21
v_mov_b32 v26, v22
v_mfma_f32_16x16x32_bf16 a[0:3], a[92:95], a[224:227], a[0:3]
v_mov_b32 v27, v23
v_mov_b32 v28, v24
v_mfma_f32_16x16x32_bf16 a[0:3], a[96:99], a[112:115], a[0:3]
s_add_u32 s44, s42, 0
ds_read_b64_tr_b16 a[104:105], v11 offset:0
ds_read_b64_tr_b16 a[106:107], v11 offset:4096
v_mfma_f32_16x16x32_bf16 a[0:3], a[100:103], a[128:131], a[0:3]
ds_read_b64_tr_b16 a[108:109], v11 offset:8192
ds_read_b64_tr_b16 a[110:111], v11 offset:12288
v_mfma_f32_16x16x32_bf16 a[8:11], a[100:103], a[132:135], a[8:11]
ds_read_b64_tr_b16 a[240:241], v11 offset:16384
ds_read_b64_tr_b16 a[242:243], v11 offset:20480
v_mfma_f32_16x16x32_bf16 a[8:11], a[96:99], a[116:119], a[8:11]
ds_read_b64_tr_b16 a[244:245], v11 offset:24576
ds_read_b64_tr_b16 a[246:247], v11 offset:28672
v_mfma_f32_16x16x32_bf16 a[8:11], a[92:95], a[228:231], a[8:11]
ds_read_b64_tr_b16 a[248:249], v11 offset:32768
ds_read_b64_tr_b16 a[250:251], v11 offset:36864
v_mfma_f32_16x16x32_bf16 a[8:11], a[88:91], a[212:215], a[8:11]
ds_read_b64_tr_b16 a[252:253], v11 offset:40960
ds_read_b64_tr_b16 a[254:255], v11 offset:45056
v_mfma_f32_16x16x32_bf16 a[8:11], a[84:87], a[196:199], a[8:11]
v_permlane16_swap_b32 v21, v25
v_permlane16_swap_b32 v22, v26
v_mfma_f32_16x16x32_bf16 a[8:11], a[80:83], a[180:183], a[8:11]
v_permlane16_swap_b32 v23, v27
v_permlane16_swap_b32 v24, v28
v_mfma_f32_16x16x32_bf16 a[16:19], a[80:83], a[184:187], a[16:19]
v_max_f32 v21, v21, v25
v_max_f32 v22, v22, v26
v_mfma_f32_16x16x32_bf16 a[16:19], a[84:87], a[200:203], a[16:19]
v_max_f32 v23, v23, v27
v_max_f32 v24, v24, v28
v_mfma_f32_16x16x32_bf16 a[16:19], a[88:91], a[216:219], a[16:19]
v_sub_f32 v48, 0x41c00000, v21
v_sub_f32 v49, 0x41c00000, v21
v_mfma_f32_16x16x32_bf16 a[16:19], a[92:95], a[232:235], a[16:19]
v_sub_f32 v50, 0x41c00000, v21
v_sub_f32 v51, 0x41c00000, v21
v_mfma_f32_16x16x32_bf16 a[16:19], a[96:99], a[120:123], a[16:19]
v_sub_f32 v52, 0x41c00000, v22
v_sub_f32 v53, 0x41c00000, v22
v_mfma_f32_16x16x32_bf16 a[16:19], a[100:103], a[136:139], a[16:19]
v_sub_f32 v54, 0x41c00000, v22
v_sub_f32 v55, 0x41c00000, v22
v_mfma_f32_16x16x32_bf16 a[24:27], a[100:103], a[140:143], a[24:27]
v_sub_f32 v56, 0x41c00000, v23
v_sub_f32 v57, 0x41c00000, v23
v_mfma_f32_16x16x32_bf16 a[24:27], a[96:99], a[124:127], a[24:27]
v_sub_f32 v58, 0x41c00000, v23
v_sub_f32 v59, 0x41c00000, v23
v_mfma_f32_16x16x32_bf16 a[24:27], a[92:95], a[236:239], a[24:27]
v_sub_f32 v60, 0x41c00000, v24
v_sub_f32 v61, 0x41c00000, v24
v_mfma_f32_16x16x32_bf16 a[24:27], a[88:91], a[220:223], a[24:27]
v_sub_f32 v62, 0x41c00000, v24
v_sub_f32 v63, 0x41c00000, v24
v_mfma_f32_16x16x32_bf16 a[24:27], a[84:87], a[204:207], a[24:27]
v_add_f32 v192, v192, v48
v_add_f32 v193, v193, v48
v_mfma_f32_16x16x32_bf16 a[24:27], a[80:83], a[188:191], a[24:27]
s_waitcnt lgkmcnt(0)
v_add_f32 v194, v194, v48
v_add_f32 v195, v195, v48
v_mfma_f32_16x16x32_bf16 a[28:31], a[104:107], a[188:191], a[28:31]
v_add_f32 v196, v196, v48
v_add_f32 v197, v197, v48
v_mfma_f32_16x16x32_bf16 a[28:31], a[108:111], a[204:207], a[28:31]
v_add_f32 v198, v198, v48
v_add_f32 v199, v199, v48
v_mfma_f32_16x16x32_bf16 a[28:31], a[240:243], a[220:223], a[28:31]
v_add_f32 v200, v200, v52
v_add_f32 v201, v201, v52
v_mfma_f32_16x16x32_bf16 a[28:31], a[244:247], a[236:239], a[28:31]
v_add_f32 v202, v202, v52
v_add_f32 v203, v203, v52
v_mfma_f32_16x16x32_bf16 a[28:31], a[248:251], a[124:127], a[28:31]
ds_read_b64_tr_b16 a[80:81], v12 offset:0
ds_read_b64_tr_b16 a[82:83], v12 offset:4096
v_mfma_f32_16x16x32_bf16 a[28:31], a[252:255], a[140:143], a[28:31]
ds_read_b64_tr_b16 a[84:85], v12 offset:8192
ds_read_b64_tr_b16 a[86:87], v12 offset:12288
v_mfma_f32_16x16x32_bf16 a[20:23], a[252:255], a[136:139], a[20:23]
ds_read_b64_tr_b16 a[88:89], v12 offset:16384
ds_read_b64_tr_b16 a[90:91], v12 offset:20480
v_mfma_f32_16x16x32_bf16 a[20:23], a[248:251], a[120:123], a[20:23]
ds_read_b64_tr_b16 a[92:93], v12 offset:24576
ds_read_b64_tr_b16 a[94:95], v12 offset:28672
v_mfma_f32_16x16x32_bf16 a[20:23], a[244:247], a[232:235], a[20:23]
ds_read_b64_tr_b16 a[96:97], v12 offset:32768
ds_read_b64_tr_b16 a[98:99], v12 offset:36864
v_mfma_f32_16x16x32_bf16 a[20:23], a[240:243], a[216:219], a[20:23]
ds_read_b64_tr_b16 a[100:101], v12 offset:40960
ds_read_b64_tr_b16 a[102:103], v12 offset:45056
v_mfma_f32_16x16x32_bf16 a[20:23], a[108:111], a[200:203], a[20:23]
v_add_f32 v204, v204, v52
v_add_f32 v205, v205, v52
v_mfma_f32_16x16x32_bf16 a[20:23], a[104:107], a[184:187], a[20:23]
v_add_f32 v206, v206, v52
v_add_f32 v207, v207, v52
v_mfma_f32_16x16x32_bf16 a[12:15], a[104:107], a[180:183], a[12:15]
v_add_f32 v208, v208, v56
v_add_f32 v209, v209, v56
v_mfma_f32_16x16x32_bf16 a[12:15], a[108:111], a[196:199], a[12:15]
v_add_f32 v210, v210, v56
v_add_f32 v211, v211, v56
v_mfma_f32_16x16x32_bf16 a[12:15], a[240:243], a[212:215], a[12:15]
v_add_f32 v212, v212, v56
v_add_f32 v213, v213, v56
v_mfma_f32_16x16x32_bf16 a[12:15], a[244:247], a[228:231], a[12:15]
v_add_f32 v214, v214, v56
v_add_f32 v215, v215, v56
v_mfma_f32_16x16x32_bf16 a[12:15], a[248:251], a[116:119], a[12:15]
v_add_f32 v216, v216, v60
v_add_f32 v217, v217, v60
v_mfma_f32_16x16x32_bf16 a[12:15], a[252:255], a[132:135], a[12:15]
v_add_f32 v218, v218, v60
v_add_f32 v219, v219, v60
v_mfma_f32_16x16x32_bf16 a[4:7], a[252:255], a[128:131], a[4:7]
v_add_f32 v220, v220, v60
v_add_f32 v221, v221, v60
v_mfma_f32_16x16x32_bf16 a[4:7], a[248:251], a[112:115], a[4:7]
v_add_f32 v222, v222, v60
v_add_f32 v223, v223, v60
v_mfma_f32_16x16x32_bf16 a[4:7], a[244:247], a[224:227], a[4:7]
v_cvt_pk_bf16_f32 v64, v64, v65
v_cvt_pk_bf16_f32 v65, v66, v67
v_mfma_f32_16x16x32_bf16 a[4:7], a[240:243], a[208:211], a[4:7]
v_cvt_pk_bf16_f32 v66, v68, v69
v_cvt_pk_bf16_f32 v67, v70, v71
v_mfma_f32_16x16x32_bf16 a[4:7], a[108:111], a[192:195], a[4:7]
v_pk_max_i16 v64, v64, 0
v_pk_max_i16 v65, v65, 0
v_mfma_f32_16x16x32_bf16 a[4:7], a[104:107], a[176:179], a[4:7]
s_waitcnt lgkmcnt(0)
v_pk_max_i16 v66, v66, 0
v_pk_max_i16 v67, v67, 0
v_mfma_f32_16x16x32_bf16 a[32:35], a[80:83], a[176:179], a[32:35]
buffer_store_dwordx4 v[64:67], v7, s[16:19], s44 offen offset:0 sc1
v_mfma_f32_16x16x32_bf16 a[32:35], a[84:87], a[192:195], a[32:35]
v_cvt_pk_bf16_f32 v72, v72, v73
v_cvt_pk_bf16_f32 v73, v74, v75
v_mfma_f32_16x16x32_bf16 a[32:35], a[88:91], a[208:211], a[32:35]
v_cvt_pk_bf16_f32 v74, v76, v77
v_cvt_pk_bf16_f32 v75, v78, v79
v_mfma_f32_16x16x32_bf16 a[32:35], a[92:95], a[224:227], a[32:35]
v_pk_max_i16 v72, v72, 0
v_pk_max_i16 v73, v73, 0
v_mfma_f32_16x16x32_bf16 a[32:35], a[96:99], a[112:115], a[32:35]
ds_read_b64_tr_b16 a[104:105], v13 offset:0
ds_read_b64_tr_b16 a[106:107], v13 offset:4096
v_mfma_f32_16x16x32_bf16 a[32:35], a[100:103], a[128:131], a[32:35]
ds_read_b64_tr_b16 a[108:109], v13 offset:8192
ds_read_b64_tr_b16 a[110:111], v13 offset:12288
v_mfma_f32_16x16x32_bf16 a[40:43], a[100:103], a[132:135], a[40:43]
ds_read_b64_tr_b16 a[240:241], v13 offset:16384
ds_read_b64_tr_b16 a[242:243], v13 offset:20480
v_mfma_f32_16x16x32_bf16 a[40:43], a[96:99], a[116:119], a[40:43]
ds_read_b64_tr_b16 a[244:245], v13 offset:24576
ds_read_b64_tr_b16 a[246:247], v13 offset:28672
v_mfma_f32_16x16x32_bf16 a[40:43], a[92:95], a[228:231], a[40:43]
ds_read_b64_tr_b16 a[248:249], v13 offset:32768
ds_read_b64_tr_b16 a[250:251], v13 offset:36864
v_mfma_f32_16x16x32_bf16 a[40:43], a[88:91], a[212:215], a[40:43]
ds_read_b64_tr_b16 a[252:253], v13 offset:40960
ds_read_b64_tr_b16 a[254:255], v13 offset:45056
v_mfma_f32_16x16x32_bf16 a[40:43], a[84:87], a[196:199], a[40:43]
v_pk_max_i16 v74, v74, 0
v_pk_max_i16 v75, v75, 0
v_mfma_f32_16x16x32_bf16 a[40:43], a[80:83], a[180:183], a[40:43]
buffer_store_dwordx4 v[72:75], v7, s[16:19], s44 offen offset:1024 sc1
v_mfma_f32_16x16x32_bf16 a[48:51], a[80:83], a[184:187], a[48:51]
v_cvt_pk_bf16_f32 v80, v80, v81
v_cvt_pk_bf16_f32 v81, v82, v83
v_mfma_f32_16x16x32_bf16 a[48:51], a[84:87], a[200:203], a[48:51]
v_cvt_pk_bf16_f32 v82, v84, v85
v_cvt_pk_bf16_f32 v83, v86, v87
v_mfma_f32_16x16x32_bf16 a[48:51], a[88:91], a[216:219], a[48:51]
v_pk_max_i16 v80, v80, 0
v_pk_max_i16 v81, v81, 0
v_mfma_f32_16x16x32_bf16 a[48:51], a[92:95], a[232:235], a[48:51]
v_pk_max_i16 v82, v82, 0
v_pk_max_i16 v83, v83, 0
v_mfma_f32_16x16x32_bf16 a[48:51], a[96:99], a[120:123], a[48:51]
buffer_store_dwordx4 v[80:83], v7, s[16:19], s44 offen offset:2048 sc1
v_mfma_f32_16x16x32_bf16 a[48:51], a[100:103], a[136:139], a[48:51]
v_cvt_pk_bf16_f32 v88, v88, v89
v_cvt_pk_bf16_f32 v89, v90, v91
v_mfma_f32_16x16x32_bf16 a[56:59], a[100:103], a[140:143], a[56:59]
v_cvt_pk_bf16_f32 v90, v92, v93
v_cvt_pk_bf16_f32 v91, v94, v95
v_mfma_f32_16x16x32_bf16 a[56:59], a[96:99], a[124:127], a[56:59]
v_pk_max_i16 v88, v88, 0
v_pk_max_i16 v89, v89, 0
v_mfma_f32_16x16x32_bf16 a[56:59], a[92:95], a[236:239], a[56:59]
v_pk_max_i16 v90, v90, 0
v_pk_max_i16 v91, v91, 0
v_mfma_f32_16x16x32_bf16 a[56:59], a[88:91], a[220:223], a[56:59]
v_mfma_f32_16x16x32_bf16 a[56:59], a[84:87], a[204:207], a[56:59]
buffer_store_dwordx4 v[88:91], v7, s[16:19], s44 offen offset:3072 sc1
v_mfma_f32_16x16x32_bf16 a[56:59], a[80:83], a[188:191], a[56:59]
s_waitcnt lgkmcnt(0)
s_add_u32 s44, s42, 16384
v_accvgpr_read_b32 v224, a0
v_mfma_f32_16x16x32_bf16 a[60:63], a[104:107], a[188:191], a[60:63]
v_accvgpr_read_b32 v225, a1
v_accvgpr_read_b32 v226, a2
v_mfma_f32_16x16x32_bf16 a[60:63], a[108:111], a[204:207], a[60:63]
v_accvgpr_read_b32 v227, a3
v_accvgpr_read_b32 v228, a4
v_mfma_f32_16x16x32_bf16 a[60:63], a[240:243], a[220:223], a[60:63]
v_accvgpr_read_b32 v229, a5
v_accvgpr_read_b32 v230, a6
v_mfma_f32_16x16x32_bf16 a[60:63], a[244:247], a[236:239], a[60:63]
v_accvgpr_read_b32 v231, a7
v_cvt_pk_bf16_f32 v224, v224, v225
v_mfma_f32_16x16x32_bf16 a[60:63], a[248:251], a[124:127], a[60:63]
ds_read_b64_tr_b16 a[80:81], v14 offset:0
ds_read_b64_tr_b16 a[82:83], v14 offset:4096
v_mfma_f32_16x16x32_bf16 a[60:63], a[252:255], a[140:143], a[60:63]
ds_read_b64_tr_b16 a[84:85], v14 offset:8192
ds_read_b64_tr_b16 a[86:87], v14 offset:12288
v_mfma_f32_16x16x32_bf16 a[52:55], a[252:255], a[136:139], a[52:55]
ds_read_b64_tr_b16 a[88:89], v14 offset:16384
ds_read_b64_tr_b16 a[90:91], v14 offset:20480
v_mfma_f32_16x16x32_bf16 a[52:55], a[248:251], a[120:123], a[52:55]
ds_read_b64_tr_b16 a[92:93], v14 offset:24576
ds_read_b64_tr_b16 a[94:95], v14 offset:28672
v_mfma_f32_16x16x32_bf16 a[52:55], a[244:247], a[232:235], a[52:55]
ds_read_b64_tr_b16 a[96:97], v14 offset:32768
ds_read_b64_tr_b16 a[98:99], v14 offset:36864
v_mfma_f32_16x16x32_bf16 a[52:55], a[240:243], a[216:219], a[52:55]
ds_read_b64_tr_b16 a[100:101], v14 offset:40960
ds_read_b64_tr_b16 a[102:103], v14 offset:45056
v_mfma_f32_16x16x32_bf16 a[52:55], a[108:111], a[200:203], a[52:55]
v_cvt_pk_bf16_f32 v225, v226, v227
v_cvt_pk_bf16_f32 v226, v228, v229
v_mfma_f32_16x16x32_bf16 a[52:55], a[104:107], a[184:187], a[52:55]
v_cvt_pk_bf16_f32 v227, v230, v231
v_pk_max_i16 v224, v224, 0
v_mfma_f32_16x16x32_bf16 a[44:47], a[104:107], a[180:183], a[44:47]
v_pk_max_i16 v225, v225, 0
v_pk_max_i16 v226, v226, 0
v_mfma_f32_16x16x32_bf16 a[44:47], a[108:111], a[196:199], a[44:47]
v_pk_max_i16 v227, v227, 0
v_mfma_f32_16x16x32_bf16 a[44:47], a[240:243], a[212:215], a[44:47]
buffer_store_dwordx4 v[224:227], v7, s[16:19], s44 offen offset:0 sc1
v_mfma_f32_16x16x32_bf16 a[44:47], a[244:247], a[228:231], a[44:47]
v_accvgpr_read_b32 v232, a8
v_accvgpr_read_b32 v233, a9
v_mfma_f32_16x16x32_bf16 a[44:47], a[248:251], a[116:119], a[44:47]
v_accvgpr_read_b32 v234, a10
v_accvgpr_read_b32 v235, a11
v_mfma_f32_16x16x32_bf16 a[44:47], a[252:255], a[132:135], a[44:47]
v_accvgpr_read_b32 v236, a12
v_accvgpr_read_b32 v237, a13
v_mfma_f32_16x16x32_bf16 a[36:39], a[252:255], a[128:131], a[36:39]
v_accvgpr_read_b32 v238, a14
v_accvgpr_read_b32 v239, a15
v_mfma_f32_16x16x32_bf16 a[36:39], a[248:251], a[112:115], a[36:39]
v_cvt_pk_bf16_f32 v232, v232, v233
v_cvt_pk_bf16_f32 v233, v234, v235
v_mfma_f32_16x16x32_bf16 a[36:39], a[244:247], a[224:227], a[36:39]
v_cvt_pk_bf16_f32 v234, v236, v237
v_cvt_pk_bf16_f32 v235, v238, v239
v_mfma_f32_16x16x32_bf16 a[36:39], a[240:243], a[208:211], a[36:39]
v_pk_max_i16 v232, v232, 0
v_pk_max_i16 v233, v233, 0
v_mfma_f32_16x16x32_bf16 a[36:39], a[108:111], a[192:195], a[36:39]
v_pk_max_i16 v234, v234, 0
v_pk_max_i16 v235, v235, 0
v_mfma_f32_16x16x32_bf16 a[36:39], a[104:107], a[176:179], a[36:39]
s_waitcnt lgkmcnt(0)
buffer_store_dwordx4 v[232:235], v7, s[16:19], s44 offen offset:1024 sc1
v_mfma_f32_16x16x32_bf16 v[96:99], a[80:83], a[176:179], v[96:99]
v_accvgpr_read_b32 v240, a16
v_accvgpr_read_b32 v241, a17
v_mfma_f32_16x16x32_bf16 v[96:99], a[84:87], a[192:195], v[96:99]
v_accvgpr_read_b32 v242, a18
v_accvgpr_read_b32 v243, a19
v_mfma_f32_16x16x32_bf16 v[96:99], a[88:91], a[208:211], v[96:99]
v_accvgpr_read_b32 v244, a20
v_accvgpr_read_b32 v245, a21
v_mfma_f32_16x16x32_bf16 v[96:99], a[92:95], a[224:227], v[96:99]
v_accvgpr_read_b32 v246, a22
v_accvgpr_read_b32 v247, a23
v_mfma_f32_16x16x32_bf16 v[96:99], a[96:99], a[112:115], v[96:99]
ds_read_b64_tr_b16 a[104:105], v15 offset:0
ds_read_b64_tr_b16 a[106:107], v15 offset:4096
v_mfma_f32_16x16x32_bf16 v[96:99], a[100:103], a[128:131], v[96:99]
ds_read_b64_tr_b16 a[108:109], v15 offset:8192
ds_read_b64_tr_b16 a[110:111], v15 offset:12288
v_mfma_f32_16x16x32_bf16 v[104:107], a[100:103], a[132:135], v[104:107]
ds_read_b64_tr_b16 a[240:241], v15 offset:16384
ds_read_b64_tr_b16 a[242:243], v15 offset:20480
v_mfma_f32_16x16x32_bf16 v[104:107], a[96:99], a[116:119], v[104:107]
ds_read_b64_tr_b16 a[244:245], v15 offset:24576
ds_read_b64_tr_b16 a[246:247], v15 offset:28672
v_mfma_f32_16x16x32_bf16 v[104:107], a[92:95], a[228:231], v[104:107]
ds_read_b64_tr_b16 a[248:249], v15 offset:32768
ds_read_b64_tr_b16 a[250:251], v15 offset:36864
v_mfma_f32_16x16x32_bf16 v[104:107], a[88:91], a[212:215], v[104:107]
ds_read_b64_tr_b16 a[252:253], v15 offset:40960
ds_read_b64_tr_b16 a[254:255], v15 offset:45056
v_mfma_f32_16x16x32_bf16 v[104:107], a[84:87], a[196:199], v[104:107]
v_cvt_pk_bf16_f32 v240, v240, v241
v_cvt_pk_bf16_f32 v241, v242, v243
v_mfma_f32_16x16x32_bf16 v[104:107], a[80:83], a[180:183], v[104:107]
v_cvt_pk_bf16_f32 v242, v244, v245
v_cvt_pk_bf16_f32 v243, v246, v247
v_mfma_f32_16x16x32_bf16 v[112:115], a[80:83], a[184:187], v[112:115]
v_pk_max_i16 v240, v240, 0
v_pk_max_i16 v241, v241, 0
v_mfma_f32_16x16x32_bf16 v[112:115], a[84:87], a[200:203], v[112:115]
v_pk_max_i16 v242, v242, 0
v_pk_max_i16 v243, v243, 0
v_mfma_f32_16x16x32_bf16 v[112:115], a[88:91], a[216:219], v[112:115]
buffer_store_dwordx4 v[240:243], v7, s[16:19], s44 offen offset:2048 sc1
v_mfma_f32_16x16x32_bf16 v[112:115], a[92:95], a[232:235], v[112:115]
v_accvgpr_read_b32 v248, a24
v_accvgpr_read_b32 v249, a25
v_mfma_f32_16x16x32_bf16 v[112:115], a[96:99], a[120:123], v[112:115]
v_accvgpr_read_b32 v250, a26
v_accvgpr_read_b32 v251, a27
v_mfma_f32_16x16x32_bf16 v[112:115], a[100:103], a[136:139], v[112:115]
v_accvgpr_read_b32 v252, a28
v_accvgpr_read_b32 v253, a29
v_mfma_f32_16x16x32_bf16 v[120:123], a[100:103], a[140:143], v[120:123]
v_accvgpr_read_b32 v254, a30
v_accvgpr_read_b32 v255, a31
v_mfma_f32_16x16x32_bf16 v[120:123], a[96:99], a[124:127], v[120:123]
v_cvt_pk_bf16_f32 v248, v248, v249
v_cvt_pk_bf16_f32 v249, v250, v251
v_mfma_f32_16x16x32_bf16 v[120:123], a[92:95], a[236:239], v[120:123]
v_cvt_pk_bf16_f32 v250, v252, v253
v_cvt_pk_bf16_f32 v251, v254, v255
v_mfma_f32_16x16x32_bf16 v[120:123], a[88:91], a[220:223], v[120:123]
v_pk_max_i16 v248, v248, 0
v_pk_max_i16 v249, v249, 0
v_mfma_f32_16x16x32_bf16 v[120:123], a[84:87], a[204:207], v[120:123]
v_pk_max_i16 v250, v250, 0
v_pk_max_i16 v251, v251, 0
v_mfma_f32_16x16x32_bf16 v[120:123], a[80:83], a[188:191], v[120:123]
s_waitcnt lgkmcnt(0)
buffer_store_dwordx4 v[248:251], v7, s[16:19], s44 offen offset:3072 sc1
v_mfma_f32_16x16x32_bf16 v[124:127], a[104:107], a[188:191], v[124:127]
s_add_u32 s44, s42, 32768
v_accvgpr_read_b32 v224, a32
v_accvgpr_read_b32 v225, a33
v_mfma_f32_16x16x32_bf16 v[124:127], a[108:111], a[204:207], v[124:127]
v_accvgpr_read_b32 v226, a34
v_accvgpr_read_b32 v227, a35
v_mfma_f32_16x16x32_bf16 v[124:127], a[240:243], a[220:223], v[124:127]
v_accvgpr_read_b32 v228, a36
v_accvgpr_read_b32 v229, a37
v_mfma_f32_16x16x32_bf16 v[124:127], a[244:247], a[236:239], v[124:127]
v_accvgpr_read_b32 v230, a38
v_accvgpr_read_b32 v231, a39
v_mfma_f32_16x16x32_bf16 v[124:127], a[248:251], a[124:127], v[124:127]
v_cvt_pk_bf16_f32 v224, v224, v225
v_cvt_pk_bf16_f32 v225, v226, v227
v_mfma_f32_16x16x32_bf16 v[124:127], a[252:255], a[140:143], v[124:127]
v_cvt_pk_bf16_f32 v226, v228, v229
v_cvt_pk_bf16_f32 v227, v230, v231
v_mfma_f32_16x16x32_bf16 v[116:119], a[252:255], a[136:139], v[116:119]
v_pk_max_i16 v224, v224, 0
v_pk_max_i16 v225, v225, 0
v_mfma_f32_16x16x32_bf16 v[116:119], a[248:251], a[120:123], v[116:119]
v_pk_max_i16 v226, v226, 0
v_pk_max_i16 v227, v227, 0
v_mfma_f32_16x16x32_bf16 v[116:119], a[244:247], a[232:235], v[116:119]
buffer_store_dwordx4 v[224:227], v7, s[16:19], s44 offen offset:0 sc1
v_mfma_f32_16x16x32_bf16 v[116:119], a[240:243], a[216:219], v[116:119]
v_accvgpr_read_b32 v232, a40
v_accvgpr_read_b32 v233, a41
v_mfma_f32_16x16x32_bf16 v[116:119], a[108:111], a[200:203], v[116:119]
v_accvgpr_read_b32 v234, a42
v_accvgpr_read_b32 v235, a43
v_mfma_f32_16x16x32_bf16 v[116:119], a[104:107], a[184:187], v[116:119]
v_accvgpr_read_b32 v236, a44
v_accvgpr_read_b32 v237, a45
v_mfma_f32_16x16x32_bf16 v[108:111], a[104:107], a[180:183], v[108:111]
v_accvgpr_read_b32 v238, a46
v_accvgpr_read_b32 v239, a47
v_mfma_f32_16x16x32_bf16 v[108:111], a[108:111], a[196:199], v[108:111]
v_cvt_pk_bf16_f32 v232, v232, v233
v_cvt_pk_bf16_f32 v233, v234, v235
v_mfma_f32_16x16x32_bf16 v[108:111], a[240:243], a[212:215], v[108:111]
v_cvt_pk_bf16_f32 v234, v236, v237
v_cvt_pk_bf16_f32 v235, v238, v239
v_mfma_f32_16x16x32_bf16 v[108:111], a[244:247], a[228:231], v[108:111]
v_pk_max_i16 v232, v232, 0
v_pk_max_i16 v233, v233, 0
v_mfma_f32_16x16x32_bf16 v[108:111], a[248:251], a[116:119], v[108:111]
v_pk_max_i16 v234, v234, 0
v_pk_max_i16 v235, v235, 0
v_mfma_f32_16x16x32_bf16 v[108:111], a[252:255], a[132:135], v[108:111]
buffer_store_dwordx4 v[232:235], v7, s[16:19], s44 offen offset:1024 sc1
v_mfma_f32_16x16x32_bf16 v[100:103], a[252:255], a[128:131], v[100:103]
v_accvgpr_read_b32 v240, a48
v_accvgpr_read_b32 v241, a49
v_mfma_f32_16x16x32_bf16 v[100:103], a[248:251], a[112:115], v[100:103]
v_accvgpr_read_b32 v242, a50
v_accvgpr_read_b32 v243, a51
v_mfma_f32_16x16x32_bf16 v[100:103], a[244:247], a[224:227], v[100:103]
v_accvgpr_read_b32 v244, a52
v_accvgpr_read_b32 v245, a53
v_mfma_f32_16x16x32_bf16 v[100:103], a[240:243], a[208:211], v[100:103]
v_accvgpr_read_b32 v246, a54
v_accvgpr_read_b32 v247, a55
v_mfma_f32_16x16x32_bf16 v[100:103], a[108:111], a[192:195], v[100:103]
v_cvt_pk_bf16_f32 v240, v240, v241
v_cvt_pk_bf16_f32 v241, v242, v243
v_mfma_f32_16x16x32_bf16 v[100:103], a[104:107], a[176:179], v[100:103]
v_cvt_pk_bf16_f32 v242, v244, v245
v_cvt_pk_bf16_f32 v243, v246, v247
v_pk_max_i16 v240, v240, 0
v_pk_max_i16 v241, v241, 0
v_pk_max_i16 v242, v242, 0
v_pk_max_i16 v243, v243, 0
buffer_store_dwordx4 v[240:243], v7, s[16:19], s44 offen offset:2048 sc1
v_accvgpr_read_b32 v248, a56
v_accvgpr_read_b32 v249, a57
v_accvgpr_read_b32 v250, a58
v_accvgpr_read_b32 v251, a59
v_accvgpr_read_b32 v252, a60
v_accvgpr_read_b32 v253, a61
v_accvgpr_read_b32 v254, a62
v_accvgpr_read_b32 v255, a63
v_cvt_pk_bf16_f32 v248, v248, v249
v_cvt_pk_bf16_f32 v249, v250, v251
v_cvt_pk_bf16_f32 v250, v252, v253
v_cvt_pk_bf16_f32 v251, v254, v255
v_pk_max_i16 v248, v248, 0
v_pk_max_i16 v249, v249, 0
v_pk_max_i16 v250, v250, 0
v_pk_max_i16 v251, v251, 0
buffer_store_dwordx4 v[248:251], v7, s[16:19], s44 offen offset:3072 sc1
s_waitcnt vmcnt(56) lgkmcnt(0)
s_barrier
s_branch M_p1e
M_p1f:
s_waitcnt vmcnt(26)
s_barrier
ds_read_b64_tr_b16 a[80:81], v16 offset:0
ds_read_b64_tr_b16 a[82:83], v16 offset:4096
ds_read_b64_tr_b16 a[84:85], v16 offset:8192
ds_read_b64_tr_b16 a[86:87], v16 offset:12288
ds_read_b64_tr_b16 a[88:89], v16 offset:8
ds_read_b64_tr_b16 a[90:91], v16 offset:4104
ds_read_b64_tr_b16 a[92:93], v16 offset:8200
ds_read_b64_tr_b16 a[94:95], v16 offset:12296
s_waitcnt vmcnt(8) lgkmcnt(4)
v_mfma_f32_16x16x32_bf16 v[128:131], a[80:83], a[112:115], 0
s_add_u32 m0, s24, 131072
buffer_load_dwordx4 a[176:179], v7, s[16:19], s38 offen offset:0 sc1
v_mfma_f32_16x16x32_bf16 v[128:131], a[84:87], a[128:131], v[128:131]
ds_read_b64_tr_b16 a[96:97], v17 offset:0
ds_read_b64_tr_b16 a[98:99], v17 offset:4096
v_mfma_f32_16x16x32_bf16 v[136:139], a[84:87], a[132:135], 0
ds_read_b64_tr_b16 a[100:101], v17 offset:8192
ds_read_b64_tr_b16 a[102:103], v17 offset:12288
v_mfma_f32_16x16x32_bf16 v[136:139], a[80:83], a[116:119], v[136:139]
v_mfma_f32_16x16x32_bf16 v[144:147], a[80:83], a[120:123], 0
v_mfma_f32_16x16x32_bf16 v[144:147], a[84:87], a[136:139], v[144:147]
buffer_load_dwordx4 v25, s[32:35], s37 offen offset:0 lds
v_mfma_f32_16x16x32_bf16 v[152:155], a[84:87], a[140:143], 0
v_mfma_f32_16x16x32_bf16 v[152:155], a[80:83], a[124:127], v[152:155]
s_waitcnt lgkmcnt(4)
v_mfma_f32_16x16x32_bf16 v[156:159], a[88:91], a[124:127], 0
ds_read_b64_tr_b16 a[104:105], v17 offset:8
ds_read_b64_tr_b16 a[106:107], v17 offset:4104
v_mfma_f32_16x16x32_bf16 v[156:159], a[92:95], a[140:143], v[156:159]
ds_read_b64_tr_b16 a[108:109], v17 offset:8200
ds_read_b64_tr_b16 a[110:111], v17 offset:12296
v_mfma_f32_16x16x32_bf16 v[148:151], a[92:95], a[136:139], 0
buffer_load_dwordx4 v26, s[32:35], s37 offen offset:1024 lds
v_mfma_f32_16x16x32_bf16 v[148:151], a[88:91], a[120:123], v[148:151]
v_mfma_f32_16x16x32_bf16 v[140:143], a[88:91], a[116:119], 0
v_mfma_f32_16x16x32_bf16 v[140:143], a[92:95], a[132:135], v[140:143]
v_mfma_f32_16x16x32_bf16 v[132:135], a[92:95], a[128:131], 0
v_mfma_f32_16x16x32_bf16 v[132:135], a[88:91], a[112:115], v[132:135]
s_waitcnt lgkmcnt(4)
buffer_load_dwordx4 v27, s[32:35], s37 offen offset:2048 lds
v_mfma_f32_16x16x32_bf16 v[160:163], a[96:99], a[112:115], 0
ds_read_b64_tr_b16 a[240:241], v18 offset:0
ds_read_b64_tr_b16 a[242:243], v18 offset:4096
v_mfma_f32_16x16x32_bf16 v[160:163], a[100:103], a[128:131], v[160:163]
ds_read_b64_tr_b16 a[244:245], v18 offset:8192
ds_read_b64_tr_b16 a[246:247], v18 offset:12288
v_mfma_f32_16x16x32_bf16 v[168:171], a[100:103], a[132:135], 0
v_mfma_f32_16x16x32_bf16 v[168:171], a[96:99], a[116:119], v[168:171]
v_mfma_f32_16x16x32_bf16 v[176:179], a[96:99], a[120:123], 0
buffer_load_dwordx4 v28, s[32:35], s37 offen offset:3072 lds
v_mfma_f32_16x16x32_bf16 v[176:179], a[100:103], a[136:139], v[176:179]
s_add_u32 s37, s37, 589824
s_add_u32 m0, s24, 65536
v_mfma_f32_16x16x32_bf16 v[184:187], a[100:103], a[140:143], 0
v_mfma_f32_16x16x32_bf16 v[184:187], a[96:99], a[124:127], v[184:187]
s_waitcnt lgkmcnt(4)
v_mfma_f32_16x16x32_bf16 v[188:191], a[104:107], a[124:127], 0
ds_read_b64_tr_b16 a[248:249], v18 offset:8
ds_read_b64_tr_b16 a[250:251], v18 offset:4104
v_mfma_f32_16x16x32_bf16 v[188:191], a[108:111], a[140:143], v[188:191]
buffer_load_dwordx4 a[180:183], v7, s[16:19], s38 offen offset:1024 sc1
v_mfma_f32_16x16x32_bf16 v[180:183], a[108:111], a[136:139], 0
ds_read_b64_tr_b16 a[252:253], v18 offset:8200
ds_read_b64_tr_b16 a[254:255], v18 offset:12296
v_mfma_f32_16x16x32_bf16 v[180:183], a[104:107], a[120:123], v[180:183]
v_mfma_f32_16x16x32_bf16 v[172:175], a[104:107], a[116:119], 0
v_mfma_f32_16x16x32_bf16 v[172:175], a[108:111], a[132:135], v[172:175]
v_mfma_f32_16x16x32_bf16 v[164:167], a[108:111], a[128:131], 0
buffer_load_dwordx4 a[184:187], v7, s[16:19], s38 offen offset:2048 sc1
v_mfma_f32_16x16x32_bf16 v[164:167], a[104:107], a[112:115], v[164:167]
s_waitcnt lgkmcnt(4)
v_mfma_f32_16x16x32_bf16 v[192:195], a[240:243], a[112:115], 0
ds_read_b64_tr_b16 a[80:81], v19 offset:0
ds_read_b64_tr_b16 a[82:83], v19 offset:4096
v_mfma_f32_16x16x32_bf16 v[192:195], a[244:247], a[128:131], v[192:195]
ds_read_b64_tr_b16 a[84:85], v19 offset:8192
ds_read_b64_tr_b16 a[86:87], v19 offset:12288
v_mfma_f32_16x16x32_bf16 v[200:203], a[244:247], a[132:135], 0
v_mfma_f32_16x16x32_bf16 v[200:203], a[240:243], a[116:119], v[200:203]
buffer_load_dwordx4 a[188:191], v7, s[16:19], s38 offen offset:3072 sc1
v_mfma_f32_16x16x32_bf16 v[208:211], a[240:243], a[120:123], 0
s_add_u32 s38, s38, 16384
v_mfma_f32_16x16x32_bf16 v[208:211], a[244:247], a[136:139], v[208:211]
v_mfma_f32_16x16x32_bf16 v[216:219], a[244:247], a[140:143], 0
v_mfma_f32_16x16x32_bf16 v[216:219], a[240:243], a[124:127], v[216:219]
s_waitcnt lgkmcnt(4)
v_mfma_f32_16x16x32_bf16 v[220:223], a[248:251], a[124:127], 0
buffer_load_dwordx4 v21, s[28:31], s36 offen offset:0 lds
v_mfma_f32_16x16x32_bf16 v[220:223], a[252:255], a[140:143], v[220:223]
ds_read_b64_tr_b16 a[88:89], v19 offset:8
ds_read_b64_tr_b16 a[90:91], v19 offset:4104
v_mfma_f32_16x16x32_bf16 v[212:215], a[252:255], a[136:139], 0
ds_read_b64_tr_b16 a[92:93], v19 offset:8200
ds_read_b64_tr_b16 a[94:95], v19 offset:12296
v_mfma_f32_16x16x32_bf16 v[212:215], a[248:251], a[120:123], v[212:215]
v_mfma_f32_16x16x32_bf16 v[204:207], a[248:251], a[116:119], 0
v_mfma_f32_16x16x32_bf16 v[204:207], a[252:255], a[132:135], v[204:207]
buffer_load_dwordx4 a[192:195], v7, s[16:19], s38 offen offset:0 sc1
v_mfma_f32_16x16x32_bf16 v[196:199], a[252:255], a[128:131], 0
v_mfma_f32_16x16x32_bf16 v[196:199], a[248:251], a[112:115], v[196:199]
s_waitcnt lgkmcnt(4)
v_mfma_f32_16x16x32_bf16 v[224:227], a[80:83], a[112:115], 0
s_waitcnt vmcnt(18) lgkmcnt(0)
s_barrier
ds_read_b64_tr_b16 a[96:97], v8 offset:0
v_mfma_f32_16x16x32_bf16 v[224:227], a[84:87], a[128:131], v[224:227]
ds_read_b64_tr_b16 a[98:99], v8 offset:4096
ds_read_b64_tr_b16 a[100:101], v8 offset:8192
v_mfma_f32_16x16x32_bf16 v[232:235], a[84:87], a[132:135], 0
buffer_load_dwordx4 v22, s[28:31], s36 offen offset:1024 lds
v_mfma_f32_16x16x32_bf16 v[232:235], a[80:83], a[116:119], v[232:235]
ds_read_b64_tr_b16 a[102:103], v8 offset:12288
v_mfma_f32_16x16x32_bf16 v[240:243], a[80:83], a[120:123], 0
v_mfma_f32_16x16x32_bf16 v[240:243], a[84:87], a[136:139], v[240:243]
v_mfma_f32_16x16x32_bf16 v[248:251], a[84:87], a[140:143], 0
v_mfma_f32_16x16x32_bf16 v[248:251], a[80:83], a[124:127], v[248:251]
s_waitcnt lgkmcnt(4)
buffer_load_dwordx4 a[196:199], v7, s[16:19], s38 offen offset:1024 sc1
v_mfma_f32_16x16x32_bf16 v[252:255], a[88:91], a[124:127], 0
ds_read_b64_tr_b16 a[104:105], v9 offset:0
ds_read_b64_tr_b16 a[106:107], v9 offset:4096
v_mfma_f32_16x16x32_bf16 v[252:255], a[92:95], a[140:143], v[252:255]
ds_read_b64_tr_b16 a[108:109], v9 offset:8192
ds_read_b64_tr_b16 a[110:111], v9 offset:12288
v_mfma_f32_16x16x32_bf16 v[244:247], a[92:95], a[136:139], 0
v_mfma_f32_16x16x32_bf16 v[244:247], a[88:91], a[120:123], v[244:247]
v_mfma_f32_16x16x32_bf16 v[236:239], a[88:91], a[116:119], 0
buffer_load_dwordx4 v23, s[28:31], s36 offen offset:2048 lds
v_mfma_f32_16x16x32_bf16 v[236:239], a[92:95], a[132:135], v[236:239]
v_mfma_f32_16x16x32_bf16 v[228:231], a[92:95], a[128:131], 0
v_mfma_f32_16x16x32_bf16 v[228:231], a[88:91], a[112:115], v[228:231]
s_waitcnt lgkmcnt(4)
v_mfma_f32_16x16x32_bf16 v[64:67], a[96:99], a[112:115], 0
ds_read_b64_tr_b16 a[240:241], v10 offset:0
ds_read_b64_tr_b16 a[242:243], v10 offset:4096
v_mfma_f32_16x16x32_bf16 v[64:67], a[100:103], a[128:131], v[64:67]
buffer_load_dwordx4 a[200:203], v7, s[16:19], s38 offen offset:2048 sc1
v_mfma_f32_16x16x32_bf16 v[72:75], a[100:103], a[132:135], 0
ds_read_b64_tr_b16 a[244:245], v10 offset:8192
ds_read_b64_tr_b16 a[246:247], v10 offset:12288
v_mfma_f32_16x16x32_bf16 v[72:75], a[96:99], a[116:119], v[72:75]
v_mfma_f32_16x16x32_bf16 v[80:83], a[96:99], a[120:123], 0
v_mfma_f32_16x16x32_bf16 v[80:83], a[100:103], a[136:139], v[80:83]
v_mfma_f32_16x16x32_bf16 v[88:91], a[100:103], a[140:143], 0
buffer_load_dwordx4 v24, s[28:31], s36 offen offset:3072 lds
v_mfma_f32_16x16x32_bf16 v[88:91], a[96:99], a[124:127], v[88:91]
s_waitcnt lgkmcnt(4)
s_add_u32 s36, s36, 524288
s_add_u32 m0, s24, 147456
v_mfma_f32_16x16x32_bf16 v[92:95], a[104:107], a[124:127], 0
ds_read_b64_tr_b16 a[248:249], v11 offset:0
ds_read_b64_tr_b16 a[250:251], v11 offset:4096
v_mfma_f32_16x16x32_bf16 v[92:95], a[108:111], a[140:143], v[92:95]
ds_read_b64_tr_b16 a[252:253], v11 offset:8192
ds_read_b64_tr_b16 a[254:255], v11 offset:12288
v_mfma_f32_16x16x32_bf16 v[84:87], a[108:111], a[136:139], 0
v_mfma_f32_16x16x32_bf16 v[84:87], a[104:107], a[120:123], v[84:87]
buffer_load_dwordx4 a[204:207], v7, s[16:19], s38 offen offset:3072 sc1
v_mfma_f32_16x16x32_bf16 v[76:79], a[104:107], a[116:119], 0
s_add_u32 s38, s38, 16384
v_mfma_f32_16x16x32_bf16 v[76:79], a[108:111], a[132:135], v[76:79]
v_mfma_f32_16x16x32_bf16 v[68:71], a[108:111], a[128:131], 0
v_mfma_f32_16x16x32_bf16 v[68:71], a[104:107], a[112:115], v[68:71]
s_waitcnt lgkmcnt(4)
v_mfma_f32_16x16x32_bf16 a[0:3], a[240:243], a[112:115], 0
buffer_load_dwordx4 v25, s[32:35], s37 offen offset:0 lds
v_mfma_f32_16x16x32_bf16 a[0:3], a[244:247], a[128:131], a[0:3]
ds_read_b64_tr_b16 a[80:81], v12 offset:0
ds_read_b64_tr_b16 a[82:83], v12 offset:4096
v_mfma_f32_16x16x32_bf16 a[8:11], a[244:247], a[132:135], 0
ds_read_b64_tr_b16 a[84:85], v12 offset:8192
ds_read_b64_tr_b16 a[86:87], v12 offset:12288
v_mfma_f32_16x16x32_bf16 a[8:11], a[240:243], a[116:119], a[8:11]
v_mfma_f32_16x16x32_bf16 a[16:19], a[240:243], a[120:123], 0
v_mfma_f32_16x16x32_bf16 a[16:19], a[244:247], a[136:139], a[16:19]
buffer_load_dwordx4 v26, s[32:35], s37 offen offset:1024 lds
v_mfma_f32_16x16x32_bf16 a[24:27], a[244:247], a[140:143], 0
v_mfma_f32_16x16x32_bf16 a[24:27], a[240:243], a[124:127], a[24:27]
s_waitcnt lgkmcnt(4)
v_mfma_f32_16x16x32_bf16 a[28:31], a[248:251], a[124:127], 0
ds_read_b64_tr_b16 a[88:89], v13 offset:0
ds_read_b64_tr_b16 a[90:91], v13 offset:4096
v_mfma_f32_16x16x32_bf16 a[28:31], a[252:255], a[140:143], a[28:31]
ds_read_b64_tr_b16 a[92:93], v13 offset:8192
ds_read_b64_tr_b16 a[94:95], v13 offset:12288
v_mfma_f32_16x16x32_bf16 a[20:23], a[252:255], a[136:139], 0
buffer_load_dwordx4 v27, s[32:35], s37 offen offset:2048 lds
v_mfma_f32_16x16x32_bf16 a[20:23], a[248:251], a[120:123], a[20:23]
v_mfma_f32_16x16x32_bf16 a[12:15], a[248:251], a[116:119], 0
v_mfma_f32_16x16x32_bf16 a[12:15], a[252:255], a[132:135], a[12:15]
v_mfma_f32_16x16x32_bf16 a[4:7], a[252:255], a[128:131], 0
v_mfma_f32_16x16x32_bf16 a[4:7], a[248:251], a[112:115], a[4:7]
s_waitcnt lgkmcnt(4)
buffer_load_dwordx4 v28, s[32:35], s37 offen offset:3072 lds
v_mfma_f32_16x16x32_bf16 a[32:35], a[80:83], a[112:115], 0
s_add_u32 s37, s37, 589824
s_add_u32 m0, s24, 32768
ds_read_b64_tr_b16 a[96:97], v14 offset:0
v_mfma_f32_16x16x32_bf16 a[32:35], a[84:87], a[128:131], a[32:35]
ds_read_b64_tr_b16 a[98:99], v14 offset:4096
ds_read_b64_tr_b16 a[100:101], v14 offset:8192
v_mfma_f32_16x16x32_bf16 a[40:43], a[84:87], a[132:135], 0
ds_read_b64_tr_b16 a[102:103], v14 offset:12288
v_mfma_f32_16x16x32_bf16 a[40:43], a[80:83], a[116:119], a[40:43]
v_mfma_f32_16x16x32_bf16 a[48:51], a[80:83], a[120:123], 0
buffer_load_dwordx4 a[208:211], v7, s[16:19], s38 offen offset:0 sc1
v_mfma_f32_16x16x32_bf16 a[48:51], a[84:87], a[136:139], a[48:51]
v_mfma_f32_16x16x32_bf16 a[56:59], a[84:87], a[140:143], 0
v_mfma_f32_16x16x32_bf16 a[56:59], a[80:83], a[124:127], a[56:59]
s_waitcnt lgkmcnt(4)
v_mfma_f32_16x16x32_bf16 a[60:63], a[88:91], a[124:127], 0
ds_read_b64_tr_b16 a[104:105], v15 offset:0
ds_read_b64_tr_b16 a[106:107], v15 offset:4096
v_mfma_f32_16x16x32_bf16 a[60:63], a[92:95], a[140:143], a[60:63]
buffer_load_dwordx4 a[212:215], v7, s[16:19], s38 offen offset:1024 sc1
v_mfma_f32_16x16x32_bf16 a[52:55], a[92:95], a[136:139], 0
ds_read_b64_tr_b16 a[108:109], v15 offset:8192
ds_read_b64_tr_b16 a[110:111], v15 offset:12288
v_mfma_f32_16x16x32_bf16 a[52:55], a[88:91], a[120:123], a[52:55]
v_mfma_f32_16x16x32_bf16 a[44:47], a[88:91], a[116:119], 0
v_mfma_f32_16x16x32_bf16 a[44:47], a[92:95], a[132:135], a[44:47]
v_mfma_f32_16x16x32_bf16 a[36:39], a[92:95], a[128:131], 0
buffer_load_dwordx4 a[216:219], v7, s[16:19], s38 offen offset:2048 sc1
v_mfma_f32_16x16x32_bf16 a[36:39], a[88:91], a[112:115], a[36:39]
s_waitcnt lgkmcnt(4)
v_mfma_f32_16x16x32_bf16 v[96:99], a[96:99], a[112:115], 0
s_waitcnt vmcnt(23) lgkmcnt(0)
s_barrier
ds_read_b64_tr_b16 a[240:241], v16 offset:16384
v_mfma_f32_16x16x32_bf16 v[96:99], a[100:103], a[128:131], v[96:99]
ds_read_b64_tr_b16 a[242:243], v16 offset:20480
ds_read_b64_tr_b16 a[244:245], v16 offset:24576
v_mfma_f32_16x16x32_bf16 v[104:107], a[100:103], a[132:135], 0
ds_read_b64_tr_b16 a[246:247], v16 offset:28672
v_mfma_f32_16x16x32_bf16 v[104:107], a[96:99], a[116:119], v[104:107]
buffer_load_dwordx4 a[220:223], v7, s[16:19], s38 offen offset:3072 sc1
v_mfma_f32_16x16x32_bf16 v[112:115], a[96:99], a[120:123], 0
s_add_u32 s38, s38, 16384
v_mfma_f32_16x16x32_bf16 v[112:115], a[100:103], a[136:139], v[112:115]
v_mfma_f32_16x16x32_bf16 v[120:123], a[100:103], a[140:143], 0
v_mfma_f32_16x16x32_bf16 v[120:123], a[96:99], a[124:127], v[120:123]
s_waitcnt lgkmcnt(4)
v_mfma_f32_16x16x32_bf16 v[124:127], a[104:107], a[124:127], 0
buffer_load_dwordx4 v21, s[28:31], s36 offen offset:0 lds
v_mfma_f32_16x16x32_bf16 v[124:127], a[108:111], a[140:143], v[124:127]
ds_read_b64_tr_b16 a[248:249], v16 offset:16392
ds_read_b64_tr_b16 a[250:251], v16 offset:20488
v_mfma_f32_16x16x32_bf16 v[116:119], a[108:111], a[136:139], 0
ds_read_b64_tr_b16 a[252:253], v16 offset:24584
ds_read_b64_tr_b16 a[254:255], v16 offset:28680
v_mfma_f32_16x16x32_bf16 v[116:119], a[104:107], a[120:123], v[116:119]
v_mfma_f32_16x16x32_bf16 v[108:111], a[104:107], a[116:119], 0
v_mfma_f32_16x16x32_bf16 v[108:111], a[108:111], a[132:135], v[108:111]
buffer_load_dwordx4 a[224:227], v7, s[16:19], s38 offen offset:0 sc1
v_mfma_f32_16x16x32_bf16 v[100:103], a[108:111], a[128:131], 0
v_mfma_f32_16x16x32_bf16 v[100:103], a[104:107], a[112:115], v[100:103]
s_waitcnt lgkmcnt(4)
v_mfma_f32_16x16x32_bf16 v[128:131], a[240:243], a[144:147], v[128:131]
ds_read_b64_tr_b16 a[80:81], v17 offset:16384
ds_read_b64_tr_b16 a[82:83], v17 offset:20480
v_mfma_f32_16x16x32_bf16 v[128:131], a[244:247], a[160:163], v[128:131]
ds_read_b64_tr_b16 a[84:85], v17 offset:24576
ds_read_b64_tr_b16 a[86:87], v17 offset:28672
v_mfma_f32_16x16x32_bf16 v[136:139], a[244:247], a[164:167], v[136:139]
buffer_load_dwordx4 v22, s[28:31], s36 offen offset:1024 lds
v_mfma_f32_16x16x32_bf16 v[136:139], a[240:243], a[148:151], v[136:139]
v_mfma_f32_16x16x32_bf16 v[144:147], a[240:243], a[152:155], v[144:147]
v_mfma_f32_16x16x32_bf16 v[144:147], a[244:247], a[168:171], v[144:147]
v_mfma_f32_16x16x32_bf16 v[152:155], a[244:247], a[172:175], v[152:155]
v_mfma_f32_16x16x32_bf16 v[152:155], a[240:243], a[156:159], v[152:155]
s_waitcnt lgkmcnt(4)
buffer_load_dwordx4 a[228:231], v7, s[16:19], s38 offen offset:1024 sc1
v_mfma_f32_16x16x32_bf16 v[156:159], a[248:251], a[156:159], v[156:159]
ds_read_b64_tr_b16 a[88:89], v17 offset:16392
ds_read_b64_tr_b16 a[90:91], v17 offset:20488
v_mfma_f32_16x16x32_bf16 v[156:159], a[252:255], a[172:175], v[156:159]
ds_read_b64_tr_b16 a[92:93], v17 offset:24584
ds_read_b64_tr_b16 a[94:95], v17 offset:28680
v_mfma_f32_16x16x32_bf16 v[148:151], a[252:255], a[168:171], v[148:151]
v_mfma_f32_16x16x32_bf16 v[148:151], a[248:251], a[152:155], v[148:151]
v_mfma_f32_16x16x32_bf16 v[140:143], a[248:251], a[148:151], v[140:143]
buffer_load_dwordx4 v23, s[28:31], s36 offen offset:2048 lds
v_mfma_f32_16x16x32_bf16 v[140:143], a[252:255], a[164:167], v[140:143]
v_mfma_f32_16x16x32_bf16 v[132:135], a[252:255], a[160:163], v[132:135]
v_mfma_f32_16x16x32_bf16 v[132:135], a[248:251], a[144:147], v[132:135]
s_waitcnt lgkmcnt(4)
v_mfma_f32_16x16x32_bf16 v[160:163], a[80:83], a[144:147], v[160:163]
ds_read_b64_tr_b16 a[96:97], v18 offset:16384
ds_read_b64_tr_b16 a[98:99], v18 offset:20480
v_mfma_f32_16x16x32_bf16 v[160:163], a[84:87], a[160:163], v[160:163]
buffer_load_dwordx4 a[232:235], v7, s[16:19], s38 offen offset:2048 sc1
v_mfma_f32_16x16x32_bf16 v[168:171], a[84:87], a[164:167], v[168:171]
ds_read_b64_tr_b16 a[100:101], v18 offset:24576
ds_read_b64_tr_b16 a[102:103], v18 offset:28672
v_mfma_f32_16x16x32_bf16 v[168:171], a[80:83], a[148:151], v[168:171]
v_mfma_f32_16x16x32_bf16 v[176:179], a[80:83], a[152:155], v[176:179]
v_mfma_f32_16x16x32_bf16 v[176:179], a[84:87], a[168:171], v[176:179]
v_mfma_f32_16x16x32_bf16 v[184:187], a[84:87], a[172:175], v[184:187]
buffer_load_dwordx4 v24, s[28:31], s36 offen offset:3072 lds
v_mfma_f32_16x16x32_bf16 v[184:187], a[80:83], a[156:159], v[184:187]
s_waitcnt lgkmcnt(4)
s_add_u32 s36, s36, 524288
s_add_u32 m0, s24, 114688
v_mfma_f32_16x16x32_bf16 v[188:191], a[88:91], a[156:159], v[188:191]
ds_read_b64_tr_b16 a[104:105], v18 offset:16392
ds_read_b64_tr_b16 a[106:107], v18 offset:20488
v_mfma_f32_16x16x32_bf16 v[188:191], a[92:95], a[172:175], v[188:191]
ds_read_b64_tr_b16 a[108:109], v18 offset:24584
ds_read_b64_tr_b16 a[110:111], v18 offset:28680
v_mfma_f32_16x16x32_bf16 v[180:183], a[92:95], a[168:171], v[180:183]
v_mfma_f32_16x16x32_bf16 v[180:183], a[88:91], a[152:155], v[180:183]
buffer_load_dwordx4 a[236:239], v7, s[16:19], s38 offen offset:3072 sc1
v_mfma_f32_16x16x32_bf16 v[172:175], a[88:91], a[148:151], v[172:175]
s_add_u32 s38, s38, 16384
v_mfma_f32_16x16x32_bf16 v[172:175], a[92:95], a[164:167], v[172:175]
v_mfma_f32_16x16x32_bf16 v[164:167], a[92:95], a[160:163], v[164:167]
v_mfma_f32_16x16x32_bf16 v[164:167], a[88:91], a[144:147], v[164:167]
s_waitcnt lgkmcnt(4)
v_mfma_f32_16x16x32_bf16 v[192:195], a[96:99], a[144:147], v[192:195]
buffer_load_dwordx4 v25, s[32:35], s37 offen offset:0 lds
v_mfma_f32_16x16x32_bf16 v[192:195], a[100:103], a[160:163], v[192:195]
ds_read_b64_tr_b16 a[240:241], v19 offset:16384
ds_read_b64_tr_b16 a[242:243], v19 offset:20480
v_mfma_f32_16x16x32_bf16 v[200:203], a[100:103], a[164:167], v[200:203]
ds_read_b64_tr_b16 a[244:245], v19 offset:24576
ds_read_b64_tr_b16 a[246:247], v19 offset:28672
v_mfma_f32_16x16x32_bf16 v[200:203], a[96:99], a[148:151], v[200:203]
v_mfma_f32_16x16x32_bf16 v[208:211], a[96:99], a[152:155], v[208:211]
v_mfma_f32_16x16x32_bf16 v[208:211], a[100:103], a[168:171], v[208:211]
buffer_load_dwordx4 v26, s[32:35], s37 offen offset:1024 lds
v_mfma_f32_16x16x32_bf16 v[216:219], a[100:103], a[172:175], v[216:219]
v_mfma_f32_16x16x32_bf16 v[216:219], a[96:99], a[156:159], v[216:219]
s_waitcnt lgkmcnt(4)
v_mfma_f32_16x16x32_bf16 v[220:223], a[104:107], a[156:159], v[220:223]
ds_read_b64_tr_b16 a[248:249], v19 offset:16392
ds_read_b64_tr_b16 a[250:251], v19 offset:20488
v_mfma_f32_16x16x32_bf16 v[220:223], a[108:111], a[172:175], v[220:223]
ds_read_b64_tr_b16 a[252:253], v19 offset:24584
ds_read_b64_tr_b16 a[254:255], v19 offset:28680
v_mfma_f32_16x16x32_bf16 v[212:215], a[108:111], a[168:171], v[212:215]
buffer_load_dwordx4 v27, s[32:35], s37 offen offset:2048 lds
v_mfma_f32_16x16x32_bf16 v[212:215], a[104:107], a[152:155], v[212:215]
v_mfma_f32_16x16x32_bf16 v[204:207], a[104:107], a[148:151], v[204:207]
v_mfma_f32_16x16x32_bf16 v[204:207], a[108:111], a[164:167], v[204:207]
v_mfma_f32_16x16x32_bf16 v[196:199], a[108:111], a[160:163], v[196:199]
v_mfma_f32_16x16x32_bf16 v[196:199], a[104:107], a[144:147], v[196:199]
s_waitcnt lgkmcnt(4)
buffer_load_dwordx4 v28, s[32:35], s37 offen offset:3072 lds
v_mfma_f32_16x16x32_bf16 v[224:227], a[240:243], a[144:147], v[224:227]
s_add_u32 s37, s37, 589824
s_waitcnt vmcnt(31) lgkmcnt(0)
s_barrier
v_mfma_f32_16x16x32_bf16 v[224:227], a[244:247], a[160:163], v[224:227]
s_add_u32 m0, s24, 49152
ds_read_b64_tr_b16 a[80:81], v8 offset:16384
ds_read_b64_tr_b16 a[82:83], v8 offset:20480
v_mfma_f32_16x16x32_bf16 v[232:235], a[244:247], a[164:167], v[232:235]
ds_read_b64_tr_b16 a[84:85], v8 offset:24576
ds_read_b64_tr_b16 a[86:87], v8 offset:28672
v_mfma_f32_16x16x32_bf16 v[232:235], a[240:243], a[148:151], v[232:235]
v_mfma_f32_16x16x32_bf16 v[240:243], a[240:243], a[152:155], v[240:243]
buffer_load_dwordx4 a[112:115], v7, s[16:19], s38 offen offset:0 sc1
v_mfma_f32_16x16x32_bf16 v[240:243], a[244:247], a[168:171], v[240:243]
v_mfma_f32_16x16x32_bf16 v[248:251], a[244:247], a[172:175], v[248:251]
v_mfma_f32_16x16x32_bf16 v[248:251], a[240:243], a[156:159], v[248:251]
s_waitcnt lgkmcnt(4)
v_mfma_f32_16x16x32_bf16 v[252:255], a[248:251], a[156:159], v[252:255]
ds_read_b64_tr_b16 a[88:89], v9 offset:16384
ds_read_b64_tr_b16 a[90:91], v9 offset:20480
v_mfma_f32_16x16x32_bf16 v[252:255], a[252:255], a[172:175], v[252:255]
buffer_load_dwordx4 a[116:119], v7, s[16:19], s38 offen offset:1024 sc1
v_mfma_f32_16x16x32_bf16 v[244:247], a[252:255], a[168:171], v[244:247]
ds_read_b64_tr_b16 a[92:93], v9 offset:24576
ds_read_b64_tr_b16 a[94:95], v9 offset:28672
v_mfma_f32_16x16x32_bf16 v[244:247], a[248:251], a[152:155], v[244:247]
v_mfma_f32_16x16x32_bf16 v[236:239], a[248:251], a[148:151], v[236:239]
v_mfma_f32_16x16x32_bf16 v[236:239], a[252:255], a[164:167], v[236:239]
v_mfma_f32_16x16x32_bf16 v[228:231], a[252:255], a[160:163], v[228:231]
buffer_load_dwordx4 a[120:123], v7, s[16:19], s38 offen offset:2048 sc1
v_mfma_f32_16x16x32_bf16 v[228:231], a[248:251], a[144:147], v[228:231]
s_waitcnt lgkmcnt(4)
v_mfma_f32_16x16x32_bf16 v[64:67], a[80:83], a[144:147], v[64:67]
ds_read_b64_tr_b16 a[96:97], v10 offset:16384
ds_read_b64_tr_b16 a[98:99], v10 offset:20480
v_mfma_f32_16x16x32_bf16 v[64:67], a[84:87], a[160:163], v[64:67]
ds_read_b64_tr_b16 a[100:101], v10 offset:24576
ds_read_b64_tr_b16 a[102:103], v10 offset:28672
v_mfma_f32_16x16x32_bf16 v[72:75], a[84:87], a[164:167], v[72:75]
v_mfma_f32_16x16x32_bf16 v[72:75], a[80:83], a[148:151], v[72:75]
buffer_load_dwordx4 a[124:127], v7, s[16:19], s38 offen offset:3072 sc1
v_mfma_f32_16x16x32_bf16 v[80:83], a[80:83], a[152:155], v[80:83]
s_add_u32 s38, s38, 16384
v_mfma_f32_16x16x32_bf16 v[80:83], a[84:87], a[168:171], v[80:83]
v_mfma_f32_16x16x32_bf16 v[88:91], a[84:87], a[172:175], v[88:91]
v_mfma_f32_16x16x32_bf16 v[88:91], a[80:83], a[156:159], v[88:91]
s_waitcnt lgkmcnt(4)
v_mfma_f32_16x16x32_bf16 v[92:95], a[88:91], a[156:159], v[92:95]
buffer_load_dwordx4 v21, s[28:31], s36 offen offset:0 lds
v_mfma_f32_16x16x32_bf16 v[92:95], a[92:95], a[172:175], v[92:95]
ds_read_b64_tr_b16 a[104:105], v11 offset:16384
ds_read_b64_tr_b16 a[106:107], v11 offset:20480
v_mfma_f32_16x16x32_bf16 v[84:87], a[92:95], a[168:171], v[84:87]
ds_read_b64_tr_b16 a[108:109], v11 offset:24576
ds_read_b64_tr_b16 a[110:111], v11 offset:28672
v_mfma_f32_16x16x32_bf16 v[84:87], a[88:91], a[152:155], v[84:87]
v_mfma_f32_16x16x32_bf16 v[76:79], a[88:91], a[148:151], v[76:79]
v_mfma_f32_16x16x32_bf16 v[76:79], a[92:95], a[164:167], v[76:79]
buffer_load_dwordx4 a[128:131], v7, s[16:19], s38 offen offset:0 sc1
v_mfma_f32_16x16x32_bf16 v[68:71], a[92:95], a[160:163], v[68:71]
v_mfma_f32_16x16x32_bf16 v[68:71], a[88:91], a[144:147], v[68:71]
s_waitcnt lgkmcnt(4)
v_mfma_f32_16x16x32_bf16 a[0:3], a[96:99], a[144:147], a[0:3]
ds_read_b64_tr_b16 a[240:241], v12 offset:16384
ds_read_b64_tr_b16 a[242:243], v12 offset:20480
v_mfma_f32_16x16x32_bf16 a[0:3], a[100:103], a[160:163], a[0:3]
ds_read_b64_tr_b16 a[244:245], v12 offset:24576
ds_read_b64_tr_b16 a[246:247], v12 offset:28672
v_mfma_f32_16x16x32_bf16 a[8:11], a[100:103], a[164:167], a[8:11]
buffer_load_dwordx4 v22, s[28:31], s36 offen offset:1024 lds
v_mfma_f32_16x16x32_bf16 a[8:11], a[96:99], a[148:151], a[8:11]
v_mfma_f32_16x16x32_bf16 a[16:19], a[96:99], a[152:155], a[16:19]
v_mfma_f32_16x16x32_bf16 a[16:19], a[100:103], a[168:171], a[16:19]
v_mfma_f32_16x16x32_bf16 a[24:27], a[100:103], a[172:175], a[24:27]
v_mfma_f32_16x16x32_bf16 a[24:27], a[96:99], a[156:159], a[24:27]
s_waitcnt lgkmcnt(4)
buffer_load_dwordx4 a[132:135], v7, s[16:19], s38 offen offset:1024 sc1
v_mfma_f32_16x16x32_bf16 a[28:31], a[104:107], a[156:159], a[28:31]
ds_read_b64_tr_b16 a[248:249], v13 offset:16384
ds_read_b64_tr_b16 a[250:251], v13 offset:20480
v_mfma_f32_16x16x32_bf16 a[28:31], a[108:111], a[172:175], a[28:31]
ds_read_b64_tr_b16 a[252:253], v13 offset:24576
ds_read_b64_tr_b16 a[254:255], v13 offset:28672
v_mfma_f32_16x16x32_bf16 a[20:23], a[108:111], a[168:171], a[20:23]
v_mfma_f32_16x16x32_bf16 a[20:23], a[104:107], a[152:155], a[20:23]
v_mfma_f32_16x16x32_bf16 a[12:15], a[104:107], a[148:151], a[12:15]
buffer_load_dwordx4 v23, s[28:31], s36 offen offset:2048 lds
v_mfma_f32_16x16x32_bf16 a[12:15], a[108:111], a[164:167], a[12:15]
v_mfma_f32_16x16x32_bf16 a[4:7], a[108:111], a[160:163], a[4:7]
v_mfma_f32_16x16x32_bf16 a[4:7], a[104:107], a[144:147], a[4:7]
s_waitcnt lgkmcnt(4)
v_mfma_f32_16x16x32_bf16 a[32:35], a[240:243], a[144:147], a[32:35]
ds_read_b64_tr_b16 a[80:81], v14 offset:16384
ds_read_b64_tr_b16 a[82:83], v14 offset:20480
v_mfma_f32_16x16x32_bf16 a[32:35], a[244:247], a[160:163], a[32:35]
buffer_load_dwordx4 a[136:139], v7, s[16:19], s38 offen offset:2048 sc1
v_mfma_f32_16x16x32_bf16 a[40:43], a[244:247], a[164:167], a[40:43]
ds_read_b64_tr_b16 a[84:85], v14 offset:24576
ds_read_b64_tr_b16 a[86:87], v14 offset:28672
v_mfma_f32_16x16x32_bf16 a[40:43], a[240:243], a[148:151], a[40:43]
v_mfma_f32_16x16x32_bf16 a[48:51], a[240:243], a[152:155], a[48:51]
v_mfma_f32_16x16x32_bf16 a[48:51], a[244:247], a[168:171], a[48:51]
v_mfma_f32_16x16x32_bf16 a[56:59], a[244:247], a[172:175], a[56:59]
buffer_load_dwordx4 v24, s[28:31], s36 offen offset:3072 lds
v_mfma_f32_16x16x32_bf16 a[56:59], a[240:243], a[156:159], a[56:59]
s_waitcnt lgkmcnt(4)
s_add_u32 s36, s36, 524288
v_mfma_f32_16x16x32_bf16 a[60:63], a[248:251], a[156:159], a[60:63]
ds_read_b64_tr_b16 a[88:89], v15 offset:16384
ds_read_b64_tr_b16 a[90:91], v15 offset:20480
v_mfma_f32_16x16x32_bf16 a[60:63], a[252:255], a[172:175], a[60:63]
ds_read_b64_tr_b16 a[92:93], v15 offset:24576
ds_read_b64_tr_b16 a[94:95], v15 offset:28672
v_mfma_f32_16x16x32_bf16 a[52:55], a[252:255], a[168:171], a[52:55]
v_mfma_f32_16x16x32_bf16 a[52:55], a[248:251], a[152:155], a[52:55]
buffer_load_dwordx4 a[140:143], v7, s[16:19], s38 offen offset:3072 sc1
v_mfma_f32_16x16x32_bf16 a[44:47], a[248:251], a[148:151], a[44:47]
s_add_u32 s38, s38, 16384
v_mfma_f32_16x16x32_bf16 a[44:47], a[252:255], a[164:167], a[44:47]
v_mfma_f32_16x16x32_bf16 a[36:39], a[252:255], a[160:163], a[36:39]
v_mfma_f32_16x16x32_bf16 a[36:39], a[248:251], a[144:147], a[36:39]
s_waitcnt lgkmcnt(4)
v_mfma_f32_16x16x32_bf16 v[96:99], a[80:83], a[144:147], v[96:99]
s_waitcnt vmcnt(32) lgkmcnt(0)
s_barrier
ds_read_b64_tr_b16 a[96:97], v16 offset:32768
v_mfma_f32_16x16x32_bf16 v[96:99], a[84:87], a[160:163], v[96:99]
s_add_u32 m0, s24, 131072
ds_read_b64_tr_b16 a[98:99], v16 offset:36864
ds_read_b64_tr_b16 a[100:101], v16 offset:40960
v_mfma_f32_16x16x32_bf16 v[104:107], a[84:87], a[164:167], v[104:107]
buffer_load_dwordx4 v25, s[32:35], s37 offen offset:0 lds
v_mfma_f32_16x16x32_bf16 v[104:107], a[80:83], a[148:151], v[104:107]
ds_read_b64_tr_b16 a[102:103], v16 offset:45056
v_mfma_f32_16x16x32_bf16 v[112:115], a[80:83], a[152:155], v[112:115]
v_mfma_f32_16x16x32_bf16 v[112:115], a[84:87], a[168:171], v[112:115]
v_mfma_f32_16x16x32_bf16 v[120:123], a[84:87], a[172:175], v[120:123]
buffer_load_dwordx4 v26, s[32:35], s37 offen offset:1024 lds
v_mfma_f32_16x16x32_bf16 v[120:123], a[80:83], a[156:159], v[120:123]
s_waitcnt lgkmcnt(4)
v_mfma_f32_16x16x32_bf16 v[124:127], a[88:91], a[156:159], v[124:127]
ds_read_b64_tr_b16 a[104:105], v16 offset:32776
ds_read_b64_tr_b16 a[106:107], v16 offset:36872
v_mfma_f32_16x16x32_bf16 v[124:127], a[92:95], a[172:175], v[124:127]
ds_read_b64_tr_b16 a[108:109], v16 offset:40968
ds_read_b64_tr_b16 a[110:111], v16 offset:45064
v_mfma_f32_16x16x32_bf16 v[116:119], a[92:95], a[168:171], v[116:119]
v_mfma_f32_16x16x32_bf16 v[116:119], a[88:91], a[152:155], v[116:119]
buffer_load_dwordx4 v27, s[32:35], s37 offen offset:2048 lds
v_mfma_f32_16x16x32_bf16 v[108:111], a[88:91], a[148:151], v[108:111]
v_mfma_f32_16x16x32_bf16 v[108:111], a[92:95], a[164:167], v[108:111]
v_mfma_f32_16x16x32_bf16 v[100:103], a[92:95], a[160:163], v[100:103]
v_mfma_f32_16x16x32_bf16 v[100:103], a[88:91], a[144:147], v[100:103]
s_waitcnt lgkmcnt(4)
v_mfma_f32_16x16x32_bf16 v[128:131], a[96:99], a[176:179], v[128:131]
buffer_load_dwordx4 v28, s[32:35], s37 offen offset:3072 lds
v_mfma_f32_16x16x32_bf16 v[128:131], a[100:103], a[192:195], v[128:131]
s_add_u32 s37, s37, 589824
ds_read_b64_tr_b16 a[240:241], v17 offset:32768
ds_read_b64_tr_b16 a[242:243], v17 offset:36864
v_mfma_f32_16x16x32_bf16 v[136:139], a[100:103], a[196:199], v[136:139]
ds_read_b64_tr_b16 a[244:245], v17 offset:40960
ds_read_b64_tr_b16 a[246:247], v17 offset:45056
v_mfma_f32_16x16x32_bf16 v[136:139], a[96:99], a[180:183], v[136:139]
v_mfma_f32_16x16x32_bf16 v[144:147], a[96:99], a[184:187], v[144:147]
v_mfma_f32_16x16x32_bf16 v[144:147], a[100:103], a[200:203], v[144:147]
buffer_load_dwordx4 a[144:147], v7, s[16:19], s38 offen offset:0 sc1
v_mfma_f32_16x16x32_bf16 v[152:155], a[100:103], a[204:207], v[152:155]
v_mfma_f32_16x16x32_bf16 v[152:155], a[96:99], a[188:191], v[152:155]
s_waitcnt lgkmcnt(4)
v_mfma_f32_16x16x32_bf16 v[156:159], a[104:107], a[188:191], v[156:159]
ds_read_b64_tr_b16 a[248:249], v17 offset:32776
ds_read_b64_tr_b16 a[250:251], v17 offset:36872
v_mfma_f32_16x16x32_bf16 v[156:159], a[108:111], a[204:207], v[156:159]
ds_read_b64_tr_b16 a[252:253], v17 offset:40968
ds_read_b64_tr_b16 a[254:255], v17 offset:45064
v_mfma_f32_16x16x32_bf16 v[148:151], a[108:111], a[200:203], v[148:151]
buffer_load_dwordx4 a[148:151], v7, s[16:19], s38 offen offset:1024 sc1
v_mfma_f32_16x16x32_bf16 v[148:151], a[104:107], a[184:187], v[148:151]
v_mfma_f32_16x16x32_bf16 v[140:143], a[104:107], a[180:183], v[140:143]
v_mfma_f32_16x16x32_bf16 v[140:143], a[108:111], a[196:199], v[140:143]
v_mfma_f32_16x16x32_bf16 v[132:135], a[108:111], a[192:195], v[132:135]
v_mfma_f32_16x16x32_bf16 v[132:135], a[104:107], a[176:179], v[132:135]
s_waitcnt lgkmcnt(4)
buffer_load_dwordx4 a[152:155], v7, s[16:19], s38 offen offset:2048 sc1
v_mfma_f32_16x16x32_bf16 v[160:163], a[240:243], a[176:179], v[160:163]
ds_read_b64_tr_b16 a[80:81], v18 offset:32768
ds_read_b64_tr_b16 a[82:83], v18 offset:36864
v_mfma_f32_16x16x32_bf16 v[160:163], a[244:247], a[192:195], v[160:163]
ds_read_b64_tr_b16 a[84:85], v18 offset:40960
ds_read_b64_tr_b16 a[86:87], v18 offset:45056
v_mfma_f32_16x16x32_bf16 v[168:171], a[244:247], a[196:199], v[168:171]
v_mfma_f32_16x16x32_bf16 v[168:171], a[240:243], a[180:183], v[168:171]
v_mfma_f32_16x16x32_bf16 v[176:179], a[240:243], a[184:187], v[176:179]
buffer_load_dwordx4 a[156:159], v7, s[16:19], s38 offen offset:3072 sc1
v_mfma_f32_16x16x32_bf16 v[176:179], a[244:247], a[200:203], v[176:179]
s_add_u32 s38, s38, 16384
v_mfma_f32_16x16x32_bf16 v[184:187], a[244:247], a[204:207], v[184:187]
v_mfma_f32_16x16x32_bf16 v[184:187], a[240:243], a[188:191], v[184:187]
s_waitcnt lgkmcnt(4)
v_mfma_f32_16x16x32_bf16 v[188:191], a[248:251], a[188:191], v[188:191]
ds_read_b64_tr_b16 a[88:89], v18 offset:32776
ds_read_b64_tr_b16 a[90:91], v18 offset:36872
v_mfma_f32_16x16x32_bf16 v[188:191], a[252:255], a[204:207], v[188:191]
buffer_load_dwordx4 a[160:163], v7, s[16:19], s38 offen offset:0 sc1
v_mfma_f32_16x16x32_bf16 v[180:183], a[252:255], a[200:203], v[180:183]
ds_read_b64_tr_b16 a[92:93], v18 offset:40968
ds_read_b64_tr_b16 a[94:95], v18 offset:45064
v_mfma_f32_16x16x32_bf16 v[180:183], a[248:251], a[184:187], v[180:183]
v_mfma_f32_16x16x32_bf16 v[172:175], a[248:251], a[180:183], v[172:175]
v_mfma_f32_16x16x32_bf16 v[172:175], a[252:255], a[196:199], v[172:175]
v_mfma_f32_16x16x32_bf16 v[164:167], a[252:255], a[192:195], v[164:167]
buffer_load_dwordx4 a[164:167], v7, s[16:19], s38 offen offset:1024 sc1
v_mfma_f32_16x16x32_bf16 v[164:167], a[248:251], a[176:179], v[164:167]
s_waitcnt lgkmcnt(4)
v_mfma_f32_16x16x32_bf16 v[192:195], a[80:83], a[176:179], v[192:195]
ds_read_b64_tr_b16 a[96:97], v19 offset:32768
ds_read_b64_tr_b16 a[98:99], v19 offset:36864
v_mfma_f32_16x16x32_bf16 v[192:195], a[84:87], a[192:195], v[192:195]
ds_read_b64_tr_b16 a[100:101], v19 offset:40960
ds_read_b64_tr_b16 a[102:103], v19 offset:45056
v_mfma_f32_16x16x32_bf16 v[200:203], a[84:87], a[196:199], v[200:203]
v_mfma_f32_16x16x32_bf16 v[200:203], a[80:83], a[180:183], v[200:203]
buffer_load_dwordx4 a[168:171], v7, s[16:19], s38 offen offset:2048 sc1
v_mfma_f32_16x16x32_bf16 v[208:211], a[80:83], a[184:187], v[208:211]
v_mfma_f32_16x16x32_bf16 v[208:211], a[84:87], a[200:203], v[208:211]
v_mfma_f32_16x16x32_bf16 v[216:219], a[84:87], a[204:207], v[216:219]
v_mfma_f32_16x16x32_bf16 v[216:219], a[80:83], a[188:191], v[216:219]
s_waitcnt lgkmcnt(4)
v_mfma_f32_16x16x32_bf16 v[220:223], a[88:91], a[188:191], v[220:223]
buffer_load_dwordx4 a[172:175], v7, s[16:19], s38 offen offset:3072 sc1
v_mfma_f32_16x16x32_bf16 v[220:223], a[92:95], a[204:207], v[220:223]
s_add_u32 s38, s38, 16384
ds_read_b64_tr_b16 a[104:105], v19 offset:32776
ds_read_b64_tr_b16 a[106:107], v19 offset:36872
v_mfma_f32_16x16x32_bf16 v[212:215], a[92:95], a[200:203], v[212:215]
ds_read_b64_tr_b16 a[108:109], v19 offset:40968
ds_read_b64_tr_b16 a[110:111], v19 offset:45064
v_mfma_f32_16x16x32_bf16 v[212:215], a[88:91], a[184:187], v[212:215]
v_mfma_f32_16x16x32_bf16 v[204:207], a[88:91], a[180:183], v[204:207]
v_mfma_f32_16x16x32_bf16 v[204:207], a[92:95], a[196:199], v[204:207]
v_mfma_f32_16x16x32_bf16 v[196:199], a[92:95], a[192:195], v[196:199]
v_mfma_f32_16x16x32_bf16 v[196:199], a[88:91], a[176:179], v[196:199]
s_waitcnt lgkmcnt(4)
v_mfma_f32_16x16x32_bf16 v[224:227], a[96:99], a[176:179], v[224:227]
s_waitcnt vmcnt(40) lgkmcnt(0)
s_barrier
ds_read_b64_tr_b16 a[240:241], v8 offset:32768
v_mfma_f32_16x16x32_bf16 v[224:227], a[100:103], a[192:195], v[224:227]
s_add_u32 m0, s24, 65536
ds_read_b64_tr_b16 a[242:243], v8 offset:36864
ds_read_b64_tr_b16 a[244:245], v8 offset:40960
v_mfma_f32_16x16x32_bf16 v[232:235], a[100:103], a[196:199], v[232:235]
buffer_load_dwordx4 v21, s[28:31], s36 offen offset:0 lds
v_mfma_f32_16x16x32_bf16 v[232:235], a[96:99], a[180:183], v[232:235]
ds_read_b64_tr_b16 a[246:247], v8 offset:45056
v_mfma_f32_16x16x32_bf16 v[240:243], a[96:99], a[184:187], v[240:243]
v_mfma_f32_16x16x32_bf16 v[240:243], a[100:103], a[200:203], v[240:243]
v_mfma_f32_16x16x32_bf16 v[248:251], a[100:103], a[204:207], v[248:251]
buffer_load_dwordx4 v22, s[28:31], s36 offen offset:1024 lds
v_mfma_f32_16x16x32_bf16 v[248:251], a[96:99], a[188:191], v[248:251]
s_waitcnt lgkmcnt(4)
v_mfma_f32_16x16x32_bf16 v[252:255], a[104:107], a[188:191], v[252:255]
ds_read_b64_tr_b16 a[248:249], v9 offset:32768
ds_read_b64_tr_b16 a[250:251], v9 offset:36864
v_mfma_f32_16x16x32_bf16 v[252:255], a[108:111], a[204:207], v[252:255]
ds_read_b64_tr_b16 a[252:253], v9 offset:40960
ds_read_b64_tr_b16 a[254:255], v9 offset:45056
v_mfma_f32_16x16x32_bf16 v[244:247], a[108:111], a[200:203], v[244:247]
v_mfma_f32_16x16x32_bf16 v[244:247], a[104:107], a[184:187], v[244:247]
buffer_load_dwordx4 v23, s[28:31], s36 offen offset:2048 lds
v_mfma_f32_16x16x32_bf16 v[236:239], a[104:107], a[180:183], v[236:239]
v_mfma_f32_16x16x32_bf16 v[236:239], a[108:111], a[196:199], v[236:239]
v_mfma_f32_16x16x32_bf16 v[228:231], a[108:111], a[192:195], v[228:231]
v_mfma_f32_16x16x32_bf16 v[228:231], a[104:107], a[176:179], v[228:231]
s_waitcnt lgkmcnt(4)
v_mfma_f32_16x16x32_bf16 v[64:67], a[240:243], a[176:179], v[64:67]
buffer_load_dwordx4 v24, s[28:31], s36 offen offset:3072 lds
v_mfma_f32_16x16x32_bf16 v[64:67], a[244:247], a[192:195], v[64:67]
s_add_u32 s36, s36, 524288
ds_read_b64_tr_b16 a[80:81], v10 offset:32768
ds_read_b64_tr_b16 a[82:83], v10 offset:36864
v_mfma_f32_16x16x32_bf16 v[72:75], a[244:247], a[196:199], v[72:75]
ds_read_b64_tr_b16 a[84:85], v10 offset:40960
ds_read_b64_tr_b16 a[86:87], v10 offset:45056
v_mfma_f32_16x16x32_bf16 v[72:75], a[240:243], a[180:183], v[72:75]
v_mfma_f32_16x16x32_bf16 v[80:83], a[240:243], a[184:187], v[80:83]
v_mfma_f32_16x16x32_bf16 v[80:83], a[244:247], a[200:203], v[80:83]
v_mfma_f32_16x16x32_bf16 v[88:91], a[244:247], a[204:207], v[88:91]
v_mfma_f32_16x16x32_bf16 v[88:91], a[240:243], a[188:191], v[88:91]
s_waitcnt lgkmcnt(4)
v_mfma_f32_16x16x32_bf16 v[92:95], a[248:251], a[188:191], v[92:95]
ds_read_b64_tr_b16 a[88:89], v11 offset:32768
ds_read_b64_tr_b16 a[90:91], v11 offset:36864
v_mfma_f32_16x16x32_bf16 v[92:95], a[252:255], a[204:207], v[92:95]
ds_read_b64_tr_b16 a[92:93], v11 offset:40960
ds_read_b64_tr_b16 a[94:95], v11 offset:45056
v_mfma_f32_16x16x32_bf16 v[84:87], a[252:255], a[200:203], v[84:87]
v_mfma_f32_16x16x32_bf16 v[84:87], a[248:251], a[184:187], v[84:87]
v_mfma_f32_16x16x32_bf16 v[76:79], a[248:251], a[180:183], v[76:79]
v_mfma_f32_16x16x32_bf16 v[76:79], a[252:255], a[196:199], v[76:79]
v_mfma_f32_16x16x32_bf16 v[68:71], a[252:255], a[192:195], v[68:71]
v_mfma_f32_16x16x32_bf16 v[68:71], a[248:251], a[176:179], v[68:71]
s_waitcnt lgkmcnt(4)
v_mfma_f32_16x16x32_bf16 a[0:3], a[80:83], a[176:179], a[0:3]
ds_read_b64_tr_b16 a[96:97], v12 offset:32768
ds_read_b64_tr_b16 a[98:99], v12 offset:36864
v_mfma_f32_16x16x32_bf16 a[0:3], a[84:87], a[192:195], a[0:3]
ds_read_b64_tr_b16 a[100:101], v12 offset:40960
ds_read_b64_tr_b16 a[102:103], v12 offset:45056
v_mfma_f32_16x16x32_bf16 a[8:11], a[84:87], a[196:199], a[8:11]
v_mfma_f32_16x16x32_bf16 a[8:11], a[80:83], a[180:183], a[8:11]
v_mfma_f32_16x16x32_bf16 a[16:19], a[80:83], a[184:187], a[16:19]
v_mfma_f32_16x16x32_bf16 a[16:19], a[84:87], a[200:203], a[16:19]
v_mfma_f32_16x16x32_bf16 a[24:27], a[84:87], a[204:207], a[24:27]
v_mfma_f32_16x16x32_bf16 a[24:27], a[80:83], a[188:191], a[24:27]
s_waitcnt lgkmcnt(4)
v_mfma_f32_16x16x32_bf16 a[28:31], a[88:91], a[188:191], a[28:31]
ds_read_b64_tr_b16 a[104:105], v13 offset:32768
ds_read_b64_tr_b16 a[106:107], v13 offset:36864
v_mfma_f32_16x16x32_bf16 a[28:31], a[92:95], a[204:207], a[28:31]
ds_read_b64_tr_b16 a[108:109], v13 offset:40960
ds_read_b64_tr_b16 a[110:111], v13 offset:45056
v_mfma_f32_16x16x32_bf16 a[20:23], a[92:95], a[200:203], a[20:23]
v_mfma_f32_16x16x32_bf16 a[20:23], a[88:91], a[184:187], a[20:23]
v_mfma_f32_16x16x32_bf16 a[12:15], a[88:91], a[180:183], a[12:15]
v_mfma_f32_16x16x32_bf16 a[12:15], a[92:95], a[196:199], a[12:15]
v_mfma_f32_16x16x32_bf16 a[4:7], a[92:95], a[192:195], a[4:7]
v_mfma_f32_16x16x32_bf16 a[4:7], a[88:91], a[176:179], a[4:7]
s_waitcnt lgkmcnt(4)
v_mfma_f32_16x16x32_bf16 a[32:35], a[96:99], a[176:179], a[32:35]
ds_read_b64_tr_b16 a[240:241], v14 offset:32768
ds_read_b64_tr_b16 a[242:243], v14 offset:36864
v_mfma_f32_16x16x32_bf16 a[32:35], a[100:103], a[192:195], a[32:35]
ds_read_b64_tr_b16 a[244:245], v14 offset:40960
ds_read_b64_tr_b16 a[246:247], v14 offset:45056
v_mfma_f32_16x16x32_bf16 a[40:43], a[100:103], a[196:199], a[40:43]
v_mfma_f32_16x16x32_bf16 a[40:43], a[96:99], a[180:183], a[40:43]
v_mfma_f32_16x16x32_bf16 a[48:51], a[96:99], a[184:187], a[48:51]
v_mfma_f32_16x16x32_bf16 a[48:51], a[100:103], a[200:203], a[48:51]
v_mfma_f32_16x16x32_bf16 a[56:59], a[100:103], a[204:207], a[56:59]
v_mfma_f32_16x16x32_bf16 a[56:59], a[96:99], a[188:191], a[56:59]
s_waitcnt lgkmcnt(4)
v_mfma_f32_16x16x32_bf16 a[60:63], a[104:107], a[188:191], a[60:63]
ds_read_b64_tr_b16 a[248:249], v15 offset:32768
ds_read_b64_tr_b16 a[250:251], v15 offset:36864
v_mfma_f32_16x16x32_bf16 a[60:63], a[108:111], a[204:207], a[60:63]
ds_read_b64_tr_b16 a[252:253], v15 offset:40960
ds_read_b64_tr_b16 a[254:255], v15 offset:45056
v_mfma_f32_16x16x32_bf16 a[52:55], a[108:111], a[200:203], a[52:55]
v_mfma_f32_16x16x32_bf16 a[52:55], a[104:107], a[184:187], a[52:55]
v_mfma_f32_16x16x32_bf16 a[44:47], a[104:107], a[180:183], a[44:47]
v_mfma_f32_16x16x32_bf16 a[44:47], a[108:111], a[196:199], a[44:47]
v_mfma_f32_16x16x32_bf16 a[36:39], a[108:111], a[192:195], a[36:39]
v_mfma_f32_16x16x32_bf16 a[36:39], a[104:107], a[176:179], a[36:39]
s_waitcnt lgkmcnt(4)
v_mfma_f32_16x16x32_bf16 v[96:99], a[240:243], a[176:179], v[96:99]
s_waitcnt vmcnt(32) lgkmcnt(0)
s_barrier
ds_read_b64_tr_b16 a[80:81], v16 offset:0
v_mfma_f32_16x16x32_bf16 v[96:99], a[244:247], a[192:195], v[96:99]
s_add_u32 m0, s24, 147456
ds_read_b64_tr_b16 a[82:83], v16 offset:4096
ds_read_b64_tr_b16 a[84:85], v16 offset:8192
v_mfma_f32_16x16x32_bf16 v[104:107], a[244:247], a[196:199], v[104:107]
buffer_load_dwordx4 v25, s[32:35], s37 offen offset:0 lds
v_mfma_f32_16x16x32_bf16 v[104:107], a[240:243], a[180:183], v[104:107]
ds_read_b64_tr_b16 a[86:87], v16 offset:12288
v_mfma_f32_16x16x32_bf16 v[112:115], a[240:243], a[184:187], v[112:115]
v_mfma_f32_16x16x32_bf16 v[112:115], a[244:247], a[200:203], v[112:115]
v_mfma_f32_16x16x32_bf16 v[120:123], a[244:247], a[204:207], v[120:123]
buffer_load_dwordx4 v26, s[32:35], s37 offen offset:1024 lds
v_mfma_f32_16x16x32_bf16 v[120:123], a[240:243], a[188:191], v[120:123]
s_waitcnt lgkmcnt(4)
v_mfma_f32_16x16x32_bf16 v[124:127], a[248:251], a[188:191], v[124:127]
ds_read_b64_tr_b16 a[88:89], v16 offset:8
ds_read_b64_tr_b16 a[90:91], v16 offset:4104
v_mfma_f32_16x16x32_bf16 v[124:127], a[252:255], a[204:207], v[124:127]
ds_read_b64_tr_b16 a[92:93], v16 offset:8200
ds_read_b64_tr_b16 a[94:95], v16 offset:12296
v_mfma_f32_16x16x32_bf16 v[116:119], a[252:255], a[200:203], v[116:119]
v_mfma_f32_16x16x32_bf16 v[116:119], a[248:251], a[184:187], v[116:119]
buffer_load_dwordx4 v27, s[32:35], s37 offen offset:2048 lds
v_mfma_f32_16x16x32_bf16 v[108:111], a[248:251], a[180:183], v[108:111]
v_mfma_f32_16x16x32_bf16 v[108:111], a[252:255], a[196:199], v[108:111]
v_mfma_f32_16x16x32_bf16 v[100:103], a[252:255], a[192:195], v[100:103]
v_mfma_f32_16x16x32_bf16 v[100:103], a[248:251], a[176:179], v[100:103]
s_waitcnt lgkmcnt(4)
v_mfma_f32_16x16x32_bf16 v[128:131], a[80:83], a[208:211], v[128:131]
buffer_load_dwordx4 v28, s[32:35], s37 offen offset:3072 lds
v_mfma_f32_16x16x32_bf16 v[128:131], a[84:87], a[224:227], v[128:131]
s_add_u32 s37, s37, 589824
ds_read_b64_tr_b16 a[96:97], v17 offset:0
ds_read_b64_tr_b16 a[98:99], v17 offset:4096
v_mfma_f32_16x16x32_bf16 v[136:139], a[84:87], a[228:231], v[136:139]
ds_read_b64_tr_b16 a[100:101], v17 offset:8192
ds_read_b64_tr_b16 a[102:103], v17 offset:12288
v_mfma_f32_16x16x32_bf16 v[136:139], a[80:83], a[212:215], v[136:139]
v_mfma_f32_16x16x32_bf16 v[144:147], a[80:83], a[216:219], v[144:147]
v_mfma_f32_16x16x32_bf16 v[144:147], a[84:87], a[232:235], v[144:147]
buffer_load_dwordx4 a[176:179], v7, s[16:19], s38 offen offset:0 sc1
v_mfma_f32_16x16x32_bf16 v[152:155], a[84:87], a[236:239], v[152:155]
v_mfma_f32_16x16x32_bf16 v[152:155], a[80:83], a[220:223], v[152:155]
s_waitcnt lgkmcnt(4)
v_mfma_f32_16x16x32_bf16 v[156:159], a[88:91], a[220:223], v[156:159]
ds_read_b64_tr_b16 a[104:105], v17 offset:8
ds_read_b64_tr_b16 a[106:107], v17 offset:4104
v_mfma_f32_16x16x32_bf16 v[156:159], a[92:95], a[236:239], v[156:159]
ds_read_b64_tr_b16 a[108:109], v17 offset:8200
ds_read_b64_tr_b16 a[110:111], v17 offset:12296
v_mfma_f32_16x16x32_bf16 v[148:151], a[92:95], a[232:235], v[148:151]
buffer_load_dwordx4 a[180:183], v7, s[16:19], s38 offen offset:1024 sc1
v_mfma_f32_16x16x32_bf16 v[148:151], a[88:91], a[216:219], v[148:151]
v_mfma_f32_16x16x32_bf16 v[140:143], a[88:91], a[212:215], v[140:143]
v_mfma_f32_16x16x32_bf16 v[140:143], a[92:95], a[228:231], v[140:143]
v_mfma_f32_16x16x32_bf16 v[132:135], a[92:95], a[224:227], v[132:135]
v_mfma_f32_16x16x32_bf16 v[132:135], a[88:91], a[208:211], v[132:135]
s_waitcnt lgkmcnt(4)
buffer_load_dwordx4 a[184:187], v7, s[16:19], s38 offen offset:2048 sc1
v_mfma_f32_16x16x32_bf16 v[160:163], a[96:99], a[208:211], v[160:163]
ds_read_b64_tr_b16 a[240:241], v18 offset:0
ds_read_b64_tr_b16 a[242:243], v18 offset:4096
v_mfma_f32_16x16x32_bf16 v[160:163], a[100:103], a[224:227], v[160:163]
ds_read_b64_tr_b16 a[244:245], v18 offset:8192
ds_read_b64_tr_b16 a[246:247], v18 offset:12288
v_mfma_f32_16x16x32_bf16 v[168:171], a[100:103], a[228:231], v[168:171]
v_mfma_f32_16x16x32_bf16 v[168:171], a[96:99], a[212:215], v[168:171]
v_mfma_f32_16x16x32_bf16 v[176:179], a[96:99], a[216:219], v[176:179]
buffer_load_dwordx4 a[188:191], v7, s[16:19], s38 offen offset:3072 sc1
v_mfma_f32_16x16x32_bf16 v[176:179], a[100:103], a[232:235], v[176:179]
s_add_u32 s38, s38, 16384
v_mfma_f32_16x16x32_bf16 v[184:187], a[100:103], a[236:239], v[184:187]
v_mfma_f32_16x16x32_bf16 v[184:187], a[96:99], a[220:223], v[184:187]
s_waitcnt lgkmcnt(4)
v_mfma_f32_16x16x32_bf16 v[188:191], a[104:107], a[220:223], v[188:191]
ds_read_b64_tr_b16 a[248:249], v18 offset:8
ds_read_b64_tr_b16 a[250:251], v18 offset:4104
v_mfma_f32_16x16x32_bf16 v[188:191], a[108:111], a[236:239], v[188:191]
buffer_load_dwordx4 a[192:195], v7, s[16:19], s38 offen offset:0 sc1
v_mfma_f32_16x16x32_bf16 v[180:183], a[108:111], a[232:235], v[180:183]
ds_read_b64_tr_b16 a[252:253], v18 offset:8200
ds_read_b64_tr_b16 a[254:255], v18 offset:12296
v_mfma_f32_16x16x32_bf16 v[180:183], a[104:107], a[216:219], v[180:183]
v_mfma_f32_16x16x32_bf16 v[172:175], a[104:107], a[212:215], v[172:175]
v_mfma_f32_16x16x32_bf16 v[172:175], a[108:111], a[228:231], v[172:175]
v_mfma_f32_16x16x32_bf16 v[164:167], a[108:111], a[224:227], v[164:167]
buffer_load_dwordx4 a[196:199], v7, s[16:19], s38 offen offset:1024 sc1
v_mfma_f32_16x16x32_bf16 v[164:167], a[104:107], a[208:211], v[164:167]
s_waitcnt lgkmcnt(4)
v_mfma_f32_16x16x32_bf16 v[192:195], a[240:243], a[208:211], v[192:195]
ds_read_b64_tr_b16 a[80:81], v19 offset:0
ds_read_b64_tr_b16 a[82:83], v19 offset:4096
v_mfma_f32_16x16x32_bf16 v[192:195], a[244:247], a[224:227], v[192:195]
ds_read_b64_tr_b16 a[84:85], v19 offset:8192
ds_read_b64_tr_b16 a[86:87], v19 offset:12288
v_mfma_f32_16x16x32_bf16 v[200:203], a[244:247], a[228:231], v[200:203]
v_mfma_f32_16x16x32_bf16 v[200:203], a[240:243], a[212:215], v[200:203]
buffer_load_dwordx4 a[200:203], v7, s[16:19], s38 offen offset:2048 sc1
v_mfma_f32_16x16x32_bf16 v[208:211], a[240:243], a[216:219], v[208:211]
v_mfma_f32_16x16x32_bf16 v[208:211], a[244:247], a[232:235], v[208:211]
v_mfma_f32_16x16x32_bf16 v[216:219], a[244:247], a[236:239], v[216:219]
v_mfma_f32_16x16x32_bf16 v[216:219], a[240:243], a[220:223], v[216:219]
s_waitcnt lgkmcnt(4)
v_mfma_f32_16x16x32_bf16 v[220:223], a[248:251], a[220:223], v[220:223]
buffer_load_dwordx4 a[204:207], v7, s[16:19], s38 offen offset:3072 sc1
v_mfma_f32_16x16x32_bf16 v[220:223], a[252:255], a[236:239], v[220:223]
s_add_u32 s38, s38, 16384
ds_read_b64_tr_b16 a[88:89], v19 offset:8
ds_read_b64_tr_b16 a[90:91], v19 offset:4104
v_mfma_f32_16x16x32_bf16 v[212:215], a[252:255], a[232:235], v[212:215]
ds_read_b64_tr_b16 a[92:93], v19 offset:8200
ds_read_b64_tr_b16 a[94:95], v19 offset:12296
v_mfma_f32_16x16x32_bf16 v[212:215], a[248:251], a[216:219], v[212:215]
v_mfma_f32_16x16x32_bf16 v[204:207], a[248:251], a[212:215], v[204:207]
v_mfma_f32_16x16x32_bf16 v[204:207], a[252:255], a[228:231], v[204:207]
v_mfma_f32_16x16x32_bf16 v[196:199], a[252:255], a[224:227], v[196:199]
v_mfma_f32_16x16x32_bf16 v[196:199], a[248:251], a[208:211], v[196:199]
s_waitcnt lgkmcnt(4)
v_mfma_f32_16x16x32_bf16 v[224:227], a[80:83], a[208:211], v[224:227]
s_waitcnt vmcnt(40) lgkmcnt(0)
s_barrier
ds_read_b64_tr_b16 a[96:97], v8 offset:0
v_mfma_f32_16x16x32_bf16 v[224:227], a[84:87], a[224:227], v[224:227]
s_add_u32 m0, s24, 32768
ds_read_b64_tr_b16 a[98:99], v8 offset:4096
ds_read_b64_tr_b16 a[100:101], v8 offset:8192
v_mfma_f32_16x16x32_bf16 v[232:235], a[84:87], a[228:231], v[232:235]
buffer_load_dwordx4 v21, s[28:31], s36 offen offset:0 lds
v_mfma_f32_16x16x32_bf16 v[232:235], a[80:83], a[212:215], v[232:235]
ds_read_b64_tr_b16 a[102:103], v8 offset:12288
v_mfma_f32_16x16x32_bf16 v[240:243], a[80:83], a[216:219], v[240:243]
v_mfma_f32_16x16x32_bf16 v[240:243], a[84:87], a[232:235], v[240:243]
v_mfma_f32_16x16x32_bf16 v[248:251], a[84:87], a[236:239], v[248:251]
buffer_load_dwordx4 v22, s[28:31], s36 offen offset:1024 lds
v_mfma_f32_16x16x32_bf16 v[248:251], a[80:83], a[220:223], v[248:251]
s_waitcnt lgkmcnt(4)
v_mfma_f32_16x16x32_bf16 v[252:255], a[88:91], a[220:223], v[252:255]
ds_read_b64_tr_b16 a[104:105], v9 offset:0
ds_read_b64_tr_b16 a[106:107], v9 offset:4096
v_mfma_f32_16x16x32_bf16 v[252:255], a[92:95], a[236:239], v[252:255]
ds_read_b64_tr_b16 a[108:109], v9 offset:8192
ds_read_b64_tr_b16 a[110:111], v9 offset:12288
v_mfma_f32_16x16x32_bf16 v[244:247], a[92:95], a[232:235], v[244:247]
v_mfma_f32_16x16x32_bf16 v[244:247], a[88:91], a[216:219], v[244:247]
buffer_load_dwordx4 v23, s[28:31], s36 offen offset:2048 lds
v_mfma_f32_16x16x32_bf16 v[236:239], a[88:91], a[212:215], v[236:239]
v_mfma_f32_16x16x32_bf16 v[236:239], a[92:95], a[228:231], v[236:239]
v_mfma_f32_16x16x32_bf16 v[228:231], a[92:95], a[224:227], v[228:231]
v_mfma_f32_16x16x32_bf16 v[228:231], a[88:91], a[208:211], v[228:231]
s_waitcnt lgkmcnt(4)
v_mfma_f32_16x16x32_bf16 v[64:67], a[96:99], a[208:211], v[64:67]
buffer_load_dwordx4 v24, s[28:31], s36 offen offset:3072 lds
v_mfma_f32_16x16x32_bf16 v[64:67], a[100:103], a[224:227], v[64:67]
s_add_u32 s36, s36, 524288
ds_read_b64_tr_b16 a[240:241], v10 offset:0
ds_read_b64_tr_b16 a[242:243], v10 offset:4096
v_mfma_f32_16x16x32_bf16 v[72:75], a[100:103], a[228:231], v[72:75]
ds_read_b64_tr_b16 a[244:245], v10 offset:8192
ds_read_b64_tr_b16 a[246:247], v10 offset:12288
v_mfma_f32_16x16x32_bf16 v[72:75], a[96:99], a[212:215], v[72:75]
v_mfma_f32_16x16x32_bf16 v[80:83], a[96:99], a[216:219], v[80:83]
v_mfma_f32_16x16x32_bf16 v[80:83], a[100:103], a[232:235], v[80:83]
v_mfma_f32_16x16x32_bf16 v[88:91], a[100:103], a[236:239], v[88:91]
v_mfma_f32_16x16x32_bf16 v[88:91], a[96:99], a[220:223], v[88:91]
s_waitcnt lgkmcnt(4)
v_mfma_f32_16x16x32_bf16 v[92:95], a[104:107], a[220:223], v[92:95]
ds_read_b64_tr_b16 a[248:249], v11 offset:0
ds_read_b64_tr_b16 a[250:251], v11 offset:4096
v_mfma_f32_16x16x32_bf16 v[92:95], a[108:111], a[236:239], v[92:95]
ds_read_b64_tr_b16 a[252:253], v11 offset:8192
ds_read_b64_tr_b16 a[254:255], v11 offset:12288
v_mfma_f32_16x16x32_bf16 v[84:87], a[108:111], a[232:235], v[84:87]
v_mfma_f32_16x16x32_bf16 v[84:87], a[104:107], a[216:219], v[84:87]
v_mfma_f32_16x16x32_bf16 v[76:79], a[104:107], a[212:215], v[76:79]
v_mfma_f32_16x16x32_bf16 v[76:79], a[108:111], a[228:231], v[76:79]
v_mfma_f32_16x16x32_bf16 v[68:71], a[108:111], a[224:227], v[68:71]
v_mfma_f32_16x16x32_bf16 v[68:71], a[104:107], a[208:211], v[68:71]
s_waitcnt lgkmcnt(4)
v_mfma_f32_16x16x32_bf16 a[0:3], a[240:243], a[208:211], a[0:3]
ds_read_b64_tr_b16 a[80:81], v12 offset:0
ds_read_b64_tr_b16 a[82:83], v12 offset:4096
v_mfma_f32_16x16x32_bf16 a[0:3], a[244:247], a[224:227], a[0:3]
ds_read_b64_tr_b16 a[84:85], v12 offset:8192
ds_read_b64_tr_b16 a[86:87], v12 offset:12288
v_mfma_f32_16x16x32_bf16 a[8:11], a[244:247], a[228:231], a[8:11]
v_mfma_f32_16x16x32_bf16 a[8:11], a[240:243], a[212:215], a[8:11]
v_mfma_f32_16x16x32_bf16 a[16:19], a[240:243], a[216:219], a[16:19]
v_mfma_f32_16x16x32_bf16 a[16:19], a[244:247], a[232:235], a[16:19]
v_mfma_f32_16x16x32_bf16 a[24:27], a[244:247], a[236:239], a[24:27]
v_mfma_f32_16x16x32_bf16 a[24:27], a[240:243], a[220:223], a[24:27]
s_waitcnt lgkmcnt(4)
s_add_u32 m0, s24, 0
v_mfma_f32_16x16x32_bf16 a[28:31], a[248:251], a[220:223], a[28:31]
buffer_load_dwordx4 v30, s[8:11], s20 offen offset:0 lds
v_mfma_f32_16x16x32_bf16 a[28:31], a[252:255], a[236:239], a[28:31]
ds_read_b64_tr_b16 a[88:89], v13 offset:0
ds_read_b64_tr_b16 a[90:91], v13 offset:4096
v_mfma_f32_16x16x32_bf16 a[20:23], a[252:255], a[232:235], a[20:23]
ds_read_b64_tr_b16 a[92:93], v13 offset:8192
ds_read_b64_tr_b16 a[94:95], v13 offset:12288
v_mfma_f32_16x16x32_bf16 a[20:23], a[248:251], a[216:219], a[20:23]
v_mfma_f32_16x16x32_bf16 a[12:15], a[248:251], a[212:215], a[12:15]
buffer_load_dwordx4 v31, s[8:11], s20 offen offset:1024 lds
v_mfma_f32_16x16x32_bf16 a[12:15], a[252:255], a[228:231], a[12:15]
v_mfma_f32_16x16x32_bf16 a[4:7], a[252:255], a[224:227], a[4:7]
v_mfma_f32_16x16x32_bf16 a[4:7], a[248:251], a[208:211], a[4:7]
s_waitcnt lgkmcnt(4)
v_mfma_f32_16x16x32_bf16 a[32:35], a[80:83], a[208:211], a[32:35]
ds_read_b64_tr_b16 a[96:97], v14 offset:0
ds_read_b64_tr_b16 a[98:99], v14 offset:4096
v_mfma_f32_16x16x32_bf16 a[32:35], a[84:87], a[224:227], a[32:35]
buffer_load_dwordx4 v32, s[8:11], s20 offen offset:2048 lds
v_mfma_f32_16x16x32_bf16 a[40:43], a[84:87], a[228:231], a[40:43]
ds_read_b64_tr_b16 a[100:101], v14 offset:8192
ds_read_b64_tr_b16 a[102:103], v14 offset:12288
v_mfma_f32_16x16x32_bf16 a[40:43], a[80:83], a[212:215], a[40:43]
v_mfma_f32_16x16x32_bf16 a[48:51], a[80:83], a[216:219], a[48:51]
v_mfma_f32_16x16x32_bf16 a[48:51], a[84:87], a[232:235], a[48:51]
v_mfma_f32_16x16x32_bf16 a[56:59], a[84:87], a[236:239], a[56:59]
buffer_load_dwordx4 v33, s[8:11], s20 offen offset:3072 lds
v_mfma_f32_16x16x32_bf16 a[56:59], a[80:83], a[220:223], a[56:59]
s_waitcnt lgkmcnt(4)
s_add_u32 s20, s20, 16384
v_mfma_f32_16x16x32_bf16 a[60:63], a[88:91], a[220:223], a[60:63]
ds_read_b64_tr_b16 a[104:105], v15 offset:0
ds_read_b64_tr_b16 a[106:107], v15 offset:4096
v_mfma_f32_16x16x32_bf16 a[60:63], a[92:95], a[236:239], a[60:63]
ds_read_b64_tr_b16 a[108:109], v15 offset:8192
ds_read_b64_tr_b16 a[110:111], v15 offset:12288
v_mfma_f32_16x16x32_bf16 a[52:55], a[92:95], a[232:235], a[52:55]
v_mfma_f32_16x16x32_bf16 a[52:55], a[88:91], a[216:219], a[52:55]
v_mfma_f32_16x16x32_bf16 a[44:47], a[88:91], a[212:215], a[44:47]
v_mfma_f32_16x16x32_bf16 a[44:47], a[92:95], a[228:231], a[44:47]
v_mfma_f32_16x16x32_bf16 a[36:39], a[92:95], a[224:227], a[36:39]
v_mfma_f32_16x16x32_bf16 a[36:39], a[88:91], a[208:211], a[36:39]
s_waitcnt lgkmcnt(4)
v_mfma_f32_16x16x32_bf16 v[96:99], a[96:99], a[208:211], v[96:99]
s_waitcnt vmcnt(36) lgkmcnt(0)
s_barrier
ds_read_b64_tr_b16 a[240:241], v16 offset:16384
v_mfma_f32_16x16x32_bf16 v[96:99], a[100:103], a[224:227], v[96:99]
s_add_u32 m0, s24, 114688
ds_read_b64_tr_b16 a[242:243], v16 offset:20480
ds_read_b64_tr_b16 a[244:245], v16 offset:24576
v_mfma_f32_16x16x32_bf16 v[104:107], a[100:103], a[228:231], v[104:107]
buffer_load_dwordx4 v25, s[32:35], s37 offen offset:0 lds
v_mfma_f32_16x16x32_bf16 v[104:107], a[96:99], a[212:215], v[104:107]
ds_read_b64_tr_b16 a[246:247], v16 offset:28672
v_mfma_f32_16x16x32_bf16 v[112:115], a[96:99], a[216:219], v[112:115]
v_mfma_f32_16x16x32_bf16 v[112:115], a[100:103], a[232:235], v[112:115]
v_mfma_f32_16x16x32_bf16 v[120:123], a[100:103], a[236:239], v[120:123]
buffer_load_dwordx4 v26, s[32:35], s37 offen offset:1024 lds
v_mfma_f32_16x16x32_bf16 v[120:123], a[96:99], a[220:223], v[120:123]
s_waitcnt lgkmcnt(4)
v_mfma_f32_16x16x32_bf16 v[124:127], a[104:107], a[220:223], v[124:127]
ds_read_b64_tr_b16 a[248:249], v16 offset:16392
ds_read_b64_tr_b16 a[250:251], v16 offset:20488
v_mfma_f32_16x16x32_bf16 v[124:127], a[108:111], a[236:239], v[124:127]
ds_read_b64_tr_b16 a[252:253], v16 offset:24584
ds_read_b64_tr_b16 a[254:255], v16 offset:28680
v_mfma_f32_16x16x32_bf16 v[116:119], a[108:111], a[232:235], v[116:119]
v_mfma_f32_16x16x32_bf16 v[116:119], a[104:107], a[216:219], v[116:119]
buffer_load_dwordx4 v27, s[32:35], s37 offen offset:2048 lds
v_mfma_f32_16x16x32_bf16 v[108:111], a[104:107], a[212:215], v[108:111]
v_mfma_f32_16x16x32_bf16 v[108:111], a[108:111], a[228:231], v[108:111]
v_mfma_f32_16x16x32_bf16 v[100:103], a[108:111], a[224:227], v[100:103]
v_mfma_f32_16x16x32_bf16 v[100:103], a[104:107], a[208:211], v[100:103]
s_waitcnt lgkmcnt(4)
v_mfma_f32_16x16x32_bf16 v[128:131], a[240:243], a[112:115], v[128:131]
buffer_load_dwordx4 a[208:211], v7, s[16:19], s38 offen offset:0 sc1
v_mfma_f32_16x16x32_bf16 v[128:131], a[244:247], a[128:131], v[128:131]
ds_read_b64_tr_b16 a[80:81], v17 offset:16384
ds_read_b64_tr_b16 a[82:83], v17 offset:20480
v_mfma_f32_16x16x32_bf16 v[136:139], a[244:247], a[132:135], v[136:139]
ds_read_b64_tr_b16 a[84:85], v17 offset:24576
ds_read_b64_tr_b16 a[86:87], v17 offset:28672
v_mfma_f32_16x16x32_bf16 v[136:139], a[240:243], a[116:119], v[136:139]
v_mfma_f32_16x16x32_bf16 v[144:147], a[240:243], a[120:123], v[144:147]
v_mfma_f32_16x16x32_bf16 v[144:147], a[244:247], a[136:139], v[144:147]
buffer_load_dwordx4 a[212:215], v7, s[16:19], s38 offen offset:1024 sc1
v_mfma_f32_16x16x32_bf16 v[152:155], a[244:247], a[140:143], v[152:155]
v_mfma_f32_16x16x32_bf16 v[152:155], a[240:243], a[124:127], v[152:155]
s_waitcnt lgkmcnt(4)
v_mfma_f32_16x16x32_bf16 v[156:159], a[248:251], a[124:127], v[156:159]
ds_read_b64_tr_b16 a[88:89], v17 offset:16392
ds_read_b64_tr_b16 a[90:91], v17 offset:20488
v_mfma_f32_16x16x32_bf16 v[156:159], a[252:255], a[140:143], v[156:159]
ds_read_b64_tr_b16 a[92:93], v17 offset:24584
ds_read_b64_tr_b16 a[94:95], v17 offset:28680
v_mfma_f32_16x16x32_bf16 v[148:151], a[252:255], a[136:139], v[148:151]
buffer_load_dwordx4 a[216:219], v7, s[16:19], s38 offen offset:2048 sc1
v_mfma_f32_16x16x32_bf16 v[148:151], a[248:251], a[120:123], v[148:151]
v_mfma_f32_16x16x32_bf16 v[140:143], a[248:251], a[116:119], v[140:143]
v_mfma_f32_16x16x32_bf16 v[140:143], a[252:255], a[132:135], v[140:143]
v_mfma_f32_16x16x32_bf16 v[132:135], a[252:255], a[128:131], v[132:135]
v_mfma_f32_16x16x32_bf16 v[132:135], a[248:251], a[112:115], v[132:135]
s_waitcnt lgkmcnt(4)
buffer_load_dwordx4 a[220:223], v7, s[16:19], s38 offen offset:3072 sc1
v_mfma_f32_16x16x32_bf16 v[160:163], a[80:83], a[112:115], v[160:163]
s_add_u32 s38, s38, 16384
ds_read_b64_tr_b16 a[96:97], v18 offset:16384
ds_read_b64_tr_b16 a[98:99], v18 offset:20480
v_mfma_f32_16x16x32_bf16 v[160:163], a[84:87], a[128:131], v[160:163]
ds_read_b64_tr_b16 a[100:101], v18 offset:24576
ds_read_b64_tr_b16 a[102:103], v18 offset:28672
v_mfma_f32_16x16x32_bf16 v[168:171], a[84:87], a[132:135], v[168:171]
v_mfma_f32_16x16x32_bf16 v[168:171], a[80:83], a[116:119], v[168:171]
v_mfma_f32_16x16x32_bf16 v[176:179], a[80:83], a[120:123], v[176:179]
buffer_load_dwordx4 a[224:227], v7, s[16:19], s38 offen offset:0 sc1
v_mfma_f32_16x16x32_bf16 v[176:179], a[84:87], a[136:139], v[176:179]
v_mfma_f32_16x16x32_bf16 v[184:187], a[84:87], a[140:143], v[184:187]
v_mfma_f32_16x16x32_bf16 v[184:187], a[80:83], a[124:127], v[184:187]
s_waitcnt lgkmcnt(4)
v_mfma_f32_16x16x32_bf16 v[188:191], a[88:91], a[124:127], v[188:191]
ds_read_b64_tr_b16 a[104:105], v18 offset:16392
ds_read_b64_tr_b16 a[106:107], v18 offset:20488
v_mfma_f32_16x16x32_bf16 v[188:191], a[92:95], a[140:143], v[188:191]
buffer_load_dwordx4 a[228:231], v7, s[16:19], s38 offen offset:1024 sc1
v_mfma_f32_16x16x32_bf16 v[180:183], a[92:95], a[136:139], v[180:183]
ds_read_b64_tr_b16 a[108:109], v18 offset:24584
ds_read_b64_tr_b16 a[110:111], v18 offset:28680
v_mfma_f32_16x16x32_bf16 v[180:183], a[88:91], a[120:123], v[180:183]
v_mfma_f32_16x16x32_bf16 v[172:175], a[88:91], a[116:119], v[172:175]
v_mfma_f32_16x16x32_bf16 v[172:175], a[92:95], a[132:135], v[172:175]
v_mfma_f32_16x16x32_bf16 v[164:167], a[92:95], a[128:131], v[164:167]
buffer_load_dwordx4 a[232:235], v7, s[16:19], s38 offen offset:2048 sc1
v_mfma_f32_16x16x32_bf16 v[164:167], a[88:91], a[112:115], v[164:167]
s_waitcnt lgkmcnt(4)
v_mfma_f32_16x16x32_bf16 v[192:195], a[96:99], a[112:115], v[192:195]
ds_read_b64_tr_b16 a[240:241], v19 offset:16384
ds_read_b64_tr_b16 a[242:243], v19 offset:20480
v_mfma_f32_16x16x32_bf16 v[192:195], a[100:103], a[128:131], v[192:195]
ds_read_b64_tr_b16 a[244:245], v19 offset:24576
ds_read_b64_tr_b16 a[246:247], v19 offset:28672
v_mfma_f32_16x16x32_bf16 v[200:203], a[100:103], a[132:135], v[200:203]
v_mfma_f32_16x16x32_bf16 v[200:203], a[96:99], a[116:119], v[200:203]
buffer_load_dwordx4 a[236:239], v7, s[16:19], s38 offen offset:3072 sc1
v_mfma_f32_16x16x32_bf16 v[208:211], a[96:99], a[120:123], v[208:211]
s_add_u32 s38, s38, 16384
v_mfma_f32_16x16x32_bf16 v[208:211], a[100:103], a[136:139], v[208:211]
v_mfma_f32_16x16x32_bf16 v[216:219], a[100:103], a[140:143], v[216:219]
v_mfma_f32_16x16x32_bf16 v[216:219], a[96:99], a[124:127], v[216:219]
s_waitcnt lgkmcnt(4)
v_mfma_f32_16x16x32_bf16 v[220:223], a[104:107], a[124:127], v[220:223]
buffer_load_dwordx4 v28, s[32:35], s37 offen offset:3072 lds
v_mfma_f32_16x16x32_bf16 v[220:223], a[108:111], a[140:143], v[220:223]
s_add_u32 s37, s37, 589824
ds_read_b64_tr_b16 a[248:249], v19 offset:16392
ds_read_b64_tr_b16 a[250:251], v19 offset:20488
v_mfma_f32_16x16x32_bf16 v[212:215], a[108:111], a[136:139], v[212:215]
ds_read_b64_tr_b16 a[252:253], v19 offset:24584
ds_read_b64_tr_b16 a[254:255], v19 offset:28680
v_mfma_f32_16x16x32_bf16 v[212:215], a[104:107], a[120:123], v[212:215]
v_mfma_f32_16x16x32_bf16 v[204:207], a[104:107], a[116:119], v[204:207]
v_mfma_f32_16x16x32_bf16 v[204:207], a[108:111], a[132:135], v[204:207]
v_mfma_f32_16x16x32_bf16 v[196:199], a[108:111], a[128:131], v[196:199]
v_mfma_f32_16x16x32_bf16 v[196:199], a[104:107], a[112:115], v[196:199]
s_waitcnt lgkmcnt(4)
v_mfma_f32_16x16x32_bf16 v[224:227], a[240:243], a[112:115], v[224:227]
s_waitcnt vmcnt(44) lgkmcnt(0)
s_barrier
ds_read_b64_tr_b16 a[80:81], v8 offset:16384
v_mfma_f32_16x16x32_bf16 v[224:227], a[244:247], a[128:131], v[224:227]
s_add_u32 m0, s24, 49152
ds_read_b64_tr_b16 a[82:83], v8 offset:20480
ds_read_b64_tr_b16 a[84:85], v8 offset:24576
v_mfma_f32_16x16x32_bf16 v[232:235], a[244:247], a[132:135], v[232:235]
buffer_load_dwordx4 v21, s[28:31], s36 offen offset:0 lds
v_mfma_f32_16x16x32_bf16 v[232:235], a[240:243], a[116:119], v[232:235]
ds_read_b64_tr_b16 a[86:87], v8 offset:28672
v_mov_b32 v1, 0
v_mfma_f32_16x16x32_bf16 v[240:243], a[240:243], a[120:123], v[240:243]
v_min_u32 v2, 1, v0
v_lshlrev_b32 v2, 28, v2
v_mfma_f32_16x16x32_bf16 v[240:243], a[244:247], a[136:139], v[240:243]
v_mfma_f32_16x16x32_bf16 v[248:251], a[244:247], a[140:143], v[248:251]
buffer_store_dword v1, v2, s[16:19], s4 offen sc1
v_mfma_f32_16x16x32_bf16 v[248:251], a[240:243], a[124:127], v[248:251]
s_waitcnt lgkmcnt(4)
v_mfma_f32_16x16x32_bf16 v[252:255], a[248:251], a[124:127], v[252:255]
buffer_load_dwordx4 v22, s[28:31], s36 offen offset:1024 lds
v_mfma_f32_16x16x32_bf16 v[252:255], a[252:255], a[140:143], v[252:255]
ds_read_b64_tr_b16 a[88:89], v9 offset:16384
ds_read_b64_tr_b16 a[90:91], v9 offset:20480
v_mfma_f32_16x16x32_bf16 v[244:247], a[252:255], a[136:139], v[244:247]
ds_read_b64_tr_b16 a[92:93], v9 offset:24576
ds_read_b64_tr_b16 a[94:95], v9 offset:28672
v_mfma_f32_16x16x32_bf16 v[244:247], a[248:251], a[120:123], v[244:247]
v_mfma_f32_16x16x32_bf16 v[236:239], a[248:251], a[116:119], v[236:239]
v_mfma_f32_16x16x32_bf16 v[236:239], a[252:255], a[132:135], v[236:239]
buffer_store_dword v1, v2, s[16:19], s6 offen sc1
v_mfma_f32_16x16x32_bf16 v[228:231], a[252:255], a[128:131], v[228:231]
s_or_b32 s49, s25, s23
s_lshl_b32 s49, s49, 3
s_add_u32 s49, s49, s26
v_mfma_f32_16x16x32_bf16 v[228:231], a[248:251], a[112:115], v[228:231]
s_waitcnt lgkmcnt(4)
buffer_load_dwordx4 v23, s[28:31], s36 offen offset:2048 lds
v_mfma_f32_16x16x32_bf16 v[64:67], a[80:83], a[112:115], v[64:67]
s_lshl_b32 s49, s49, 5
ds_read_b64_tr_b16 a[96:97], v10 offset:16384
ds_read_b64_tr_b16 a[98:99], v10 offset:20480
v_mfma_f32_16x16x32_bf16 v[64:67], a[84:87], a[128:131], v[64:67]
ds_read_b64_tr_b16 a[100:101], v10 offset:24576
ds_read_b64_tr_b16 a[102:103], v10 offset:28672
v_mfma_f32_16x16x32_bf16 v[72:75], a[84:87], a[132:135], v[72:75]
v_mfma_f32_16x16x32_bf16 v[72:75], a[80:83], a[116:119], v[72:75]
v_mfma_f32_16x16x32_bf16 v[80:83], a[80:83], a[120:123], v[80:83]
buffer_load_dwordx4 v24, s[28:31], s36 offen offset:3072 lds
v_mfma_f32_16x16x32_bf16 v[80:83], a[84:87], a[136:139], v[80:83]
s_add_u32 s36, s36, 524288
v_mfma_f32_16x16x32_bf16 v[88:91], a[84:87], a[140:143], v[88:91]
v_mfma_f32_16x16x32_bf16 v[88:91], a[80:83], a[124:127], v[88:91]
s_waitcnt lgkmcnt(4)
v_mfma_f32_16x16x32_bf16 v[92:95], a[88:91], a[124:127], v[92:95]
s_add_u32 m0, s24, 16384
ds_read_b64_tr_b16 a[104:105], v11 offset:16384
ds_read_b64_tr_b16 a[106:107], v11 offset:20480
v_mfma_f32_16x16x32_bf16 v[92:95], a[92:95], a[140:143], v[92:95]
buffer_load_dwordx4 v30, s[8:11], s20 offen offset:0 lds
v_mfma_f32_16x16x32_bf16 v[84:87], a[92:95], a[136:139], v[84:87]
ds_read_b64_tr_b16 a[108:109], v11 offset:24576
ds_read_b64_tr_b16 a[110:111], v11 offset:28672
v_mfma_f32_16x16x32_bf16 v[84:87], a[88:91], a[120:123], v[84:87]
v_mfma_f32_16x16x32_bf16 v[76:79], a[88:91], a[116:119], v[76:79]
v_mfma_f32_16x16x32_bf16 v[76:79], a[92:95], a[132:135], v[76:79]
v_mfma_f32_16x16x32_bf16 v[68:71], a[92:95], a[128:131], v[68:71]
buffer_load_dwordx4 v31, s[8:11], s20 offen offset:1024 lds
v_mfma_f32_16x16x32_bf16 v[68:71], a[88:91], a[112:115], v[68:71]
s_waitcnt lgkmcnt(4)
v_mfma_f32_16x16x32_bf16 a[0:3], a[96:99], a[112:115], a[0:3]
ds_read_b64_tr_b16 a[240:241], v12 offset:16384
ds_read_b64_tr_b16 a[242:243], v12 offset:20480
v_mfma_f32_16x16x32_bf16 a[0:3], a[100:103], a[128:131], a[0:3]
ds_read_b64_tr_b16 a[244:245], v12 offset:24576
ds_read_b64_tr_b16 a[246:247], v12 offset:28672
v_mfma_f32_16x16x32_bf16 a[8:11], a[100:103], a[132:135], a[8:11]
v_mfma_f32_16x16x32_bf16 a[8:11], a[96:99], a[116:119], a[8:11]
buffer_load_dwordx4 v32, s[8:11], s20 offen offset:2048 lds
v_mfma_f32_16x16x32_bf16 a[16:19], a[96:99], a[120:123], a[16:19]
v_mfma_f32_16x16x32_bf16 a[16:19], a[100:103], a[136:139], a[16:19]
v_mfma_f32_16x16x32_bf16 a[24:27], a[100:103], a[140:143], a[24:27]
v_mfma_f32_16x16x32_bf16 a[24:27], a[96:99], a[124:127], a[24:27]
s_waitcnt lgkmcnt(4)
v_mfma_f32_16x16x32_bf16 a[28:31], a[104:107], a[124:127], a[28:31]
buffer_load_dwordx4 v33, s[8:11], s20 offen offset:3072 lds
v_mfma_f32_16x16x32_bf16 a[28:31], a[108:111], a[140:143], a[28:31]
s_add_u32 s20, s20, 16384
ds_read_b64_tr_b16 a[248:249], v13 offset:16384
ds_read_b64_tr_b16 a[250:251], v13 offset:20480
v_mfma_f32_16x16x32_bf16 a[20:23], a[108:111], a[136:139], a[20:23]
ds_read_b64_tr_b16 a[252:253], v13 offset:24576
ds_read_b64_tr_b16 a[254:255], v13 offset:28672
v_mfma_f32_16x16x32_bf16 a[20:23], a[104:107], a[120:123], a[20:23]
v_mfma_f32_16x16x32_bf16 a[12:15], a[104:107], a[116:119], a[12:15]
v_mfma_f32_16x16x32_bf16 a[12:15], a[108:111], a[132:135], a[12:15]
buffer_store_dword v1, v2, s[56:59], s49 offen offset:4 sc1
v_mfma_f32_16x16x32_bf16 a[4:7], a[108:111], a[128:131], a[4:7]
v_mfma_f32_16x16x32_bf16 a[4:7], a[104:107], a[112:115], a[4:7]
s_waitcnt lgkmcnt(4)
v_mfma_f32_16x16x32_bf16 a[32:35], a[240:243], a[112:115], a[32:35]
ds_read_b64_tr_b16 a[80:81], v14 offset:16384
ds_read_b64_tr_b16 a[82:83], v14 offset:20480
v_mfma_f32_16x16x32_bf16 a[32:35], a[244:247], a[128:131], a[32:35]
ds_read_b64_tr_b16 a[84:85], v14 offset:24576
ds_read_b64_tr_b16 a[86:87], v14 offset:28672
v_mfma_f32_16x16x32_bf16 a[40:43], a[244:247], a[132:135], a[40:43]
v_mfma_f32_16x16x32_bf16 a[40:43], a[240:243], a[116:119], a[40:43]
v_mfma_f32_16x16x32_bf16 a[48:51], a[240:243], a[120:123], a[48:51]
v_mfma_f32_16x16x32_bf16 a[48:51], a[244:247], a[136:139], a[48:51]
v_mfma_f32_16x16x32_bf16 a[56:59], a[244:247], a[140:143], a[56:59]
v_mfma_f32_16x16x32_bf16 a[56:59], a[240:243], a[124:127], a[56:59]
s_waitcnt lgkmcnt(4)
v_mfma_f32_16x16x32_bf16 a[60:63], a[248:251], a[124:127], a[60:63]
ds_read_b64_tr_b16 a[88:89], v15 offset:16384
ds_read_b64_tr_b16 a[90:91], v15 offset:20480
v_mfma_f32_16x16x32_bf16 a[60:63], a[252:255], a[140:143], a[60:63]
ds_read_b64_tr_b16 a[92:93], v15 offset:24576
ds_read_b64_tr_b16 a[94:95], v15 offset:28672
v_mfma_f32_16x16x32_bf16 a[52:55], a[252:255], a[136:139], a[52:55]
v_mfma_f32_16x16x32_bf16 a[52:55], a[248:251], a[120:123], a[52:55]
v_mfma_f32_16x16x32_bf16 a[44:47], a[248:251], a[116:119], a[44:47]
v_mfma_f32_16x16x32_bf16 a[44:47], a[252:255], a[132:135], a[44:47]
v_mfma_f32_16x16x32_bf16 a[36:39], a[252:255], a[128:131], a[36:39]
v_mfma_f32_16x16x32_bf16 a[36:39], a[248:251], a[112:115], a[36:39]
s_waitcnt lgkmcnt(4)
v_mfma_f32_16x16x32_bf16 v[96:99], a[80:83], a[112:115], v[96:99]
s_waitcnt vmcnt(43) lgkmcnt(0)
s_barrier
ds_read_b64_tr_b16 a[96:97], v16 offset:32768
v_mfma_f32_16x16x32_bf16 v[96:99], a[84:87], a[128:131], v[96:99]
s_add_u32 m0, s24, 131072
ds_read_b64_tr_b16 a[98:99], v16 offset:36864
ds_read_b64_tr_b16 a[100:101], v16 offset:40960
v_mfma_f32_16x16x32_bf16 v[104:107], a[84:87], a[132:135], v[104:107]
buffer_load_dwordx4 v25, s[32:35], s37 offen offset:0 lds
v_mfma_f32_16x16x32_bf16 v[104:107], a[80:83], a[116:119], v[104:107]
ds_read_b64_tr_b16 a[102:103], v16 offset:45056
v_mfma_f32_16x16x32_bf16 v[112:115], a[80:83], a[120:123], v[112:115]
v_mfma_f32_16x16x32_bf16 v[112:115], a[84:87], a[136:139], v[112:115]
v_mfma_f32_16x16x32_bf16 v[120:123], a[84:87], a[140:143], v[120:123]
buffer_load_dwordx4 v26, s[32:35], s37 offen offset:1024 lds
v_mfma_f32_16x16x32_bf16 v[120:123], a[80:83], a[124:127], v[120:123]
s_waitcnt lgkmcnt(4)
v_mfma_f32_16x16x32_bf16 v[124:127], a[88:91], a[124:127], v[124:127]
ds_read_b64_tr_b16 a[104:105], v16 offset:32776
ds_read_b64_tr_b16 a[106:107], v16 offset:36872
v_mfma_f32_16x16x32_bf16 v[124:127], a[92:95], a[140:143], v[124:127]
ds_read_b64_tr_b16 a[108:109], v16 offset:40968
ds_read_b64_tr_b16 a[110:111], v16 offset:45064
v_mfma_f32_16x16x32_bf16 v[116:119], a[92:95], a[136:139], v[116:119]
v_mfma_f32_16x16x32_bf16 v[116:119], a[88:91], a[120:123], v[116:119]
buffer_load_dwordx4 v27, s[32:35], s37 offen offset:2048 lds
v_mfma_f32_16x16x32_bf16 v[108:111], a[88:91], a[116:119], v[108:111]
v_mfma_f32_16x16x32_bf16 v[108:111], a[92:95], a[132:135], v[108:111]
v_mfma_f32_16x16x32_bf16 v[100:103], a[92:95], a[128:131], v[100:103]
v_mfma_f32_16x16x32_bf16 v[100:103], a[88:91], a[112:115], v[100:103]
s_waitcnt lgkmcnt(4)
v_mfma_f32_16x16x32_bf16 v[128:131], a[96:99], a[144:147], v[128:131]
buffer_load_dwordx4 a[112:115], v7, s[16:19], s38 offen offset:0 sc1
v_mfma_f32_16x16x32_bf16 v[128:131], a[100:103], a[160:163], v[128:131]
ds_read_b64_tr_b16 a[240:241], v17 offset:32768
ds_read_b64_tr_b16 a[242:243], v17 offset:36864
v_mfma_f32_16x16x32_bf16 v[136:139], a[100:103], a[164:167], v[136:139]
ds_read_b64_tr_b16 a[244:245], v17 offset:40960
ds_read_b64_tr_b16 a[246:247], v17 offset:45056
v_mfma_f32_16x16x32_bf16 v[136:139], a[96:99], a[148:151], v[136:139]
v_mfma_f32_16x16x32_bf16 v[144:147], a[96:99], a[152:155], v[144:147]
v_mfma_f32_16x16x32_bf16 v[144:147], a[100:103], a[168:171], v[144:147]
buffer_load_dwordx4 a[116:119], v7, s[16:19], s38 offen offset:1024 sc1
v_mfma_f32_16x16x32_bf16 v[152:155], a[100:103], a[172:175], v[152:155]
v_mfma_f32_16x16x32_bf16 v[152:155], a[96:99], a[156:159], v[152:155]
s_waitcnt lgkmcnt(4)
v_mfma_f32_16x16x32_bf16 v[156:159], a[104:107], a[156:159], v[156:159]
ds_read_b64_tr_b16 a[248:249], v17 offset:32776
ds_read_b64_tr_b16 a[250:251], v17 offset:36872
v_mfma_f32_16x16x32_bf16 v[156:159], a[108:111], a[172:175], v[156:159]
ds_read_b64_tr_b16 a[252:253], v17 offset:40968
ds_read_b64_tr_b16 a[254:255], v17 offset:45064
v_mfma_f32_16x16x32_bf16 v[148:151], a[108:111], a[168:171], v[148:151]
buffer_load_dwordx4 a[120:123], v7, s[16:19], s38 offen offset:2048 sc1
v_mfma_f32_16x16x32_bf16 v[148:151], a[104:107], a[152:155], v[148:151]
v_mfma_f32_16x16x32_bf16 v[140:143], a[104:107], a[148:151], v[140:143]
v_mfma_f32_16x16x32_bf16 v[140:143], a[108:111], a[164:167], v[140:143]
v_mfma_f32_16x16x32_bf16 v[132:135], a[108:111], a[160:163], v[132:135]
v_mfma_f32_16x16x32_bf16 v[132:135], a[104:107], a[144:147], v[132:135]
s_waitcnt lgkmcnt(4)
buffer_load_dwordx4 a[124:127], v7, s[16:19], s38 offen offset:3072 sc1
v_mfma_f32_16x16x32_bf16 v[160:163], a[240:243], a[144:147], v[160:163]
s_add_u32 s38, s38, 16384
ds_read_b64_tr_b16 a[80:81], v18 offset:32768
ds_read_b64_tr_b16 a[82:83], v18 offset:36864
v_mfma_f32_16x16x32_bf16 v[160:163], a[244:247], a[160:163], v[160:163]
ds_read_b64_tr_b16 a[84:85], v18 offset:40960
ds_read_b64_tr_b16 a[86:87], v18 offset:45056
v_mfma_f32_16x16x32_bf16 v[168:171], a[244:247], a[164:167], v[168:171]
v_mfma_f32_16x16x32_bf16 v[168:171], a[240:243], a[148:151], v[168:171]
v_mfma_f32_16x16x32_bf16 v[176:179], a[240:243], a[152:155], v[176:179]
buffer_load_dwordx4 a[128:131], v7, s[16:19], s38 offen offset:0 sc1
v_mfma_f32_16x16x32_bf16 v[176:179], a[244:247], a[168:171], v[176:179]
v_mfma_f32_16x16x32_bf16 v[184:187], a[244:247], a[172:175], v[184:187]
v_mfma_f32_16x16x32_bf16 v[184:187], a[240:243], a[156:159], v[184:187]
s_waitcnt lgkmcnt(4)
v_mfma_f32_16x16x32_bf16 v[188:191], a[248:251], a[156:159], v[188:191]
ds_read_b64_tr_b16 a[88:89], v18 offset:32776
ds_read_b64_tr_b16 a[90:91], v18 offset:36872
v_mfma_f32_16x16x32_bf16 v[188:191], a[252:255], a[172:175], v[188:191]
buffer_load_dwordx4 a[132:135], v7, s[16:19], s38 offen offset:1024 sc1
v_mfma_f32_16x16x32_bf16 v[180:183], a[252:255], a[168:171], v[180:183]
ds_read_b64_tr_b16 a[92:93], v18 offset:40968
ds_read_b64_tr_b16 a[94:95], v18 offset:45064
v_mfma_f32_16x16x32_bf16 v[180:183], a[248:251], a[152:155], v[180:183]
v_mfma_f32_16x16x32_bf16 v[172:175], a[248:251], a[148:151], v[172:175]
v_mfma_f32_16x16x32_bf16 v[172:175], a[252:255], a[164:167], v[172:175]
v_mfma_f32_16x16x32_bf16 v[164:167], a[252:255], a[160:163], v[164:167]
buffer_load_dwordx4 a[136:139], v7, s[16:19], s38 offen offset:2048 sc1
v_mfma_f32_16x16x32_bf16 v[164:167], a[248:251], a[144:147], v[164:167]
s_waitcnt lgkmcnt(4)
v_mfma_f32_16x16x32_bf16 v[192:195], a[80:83], a[144:147], v[192:195]
ds_read_b64_tr_b16 a[96:97], v19 offset:32768
ds_read_b64_tr_b16 a[98:99], v19 offset:36864
v_mfma_f32_16x16x32_bf16 v[192:195], a[84:87], a[160:163], v[192:195]
ds_read_b64_tr_b16 a[100:101], v19 offset:40960
ds_read_b64_tr_b16 a[102:103], v19 offset:45056
v_mfma_f32_16x16x32_bf16 v[200:203], a[84:87], a[164:167], v[200:203]
v_mfma_f32_16x16x32_bf16 v[200:203], a[80:83], a[148:151], v[200:203]
buffer_load_dwordx4 v28, s[32:35], s37 offen offset:3072 lds
v_mfma_f32_16x16x32_bf16 v[208:211], a[80:83], a[152:155], v[208:211]
s_add_u32 s37, s37, 589824
v_mfma_f32_16x16x32_bf16 v[208:211], a[84:87], a[168:171], v[208:211]
v_mfma_f32_16x16x32_bf16 v[216:219], a[84:87], a[172:175], v[216:219]
v_mfma_f32_16x16x32_bf16 v[216:219], a[80:83], a[156:159], v[216:219]
s_waitcnt lgkmcnt(4)
v_mfma_f32_16x16x32_bf16 v[220:223], a[88:91], a[156:159], v[220:223]
buffer_load_dwordx4 a[140:143], v7, s[16:19], s38 offen offset:3072 sc1
v_mfma_f32_16x16x32_bf16 v[220:223], a[92:95], a[172:175], v[220:223]
s_add_u32 s38, s38, 16384
ds_read_b64_tr_b16 a[104:105], v19 offset:32776
ds_read_b64_tr_b16 a[106:107], v19 offset:36872
v_mfma_f32_16x16x32_bf16 v[212:215], a[92:95], a[168:171], v[212:215]
ds_read_b64_tr_b16 a[108:109], v19 offset:40968
ds_read_b64_tr_b16 a[110:111], v19 offset:45064
v_mfma_f32_16x16x32_bf16 v[212:215], a[88:91], a[152:155], v[212:215]
v_mfma_f32_16x16x32_bf16 v[204:207], a[88:91], a[148:151], v[204:207]
v_mfma_f32_16x16x32_bf16 v[204:207], a[92:95], a[164:167], v[204:207]
v_mfma_f32_16x16x32_bf16 v[196:199], a[92:95], a[160:163], v[196:199]
v_mfma_f32_16x16x32_bf16 v[196:199], a[88:91], a[144:147], v[196:199]
s_waitcnt lgkmcnt(4)
v_mfma_f32_16x16x32_bf16 v[224:227], a[96:99], a[144:147], v[224:227]
s_waitcnt vmcnt(51) lgkmcnt(0)
s_barrier
ds_read_b64_tr_b16 a[240:241], v8 offset:32768
v_mfma_f32_16x16x32_bf16 v[224:227], a[100:103], a[160:163], v[224:227]
s_add_u32 m0, s24, 65536
s_nop 0
buffer_load_dwordx4 v21, s[28:31], s36 offen offset:0 lds
buffer_load_dwordx4 v22, s[28:31], s36 offen offset:1024 lds
buffer_load_dwordx4 v23, s[28:31], s36 offen offset:2048 lds
v_mfma_f32_16x16x32_bf16 v[232:235], a[100:103], a[164:167], v[232:235]
ds_read_b64_tr_b16 a[242:243], v8 offset:36864
ds_read_b64_tr_b16 a[244:245], v8 offset:40960
v_mfma_f32_16x16x32_bf16 v[232:235], a[96:99], a[148:151], v[232:235]
buffer_load_dwordx4 v24, s[28:31], s36 offen offset:3072 lds
v_mfma_f32_16x16x32_bf16 v[240:243], a[96:99], a[152:155], v[240:243]
s_add_u32 s36, s36, 524288
ds_read_b64_tr_b16 a[246:247], v8 offset:45056
v_mfma_f32_16x16x32_bf16 v[240:243], a[100:103], a[168:171], v[240:243]
v_mfma_f32_16x16x32_bf16 v[248:251], a[100:103], a[172:175], v[248:251]
v_mfma_f32_16x16x32_bf16 v[248:251], a[96:99], a[156:159], v[248:251]
s_waitcnt lgkmcnt(4)
v_mfma_f32_16x16x32_bf16 v[252:255], a[104:107], a[156:159], v[252:255]
ds_read_b64_tr_b16 a[248:249], v9 offset:32768
ds_read_b64_tr_b16 a[250:251], v9 offset:36864
v_mfma_f32_16x16x32_bf16 v[252:255], a[108:111], a[172:175], v[252:255]
s_add_u32 m0, s24, 81920
ds_read_b64_tr_b16 a[252:253], v9 offset:40960
ds_read_b64_tr_b16 a[254:255], v9 offset:45056
v_mfma_f32_16x16x32_bf16 v[244:247], a[108:111], a[168:171], v[244:247]
v_mfma_f32_16x16x32_bf16 v[244:247], a[104:107], a[152:155], v[244:247]
v_mfma_f32_16x16x32_bf16 v[236:239], a[104:107], a[148:151], v[236:239]
v_mfma_f32_16x16x32_bf16 v[236:239], a[108:111], a[164:167], v[236:239]
v_mfma_f32_16x16x32_bf16 v[228:231], a[108:111], a[160:163], v[228:231]
v_mfma_f32_16x16x32_bf16 v[228:231], a[104:107], a[144:147], v[228:231]
s_waitcnt lgkmcnt(4)
v_mfma_f32_16x16x32_bf16 v[64:67], a[240:243], a[144:147], v[64:67]
ds_read_b64_tr_b16 a[80:81], v10 offset:32768
ds_read_b64_tr_b16 a[82:83], v10 offset:36864
v_mfma_f32_16x16x32_bf16 v[64:67], a[244:247], a[160:163], v[64:67]
ds_read_b64_tr_b16 a[84:85], v10 offset:40960
ds_read_b64_tr_b16 a[86:87], v10 offset:45056
v_mfma_f32_16x16x32_bf16 v[72:75], a[244:247], a[164:167], v[72:75]
buffer_load_dwordx4 v34, s[12:15], s21 offen offset:0 lds
v_mfma_f32_16x16x32_bf16 v[72:75], a[240:243], a[148:151], v[72:75]
v_mfma_f32_16x16x32_bf16 v[80:83], a[240:243], a[152:155], v[80:83]
v_mfma_f32_16x16x32_bf16 v[80:83], a[244:247], a[168:171], v[80:83]
v_mfma_f32_16x16x32_bf16 v[88:91], a[244:247], a[172:175], v[88:91]
v_mfma_f32_16x16x32_bf16 v[88:91], a[240:243], a[156:159], v[88:91]
s_waitcnt lgkmcnt(4)
buffer_load_dwordx4 v35, s[12:15], s21 offen offset:1024 lds
v_mfma_f32_16x16x32_bf16 v[92:95], a[248:251], a[156:159], v[92:95]
ds_read_b64_tr_b16 a[88:89], v11 offset:32768
ds_read_b64_tr_b16 a[90:91], v11 offset:36864
v_mfma_f32_16x16x32_bf16 v[92:95], a[252:255], a[172:175], v[92:95]
ds_read_b64_tr_b16 a[92:93], v11 offset:40960
ds_read_b64_tr_b16 a[94:95], v11 offset:45056
v_mfma_f32_16x16x32_bf16 v[84:87], a[252:255], a[168:171], v[84:87]
v_mfma_f32_16x16x32_bf16 v[84:87], a[248:251], a[152:155], v[84:87]
v_mfma_f32_16x16x32_bf16 v[76:79], a[248:251], a[148:151], v[76:79]
buffer_load_dwordx4 v34, s[12:15], s21 offen offset:2048 lds
v_mfma_f32_16x16x32_bf16 v[76:79], a[252:255], a[164:167], v[76:79]
v_mfma_f32_16x16x32_bf16 v[68:71], a[252:255], a[160:163], v[68:71]
v_mfma_f32_16x16x32_bf16 v[68:71], a[248:251], a[144:147], v[68:71]
s_waitcnt lgkmcnt(4)
v_mfma_f32_16x16x32_bf16 a[0:3], a[80:83], a[144:147], a[0:3]
ds_read_b64_tr_b16 a[96:97], v12 offset:32768
ds_read_b64_tr_b16 a[98:99], v12 offset:36864
v_mfma_f32_16x16x32_bf16 a[0:3], a[84:87], a[160:163], a[0:3]
buffer_load_dwordx4 v35, s[12:15], s21 offen offset:3072 lds
v_mfma_f32_16x16x32_bf16 a[8:11], a[84:87], a[164:167], a[8:11]
s_add_u32 s21, s21, 16384
ds_read_b64_tr_b16 a[100:101], v12 offset:40960
ds_read_b64_tr_b16 a[102:103], v12 offset:45056
v_mfma_f32_16x16x32_bf16 a[8:11], a[80:83], a[148:151], a[8:11]
v_mfma_f32_16x16x32_bf16 a[16:19], a[80:83], a[152:155], a[16:19]
v_mfma_f32_16x16x32_bf16 a[16:19], a[84:87], a[168:171], a[16:19]
v_mfma_f32_16x16x32_bf16 a[24:27], a[84:87], a[172:175], a[24:27]
v_mfma_f32_16x16x32_bf16 a[24:27], a[80:83], a[156:159], a[24:27]
s_waitcnt lgkmcnt(4)
v_mfma_f32_16x16x32_bf16 a[28:31], a[88:91], a[156:159], a[28:31]
ds_read_b64_tr_b16 a[104:105], v13 offset:32768
ds_read_b64_tr_b16 a[106:107], v13 offset:36864
v_mfma_f32_16x16x32_bf16 a[28:31], a[92:95], a[172:175], a[28:31]
ds_read_b64_tr_b16 a[108:109], v13 offset:40960
ds_read_b64_tr_b16 a[110:111], v13 offset:45056
v_mfma_f32_16x16x32_bf16 a[20:23], a[92:95], a[168:171], a[20:23]
v_mfma_f32_16x16x32_bf16 a[20:23], a[88:91], a[152:155], a[20:23]
v_mfma_f32_16x16x32_bf16 a[12:15], a[88:91], a[148:151], a[12:15]
v_mfma_f32_16x16x32_bf16 a[12:15], a[92:95], a[164:167], a[12:15]
v_mfma_f32_16x16x32_bf16 a[4:7], a[92:95], a[160:163], a[4:7]
v_mfma_f32_16x16x32_bf16 a[4:7], a[88:91], a[144:147], a[4:7]
s_waitcnt lgkmcnt(4)
v_mfma_f32_16x16x32_bf16 a[32:35], a[96:99], a[144:147], a[32:35]
ds_read_b64_tr_b16 a[240:241], v14 offset:32768
ds_read_b64_tr_b16 a[242:243], v14 offset:36864
v_mfma_f32_16x16x32_bf16 a[32:35], a[100:103], a[160:163], a[32:35]
ds_read_b64_tr_b16 a[244:245], v14 offset:40960
ds_read_b64_tr_b16 a[246:247], v14 offset:45056
v_mfma_f32_16x16x32_bf16 a[40:43], a[100:103], a[164:167], a[40:43]
v_mfma_f32_16x16x32_bf16 a[40:43], a[96:99], a[148:151], a[40:43]
v_mfma_f32_16x16x32_bf16 a[48:51], a[96:99], a[152:155], a[48:51]
v_mfma_f32_16x16x32_bf16 a[48:51], a[100:103], a[168:171], a[48:51]
v_mfma_f32_16x16x32_bf16 a[56:59], a[100:103], a[172:175], a[56:59]
v_mfma_f32_16x16x32_bf16 a[56:59], a[96:99], a[156:159], a[56:59]
s_waitcnt lgkmcnt(4)
v_mfma_f32_16x16x32_bf16 a[60:63], a[104:107], a[156:159], a[60:63]
ds_read_b64_tr_b16 a[248:249], v15 offset:32768
ds_read_b64_tr_b16 a[250:251], v15 offset:36864
v_mfma_f32_16x16x32_bf16 a[60:63], a[108:111], a[172:175], a[60:63]
ds_read_b64_tr_b16 a[252:253], v15 offset:40960
ds_read_b64_tr_b16 a[254:255], v15 offset:45056
v_mfma_f32_16x16x32_bf16 a[52:55], a[108:111], a[168:171], a[52:55]
v_mfma_f32_16x16x32_bf16 a[52:55], a[104:107], a[152:155], a[52:55]
v_mfma_f32_16x16x32_bf16 a[44:47], a[104:107], a[148:151], a[44:47]
v_mfma_f32_16x16x32_bf16 a[44:47], a[108:111], a[164:167], a[44:47]
v_mfma_f32_16x16x32_bf16 a[36:39], a[108:111], a[160:163], a[36:39]
v_mfma_f32_16x16x32_bf16 a[36:39], a[104:107], a[144:147], a[36:39]
s_waitcnt lgkmcnt(4)
v_mfma_f32_16x16x32_bf16 v[96:99], a[240:243], a[144:147], v[96:99]
s_waitcnt vmcnt(47) lgkmcnt(0)
s_barrier
ds_read_b64_tr_b16 a[80:81], v16 offset:0
v_mfma_f32_16x16x32_bf16 v[96:99], a[244:247], a[160:163], v[96:99]
s_add_u32 m0, s24, 147456
ds_read_b64_tr_b16 a[82:83], v16 offset:4096
ds_read_b64_tr_b16 a[84:85], v16 offset:8192
v_mfma_f32_16x16x32_bf16 v[104:107], a[244:247], a[164:167], v[104:107]
buffer_load_dwordx4 v25, s[32:35], s37 offen offset:0 lds
v_mfma_f32_16x16x32_bf16 v[104:107], a[240:243], a[148:151], v[104:107]
ds_read_b64_tr_b16 a[86:87], v16 offset:12288
v_mfma_f32_16x16x32_bf16 v[112:115], a[240:243], a[152:155], v[112:115]
v_mfma_f32_16x16x32_bf16 v[112:115], a[244:247], a[168:171], v[112:115]
v_mfma_f32_16x16x32_bf16 v[120:123], a[244:247], a[172:175], v[120:123]
buffer_load_dwordx4 v26, s[32:35], s37 offen offset:1024 lds
v_mfma_f32_16x16x32_bf16 v[120:123], a[240:243], a[156:159], v[120:123]
s_waitcnt lgkmcnt(4)
v_mfma_f32_16x16x32_bf16 v[124:127], a[248:251], a[156:159], v[124:127]
ds_read_b64_tr_b16 a[88:89], v16 offset:8
ds_read_b64_tr_b16 a[90:91], v16 offset:4104
v_mfma_f32_16x16x32_bf16 v[124:127], a[252:255], a[172:175], v[124:127]
ds_read_b64_tr_b16 a[92:93], v16 offset:8200
ds_read_b64_tr_b16 a[94:95], v16 offset:12296
v_mfma_f32_16x16x32_bf16 v[116:119], a[252:255], a[168:171], v[116:119]
v_mfma_f32_16x16x32_bf16 v[116:119], a[248:251], a[152:155], v[116:119]
buffer_load_dwordx4 v27, s[32:35], s37 offen offset:2048 lds
v_mfma_f32_16x16x32_bf16 v[108:111], a[248:251], a[148:151], v[108:111]
v_mfma_f32_16x16x32_bf16 v[108:111], a[252:255], a[164:167], v[108:111]
v_mfma_f32_16x16x32_bf16 v[100:103], a[252:255], a[160:163], v[100:103]
v_mfma_f32_16x16x32_bf16 v[100:103], a[248:251], a[144:147], v[100:103]
s_waitcnt lgkmcnt(4)
v_mfma_f32_16x16x32_bf16 v[128:131], a[80:83], a[176:179], v[128:131]
buffer_load_dwordx4 v28, s[32:35], s37 offen offset:3072 lds
v_mfma_f32_16x16x32_bf16 v[128:131], a[84:87], a[192:195], v[128:131]
s_add_u32 s37, s37, 589824
ds_read_b64_tr_b16 a[96:97], v17 offset:0
ds_read_b64_tr_b16 a[98:99], v17 offset:4096
v_mfma_f32_16x16x32_bf16 v[136:139], a[84:87], a[196:199], v[136:139]
ds_read_b64_tr_b16 a[100:101], v17 offset:8192
ds_read_b64_tr_b16 a[102:103], v17 offset:12288
v_mfma_f32_16x16x32_bf16 v[136:139], a[80:83], a[180:183], v[136:139]
v_mfma_f32_16x16x32_bf16 v[144:147], a[80:83], a[184:187], v[144:147]
s_lshr_b32 s46, s26, 1
s_lshl_b32 s46, s46, 2
s_add_u32 s46, s46, s23
v_mfma_f32_16x16x32_bf16 v[144:147], a[84:87], a[200:203], v[144:147]
s_lshl_b32 s46, s46, 11
s_add_u32 s46, s46, 65536
v_and_b32 v3, 15, v0
v_mfma_f32_16x16x32_bf16 v[152:155], a[84:87], a[204:207], v[152:155]
v_lshlrev_b32 v3, 7, v3
v_mfma_f32_16x16x32_bf16 v[152:155], a[80:83], a[188:191], v[152:155]
s_waitcnt lgkmcnt(4)
buffer_load_dword v4, v3, s[8:11], s46 offen
v_mfma_f32_16x16x32_bf16 v[156:159], a[88:91], a[188:191], v[156:159]
s_sub_u32 s46, s46, 32768
ds_read_b64_tr_b16 a[104:105], v17 offset:8
ds_read_b64_tr_b16 a[106:107], v17 offset:4104
v_mfma_f32_16x16x32_bf16 v[156:159], a[92:95], a[204:207], v[156:159]
buffer_load_dword v5, v3, s[12:15], s46 offen
v_mfma_f32_16x16x32_bf16 v[148:151], a[92:95], a[200:203], v[148:151]
ds_read_b64_tr_b16 a[108:109], v17 offset:8200
ds_read_b64_tr_b16 a[110:111], v17 offset:12296
v_mfma_f32_16x16x32_bf16 v[148:151], a[88:91], a[184:187], v[148:151]
v_mfma_f32_16x16x32_bf16 v[140:143], a[88:91], a[180:183], v[140:143]
v_mfma_f32_16x16x32_bf16 v[140:143], a[92:95], a[196:199], v[140:143]
v_mfma_f32_16x16x32_bf16 v[132:135], a[92:95], a[192:195], v[132:135]
v_mfma_f32_16x16x32_bf16 v[132:135], a[88:91], a[176:179], v[132:135]
s_waitcnt lgkmcnt(4)
v_mfma_f32_16x16x32_bf16 v[160:163], a[96:99], a[176:179], v[160:163]
ds_read_b64_tr_b16 a[240:241], v18 offset:0
ds_read_b64_tr_b16 a[242:243], v18 offset:4096
v_mfma_f32_16x16x32_bf16 v[160:163], a[100:103], a[192:195], v[160:163]
ds_read_b64_tr_b16 a[244:245], v18 offset:8192
ds_read_b64_tr_b16 a[246:247], v18 offset:12288
v_mfma_f32_16x16x32_bf16 v[168:171], a[100:103], a[196:199], v[168:171]
v_mfma_f32_16x16x32_bf16 v[168:171], a[96:99], a[180:183], v[168:171]
v_mfma_f32_16x16x32_bf16 v[176:179], a[96:99], a[184:187], v[176:179]
v_mfma_f32_16x16x32_bf16 v[176:179], a[100:103], a[200:203], v[176:179]
v_mfma_f32_16x16x32_bf16 v[184:187], a[100:103], a[204:207], v[184:187]
v_mfma_f32_16x16x32_bf16 v[184:187], a[96:99], a[188:191], v[184:187]
s_waitcnt lgkmcnt(4)
v_mfma_f32_16x16x32_bf16 v[188:191], a[104:107], a[188:191], v[188:191]
ds_read_b64_tr_b16 a[248:249], v18 offset:8
ds_read_b64_tr_b16 a[250:251], v18 offset:4104
v_mfma_f32_16x16x32_bf16 v[188:191], a[108:111], a[204:207], v[188:191]
ds_read_b64_tr_b16 a[252:253], v18 offset:8200
ds_read_b64_tr_b16 a[254:255], v18 offset:12296
v_mfma_f32_16x16x32_bf16 v[180:183], a[108:111], a[200:203], v[180:183]
v_mfma_f32_16x16x32_bf16 v[180:183], a[104:107], a[184:187], v[180:183]
v_mfma_f32_16x16x32_bf16 v[172:175], a[104:107], a[180:183], v[172:175]
v_mfma_f32_16x16x32_bf16 v[172:175], a[108:111], a[196:199], v[172:175]
v_mfma_f32_16x16x32_bf16 v[164:167], a[108:111], a[192:195], v[164:167]
v_mfma_f32_16x16x32_bf16 v[164:167], a[104:107], a[176:179], v[164:167]
s_waitcnt lgkmcnt(4)
v_mfma_f32_16x16x32_bf16 v[192:195], a[240:243], a[176:179], v[192:195]
ds_read_b64_tr_b16 a[80:81], v19 offset:0
ds_read_b64_tr_b16 a[82:83], v19 offset:4096
v_mfma_f32_16x16x32_bf16 v[192:195], a[244:247], a[192:195], v[192:195]
ds_read_b64_tr_b16 a[84:85], v19 offset:8192
ds_read_b64_tr_b16 a[86:87], v19 offset:12288
v_mfma_f32_16x16x32_bf16 v[200:203], a[244:247], a[196:199], v[200:203]
v_mfma_f32_16x16x32_bf16 v[200:203], a[240:243], a[180:183], v[200:203]
v_mfma_f32_16x16x32_bf16 v[208:211], a[240:243], a[184:187], v[208:211]
v_mfma_f32_16x16x32_bf16 v[208:211], a[244:247], a[200:203], v[208:211]
v_mfma_f32_16x16x32_bf16 v[216:219], a[244:247], a[204:207], v[216:219]
v_mfma_f32_16x16x32_bf16 v[216:219], a[240:243], a[188:191], v[216:219]
s_waitcnt lgkmcnt(4)
v_mfma_f32_16x16x32_bf16 v[220:223], a[248:251], a[188:191], v[220:223]
ds_read_b64_tr_b16 a[88:89], v19 offset:8
ds_read_b64_tr_b16 a[90:91], v19 offset:4104
v_mfma_f32_16x16x32_bf16 v[220:223], a[252:255], a[204:207], v[220:223]
ds_read_b64_tr_b16 a[92:93], v19 offset:8200
ds_read_b64_tr_b16 a[94:95], v19 offset:12296
v_mfma_f32_16x16x32_bf16 v[212:215], a[252:255], a[200:203], v[212:215]
v_mfma_f32_16x16x32_bf16 v[212:215], a[248:251], a[184:187], v[212:215]
v_mfma_f32_16x16x32_bf16 v[204:207], a[248:251], a[180:183], v[204:207]
v_mfma_f32_16x16x32_bf16 v[204:207], a[252:255], a[196:199], v[204:207]
v_mfma_f32_16x16x32_bf16 v[196:199], a[252:255], a[192:195], v[196:199]
s_waitcnt vmcnt(10) lgkmcnt(0)
s_barrier
ds_read_b64_tr_b16 a[96:97], v16 offset:16384
v_mfma_f32_16x16x32_bf16 v[196:199], a[248:251], a[176:179], v[196:199]
s_waitcnt lgkmcnt(5)
ds_read_b64_tr_b16 a[98:99], v16 offset:20480
ds_read_b64_tr_b16 a[100:101], v16 offset:24576
v_mfma_f32_16x16x32_bf16 v[224:227], a[80:83], a[176:179], v[224:227]
ds_read_b64_tr_b16 a[102:103], v16 offset:28672
ds_read_b64_tr_b16 a[104:105], v16 offset:32768
v_mfma_f32_16x16x32_bf16 v[224:227], a[84:87], a[192:195], v[224:227]
ds_read_b64_tr_b16 a[106:107], v16 offset:36864
ds_read_b64_tr_b16 a[108:109], v16 offset:40960
v_mfma_f32_16x16x32_bf16 v[232:235], a[84:87], a[196:199], v[232:235]
ds_read_b64_tr_b16 a[110:111], v16 offset:45056
v_mfma_f32_16x16x32_bf16 v[232:235], a[80:83], a[180:183], v[232:235]
v_mfma_f32_16x16x32_bf16 v[240:243], a[80:83], a[184:187], v[240:243]
v_mfma_f32_16x16x32_bf16 v[240:243], a[84:87], a[200:203], v[240:243]
v_mfma_f32_16x16x32_bf16 v[248:251], a[84:87], a[204:207], v[248:251]
v_mfma_f32_16x16x32_bf16 v[248:251], a[80:83], a[188:191], v[248:251]
s_waitcnt lgkmcnt(8)
v_mfma_f32_16x16x32_bf16 v[252:255], a[88:91], a[188:191], v[252:255]
v_mfma_f32_16x16x32_bf16 v[252:255], a[92:95], a[204:207], v[252:255]
v_mfma_f32_16x16x32_bf16 v[244:247], a[92:95], a[200:203], v[244:247]
v_mfma_f32_16x16x32_bf16 v[244:247], a[88:91], a[184:187], v[244:247]
v_mfma_f32_16x16x32_bf16 v[236:239], a[88:91], a[180:183], v[236:239]
v_mfma_f32_16x16x32_bf16 v[236:239], a[92:95], a[196:199], v[236:239]
v_mfma_f32_16x16x32_bf16 v[228:231], a[92:95], a[192:195], v[228:231]
ds_read_b64_tr_b16 a[240:241], v16 offset:16392
ds_read_b64_tr_b16 a[242:243], v16 offset:20488
v_mfma_f32_16x16x32_bf16 v[228:231], a[88:91], a[176:179], v[228:231]
s_waitcnt lgkmcnt(2)
ds_read_b64_tr_b16 a[244:245], v16 offset:24584
ds_read_b64_tr_b16 a[246:247], v16 offset:28680
v_mfma_f32_16x16x32_bf16 v[128:131], a[96:99], a[208:211], v[128:131]
ds_read_b64_tr_b16 a[248:249], v16 offset:32776
ds_read_b64_tr_b16 a[250:251], v16 offset:36872
v_mfma_f32_16x16x32_bf16 v[128:131], a[100:103], a[224:227], v[128:131]
ds_read_b64_tr_b16 a[252:253], v16 offset:40968
ds_read_b64_tr_b16 a[254:255], v16 offset:45064
v_mfma_f32_16x16x32_bf16 v[128:131], a[104:107], a[112:115], v[128:131]
v_mfma_f32_16x16x32_bf16 v[128:131], a[108:111], a[128:131], v[128:131]
v_mfma_f32_16x16x32_bf16 v[136:139], a[108:111], a[132:135], v[136:139]
v_mfma_f32_16x16x32_bf16 v[136:139], a[104:107], a[116:119], v[136:139]
v_mfma_f32_16x16x32_bf16 v[136:139], a[100:103], a[228:231], v[136:139]
v_mfma_f32_16x16x32_bf16 v[136:139], a[96:99], a[212:215], v[136:139]
v_mfma_f32_16x16x32_bf16 v[144:147], a[96:99], a[216:219], v[144:147]
v_mfma_f32_16x16x32_bf16 v[144:147], a[100:103], a[232:235], v[144:147]
v_mfma_f32_16x16x32_bf16 v[144:147], a[104:107], a[120:123], v[144:147]
v_mfma_f32_16x16x32_bf16 v[144:147], a[108:111], a[136:139], v[144:147]
v_mfma_f32_16x16x32_bf16 v[152:155], a[108:111], a[140:143], v[152:155]
v_mfma_f32_16x16x32_bf16 v[152:155], a[104:107], a[124:127], v[152:155]
v_mfma_f32_16x16x32_bf16 v[152:155], a[100:103], a[236:239], v[152:155]
ds_read_b64_tr_b16 a[80:81], v17 offset:16384
ds_read_b64_tr_b16 a[82:83], v17 offset:20480
v_mfma_f32_16x16x32_bf16 v[152:155], a[96:99], a[220:223], v[152:155]
s_waitcnt lgkmcnt(2)
ds_read_b64_tr_b16 a[84:85], v17 offset:24576
ds_read_b64_tr_b16 a[86:87], v17 offset:28672
v_mfma_f32_16x16x32_bf16 v[156:159], a[240:243], a[220:223], v[156:159]
s_lshr_b32 s46, s26, 1
s_lshl_b32 s46, s46, 2
s_add_u32 s46, s46, s23
v_mfma_f32_16x16x32_bf16 v[156:159], a[244:247], a[236:239], v[156:159]
s_lshl_b32 s46, s46, 11
ds_read_b64_tr_b16 a[88:89], v17 offset:32768
ds_read_b64_tr_b16 a[90:91], v17 offset:36864
v_mfma_f32_16x16x32_bf16 v[156:159], a[248:251], a[124:127], v[156:159]
s_add_u32 s46, s46, 98304
ds_read_b64_tr_b16 a[92:93], v17 offset:40960
ds_read_b64_tr_b16 a[94:95], v17 offset:45056
v_mfma_f32_16x16x32_bf16 v[156:159], a[252:255], a[140:143], v[156:159]
v_and_b32 v3, 15, v0
v_lshlrev_b32 v3, 7, v3
v_mfma_f32_16x16x32_bf16 v[148:151], a[252:255], a[136:139], v[148:151]
buffer_load_dword v4, v3, s[8:11], s46 offen
v_mfma_f32_16x16x32_bf16 v[148:151], a[248:251], a[120:123], v[148:151]
s_sub_u32 s46, s46, 32768
buffer_load_dword v5, v3, s[12:15], s46 offen
v_mfma_f32_16x16x32_bf16 v[148:151], a[244:247], a[232:235], v[148:151]
v_mfma_f32_16x16x32_bf16 v[148:151], a[240:243], a[216:219], v[148:151]
v_mfma_f32_16x16x32_bf16 v[140:143], a[240:243], a[212:215], v[140:143]
v_mfma_f32_16x16x32_bf16 v[140:143], a[244:247], a[228:231], v[140:143]
v_mfma_f32_16x16x32_bf16 v[140:143], a[248:251], a[116:119], v[140:143]
v_mfma_f32_16x16x32_bf16 v[140:143], a[252:255], a[132:135], v[140:143]
v_mfma_f32_16x16x32_bf16 v[132:135], a[252:255], a[128:131], v[132:135]
v_mfma_f32_16x16x32_bf16 v[132:135], a[248:251], a[112:115], v[132:135]
v_mfma_f32_16x16x32_bf16 v[132:135], a[244:247], a[224:227], v[132:135]
ds_read_b64_tr_b16 a[96:97], v17 offset:16392
ds_read_b64_tr_b16 a[98:99], v17 offset:20488
v_mfma_f32_16x16x32_bf16 v[132:135], a[240:243], a[208:211], v[132:135]
s_waitcnt lgkmcnt(2)
ds_read_b64_tr_b16 a[100:101], v17 offset:24584
ds_read_b64_tr_b16 a[102:103], v17 offset:28680
v_mfma_f32_16x16x32_bf16 v[160:163], a[80:83], a[208:211], v[160:163]
ds_read_b64_tr_b16 a[104:105], v17 offset:32776
ds_read_b64_tr_b16 a[106:107], v17 offset:36872
v_mfma_f32_16x16x32_bf16 v[160:163], a[84:87], a[224:227], v[160:163]
ds_read_b64_tr_b16 a[108:109], v17 offset:40968
ds_read_b64_tr_b16 a[110:111], v17 offset:45064
v_mfma_f32_16x16x32_bf16 v[160:163], a[88:91], a[112:115], v[160:163]
v_mfma_f32_16x16x32_bf16 v[160:163], a[92:95], a[128:131], v[160:163]
v_mfma_f32_16x16x32_bf16 v[168:171], a[92:95], a[132:135], v[168:171]
v_mul_f32 v128, s45, v128
v_mul_f32 v129, s45, v129
v_mfma_f32_16x16x32_bf16 v[168:171], a[88:91], a[116:119], v[168:171]
v_mul_f32 v130, s45, v130
v_mul_f32 v131, s45, v131
v_mfma_f32_16x16x32_bf16 v[168:171], a[84:87], a[228:231], v[168:171]
v_mul_f32 v132, s45, v132
v_mul_f32 v133, s45, v133
v_mfma_f32_16x16x32_bf16 v[168:171], a[80:83], a[212:215], v[168:171]
v_mul_f32 v134, s45, v134
v_mul_f32 v135, s45, v135
v_mfma_f32_16x16x32_bf16 v[176:179], a[80:83], a[216:219], v[176:179]
v_cvt_pk_bf16_f32 v128, v128, v129
v_cvt_pk_bf16_f32 v129, v130, v131
v_mfma_f32_16x16x32_bf16 v[176:179], a[84:87], a[232:235], v[176:179]
v_cvt_pk_bf16_f32 v130, v132, v133
v_cvt_pk_bf16_f32 v131, v134, v135
v_mfma_f32_16x16x32_bf16 v[176:179], a[88:91], a[120:123], v[176:179]
v_mul_f32 v136, s45, v136
v_mul_f32 v137, s45, v137
v_mfma_f32_16x16x32_bf16 v[176:179], a[92:95], a[136:139], v[176:179]
v_mul_f32 v138, s45, v138
v_mul_f32 v139, s45, v139
v_mfma_f32_16x16x32_bf16 v[184:187], a[92:95], a[140:143], v[184:187]
v_mul_f32 v140, s45, v140
v_mul_f32 v141, s45, v141
v_mfma_f32_16x16x32_bf16 v[184:187], a[88:91], a[124:127], v[184:187]
v_mul_f32 v142, s45, v142
v_mul_f32 v143, s45, v143
v_mfma_f32_16x16x32_bf16 v[184:187], a[84:87], a[236:239], v[184:187]
ds_read_b64_tr_b16 a[240:241], v18 offset:16384
ds_read_b64_tr_b16 a[242:243], v18 offset:20480
v_mfma_f32_16x16x32_bf16 v[184:187], a[80:83], a[220:223], v[184:187]
s_waitcnt lgkmcnt(2)
ds_read_b64_tr_b16 a[244:245], v18 offset:24576
ds_read_b64_tr_b16 a[246:247], v18 offset:28672
v_mfma_f32_16x16x32_bf16 v[188:191], a[96:99], a[220:223], v[188:191]
ds_read_b64_tr_b16 a[248:249], v18 offset:32768
ds_read_b64_tr_b16 a[250:251], v18 offset:36864
v_mfma_f32_16x16x32_bf16 v[188:191], a[100:103], a[236:239], v[188:191]
ds_read_b64_tr_b16 a[252:253], v18 offset:40960
ds_read_b64_tr_b16 a[254:255], v18 offset:45056
v_mfma_f32_16x16x32_bf16 v[188:191], a[104:107], a[124:127], v[188:191]
v_cvt_pk_bf16_f32 v132, v136, v137
v_cvt_pk_bf16_f32 v133, v138, v139
v_mfma_f32_16x16x32_bf16 v[188:191], a[108:111], a[140:143], v[188:191]
v_cvt_pk_bf16_f32 v134, v140, v141
v_cvt_pk_bf16_f32 v135, v142, v143
v_mfma_f32_16x16x32_bf16 v[180:183], a[108:111], a[136:139], v[180:183]
v_mul_f32 v144, s45, v144
v_mul_f32 v145, s45, v145
v_mfma_f32_16x16x32_bf16 v[180:183], a[104:107], a[120:123], v[180:183]
v_mul_f32 v146, s45, v146
v_mul_f32 v147, s45, v147
v_mfma_f32_16x16x32_bf16 v[180:183], a[100:103], a[232:235], v[180:183]
v_mul_f32 v148, s45, v148
v_mul_f32 v149, s45, v149
v_mfma_f32_16x16x32_bf16 v[180:183], a[96:99], a[216:219], v[180:183]
v_mul_f32 v150, s45, v150
v_mul_f32 v151, s45, v151
v_mfma_f32_16x16x32_bf16 v[172:175], a[96:99], a[212:215], v[172:175]
v_cvt_pk_bf16_f32 v136, v144, v145
v_cvt_pk_bf16_f32 v137, v146, v147
v_mfma_f32_16x16x32_bf16 v[172:175], a[100:103], a[228:231], v[172:175]
v_cvt_pk_bf16_f32 v138, v148, v149
v_cvt_pk_bf16_f32 v139, v150, v151
v_mfma_f32_16x16x32_bf16 v[172:175], a[104:107], a[116:119], v[172:175]
v_mul_f32 v152, s45, v152
v_mul_f32 v153, s45, v153
v_mfma_f32_16x16x32_bf16 v[172:175], a[108:111], a[132:135], v[172:175]
v_mul_f32 v154, s45, v154
v_mul_f32 v155, s45, v155
v_mfma_f32_16x16x32_bf16 v[164:167], a[108:111], a[128:131], v[164:167]
v_mul_f32 v156, s45, v156
v_mul_f32 v157, s45, v157
v_mfma_f32_16x16x32_bf16 v[164:167], a[104:107], a[112:115], v[164:167]
v_mul_f32 v158, s45, v158
v_mul_f32 v159, s45, v159
v_mfma_f32_16x16x32_bf16 v[164:167], a[100:103], a[224:227], v[164:167]
ds_read_b64_tr_b16 a[80:81], v18 offset:16392
ds_read_b64_tr_b16 a[82:83], v18 offset:20488
v_mfma_f32_16x16x32_bf16 v[164:167], a[96:99], a[208:211], v[164:167]
s_waitcnt lgkmcnt(2)
ds_read_b64_tr_b16 a[84:85], v18 offset:24584
ds_read_b64_tr_b16 a[86:87], v18 offset:28680
v_mfma_f32_16x16x32_bf16 v[192:195], a[240:243], a[208:211], v[192:195]
ds_read_b64_tr_b16 a[88:89], v18 offset:32776
ds_read_b64_tr_b16 a[90:91], v18 offset:36872
v_mfma_f32_16x16x32_bf16 v[192:195], a[244:247], a[224:227], v[192:195]
ds_read_b64_tr_b16 a[92:93], v18 offset:40968
ds_read_b64_tr_b16 a[94:95], v18 offset:45064
v_mfma_f32_16x16x32_bf16 v[192:195], a[248:251], a[112:115], v[192:195]
v_cvt_pk_bf16_f32 v140, v152, v153
v_cvt_pk_bf16_f32 v141, v154, v155
v_mfma_f32_16x16x32_bf16 v[192:195], a[252:255], a[128:131], v[192:195]
v_cvt_pk_bf16_f32 v142, v156, v157
v_cvt_pk_bf16_f32 v143, v158, v159
v_mfma_f32_16x16x32_bf16 v[200:203], a[252:255], a[132:135], v[200:203]
v_mul_f32 v160, s45, v160
v_mul_f32 v161, s45, v161
v_mfma_f32_16x16x32_bf16 v[200:203], a[248:251], a[116:119], v[200:203]
v_mul_f32 v162, s45, v162
v_mul_f32 v163, s45, v163
v_mfma_f32_16x16x32_bf16 v[200:203], a[244:247], a[228:231], v[200:203]
v_mul_f32 v164, s45, v164
v_mul_f32 v165, s45, v165
v_mfma_f32_16x16x32_bf16 v[200:203], a[240:243], a[212:215], v[200:203]
v_mul_f32 v166, s45, v166
v_mul_f32 v167, s45, v167
v_mfma_f32_16x16x32_bf16 v[208:211], a[240:243], a[216:219], v[208:211]
v_cvt_pk_bf16_f32 v144, v160, v161
v_cvt_pk_bf16_f32 v145, v162, v163
v_mfma_f32_16x16x32_bf16 v[208:211], a[244:247], a[232:235], v[208:211]
v_cvt_pk_bf16_f32 v146, v164, v165
v_cvt_pk_bf16_f32 v147, v166, v167
v_mfma_f32_16x16x32_bf16 v[208:211], a[248:251], a[120:123], v[208:211]
v_mul_f32 v168, s45, v168
v_mul_f32 v169, s45, v169
v_mfma_f32_16x16x32_bf16 v[208:211], a[252:255], a[136:139], v[208:211]
v_mul_f32 v170, s45, v170
v_mul_f32 v171, s45, v171
v_mfma_f32_16x16x32_bf16 v[216:219], a[252:255], a[140:143], v[216:219]
v_mul_f32 v172, s45, v172
v_mul_f32 v173, s45, v173
v_mfma_f32_16x16x32_bf16 v[216:219], a[248:251], a[124:127], v[216:219]
v_mul_f32 v174, s45, v174
v_mul_f32 v175, s45, v175
v_mfma_f32_16x16x32_bf16 v[216:219], a[244:247], a[236:239], v[216:219]
ds_read_b64_tr_b16 a[96:97], v19 offset:16384
ds_read_b64_tr_b16 a[98:99], v19 offset:20480
v_mfma_f32_16x16x32_bf16 v[216:219], a[240:243], a[220:223], v[216:219]
s_waitcnt lgkmcnt(2)
ds_read_b64_tr_b16 a[100:101], v19 offset:24576
ds_read_b64_tr_b16 a[102:103], v19 offset:28672
v_mfma_f32_16x16x32_bf16 v[220:223], a[80:83], a[220:223], v[220:223]
ds_read_b64_tr_b16 a[104:105], v19 offset:32768
ds_read_b64_tr_b16 a[106:107], v19 offset:36864
v_mfma_f32_16x16x32_bf16 v[220:223], a[84:87], a[236:239], v[220:223]
ds_read_b64_tr_b16 a[108:109], v19 offset:40960
ds_read_b64_tr_b16 a[110:111], v19 offset:45056
v_mfma_f32_16x16x32_bf16 v[220:223], a[88:91], a[124:127], v[220:223]
v_cvt_pk_bf16_f32 v148, v168, v169
v_cvt_pk_bf16_f32 v149, v170, v171
v_mfma_f32_16x16x32_bf16 v[220:223], a[92:95], a[140:143], v[220:223]
v_cvt_pk_bf16_f32 v150, v172, v173
v_cvt_pk_bf16_f32 v151, v174, v175
v_mfma_f32_16x16x32_bf16 v[212:215], a[92:95], a[136:139], v[212:215]
v_mul_f32 v176, s45, v176
v_mul_f32 v177, s45, v177
v_mfma_f32_16x16x32_bf16 v[212:215], a[88:91], a[120:123], v[212:215]
v_mul_f32 v178, s45, v178
v_mul_f32 v179, s45, v179
v_mfma_f32_16x16x32_bf16 v[212:215], a[84:87], a[232:235], v[212:215]
v_mul_f32 v180, s45, v180
v_mul_f32 v181, s45, v181
v_mfma_f32_16x16x32_bf16 v[212:215], a[80:83], a[216:219], v[212:215]
v_mul_f32 v182, s45, v182
v_mul_f32 v183, s45, v183
v_mfma_f32_16x16x32_bf16 v[204:207], a[80:83], a[212:215], v[204:207]
v_cvt_pk_bf16_f32 v152, v176, v177
v_cvt_pk_bf16_f32 v153, v178, v179
v_mfma_f32_16x16x32_bf16 v[204:207], a[84:87], a[228:231], v[204:207]
v_cvt_pk_bf16_f32 v154, v180, v181
v_cvt_pk_bf16_f32 v155, v182, v183
v_mfma_f32_16x16x32_bf16 v[204:207], a[88:91], a[116:119], v[204:207]
v_mul_f32 v184, s45, v184
v_mul_f32 v185, s45, v185
v_mfma_f32_16x16x32_bf16 v[204:207], a[92:95], a[132:135], v[204:207]
v_mul_f32 v186, s45, v186
v_mul_f32 v187, s45, v187
v_mfma_f32_16x16x32_bf16 v[196:199], a[92:95], a[128:131], v[196:199]
v_mul_f32 v188, s45, v188
v_mul_f32 v189, s45, v189
v_mfma_f32_16x16x32_bf16 v[196:199], a[88:91], a[112:115], v[196:199]
v_mul_f32 v190, s45, v190
v_mul_f32 v191, s45, v191
v_mfma_f32_16x16x32_bf16 v[196:199], a[84:87], a[224:227], v[196:199]
ds_read_b64_tr_b16 a[240:241], v19 offset:16392
ds_read_b64_tr_b16 a[242:243], v19 offset:20488
v_mfma_f32_16x16x32_bf16 v[196:199], a[80:83], a[208:211], v[196:199]
s_waitcnt lgkmcnt(2)
ds_read_b64_tr_b16 a[244:245], v19 offset:24584
ds_read_b64_tr_b16 a[246:247], v19 offset:28680
v_mfma_f32_16x16x32_bf16 v[224:227], a[96:99], a[208:211], v[224:227]
ds_read_b64_tr_b16 a[248:249], v19 offset:32776
ds_read_b64_tr_b16 a[250:251], v19 offset:36872
v_mfma_f32_16x16x32_bf16 v[224:227], a[100:103], a[224:227], v[224:227]
ds_read_b64_tr_b16 a[252:253], v19 offset:40968
ds_read_b64_tr_b16 a[254:255], v19 offset:45064
v_mfma_f32_16x16x32_bf16 v[224:227], a[104:107], a[112:115], v[224:227]
v_cvt_pk_bf16_f32 v156, v184, v185
v_cvt_pk_bf16_f32 v157, v186, v187
v_mfma_f32_16x16x32_bf16 v[224:227], a[108:111], a[128:131], v[224:227]
v_cvt_pk_bf16_f32 v158, v188, v189
v_cvt_pk_bf16_f32 v159, v190, v191
v_mfma_f32_16x16x32_bf16 v[232:235], a[108:111], a[132:135], v[232:235]
v_mul_f32 v192, s45, v192
v_mul_f32 v193, s45, v193
v_mfma_f32_16x16x32_bf16 v[232:235], a[104:107], a[116:119], v[232:235]
v_mul_f32 v194, s45, v194
v_mul_f32 v195, s45, v195
v_mfma_f32_16x16x32_bf16 v[232:235], a[100:103], a[228:231], v[232:235]
v_mul_f32 v196, s45, v196
v_mul_f32 v197, s45, v197
v_mfma_f32_16x16x32_bf16 v[232:235], a[96:99], a[212:215], v[232:235]
v_mul_f32 v198, s45, v198
v_mul_f32 v199, s45, v199
v_mfma_f32_16x16x32_bf16 v[240:243], a[96:99], a[216:219], v[240:243]
v_cvt_pk_bf16_f32 v160, v192, v193
v_cvt_pk_bf16_f32 v161, v194, v195
v_mfma_f32_16x16x32_bf16 v[240:243], a[100:103], a[232:235], v[240:243]
v_cvt_pk_bf16_f32 v162, v196, v197
v_cvt_pk_bf16_f32 v163, v198, v199
v_mfma_f32_16x16x32_bf16 v[240:243], a[104:107], a[120:123], v[240:243]
v_mul_f32 v200, s45, v200
v_mul_f32 v201, s45, v201
v_mfma_f32_16x16x32_bf16 v[240:243], a[108:111], a[136:139], v[240:243]
v_mul_f32 v202, s45, v202
v_mul_f32 v203, s45, v203
v_mfma_f32_16x16x32_bf16 v[248:251], a[108:111], a[140:143], v[248:251]
v_mul_f32 v204, s45, v204
v_mul_f32 v205, s45, v205
v_mfma_f32_16x16x32_bf16 v[248:251], a[104:107], a[124:127], v[248:251]
v_mul_f32 v206, s45, v206
v_mul_f32 v207, s45, v207
v_mfma_f32_16x16x32_bf16 v[248:251], a[100:103], a[236:239], v[248:251]
v_cvt_pk_bf16_f32 v164, v200, v201
v_cvt_pk_bf16_f32 v165, v202, v203
v_mfma_f32_16x16x32_bf16 v[248:251], a[96:99], a[220:223], v[248:251]
s_waitcnt lgkmcnt(0)
s_waitcnt vmcnt(4) lgkmcnt(0)
s_barrier
v_mfma_f32_16x16x32_bf16 v[252:255], a[240:243], a[220:223], v[252:255]
s_add_u32 m0, s24, 32768
ds_read_b64_tr_b16 a[80:81], v8 offset:0
ds_read_b64_tr_b16 a[82:83], v8 offset:4096
v_mfma_f32_16x16x32_bf16 v[252:255], a[244:247], a[236:239], v[252:255]
buffer_load_dwordx4 v30, s[8:11], s20 offen offset:0 lds
v_mfma_f32_16x16x32_bf16 v[252:255], a[248:251], a[124:127], v[252:255]
ds_read_b64_tr_b16 a[84:85], v8 offset:8192
ds_read_b64_tr_b16 a[86:87], v8 offset:12288
v_mfma_f32_16x16x32_bf16 v[252:255], a[252:255], a[140:143], v[252:255]
ds_read_b64_tr_b16 a[88:89], v8 offset:16384
ds_read_b64_tr_b16 a[90:91], v8 offset:20480
v_mfma_f32_16x16x32_bf16 v[244:247], a[252:255], a[136:139], v[244:247]
ds_read_b64_tr_b16 a[92:93], v8 offset:24576
ds_read_b64_tr_b16 a[94:95], v8 offset:28672
v_mfma_f32_16x16x32_bf16 v[244:247], a[248:251], a[120:123], v[244:247]
buffer_load_dwordx4 v31, s[8:11], s20 offen offset:1024 lds
v_mfma_f32_16x16x32_bf16 v[244:247], a[244:247], a[232:235], v[244:247]
ds_read_b64_tr_b16 a[96:97], v8 offset:32768
ds_read_b64_tr_b16 a[98:99], v8 offset:36864
v_mfma_f32_16x16x32_bf16 v[244:247], a[240:243], a[216:219], v[244:247]
ds_read_b64_tr_b16 a[100:101], v8 offset:40960
ds_read_b64_tr_b16 a[102:103], v8 offset:45056
v_mfma_f32_16x16x32_bf16 v[236:239], a[240:243], a[212:215], v[236:239]
v_cvt_pk_bf16_f32 v166, v204, v205
v_cvt_pk_bf16_f32 v167, v206, v207
v_mfma_f32_16x16x32_bf16 v[236:239], a[244:247], a[228:231], v[236:239]
v_mul_f32 v208, s45, v208
v_mul_f32 v209, s45, v209
v_mfma_f32_16x16x32_bf16 v[236:239], a[248:251], a[116:119], v[236:239]
buffer_load_dwordx4 v32, s[8:11], s20 offen offset:2048 lds
v_mfma_f32_16x16x32_bf16 v[236:239], a[252:255], a[132:135], v[236:239]
v_mul_f32 v210, s45, v210
v_mul_f32 v211, s45, v211
v_mfma_f32_16x16x32_bf16 v[228:231], a[252:255], a[128:131], v[228:231]
v_mul_f32 v212, s45, v212
v_mul_f32 v213, s45, v213
v_mfma_f32_16x16x32_bf16 v[228:231], a[248:251], a[112:115], v[228:231]
v_mul_f32 v214, s45, v214
v_mul_f32 v215, s45, v215
v_mfma_f32_16x16x32_bf16 v[228:231], a[244:247], a[224:227], v[228:231]
v_cvt_pk_bf16_f32 v168, v208, v209
v_cvt_pk_bf16_f32 v169, v210, v211
v_mfma_f32_16x16x32_bf16 v[228:231], a[240:243], a[208:211], v[228:231]
s_waitcnt lgkmcnt(0)
buffer_load_dwordx4 v33, s[8:11], s20 offen offset:3072 lds
v_mfma_f32_16x16x32_bf16 v[64:67], a[80:83], a[176:179], v[64:67]
s_add_u32 s20, s20, 16384
s_add_u32 m0, s24, 65536
v_cvt_pk_bf16_f32 v170, v212, v213
v_mfma_f32_16x16x32_bf16 v[64:67], a[84:87], a[192:195], v[64:67]
v_cvt_pk_bf16_f32 v171, v214, v215
v_mul_f32 v216, s45, v216
v_mfma_f32_16x16x32_bf16 v[64:67], a[88:91], a[208:211], v[64:67]
v_mul_f32 v217, s45, v217
v_mul_f32 v218, s45, v218
v_mfma_f32_16x16x32_bf16 v[64:67], a[92:95], a[224:227], v[64:67]
v_mul_f32 v219, s45, v219
v_mul_f32 v220, s45, v220
v_mfma_f32_16x16x32_bf16 v[64:67], a[96:99], a[112:115], v[64:67]
buffer_load_dwordx4 v34, s[12:15], s21 offen offset:0 lds
v_mfma_f32_16x16x32_bf16 v[64:67], a[100:103], a[128:131], v[64:67]
ds_read_b64_tr_b16 a[104:105], v9 offset:0
ds_read_b64_tr_b16 a[106:107], v9 offset:4096
v_mfma_f32_16x16x32_bf16 v[72:75], a[100:103], a[132:135], v[72:75]
ds_read_b64_tr_b16 a[108:109], v9 offset:8192
ds_read_b64_tr_b16 a[110:111], v9 offset:12288
v_mfma_f32_16x16x32_bf16 v[72:75], a[96:99], a[116:119], v[72:75]
ds_read_b64_tr_b16 a[240:241], v9 offset:16384
ds_read_b64_tr_b16 a[242:243], v9 offset:20480
v_mfma_f32_16x16x32_bf16 v[72:75], a[92:95], a[228:231], v[72:75]
ds_read_b64_tr_b16 a[244:245], v9 offset:24576
ds_read_b64_tr_b16 a[246:247], v9 offset:28672
v_mfma_f32_16x16x32_bf16 v[72:75], a[88:91], a[212:215], v[72:75]
buffer_load_dwordx4 v35, s[12:15], s21 offen offset:1024 lds
v_mfma_f32_16x16x32_bf16 v[72:75], a[84:87], a[196:199], v[72:75]
ds_read_b64_tr_b16 a[248:249], v9 offset:32768
ds_read_b64_tr_b16 a[250:251], v9 offset:36864
v_mfma_f32_16x16x32_bf16 v[72:75], a[80:83], a[180:183], v[72:75]
ds_read_b64_tr_b16 a[252:253], v9 offset:40960
ds_read_b64_tr_b16 a[254:255], v9 offset:45056
v_mfma_f32_16x16x32_bf16 v[80:83], a[80:83], a[184:187], v[80:83]
v_mul_f32 v221, s45, v221
v_mul_f32 v222, s45, v222
v_mfma_f32_16x16x32_bf16 v[80:83], a[84:87], a[200:203], v[80:83]
v_mul_f32 v223, s45, v223
v_cvt_pk_bf16_f32 v172, v216, v217
v_mfma_f32_16x16x32_bf16 v[80:83], a[88:91], a[216:219], v[80:83]
buffer_load_dwordx4 v34, s[12:15], s21 offen offset:2048 lds
v_mfma_f32_16x16x32_bf16 v[80:83], a[92:95], a[232:235], v[80:83]
v_cvt_pk_bf16_f32 v173, v218, v219
v_cvt_pk_bf16_f32 v174, v220, v221
v_mfma_f32_16x16x32_bf16 v[80:83], a[96:99], a[120:123], v[80:83]
v_cvt_pk_bf16_f32 v175, v222, v223
v_mul_f32 v224, s45, v224
v_mfma_f32_16x16x32_bf16 v[80:83], a[100:103], a[136:139], v[80:83]
v_mul_f32 v225, s45, v225
v_mul_f32 v226, s45, v226
v_mfma_f32_16x16x32_bf16 v[88:91], a[100:103], a[140:143], v[88:91]
ds_read_b128 a[144:147], v36 offset:0
v_mul_f32 v227, s45, v227
v_mfma_f32_16x16x32_bf16 v[88:91], a[96:99], a[124:127], v[88:91]
buffer_load_dwordx4 v35, s[12:15], s21 offen offset:3072 lds
v_mfma_f32_16x16x32_bf16 v[88:91], a[92:95], a[236:239], v[88:91]
s_add_u32 s21, s21, 16384
s_add_u32 m0, s24, 49152
ds_read_b128 a[148:151], v37 offset:0
v_mfma_f32_16x16x32_bf16 v[88:91], a[88:91], a[220:223], v[88:91]
ds_read_b128 a[152:155], v38 offset:0
ds_read_b128 a[156:159], v39 offset:0
v_mfma_f32_16x16x32_bf16 v[88:91], a[84:87], a[204:207], v[88:91]
ds_read_b128 a[160:163], v36 offset:4096
v_mul_f32 v228, s45, v228
v_mfma_f32_16x16x32_bf16 v[88:91], a[80:83], a[188:191], v[88:91]
s_waitcnt lgkmcnt(5)
ds_read_b128 a[164:167], v37 offset:4096
v_mul_f32 v229, s45, v229
v_mfma_f32_16x16x32_bf16 v[92:95], a[104:107], a[188:191], v[92:95]
buffer_load_dwordx4 v30, s[8:11], s20 offen offset:0 lds
v_mfma_f32_16x16x32_bf16 v[92:95], a[108:111], a[204:207], v[92:95]
ds_read_b128 a[168:171], v38 offset:4096
ds_read_b128 a[172:175], v39 offset:4096
v_mfma_f32_16x16x32_bf16 v[92:95], a[240:243], a[220:223], v[92:95]
v_mul_f32 v230, s45, v230
v_mul_f32 v231, s45, v231
v_mfma_f32_16x16x32_bf16 v[92:95], a[244:247], a[236:239], v[92:95]
v_cvt_pk_bf16_f32 v176, v224, v225
v_cvt_pk_bf16_f32 v177, v226, v227
v_mfma_f32_16x16x32_bf16 v[92:95], a[248:251], a[124:127], v[92:95]
v_cvt_pk_bf16_f32 v178, v228, v229
v_cvt_pk_bf16_f32 v179, v230, v231
v_mfma_f32_16x16x32_bf16 v[92:95], a[252:255], a[140:143], v[92:95]
buffer_load_dwordx4 v31, s[8:11], s20 offen offset:1024 lds
v_mfma_f32_16x16x32_bf16 v[84:87], a[252:255], a[136:139], v[84:87]
v_mul_f32 v232, s45, v232
v_mul_f32 v233, s45, v233
v_mfma_f32_16x16x32_bf16 v[84:87], a[248:251], a[120:123], v[84:87]
v_mul_f32 v234, s45, v234
v_mul_f32 v235, s45, v235
v_mfma_f32_16x16x32_bf16 v[84:87], a[244:247], a[232:235], v[84:87]
v_mul_f32 v236, s45, v236
v_mul_f32 v237, s45, v237
v_mfma_f32_16x16x32_bf16 v[84:87], a[240:243], a[216:219], v[84:87]
v_mul_f32 v238, s45, v238
v_mul_f32 v239, s45, v239
v_mfma_f32_16x16x32_bf16 v[84:87], a[108:111], a[200:203], v[84:87]
buffer_load_dwordx4 v32, s[8:11], s20 offen offset:2048 lds
v_mfma_f32_16x16x32_bf16 v[84:87], a[104:107], a[184:187], v[84:87]
v_cvt_pk_bf16_f32 v180, v232, v233
v_cvt_pk_bf16_f32 v181, v234, v235
v_mfma_f32_16x16x32_bf16 v[76:79], a[104:107], a[180:183], v[76:79]
v_cvt_pk_bf16_f32 v182, v236, v237
v_cvt_pk_bf16_f32 v183, v238, v239
v_mfma_f32_16x16x32_bf16 v[76:79], a[108:111], a[196:199], v[76:79]
v_mul_f32 v240, s45, v240
v_mul_f32 v241, s45, v241
v_mfma_f32_16x16x32_bf16 v[76:79], a[240:243], a[212:215], v[76:79]
v_mul_f32 v242, s45, v242
v_mul_f32 v243, s45, v243
v_mfma_f32_16x16x32_bf16 v[76:79], a[244:247], a[228:231], v[76:79]
buffer_load_dwordx4 v33, s[8:11], s20 offen offset:3072 lds
v_mfma_f32_16x16x32_bf16 v[76:79], a[248:251], a[116:119], v[76:79]
s_add_u32 s20, s20, 16384
v_mul_f32 v244, s45, v244
v_mul_f32 v245, s45, v245
v_mfma_f32_16x16x32_bf16 v[76:79], a[252:255], a[132:135], v[76:79]
v_mul_f32 v246, s45, v246
v_mul_f32 v247, s45, v247
v_mfma_f32_16x16x32_bf16 v[68:71], a[252:255], a[128:131], v[68:71]
v_cvt_pk_bf16_f32 v184, v240, v241
v_cvt_pk_bf16_f32 v185, v242, v243
v_mfma_f32_16x16x32_bf16 v[68:71], a[248:251], a[112:115], v[68:71]
v_cvt_pk_bf16_f32 v186, v244, v245
v_cvt_pk_bf16_f32 v187, v246, v247
v_mfma_f32_16x16x32_bf16 v[68:71], a[244:247], a[224:227], v[68:71]
v_mul_f32 v248, s45, v248
v_mul_f32 v249, s45, v249
v_mfma_f32_16x16x32_bf16 v[68:71], a[240:243], a[208:211], v[68:71]
v_mul_f32 v250, s45, v250
v_mul_f32 v251, s45, v251
v_mul_f32 v252, s45, v252
v_mul_f32 v253, s45, v253
v_mul_f32 v254, s45, v254
v_mul_f32 v255, s45, v255
v_cvt_pk_bf16_f32 v188, v248, v249
v_cvt_pk_bf16_f32 v189, v250, v251
v_cvt_pk_bf16_f32 v190, v252, v253
v_cvt_pk_bf16_f32 v191, v254, v255
v_mfma_f32_16x16x32_bf16 v[68:71], a[108:111], a[192:195], v[68:71]
v_mfma_f32_16x16x32_bf16 v[68:71], a[104:107], a[176:179], v[68:71]
s_waitcnt lgkmcnt(0)
v_mfma_f32_16x16x32_bf16 v[192:195], a[144:147], v[128:131], 0
v_mfma_f32_16x16x32_bf16 v[192:195], a[148:151], v[144:147], v[192:195]
v_mfma_f32_16x16x32_bf16 v[192:195], a[152:155], v[160:163], v[192:195]
v_mfma_f32_16x16x32_bf16 v[192:195], a[156:159], v[176:179], v[192:195]
v_mfma_f32_16x16x32_bf16 v[200:203], a[156:159], v[180:183], 0
s_add_u32 s44, s42, 0
v_cvt_pk_bf16_f32 v64, v64, v65
v_cvt_pk_bf16_f32 v65, v66, v67
v_mfma_f32_16x16x32_bf16 v[200:203], a[152:155], v[164:167], v[200:203]
v_cvt_pk_bf16_f32 v66, v68, v69
v_cvt_pk_bf16_f32 v67, v70, v71
v_mfma_f32_16x16x32_bf16 v[200:203], a[148:151], v[148:151], v[200:203]
v_pk_max_i16 v64, v64, 0
v_pk_max_i16 v65, v65, 0
v_mfma_f32_16x16x32_bf16 v[200:203], a[144:147], v[132:135], v[200:203]
v_pk_max_i16 v66, v66, 0
v_pk_max_i16 v67, v67, 0
v_mfma_f32_16x16x32_bf16 v[208:211], a[144:147], v[136:139], 0
buffer_store_dwordx4 v[64:67], v7, s[16:19], s44 offen offset:0 sc1
v_mfma_f32_16x16x32_bf16 v[208:211], a[148:151], v[152:155], v[208:211]
v_cvt_pk_bf16_f32 v72, v72, v73
v_cvt_pk_bf16_f32 v73, v74, v75
v_mfma_f32_16x16x32_bf16 v[208:211], a[152:155], v[168:171], v[208:211]
v_cvt_pk_bf16_f32 v74, v76, v77
v_cvt_pk_bf16_f32 v75, v78, v79
v_mfma_f32_16x16x32_bf16 v[208:211], a[156:159], v[184:187], v[208:211]
v_pk_max_i16 v72, v72, 0
v_pk_max_i16 v73, v73, 0
v_mfma_f32_16x16x32_bf16 v[216:219], a[156:159], v[188:191], 0
ds_read_b64_tr_b16 a[80:81], v10 offset:0
ds_read_b64_tr_b16 a[82:83], v10 offset:4096
v_mfma_f32_16x16x32_bf16 v[216:219], a[152:155], v[172:175], v[216:219]
ds_read_b64_tr_b16 a[84:85], v10 offset:8192
ds_read_b64_tr_b16 a[86:87], v10 offset:12288
v_mfma_f32_16x16x32_bf16 v[216:219], a[148:151], v[156:159], v[216:219]
ds_read_b64_tr_b16 a[88:89], v10 offset:16384
ds_read_b64_tr_b16 a[90:91], v10 offset:20480
v_mfma_f32_16x16x32_bf16 v[216:219], a[144:147], v[140:143], v[216:219]
ds_read_b64_tr_b16 a[92:93], v10 offset:24576
ds_read_b64_tr_b16 a[94:95], v10 offset:28672
v_mfma_f32_16x16x32_bf16 v[220:223], a[160:163], v[140:143], 0
ds_read_b64_tr_b16 a[96:97], v10 offset:32768
ds_read_b64_tr_b16 a[98:99], v10 offset:36864
v_mfma_f32_16x16x32_bf16 v[220:223], a[164:167], v[156:159], v[220:223]
ds_read_b64_tr_b16 a[100:101], v10 offset:40960
ds_read_b64_tr_b16 a[102:103], v10 offset:45056
v_mfma_f32_16x16x32_bf16 v[220:223], a[168:171], v[172:175], v[220:223]
v_pk_max_i16 v74, v74, 0
v_pk_max_i16 v75, v75, 0
v_mfma_f32_16x16x32_bf16 v[220:223], a[172:175], v[188:191], v[220:223]
buffer_store_dwordx4 v[72:75], v7, s[16:19], s44 offen offset:1024 sc1
v_mfma_f32_16x16x32_bf16 v[212:215], a[172:175], v[184:187], 0
v_cvt_pk_bf16_f32 v80, v80, v81
v_cvt_pk_bf16_f32 v81, v82, v83
v_mfma_f32_16x16x32_bf16 v[212:215], a[168:171], v[168:171], v[212:215]
v_cvt_pk_bf16_f32 v82, v84, v85
v_cvt_pk_bf16_f32 v83, v86, v87
v_mfma_f32_16x16x32_bf16 v[212:215], a[164:167], v[152:155], v[212:215]
v_pk_max_i16 v80, v80, 0
v_pk_max_i16 v81, v81, 0
v_mfma_f32_16x16x32_bf16 v[212:215], a[160:163], v[136:139], v[212:215]
v_pk_max_i16 v82, v82, 0
v_pk_max_i16 v83, v83, 0
v_mfma_f32_16x16x32_bf16 v[204:207], a[160:163], v[132:135], 0
buffer_store_dwordx4 v[80:83], v7, s[16:19], s44 offen offset:2048 sc1
v_mfma_f32_16x16x32_bf16 v[204:207], a[164:167], v[148:151], v[204:207]
v_cvt_pk_bf16_f32 v88, v88, v89
v_cvt_pk_bf16_f32 v89, v90, v91
v_mfma_f32_16x16x32_bf16 v[204:207], a[168:171], v[164:167], v[204:207]
v_cvt_pk_bf16_f32 v90, v92, v93
v_cvt_pk_bf16_f32 v91, v94, v95
v_mfma_f32_16x16x32_bf16 v[204:207], a[172:175], v[180:183], v[204:207]
v_pk_max_i16 v88, v88, 0
v_pk_max_i16 v89, v89, 0
v_mfma_f32_16x16x32_bf16 v[196:199], a[172:175], v[176:179], 0
v_pk_max_i16 v90, v90, 0
v_pk_max_i16 v91, v91, 0
v_mfma_f32_16x16x32_bf16 v[196:199], a[168:171], v[160:163], v[196:199]
v_mfma_f32_16x16x32_bf16 v[196:199], a[164:167], v[144:147], v[196:199]
buffer_store_dwordx4 v[88:91], v7, s[16:19], s44 offen offset:3072 sc1
v_mfma_f32_16x16x32_bf16 v[196:199], a[160:163], v[128:131], v[196:199]
s_waitcnt lgkmcnt(0)
v_mfma_f32_16x16x32_bf16 a[0:3], a[80:83], a[176:179], a[0:3]
ds_read_b128 a[144:147], v36 offset:8192
v_mfma_f32_16x16x32_bf16 a[0:3], a[84:87], a[192:195], a[0:3]
ds_read_b128 a[148:151], v37 offset:8192
v_mfma_f32_16x16x32_bf16 a[0:3], a[88:91], a[208:211], a[0:3]
ds_read_b128 a[152:155], v38 offset:8192
v_mfma_f32_16x16x32_bf16 a[0:3], a[92:95], a[224:227], a[0:3]
ds_read_b128 a[156:159], v39 offset:8192
v_mfma_f32_16x16x32_bf16 a[0:3], a[96:99], a[112:115], a[0:3]
ds_read_b64_tr_b16 a[104:105], v11 offset:0
ds_read_b64_tr_b16 a[106:107], v11 offset:4096
v_mfma_f32_16x16x32_bf16 a[0:3], a[100:103], a[128:131], a[0:3]
ds_read_b64_tr_b16 a[108:109], v11 offset:8192
ds_read_b64_tr_b16 a[110:111], v11 offset:12288
v_mfma_f32_16x16x32_bf16 a[8:11], a[100:103], a[132:135], a[8:11]
ds_read_b64_tr_b16 a[240:241], v11 offset:16384
ds_read_b64_tr_b16 a[242:243], v11 offset:20480
v_mfma_f32_16x16x32_bf16 a[8:11], a[96:99], a[116:119], a[8:11]
ds_read_b64_tr_b16 a[244:245], v11 offset:24576
ds_read_b64_tr_b16 a[246:247], v11 offset:28672
v_mfma_f32_16x16x32_bf16 a[8:11], a[92:95], a[228:231], a[8:11]
ds_read_b64_tr_b16 a[248:249], v11 offset:32768
ds_read_b64_tr_b16 a[250:251], v11 offset:36864
v_mfma_f32_16x16x32_bf16 a[8:11], a[88:91], a[212:215], a[8:11]
ds_read_b64_tr_b16 a[252:253], v11 offset:40960
ds_read_b64_tr_b16 a[254:255], v11 offset:45056
v_mfma_f32_16x16x32_bf16 a[8:11], a[84:87], a[196:199], a[8:11]
ds_read_b128 a[160:163], v36 offset:12288
ds_read_b128 a[164:167], v37 offset:12288
v_mfma_f32_16x16x32_bf16 a[8:11], a[80:83], a[180:183], a[8:11]
ds_read_b128 a[168:171], v38 offset:12288
ds_read_b128 a[172:175], v39 offset:12288
v_mfma_f32_16x16x32_bf16 a[16:19], a[80:83], a[184:187], a[16:19]
v_max3_f32 v21, v192, v193, v194
v_max3_f32 v22, v200, v201, v202
v_mfma_f32_16x16x32_bf16 a[16:19], a[84:87], a[200:203], a[16:19]
v_max3_f32 v23, v208, v209, v210
v_max3_f32 v24, v216, v217, v218
v_mfma_f32_16x16x32_bf16 a[16:19], a[88:91], a[216:219], a[16:19]
v_max3_f32 v21, v21, v195, v196
v_max3_f32 v22, v22, v203, v204
v_mfma_f32_16x16x32_bf16 a[16:19], a[92:95], a[232:235], a[16:19]
v_max3_f32 v23, v23, v211, v212
v_max3_f32 v24, v24, v219, v220
v_mfma_f32_16x16x32_bf16 a[16:19], a[96:99], a[120:123], a[16:19]
v_max3_f32 v21, v21, v197, v198
v_max3_f32 v22, v22, v205, v206
v_mfma_f32_16x16x32_bf16 a[16:19], a[100:103], a[136:139], a[16:19]
v_max3_f32 v23, v23, v213, v214
v_max3_f32 v24, v24, v221, v222
v_mfma_f32_16x16x32_bf16 a[24:27], a[100:103], a[140:143], a[24:27]
v_max_f32 v21, v21, v199
v_max_f32 v22, v22, v207
v_mfma_f32_16x16x32_bf16 a[24:27], a[96:99], a[124:127], a[24:27]
v_max_f32 v23, v23, v215
v_max_f32 v24, v24, v223
v_mfma_f32_16x16x32_bf16 a[24:27], a[92:95], a[236:239], a[24:27]
v_mov_b32 v25, v21
v_mov_b32 v26, v22
v_mfma_f32_16x16x32_bf16 a[24:27], a[88:91], a[220:223], a[24:27]
v_mov_b32 v27, v23
v_mov_b32 v28, v24
v_mfma_f32_16x16x32_bf16 a[24:27], a[84:87], a[204:207], a[24:27]
v_permlane32_swap_b32 v21, v25
v_permlane32_swap_b32 v22, v26
v_mfma_f32_16x16x32_bf16 a[24:27], a[80:83], a[188:191], a[24:27]
s_waitcnt lgkmcnt(4)
v_permlane32_swap_b32 v23, v27
v_permlane32_swap_b32 v24, v28
v_mfma_f32_16x16x32_bf16 a[28:31], a[104:107], a[188:191], a[28:31]
v_max_f32 v21, v21, v25
v_max_f32 v22, v22, v26
v_mfma_f32_16x16x32_bf16 a[28:31], a[108:111], a[204:207], a[28:31]
v_max_f32 v23, v23, v27
v_max_f32 v24, v24, v28
v_mfma_f32_16x16x32_bf16 a[28:31], a[240:243], a[220:223], a[28:31]
v_mov_b32 v25, v21
v_mov_b32 v26, v22
v_mfma_f32_16x16x32_bf16 a[28:31], a[244:247], a[236:239], a[28:31]
v_mov_b32 v27, v23
v_mov_b32 v28, v24
v_mfma_f32_16x16x32_bf16 a[28:31], a[248:251], a[124:127], a[28:31]
ds_read_b64_tr_b16 a[80:81], v12 offset:0
ds_read_b64_tr_b16 a[82:83], v12 offset:4096
v_mfma_f32_16x16x32_bf16 a[28:31], a[252:255], a[140:143], a[28:31]
ds_read_b64_tr_b16 a[84:85], v12 offset:8192
ds_read_b64_tr_b16 a[86:87], v12 offset:12288
v_mfma_f32_16x16x32_bf16 a[20:23], a[252:255], a[136:139], a[20:23]
ds_read_b64_tr_b16 a[88:89], v12 offset:16384
ds_read_b64_tr_b16 a[90:91], v12 offset:20480
v_mfma_f32_16x16x32_bf16 a[20:23], a[248:251], a[120:123], a[20:23]
ds_read_b64_tr_b16 a[92:93], v12 offset:24576
ds_read_b64_tr_b16 a[94:95], v12 offset:28672
v_mfma_f32_16x16x32_bf16 a[20:23], a[244:247], a[232:235], a[20:23]
ds_read_b64_tr_b16 a[96:97], v12 offset:32768
ds_read_b64_tr_b16 a[98:99], v12 offset:36864
v_mfma_f32_16x16x32_bf16 a[20:23], a[240:243], a[216:219], a[20:23]
ds_read_b64_tr_b16 a[100:101], v12 offset:40960
ds_read_b64_tr_b16 a[102:103], v12 offset:45056
v_mfma_f32_16x16x32_bf16 a[20:23], a[108:111], a[200:203], a[20:23]
v_permlane16_swap_b32 v21, v25
v_permlane16_swap_b32 v22, v26
v_mfma_f32_16x16x32_bf16 a[20:23], a[104:107], a[184:187], a[20:23]
v_permlane16_swap_b32 v23, v27
v_permlane16_swap_b32 v24, v28
v_mfma_f32_16x16x32_bf16 a[12:15], a[104:107], a[180:183], a[12:15]
v_max_f32 v21, v21, v25
v_max_f32 v22, v22, v26
v_mfma_f32_16x16x32_bf16 a[12:15], a[108:111], a[196:199], a[12:15]
v_max_f32 v23, v23, v27
v_max_f32 v24, v24, v28
v_mfma_f32_16x16x32_bf16 a[12:15], a[240:243], a[212:215], a[12:15]
v_sub_f32 v48, 0x41c00000, v21
v_sub_f32 v49, 0x41c00000, v21
v_mfma_f32_16x16x32_bf16 a[12:15], a[244:247], a[228:231], a[12:15]
v_sub_f32 v50, 0x41c00000, v21
v_sub_f32 v51, 0x41c00000, v21
v_mfma_f32_16x16x32_bf16 a[12:15], a[248:251], a[116:119], a[12:15]
v_sub_f32 v52, 0x41c00000, v22
v_sub_f32 v53, 0x41c00000, v22
v_mfma_f32_16x16x32_bf16 a[12:15], a[252:255], a[132:135], a[12:15]
v_sub_f32 v54, 0x41c00000, v22
v_sub_f32 v55, 0x41c00000, v22
v_mfma_f32_16x16x32_bf16 a[4:7], a[252:255], a[128:131], a[4:7]
v_sub_f32 v56, 0x41c00000, v23
v_sub_f32 v57, 0x41c00000, v23
v_mfma_f32_16x16x32_bf16 a[4:7], a[248:251], a[112:115], a[4:7]
v_sub_f32 v58, 0x41c00000, v23
v_sub_f32 v59, 0x41c00000, v23
v_mfma_f32_16x16x32_bf16 a[4:7], a[244:247], a[224:227], a[4:7]
v_sub_f32 v60, 0x41c00000, v24
v_sub_f32 v61, 0x41c00000, v24
v_mfma_f32_16x16x32_bf16 a[4:7], a[240:243], a[208:211], a[4:7]
v_sub_f32 v62, 0x41c00000, v24
v_sub_f32 v63, 0x41c00000, v24
v_mfma_f32_16x16x32_bf16 a[4:7], a[108:111], a[192:195], a[4:7]
v_add_f32 v192, v192, v48
v_add_f32 v193, v193, v48
v_mfma_f32_16x16x32_bf16 a[4:7], a[104:107], a[176:179], a[4:7]
s_waitcnt lgkmcnt(0)
v_add_f32 v194, v194, v48
v_add_f32 v195, v195, v48
v_mfma_f32_16x16x32_bf16 a[32:35], a[80:83], a[176:179], a[32:35]
v_add_f32 v196, v196, v48
v_add_f32 v197, v197, v48
v_mfma_f32_16x16x32_bf16 a[32:35], a[84:87], a[192:195], a[32:35]
v_add_f32 v198, v198, v48
v_add_f32 v199, v199, v48
v_mfma_f32_16x16x32_bf16 a[32:35], a[88:91], a[208:211], a[32:35]
v_add_f32 v200, v200, v52
v_add_f32 v201, v201, v52
v_mfma_f32_16x16x32_bf16 a[32:35], a[92:95], a[224:227], a[32:35]
v_add_f32 v202, v202, v52
v_add_f32 v203, v203, v52
v_mfma_f32_16x16x32_bf16 a[32:35], a[96:99], a[112:115], a[32:35]
s_add_u32 s44, s42, 16384
ds_read_b64_tr_b16 a[104:105], v13 offset:0
ds_read_b64_tr_b16 a[106:107], v13 offset:4096
v_mfma_f32_16x16x32_bf16 a[32:35], a[100:103], a[128:131], a[32:35]
ds_read_b64_tr_b16 a[108:109], v13 offset:8192
ds_read_b64_tr_b16 a[110:111], v13 offset:12288
v_mfma_f32_16x16x32_bf16 a[40:43], a[100:103], a[132:135], a[40:43]
ds_read_b64_tr_b16 a[240:241], v13 offset:16384
ds_read_b64_tr_b16 a[242:243], v13 offset:20480
v_mfma_f32_16x16x32_bf16 a[40:43], a[96:99], a[116:119], a[40:43]
ds_read_b64_tr_b16 a[244:245], v13 offset:24576
ds_read_b64_tr_b16 a[246:247], v13 offset:28672
v_mfma_f32_16x16x32_bf16 a[40:43], a[92:95], a[228:231], a[40:43]
ds_read_b64_tr_b16 a[248:249], v13 offset:32768
ds_read_b64_tr_b16 a[250:251], v13 offset:36864
v_mfma_f32_16x16x32_bf16 a[40:43], a[88:91], a[212:215], a[40:43]
ds_read_b64_tr_b16 a[252:253], v13 offset:40960
ds_read_b64_tr_b16 a[254:255], v13 offset:45056
v_mfma_f32_16x16x32_bf16 a[40:43], a[84:87], a[196:199], a[40:43]
v_add_f32 v204, v204, v52
v_add_f32 v205, v205, v52
v_mfma_f32_16x16x32_bf16 a[40:43], a[80:83], a[180:183], a[40:43]
v_add_f32 v206, v206, v52
v_add_f32 v207, v207, v52
v_mfma_f32_16x16x32_bf16 a[48:51], a[80:83], a[184:187], a[48:51]
v_add_f32 v208, v208, v56
v_add_f32 v209, v209, v56
v_mfma_f32_16x16x32_bf16 a[48:51], a[84:87], a[200:203], a[48:51]
v_add_f32 v210, v210, v56
v_add_f32 v211, v211, v56
v_mfma_f32_16x16x32_bf16 a[48:51], a[88:91], a[216:219], a[48:51]
v_add_f32 v212, v212, v56
v_add_f32 v213, v213, v56
v_mfma_f32_16x16x32_bf16 a[48:51], a[92:95], a[232:235], a[48:51]
v_add_f32 v214, v214, v56
v_add_f32 v215, v215, v56
v_mfma_f32_16x16x32_bf16 a[48:51], a[96:99], a[120:123], a[48:51]
v_add_f32 v216, v216, v60
v_add_f32 v217, v217, v60
v_mfma_f32_16x16x32_bf16 a[48:51], a[100:103], a[136:139], a[48:51]
v_add_f32 v218, v218, v60
v_add_f32 v219, v219, v60
v_mfma_f32_16x16x32_bf16 a[56:59], a[100:103], a[140:143], a[56:59]
v_add_f32 v220, v220, v60
v_add_f32 v221, v221, v60
v_mfma_f32_16x16x32_bf16 a[56:59], a[96:99], a[124:127], a[56:59]
v_add_f32 v222, v222, v60
v_add_f32 v223, v223, v60
v_mfma_f32_16x16x32_bf16 a[56:59], a[92:95], a[236:239], a[56:59]
v_accvgpr_read_b32 v224, a0
v_accvgpr_read_b32 v225, a1
v_mfma_f32_16x16x32_bf16 a[56:59], a[88:91], a[220:223], a[56:59]
v_accvgpr_read_b32 v226, a2
v_accvgpr_read_b32 v227, a3
v_mfma_f32_16x16x32_bf16 a[56:59], a[84:87], a[204:207], a[56:59]
v_accvgpr_read_b32 v228, a4
v_accvgpr_read_b32 v229, a5
v_mfma_f32_16x16x32_bf16 a[56:59], a[80:83], a[188:191], a[56:59]
s_waitcnt lgkmcnt(0)
v_accvgpr_read_b32 v230, a6
v_accvgpr_read_b32 v231, a7
v_mfma_f32_16x16x32_bf16 a[60:63], a[104:107], a[188:191], a[60:63]
v_cvt_pk_bf16_f32 v224, v224, v225
v_cvt_pk_bf16_f32 v225, v226, v227
v_mfma_f32_16x16x32_bf16 a[60:63], a[108:111], a[204:207], a[60:63]
v_cvt_pk_bf16_f32 v226, v228, v229
v_cvt_pk_bf16_f32 v227, v230, v231
v_mfma_f32_16x16x32_bf16 a[60:63], a[240:243], a[220:223], a[60:63]
v_pk_max_i16 v224, v224, 0
v_pk_max_i16 v225, v225, 0
v_mfma_f32_16x16x32_bf16 a[60:63], a[244:247], a[236:239], a[60:63]
v_pk_max_i16 v226, v226, 0
v_pk_max_i16 v227, v227, 0
v_mfma_f32_16x16x32_bf16 a[60:63], a[248:251], a[124:127], a[60:63]
buffer_store_dwordx4 v[224:227], v7, s[16:19], s44 offen offset:0 sc1
v_mfma_f32_16x16x32_bf16 a[60:63], a[252:255], a[140:143], a[60:63]
ds_read_b64_tr_b16 a[80:81], v14 offset:0
ds_read_b64_tr_b16 a[82:83], v14 offset:4096
v_mfma_f32_16x16x32_bf16 a[52:55], a[252:255], a[136:139], a[52:55]
ds_read_b64_tr_b16 a[84:85], v14 offset:8192
ds_read_b64_tr_b16 a[86:87], v14 offset:12288
v_mfma_f32_16x16x32_bf16 a[52:55], a[248:251], a[120:123], a[52:55]
ds_read_b64_tr_b16 a[88:89], v14 offset:16384
ds_read_b64_tr_b16 a[90:91], v14 offset:20480
v_mfma_f32_16x16x32_bf16 a[52:55], a[244:247], a[232:235], a[52:55]
ds_read_b64_tr_b16 a[92:93], v14 offset:24576
ds_read_b64_tr_b16 a[94:95], v14 offset:28672
v_mfma_f32_16x16x32_bf16 a[52:55], a[240:243], a[216:219], a[52:55]
ds_read_b64_tr_b16 a[96:97], v14 offset:32768
ds_read_b64_tr_b16 a[98:99], v14 offset:36864
v_mfma_f32_16x16x32_bf16 a[52:55], a[108:111], a[200:203], a[52:55]
ds_read_b64_tr_b16 a[100:101], v14 offset:40960
ds_read_b64_tr_b16 a[102:103], v14 offset:45056
v_mfma_f32_16x16x32_bf16 a[52:55], a[104:107], a[184:187], a[52:55]
v_accvgpr_read_b32 v232, a8
v_accvgpr_read_b32 v233, a9
v_mfma_f32_16x16x32_bf16 a[44:47], a[104:107], a[180:183], a[44:47]
v_accvgpr_read_b32 v234, a10
v_accvgpr_read_b32 v235, a11
v_mfma_f32_16x16x32_bf16 a[44:47], a[108:111], a[196:199], a[44:47]
v_accvgpr_read_b32 v236, a12
v_accvgpr_read_b32 v237, a13
v_mfma_f32_16x16x32_bf16 a[44:47], a[240:243], a[212:215], a[44:47]
v_accvgpr_read_b32 v238, a14
v_accvgpr_read_b32 v239, a15
v_mfma_f32_16x16x32_bf16 a[44:47], a[244:247], a[228:231], a[44:47]
v_cvt_pk_bf16_f32 v232, v232, v233
v_cvt_pk_bf16_f32 v233, v234, v235
v_mfma_f32_16x16x32_bf16 a[44:47], a[248:251], a[116:119], a[44:47]
v_cvt_pk_bf16_f32 v234, v236, v237
v_cvt_pk_bf16_f32 v235, v238, v239
v_mfma_f32_16x16x32_bf16 a[44:47], a[252:255], a[132:135], a[44:47]
v_pk_max_i16 v232, v232, 0
v_pk_max_i16 v233, v233, 0
v_mfma_f32_16x16x32_bf16 a[36:39], a[252:255], a[128:131], a[36:39]
v_pk_max_i16 v234, v234, 0
v_pk_max_i16 v235, v235, 0
v_mfma_f32_16x16x32_bf16 a[36:39], a[248:251], a[112:115], a[36:39]
buffer_store_dwordx4 v[232:235], v7, s[16:19], s44 offen offset:1024 sc1
v_mfma_f32_16x16x32_bf16 a[36:39], a[244:247], a[224:227], a[36:39]
v_accvgpr_read_b32 v240, a16
v_accvgpr_read_b32 v241, a17
v_mfma_f32_16x16x32_bf16 a[36:39], a[240:243], a[208:211], a[36:39]
v_accvgpr_read_b32 v242, a18
v_accvgpr_read_b32 v243, a19
v_mfma_f32_16x16x32_bf16 a[36:39], a[108:111], a[192:195], a[36:39]
v_accvgpr_read_b32 v244, a20
v_accvgpr_read_b32 v245, a21
v_mfma_f32_16x16x32_bf16 a[36:39], a[104:107], a[176:179], a[36:39]
s_waitcnt lgkmcnt(0)
v_accvgpr_read_b32 v246, a22
v_accvgpr_read_b32 v247, a23
v_mfma_f32_16x16x32_bf16 v[96:99], a[80:83], a[176:179], v[96:99]
v_cvt_pk_bf16_f32 v240, v240, v241
v_cvt_pk_bf16_f32 v241, v242, v243
v_mfma_f32_16x16x32_bf16 v[96:99], a[84:87], a[192:195], v[96:99]
v_cvt_pk_bf16_f32 v242, v244, v245
v_cvt_pk_bf16_f32 v243, v246, v247
v_mfma_f32_16x16x32_bf16 v[96:99], a[88:91], a[208:211], v[96:99]
v_pk_max_i16 v240, v240, 0
v_pk_max_i16 v241, v241, 0
v_mfma_f32_16x16x32_bf16 v[96:99], a[92:95], a[224:227], v[96:99]
v_pk_max_i16 v242, v242, 0
v_pk_max_i16 v243, v243, 0
v_mfma_f32_16x16x32_bf16 v[96:99], a[96:99], a[112:115], v[96:99]
buffer_store_dwordx4 v[240:243], v7, s[16:19], s44 offen offset:2048 sc1
v_mfma_f32_16x16x32_bf16 v[96:99], a[100:103], a[128:131], v[96:99]
ds_read_b64_tr_b16 a[104:105], v15 offset:0
ds_read_b64_tr_b16 a[106:107], v15 offset:4096
v_mfma_f32_16x16x32_bf16 v[104:107], a[100:103], a[132:135], v[104:107]
ds_read_b64_tr_b16 a[108:109], v15 offset:8192
ds_read_b64_tr_b16 a[110:111], v15 offset:12288
v_mfma_f32_16x16x32_bf16 v[104:107], a[96:99], a[116:119], v[104:107]
ds_read_b64_tr_b16 a[240:241], v15 offset:16384
ds_read_b64_tr_b16 a[242:243], v15 offset:20480
v_mfma_f32_16x16x32_bf16 v[104:107], a[92:95], a[228:231], v[104:107]
ds_read_b64_tr_b16 a[244:245], v15 offset:24576
ds_read_b64_tr_b16 a[246:247], v15 offset:28672
v_mfma_f32_16x16x32_bf16 v[104:107], a[88:91], a[212:215], v[104:107]
ds_read_b64_tr_b16 a[248:249], v15 offset:32768
ds_read_b64_tr_b16 a[250:251], v15 offset:36864
v_mfma_f32_16x16x32_bf16 v[104:107], a[84:87], a[196:199], v[104:107]
ds_read_b64_tr_b16 a[252:253], v15 offset:40960
ds_read_b64_tr_b16 a[254:255], v15 offset:45056
v_mfma_f32_16x16x32_bf16 v[104:107], a[80:83], a[180:183], v[104:107]
v_accvgpr_read_b32 v248, a24
v_accvgpr_read_b32 v249, a25
v_mfma_f32_16x16x32_bf16 v[112:115], a[80:83], a[184:187], v[112:115]
v_accvgpr_read_b32 v250, a26
v_accvgpr_read_b32 v251, a27
v_mfma_f32_16x16x32_bf16 v[112:115], a[84:87], a[200:203], v[112:115]
v_accvgpr_read_b32 v252, a28
v_accvgpr_read_b32 v253, a29
v_mfma_f32_16x16x32_bf16 v[112:115], a[88:91], a[216:219], v[112:115]
v_accvgpr_read_b32 v254, a30
v_accvgpr_read_b32 v255, a31
v_mfma_f32_16x16x32_bf16 v[112:115], a[92:95], a[232:235], v[112:115]
v_cvt_pk_bf16_f32 v248, v248, v249
v_cvt_pk_bf16_f32 v249, v250, v251
v_mfma_f32_16x16x32_bf16 v[112:115], a[96:99], a[120:123], v[112:115]
v_cvt_pk_bf16_f32 v250, v252, v253
v_cvt_pk_bf16_f32 v251, v254, v255
v_mfma_f32_16x16x32_bf16 v[112:115], a[100:103], a[136:139], v[112:115]
v_pk_max_i16 v248, v248, 0
v_pk_max_i16 v249, v249, 0
v_mfma_f32_16x16x32_bf16 v[120:123], a[100:103], a[140:143], v[120:123]
v_pk_max_i16 v250, v250, 0
v_pk_max_i16 v251, v251, 0
v_mfma_f32_16x16x32_bf16 v[120:123], a[96:99], a[124:127], v[120:123]
buffer_store_dwordx4 v[248:251], v7, s[16:19], s44 offen offset:3072 sc1
v_mfma_f32_16x16x32_bf16 v[120:123], a[92:95], a[236:239], v[120:123]
s_add_u32 s44, s42, 32768
v_accvgpr_read_b32 v224, a32
v_accvgpr_read_b32 v225, a33
v_mfma_f32_16x16x32_bf16 v[120:123], a[88:91], a[220:223], v[120:123]
v_accvgpr_read_b32 v226, a34
v_accvgpr_read_b32 v227, a35
v_mfma_f32_16x16x32_bf16 v[120:123], a[84:87], a[204:207], v[120:123]
v_accvgpr_read_b32 v228, a36
v_accvgpr_read_b32 v229, a37
v_mfma_f32_16x16x32_bf16 v[120:123], a[80:83], a[188:191], v[120:123]
s_waitcnt lgkmcnt(0)
v_accvgpr_read_b32 v230, a38
v_accvgpr_read_b32 v231, a39
v_mfma_f32_16x16x32_bf16 v[124:127], a[104:107], a[188:191], v[124:127]
v_cvt_pk_bf16_f32 v224, v224, v225
v_cvt_pk_bf16_f32 v225, v226, v227
v_mfma_f32_16x16x32_bf16 v[124:127], a[108:111], a[204:207], v[124:127]
v_cvt_pk_bf16_f32 v226, v228, v229
v_cvt_pk_bf16_f32 v227, v230, v231
v_mfma_f32_16x16x32_bf16 v[124:127], a[240:243], a[220:223], v[124:127]
v_pk_max_i16 v224, v224, 0
v_pk_max_i16 v225, v225, 0
v_mfma_f32_16x16x32_bf16 v[124:127], a[244:247], a[236:239], v[124:127]
v_pk_max_i16 v226, v226, 0
v_pk_max_i16 v227, v227, 0
v_mfma_f32_16x16x32_bf16 v[124:127], a[248:251], a[124:127], v[124:127]
buffer_store_dwordx4 v[224:227], v7, s[16:19], s44 offen offset:0 sc1
v_mfma_f32_16x16x32_bf16 v[124:127], a[252:255], a[140:143], v[124:127]
v_accvgpr_read_b32 v232, a40
v_accvgpr_read_b32 v233, a41
v_mfma_f32_16x16x32_bf16 v[116:119], a[252:255], a[136:139], v[116:119]
v_accvgpr_read_b32 v234, a42
v_accvgpr_read_b32 v235, a43
v_mfma_f32_16x16x32_bf16 v[116:119], a[248:251], a[120:123], v[116:119]
v_accvgpr_read_b32 v236, a44
v_accvgpr_read_b32 v237, a45
v_mfma_f32_16x16x32_bf16 v[116:119], a[244:247], a[232:235], v[116:119]
v_accvgpr_read_b32 v238, a46
v_accvgpr_read_b32 v239, a47
v_mfma_f32_16x16x32_bf16 v[116:119], a[240:243], a[216:219], v[116:119]
v_cvt_pk_bf16_f32 v232, v232, v233
v_cvt_pk_bf16_f32 v233, v234, v235
v_mfma_f32_16x16x32_bf16 v[116:119], a[108:111], a[200:203], v[116:119]
v_cvt_pk_bf16_f32 v234, v236, v237
v_cvt_pk_bf16_f32 v235, v238, v239
v_mfma_f32_16x16x32_bf16 v[116:119], a[104:107], a[184:187], v[116:119]
v_pk_max_i16 v232, v232, 0
v_pk_max_i16 v233, v233, 0
v_mfma_f32_16x16x32_bf16 v[108:111], a[104:107], a[180:183], v[108:111]
v_pk_max_i16 v234, v234, 0
v_pk_max_i16 v235, v235, 0
v_mfma_f32_16x16x32_bf16 v[108:111], a[108:111], a[196:199], v[108:111]
buffer_store_dwordx4 v[232:235], v7, s[16:19], s44 offen offset:1024 sc1
v_mfma_f32_16x16x32_bf16 v[108:111], a[240:243], a[212:215], v[108:111]
v_accvgpr_read_b32 v240, a48
v_accvgpr_read_b32 v241, a49
v_mfma_f32_16x16x32_bf16 v[108:111], a[244:247], a[228:231], v[108:111]
v_accvgpr_read_b32 v242, a50
v_accvgpr_read_b32 v243, a51
v_mfma_f32_16x16x32_bf16 v[108:111], a[248:251], a[116:119], v[108:111]
v_accvgpr_read_b32 v244, a52
v_accvgpr_read_b32 v245, a53
v_mfma_f32_16x16x32_bf16 v[108:111], a[252:255], a[132:135], v[108:111]
v_accvgpr_read_b32 v246, a54
v_accvgpr_read_b32 v247, a55
v_mfma_f32_16x16x32_bf16 v[100:103], a[252:255], a[128:131], v[100:103]
v_cvt_pk_bf16_f32 v240, v240, v241
v_cvt_pk_bf16_f32 v241, v242, v243
v_mfma_f32_16x16x32_bf16 v[100:103], a[248:251], a[112:115], v[100:103]
v_cvt_pk_bf16_f32 v242, v244, v245
v_cvt_pk_bf16_f32 v243, v246, v247
v_mfma_f32_16x16x32_bf16 v[100:103], a[244:247], a[224:227], v[100:103]
v_pk_max_i16 v240, v240, 0
v_pk_max_i16 v241, v241, 0
v_mfma_f32_16x16x32_bf16 v[100:103], a[240:243], a[208:211], v[100:103]
v_pk_max_i16 v242, v242, 0
v_pk_max_i16 v243, v243, 0
v_mfma_f32_16x16x32_bf16 v[100:103], a[108:111], a[192:195], v[100:103]
buffer_store_dwordx4 v[240:243], v7, s[16:19], s44 offen offset:2048 sc1
v_mfma_f32_16x16x32_bf16 v[100:103], a[104:107], a[176:179], v[100:103]
v_accvgpr_read_b32 v248, a56
v_accvgpr_read_b32 v249, a57
v_accvgpr_read_b32 v250, a58
v_accvgpr_read_b32 v251, a59
v_accvgpr_read_b32 v252, a60
v_accvgpr_read_b32 v253, a61
v_accvgpr_read_b32 v254, a62
v_accvgpr_read_b32 v255, a63
v_cvt_pk_bf16_f32 v248, v248, v249
v_cvt_pk_bf16_f32 v249, v250, v251
v_cvt_pk_bf16_f32 v250, v252, v253
v_cvt_pk_bf16_f32 v251, v254, v255
v_pk_max_i16 v248, v248, 0
v_pk_max_i16 v249, v249, 0
v_pk_max_i16 v250, v250, 0
v_pk_max_i16 v251, v251, 0
buffer_store_dwordx4 v[248:251], v7, s[16:19], s44 offen offset:3072 sc1
s_waitcnt vmcnt(53) lgkmcnt(0)
s_barrier
M_p1e:
v_mfma_f32_16x16x32_bf16 v[224:227], a[144:147], v[128:131], v[48:51]
ds_read_b128 a[176:179], v36 offset:16384
v_mfma_f32_16x16x32_bf16 v[224:227], a[148:151], v[144:147], v[224:227]
s_add_u32 m0, s24, 0
v_exp_f32 v192, v192
v_mfma_f32_16x16x32_bf16 v[224:227], a[152:155], v[160:163], v[224:227]
v_exp_f32 v193, v193
v_mfma_f32_16x16x32_bf16 v[224:227], a[156:159], v[176:179], v[224:227]
v_exp_f32 v194, v194
v_mfma_f32_16x16x32_bf16 v[232:235], a[156:159], v[180:183], v[52:55]
v_exp_f32 v195, v195
v_mfma_f32_16x16x32_bf16 v[232:235], a[152:155], v[164:167], v[232:235]
ds_read_b128 a[180:183], v37 offset:16384
v_cvt_pk_bf16_f32 v64, v192, v193
v_mfma_f32_16x16x32_bf16 v[232:235], a[148:151], v[148:151], v[232:235]
v_exp_f32 v196, v196
v_mfma_f32_16x16x32_bf16 v[232:235], a[144:147], v[132:135], v[232:235]
v_exp_f32 v197, v197
v_mfma_f32_16x16x32_bf16 v[240:243], a[144:147], v[136:139], v[56:59]
ds_read_b128 a[184:187], v38 offset:16384
buffer_load_dwordx4 v30, s[8:11], s20 offen offset:0 lds
v_exp_f32 v198, v198
v_mfma_f32_16x16x32_bf16 v[240:243], a[148:151], v[152:155], v[240:243]
v_exp_f32 v199, v199
v_cvt_pk_bf16_f32 v65, v194, v195
v_mfma_f32_16x16x32_bf16 v[240:243], a[152:155], v[168:171], v[240:243]
v_exp_f32 v200, v200
v_mfma_f32_16x16x32_bf16 v[240:243], a[156:159], v[184:187], v[240:243]
ds_read_b128 a[188:191], v39 offset:16384
v_exp_f32 v201, v201
v_cvt_pk_bf16_f32 v66, v196, v197
v_mfma_f32_16x16x32_bf16 v[248:251], a[156:159], v[188:191], v[60:63]
buffer_load_dwordx4 v31, s[8:11], s20 offen offset:1024 lds
v_exp_f32 v202, v202
v_mfma_f32_16x16x32_bf16 v[248:251], a[152:155], v[172:175], v[248:251]
v_exp_f32 v203, v203
v_cvt_pk_bf16_f32 v67, v198, v199
v_mfma_f32_16x16x32_bf16 v[248:251], a[148:151], v[156:159], v[248:251]
ds_read_b128 a[192:195], v36 offset:20480
v_exp_f32 v204, v204
v_mfma_f32_16x16x32_bf16 v[248:251], a[144:147], v[140:143], v[248:251]
v_exp_f32 v205, v205
v_cvt_pk_bf16_f32 v72, v200, v201
v_mfma_f32_16x16x32_bf16 v[252:255], a[160:163], v[140:143], v[60:63]
v_exp_f32 v206, v206
v_mfma_f32_16x16x32_bf16 v[252:255], a[164:167], v[156:159], v[252:255]
ds_read_b128 a[196:199], v37 offset:20480
buffer_load_dwordx4 v32, s[8:11], s20 offen offset:2048 lds
v_exp_f32 v207, v207
v_cvt_pk_bf16_f32 v73, v202, v203
v_mfma_f32_16x16x32_bf16 v[252:255], a[168:171], v[172:175], v[252:255]
v_exp_f32 v208, v208
v_exp_f32 v209, v209
v_mfma_f32_16x16x32_bf16 v[252:255], a[172:175], v[188:191], v[252:255]
v_exp_f32 v210, v210
v_cvt_pk_bf16_f32 v74, v204, v205
v_mfma_f32_16x16x32_bf16 v[244:247], a[172:175], v[184:187], v[56:59]
ds_read_b128 a[200:203], v38 offset:20480
v_exp_f32 v211, v211
v_mfma_f32_16x16x32_bf16 v[244:247], a[168:171], v[168:171], v[244:247]
buffer_load_dwordx4 v33, s[8:11], s20 offen offset:3072 lds
v_exp_f32 v212, v212
v_cvt_pk_bf16_f32 v75, v206, v207
v_mfma_f32_16x16x32_bf16 v[244:247], a[164:167], v[152:155], v[244:247]
v_exp_f32 v213, v213
v_cvt_pk_bf16_f32 v80, v208, v209
v_mfma_f32_16x16x32_bf16 v[244:247], a[160:163], v[136:139], v[244:247]
ds_read_b128 a[204:207], v39 offset:20480
v_exp_f32 v214, v214
v_mfma_f32_16x16x32_bf16 v[236:239], a[160:163], v[132:135], v[52:55]
v_exp_f32 v215, v215
v_cvt_pk_bf16_f32 v81, v210, v211
v_mfma_f32_16x16x32_bf16 v[236:239], a[164:167], v[148:151], v[236:239]
s_add_u32 s20, s20, 16384
v_exp_f32 v216, v216
v_mfma_f32_16x16x32_bf16 v[236:239], a[168:171], v[164:167], v[236:239]
v_exp_f32 v217, v217
v_cvt_pk_bf16_f32 v82, v212, v213
v_mfma_f32_16x16x32_bf16 v[236:239], a[172:175], v[180:183], v[236:239]
v_exp_f32 v218, v218
v_mfma_f32_16x16x32_bf16 v[228:231], a[172:175], v[176:179], v[48:51]
v_exp_f32 v219, v219
v_cvt_pk_bf16_f32 v83, v214, v215
v_mfma_f32_16x16x32_bf16 v[228:231], a[168:171], v[160:163], v[228:231]
v_exp_f32 v220, v220
v_mfma_f32_16x16x32_bf16 v[228:231], a[164:167], v[144:147], v[228:231]
v_exp_f32 v221, v221
v_cvt_pk_bf16_f32 v88, v216, v217
v_mfma_f32_16x16x32_bf16 v[228:231], a[160:163], v[128:131], v[228:231]
v_exp_f32 v222, v222
v_cvt_pk_bf16_f32 v89, v218, v219
v_cvt_pk_bf16_f32 v90, v220, v221
v_exp_f32 v223, v223
s_nop 0
v_cvt_pk_bf16_f32 v91, v222, v223
s_waitcnt lgkmcnt(0)
v_mfma_f32_16x16x32_bf16 v[192:195], a[176:179], v[128:131], v[48:51]
s_add_u32 s44, s42, 49152
ds_read_b128 a[144:147], v36 offset:24576
v_cvt_pk_bf16_f32 v96, v96, v97
v_mfma_f32_16x16x32_bf16 v[192:195], a[180:183], v[144:147], v[192:195]
s_add_u32 m0, s24, 98304
v_exp_f32 v224, v224
v_mfma_f32_16x16x32_bf16 v[192:195], a[184:187], v[160:163], v[192:195]
v_exp_f32 v225, v225
v_mfma_f32_16x16x32_bf16 v[192:195], a[188:191], v[176:179], v[192:195]
v_exp_f32 v226, v226
v_mfma_f32_16x16x32_bf16 v[200:203], a[188:191], v[180:183], v[52:55]
v_exp_f32 v227, v227
v_mfma_f32_16x16x32_bf16 v[200:203], a[184:187], v[164:167], v[200:203]
ds_read_b128 a[148:151], v37 offset:24576
v_cvt_pk_bf16_f32 v68, v224, v225
v_mfma_f32_16x16x32_bf16 v[200:203], a[180:183], v[148:151], v[200:203]
v_exp_f32 v232, v232
v_mfma_f32_16x16x32_bf16 v[200:203], a[176:179], v[132:135], v[200:203]
v_exp_f32 v233, v233
v_mfma_f32_16x16x32_bf16 v[208:211], a[176:179], v[136:139], v[56:59]
ds_read_b128 a[152:155], v38 offset:24576
buffer_load_dwordx4 v34, s[12:15], s21 offen offset:0 lds
v_exp_f32 v234, v234
v_mfma_f32_16x16x32_bf16 v[208:211], a[180:183], v[152:155], v[208:211]
v_exp_f32 v235, v235
v_cvt_pk_bf16_f32 v69, v226, v227
v_mfma_f32_16x16x32_bf16 v[208:211], a[184:187], v[168:171], v[208:211]
v_exp_f32 v240, v240
v_mfma_f32_16x16x32_bf16 v[208:211], a[188:191], v[184:187], v[208:211]
ds_read_b128 a[156:159], v39 offset:24576
v_exp_f32 v241, v241
v_cvt_pk_bf16_f32 v76, v232, v233
v_mfma_f32_16x16x32_bf16 v[216:219], a[188:191], v[188:191], v[60:63]
buffer_load_dwordx4 v35, s[12:15], s21 offen offset:1024 lds
v_exp_f32 v242, v242
v_mfma_f32_16x16x32_bf16 v[216:219], a[184:187], v[172:175], v[216:219]
v_exp_f32 v243, v243
v_cvt_pk_bf16_f32 v77, v234, v235
v_mfma_f32_16x16x32_bf16 v[216:219], a[180:183], v[156:159], v[216:219]
ds_read_b128 a[160:163], v36 offset:28672
v_exp_f32 v248, v248
v_mfma_f32_16x16x32_bf16 v[216:219], a[176:179], v[140:143], v[216:219]
v_exp_f32 v249, v249
v_cvt_pk_bf16_f32 v84, v240, v241
v_mfma_f32_16x16x32_bf16 v[220:223], a[192:195], v[140:143], v[60:63]
v_exp_f32 v250, v250
v_mfma_f32_16x16x32_bf16 v[220:223], a[196:199], v[156:159], v[220:223]
ds_read_b128 a[164:167], v37 offset:28672
buffer_load_dwordx4 v34, s[12:15], s21 offen offset:2048 lds
v_exp_f32 v251, v251
v_cvt_pk_bf16_f32 v85, v242, v243
v_mfma_f32_16x16x32_bf16 v[220:223], a[200:203], v[172:175], v[220:223]
v_exp_f32 v228, v228
v_exp_f32 v229, v229
v_mfma_f32_16x16x32_bf16 v[220:223], a[204:207], v[188:191], v[220:223]
v_exp_f32 v230, v230
v_cvt_pk_bf16_f32 v92, v248, v249
v_mfma_f32_16x16x32_bf16 v[212:215], a[204:207], v[184:187], v[56:59]
ds_read_b128 a[168:171], v38 offset:28672
v_exp_f32 v231, v231
v_mfma_f32_16x16x32_bf16 v[212:215], a[200:203], v[168:171], v[212:215]
buffer_load_dwordx4 v35, s[12:15], s21 offen offset:3072 lds
v_exp_f32 v236, v236
v_cvt_pk_bf16_f32 v93, v250, v251
v_mfma_f32_16x16x32_bf16 v[212:215], a[196:199], v[152:155], v[212:215]
v_exp_f32 v237, v237
v_cvt_pk_bf16_f32 v70, v228, v229
v_mfma_f32_16x16x32_bf16 v[212:215], a[192:195], v[136:139], v[212:215]
ds_read_b128 a[172:175], v39 offset:28672
v_exp_f32 v238, v238
v_mfma_f32_16x16x32_bf16 v[204:207], a[192:195], v[132:135], v[52:55]
v_exp_f32 v239, v239
v_cvt_pk_bf16_f32 v71, v230, v231
v_mfma_f32_16x16x32_bf16 v[204:207], a[196:199], v[148:151], v[204:207]
s_add_u32 s21, s21, 16384
v_exp_f32 v244, v244
v_mfma_f32_16x16x32_bf16 v[204:207], a[200:203], v[164:167], v[204:207]
v_exp_f32 v245, v245
v_cvt_pk_bf16_f32 v78, v236, v237
v_mfma_f32_16x16x32_bf16 v[204:207], a[204:207], v[180:183], v[204:207]
v_exp_f32 v246, v246
v_mfma_f32_16x16x32_bf16 v[196:199], a[204:207], v[176:179], v[48:51]
v_exp_f32 v247, v247
v_cvt_pk_bf16_f32 v79, v238, v239
v_mfma_f32_16x16x32_bf16 v[196:199], a[200:203], v[160:163], v[196:199]
v_exp_f32 v252, v252
v_cvt_pk_bf16_f32 v97, v98, v99
v_cvt_pk_bf16_f32 v98, v100, v101
v_cvt_pk_bf16_f32 v99, v102, v103
v_pk_max_i16 v96, v96, 0
v_pk_max_i16 v97, v97, 0
v_pk_max_i16 v98, v98, 0
v_pk_max_i16 v99, v99, 0
buffer_store_dwordx4 v[96:99], v7, s[16:19], s44 offen offset:0 sc1
v_mfma_f32_16x16x32_bf16 v[196:199], a[196:199], v[144:147], v[196:199]
v_exp_f32 v253, v253
v_cvt_pk_bf16_f32 v86, v244, v245
v_mfma_f32_16x16x32_bf16 v[196:199], a[192:195], v[128:131], v[196:199]
v_exp_f32 v254, v254
v_cvt_pk_bf16_f32 v87, v246, v247
v_cvt_pk_bf16_f32 v94, v252, v253
v_exp_f32 v255, v255
s_nop 0
v_cvt_pk_bf16_f32 v95, v254, v255
s_waitcnt vmcnt(16) lgkmcnt(0)
s_barrier
v_mfma_f32_16x16x32_bf16 v[224:227], a[144:147], v[128:131], v[48:51]
ds_read_b64_tr_b16 a[176:177], v40 offset:16384
v_cvt_pk_bf16_f32 v104, v104, v105
v_mfma_f32_16x16x32_bf16 v[224:227], a[148:151], v[144:147], v[224:227]
s_add_u32 m0, s24, 16384
v_exp_f32 v192, v192
v_mfma_f32_16x16x32_bf16 v[224:227], a[152:155], v[160:163], v[224:227]
ds_read_b64_tr_b16 a[178:179], v40 offset:20480
v_cvt_pk_bf16_f32 v105, v106, v107
v_mfma_f32_16x16x32_bf16 v[224:227], a[156:159], v[176:179], v[224:227]
v_exp_f32 v193, v193
v_mfma_f32_16x16x32_bf16 v[232:235], a[156:159], v[180:183], v[52:55]
ds_read_b64_tr_b16 a[180:181], v40 offset:24576
ds_read_b64_tr_b16 a[182:183], v40 offset:28672
v_mfma_f32_16x16x32_bf16 v[232:235], a[152:155], v[164:167], v[232:235]
v_exp_f32 v194, v194
v_mfma_f32_16x16x32_bf16 v[232:235], a[148:151], v[148:151], v[232:235]
ds_read_b64_tr_b16 a[184:185], v41 offset:16384
v_cvt_pk_bf16_f32 v96, v192, v193
v_mfma_f32_16x16x32_bf16 v[232:235], a[144:147], v[132:135], v[232:235]
v_exp_f32 v195, v195
v_mfma_f32_16x16x32_bf16 v[240:243], a[144:147], v[136:139], v[56:59]
ds_read_b64_tr_b16 a[186:187], v41 offset:20480
v_cvt_pk_bf16_f32 v97, v194, v195
v_mfma_f32_16x16x32_bf16 v[240:243], a[148:151], v[152:155], v[240:243]
v_exp_f32 v196, v196
v_mfma_f32_16x16x32_bf16 v[240:243], a[152:155], v[168:171], v[240:243]
ds_read_b64_tr_b16 a[188:189], v41 offset:24576
ds_read_b64_tr_b16 a[190:191], v41 offset:28672
v_mfma_f32_16x16x32_bf16 v[240:243], a[156:159], v[184:187], v[240:243]
v_exp_f32 v197, v197
v_mfma_f32_16x16x32_bf16 v[248:251], a[156:159], v[188:191], v[60:63]
ds_read_b64_tr_b16 a[192:193], v42 offset:16384
v_cvt_pk_bf16_f32 v106, v108, v109
v_mfma_f32_16x16x32_bf16 v[248:251], a[152:155], v[172:175], v[248:251]
buffer_load_dwordx4 v30, s[8:11], s20 offen offset:0 lds
v_mfma_f32_16x16x32_bf16 v[248:251], a[148:151], v[156:159], v[248:251]
v_cvt_pk_bf16_f32 v107, v110, v111
v_pk_max_i16 v104, v104, 0
v_pk_max_i16 v105, v105, 0
v_pk_max_i16 v106, v106, 0
v_pk_max_i16 v107, v107, 0
buffer_store_dwordx4 v[104:107], v7, s[16:19], s44 offen offset:1024 sc1
v_mfma_f32_16x16x32_bf16 v[248:251], a[144:147], v[140:143], v[248:251]
ds_read_b64_tr_b16 a[194:195], v42 offset:20480
v_exp_f32 v198, v198
v_mfma_f32_16x16x32_bf16 v[252:255], a[160:163], v[140:143], v[60:63]
v_exp_f32 v199, v199
v_mfma_f32_16x16x32_bf16 v[252:255], a[164:167], v[156:159], v[252:255]
ds_read_b64_tr_b16 a[196:197], v42 offset:24576
v_cvt_pk_bf16_f32 v98, v196, v197
v_mfma_f32_16x16x32_bf16 v[252:255], a[168:171], v[172:175], v[252:255]
ds_read_b64_tr_b16 a[198:199], v42 offset:28672
ds_read_b64_tr_b16 a[200:201], v43 offset:16384
v_mfma_f32_16x16x32_bf16 v[252:255], a[172:175], v[188:191], v[252:255]
v_exp_f32 v200, v200
v_mfma_f32_16x16x32_bf16 v[244:247], a[172:175], v[184:187], v[56:59]
v_exp_f32 v201, v201
v_mfma_f32_16x16x32_bf16 v[244:247], a[168:171], v[168:171], v[244:247]
ds_read_b64_tr_b16 a[202:203], v43 offset:20480
v_cvt_pk_bf16_f32 v99, v198, v199
v_mfma_f32_16x16x32_bf16 v[244:247], a[164:167], v[152:155], v[244:247]
v_exp_f32 v202, v202
v_mfma_f32_16x16x32_bf16 v[244:247], a[160:163], v[136:139], v[244:247]
ds_read_b64_tr_b16 a[204:205], v43 offset:24576
ds_read_b64_tr_b16 a[206:207], v43 offset:28672
v_mfma_f32_16x16x32_bf16 v[236:239], a[160:163], v[132:135], v[52:55]
buffer_load_dwordx4 v31, s[8:11], s20 offen offset:1024 lds
v_mfma_f32_16x16x32_bf16 v[236:239], a[164:167], v[148:151], v[236:239]
v_exp_f32 v203, v203
v_cvt_pk_bf16_f32 v104, v200, v201
v_mfma_f32_16x16x32_bf16 v[236:239], a[168:171], v[164:167], v[236:239]
v_exp_f32 v204, v204
v_mfma_f32_16x16x32_bf16 v[236:239], a[172:175], v[180:183], v[236:239]
v_exp_f32 v205, v205
v_mfma_f32_16x16x32_bf16 v[228:231], a[172:175], v[176:179], v[48:51]
v_cvt_pk_bf16_f32 v105, v202, v203
v_cvt_pk_bf16_f32 v112, v112, v113
v_mfma_f32_16x16x32_bf16 v[228:231], a[168:171], v[160:163], v[228:231]
v_cvt_pk_bf16_f32 v113, v114, v115
v_cvt_pk_bf16_f32 v114, v116, v117
v_mfma_f32_16x16x32_bf16 v[228:231], a[164:167], v[144:147], v[228:231]
v_cvt_pk_bf16_f32 v115, v118, v119
v_pk_max_i16 v112, v112, 0
v_pk_max_i16 v113, v113, 0
v_pk_max_i16 v114, v114, 0
v_pk_max_i16 v115, v115, 0
buffer_store_dwordx4 v[112:115], v7, s[16:19], s44 offen offset:2048 sc1
v_mfma_f32_16x16x32_bf16 v[228:231], a[160:163], v[128:131], v[228:231]
s_waitcnt lgkmcnt(0)
v_exp_f32 v206, v206
v_mfma_f32_16x16x32_bf16 a[0:3], v[64:67], a[176:179], 0
v_exp_f32 v207, v207
v_mfma_f32_16x16x32_bf16 a[0:3], v[68:71], a[180:183], a[0:3]
ds_read_b128 a[144:147], v36 offset:32768
v_cvt_pk_bf16_f32 v106, v204, v205
v_mfma_f32_16x16x32_bf16 a[4:7], v[76:79], a[180:183], 0
buffer_load_dwordx4 v32, s[8:11], s20 offen offset:2048 lds
v_mfma_f32_16x16x32_bf16 a[4:7], v[72:75], a[176:179], a[4:7]
v_exp_f32 v208, v208
v_mfma_f32_16x16x32_bf16 a[8:11], v[80:83], a[176:179], 0
v_exp_f32 v209, v209
v_mfma_f32_16x16x32_bf16 a[8:11], v[84:87], a[180:183], a[8:11]
ds_read_b128 a[148:151], v37 offset:32768
v_cvt_pk_bf16_f32 v107, v206, v207
v_mfma_f32_16x16x32_bf16 a[12:15], v[92:95], a[180:183], 0
v_exp_f32 v210, v210
v_mfma_f32_16x16x32_bf16 a[12:15], v[88:91], a[176:179], a[12:15]
ds_read_b128 a[152:155], v38 offset:32768
v_cvt_pk_bf16_f32 v112, v208, v209
v_mfma_f32_16x16x32_bf16 a[28:31], v[88:91], a[184:187], 0
v_exp_f32 v211, v211
v_mfma_f32_16x16x32_bf16 a[28:31], v[92:95], a[188:191], a[28:31]
v_exp_f32 v212, v212
v_mfma_f32_16x16x32_bf16 a[24:27], v[84:87], a[188:191], 0
ds_read_b128 a[156:159], v39 offset:32768
v_cvt_pk_bf16_f32 v113, v210, v211
v_mfma_f32_16x16x32_bf16 a[24:27], v[80:83], a[184:187], a[24:27]
buffer_load_dwordx4 v33, s[8:11], s20 offen offset:3072 lds
v_mfma_f32_16x16x32_bf16 a[20:23], v[72:75], a[184:187], 0
v_exp_f32 v213, v213
v_mfma_f32_16x16x32_bf16 a[20:23], v[76:79], a[188:191], a[20:23]
v_cvt_pk_bf16_f32 v120, v120, v121
v_cvt_pk_bf16_f32 v121, v122, v123
v_mfma_f32_16x16x32_bf16 a[16:19], v[68:71], a[188:191], 0
v_cvt_pk_bf16_f32 v122, v124, v125
v_cvt_pk_bf16_f32 v123, v126, v127
v_pk_max_i16 v120, v120, 0
v_pk_max_i16 v121, v121, 0
v_pk_max_i16 v122, v122, 0
v_pk_max_i16 v123, v123, 0
buffer_store_dwordx4 v[120:123], v7, s[16:19], s44 offen offset:3072 sc1
v_mfma_f32_16x16x32_bf16 a[16:19], v[64:67], a[184:187], a[16:19]
ds_read_b128 a[160:163], v36 offset:36864
v_exp_f32 v214, v214
v_mfma_f32_16x16x32_bf16 a[32:35], v[64:67], a[192:195], 0
v_exp_f32 v215, v215
v_mfma_f32_16x16x32_bf16 a[32:35], v[68:71], a[196:199], a[32:35]
ds_read_b128 a[164:167], v37 offset:36864
v_cvt_pk_bf16_f32 v114, v212, v213
v_mfma_f32_16x16x32_bf16 a[36:39], v[76:79], a[196:199], 0
v_exp_f32 v216, v216
v_mfma_f32_16x16x32_bf16 a[36:39], v[72:75], a[192:195], a[36:39]
s_add_u32 s20, s20, 16384
v_exp_f32 v217, v217
v_mfma_f32_16x16x32_bf16 a[40:43], v[80:83], a[192:195], 0
ds_read_b128 a[168:171], v38 offset:36864
v_cvt_pk_bf16_f32 v115, v214, v215
v_mfma_f32_16x16x32_bf16 a[40:43], v[84:87], a[196:199], a[40:43]
v_exp_f32 v218, v218
v_mfma_f32_16x16x32_bf16 a[44:47], v[92:95], a[196:199], 0
ds_read_b128 a[172:175], v39 offset:36864
v_cvt_pk_bf16_f32 v120, v216, v217
v_mfma_f32_16x16x32_bf16 a[44:47], v[88:91], a[192:195], a[44:47]
v_exp_f32 v219, v219
v_mfma_f32_16x16x32_bf16 a[60:63], v[88:91], a[200:203], 0
v_bfe_u32 v16, v0, 1, 1
v_add_u32 v16, -1, v16
v_mfma_f32_16x16x32_bf16 a[60:63], v[92:95], a[204:207], a[60:63]
v_and_b32 v16, 0x3f803f80, v16
v_mov_b32 v17, v16
v_mfma_f32_16x16x32_bf16 a[56:59], v[84:87], a[204:207], 0
v_mov_b32 v18, v16
v_mov_b32 v19, v16
v_bfe_i32 v26, v0, 0, 1
v_and_b32 v26, 0xaaaaaaaa, v26
v_or_b32 v26, 0x44444444, v26
v_accvgpr_write_b32 a128, 0
v_accvgpr_write_b32 a129, 0
v_accvgpr_write_b32 a132, 0
v_accvgpr_write_b32 a133, 0
v_accvgpr_write_b32 a136, 0
v_accvgpr_write_b32 a137, 0
v_accvgpr_write_b32 a140, 0
v_accvgpr_write_b32 a141, 0
v_mfma_f32_16x16x32_bf16 a[56:59], v[80:83], a[200:203], a[56:59]
v_exp_f32 v220, v220
v_mfma_f32_16x16x32_bf16 a[52:55], v[72:75], a[200:203], 0
v_exp_f32 v221, v221
v_mfma_f32_16x16x32_bf16 a[52:55], v[76:79], a[204:207], a[52:55]
v_cvt_pk_bf16_f32 v121, v218, v219
v_cvt_pk_bf16_f32 v122, v220, v221
v_mfma_f32_16x16x32_bf16 a[48:51], v[68:71], a[204:207], 0
v_exp_f32 v222, v222
v_mfma_f32_16x16x32_bf16 a[48:51], v[64:67], a[200:203], a[48:51]
v_exp_f32 v223, v223
v_smfmac_f32_16x16x64_bf16 a[128:131], v[16:19], v[64:71], v26
v_cvt_pk_bf16_f32 v123, v222, v223
v_smfmac_f32_16x16x64_bf16 a[132:135], v[16:19], v[72:79], v26
s_waitcnt lgkmcnt(0)
M_main:
v_mfma_f32_16x16x32_bf16 v[192:195], a[144:147], v[128:131], v[48:51]
s_load_dwordx2 s[28:29], s[0:1], 56
s_load_dwordx2 s[32:33], s[0:1], 32
ds_read_b64_tr_b16 a[176:177], v44 offset:16384
v_mfma_f32_16x16x32_bf16 v[192:195], a[148:151], v[144:147], v[192:195]
s_add_u32 m0, s24, 114688
v_exp_f32 v224, v224
v_mfma_f32_16x16x32_bf16 v[192:195], a[152:155], v[160:163], v[192:195]
s_mov_b32 s30, 5308416
s_mov_b32 s34, 4718592
ds_read_b64_tr_b16 a[178:179], v44 offset:20480
v_mfma_f32_16x16x32_bf16 v[192:195], a[156:159], v[176:179], v[192:195]
s_lshr_b32 s3, s2, 3
v_exp_f32 v225, v225
v_mfma_f32_16x16x32_bf16 v[200:203], a[156:159], v[180:183], v[52:55]
s_lshl_b32 s3, s3, 2
ds_read_b64_tr_b16 a[180:181], v44 offset:24576
ds_read_b64_tr_b16 a[182:183], v44 offset:28672
v_mfma_f32_16x16x32_bf16 v[200:203], a[152:155], v[164:167], v[200:203]
s_add_u32 s3, s3, s23
v_exp_f32 v226, v226
v_mfma_f32_16x16x32_bf16 v[200:203], a[148:151], v[148:151], v[200:203]
s_mul_i32 s36, s3, 4608
ds_read_b64_tr_b16 a[184:185], v45 offset:16384
v_cvt_pk_bf16_f32 v100, v224, v225
v_mfma_f32_16x16x32_bf16 v[200:203], a[144:147], v[132:135], v[200:203]
s_and_b32 s27, s2, 7
v_exp_f32 v227, v227
v_mfma_f32_16x16x32_bf16 v[208:211], a[144:147], v[136:139], v[56:59]
s_mul_i32 s27, s27, 589824
ds_read_b64_tr_b16 a[186:187], v45 offset:20480
v_cvt_pk_bf16_f32 v101, v226, v227
v_mfma_f32_16x16x32_bf16 v[208:211], a[148:151], v[152:155], v[208:211]
s_add_u32 s36, s36, s27
v_exp_f32 v228, v228
v_mfma_f32_16x16x32_bf16 v[208:211], a[152:155], v[168:171], v[208:211]
s_mul_i32 s37, s3, 576
ds_read_b64_tr_b16 a[188:189], v45 offset:24576
ds_read_b64_tr_b16 a[190:191], v45 offset:28672
v_mfma_f32_16x16x32_bf16 v[208:211], a[156:159], v[184:187], v[208:211]
s_and_b32 s27, s2, 7
v_exp_f32 v229, v229
v_mfma_f32_16x16x32_bf16 v[216:219], a[156:159], v[188:191], v[60:63]
s_mul_i32 s27, s27, 73728
ds_read_b64_tr_b16 a[192:193], v46 offset:16384
v_cvt_pk_bf16_f32 v102, v228, v229
v_mfma_f32_16x16x32_bf16 v[216:219], a[152:155], v[172:175], v[216:219]
s_add_u32 s37, s37, s27
buffer_load_dwordx4 v34, s[12:15], s21 offen offset:0 lds
v_mfma_f32_16x16x32_bf16 v[216:219], a[148:151], v[156:159], v[216:219]
s_add_u32 s37, s37, 4718592
v_exp_f32 v230, v230
v_mfma_f32_16x16x32_bf16 v[216:219], a[144:147], v[140:143], v[216:219]
ds_read_b64_tr_b16 a[194:195], v46 offset:20480
ds_read_b64_tr_b16 a[196:197], v46 offset:24576
v_mfma_f32_16x16x32_bf16 v[220:223], a[160:163], v[140:143], v[60:63]
v_exp_f32 v231, v231
v_mfma_f32_16x16x32_bf16 v[220:223], a[164:167], v[156:159], v[220:223]
ds_read_b64_tr_b16 a[198:199], v46 offset:28672
v_cvt_pk_bf16_f32 v103, v230, v231
v_mfma_f32_16x16x32_bf16 v[220:223], a[168:171], v[172:175], v[220:223]
v_exp_f32 v232, v232
v_mfma_f32_16x16x32_bf16 v[220:223], a[172:175], v[188:191], v[220:223]
ds_read_b64_tr_b16 a[200:201], v47 offset:16384
ds_read_b64_tr_b16 a[202:203], v47 offset:20480
v_mfma_f32_16x16x32_bf16 v[212:215], a[172:175], v[184:187], v[56:59]
v_exp_f32 v233, v233
v_mfma_f32_16x16x32_bf16 v[212:215], a[168:171], v[168:171], v[212:215]
v_exp_f32 v234, v234
v_mfma_f32_16x16x32_bf16 v[212:215], a[164:167], v[152:155], v[212:215]
ds_read_b64_tr_b16 a[204:205], v47 offset:24576
ds_read_b64_tr_b16 a[206:207], v47 offset:28672
v_mfma_f32_16x16x32_bf16 v[212:215], a[160:163], v[136:139], v[212:215]
buffer_load_dwordx4 v35, s[12:15], s21 offen offset:1024 lds
v_mfma_f32_16x16x32_bf16 v[204:207], a[160:163], v[132:135], v[52:55]
v_exp_f32 v235, v235
v_mfma_f32_16x16x32_bf16 v[204:207], a[164:167], v[148:151], v[204:207]
v_cvt_pk_bf16_f32 v108, v232, v233
v_cvt_pk_bf16_f32 v109, v234, v235
v_mfma_f32_16x16x32_bf16 v[204:207], a[168:171], v[164:167], v[204:207]
v_exp_f32 v236, v236
v_mfma_f32_16x16x32_bf16 v[204:207], a[172:175], v[180:183], v[204:207]
v_exp_f32 v237, v237
v_mfma_f32_16x16x32_bf16 v[196:199], a[172:175], v[176:179], v[48:51]
v_min_u32 v28, 5, v0
v_lshlrev_b32 v28, 7, v28
v_mfma_f32_16x16x32_bf16 v[196:199], a[168:171], v[160:163], v[196:199]
s_getpc_b64 s[64:65]
M_pc2:
s_add_u32 s64, s64, M_tail-M_pc2
s_addc_u32 s65, s65, 0
v_mfma_f32_16x16x32_bf16 v[196:199], a[164:167], v[144:147], v[196:199]
s_lshl_b32 s3, s3, 9
v_lshl_add_u32 v6, v0, 3, s3
v_min_u32 v6, M_end-M_tail-16, v6
s_mov_b32 s22, 0
v_mfma_f32_16x16x32_bf16 v[196:199], a[160:163], v[128:131], v[196:199]
s_waitcnt lgkmcnt(0)
v_exp_f32 v238, v238
v_mfma_f32_16x16x32_bf16 a[64:67], v[64:67], a[176:179], 0
v_exp_f32 v239, v239
v_mfma_f32_16x16x32_bf16 a[64:67], v[68:71], a[180:183], a[64:67]
ds_read_b128 a[144:147], v36 offset:40960
v_cvt_pk_bf16_f32 v110, v236, v237
v_mfma_f32_16x16x32_bf16 a[68:71], v[76:79], a[180:183], 0
buffer_load_dwordx4 v34, s[12:15], s21 offen offset:2048 lds
v_mfma_f32_16x16x32_bf16 a[68:71], v[72:75], a[176:179], a[68:71]
v_exp_f32 v240, v240
v_mfma_f32_16x16x32_bf16 a[72:75], v[80:83], a[176:179], 0
v_exp_f32 v241, v241
v_mfma_f32_16x16x32_bf16 a[72:75], v[84:87], a[180:183], a[72:75]
ds_read_b128 a[148:151], v37 offset:40960
v_cvt_pk_bf16_f32 v111, v238, v239
v_mfma_f32_16x16x32_bf16 a[76:79], v[92:95], a[180:183], 0
v_exp_f32 v242, v242
v_mfma_f32_16x16x32_bf16 a[76:79], v[88:91], a[176:179], a[76:79]
ds_read_b128 a[152:155], v38 offset:40960
v_cvt_pk_bf16_f32 v116, v240, v241
v_mfma_f32_16x16x32_bf16 a[92:95], v[88:91], a[184:187], 0
v_exp_f32 v243, v243
v_mfma_f32_16x16x32_bf16 a[92:95], v[92:95], a[188:191], a[92:95]
v_exp_f32 v244, v244
v_mfma_f32_16x16x32_bf16 a[88:91], v[84:87], a[188:191], 0
ds_read_b128 a[156:159], v39 offset:40960
v_cvt_pk_bf16_f32 v117, v242, v243
v_mfma_f32_16x16x32_bf16 a[88:91], v[80:83], a[184:187], a[88:91]
buffer_load_dwordx4 v35, s[12:15], s21 offen offset:3072 lds
v_mfma_f32_16x16x32_bf16 a[84:87], v[72:75], a[184:187], 0
v_exp_f32 v245, v245
v_mfma_f32_16x16x32_bf16 a[84:87], v[76:79], a[188:191], a[84:87]
v_exp_f32 v246, v246
v_mfma_f32_16x16x32_bf16 a[80:83], v[68:71], a[188:191], 0
ds_read_b128 a[160:163], v36 offset:45056
v_cvt_pk_bf16_f32 v118, v244, v245
v_mfma_f32_16x16x32_bf16 a[80:83], v[64:67], a[184:187], a[80:83]
v_exp_f32 v247, v247
v_mfma_f32_16x16x32_bf16 a[96:99], v[64:67], a[192:195], 0
ds_read_b128 a[164:167], v37 offset:45056
v_cvt_pk_bf16_f32 v119, v246, v247
v_mfma_f32_16x16x32_bf16 a[96:99], v[68:71], a[196:199], a[96:99]
v_exp_f32 v248, v248
v_mfma_f32_16x16x32_bf16 a[100:103], v[76:79], a[196:199], 0
v_exp_f32 v249, v249
v_mfma_f32_16x16x32_bf16 a[100:103], v[72:75], a[192:195], a[100:103]
s_add_u32 s21, s21, 16384
ds_read_b128 a[168:171], v38 offset:45056
v_cvt_pk_bf16_f32 v124, v248, v249
v_mfma_f32_16x16x32_bf16 a[104:107], v[80:83], a[192:195], 0
v_exp_f32 v250, v250
v_mfma_f32_16x16x32_bf16 a[104:107], v[84:87], a[196:199], a[104:107]
buffer_load_dword a255, v28, s[28:31], s37 offen
v_mfma_f32_16x16x32_bf16 a[108:111], v[92:95], a[196:199], 0
ds_read_b128 a[172:175], v39 offset:45056
v_mfma_f32_16x16x32_bf16 a[108:111], v[88:91], a[192:195], a[108:111]
v_exp_f32 v251, v251
v_mfma_f32_16x16x32_bf16 a[124:127], v[88:91], a[200:203], 0
v_exp_f32 v252, v252
v_mfma_f32_16x16x32_bf16 a[124:127], v[92:95], a[204:207], a[124:127]
v_cvt_pk_bf16_f32 v125, v250, v251
v_mfma_f32_16x16x32_bf16 a[120:123], v[84:87], a[204:207], 0
v_exp_f32 v253, v253
v_mfma_f32_16x16x32_bf16 a[120:123], v[80:83], a[200:203], a[120:123]
s_cmp_eq_u32 s54, 0
s_cselect_b64 s[44:45], s[28:29], s[32:33]
s_cselect_b32 s46, s30, s34
v_mfma_f32_16x16x32_bf16 a[116:119], v[72:75], a[200:203], 0
s_mov_b32 s47, 0x20000
v_exp_f32 v254, v254
v_mfma_f32_16x16x32_bf16 a[116:119], v[76:79], a[204:207], a[116:119]
s_cmp_eq_u32 s54, 0
s_cselect_b32 s48, 2097152, 0
s_add_u32 s48, s48, s41
v_mfma_f32_16x16x32_bf16 a[112:115], v[68:71], a[204:207], 0
s_add_u32 s48, s48, 23068672
s_cmp_eq_u32 s54, 0
s_cselect_b32 s49, s48, s18
v_mfma_f32_16x16x32_bf16 a[112:115], v[64:67], a[200:203], a[112:115]
s_lshr_b32 s42, s25, 3
s_add_u32 s42, s42, 32
s_mul_i32 s27, s23, 14336
v_smfmac_f32_16x16x64_bf16 a[136:139], v[16:19], v[80:87], v26
s_lshl_b32 s3, s52, 8
s_add_u32 s27, s27, s3
v_lshrrev_b32 v4, 4, v0
v_mul_u32_u24 v4, 896, v4
v_add3_u32 v21, v4, v34, s27
s_add_u32 s27, s27, 3584
v_add3_u32 v22, v4, v35, s27
v_add_u32 v23, 7168, v21
v_add_u32 v24, 7168, v22
s_mul_i32 s27, s23, 36864
s_lshl_b32 s3, s52, 5
s_add_u32 s27, s27, s3
s_add_u32 s27, s27, 1024
v_lshrrev_b32 v4, 1, v0
v_mul_u32_u24 v4, 1120, v4
v_add3_u32 v25, v4, v7, s27
v_and_b32 v29, 31, v0
v_lshlrev_b32 v29, 7, v29
s_lshl_b32 s38, s26, 12
s_add_u32 s38, s38, 2883648
s_lshl_b32 s37, s25, 7
s_add_u32 s37, s37, s38
v_mov_b32 v2, s66
v_mov_b32 v3, s67
v_or_b32 v1, s23, v0
v_min_u32 v1, 1, v1
v_lshlrev_b32 v1, 28, v1
v_smfmac_f32_16x16x64_bf16 a[140:143], v[16:19], v[88:95], v26
v_exp_f32 v255, v255
v_cvt_pk_bf16_f32 v126, v252, v253
v_cvt_pk_bf16_f32 v127, v254, v255
s_waitcnt vmcnt(16) lgkmcnt(0)
s_barrier
.p2align 6
M_loop:
v_mfma_f32_16x16x32_bf16 v[224:227], a[144:147], v[128:131], v[48:51]
ds_read_b64_tr_b16 a[176:177], v40 offset:0
v_mfma_f32_16x16x32_bf16 v[224:227], a[148:151], v[144:147], v[224:227]
s_add_u32 m0, s24, 32768
v_exp_f32 v192, v192
v_mfma_f32_16x16x32_bf16 v[224:227], a[152:155], v[160:163], v[224:227]
ds_read_b64_tr_b16 a[178:179], v40 offset:4096
v_mfma_f32_16x16x32_bf16 v[224:227], a[156:159], v[176:179], v[224:227]
v_exp_f32 v193, v193
v_mfma_f32_16x16x32_bf16 v[232:235], a[156:159], v[180:183], v[52:55]
ds_read_b64_tr_b16 a[180:181], v40 offset:8192
ds_read_b64_tr_b16 a[182:183], v40 offset:12288
v_mfma_f32_16x16x32_bf16 v[232:235], a[152:155], v[164:167], v[232:235]
v_exp_f32 v194, v194
v_mfma_f32_16x16x32_bf16 v[232:235], a[148:151], v[148:151], v[232:235]
ds_read_b64_tr_b16 a[184:185], v41 offset:0
v_cvt_pk_bf16_f32 v64, v192, v193
v_mfma_f32_16x16x32_bf16 v[232:235], a[144:147], v[132:135], v[232:235]
v_exp_f32 v195, v195
v_mfma_f32_16x16x32_bf16 v[240:243], a[144:147], v[136:139], v[56:59]
ds_read_b64_tr_b16 a[186:187], v41 offset:4096
v_cvt_pk_bf16_f32 v65, v194, v195
v_mfma_f32_16x16x32_bf16 v[240:243], a[148:151], v[152:155], v[240:243]
v_exp_f32 v196, v196
v_mfma_f32_16x16x32_bf16 v[240:243], a[152:155], v[168:171], v[240:243]
ds_read_b64_tr_b16 a[188:189], v41 offset:8192
ds_read_b64_tr_b16 a[190:191], v41 offset:12288
v_mfma_f32_16x16x32_bf16 v[240:243], a[156:159], v[184:187], v[240:243]
buffer_load_dword a254, v28, s[28:31], s36 offen
v_mfma_f32_16x16x32_bf16 v[248:251], a[156:159], v[188:191], v[60:63]
v_exp_f32 v197, v197
v_mfma_f32_16x16x32_bf16 v[248:251], a[152:155], v[172:175], v[248:251]
ds_read_b64_tr_b16 a[192:193], v42 offset:0
ds_read_b64_tr_b16 a[194:195], v42 offset:4096
v_mfma_f32_16x16x32_bf16 v[248:251], a[148:151], v[156:159], v[248:251]
buffer_load_dwordx4 v30, s[8:11], s20 offen offset:0 lds
v_mfma_f32_16x16x32_bf16 v[248:251], a[144:147], v[140:143], v[248:251]
v_exp_f32 v198, v198
v_mfma_f32_16x16x32_bf16 v[252:255], a[160:163], v[140:143], v[60:63]
v_exp_f32 v199, v199
v_mfma_f32_16x16x32_bf16 v[252:255], a[164:167], v[156:159], v[252:255]
ds_read_b64_tr_b16 a[196:197], v42 offset:8192
v_cvt_pk_bf16_f32 v66, v196, v197
v_mfma_f32_16x16x32_bf16 v[252:255], a[168:171], v[172:175], v[252:255]
ds_read_b64_tr_b16 a[198:199], v42 offset:12288
ds_read_b64_tr_b16 a[200:201], v43 offset:0
v_mfma_f32_16x16x32_bf16 v[252:255], a[172:175], v[188:191], v[252:255]
v_exp_f32 v200, v200
v_mfma_f32_16x16x32_bf16 v[244:247], a[172:175], v[184:187], v[56:59]
v_exp_f32 v201, v201
v_mfma_f32_16x16x32_bf16 v[244:247], a[168:171], v[168:171], v[244:247]
ds_read_b64_tr_b16 a[202:203], v43 offset:4096
buffer_load_dword a253, v28, s[32:35], s36 offen
v_cvt_pk_bf16_f32 v67, v198, v199
v_mfma_f32_16x16x32_bf16 v[244:247], a[164:167], v[152:155], v[244:247]
v_exp_f32 v202, v202
v_mfma_f32_16x16x32_bf16 v[244:247], a[160:163], v[136:139], v[244:247]
ds_read_b64_tr_b16 a[204:205], v43 offset:8192
ds_read_b64_tr_b16 a[206:207], v43 offset:12288
v_mfma_f32_16x16x32_bf16 v[236:239], a[160:163], v[132:135], v[52:55]
buffer_load_dwordx4 v31, s[8:11], s20 offen offset:1024 lds
v_mfma_f32_16x16x32_bf16 v[236:239], a[164:167], v[148:151], v[236:239]
v_exp_f32 v203, v203
v_cvt_pk_bf16_f32 v72, v200, v201
v_mfma_f32_16x16x32_bf16 v[236:239], a[168:171], v[164:167], v[236:239]
v_exp_f32 v204, v204
v_mfma_f32_16x16x32_bf16 v[236:239], a[172:175], v[180:183], v[236:239]
v_exp_f32 v205, v205
v_mfma_f32_16x16x32_bf16 v[228:231], a[172:175], v[176:179], v[48:51]
v_cvt_pk_bf16_f32 v73, v202, v203
v_cvt_pk_bf16_f32 v74, v204, v205
v_mfma_f32_16x16x32_bf16 v[228:231], a[168:171], v[160:163], v[228:231]
s_add_u32 s36, s36, 768
v_exp_f32 v206, v206
v_mfma_f32_16x16x32_bf16 v[228:231], a[164:167], v[144:147], v[228:231]
v_exp_f32 v207, v207
v_mfma_f32_16x16x32_bf16 v[228:231], a[160:163], v[128:131], v[228:231]
s_waitcnt lgkmcnt(0)
buffer_load_dwordx4 v32, s[8:11], s20 offen offset:2048 lds
v_mfma_f32_16x16x32_bf16 a[0:3], v[96:99], a[176:179], a[0:3]
ds_read_b128 a[144:147], v36 offset:49152
v_cvt_pk_bf16_f32 v75, v206, v207
v_mfma_f32_16x16x32_bf16 a[0:3], v[100:103], a[180:183], a[0:3]
v_exp_f32 v208, v208
v_mfma_f32_16x16x32_bf16 a[4:7], v[108:111], a[180:183], a[4:7]
v_exp_f32 v209, v209
v_mfma_f32_16x16x32_bf16 a[4:7], v[104:107], a[176:179], a[4:7]
ds_read_b128 a[148:151], v37 offset:49152
v_cvt_pk_bf16_f32 v80, v208, v209
v_mfma_f32_16x16x32_bf16 a[8:11], v[112:115], a[176:179], a[8:11]
v_exp_f32 v210, v210
v_mfma_f32_16x16x32_bf16 a[8:11], v[116:119], a[180:183], a[8:11]
v_mfma_f32_16x16x32_bf16 a[12:15], v[124:127], a[180:183], a[12:15]
ds_read_b128 a[152:155], v38 offset:49152
v_mfma_f32_16x16x32_bf16 a[12:15], v[120:123], a[176:179], a[12:15]
v_exp_f32 v211, v211
v_mfma_f32_16x16x32_bf16 a[28:31], v[120:123], a[184:187], a[28:31]
global_load_dwordx2 a[250:251], v6, s[64:65]
v_mfma_f32_16x16x32_bf16 a[28:31], v[124:127], a[188:191], a[28:31]
v_exp_f32 v212, v212
v_mfma_f32_16x16x32_bf16 a[24:27], v[116:119], a[188:191], a[24:27]
ds_read_b128 a[156:159], v39 offset:49152
v_cvt_pk_bf16_f32 v81, v210, v211
v_mfma_f32_16x16x32_bf16 a[24:27], v[112:115], a[184:187], a[24:27]
buffer_load_dwordx4 v33, s[8:11], s20 offen offset:3072 lds
v_mfma_f32_16x16x32_bf16 a[20:23], v[104:107], a[184:187], a[20:23]
v_exp_f32 v213, v213
v_mfma_f32_16x16x32_bf16 a[20:23], v[108:111], a[188:191], a[20:23]
v_exp_f32 v214, v214
v_mfma_f32_16x16x32_bf16 a[16:19], v[100:103], a[188:191], a[16:19]
ds_read_b128 a[160:163], v36 offset:53248
v_cvt_pk_bf16_f32 v82, v212, v213
v_mfma_f32_16x16x32_bf16 a[16:19], v[96:99], a[184:187], a[16:19]
v_exp_f32 v215, v215
v_mfma_f32_16x16x32_bf16 a[32:35], v[96:99], a[192:195], a[32:35]
ds_read_b128 a[164:167], v37 offset:53248
v_cvt_pk_bf16_f32 v83, v214, v215
v_mfma_f32_16x16x32_bf16 a[32:35], v[100:103], a[196:199], a[32:35]
v_exp_f32 v216, v216
v_mfma_f32_16x16x32_bf16 a[36:39], v[108:111], a[196:199], a[36:39]
v_exp_f32 v217, v217
v_mfma_f32_16x16x32_bf16 a[36:39], v[104:107], a[192:195], a[36:39]
s_add_u32 s20, s20, 16384
ds_read_b128 a[168:171], v38 offset:53248
v_cvt_pk_bf16_f32 v88, v216, v217
v_mfma_f32_16x16x32_bf16 a[40:43], v[112:115], a[192:195], a[40:43]
v_exp_f32 v218, v218
v_mfma_f32_16x16x32_bf16 a[40:43], v[116:119], a[196:199], a[40:43]
v_mfma_f32_16x16x32_bf16 a[44:47], v[124:127], a[196:199], a[44:47]
ds_read_b128 a[172:175], v39 offset:53248
v_mfma_f32_16x16x32_bf16 a[44:47], v[120:123], a[192:195], a[44:47]
v_exp_f32 v219, v219
v_mfma_f32_16x16x32_bf16 a[60:63], v[120:123], a[200:203], a[60:63]
v_exp_f32 v220, v220
v_mfma_f32_16x16x32_bf16 a[60:63], v[124:127], a[204:207], a[60:63]
v_cvt_pk_bf16_f32 v89, v218, v219
v_mfma_f32_16x16x32_bf16 a[56:59], v[116:119], a[204:207], a[56:59]
v_exp_f32 v221, v221
v_mfma_f32_16x16x32_bf16 a[56:59], v[112:115], a[200:203], a[56:59]
v_cvt_pk_bf16_f32 v90, v220, v221
v_mfma_f32_16x16x32_bf16 a[52:55], v[104:107], a[200:203], a[52:55]
v_exp_f32 v222, v222
v_mfma_f32_16x16x32_bf16 a[52:55], v[108:111], a[204:207], a[52:55]
v_mfma_f32_16x16x32_bf16 a[48:51], v[100:103], a[204:207], a[48:51]
v_exp_f32 v223, v223
v_mfma_f32_16x16x32_bf16 a[48:51], v[96:99], a[200:203], a[48:51]
v_cvt_pk_bf16_f32 v91, v222, v223
v_smfmac_f32_16x16x64_bf16 a[128:131], v[16:19], v[96:103], v26
v_smfmac_f32_16x16x64_bf16 a[132:135], v[16:19], v[104:111], v26
s_waitcnt lgkmcnt(0)
v_mfma_f32_16x16x32_bf16 v[192:195], a[144:147], v[128:131], v[48:51]
ds_read_b64_tr_b16 a[176:177], v44 offset:0
v_mfma_f32_16x16x32_bf16 v[192:195], a[148:151], v[144:147], v[192:195]
s_add_u32 m0, s24, 81920
v_exp_f32 v224, v224
v_mfma_f32_16x16x32_bf16 v[192:195], a[152:155], v[160:163], v[192:195]
ds_read_b64_tr_b16 a[178:179], v44 offset:4096
v_mfma_f32_16x16x32_bf16 v[192:195], a[156:159], v[176:179], v[192:195]
v_exp_f32 v225, v225
v_mfma_f32_16x16x32_bf16 v[200:203], a[156:159], v[180:183], v[52:55]
ds_read_b64_tr_b16 a[180:181], v44 offset:8192
ds_read_b64_tr_b16 a[182:183], v44 offset:12288
v_mfma_f32_16x16x32_bf16 v[200:203], a[152:155], v[164:167], v[200:203]
v_exp_f32 v226, v226
v_mfma_f32_16x16x32_bf16 v[200:203], a[148:151], v[148:151], v[200:203]
ds_read_b64_tr_b16 a[184:185], v45 offset:0
v_cvt_pk_bf16_f32 v68, v224, v225
v_mfma_f32_16x16x32_bf16 v[200:203], a[144:147], v[132:135], v[200:203]
v_exp_f32 v227, v227
v_mfma_f32_16x16x32_bf16 v[208:211], a[144:147], v[136:139], v[56:59]
ds_read_b64_tr_b16 a[186:187], v45 offset:4096
v_cvt_pk_bf16_f32 v69, v226, v227
v_mfma_f32_16x16x32_bf16 v[208:211], a[148:151], v[152:155], v[208:211]
v_exp_f32 v228, v228
v_mfma_f32_16x16x32_bf16 v[208:211], a[152:155], v[168:171], v[208:211]
ds_read_b64_tr_b16 a[188:189], v45 offset:8192
ds_read_b64_tr_b16 a[190:191], v45 offset:12288
v_mfma_f32_16x16x32_bf16 v[208:211], a[156:159], v[184:187], v[208:211]
v_exp_f32 v229, v229
v_mfma_f32_16x16x32_bf16 v[216:219], a[156:159], v[188:191], v[60:63]
ds_read_b64_tr_b16 a[192:193], v46 offset:0
v_cvt_pk_bf16_f32 v70, v228, v229
v_mfma_f32_16x16x32_bf16 v[216:219], a[152:155], v[172:175], v[216:219]
buffer_load_dwordx4 v34, s[12:15], s21 offen offset:0 lds
v_mfma_f32_16x16x32_bf16 v[216:219], a[148:151], v[156:159], v[216:219]
v_exp_f32 v230, v230
v_mfma_f32_16x16x32_bf16 v[216:219], a[144:147], v[140:143], v[216:219]
ds_read_b64_tr_b16 a[194:195], v46 offset:4096
ds_read_b64_tr_b16 a[196:197], v46 offset:8192
v_mfma_f32_16x16x32_bf16 v[220:223], a[160:163], v[140:143], v[60:63]
v_exp_f32 v231, v231
v_mfma_f32_16x16x32_bf16 v[220:223], a[164:167], v[156:159], v[220:223]
ds_read_b64_tr_b16 a[198:199], v46 offset:12288
v_cvt_pk_bf16_f32 v71, v230, v231
v_mfma_f32_16x16x32_bf16 v[220:223], a[168:171], v[172:175], v[220:223]
v_exp_f32 v232, v232
v_mfma_f32_16x16x32_bf16 v[220:223], a[172:175], v[188:191], v[220:223]
ds_read_b64_tr_b16 a[200:201], v47 offset:0
ds_read_b64_tr_b16 a[202:203], v47 offset:4096
v_mfma_f32_16x16x32_bf16 v[212:215], a[172:175], v[184:187], v[56:59]
v_exp_f32 v233, v233
v_mfma_f32_16x16x32_bf16 v[212:215], a[168:171], v[168:171], v[212:215]
v_exp_f32 v234, v234
v_mfma_f32_16x16x32_bf16 v[212:215], a[164:167], v[152:155], v[212:215]
ds_read_b64_tr_b16 a[204:205], v47 offset:8192
ds_read_b64_tr_b16 a[206:207], v47 offset:12288
v_mfma_f32_16x16x32_bf16 v[212:215], a[160:163], v[136:139], v[212:215]
buffer_load_dwordx4 v35, s[12:15], s21 offen offset:1024 lds
v_mfma_f32_16x16x32_bf16 v[204:207], a[160:163], v[132:135], v[52:55]
v_exp_f32 v235, v235
v_mfma_f32_16x16x32_bf16 v[204:207], a[164:167], v[148:151], v[204:207]
v_cvt_pk_bf16_f32 v76, v232, v233
v_cvt_pk_bf16_f32 v77, v234, v235
v_mfma_f32_16x16x32_bf16 v[204:207], a[168:171], v[164:167], v[204:207]
v_exp_f32 v236, v236
v_mfma_f32_16x16x32_bf16 v[204:207], a[172:175], v[180:183], v[204:207]
v_exp_f32 v237, v237
v_mfma_f32_16x16x32_bf16 v[196:199], a[172:175], v[176:179], v[48:51]
v_exp_f32 v238, v238
v_mfma_f32_16x16x32_bf16 v[196:199], a[168:171], v[160:163], v[196:199]
v_cvt_pk_bf16_f32 v78, v236, v237
v_mfma_f32_16x16x32_bf16 v[196:199], a[164:167], v[144:147], v[196:199]
v_exp_f32 v239, v239
v_mfma_f32_16x16x32_bf16 v[196:199], a[160:163], v[128:131], v[196:199]
s_waitcnt lgkmcnt(0)
buffer_load_dwordx4 v34, s[12:15], s21 offen offset:2048 lds
v_mfma_f32_16x16x32_bf16 a[64:67], v[96:99], a[176:179], a[64:67]
ds_read_b128 a[144:147], v36 offset:57344
v_cvt_pk_bf16_f32 v79, v238, v239
v_mfma_f32_16x16x32_bf16 a[64:67], v[100:103], a[180:183], a[64:67]
v_exp_f32 v240, v240
v_mfma_f32_16x16x32_bf16 a[68:71], v[108:111], a[180:183], a[68:71]
v_exp_f32 v241, v241
v_mfma_f32_16x16x32_bf16 a[68:71], v[104:107], a[176:179], a[68:71]
ds_read_b128 a[148:151], v37 offset:57344
v_cvt_pk_bf16_f32 v84, v240, v241
v_mfma_f32_16x16x32_bf16 a[72:75], v[112:115], a[176:179], a[72:75]
v_exp_f32 v242, v242
v_mfma_f32_16x16x32_bf16 a[72:75], v[116:119], a[180:183], a[72:75]
v_mfma_f32_16x16x32_bf16 a[76:79], v[124:127], a[180:183], a[76:79]
ds_read_b128 a[152:155], v38 offset:57344
v_mfma_f32_16x16x32_bf16 a[76:79], v[120:123], a[176:179], a[76:79]
v_exp_f32 v243, v243
v_mfma_f32_16x16x32_bf16 a[92:95], v[120:123], a[184:187], a[92:95]
v_exp_f32 v244, v244
v_mfma_f32_16x16x32_bf16 a[92:95], v[124:127], a[188:191], a[92:95]
ds_read_b128 a[156:159], v39 offset:57344
v_cvt_pk_bf16_f32 v85, v242, v243
v_mfma_f32_16x16x32_bf16 a[88:91], v[116:119], a[188:191], a[88:91]
buffer_load_dwordx4 v35, s[12:15], s21 offen offset:3072 lds
v_mfma_f32_16x16x32_bf16 a[88:91], v[112:115], a[184:187], a[88:91]
v_exp_f32 v245, v245
v_mfma_f32_16x16x32_bf16 a[84:87], v[104:107], a[184:187], a[84:87]
v_exp_f32 v246, v246
v_mfma_f32_16x16x32_bf16 a[84:87], v[108:111], a[188:191], a[84:87]
ds_read_b128 a[160:163], v36 offset:61440
v_cvt_pk_bf16_f32 v86, v244, v245
v_mfma_f32_16x16x32_bf16 a[80:83], v[100:103], a[188:191], a[80:83]
v_exp_f32 v247, v247
v_mfma_f32_16x16x32_bf16 a[80:83], v[96:99], a[184:187], a[80:83]
v_cvt_pk_bf16_f32 v87, v246, v247
v_mfma_f32_16x16x32_bf16 a[96:99], v[96:99], a[192:195], a[96:99]
ds_read_b128 a[164:167], v37 offset:61440
v_mfma_f32_16x16x32_bf16 a[96:99], v[100:103], a[196:199], a[96:99]
v_exp_f32 v248, v248
v_mfma_f32_16x16x32_bf16 a[100:103], v[108:111], a[196:199], a[100:103]
v_exp_f32 v249, v249
v_mfma_f32_16x16x32_bf16 a[100:103], v[104:107], a[192:195], a[100:103]
s_add_u32 s21, s21, 16384
ds_read_b128 a[168:171], v38 offset:61440
v_cvt_pk_bf16_f32 v92, v248, v249
v_mfma_f32_16x16x32_bf16 a[104:107], v[112:115], a[192:195], a[104:107]
v_exp_f32 v250, v250
v_mfma_f32_16x16x32_bf16 a[104:107], v[116:119], a[196:199], a[104:107]
v_mfma_f32_16x16x32_bf16 a[108:111], v[124:127], a[196:199], a[108:111]
ds_read_b128 a[172:175], v39 offset:61440
v_mfma_f32_16x16x32_bf16 a[108:111], v[120:123], a[192:195], a[108:111]
v_exp_f32 v251, v251
v_mfma_f32_16x16x32_bf16 a[124:127], v[120:123], a[200:203], a[124:127]
v_exp_f32 v252, v252
v_mfma_f32_16x16x32_bf16 a[124:127], v[124:127], a[204:207], a[124:127]
v_cvt_pk_bf16_f32 v93, v250, v251
v_mfma_f32_16x16x32_bf16 a[120:123], v[116:119], a[204:207], a[120:123]
v_exp_f32 v253, v253
v_mfma_f32_16x16x32_bf16 a[120:123], v[112:115], a[200:203], a[120:123]
v_cvt_pk_bf16_f32 v94, v252, v253
v_mfma_f32_16x16x32_bf16 a[116:119], v[104:107], a[200:203], a[116:119]
v_exp_f32 v254, v254
v_mfma_f32_16x16x32_bf16 a[116:119], v[108:111], a[204:207], a[116:119]
v_mfma_f32_16x16x32_bf16 a[112:115], v[100:103], a[204:207], a[112:115]
v_exp_f32 v255, v255
v_mfma_f32_16x16x32_bf16 a[112:115], v[96:99], a[200:203], a[112:115]
v_cvt_pk_bf16_f32 v95, v254, v255
v_smfmac_f32_16x16x64_bf16 a[136:139], v[16:19], v[112:119], v26
v_smfmac_f32_16x16x64_bf16 a[140:143], v[16:19], v[120:127], v26
s_waitcnt vmcnt(19) lgkmcnt(0)
s_barrier
v_mfma_f32_16x16x32_bf16 v[224:227], a[144:147], v[128:131], v[48:51]
ds_read_b64_tr_b16 a[176:177], v40 offset:32768
v_mfma_f32_16x16x32_bf16 v[224:227], a[148:151], v[144:147], v[224:227]
s_add_u32 m0, s24, 49152
v_exp_f32 v192, v192
v_mfma_f32_16x16x32_bf16 v[224:227], a[152:155], v[160:163], v[224:227]
ds_read_b64_tr_b16 a[178:179], v40 offset:36864
v_mfma_f32_16x16x32_bf16 v[224:227], a[156:159], v[176:179], v[224:227]
v_exp_f32 v193, v193
v_mfma_f32_16x16x32_bf16 v[232:235], a[156:159], v[180:183], v[52:55]
ds_read_b64_tr_b16 a[180:181], v40 offset:40960
ds_read_b64_tr_b16 a[182:183], v40 offset:45056
v_mfma_f32_16x16x32_bf16 v[232:235], a[152:155], v[164:167], v[232:235]
v_exp_f32 v194, v194
v_mfma_f32_16x16x32_bf16 v[232:235], a[148:151], v[148:151], v[232:235]
ds_read_b64_tr_b16 a[184:185], v41 offset:32768
v_cvt_pk_bf16_f32 v96, v192, v193
v_mfma_f32_16x16x32_bf16 v[232:235], a[144:147], v[132:135], v[232:235]
v_exp_f32 v195, v195
v_mfma_f32_16x16x32_bf16 v[240:243], a[144:147], v[136:139], v[56:59]
ds_read_b64_tr_b16 a[186:187], v41 offset:36864
v_cvt_pk_bf16_f32 v97, v194, v195
v_mfma_f32_16x16x32_bf16 v[240:243], a[148:151], v[152:155], v[240:243]
v_exp_f32 v196, v196
v_mfma_f32_16x16x32_bf16 v[240:243], a[152:155], v[168:171], v[240:243]
ds_read_b64_tr_b16 a[188:189], v41 offset:40960
ds_read_b64_tr_b16 a[190:191], v41 offset:45056
v_mfma_f32_16x16x32_bf16 v[240:243], a[156:159], v[184:187], v[240:243]
v_exp_f32 v197, v197
v_mfma_f32_16x16x32_bf16 v[248:251], a[156:159], v[188:191], v[60:63]
ds_read_b64_tr_b16 a[192:193], v42 offset:32768
v_cvt_pk_bf16_f32 v98, v196, v197
v_mfma_f32_16x16x32_bf16 v[248:251], a[152:155], v[172:175], v[248:251]
buffer_load_dwordx4 v30, s[8:11], s20 offen offset:0 lds
v_mfma_f32_16x16x32_bf16 v[248:251], a[148:151], v[156:159], v[248:251]
v_exp_f32 v198, v198
v_mfma_f32_16x16x32_bf16 v[248:251], a[144:147], v[140:143], v[248:251]
ds_read_b64_tr_b16 a[194:195], v42 offset:36864
ds_read_b64_tr_b16 a[196:197], v42 offset:40960
v_mfma_f32_16x16x32_bf16 v[252:255], a[160:163], v[140:143], v[60:63]
v_exp_f32 v199, v199
v_mfma_f32_16x16x32_bf16 v[252:255], a[164:167], v[156:159], v[252:255]
ds_read_b64_tr_b16 a[198:199], v42 offset:45056
v_cvt_pk_bf16_f32 v99, v198, v199
v_mfma_f32_16x16x32_bf16 v[252:255], a[168:171], v[172:175], v[252:255]
v_exp_f32 v200, v200
v_mfma_f32_16x16x32_bf16 v[252:255], a[172:175], v[188:191], v[252:255]
ds_read_b64_tr_b16 a[200:201], v43 offset:32768
ds_read_b64_tr_b16 a[202:203], v43 offset:36864
v_mfma_f32_16x16x32_bf16 v[244:247], a[172:175], v[184:187], v[56:59]
v_exp_f32 v201, v201
v_mfma_f32_16x16x32_bf16 v[244:247], a[168:171], v[168:171], v[244:247]
v_exp_f32 v202, v202
v_mfma_f32_16x16x32_bf16 v[244:247], a[164:167], v[152:155], v[244:247]
ds_read_b64_tr_b16 a[204:205], v43 offset:40960
ds_read_b64_tr_b16 a[206:207], v43 offset:45056
v_mfma_f32_16x16x32_bf16 v[244:247], a[160:163], v[136:139], v[244:247]
buffer_load_dwordx4 v31, s[8:11], s20 offen offset:1024 lds
v_mfma_f32_16x16x32_bf16 v[236:239], a[160:163], v[132:135], v[52:55]
v_exp_f32 v203, v203
v_mfma_f32_16x16x32_bf16 v[236:239], a[164:167], v[148:151], v[236:239]
v_cvt_pk_bf16_f32 v104, v200, v201
v_cvt_pk_bf16_f32 v105, v202, v203
v_mfma_f32_16x16x32_bf16 v[236:239], a[168:171], v[164:167], v[236:239]
v_exp_f32 v204, v204
v_mfma_f32_16x16x32_bf16 v[236:239], a[172:175], v[180:183], v[236:239]
v_exp_f32 v205, v205
v_mfma_f32_16x16x32_bf16 v[228:231], a[172:175], v[176:179], v[48:51]
v_exp_f32 v206, v206
v_mfma_f32_16x16x32_bf16 v[228:231], a[168:171], v[160:163], v[228:231]
v_cvt_pk_bf16_f32 v106, v204, v205
v_mfma_f32_16x16x32_bf16 v[228:231], a[164:167], v[144:147], v[228:231]
v_exp_f32 v207, v207
v_mfma_f32_16x16x32_bf16 v[228:231], a[160:163], v[128:131], v[228:231]
s_waitcnt lgkmcnt(0)
buffer_load_dwordx4 v32, s[8:11], s20 offen offset:2048 lds
v_mfma_f32_16x16x32_bf16 a[0:3], v[64:67], a[176:179], a[0:3]
ds_read_b128 a[144:147], v36 offset:0
v_cvt_pk_bf16_f32 v107, v206, v207
v_mfma_f32_16x16x32_bf16 a[0:3], v[68:71], a[180:183], a[0:3]
v_exp_f32 v208, v208
v_mfma_f32_16x16x32_bf16 a[4:7], v[76:79], a[180:183], a[4:7]
v_exp_f32 v209, v209
v_mfma_f32_16x16x32_bf16 a[4:7], v[72:75], a[176:179], a[4:7]
ds_read_b128 a[148:151], v37 offset:0
v_cvt_pk_bf16_f32 v112, v208, v209
v_mfma_f32_16x16x32_bf16 a[8:11], v[80:83], a[176:179], a[8:11]
v_exp_f32 v210, v210
v_mfma_f32_16x16x32_bf16 a[8:11], v[84:87], a[180:183], a[8:11]
v_mfma_f32_16x16x32_bf16 a[12:15], v[92:95], a[180:183], a[12:15]
ds_read_b128 a[152:155], v38 offset:0
v_mfma_f32_16x16x32_bf16 a[12:15], v[88:91], a[176:179], a[12:15]
v_exp_f32 v211, v211
v_mfma_f32_16x16x32_bf16 a[28:31], v[88:91], a[184:187], a[28:31]
v_exp_f32 v212, v212
v_mfma_f32_16x16x32_bf16 a[28:31], v[92:95], a[188:191], a[28:31]
ds_read_b128 a[156:159], v39 offset:0
v_cvt_pk_bf16_f32 v113, v210, v211
v_mfma_f32_16x16x32_bf16 a[24:27], v[84:87], a[188:191], a[24:27]
buffer_load_dwordx4 v33, s[8:11], s20 offen offset:3072 lds
v_mfma_f32_16x16x32_bf16 a[24:27], v[80:83], a[184:187], a[24:27]
v_exp_f32 v213, v213
v_mfma_f32_16x16x32_bf16 a[20:23], v[72:75], a[184:187], a[20:23]
v_exp_f32 v214, v214
v_mfma_f32_16x16x32_bf16 a[20:23], v[76:79], a[188:191], a[20:23]
ds_read_b128 a[160:163], v36 offset:4096
v_cvt_pk_bf16_f32 v114, v212, v213
v_mfma_f32_16x16x32_bf16 a[16:19], v[68:71], a[188:191], a[16:19]
v_exp_f32 v215, v215
v_mfma_f32_16x16x32_bf16 a[16:19], v[64:67], a[184:187], a[16:19]
v_cvt_pk_bf16_f32 v115, v214, v215
v_mfma_f32_16x16x32_bf16 a[32:35], v[64:67], a[192:195], a[32:35]
ds_read_b128 a[164:167], v37 offset:4096
v_mfma_f32_16x16x32_bf16 a[32:35], v[68:71], a[196:199], a[32:35]
v_exp_f32 v216, v216
v_mfma_f32_16x16x32_bf16 a[36:39], v[76:79], a[196:199], a[36:39]
v_exp_f32 v217, v217
v_mfma_f32_16x16x32_bf16 a[36:39], v[72:75], a[192:195], a[36:39]
s_add_u32 s20, s20, 16384
ds_read_b128 a[168:171], v38 offset:4096
v_cvt_pk_bf16_f32 v120, v216, v217
v_mfma_f32_16x16x32_bf16 a[40:43], v[80:83], a[192:195], a[40:43]
v_exp_f32 v218, v218
v_mfma_f32_16x16x32_bf16 a[40:43], v[84:87], a[196:199], a[40:43]
v_mfma_f32_16x16x32_bf16 a[44:47], v[92:95], a[196:199], a[44:47]
ds_read_b128 a[172:175], v39 offset:4096
v_mfma_f32_16x16x32_bf16 a[44:47], v[88:91], a[192:195], a[44:47]
v_exp_f32 v219, v219
v_mfma_f32_16x16x32_bf16 a[60:63], v[88:91], a[200:203], a[60:63]
v_exp_f32 v220, v220
v_mfma_f32_16x16x32_bf16 a[60:63], v[92:95], a[204:207], a[60:63]
v_cvt_pk_bf16_f32 v121, v218, v219
v_mfma_f32_16x16x32_bf16 a[56:59], v[84:87], a[204:207], a[56:59]
v_exp_f32 v221, v221
v_mfma_f32_16x16x32_bf16 a[56:59], v[80:83], a[200:203], a[56:59]
v_cvt_pk_bf16_f32 v122, v220, v221
v_mfma_f32_16x16x32_bf16 a[52:55], v[72:75], a[200:203], a[52:55]
v_exp_f32 v222, v222
v_mfma_f32_16x16x32_bf16 a[52:55], v[76:79], a[204:207], a[52:55]
v_mfma_f32_16x16x32_bf16 a[48:51], v[68:71], a[204:207], a[48:51]
v_exp_f32 v223, v223
v_mfma_f32_16x16x32_bf16 a[48:51], v[64:67], a[200:203], a[48:51]
v_cvt_pk_bf16_f32 v123, v222, v223
v_smfmac_f32_16x16x64_bf16 a[128:131], v[16:19], v[64:71], v26
v_smfmac_f32_16x16x64_bf16 a[132:135], v[16:19], v[72:79], v26
s_waitcnt lgkmcnt(0)
v_mfma_f32_16x16x32_bf16 v[192:195], a[144:147], v[128:131], v[48:51]
ds_read_b64_tr_b16 a[176:177], v44 offset:32768
v_mfma_f32_16x16x32_bf16 v[192:195], a[148:151], v[144:147], v[192:195]
s_add_u32 m0, s24, 65536
v_exp_f32 v224, v224
v_mfma_f32_16x16x32_bf16 v[192:195], a[152:155], v[160:163], v[192:195]
ds_read_b64_tr_b16 a[178:179], v44 offset:36864
v_mfma_f32_16x16x32_bf16 v[192:195], a[156:159], v[176:179], v[192:195]
v_exp_f32 v225, v225
v_mfma_f32_16x16x32_bf16 v[200:203], a[156:159], v[180:183], v[52:55]
ds_read_b64_tr_b16 a[180:181], v44 offset:40960
ds_read_b64_tr_b16 a[182:183], v44 offset:45056
v_mfma_f32_16x16x32_bf16 v[200:203], a[152:155], v[164:167], v[200:203]
v_exp_f32 v226, v226
v_mfma_f32_16x16x32_bf16 v[200:203], a[148:151], v[148:151], v[200:203]
ds_read_b64_tr_b16 a[184:185], v45 offset:32768
v_cvt_pk_bf16_f32 v100, v224, v225
v_mfma_f32_16x16x32_bf16 v[200:203], a[144:147], v[132:135], v[200:203]
v_exp_f32 v227, v227
v_mfma_f32_16x16x32_bf16 v[208:211], a[144:147], v[136:139], v[56:59]
ds_read_b64_tr_b16 a[186:187], v45 offset:36864
v_cvt_pk_bf16_f32 v101, v226, v227
v_mfma_f32_16x16x32_bf16 v[208:211], a[148:151], v[152:155], v[208:211]
v_exp_f32 v228, v228
v_mfma_f32_16x16x32_bf16 v[208:211], a[152:155], v[168:171], v[208:211]
ds_read_b64_tr_b16 a[188:189], v45 offset:40960
ds_read_b64_tr_b16 a[190:191], v45 offset:45056
v_mfma_f32_16x16x32_bf16 v[208:211], a[156:159], v[184:187], v[208:211]
v_exp_f32 v229, v229
v_mfma_f32_16x16x32_bf16 v[216:219], a[156:159], v[188:191], v[60:63]
ds_read_b64_tr_b16 a[192:193], v46 offset:32768
v_cvt_pk_bf16_f32 v102, v228, v229
v_mfma_f32_16x16x32_bf16 v[216:219], a[152:155], v[172:175], v[216:219]
buffer_load_dwordx4 v34, s[12:15], s21 offen offset:0 lds
v_mfma_f32_16x16x32_bf16 v[216:219], a[148:151], v[156:159], v[216:219]
v_exp_f32 v230, v230
v_mfma_f32_16x16x32_bf16 v[216:219], a[144:147], v[140:143], v[216:219]
ds_read_b64_tr_b16 a[194:195], v46 offset:36864
ds_read_b64_tr_b16 a[196:197], v46 offset:40960
v_mfma_f32_16x16x32_bf16 v[220:223], a[160:163], v[140:143], v[60:63]
v_exp_f32 v231, v231
v_mfma_f32_16x16x32_bf16 v[220:223], a[164:167], v[156:159], v[220:223]
ds_read_b64_tr_b16 a[198:199], v46 offset:45056
v_cvt_pk_bf16_f32 v103, v230, v231
v_mfma_f32_16x16x32_bf16 v[220:223], a[168:171], v[172:175], v[220:223]
v_exp_f32 v232, v232
v_mfma_f32_16x16x32_bf16 v[220:223], a[172:175], v[188:191], v[220:223]
ds_read_b64_tr_b16 a[200:201], v47 offset:32768
ds_read_b64_tr_b16 a[202:203], v47 offset:36864
v_mfma_f32_16x16x32_bf16 v[212:215], a[172:175], v[184:187], v[56:59]
v_exp_f32 v233, v233
v_mfma_f32_16x16x32_bf16 v[212:215], a[168:171], v[168:171], v[212:215]
v_exp_f32 v234, v234
v_mfma_f32_16x16x32_bf16 v[212:215], a[164:167], v[152:155], v[212:215]
ds_read_b64_tr_b16 a[204:205], v47 offset:40960
ds_read_b64_tr_b16 a[206:207], v47 offset:45056
v_mfma_f32_16x16x32_bf16 v[212:215], a[160:163], v[136:139], v[212:215]
buffer_load_dwordx4 v35, s[12:15], s21 offen offset:1024 lds
v_mfma_f32_16x16x32_bf16 v[204:207], a[160:163], v[132:135], v[52:55]
v_exp_f32 v235, v235
v_mfma_f32_16x16x32_bf16 v[204:207], a[164:167], v[148:151], v[204:207]
v_cvt_pk_bf16_f32 v108, v232, v233
v_cvt_pk_bf16_f32 v109, v234, v235
v_mfma_f32_16x16x32_bf16 v[204:207], a[168:171], v[164:167], v[204:207]
v_exp_f32 v236, v236
v_mfma_f32_16x16x32_bf16 v[204:207], a[172:175], v[180:183], v[204:207]
v_exp_f32 v237, v237
v_mfma_f32_16x16x32_bf16 v[196:199], a[172:175], v[176:179], v[48:51]
v_exp_f32 v238, v238
v_mfma_f32_16x16x32_bf16 v[196:199], a[168:171], v[160:163], v[196:199]
v_cvt_pk_bf16_f32 v110, v236, v237
v_mfma_f32_16x16x32_bf16 v[196:199], a[164:167], v[144:147], v[196:199]
v_exp_f32 v239, v239
v_mfma_f32_16x16x32_bf16 v[196:199], a[160:163], v[128:131], v[196:199]
s_waitcnt lgkmcnt(0)
buffer_load_dwordx4 v34, s[12:15], s21 offen offset:2048 lds
v_mfma_f32_16x16x32_bf16 a[64:67], v[64:67], a[176:179], a[64:67]
ds_read_b128 a[144:147], v36 offset:8192
v_cvt_pk_bf16_f32 v111, v238, v239
v_mfma_f32_16x16x32_bf16 a[64:67], v[68:71], a[180:183], a[64:67]
v_exp_f32 v240, v240
v_mfma_f32_16x16x32_bf16 a[68:71], v[76:79], a[180:183], a[68:71]
v_exp_f32 v241, v241
v_mfma_f32_16x16x32_bf16 a[68:71], v[72:75], a[176:179], a[68:71]
ds_read_b128 a[148:151], v37 offset:8192
v_cvt_pk_bf16_f32 v116, v240, v241
v_mfma_f32_16x16x32_bf16 a[72:75], v[80:83], a[176:179], a[72:75]
v_exp_f32 v242, v242
v_mfma_f32_16x16x32_bf16 a[72:75], v[84:87], a[180:183], a[72:75]
v_mfma_f32_16x16x32_bf16 a[76:79], v[92:95], a[180:183], a[76:79]
ds_read_b128 a[152:155], v38 offset:8192
v_mfma_f32_16x16x32_bf16 a[76:79], v[88:91], a[176:179], a[76:79]
v_exp_f32 v243, v243
v_mfma_f32_16x16x32_bf16 a[92:95], v[88:91], a[184:187], a[92:95]
v_exp_f32 v244, v244
v_mfma_f32_16x16x32_bf16 a[92:95], v[92:95], a[188:191], a[92:95]
ds_read_b128 a[156:159], v39 offset:8192
v_cvt_pk_bf16_f32 v117, v242, v243
v_mfma_f32_16x16x32_bf16 a[88:91], v[84:87], a[188:191], a[88:91]
buffer_load_dwordx4 v35, s[12:15], s21 offen offset:3072 lds
v_mfma_f32_16x16x32_bf16 a[88:91], v[80:83], a[184:187], a[88:91]
v_exp_f32 v245, v245
v_mfma_f32_16x16x32_bf16 a[84:87], v[72:75], a[184:187], a[84:87]
v_exp_f32 v246, v246
v_mfma_f32_16x16x32_bf16 a[84:87], v[76:79], a[188:191], a[84:87]
ds_read_b128 a[160:163], v36 offset:12288
v_cvt_pk_bf16_f32 v118, v244, v245
v_mfma_f32_16x16x32_bf16 a[80:83], v[68:71], a[188:191], a[80:83]
v_exp_f32 v247, v247
v_mfma_f32_16x16x32_bf16 a[80:83], v[64:67], a[184:187], a[80:83]
v_cvt_pk_bf16_f32 v119, v246, v247
v_mfma_f32_16x16x32_bf16 a[96:99], v[64:67], a[192:195], a[96:99]
ds_read_b128 a[164:167], v37 offset:12288
v_mfma_f32_16x16x32_bf16 a[96:99], v[68:71], a[196:199], a[96:99]
v_exp_f32 v248, v248
v_mfma_f32_16x16x32_bf16 a[100:103], v[76:79], a[196:199], a[100:103]
v_exp_f32 v249, v249
v_mfma_f32_16x16x32_bf16 a[100:103], v[72:75], a[192:195], a[100:103]
s_add_u32 s21, s21, 16384
ds_read_b128 a[168:171], v38 offset:12288
v_cvt_pk_bf16_f32 v124, v248, v249
v_mfma_f32_16x16x32_bf16 a[104:107], v[80:83], a[192:195], a[104:107]
v_exp_f32 v250, v250
v_mfma_f32_16x16x32_bf16 a[104:107], v[84:87], a[196:199], a[104:107]
v_mfma_f32_16x16x32_bf16 a[108:111], v[92:95], a[196:199], a[108:111]
ds_read_b128 a[172:175], v39 offset:12288
v_mfma_f32_16x16x32_bf16 a[108:111], v[88:91], a[192:195], a[108:111]
v_exp_f32 v251, v251
v_mfma_f32_16x16x32_bf16 a[124:127], v[88:91], a[200:203], a[124:127]
v_exp_f32 v252, v252
v_mfma_f32_16x16x32_bf16 a[124:127], v[92:95], a[204:207], a[124:127]
v_cvt_pk_bf16_f32 v125, v250, v251
v_mfma_f32_16x16x32_bf16 a[120:123], v[84:87], a[204:207], a[120:123]
v_exp_f32 v253, v253
v_mfma_f32_16x16x32_bf16 a[120:123], v[80:83], a[200:203], a[120:123]
v_cvt_pk_bf16_f32 v126, v252, v253
v_mfma_f32_16x16x32_bf16 a[116:119], v[72:75], a[200:203], a[116:119]
v_exp_f32 v254, v254
v_mfma_f32_16x16x32_bf16 a[116:119], v[76:79], a[204:207], a[116:119]
v_mfma_f32_16x16x32_bf16 a[112:115], v[68:71], a[204:207], a[112:115]
v_exp_f32 v255, v255
v_mfma_f32_16x16x32_bf16 a[112:115], v[64:67], a[200:203], a[112:115]
v_cvt_pk_bf16_f32 v127, v254, v255
v_smfmac_f32_16x16x64_bf16 a[136:139], v[16:19], v[80:87], v26
v_smfmac_f32_16x16x64_bf16 a[140:143], v[16:19], v[88:95], v26
s_waitcnt vmcnt(19) lgkmcnt(0)
s_barrier
v_mfma_f32_16x16x32_bf16 v[224:227], a[144:147], v[128:131], v[48:51]
ds_read_b64_tr_b16 a[176:177], v40 offset:49152
v_mfma_f32_16x16x32_bf16 v[224:227], a[148:151], v[144:147], v[224:227]
s_add_u32 m0, s24, 0
v_exp_f32 v192, v192
v_mfma_f32_16x16x32_bf16 v[224:227], a[152:155], v[160:163], v[224:227]
ds_read_b64_tr_b16 a[178:179], v40 offset:53248
v_mfma_f32_16x16x32_bf16 v[224:227], a[156:159], v[176:179], v[224:227]
v_exp_f32 v193, v193
v_mfma_f32_16x16x32_bf16 v[232:235], a[156:159], v[180:183], v[52:55]
ds_read_b64_tr_b16 a[180:181], v40 offset:57344
ds_read_b64_tr_b16 a[182:183], v40 offset:61440
v_mfma_f32_16x16x32_bf16 v[232:235], a[152:155], v[164:167], v[232:235]
v_exp_f32 v194, v194
v_mfma_f32_16x16x32_bf16 v[232:235], a[148:151], v[148:151], v[232:235]
ds_read_b64_tr_b16 a[184:185], v41 offset:49152
v_cvt_pk_bf16_f32 v64, v192, v193
v_mfma_f32_16x16x32_bf16 v[232:235], a[144:147], v[132:135], v[232:235]
v_exp_f32 v195, v195
v_mfma_f32_16x16x32_bf16 v[240:243], a[144:147], v[136:139], v[56:59]
ds_read_b64_tr_b16 a[186:187], v41 offset:53248
v_cvt_pk_bf16_f32 v65, v194, v195
v_mfma_f32_16x16x32_bf16 v[240:243], a[148:151], v[152:155], v[240:243]
v_exp_f32 v196, v196
v_mfma_f32_16x16x32_bf16 v[240:243], a[152:155], v[168:171], v[240:243]
ds_read_b64_tr_b16 a[188:189], v41 offset:57344
ds_read_b64_tr_b16 a[190:191], v41 offset:61440
v_mfma_f32_16x16x32_bf16 v[240:243], a[156:159], v[184:187], v[240:243]
v_exp_f32 v197, v197
v_mfma_f32_16x16x32_bf16 v[248:251], a[156:159], v[188:191], v[60:63]
ds_read_b64_tr_b16 a[192:193], v42 offset:49152
v_cvt_pk_bf16_f32 v66, v196, v197
v_mfma_f32_16x16x32_bf16 v[248:251], a[152:155], v[172:175], v[248:251]
buffer_load_dwordx4 v30, s[8:11], s20 offen offset:0 lds
v_mfma_f32_16x16x32_bf16 v[248:251], a[148:151], v[156:159], v[248:251]
v_exp_f32 v198, v198
v_mfma_f32_16x16x32_bf16 v[248:251], a[144:147], v[140:143], v[248:251]
ds_read_b64_tr_b16 a[194:195], v42 offset:53248
ds_read_b64_tr_b16 a[196:197], v42 offset:57344
v_mfma_f32_16x16x32_bf16 v[252:255], a[160:163], v[140:143], v[60:63]
v_exp_f32 v199, v199
v_mfma_f32_16x16x32_bf16 v[252:255], a[164:167], v[156:159], v[252:255]
ds_read_b64_tr_b16 a[198:199], v42 offset:61440
v_cvt_pk_bf16_f32 v67, v198, v199
v_mfma_f32_16x16x32_bf16 v[252:255], a[168:171], v[172:175], v[252:255]
v_exp_f32 v200, v200
v_mfma_f32_16x16x32_bf16 v[252:255], a[172:175], v[188:191], v[252:255]
ds_read_b64_tr_b16 a[200:201], v43 offset:49152
ds_read_b64_tr_b16 a[202:203], v43 offset:53248
v_mfma_f32_16x16x32_bf16 v[244:247], a[172:175], v[184:187], v[56:59]
v_exp_f32 v201, v201
v_mfma_f32_16x16x32_bf16 v[244:247], a[168:171], v[168:171], v[244:247]
v_exp_f32 v202, v202
v_mfma_f32_16x16x32_bf16 v[244:247], a[164:167], v[152:155], v[244:247]
ds_read_b64_tr_b16 a[204:205], v43 offset:57344
ds_read_b64_tr_b16 a[206:207], v43 offset:61440
v_mfma_f32_16x16x32_bf16 v[244:247], a[160:163], v[136:139], v[244:247]
buffer_load_dwordx4 v31, s[8:11], s20 offen offset:1024 lds
v_mfma_f32_16x16x32_bf16 v[236:239], a[160:163], v[132:135], v[52:55]
v_exp_f32 v203, v203
v_mfma_f32_16x16x32_bf16 v[236:239], a[164:167], v[148:151], v[236:239]
v_cvt_pk_bf16_f32 v72, v200, v201
v_cvt_pk_bf16_f32 v73, v202, v203
v_mfma_f32_16x16x32_bf16 v[236:239], a[168:171], v[164:167], v[236:239]
v_exp_f32 v204, v204
v_mfma_f32_16x16x32_bf16 v[236:239], a[172:175], v[180:183], v[236:239]
v_exp_f32 v205, v205
v_mfma_f32_16x16x32_bf16 v[228:231], a[172:175], v[176:179], v[48:51]
v_exp_f32 v206, v206
v_mfma_f32_16x16x32_bf16 v[228:231], a[168:171], v[160:163], v[228:231]
v_cvt_pk_bf16_f32 v74, v204, v205
v_mfma_f32_16x16x32_bf16 v[228:231], a[164:167], v[144:147], v[228:231]
v_exp_f32 v207, v207
v_mfma_f32_16x16x32_bf16 v[228:231], a[160:163], v[128:131], v[228:231]
s_waitcnt lgkmcnt(0)
buffer_load_dwordx4 v32, s[8:11], s20 offen offset:2048 lds
v_mfma_f32_16x16x32_bf16 a[0:3], v[96:99], a[176:179], a[0:3]
ds_read_b128 a[144:147], v36 offset:16384
v_cvt_pk_bf16_f32 v75, v206, v207
v_mfma_f32_16x16x32_bf16 a[0:3], v[100:103], a[180:183], a[0:3]
v_exp_f32 v208, v208
v_mfma_f32_16x16x32_bf16 a[4:7], v[108:111], a[180:183], a[4:7]
v_exp_f32 v209, v209
v_mfma_f32_16x16x32_bf16 a[4:7], v[104:107], a[176:179], a[4:7]
ds_read_b128 a[148:151], v37 offset:16384
v_cvt_pk_bf16_f32 v80, v208, v209
v_mfma_f32_16x16x32_bf16 a[8:11], v[112:115], a[176:179], a[8:11]
v_exp_f32 v210, v210
v_mfma_f32_16x16x32_bf16 a[8:11], v[116:119], a[180:183], a[8:11]
v_mfma_f32_16x16x32_bf16 a[12:15], v[124:127], a[180:183], a[12:15]
ds_read_b128 a[152:155], v38 offset:16384
v_mfma_f32_16x16x32_bf16 a[12:15], v[120:123], a[176:179], a[12:15]
v_exp_f32 v211, v211
v_mfma_f32_16x16x32_bf16 a[28:31], v[120:123], a[184:187], a[28:31]
v_exp_f32 v212, v212
v_mfma_f32_16x16x32_bf16 a[28:31], v[124:127], a[188:191], a[28:31]
ds_read_b128 a[156:159], v39 offset:16384
v_cvt_pk_bf16_f32 v81, v210, v211
v_mfma_f32_16x16x32_bf16 a[24:27], v[116:119], a[188:191], a[24:27]
buffer_load_dwordx4 v33, s[8:11], s20 offen offset:3072 lds
v_mfma_f32_16x16x32_bf16 a[24:27], v[112:115], a[184:187], a[24:27]
v_exp_f32 v213, v213
v_mfma_f32_16x16x32_bf16 a[20:23], v[104:107], a[184:187], a[20:23]
v_exp_f32 v214, v214
v_mfma_f32_16x16x32_bf16 a[20:23], v[108:111], a[188:191], a[20:23]
ds_read_b128 a[160:163], v36 offset:20480
v_cvt_pk_bf16_f32 v82, v212, v213
v_mfma_f32_16x16x32_bf16 a[16:19], v[100:103], a[188:191], a[16:19]
v_exp_f32 v215, v215
v_mfma_f32_16x16x32_bf16 a[16:19], v[96:99], a[184:187], a[16:19]
v_cvt_pk_bf16_f32 v83, v214, v215
v_mfma_f32_16x16x32_bf16 a[32:35], v[96:99], a[192:195], a[32:35]
ds_read_b128 a[164:167], v37 offset:20480
v_mfma_f32_16x16x32_bf16 a[32:35], v[100:103], a[196:199], a[32:35]
v_exp_f32 v216, v216
v_mfma_f32_16x16x32_bf16 a[36:39], v[108:111], a[196:199], a[36:39]
v_exp_f32 v217, v217
v_mfma_f32_16x16x32_bf16 a[36:39], v[104:107], a[192:195], a[36:39]
s_add_u32 s20, s20, 16384
ds_read_b128 a[168:171], v38 offset:20480
v_cvt_pk_bf16_f32 v88, v216, v217
v_mfma_f32_16x16x32_bf16 a[40:43], v[112:115], a[192:195], a[40:43]
v_exp_f32 v218, v218
v_mfma_f32_16x16x32_bf16 a[40:43], v[116:119], a[196:199], a[40:43]
v_mfma_f32_16x16x32_bf16 a[44:47], v[124:127], a[196:199], a[44:47]
ds_read_b128 a[172:175], v39 offset:20480
v_mfma_f32_16x16x32_bf16 a[44:47], v[120:123], a[192:195], a[44:47]
v_exp_f32 v219, v219
v_mfma_f32_16x16x32_bf16 a[60:63], v[120:123], a[200:203], a[60:63]
v_exp_f32 v220, v220
v_mfma_f32_16x16x32_bf16 a[60:63], v[124:127], a[204:207], a[60:63]
v_cvt_pk_bf16_f32 v89, v218, v219
v_mfma_f32_16x16x32_bf16 a[56:59], v[116:119], a[204:207], a[56:59]
v_exp_f32 v221, v221
v_mfma_f32_16x16x32_bf16 a[56:59], v[112:115], a[200:203], a[56:59]
v_cvt_pk_bf16_f32 v90, v220, v221
v_mfma_f32_16x16x32_bf16 a[52:55], v[104:107], a[200:203], a[52:55]
v_exp_f32 v222, v222
v_mfma_f32_16x16x32_bf16 a[52:55], v[108:111], a[204:207], a[52:55]
v_mfma_f32_16x16x32_bf16 a[48:51], v[100:103], a[204:207], a[48:51]
v_exp_f32 v223, v223
v_mfma_f32_16x16x32_bf16 a[48:51], v[96:99], a[200:203], a[48:51]
v_cvt_pk_bf16_f32 v91, v222, v223
v_smfmac_f32_16x16x64_bf16 a[128:131], v[16:19], v[96:103], v26
v_smfmac_f32_16x16x64_bf16 a[132:135], v[16:19], v[104:111], v26
s_waitcnt lgkmcnt(0)
v_mfma_f32_16x16x32_bf16 v[192:195], a[144:147], v[128:131], v[48:51]
ds_read_b64_tr_b16 a[176:177], v44 offset:49152
v_mfma_f32_16x16x32_bf16 v[192:195], a[148:151], v[144:147], v[192:195]
s_add_u32 m0, s24, 98304
v_exp_f32 v224, v224
v_mfma_f32_16x16x32_bf16 v[192:195], a[152:155], v[160:163], v[192:195]
ds_read_b64_tr_b16 a[178:179], v44 offset:53248
v_mfma_f32_16x16x32_bf16 v[192:195], a[156:159], v[176:179], v[192:195]
v_exp_f32 v225, v225
v_mfma_f32_16x16x32_bf16 v[200:203], a[156:159], v[180:183], v[52:55]
ds_read_b64_tr_b16 a[180:181], v44 offset:57344
ds_read_b64_tr_b16 a[182:183], v44 offset:61440
v_mfma_f32_16x16x32_bf16 v[200:203], a[152:155], v[164:167], v[200:203]
v_exp_f32 v226, v226
v_mfma_f32_16x16x32_bf16 v[200:203], a[148:151], v[148:151], v[200:203]
ds_read_b64_tr_b16 a[184:185], v45 offset:49152
v_cvt_pk_bf16_f32 v68, v224, v225
v_mfma_f32_16x16x32_bf16 v[200:203], a[144:147], v[132:135], v[200:203]
v_exp_f32 v227, v227
v_mfma_f32_16x16x32_bf16 v[208:211], a[144:147], v[136:139], v[56:59]
ds_read_b64_tr_b16 a[186:187], v45 offset:53248
v_cvt_pk_bf16_f32 v69, v226, v227
v_mfma_f32_16x16x32_bf16 v[208:211], a[148:151], v[152:155], v[208:211]
v_exp_f32 v228, v228
v_mfma_f32_16x16x32_bf16 v[208:211], a[152:155], v[168:171], v[208:211]
ds_read_b64_tr_b16 a[188:189], v45 offset:57344
ds_read_b64_tr_b16 a[190:191], v45 offset:61440
v_mfma_f32_16x16x32_bf16 v[208:211], a[156:159], v[184:187], v[208:211]
v_exp_f32 v229, v229
v_mfma_f32_16x16x32_bf16 v[216:219], a[156:159], v[188:191], v[60:63]
ds_read_b64_tr_b16 a[192:193], v46 offset:49152
v_cvt_pk_bf16_f32 v70, v228, v229
v_mfma_f32_16x16x32_bf16 v[216:219], a[152:155], v[172:175], v[216:219]
buffer_load_dwordx4 v34, s[12:15], s21 offen offset:0 lds
v_mfma_f32_16x16x32_bf16 v[216:219], a[148:151], v[156:159], v[216:219]
v_exp_f32 v230, v230
v_mfma_f32_16x16x32_bf16 v[216:219], a[144:147], v[140:143], v[216:219]
ds_read_b64_tr_b16 a[194:195], v46 offset:53248
ds_read_b64_tr_b16 a[196:197], v46 offset:57344
v_mfma_f32_16x16x32_bf16 v[220:223], a[160:163], v[140:143], v[60:63]
v_exp_f32 v231, v231
v_mfma_f32_16x16x32_bf16 v[220:223], a[164:167], v[156:159], v[220:223]
ds_read_b64_tr_b16 a[198:199], v46 offset:61440
v_cvt_pk_bf16_f32 v71, v230, v231
v_mfma_f32_16x16x32_bf16 v[220:223], a[168:171], v[172:175], v[220:223]
v_exp_f32 v232, v232
v_mfma_f32_16x16x32_bf16 v[220:223], a[172:175], v[188:191], v[220:223]
ds_read_b64_tr_b16 a[200:201], v47 offset:49152
ds_read_b64_tr_b16 a[202:203], v47 offset:53248
v_mfma_f32_16x16x32_bf16 v[212:215], a[172:175], v[184:187], v[56:59]
v_exp_f32 v233, v233
v_mfma_f32_16x16x32_bf16 v[212:215], a[168:171], v[168:171], v[212:215]
v_exp_f32 v234, v234
v_mfma_f32_16x16x32_bf16 v[212:215], a[164:167], v[152:155], v[212:215]
ds_read_b64_tr_b16 a[204:205], v47 offset:57344
ds_read_b64_tr_b16 a[206:207], v47 offset:61440
v_mfma_f32_16x16x32_bf16 v[212:215], a[160:163], v[136:139], v[212:215]
buffer_load_dwordx4 v35, s[12:15], s21 offen offset:1024 lds
v_mfma_f32_16x16x32_bf16 v[204:207], a[160:163], v[132:135], v[52:55]
v_exp_f32 v235, v235
v_mfma_f32_16x16x32_bf16 v[204:207], a[164:167], v[148:151], v[204:207]
v_cvt_pk_bf16_f32 v76, v232, v233
v_cvt_pk_bf16_f32 v77, v234, v235
v_mfma_f32_16x16x32_bf16 v[204:207], a[168:171], v[164:167], v[204:207]
v_exp_f32 v236, v236
v_mfma_f32_16x16x32_bf16 v[204:207], a[172:175], v[180:183], v[204:207]
v_exp_f32 v237, v237
v_mfma_f32_16x16x32_bf16 v[196:199], a[172:175], v[176:179], v[48:51]
v_exp_f32 v238, v238
v_mfma_f32_16x16x32_bf16 v[196:199], a[168:171], v[160:163], v[196:199]
v_cvt_pk_bf16_f32 v78, v236, v237
v_mfma_f32_16x16x32_bf16 v[196:199], a[164:167], v[144:147], v[196:199]
v_exp_f32 v239, v239
v_mfma_f32_16x16x32_bf16 v[196:199], a[160:163], v[128:131], v[196:199]
s_waitcnt lgkmcnt(0)
buffer_load_dwordx4 v34, s[12:15], s21 offen offset:2048 lds
v_mfma_f32_16x16x32_bf16 a[64:67], v[96:99], a[176:179], a[64:67]
ds_read_b128 a[144:147], v36 offset:24576
v_cvt_pk_bf16_f32 v79, v238, v239
v_mfma_f32_16x16x32_bf16 a[64:67], v[100:103], a[180:183], a[64:67]
v_exp_f32 v240, v240
v_mfma_f32_16x16x32_bf16 a[68:71], v[108:111], a[180:183], a[68:71]
v_exp_f32 v241, v241
v_mfma_f32_16x16x32_bf16 a[68:71], v[104:107], a[176:179], a[68:71]
ds_read_b128 a[148:151], v37 offset:24576
v_cvt_pk_bf16_f32 v84, v240, v241
v_mfma_f32_16x16x32_bf16 a[72:75], v[112:115], a[176:179], a[72:75]
v_exp_f32 v242, v242
v_mfma_f32_16x16x32_bf16 a[72:75], v[116:119], a[180:183], a[72:75]
v_mfma_f32_16x16x32_bf16 a[76:79], v[124:127], a[180:183], a[76:79]
ds_read_b128 a[152:155], v38 offset:24576
v_mfma_f32_16x16x32_bf16 a[76:79], v[120:123], a[176:179], a[76:79]
v_exp_f32 v243, v243
v_mfma_f32_16x16x32_bf16 a[92:95], v[120:123], a[184:187], a[92:95]
v_exp_f32 v244, v244
v_mfma_f32_16x16x32_bf16 a[92:95], v[124:127], a[188:191], a[92:95]
ds_read_b128 a[156:159], v39 offset:24576
v_cvt_pk_bf16_f32 v85, v242, v243
v_mfma_f32_16x16x32_bf16 a[88:91], v[116:119], a[188:191], a[88:91]
buffer_load_dwordx4 v35, s[12:15], s21 offen offset:3072 lds
v_mfma_f32_16x16x32_bf16 a[88:91], v[112:115], a[184:187], a[88:91]
v_exp_f32 v245, v245
v_mfma_f32_16x16x32_bf16 a[84:87], v[104:107], a[184:187], a[84:87]
v_exp_f32 v246, v246
v_mfma_f32_16x16x32_bf16 a[84:87], v[108:111], a[188:191], a[84:87]
ds_read_b128 a[160:163], v36 offset:28672
v_cvt_pk_bf16_f32 v86, v244, v245
v_mfma_f32_16x16x32_bf16 a[80:83], v[100:103], a[188:191], a[80:83]
v_exp_f32 v247, v247
v_mfma_f32_16x16x32_bf16 a[80:83], v[96:99], a[184:187], a[80:83]
v_cvt_pk_bf16_f32 v87, v246, v247
v_mfma_f32_16x16x32_bf16 a[96:99], v[96:99], a[192:195], a[96:99]
ds_read_b128 a[164:167], v37 offset:28672
v_mfma_f32_16x16x32_bf16 a[96:99], v[100:103], a[196:199], a[96:99]
v_exp_f32 v248, v248
v_mfma_f32_16x16x32_bf16 a[100:103], v[108:111], a[196:199], a[100:103]
v_exp_f32 v249, v249
v_mfma_f32_16x16x32_bf16 a[100:103], v[104:107], a[192:195], a[100:103]
s_add_u32 s21, s21, 16384
ds_read_b128 a[168:171], v38 offset:28672
v_cvt_pk_bf16_f32 v92, v248, v249
v_mfma_f32_16x16x32_bf16 a[104:107], v[112:115], a[192:195], a[104:107]
v_exp_f32 v250, v250
v_mfma_f32_16x16x32_bf16 a[104:107], v[116:119], a[196:199], a[104:107]
v_mfma_f32_16x16x32_bf16 a[108:111], v[124:127], a[196:199], a[108:111]
ds_read_b128 a[172:175], v39 offset:28672
v_mfma_f32_16x16x32_bf16 a[108:111], v[120:123], a[192:195], a[108:111]
v_exp_f32 v251, v251
v_mfma_f32_16x16x32_bf16 a[124:127], v[120:123], a[200:203], a[124:127]
v_exp_f32 v252, v252
v_mfma_f32_16x16x32_bf16 a[124:127], v[124:127], a[204:207], a[124:127]
v_cvt_pk_bf16_f32 v93, v250, v251
v_mfma_f32_16x16x32_bf16 a[120:123], v[116:119], a[204:207], a[120:123]
v_exp_f32 v253, v253
v_mfma_f32_16x16x32_bf16 a[120:123], v[112:115], a[200:203], a[120:123]
v_cvt_pk_bf16_f32 v94, v252, v253
v_mfma_f32_16x16x32_bf16 a[116:119], v[104:107], a[200:203], a[116:119]
v_exp_f32 v254, v254
v_mfma_f32_16x16x32_bf16 a[116:119], v[108:111], a[204:207], a[116:119]
v_mfma_f32_16x16x32_bf16 a[112:115], v[100:103], a[204:207], a[112:115]
v_exp_f32 v255, v255
v_mfma_f32_16x16x32_bf16 a[112:115], v[96:99], a[200:203], a[112:115]
v_cvt_pk_bf16_f32 v95, v254, v255
v_smfmac_f32_16x16x64_bf16 a[136:139], v[16:19], v[112:119], v26
v_smfmac_f32_16x16x64_bf16 a[140:143], v[16:19], v[120:127], v26
s_waitcnt vmcnt(16) lgkmcnt(0)
s_barrier
v_mfma_f32_16x16x32_bf16 v[224:227], a[144:147], v[128:131], v[48:51]
ds_read_b64_tr_b16 a[176:177], v40 offset:16384
v_mfma_f32_16x16x32_bf16 v[224:227], a[148:151], v[144:147], v[224:227]
s_add_u32 m0, s24, 16384
v_exp_f32 v192, v192
v_mfma_f32_16x16x32_bf16 v[224:227], a[152:155], v[160:163], v[224:227]
ds_read_b64_tr_b16 a[178:179], v40 offset:20480
v_mfma_f32_16x16x32_bf16 v[224:227], a[156:159], v[176:179], v[224:227]
v_exp_f32 v193, v193
v_mfma_f32_16x16x32_bf16 v[232:235], a[156:159], v[180:183], v[52:55]
ds_read_b64_tr_b16 a[180:181], v40 offset:24576
ds_read_b64_tr_b16 a[182:183], v40 offset:28672
v_mfma_f32_16x16x32_bf16 v[232:235], a[152:155], v[164:167], v[232:235]
v_exp_f32 v194, v194
v_mfma_f32_16x16x32_bf16 v[232:235], a[148:151], v[148:151], v[232:235]
ds_read_b64_tr_b16 a[184:185], v41 offset:16384
v_cvt_pk_bf16_f32 v96, v192, v193
v_mfma_f32_16x16x32_bf16 v[232:235], a[144:147], v[132:135], v[232:235]
v_exp_f32 v195, v195
v_mfma_f32_16x16x32_bf16 v[240:243], a[144:147], v[136:139], v[56:59]
ds_read_b64_tr_b16 a[186:187], v41 offset:20480
v_cvt_pk_bf16_f32 v97, v194, v195
v_mfma_f32_16x16x32_bf16 v[240:243], a[148:151], v[152:155], v[240:243]
v_exp_f32 v196, v196
v_mfma_f32_16x16x32_bf16 v[240:243], a[152:155], v[168:171], v[240:243]
ds_read_b64_tr_b16 a[188:189], v41 offset:24576
ds_read_b64_tr_b16 a[190:191], v41 offset:28672
v_mfma_f32_16x16x32_bf16 v[240:243], a[156:159], v[184:187], v[240:243]
v_exp_f32 v197, v197
v_mfma_f32_16x16x32_bf16 v[248:251], a[156:159], v[188:191], v[60:63]
ds_read_b64_tr_b16 a[192:193], v42 offset:16384
v_cvt_pk_bf16_f32 v98, v196, v197
v_mfma_f32_16x16x32_bf16 v[248:251], a[152:155], v[172:175], v[248:251]
buffer_load_dwordx4 v30, s[8:11], s20 offen offset:0 lds
v_mfma_f32_16x16x32_bf16 v[248:251], a[148:151], v[156:159], v[248:251]
v_exp_f32 v198, v198
v_mfma_f32_16x16x32_bf16 v[248:251], a[144:147], v[140:143], v[248:251]
ds_read_b64_tr_b16 a[194:195], v42 offset:20480
ds_read_b64_tr_b16 a[196:197], v42 offset:24576
v_mfma_f32_16x16x32_bf16 v[252:255], a[160:163], v[140:143], v[60:63]
v_exp_f32 v199, v199
v_mfma_f32_16x16x32_bf16 v[252:255], a[164:167], v[156:159], v[252:255]
ds_read_b64_tr_b16 a[198:199], v42 offset:28672
v_cvt_pk_bf16_f32 v99, v198, v199
v_mfma_f32_16x16x32_bf16 v[252:255], a[168:171], v[172:175], v[252:255]
v_exp_f32 v200, v200
v_mfma_f32_16x16x32_bf16 v[252:255], a[172:175], v[188:191], v[252:255]
ds_read_b64_tr_b16 a[200:201], v43 offset:16384
ds_read_b64_tr_b16 a[202:203], v43 offset:20480
v_mfma_f32_16x16x32_bf16 v[244:247], a[172:175], v[184:187], v[56:59]
v_exp_f32 v201, v201
v_mfma_f32_16x16x32_bf16 v[244:247], a[168:171], v[168:171], v[244:247]
v_exp_f32 v202, v202
v_mfma_f32_16x16x32_bf16 v[244:247], a[164:167], v[152:155], v[244:247]
ds_read_b64_tr_b16 a[204:205], v43 offset:24576
ds_read_b64_tr_b16 a[206:207], v43 offset:28672
v_mfma_f32_16x16x32_bf16 v[244:247], a[160:163], v[136:139], v[244:247]
buffer_load_dwordx4 v31, s[8:11], s20 offen offset:1024 lds
v_mfma_f32_16x16x32_bf16 v[236:239], a[160:163], v[132:135], v[52:55]
v_exp_f32 v203, v203
v_mfma_f32_16x16x32_bf16 v[236:239], a[164:167], v[148:151], v[236:239]
v_cvt_pk_bf16_f32 v104, v200, v201
v_cvt_pk_bf16_f32 v105, v202, v203
v_mfma_f32_16x16x32_bf16 v[236:239], a[168:171], v[164:167], v[236:239]
v_exp_f32 v204, v204
v_mfma_f32_16x16x32_bf16 v[236:239], a[172:175], v[180:183], v[236:239]
v_exp_f32 v205, v205
v_mfma_f32_16x16x32_bf16 v[228:231], a[172:175], v[176:179], v[48:51]
v_exp_f32 v206, v206
v_mfma_f32_16x16x32_bf16 v[228:231], a[168:171], v[160:163], v[228:231]
v_cvt_pk_bf16_f32 v106, v204, v205
v_mfma_f32_16x16x32_bf16 v[228:231], a[164:167], v[144:147], v[228:231]
v_exp_f32 v207, v207
v_mfma_f32_16x16x32_bf16 v[228:231], a[160:163], v[128:131], v[228:231]
s_waitcnt lgkmcnt(0)
buffer_load_dwordx4 v32, s[8:11], s20 offen offset:2048 lds
v_mfma_f32_16x16x32_bf16 a[0:3], v[64:67], a[176:179], a[0:3]
ds_read_b128 a[144:147], v36 offset:32768
v_cvt_pk_bf16_f32 v107, v206, v207
v_mfma_f32_16x16x32_bf16 a[0:3], v[68:71], a[180:183], a[0:3]
v_exp_f32 v208, v208
v_mfma_f32_16x16x32_bf16 a[4:7], v[76:79], a[180:183], a[4:7]
v_exp_f32 v209, v209
v_mfma_f32_16x16x32_bf16 a[4:7], v[72:75], a[176:179], a[4:7]
ds_read_b128 a[148:151], v37 offset:32768
v_cvt_pk_bf16_f32 v112, v208, v209
v_mfma_f32_16x16x32_bf16 a[8:11], v[80:83], a[176:179], a[8:11]
v_exp_f32 v210, v210
v_mfma_f32_16x16x32_bf16 a[8:11], v[84:87], a[180:183], a[8:11]
v_mfma_f32_16x16x32_bf16 a[12:15], v[92:95], a[180:183], a[12:15]
ds_read_b128 a[152:155], v38 offset:32768
v_mfma_f32_16x16x32_bf16 a[12:15], v[88:91], a[176:179], a[12:15]
v_exp_f32 v211, v211
v_mfma_f32_16x16x32_bf16 a[28:31], v[88:91], a[184:187], a[28:31]
v_exp_f32 v212, v212
v_mfma_f32_16x16x32_bf16 a[28:31], v[92:95], a[188:191], a[28:31]
ds_read_b128 a[156:159], v39 offset:32768
v_cvt_pk_bf16_f32 v113, v210, v211
v_mfma_f32_16x16x32_bf16 a[24:27], v[84:87], a[188:191], a[24:27]
buffer_load_dwordx4 v33, s[8:11], s20 offen offset:3072 lds
v_mfma_f32_16x16x32_bf16 a[24:27], v[80:83], a[184:187], a[24:27]
v_exp_f32 v213, v213
v_mfma_f32_16x16x32_bf16 a[20:23], v[72:75], a[184:187], a[20:23]
v_exp_f32 v214, v214
v_mfma_f32_16x16x32_bf16 a[20:23], v[76:79], a[188:191], a[20:23]
ds_read_b128 a[160:163], v36 offset:36864
v_cvt_pk_bf16_f32 v114, v212, v213
v_mfma_f32_16x16x32_bf16 a[16:19], v[68:71], a[188:191], a[16:19]
v_exp_f32 v215, v215
v_mfma_f32_16x16x32_bf16 a[16:19], v[64:67], a[184:187], a[16:19]
v_cvt_pk_bf16_f32 v115, v214, v215
v_mfma_f32_16x16x32_bf16 a[32:35], v[64:67], a[192:195], a[32:35]
ds_read_b128 a[164:167], v37 offset:36864
v_mfma_f32_16x16x32_bf16 a[32:35], v[68:71], a[196:199], a[32:35]
v_exp_f32 v216, v216
v_mfma_f32_16x16x32_bf16 a[36:39], v[76:79], a[196:199], a[36:39]
v_exp_f32 v217, v217
v_mfma_f32_16x16x32_bf16 a[36:39], v[72:75], a[192:195], a[36:39]
s_add_u32 s20, s20, 16384
ds_read_b128 a[168:171], v38 offset:36864
v_cvt_pk_bf16_f32 v120, v216, v217
v_mfma_f32_16x16x32_bf16 a[40:43], v[80:83], a[192:195], a[40:43]
v_exp_f32 v218, v218
v_mfma_f32_16x16x32_bf16 a[40:43], v[84:87], a[196:199], a[40:43]
v_mfma_f32_16x16x32_bf16 a[44:47], v[92:95], a[196:199], a[44:47]
ds_read_b128 a[172:175], v39 offset:36864
v_mfma_f32_16x16x32_bf16 a[44:47], v[88:91], a[192:195], a[44:47]
v_exp_f32 v219, v219
v_mfma_f32_16x16x32_bf16 a[60:63], v[88:91], a[200:203], a[60:63]
v_exp_f32 v220, v220
v_mfma_f32_16x16x32_bf16 a[60:63], v[92:95], a[204:207], a[60:63]
v_cvt_pk_bf16_f32 v121, v218, v219
v_mfma_f32_16x16x32_bf16 a[56:59], v[84:87], a[204:207], a[56:59]
v_exp_f32 v221, v221
v_mfma_f32_16x16x32_bf16 a[56:59], v[80:83], a[200:203], a[56:59]
v_cvt_pk_bf16_f32 v122, v220, v221
v_mfma_f32_16x16x32_bf16 a[52:55], v[72:75], a[200:203], a[52:55]
v_exp_f32 v222, v222
v_mfma_f32_16x16x32_bf16 a[52:55], v[76:79], a[204:207], a[52:55]
v_mfma_f32_16x16x32_bf16 a[48:51], v[68:71], a[204:207], a[48:51]
v_exp_f32 v223, v223
v_mfma_f32_16x16x32_bf16 a[48:51], v[64:67], a[200:203], a[48:51]
v_cvt_pk_bf16_f32 v123, v222, v223
v_smfmac_f32_16x16x64_bf16 a[128:131], v[16:19], v[64:71], v26
v_smfmac_f32_16x16x64_bf16 a[132:135], v[16:19], v[72:79], v26
s_waitcnt lgkmcnt(0)
v_mfma_f32_16x16x32_bf16 v[192:195], a[144:147], v[128:131], v[48:51]
ds_read_b64_tr_b16 a[176:177], v44 offset:16384
v_mfma_f32_16x16x32_bf16 v[192:195], a[148:151], v[144:147], v[192:195]
s_add_u32 m0, s24, 114688
v_exp_f32 v224, v224
v_mfma_f32_16x16x32_bf16 v[192:195], a[152:155], v[160:163], v[192:195]
ds_read_b64_tr_b16 a[178:179], v44 offset:20480
v_mfma_f32_16x16x32_bf16 v[192:195], a[156:159], v[176:179], v[192:195]
v_exp_f32 v225, v225
v_mfma_f32_16x16x32_bf16 v[200:203], a[156:159], v[180:183], v[52:55]
ds_read_b64_tr_b16 a[180:181], v44 offset:24576
ds_read_b64_tr_b16 a[182:183], v44 offset:28672
v_mfma_f32_16x16x32_bf16 v[200:203], a[152:155], v[164:167], v[200:203]
v_exp_f32 v226, v226
v_mfma_f32_16x16x32_bf16 v[200:203], a[148:151], v[148:151], v[200:203]
buffer_load_dwordx4 v34, s[12:15], s21 offen offset:0 lds
v_mfma_f32_16x16x32_bf16 v[200:203], a[144:147], v[132:135], v[200:203]
ds_read_b64_tr_b16 a[184:185], v45 offset:16384
v_cvt_pk_bf16_f32 v100, v224, v225
v_mfma_f32_16x16x32_bf16 v[208:211], a[144:147], v[136:139], v[56:59]
v_exp_f32 v227, v227
v_mfma_f32_16x16x32_bf16 v[208:211], a[148:151], v[152:155], v[208:211]
ds_read_b64_tr_b16 a[186:187], v45 offset:20480
ds_read_b64_tr_b16 a[188:189], v45 offset:24576
v_mfma_f32_16x16x32_bf16 v[208:211], a[152:155], v[168:171], v[208:211]
buffer_load_dwordx4 v35, s[12:15], s21 offen offset:1024 lds
v_mfma_f32_16x16x32_bf16 v[208:211], a[156:159], v[184:187], v[208:211]
v_exp_f32 v228, v228
v_mfma_f32_16x16x32_bf16 v[216:219], a[156:159], v[188:191], v[60:63]
ds_read_b64_tr_b16 a[190:191], v45 offset:28672
v_cvt_pk_bf16_f32 v101, v226, v227
v_mfma_f32_16x16x32_bf16 v[216:219], a[152:155], v[172:175], v[216:219]
v_exp_f32 v229, v229
v_mfma_f32_16x16x32_bf16 v[216:219], a[148:151], v[156:159], v[216:219]
ds_read_b64_tr_b16 a[192:193], v46 offset:16384
buffer_load_dwordx4 v34, s[12:15], s21 offen offset:2048 lds
v_mfma_f32_16x16x32_bf16 v[216:219], a[144:147], v[140:143], v[216:219]
ds_read_b64_tr_b16 a[194:195], v46 offset:20480
v_exp_f32 v230, v230
v_mfma_f32_16x16x32_bf16 v[220:223], a[160:163], v[140:143], v[60:63]
v_exp_f32 v231, v231
v_mfma_f32_16x16x32_bf16 v[220:223], a[164:167], v[156:159], v[220:223]
ds_read_b64_tr_b16 a[196:197], v46 offset:24576
buffer_load_dwordx4 v35, s[12:15], s21 offen offset:3072 lds
v_cvt_pk_bf16_f32 v102, v228, v229
v_mfma_f32_16x16x32_bf16 v[220:223], a[168:171], v[172:175], v[220:223]
s_add_u32 s21, s21, 16384
ds_read_b64_tr_b16 a[198:199], v46 offset:28672
ds_read_b64_tr_b16 a[200:201], v47 offset:16384
v_mfma_f32_16x16x32_bf16 v[220:223], a[172:175], v[188:191], v[220:223]
v_exp_f32 v232, v232
v_mfma_f32_16x16x32_bf16 v[212:215], a[172:175], v[184:187], v[56:59]
v_exp_f32 v233, v233
v_mfma_f32_16x16x32_bf16 v[212:215], a[168:171], v[168:171], v[212:215]
ds_read_b64_tr_b16 a[202:203], v47 offset:20480
v_cvt_pk_bf16_f32 v103, v230, v231
v_mfma_f32_16x16x32_bf16 v[212:215], a[164:167], v[152:155], v[212:215]
v_exp_f32 v234, v234
v_mfma_f32_16x16x32_bf16 v[212:215], a[160:163], v[136:139], v[212:215]
ds_read_b64_tr_b16 a[204:205], v47 offset:24576
ds_read_b64_tr_b16 a[206:207], v47 offset:28672
v_mfma_f32_16x16x32_bf16 v[204:207], a[160:163], v[132:135], v[52:55]
s_cmp_gt_u32 s22, 2
s_addc_u32 s3, s22, 0
v_cvt_pk_bf16_f32 v108, v232, v233
v_mfma_f32_16x16x32_bf16 v[204:207], a[164:167], v[148:151], v[204:207]
s_xor_b32 s40, s25, s3
v_exp_f32 v235, v235
v_mfma_f32_16x16x32_bf16 v[204:207], a[168:171], v[164:167], v[204:207]
v_exp_f32 v236, v236
v_mfma_f32_16x16x32_bf16 v[204:207], a[172:175], v[180:183], v[204:207]
s_mul_i32 s40, s40, 147456
v_exp_f32 v237, v237
v_mfma_f32_16x16x32_bf16 v[196:199], a[172:175], v[176:179], v[48:51]
v_cvt_pk_bf16_f32 v109, v234, v235
v_cvt_pk_bf16_f32 v110, v236, v237
v_mfma_f32_16x16x32_bf16 v[196:199], a[168:171], v[160:163], v[196:199]
v_exp_f32 v238, v238
v_mfma_f32_16x16x32_bf16 v[196:199], a[164:167], v[144:147], v[196:199]
v_exp_f32 v239, v239
v_mfma_f32_16x16x32_bf16 v[196:199], a[160:163], v[128:131], v[196:199]
s_waitcnt lgkmcnt(0)
s_lshl_b32 s3, s3, 12
v_cvt_pk_bf16_f32 v111, v238, v239
v_mfma_f32_16x16x32_bf16 a[64:67], v[64:67], a[176:179], a[64:67]
ds_read_b128 a[144:147], v36 offset:40960
v_mfma_f32_16x16x32_bf16 a[64:67], v[68:71], a[180:183], a[64:67]
v_exp_f32 v240, v240
v_mfma_f32_16x16x32_bf16 a[68:71], v[76:79], a[180:183], a[68:71]
s_add_u32 s3, s3, s39
v_exp_f32 v241, v241
v_mfma_f32_16x16x32_bf16 a[68:71], v[72:75], a[176:179], a[68:71]
ds_read_b128 a[148:151], v37 offset:40960
v_cvt_pk_bf16_f32 v116, v240, v241
v_mfma_f32_16x16x32_bf16 a[72:75], v[80:83], a[176:179], a[72:75]
v_exp_f32 v242, v242
v_mfma_f32_16x16x32_bf16 a[72:75], v[84:87], a[180:183], a[72:75]
s_add_u32 m0, s3, 131072
v_mfma_f32_16x16x32_bf16 a[76:79], v[92:95], a[180:183], a[76:79]
ds_read_b128 a[152:155], v38 offset:40960
v_mfma_f32_16x16x32_bf16 a[76:79], v[88:91], a[176:179], a[76:79]
v_exp_f32 v243, v243
v_mfma_f32_16x16x32_bf16 a[92:95], v[88:91], a[184:187], a[92:95]
v_exp_f32 v244, v244
v_mfma_f32_16x16x32_bf16 a[92:95], v[92:95], a[188:191], a[92:95]
ds_read_b128 a[156:159], v39 offset:40960
v_cvt_pk_bf16_f32 v117, v242, v243
v_mfma_f32_16x16x32_bf16 a[88:91], v[84:87], a[188:191], a[88:91]
buffer_load_dwordx4 v25, s[44:47], s40 offen lds
v_mfma_f32_16x16x32_bf16 a[88:91], v[80:83], a[184:187], a[88:91]
v_exp_f32 v245, v245
v_mfma_f32_16x16x32_bf16 a[84:87], v[72:75], a[184:187], a[84:87]
v_exp_f32 v246, v246
v_mfma_f32_16x16x32_bf16 a[84:87], v[76:79], a[188:191], a[84:87]
s_cmp_eq_u32 s22, 0
s_cselect_b32 s3, s37, s18
ds_read_b128 a[160:163], v36 offset:45056
v_mfma_f32_16x16x32_bf16 a[80:83], v[68:71], a[188:191], a[80:83]
v_exp_f32 v247, v247
v_mfma_f32_16x16x32_bf16 a[80:83], v[64:67], a[184:187], a[80:83]
v_cvt_pk_bf16_f32 v118, v244, v245
v_cvt_pk_bf16_f32 v119, v246, v247
v_mfma_f32_16x16x32_bf16 a[96:99], v[64:67], a[192:195], a[96:99]
ds_read_b128 a[164:167], v37 offset:45056
v_mfma_f32_16x16x32_bf16 a[96:99], v[68:71], a[196:199], a[96:99]
buffer_store_dwordx2 v[2:3], v1, s[16:19], s3 offen sc1
v_mfma_f32_16x16x32_bf16 a[100:103], v[76:79], a[196:199], a[100:103]
v_exp_f32 v248, v248
v_mfma_f32_16x16x32_bf16 a[100:103], v[72:75], a[192:195], a[100:103]
v_exp_f32 v249, v249
v_mfma_f32_16x16x32_bf16 a[104:107], v[80:83], a[192:195], a[104:107]
s_cmp_eq_u32 s22, 6
s_cselect_b32 s3, s38, s18
ds_read_b128 a[168:171], v38 offset:45056
v_mfma_f32_16x16x32_bf16 a[104:107], v[84:87], a[196:199], a[104:107]
v_exp_f32 v250, v250
v_mfma_f32_16x16x32_bf16 a[108:111], v[92:95], a[196:199], a[108:111]
ds_read_b128 a[172:175], v39 offset:45056
v_cvt_pk_bf16_f32 v124, v248, v249
v_mfma_f32_16x16x32_bf16 a[108:111], v[88:91], a[192:195], a[108:111]
v_exp_f32 v251, v251
v_mfma_f32_16x16x32_bf16 a[124:127], v[88:91], a[200:203], a[124:127]
buffer_load_dwordx2 a[248:249], v29, s[16:19], s3 offen sc1
v_mfma_f32_16x16x32_bf16 a[124:127], v[92:95], a[204:207], a[124:127]
s_add_u32 s22, s22, 1
v_exp_f32 v252, v252
v_mfma_f32_16x16x32_bf16 a[120:123], v[84:87], a[204:207], a[120:123]
v_exp_f32 v253, v253
v_mfma_f32_16x16x32_bf16 a[120:123], v[80:83], a[200:203], a[120:123]
v_cvt_pk_bf16_f32 v125, v250, v251
v_cvt_pk_bf16_f32 v126, v252, v253
v_mfma_f32_16x16x32_bf16 a[116:119], v[72:75], a[200:203], a[116:119]
v_exp_f32 v254, v254
v_mfma_f32_16x16x32_bf16 a[116:119], v[76:79], a[204:207], a[116:119]
v_mfma_f32_16x16x32_bf16 a[112:115], v[68:71], a[204:207], a[112:115]
v_exp_f32 v255, v255
v_mfma_f32_16x16x32_bf16 a[112:115], v[64:67], a[200:203], a[112:115]
v_cvt_pk_bf16_f32 v127, v254, v255
v_smfmac_f32_16x16x64_bf16 a[136:139], v[16:19], v[80:87], v26
v_smfmac_f32_16x16x64_bf16 a[140:143], v[16:19], v[88:95], v26
s_waitcnt vmcnt(19) lgkmcnt(0)
s_barrier
s_cmp_lg_u32 s22, 7
s_cbranch_scc1 M_loop
M_tail:
v_mfma_f32_16x16x32_bf16 v[224:227], a[144:147], v[128:131], v[48:51]
s_xor_b32 s36, s25, 4
ds_read_b64_tr_b16 a[176:177], v40 offset:0
v_subrev_u32 v8, 65536, v40
v_mfma_f32_16x16x32_bf16 v[224:227], a[148:151], v[144:147], v[224:227]
v_exp_f32 v192, v192
v_mfma_f32_16x16x32_bf16 v[224:227], a[152:155], v[160:163], v[224:227]
ds_read_b64_tr_b16 a[178:179], v40 offset:4096
v_subrev_u32 v9, 65536, v41
v_mfma_f32_16x16x32_bf16 v[224:227], a[156:159], v[176:179], v[224:227]
s_mul_i32 s36, s36, 147456
v_exp_f32 v193, v193
v_mfma_f32_16x16x32_bf16 v[232:235], a[156:159], v[180:183], v[52:55]
ds_read_b64_tr_b16 a[180:181], v40 offset:8192
ds_read_b64_tr_b16 a[182:183], v40 offset:12288
v_mfma_f32_16x16x32_bf16 v[232:235], a[152:155], v[164:167], v[232:235]
v_exp_f32 v194, v194
v_mfma_f32_16x16x32_bf16 v[232:235], a[148:151], v[148:151], v[232:235]
ds_read_b64_tr_b16 a[184:185], v41 offset:0
v_cvt_pk_bf16_f32 v64, v192, v193
v_mfma_f32_16x16x32_bf16 v[232:235], a[144:147], v[132:135], v[232:235]
s_add_u32 m0, s24, 32768
v_exp_f32 v195, v195
v_mfma_f32_16x16x32_bf16 v[240:243], a[144:147], v[136:139], v[56:59]
ds_read_b64_tr_b16 a[186:187], v41 offset:4096
v_cvt_pk_bf16_f32 v65, v194, v195
v_mfma_f32_16x16x32_bf16 v[240:243], a[148:151], v[152:155], v[240:243]
v_exp_f32 v196, v196
v_mfma_f32_16x16x32_bf16 v[240:243], a[152:155], v[168:171], v[240:243]
ds_read_b64_tr_b16 a[188:189], v41 offset:8192
ds_read_b64_tr_b16 a[190:191], v41 offset:12288
v_mfma_f32_16x16x32_bf16 v[240:243], a[156:159], v[184:187], v[240:243]
v_exp_f32 v197, v197
v_mfma_f32_16x16x32_bf16 v[248:251], a[156:159], v[188:191], v[60:63]
ds_read_b64_tr_b16 a[192:193], v42 offset:0
v_cvt_pk_bf16_f32 v66, v196, v197
v_mfma_f32_16x16x32_bf16 v[248:251], a[152:155], v[172:175], v[248:251]
buffer_load_dwordx4 v21, s[44:47], s36 offen offset:0 lds
v_mfma_f32_16x16x32_bf16 v[248:251], a[148:151], v[156:159], v[248:251]
v_exp_f32 v198, v198
v_mfma_f32_16x16x32_bf16 v[248:251], a[144:147], v[140:143], v[248:251]
ds_read_b64_tr_b16 a[194:195], v42 offset:4096
ds_read_b64_tr_b16 a[196:197], v42 offset:8192
v_mfma_f32_16x16x32_bf16 v[252:255], a[160:163], v[140:143], v[60:63]
v_exp_f32 v199, v199
v_mfma_f32_16x16x32_bf16 v[252:255], a[164:167], v[156:159], v[252:255]
ds_read_b64_tr_b16 a[198:199], v42 offset:12288
v_cvt_pk_bf16_f32 v67, v198, v199
v_mfma_f32_16x16x32_bf16 v[252:255], a[168:171], v[172:175], v[252:255]
buffer_load_dwordx4 v22, s[44:47], s36 offen offset:1024 lds
v_mfma_f32_16x16x32_bf16 v[252:255], a[172:175], v[188:191], v[252:255]
v_exp_f32 v200, v200
v_mfma_f32_16x16x32_bf16 v[244:247], a[172:175], v[184:187], v[56:59]
ds_read_b64_tr_b16 a[200:201], v43 offset:0
ds_read_b64_tr_b16 a[202:203], v43 offset:4096
v_mfma_f32_16x16x32_bf16 v[244:247], a[168:171], v[168:171], v[244:247]
v_exp_f32 v201, v201
v_mfma_f32_16x16x32_bf16 v[244:247], a[164:167], v[152:155], v[244:247]
buffer_load_dwordx4 v23, s[44:47], s36 offen offset:2048 lds
v_mfma_f32_16x16x32_bf16 v[244:247], a[160:163], v[136:139], v[244:247]
ds_read_b64_tr_b16 a[204:205], v43 offset:8192
v_exp_f32 v202, v202
v_mfma_f32_16x16x32_bf16 v[236:239], a[160:163], v[132:135], v[52:55]
ds_read_b64_tr_b16 a[206:207], v43 offset:12288
v_cvt_pk_bf16_f32 v72, v200, v201
v_mfma_f32_16x16x32_bf16 v[236:239], a[164:167], v[148:151], v[236:239]
v_exp_f32 v203, v203
v_mfma_f32_16x16x32_bf16 v[236:239], a[168:171], v[164:167], v[236:239]
buffer_load_dwordx4 v24, s[44:47], s36 offen offset:3072 lds
v_mfma_f32_16x16x32_bf16 v[236:239], a[172:175], v[180:183], v[236:239]
s_xor_b32 s36, s25, 5
v_exp_f32 v204, v204
v_mfma_f32_16x16x32_bf16 v[228:231], a[172:175], v[176:179], v[48:51]
v_exp_f32 v205, v205
v_mfma_f32_16x16x32_bf16 v[228:231], a[168:171], v[160:163], v[228:231]
v_cvt_pk_bf16_f32 v73, v202, v203
v_cvt_pk_bf16_f32 v74, v204, v205
v_mfma_f32_16x16x32_bf16 v[228:231], a[164:167], v[144:147], v[228:231]
s_mul_i32 s36, s36, 147456
v_exp_f32 v206, v206
v_mfma_f32_16x16x32_bf16 v[228:231], a[160:163], v[128:131], v[228:231]
s_waitcnt lgkmcnt(0)
v_exp_f32 v207, v207
v_mfma_f32_16x16x32_bf16 a[0:3], v[96:99], a[176:179], a[0:3]
ds_read_b128 a[144:147], v36 offset:49152
v_cvt_pk_bf16_f32 v75, v206, v207
v_mfma_f32_16x16x32_bf16 a[0:3], v[100:103], a[180:183], a[0:3]
v_exp_f32 v208, v208
v_mfma_f32_16x16x32_bf16 a[4:7], v[108:111], a[180:183], a[4:7]
s_add_u32 m0, s24, 81920
v_exp_f32 v209, v209
v_mfma_f32_16x16x32_bf16 a[4:7], v[104:107], a[176:179], a[4:7]
ds_read_b128 a[148:151], v37 offset:49152
v_cvt_pk_bf16_f32 v80, v208, v209
v_mfma_f32_16x16x32_bf16 a[8:11], v[112:115], a[176:179], a[8:11]
v_exp_f32 v210, v210
v_mfma_f32_16x16x32_bf16 a[8:11], v[116:119], a[180:183], a[8:11]
v_subrev_u32 v10, 65536, v42
v_subrev_u32 v11, 65536, v43
v_mfma_f32_16x16x32_bf16 a[12:15], v[124:127], a[180:183], a[12:15]
ds_read_b128 a[152:155], v38 offset:49152
v_subrev_u32 v12, 65536, v44
v_mfma_f32_16x16x32_bf16 a[12:15], v[120:123], a[176:179], a[12:15]
v_exp_f32 v211, v211
v_mfma_f32_16x16x32_bf16 a[28:31], v[120:123], a[184:187], a[28:31]
buffer_load_dwordx4 v21, s[44:47], s36 offen offset:0 lds
v_mfma_f32_16x16x32_bf16 a[28:31], v[124:127], a[188:191], a[28:31]
v_exp_f32 v212, v212
v_mfma_f32_16x16x32_bf16 a[24:27], v[116:119], a[188:191], a[24:27]
ds_read_b128 a[156:159], v39 offset:49152
v_cvt_pk_bf16_f32 v81, v210, v211
v_mfma_f32_16x16x32_bf16 a[24:27], v[112:115], a[184:187], a[24:27]
v_exp_f32 v213, v213
v_mfma_f32_16x16x32_bf16 a[20:23], v[104:107], a[184:187], a[20:23]
buffer_load_dwordx4 v22, s[44:47], s36 offen offset:1024 lds
v_mfma_f32_16x16x32_bf16 a[20:23], v[108:111], a[188:191], a[20:23]
v_exp_f32 v214, v214
v_mfma_f32_16x16x32_bf16 a[16:19], v[100:103], a[188:191], a[16:19]
ds_read_b128 a[160:163], v36 offset:53248
v_cvt_pk_bf16_f32 v82, v212, v213
v_mfma_f32_16x16x32_bf16 a[16:19], v[96:99], a[184:187], a[16:19]
v_exp_f32 v215, v215
v_mfma_f32_16x16x32_bf16 a[32:35], v[96:99], a[192:195], a[32:35]
buffer_load_dwordx4 v23, s[44:47], s36 offen offset:2048 lds
v_mfma_f32_16x16x32_bf16 a[32:35], v[100:103], a[196:199], a[32:35]
ds_read_b128 a[164:167], v37 offset:53248
v_cvt_pk_bf16_f32 v83, v214, v215
v_mfma_f32_16x16x32_bf16 a[36:39], v[108:111], a[196:199], a[36:39]
v_exp_f32 v216, v216
v_mfma_f32_16x16x32_bf16 a[36:39], v[104:107], a[192:195], a[36:39]
v_exp_f32 v217, v217
v_mfma_f32_16x16x32_bf16 a[40:43], v[112:115], a[192:195], a[40:43]
ds_read_b128 a[168:171], v38 offset:53248
v_cvt_pk_bf16_f32 v88, v216, v217
v_mfma_f32_16x16x32_bf16 a[40:43], v[116:119], a[196:199], a[40:43]
buffer_load_dwordx4 v24, s[44:47], s36 offen offset:3072 lds
v_mfma_f32_16x16x32_bf16 a[44:47], v[124:127], a[196:199], a[44:47]
v_exp_f32 v218, v218
v_mfma_f32_16x16x32_bf16 a[44:47], v[120:123], a[192:195], a[44:47]
ds_read_b128 a[172:175], v39 offset:53248
v_subrev_u32 v13, 65536, v45
v_mfma_f32_16x16x32_bf16 a[60:63], v[120:123], a[200:203], a[60:63]
s_waitcnt vmcnt(8)
v_exp_f32 v219, v219
v_mfma_f32_16x16x32_bf16 a[60:63], v[124:127], a[204:207], a[60:63]
v_exp_f32 v220, v220
v_mfma_f32_16x16x32_bf16 a[56:59], v[116:119], a[204:207], a[56:59]
v_accvgpr_read_b32 v4, a248
v_cvt_pk_bf16_f32 v89, v218, v219
v_mfma_f32_16x16x32_bf16 a[56:59], v[112:115], a[200:203], a[56:59]
v_exp_f32 v221, v221
v_mfma_f32_16x16x32_bf16 a[52:55], v[104:107], a[200:203], a[52:55]
v_accvgpr_read_b32 v5, a249
v_subrev_u32 v14, 65536, v46
v_mfma_f32_16x16x32_bf16 a[52:55], v[108:111], a[204:207], a[52:55]
v_exp_f32 v222, v222
v_mfma_f32_16x16x32_bf16 a[48:51], v[100:103], a[204:207], a[48:51]
v_cmp_eq_u64 vcc, s[66:67], v[4:5]
s_cmp_eq_u64 vcc, exec
s_cbranch_scc0 M_sps
M_sps_b:
v_mfma_f32_16x16x32_bf16 a[48:51], v[96:99], a[200:203], a[48:51]
v_subrev_u32 v15, 65536, v47
v_lshlrev_b32 v20, 3, v0
v_smfmac_f32_16x16x64_bf16 a[128:131], v[16:19], v[96:103], v26
v_add_u32 v20, 131072, v20
v_cvt_pk_bf16_f32 v90, v220, v221
v_smfmac_f32_16x16x64_bf16 a[132:135], v[16:19], v[104:111], v26
v_exp_f32 v223, v223
s_nop 0
v_cvt_pk_bf16_f32 v91, v222, v223
s_waitcnt lgkmcnt(0)
v_mfma_f32_16x16x32_bf16 v[192:195], a[144:147], v[128:131], v[48:51]
s_xor_b32 s37, s25, 0
ds_read_b64_tr_b16 a[176:177], v44 offset:0
v_and_b32 v2, 15, v0
v_mfma_f32_16x16x32_bf16 v[192:195], a[148:151], v[144:147], v[192:195]
v_exp_f32 v224, v224
v_mfma_f32_16x16x32_bf16 v[192:195], a[152:155], v[160:163], v[192:195]
ds_read_b64_tr_b16 a[178:179], v44 offset:4096
v_bfe_u32 v3, v0, 2, 2
v_mfma_f32_16x16x32_bf16 v[192:195], a[156:159], v[176:179], v[192:195]
s_mul_i32 s37, s37, 65536
v_exp_f32 v225, v225
v_mfma_f32_16x16x32_bf16 v[200:203], a[156:159], v[180:183], v[52:55]
ds_read_b64_tr_b16 a[180:181], v44 offset:8192
ds_read_b64_tr_b16 a[182:183], v44 offset:12288
v_mfma_f32_16x16x32_bf16 v[200:203], a[152:155], v[164:167], v[200:203]
v_exp_f32 v226, v226
v_mfma_f32_16x16x32_bf16 v[200:203], a[148:151], v[148:151], v[200:203]
s_add_u32 s37, s37, s49
ds_read_b64_tr_b16 a[184:185], v45 offset:0
v_cvt_pk_bf16_f32 v68, v224, v225
v_mfma_f32_16x16x32_bf16 v[200:203], a[144:147], v[132:135], v[200:203]
v_exp_f32 v227, v227
v_mfma_f32_16x16x32_bf16 v[208:211], a[144:147], v[136:139], v[56:59]
ds_read_b64_tr_b16 a[186:187], v45 offset:4096
v_cvt_pk_bf16_f32 v69, v226, v227
v_mfma_f32_16x16x32_bf16 v[208:211], a[148:151], v[152:155], v[208:211]
v_exp_f32 v228, v228
v_mfma_f32_16x16x32_bf16 v[208:211], a[152:155], v[168:171], v[208:211]
ds_read_b64_tr_b16 a[188:189], v45 offset:8192
ds_read_b64_tr_b16 a[190:191], v45 offset:12288
v_mfma_f32_16x16x32_bf16 v[208:211], a[156:159], v[184:187], v[208:211]
buffer_load_dwordx4 a[208:211], v7, s[16:19], s37 offen offset:0 sc1
v_mfma_f32_16x16x32_bf16 v[216:219], a[156:159], v[188:191], v[60:63]
v_exp_f32 v229, v229
v_mfma_f32_16x16x32_bf16 v[216:219], a[152:155], v[172:175], v[216:219]
ds_read_b64_tr_b16 a[192:193], v46 offset:0
ds_read_b64_tr_b16 a[194:195], v46 offset:4096
v_mfma_f32_16x16x32_bf16 v[216:219], a[148:151], v[156:159], v[216:219]
v_exp_f32 v230, v230
v_mfma_f32_16x16x32_bf16 v[216:219], a[144:147], v[140:143], v[216:219]
buffer_load_dwordx4 a[212:215], v7, s[16:19], s37 offen offset:1024 sc1
v_mfma_f32_16x16x32_bf16 v[220:223], a[160:163], v[140:143], v[60:63]
v_exp_f32 v231, v231
v_mfma_f32_16x16x32_bf16 v[220:223], a[164:167], v[156:159], v[220:223]
ds_read_b64_tr_b16 a[196:197], v46 offset:8192
v_cvt_pk_bf16_f32 v70, v228, v229
v_mfma_f32_16x16x32_bf16 v[220:223], a[168:171], v[172:175], v[220:223]
ds_read_b64_tr_b16 a[198:199], v46 offset:12288
ds_read_b64_tr_b16 a[200:201], v47 offset:0
v_mfma_f32_16x16x32_bf16 v[220:223], a[172:175], v[188:191], v[220:223]
buffer_load_dwordx4 a[216:219], v7, s[16:19], s37 offen offset:2048 sc1
v_exp_f32 v232, v232
v_mfma_f32_16x16x32_bf16 v[212:215], a[172:175], v[184:187], v[56:59]
v_exp_f32 v233, v233
v_mfma_f32_16x16x32_bf16 v[212:215], a[168:171], v[168:171], v[212:215]
ds_read_b64_tr_b16 a[202:203], v47 offset:4096
v_cvt_pk_bf16_f32 v71, v230, v231
v_mfma_f32_16x16x32_bf16 v[212:215], a[164:167], v[152:155], v[212:215]
buffer_load_dwordx4 a[220:223], v7, s[16:19], s37 offen offset:3072 sc1
v_mfma_f32_16x16x32_bf16 v[212:215], a[160:163], v[136:139], v[212:215]
ds_read_b64_tr_b16 a[204:205], v47 offset:8192
v_exp_f32 v234, v234
v_mfma_f32_16x16x32_bf16 v[204:207], a[160:163], v[132:135], v[52:55]
s_add_u32 s38, s37, 16384
ds_read_b64_tr_b16 a[206:207], v47 offset:12288
v_cvt_pk_bf16_f32 v76, v232, v233
v_mfma_f32_16x16x32_bf16 v[204:207], a[164:167], v[148:151], v[204:207]
v_exp_f32 v235, v235
v_mfma_f32_16x16x32_bf16 v[204:207], a[168:171], v[164:167], v[204:207]
v_exp_f32 v236, v236
v_mfma_f32_16x16x32_bf16 v[204:207], a[172:175], v[180:183], v[204:207]
buffer_load_dwordx4 a[224:227], v7, s[16:19], s38 offen offset:0 sc1
v_mfma_f32_16x16x32_bf16 v[196:199], a[172:175], v[176:179], v[48:51]
v_exp_f32 v237, v237
v_mfma_f32_16x16x32_bf16 v[196:199], a[168:171], v[160:163], v[196:199]
v_cvt_pk_bf16_f32 v77, v234, v235
v_cvt_pk_bf16_f32 v78, v236, v237
v_mfma_f32_16x16x32_bf16 v[196:199], a[164:167], v[144:147], v[196:199]
v_exp_f32 v238, v238
v_mfma_f32_16x16x32_bf16 v[196:199], a[160:163], v[128:131], v[196:199]
s_waitcnt lgkmcnt(0)
buffer_load_dwordx4 a[228:231], v7, s[16:19], s38 offen offset:1024 sc1
v_mfma_f32_16x16x32_bf16 a[64:67], v[96:99], a[176:179], a[64:67]
v_exp_f32 v239, v239
v_mfma_f32_16x16x32_bf16 a[64:67], v[100:103], a[180:183], a[64:67]
ds_read_b128 a[144:147], v36 offset:57344
v_cvt_pk_bf16_f32 v79, v238, v239
v_mfma_f32_16x16x32_bf16 a[68:71], v[108:111], a[180:183], a[68:71]
v_exp_f32 v240, v240
v_mfma_f32_16x16x32_bf16 a[68:71], v[104:107], a[176:179], a[68:71]
buffer_load_dwordx4 a[232:235], v7, s[16:19], s38 offen offset:2048 sc1
v_mfma_f32_16x16x32_bf16 a[72:75], v[112:115], a[176:179], a[72:75]
v_exp_f32 v241, v241
v_mfma_f32_16x16x32_bf16 a[72:75], v[116:119], a[180:183], a[72:75]
ds_read_b128 a[148:151], v37 offset:57344
v_cvt_pk_bf16_f32 v84, v240, v241
v_mfma_f32_16x16x32_bf16 a[76:79], v[124:127], a[180:183], a[76:79]
buffer_load_dwordx4 a[236:239], v7, s[16:19], s38 offen offset:3072 sc1
v_mfma_f32_16x16x32_bf16 a[76:79], v[120:123], a[176:179], a[76:79]
s_xor_b32 s37, s25, 0
v_exp_f32 v242, v242
v_mfma_f32_16x16x32_bf16 a[92:95], v[120:123], a[184:187], a[92:95]
ds_read_b128 a[152:155], v38 offset:57344
v_lshrrev_b32 v4, 4, v0
v_mfma_f32_16x16x32_bf16 a[92:95], v[124:127], a[188:191], a[92:95]
s_mul_i32 s37, s37, 65536
v_exp_f32 v243, v243
v_mfma_f32_16x16x32_bf16 a[88:91], v[116:119], a[188:191], a[88:91]
v_exp_f32 v244, v244
v_mfma_f32_16x16x32_bf16 a[88:91], v[112:115], a[184:187], a[88:91]
ds_read_b128 a[156:159], v39 offset:57344
v_cvt_pk_bf16_f32 v85, v242, v243
v_mfma_f32_16x16x32_bf16 a[84:87], v[104:107], a[184:187], a[84:87]
s_add_u32 s37, s37, s49
v_exp_f32 v245, v245
v_mfma_f32_16x16x32_bf16 a[84:87], v[108:111], a[188:191], a[84:87]
v_exp_f32 v246, v246
v_mfma_f32_16x16x32_bf16 a[80:83], v[100:103], a[188:191], a[80:83]
ds_read_b128 a[160:163], v36 offset:61440
v_cvt_pk_bf16_f32 v86, v244, v245
v_mfma_f32_16x16x32_bf16 a[80:83], v[96:99], a[184:187], a[80:83]
v_exp_f32 v247, v247
v_mfma_f32_16x16x32_bf16 a[96:99], v[96:99], a[192:195], a[96:99]
s_add_u32 s37, s37, 32768
ds_read_b128 a[164:167], v37 offset:61440
v_cvt_pk_bf16_f32 v87, v246, v247
v_mfma_f32_16x16x32_bf16 a[96:99], v[100:103], a[196:199], a[96:99]
v_exp_f32 v248, v248
v_mfma_f32_16x16x32_bf16 a[100:103], v[108:111], a[196:199], a[100:103]
v_exp_f32 v249, v249
v_mfma_f32_16x16x32_bf16 a[100:103], v[104:107], a[192:195], a[100:103]
ds_read_b128 a[168:171], v38 offset:61440
v_cvt_pk_bf16_f32 v92, v248, v249
v_mfma_f32_16x16x32_bf16 a[104:107], v[112:115], a[192:195], a[104:107]
buffer_load_dwordx4 a[240:243], v7, s[16:19], s37 offen offset:0 sc1
v_mfma_f32_16x16x32_bf16 a[104:107], v[116:119], a[196:199], a[104:107]
v_exp_f32 v250, v250
v_mfma_f32_16x16x32_bf16 a[108:111], v[124:127], a[196:199], a[108:111]
ds_read_b128 a[172:175], v39 offset:61440
v_xor_b32 v3, v3, v4
v_mfma_f32_16x16x32_bf16 a[108:111], v[120:123], a[192:195], a[108:111]
v_exp_f32 v251, v251
v_mfma_f32_16x16x32_bf16 a[124:127], v[120:123], a[200:203], a[124:127]
buffer_load_dwordx4 a[244:247], v7, s[16:19], s37 offen offset:1024 sc1
v_mfma_f32_16x16x32_bf16 a[124:127], v[124:127], a[204:207], a[124:127]
v_exp_f32 v252, v252
v_mfma_f32_16x16x32_bf16 a[120:123], v[116:119], a[204:207], a[120:123]
buffer_load_dwordx4 a[248:251], v7, s[16:19], s37 offen offset:2048 sc1
v_mfma_f32_16x16x32_bf16 a[120:123], v[112:115], a[200:203], a[120:123]
v_exp_f32 v253, v253
v_mfma_f32_16x16x32_bf16 a[116:119], v[104:107], a[200:203], a[116:119]
v_cvt_pk_bf16_f32 v93, v250, v251
v_lshlrev_b32 v3, 3, v3
v_mfma_f32_16x16x32_bf16 a[116:119], v[108:111], a[204:207], a[116:119]
v_exp_f32 v254, v254
v_mfma_f32_16x16x32_bf16 a[112:115], v[100:103], a[204:207], a[112:115]
buffer_load_dwordx4 a[252:255], v7, s[16:19], s37 offen offset:3072 sc1
v_mfma_f32_16x16x32_bf16 a[112:115], v[96:99], a[200:203], a[112:115]
v_lshl_add_u32 v1, v2, 5, v3
v_cvt_pk_bf16_f32 v94, v252, v253
v_smfmac_f32_16x16x64_bf16 a[136:139], v[16:19], v[112:119], v26
s_add_u32 s3, s39, 143360
v_add_u32 v1, s3, v1
v_and_b32 v3, 3, v0
v_xor_b32 v3, v3, v4
v_lshlrev_b32 v3, 3, v3
v_lshrrev_b32 v6, 2, v0
v_lshl_add_u32 v6, v6, 5, v3
v_add_u32 v6, s3, v6
v_lshl_add_u32 v28, v2, 2, s3
v_lshl_add_u32 v29, v4, 4, s3
v_mov_b32 v27, 1
v_min_u32 v32, 1, v0
v_lshlrev_b32 v32, 28, v32
v_and_b32 v33, 7, v0
v_lshlrev_b32 v33, 7, v33
v_smfmac_f32_16x16x64_bf16 a[140:143], v[16:19], v[120:127], v26
v_exp_f32 v255, v255
s_nop 0
v_cvt_pk_bf16_f32 v95, v254, v255
s_waitcnt vmcnt(22) lgkmcnt(0)
s_barrier
v_mfma_f32_16x16x32_bf16 v[224:227], a[144:147], v[128:131], v[48:51]
s_xor_b32 s36, s25, 0
ds_read_b64_tr_b16 a[176:177], v40 offset:32768
v_mfma_f32_16x16x32_bf16 v[224:227], a[148:151], v[144:147], v[224:227]
ds_read_b64_tr_b16 a[178:179], v40 offset:36864
v_mfma_f32_16x16x32_bf16 v[224:227], a[152:155], v[160:163], v[224:227]
v_exp_f32 v192, v192
v_mfma_f32_16x16x32_bf16 v[224:227], a[156:159], v[176:179], v[224:227]
v_exp_f32 v193, v193
v_mfma_f32_16x16x32_bf16 v[232:235], a[156:159], v[180:183], v[52:55]
ds_read_b64_tr_b16 a[180:181], v40 offset:40960
ds_read_b64_tr_b16 a[182:183], v40 offset:45056
v_mfma_f32_16x16x32_bf16 v[232:235], a[152:155], v[164:167], v[232:235]
s_mul_i32 s36, s36, 147456
v_exp_f32 v194, v194
v_mfma_f32_16x16x32_bf16 v[232:235], a[148:151], v[148:151], v[232:235]
v_exp_f32 v195, v195
v_mfma_f32_16x16x32_bf16 v[232:235], a[144:147], v[132:135], v[232:235]
v_exp_f32 v196, v196
v_mfma_f32_16x16x32_bf16 v[240:243], a[144:147], v[136:139], v[56:59]
ds_read_b64_tr_b16 a[184:185], v41 offset:32768
v_exp_f32 v197, v197
v_cvt_pk_bf16_f32 v96, v192, v193
v_mfma_f32_16x16x32_bf16 v[240:243], a[148:151], v[152:155], v[240:243]
ds_read_b64_tr_b16 a[186:187], v41 offset:36864
v_exp_f32 v198, v198
v_mfma_f32_16x16x32_bf16 v[240:243], a[152:155], v[168:171], v[240:243]
v_exp_f32 v199, v199
v_cvt_pk_bf16_f32 v97, v194, v195
v_mfma_f32_16x16x32_bf16 v[240:243], a[156:159], v[184:187], v[240:243]
ds_read_b64_tr_b16 a[188:189], v41 offset:40960
v_exp_f32 v200, v200
v_mfma_f32_16x16x32_bf16 v[248:251], a[156:159], v[188:191], v[60:63]
ds_read_b64_tr_b16 a[190:191], v41 offset:45056
v_exp_f32 v201, v201
v_cvt_pk_bf16_f32 v98, v196, v197
v_mfma_f32_16x16x32_bf16 v[248:251], a[152:155], v[172:175], v[248:251]
s_add_u32 m0, s24, 0
v_exp_f32 v202, v202
v_mfma_f32_16x16x32_bf16 v[248:251], a[148:151], v[156:159], v[248:251]
ds_read_b64_tr_b16 a[192:193], v42 offset:32768
v_exp_f32 v203, v203
v_cvt_pk_bf16_f32 v99, v198, v199
v_mfma_f32_16x16x32_bf16 v[248:251], a[144:147], v[140:143], v[248:251]
ds_read_b64_tr_b16 a[194:195], v42 offset:36864
v_exp_f32 v204, v204
v_mfma_f32_16x16x32_bf16 v[252:255], a[160:163], v[140:143], v[60:63]
v_exp_f32 v205, v205
v_cvt_pk_bf16_f32 v104, v200, v201
v_mfma_f32_16x16x32_bf16 v[252:255], a[164:167], v[156:159], v[252:255]
ds_read_b64_tr_b16 a[196:197], v42 offset:40960
v_exp_f32 v206, v206
v_mfma_f32_16x16x32_bf16 v[252:255], a[168:171], v[172:175], v[252:255]
ds_read_b64_tr_b16 a[198:199], v42 offset:45056
v_exp_f32 v207, v207
v_cvt_pk_bf16_f32 v105, v202, v203
v_mfma_f32_16x16x32_bf16 v[252:255], a[172:175], v[188:191], v[252:255]
v_exp_f32 v208, v208
v_mfma_f32_16x16x32_bf16 v[244:247], a[172:175], v[184:187], v[56:59]
ds_read_b64_tr_b16 a[200:201], v43 offset:32768
buffer_load_dwordx4 v21, s[44:47], s36 offen offset:0 lds
v_exp_f32 v209, v209
v_cvt_pk_bf16_f32 v106, v204, v205
v_mfma_f32_16x16x32_bf16 v[244:247], a[168:171], v[168:171], v[244:247]
ds_read_b64_tr_b16 a[202:203], v43 offset:36864
v_exp_f32 v210, v210
v_mfma_f32_16x16x32_bf16 v[244:247], a[164:167], v[152:155], v[244:247]
v_exp_f32 v211, v211
v_cvt_pk_bf16_f32 v107, v206, v207
v_mfma_f32_16x16x32_bf16 v[244:247], a[160:163], v[136:139], v[244:247]
ds_read_b64_tr_b16 a[204:205], v43 offset:40960
v_exp_f32 v212, v212
v_mfma_f32_16x16x32_bf16 v[236:239], a[160:163], v[132:135], v[52:55]
ds_read_b64_tr_b16 a[206:207], v43 offset:45056
v_exp_f32 v213, v213
v_cvt_pk_bf16_f32 v112, v208, v209
v_mfma_f32_16x16x32_bf16 v[236:239], a[164:167], v[148:151], v[236:239]
buffer_load_dwordx4 v22, s[44:47], s36 offen offset:1024 lds
v_exp_f32 v214, v214
v_mfma_f32_16x16x32_bf16 v[236:239], a[168:171], v[164:167], v[236:239]
v_exp_f32 v215, v215
v_cvt_pk_bf16_f32 v113, v210, v211
v_mfma_f32_16x16x32_bf16 v[236:239], a[172:175], v[180:183], v[236:239]
v_exp_f32 v216, v216
v_mfma_f32_16x16x32_bf16 v[228:231], a[172:175], v[176:179], v[48:51]
v_exp_f32 v217, v217
v_cvt_pk_bf16_f32 v114, v212, v213
v_mfma_f32_16x16x32_bf16 v[228:231], a[168:171], v[160:163], v[228:231]
v_exp_f32 v218, v218
v_mfma_f32_16x16x32_bf16 v[228:231], a[164:167], v[144:147], v[228:231]
v_exp_f32 v219, v219
v_cvt_pk_bf16_f32 v115, v214, v215
v_mfma_f32_16x16x32_bf16 v[228:231], a[160:163], v[128:131], v[228:231]
s_waitcnt lgkmcnt(0)
buffer_load_dwordx4 v23, s[44:47], s36 offen offset:2048 lds
v_exp_f32 v220, v220
v_mfma_f32_16x16x32_bf16 a[0:3], v[64:67], a[176:179], a[0:3]
v_exp_f32 v221, v221
v_cvt_pk_bf16_f32 v120, v216, v217
v_mfma_f32_16x16x32_bf16 a[0:3], v[68:71], a[180:183], a[0:3]
v_exp_f32 v222, v222
v_cvt_pk_bf16_f32 v121, v218, v219
v_cvt_pk_bf16_f32 v122, v220, v221
v_mfma_f32_16x16x32_bf16 a[4:7], v[76:79], a[180:183], a[4:7]
v_exp_f32 v223, v223
v_mfma_f32_16x16x32_bf16 a[4:7], v[72:75], a[176:179], a[4:7]
v_cvt_pk_bf16_f32 v123, v222, v223
v_mfma_f32_16x16x32_bf16 a[8:11], v[80:83], a[176:179], a[8:11]
v_exp_f32 v224, v224
v_mfma_f32_16x16x32_bf16 a[8:11], v[84:87], a[180:183], a[8:11]
buffer_load_dwordx4 v24, s[44:47], s36 offen offset:3072 lds
v_exp_f32 v225, v225
v_mfma_f32_16x16x32_bf16 a[12:15], v[92:95], a[180:183], a[12:15]
ds_read_b64_tr_b16 a[144:145], v40 offset:49152
v_exp_f32 v226, v226
v_mfma_f32_16x16x32_bf16 a[12:15], v[88:91], a[176:179], a[12:15]
ds_read_b64_tr_b16 a[146:147], v40 offset:53248
v_exp_f32 v227, v227
v_mfma_f32_16x16x32_bf16 a[28:31], v[88:91], a[184:187], a[28:31]
v_exp_f32 v232, v232
v_mfma_f32_16x16x32_bf16 a[28:31], v[92:95], a[188:191], a[28:31]
ds_read_b64_tr_b16 a[148:149], v40 offset:57344
v_exp_f32 v233, v233
v_cvt_pk_bf16_f32 v100, v224, v225
v_mfma_f32_16x16x32_bf16 a[24:27], v[84:87], a[188:191], a[24:27]
v_exp_f32 v234, v234
v_mfma_f32_16x16x32_bf16 a[24:27], v[80:83], a[184:187], a[24:27]
ds_read_b64_tr_b16 a[150:151], v40 offset:61440
v_exp_f32 v235, v235
v_cvt_pk_bf16_f32 v101, v226, v227
v_mfma_f32_16x16x32_bf16 a[20:23], v[72:75], a[184:187], a[20:23]
v_exp_f32 v240, v240
v_mfma_f32_16x16x32_bf16 a[20:23], v[76:79], a[188:191], a[20:23]
ds_read_b64_tr_b16 a[152:153], v41 offset:49152
v_exp_f32 v241, v241
v_cvt_pk_bf16_f32 v108, v232, v233
v_mfma_f32_16x16x32_bf16 a[16:19], v[68:71], a[188:191], a[16:19]
ds_read_b64_tr_b16 a[154:155], v41 offset:53248
v_exp_f32 v242, v242
v_mfma_f32_16x16x32_bf16 a[16:19], v[64:67], a[184:187], a[16:19]
v_exp_f32 v243, v243
v_cvt_pk_bf16_f32 v109, v234, v235
v_mfma_f32_16x16x32_bf16 a[32:35], v[64:67], a[192:195], a[32:35]
ds_read_b64_tr_b16 a[156:157], v41 offset:57344
v_exp_f32 v248, v248
v_mfma_f32_16x16x32_bf16 a[32:35], v[68:71], a[196:199], a[32:35]
v_exp_f32 v249, v249
v_cvt_pk_bf16_f32 v116, v240, v241
v_mfma_f32_16x16x32_bf16 a[36:39], v[76:79], a[196:199], a[36:39]
ds_read_b64_tr_b16 a[158:159], v41 offset:61440
v_exp_f32 v250, v250
v_mfma_f32_16x16x32_bf16 a[36:39], v[72:75], a[192:195], a[36:39]
v_exp_f32 v251, v251
v_cvt_pk_bf16_f32 v117, v242, v243
v_mfma_f32_16x16x32_bf16 a[40:43], v[80:83], a[192:195], a[40:43]
ds_read_b64_tr_b16 a[160:161], v42 offset:49152
v_exp_f32 v228, v228
v_mfma_f32_16x16x32_bf16 a[40:43], v[84:87], a[196:199], a[40:43]
ds_read_b64_tr_b16 a[162:163], v42 offset:53248
v_exp_f32 v229, v229
v_cvt_pk_bf16_f32 v124, v248, v249
v_mfma_f32_16x16x32_bf16 a[44:47], v[92:95], a[196:199], a[44:47]
v_exp_f32 v230, v230
v_mfma_f32_16x16x32_bf16 a[44:47], v[88:91], a[192:195], a[44:47]
ds_read_b64_tr_b16 a[164:165], v42 offset:57344
v_exp_f32 v231, v231
v_cvt_pk_bf16_f32 v125, v250, v251
v_mfma_f32_16x16x32_bf16 a[60:63], v[88:91], a[200:203], a[60:63]
v_exp_f32 v236, v236
v_mfma_f32_16x16x32_bf16 a[60:63], v[92:95], a[204:207], a[60:63]
ds_read_b64_tr_b16 a[166:167], v42 offset:61440
v_exp_f32 v237, v237
v_cvt_pk_bf16_f32 v102, v228, v229
v_mfma_f32_16x16x32_bf16 a[56:59], v[84:87], a[204:207], a[56:59]
v_exp_f32 v238, v238
v_mfma_f32_16x16x32_bf16 a[56:59], v[80:83], a[200:203], a[56:59]
ds_read_b64_tr_b16 a[168:169], v43 offset:49152
v_exp_f32 v239, v239
v_cvt_pk_bf16_f32 v103, v230, v231
v_mfma_f32_16x16x32_bf16 a[52:55], v[72:75], a[200:203], a[52:55]
ds_read_b64_tr_b16 a[170:171], v43 offset:53248
v_exp_f32 v244, v244
v_mfma_f32_16x16x32_bf16 a[52:55], v[76:79], a[204:207], a[52:55]
v_exp_f32 v245, v245
v_cvt_pk_bf16_f32 v110, v236, v237
v_mfma_f32_16x16x32_bf16 a[48:51], v[68:71], a[204:207], a[48:51]
ds_read_b64_tr_b16 a[172:173], v43 offset:57344
v_exp_f32 v246, v246
v_mfma_f32_16x16x32_bf16 a[48:51], v[64:67], a[200:203], a[48:51]
v_exp_f32 v247, v247
v_cvt_pk_bf16_f32 v111, v238, v239
v_smfmac_f32_16x16x64_bf16 a[128:131], v[16:19], v[64:71], v26
ds_read_b64_tr_b16 a[174:175], v43 offset:61440
v_exp_f32 v252, v252
v_smfmac_f32_16x16x64_bf16 a[132:135], v[16:19], v[72:79], v26
v_exp_f32 v253, v253
v_cvt_pk_bf16_f32 v118, v244, v245
v_smfmac_f32_16x16x64_bf16 a[136:139], v[16:19], v[80:87], v26
v_exp_f32 v254, v254
v_cvt_pk_bf16_f32 v119, v246, v247
v_cvt_pk_bf16_f32 v126, v252, v253
v_smfmac_f32_16x16x64_bf16 a[140:143], v[16:19], v[88:95], v26
v_exp_f32 v255, v255
v_smfmac_f32_16x16x64_bf16 a[128:131], v[16:19], v[96:103], v26
s_xor_b32 s36, s25, 0
v_cvt_pk_bf16_f32 v127, v254, v255
v_smfmac_f32_16x16x64_bf16 a[132:135], v[16:19], v[104:111], v26
v_smfmac_f32_16x16x64_bf16 a[136:139], v[16:19], v[112:119], v26
s_mul_i32 s36, s36, 147456
v_smfmac_f32_16x16x64_bf16 a[140:143], v[16:19], v[120:127], v26
s_waitcnt lgkmcnt(0)
v_mfma_f32_16x16x32_bf16 a[0:3], v[96:99], a[144:147], a[0:3]
ds_read_b64_tr_b16 a[176:177], v44 offset:32768
v_mfma_f32_16x16x32_bf16 a[0:3], v[100:103], a[148:151], a[0:3]
s_add_u32 s36, s36, 73728
ds_read_b64_tr_b16 a[178:179], v44 offset:36864
v_mfma_f32_16x16x32_bf16 a[4:7], v[108:111], a[148:151], a[4:7]
ds_read_b64_tr_b16 a[180:181], v44 offset:40960
v_mfma_f32_16x16x32_bf16 a[4:7], v[104:107], a[144:147], a[4:7]
v_mfma_f32_16x16x32_bf16 a[8:11], v[112:115], a[144:147], a[8:11]
s_add_u32 m0, s24, 16384
ds_read_b64_tr_b16 a[182:183], v44 offset:45056
v_accvgpr_read_b32 v240, a128
v_mfma_f32_16x16x32_bf16 a[8:11], v[116:119], a[148:151], a[8:11]
ds_read_b64_tr_b16 a[184:185], v45 offset:32768
v_accvgpr_read_b32 v241, a132
v_mfma_f32_16x16x32_bf16 a[12:15], v[124:127], a[148:151], a[12:15]
v_accvgpr_read_b32 v242, a136
v_accvgpr_read_b32 v243, a140
v_mfma_f32_16x16x32_bf16 a[12:15], v[120:123], a[144:147], a[12:15]
ds_read_b64_tr_b16 a[186:187], v45 offset:36864
v_accvgpr_read_b32 v244, a129
v_mfma_f32_16x16x32_bf16 a[28:31], v[120:123], a[152:155], a[28:31]
v_accvgpr_read_b32 v245, a133
v_accvgpr_read_b32 v246, a137
v_mfma_f32_16x16x32_bf16 a[28:31], v[124:127], a[156:159], a[28:31]
ds_read_b64_tr_b16 a[188:189], v45 offset:40960
v_accvgpr_read_b32 v247, a141
v_mfma_f32_16x16x32_bf16 a[24:27], v[116:119], a[156:159], a[24:27]
buffer_load_dwordx4 v21, s[44:47], s36 offen offset:0 lds
v_add_f32 v240, v240, v244
v_mfma_f32_16x16x32_bf16 a[24:27], v[112:115], a[152:155], a[24:27]
v_add_f32 v241, v241, v245
v_add_f32 v242, v242, v246
v_add_f32 v243, v243, v247
v_mfma_f32_16x16x32_bf16 a[20:23], v[104:107], a[152:155], a[20:23]
ds_read_b64_tr_b16 a[190:191], v45 offset:45056
v_rcp_f32 v244, v240
v_rcp_f32 v245, v241
v_mfma_f32_16x16x32_bf16 a[20:23], v[108:111], a[156:159], a[20:23]
ds_read_b64_tr_b16 a[192:193], v46 offset:32768
buffer_load_dwordx4 v22, s[44:47], s36 offen offset:1024 lds
v_rcp_f32 v246, v242
v_rcp_f32 v247, v243
v_mfma_f32_16x16x32_bf16 a[16:19], v[100:103], a[156:159], a[16:19]
s_mov_b32 s3, 0x5b800000
ds_read_b64_tr_b16 a[194:195], v46 offset:36864
v_add_f32 v240, v240, v241
v_mfma_f32_16x16x32_bf16 a[16:19], v[96:99], a[152:155], a[16:19]
v_add_f32 v242, v242, v243
v_add_f32 v240, v240, v242
ds_write2st64_b32 v28, v244, v245 offset1:1
buffer_load_dwordx4 v23, s[44:47], s36 offen offset:2048 lds
v_mfma_f32_16x16x32_bf16 a[32:35], v[96:99], a[160:163], a[32:35]
ds_read_b64_tr_b16 a[196:197], v46 offset:40960
ds_write2st64_b32 v28, v246, v247 offset0:2 offset1:3
ds_read_b128 v[16:19], v29 offset:0
v_mfma_f32_16x16x32_bf16 a[32:35], v[100:103], a[164:167], a[32:35]
ds_read_b64_tr_b16 a[198:199], v46 offset:45056
ds_read_b128 v[36:39], v29 offset:256
ds_read_b128 v[2:5], v29 offset:512
v_mfma_f32_16x16x32_bf16 a[36:39], v[108:111], a[164:167], a[36:39]
ds_read_b128 v[28:31], v29 offset:768
buffer_load_dwordx4 v24, s[44:47], s36 offen offset:3072 lds
v_cmp_nge_f32 vcc, s3, v240
v_mfma_f32_16x16x32_bf16 a[36:39], v[104:107], a[160:163], a[36:39]
s_lshl_b32 s3, s23, 2
s_add_u32 s3, s3, 65536
ds_read_b64_tr_b16 a[200:201], v47 offset:32768
v_mov_b32 v241, s3
v_mfma_f32_16x16x32_bf16 a[40:43], v[112:115], a[160:163], a[40:43]
s_cmp_lg_u64 vcc, 0
s_cselect_b32 s3, 1, 0
ds_read_b64_tr_b16 a[202:203], v47 offset:36864
v_mov_b32 v242, s3
v_accvgpr_read_b32 v192, a0
v_accvgpr_read_b32 v193, a1
v_mfma_f32_16x16x32_bf16 a[40:43], v[116:119], a[164:167], a[40:43]
s_xor_b32 s36, s25, 6
ds_write_b32 v241, v242
v_and_b32 v26, 3, v0
v_accvgpr_read_b32 v194, a2
v_accvgpr_read_b32 v195, a3
v_mfma_f32_16x16x32_bf16 a[44:47], v[124:127], a[164:167], a[44:47]
ds_read_b64_tr_b16 a[204:205], v47 offset:40960
v_lshlrev_b32 v26, 2, v26
v_add_u32 v26, 65536, v26
v_accvgpr_read_b32 v196, a16
v_accvgpr_read_b32 v197, a17
v_accvgpr_read_b32 v198, a18
v_mfma_f32_16x16x32_bf16 a[44:47], v[120:123], a[160:163], a[44:47]
ds_read_b64_tr_b16 a[206:207], v47 offset:45056
v_accvgpr_read_b32 v199, a19
v_accvgpr_read_b32 v200, a4
v_mfma_f32_16x16x32_bf16 a[60:63], v[120:123], a[168:171], a[60:63]
s_mul_i32 s36, s36, 147456
v_accvgpr_read_b32 v201, a5
v_accvgpr_read_b32 v202, a6
v_accvgpr_read_b32 v203, a7
v_mfma_f32_16x16x32_bf16 a[60:63], v[124:127], a[172:175], a[60:63]
s_waitcnt lgkmcnt(5)
v_accvgpr_read_b32 v204, a20
v_accvgpr_read_b32 v205, a21
v_mfma_f32_16x16x32_bf16 a[56:59], v[116:119], a[172:175], a[56:59]
v_accvgpr_read_b32 v206, a22
v_accvgpr_read_b32 v207, a23
v_mul_f32 v192, v192, v16
v_mfma_f32_16x16x32_bf16 a[56:59], v[112:115], a[168:171], a[56:59]
s_add_u32 m0, s24, 49152
v_mul_f32 v193, v193, v17
v_mul_f32 v194, v194, v18
v_mfma_f32_16x16x32_bf16 a[52:55], v[104:107], a[168:171], a[52:55]
v_mul_f32 v195, v195, v19
v_mul_f32 v196, v196, v16
v_mul_f32 v197, v197, v17
v_mfma_f32_16x16x32_bf16 a[52:55], v[108:111], a[172:175], a[52:55]
buffer_load_dwordx4 v21, s[44:47], s36 offen offset:0 lds
v_mul_f32 v198, v198, v18
v_mul_f32 v199, v199, v19
v_mfma_f32_16x16x32_bf16 a[48:51], v[100:103], a[172:175], a[48:51]
v_cvt_pk_bf16_f32 v192, v192, v193
v_cvt_pk_bf16_f32 v193, v194, v195
v_cvt_pk_bf16_f32 v194, v196, v197
v_mfma_f32_16x16x32_bf16 a[48:51], v[96:99], a[168:171], a[48:51]
s_waitcnt lgkmcnt(0)
v_cvt_pk_bf16_f32 v195, v198, v199
v_mul_f32 v200, v200, v36
v_mfma_f32_16x16x32_bf16 a[64:67], v[64:67], a[176:179], a[64:67]
buffer_load_dwordx4 v22, s[44:47], s36 offen offset:1024 lds
v_mul_f32 v201, v201, v37
v_mul_f32 v202, v202, v38
v_mul_f32 v203, v203, v39
v_mfma_f32_16x16x32_bf16 a[64:67], v[68:71], a[180:183], a[64:67]
ds_write2st64_b64 v1, v[192:193], v[194:195] offset1:1
v_mul_f32 v204, v204, v36
v_mul_f32 v205, v205, v37
v_mfma_f32_16x16x32_bf16 a[68:71], v[76:79], a[180:183], a[68:71]
ds_read_b64_tr_b16 a[144:145], v44 offset:49152
ds_read_b64_tr_b16 v[48:49], v6 offset:0
v_mul_f32 v206, v206, v38
v_mul_f32 v207, v207, v39
v_cvt_pk_bf16_f32 v200, v200, v201
v_mfma_f32_16x16x32_bf16 a[68:71], v[72:75], a[176:179], a[68:71]
ds_read_b64_tr_b16 a[146:147], v44 offset:53248
ds_read_b64_tr_b16 v[50:51], v6 offset:512
buffer_load_dwordx4 v23, s[44:47], s36 offen offset:2048 lds
v_cvt_pk_bf16_f32 v201, v202, v203
v_cvt_pk_bf16_f32 v202, v204, v205
v_mfma_f32_16x16x32_bf16 a[72:75], v[80:83], a[176:179], a[72:75]
ds_read_b64_tr_b16 a[148:149], v44 offset:57344
v_cvt_pk_bf16_f32 v203, v206, v207
v_accvgpr_read_b32 v208, a8
v_accvgpr_read_b32 v209, a9
v_mfma_f32_16x16x32_bf16 a[72:75], v[84:87], a[180:183], a[72:75]
v_accvgpr_read_b32 v210, a10
v_accvgpr_read_b32 v211, a11
v_mfma_f32_16x16x32_bf16 a[76:79], v[92:95], a[180:183], a[76:79]
ds_read_b64_tr_b16 a[150:151], v44 offset:61440
ds_write2st64_b64 v1, v[200:201], v[202:203] offset1:1
buffer_load_dwordx4 v24, s[44:47], s36 offen offset:3072 lds
v_accvgpr_read_b32 v212, a24
v_accvgpr_read_b32 v213, a25
v_accvgpr_read_b32 v214, a26
v_mfma_f32_16x16x32_bf16 a[76:79], v[88:91], a[176:179], a[76:79]
ds_read_b64_tr_b16 a[152:153], v45 offset:49152
ds_read_b64_tr_b16 v[52:53], v6 offset:0
v_accvgpr_read_b32 v215, a27
v_mul_f32 v208, v208, v2
v_mfma_f32_16x16x32_bf16 a[92:95], v[88:91], a[184:187], a[92:95]
ds_read_b64_tr_b16 v[54:55], v6 offset:512
v_mul_f32 v209, v209, v3
v_mul_f32 v210, v210, v4
v_mul_f32 v211, v211, v5
v_mfma_f32_16x16x32_bf16 a[92:95], v[92:95], a[188:191], a[92:95]
ds_read_b64_tr_b16 a[154:155], v45 offset:53248
v_mul_f32 v212, v212, v2
v_mul_f32 v213, v213, v3
v_mfma_f32_16x16x32_bf16 a[88:91], v[84:87], a[188:191], a[88:91]
ds_read_b64_tr_b16 a[156:157], v45 offset:57344
v_mul_f32 v214, v214, v4
v_mul_f32 v215, v215, v5
v_cvt_pk_bf16_f32 v208, v208, v209
v_mfma_f32_16x16x32_bf16 a[88:91], v[80:83], a[184:187], a[88:91]
s_waitcnt lgkmcnt(8)
s_add_u32 s40, s53, 0
buffer_store_dwordx4 v[48:51], v7, s[16:19], s40 offen offset:0 sc1
v_cvt_pk_bf16_f32 v209, v210, v211
v_cvt_pk_bf16_f32 v210, v212, v213
v_mfma_f32_16x16x32_bf16 a[84:87], v[72:75], a[184:187], a[84:87]
ds_read_b64_tr_b16 a[158:159], v45 offset:61440
v_cvt_pk_bf16_f32 v211, v214, v215
v_accvgpr_read_b32 v216, a12
v_accvgpr_read_b32 v217, a13
v_mfma_f32_16x16x32_bf16 a[84:87], v[76:79], a[188:191], a[84:87]
ds_read_b64_tr_b16 a[160:161], v46 offset:49152
v_accvgpr_read_b32 v218, a14
v_accvgpr_read_b32 v219, a15
v_mfma_f32_16x16x32_bf16 a[80:83], v[68:71], a[188:191], a[80:83]
ds_read_b64_tr_b16 a[162:163], v46 offset:53248
ds_write2st64_b64 v1, v[208:209], v[210:211] offset1:1
v_accvgpr_read_b32 v220, a28
v_accvgpr_read_b32 v221, a29
v_accvgpr_read_b32 v222, a30
v_mfma_f32_16x16x32_bf16 a[80:83], v[64:67], a[184:187], a[80:83]
ds_read_b64_tr_b16 v[56:57], v6 offset:0
v_accvgpr_read_b32 v223, a31
v_mul_f32 v216, v216, v28
v_mfma_f32_16x16x32_bf16 a[96:99], v[64:67], a[192:195], a[96:99]
s_waitcnt lgkmcnt(7)
ds_read_b64_tr_b16 a[164:165], v46 offset:57344
ds_read_b64_tr_b16 v[58:59], v6 offset:512
buffer_store_dwordx4 v[52:55], v7, s[16:19], s40 offen offset:1024 sc1
v_mul_f32 v217, v217, v29
v_mul_f32 v218, v218, v30
v_mul_f32 v219, v219, v31
v_mfma_f32_16x16x32_bf16 a[96:99], v[68:71], a[196:199], a[96:99]
ds_read_b64_tr_b16 a[166:167], v46 offset:61440
v_mul_f32 v220, v220, v28
v_mul_f32 v221, v221, v29
v_mfma_f32_16x16x32_bf16 a[100:103], v[76:79], a[196:199], a[100:103]
v_mul_f32 v222, v222, v30
v_mul_f32 v223, v223, v31
v_cvt_pk_bf16_f32 v216, v216, v217
v_mfma_f32_16x16x32_bf16 a[100:103], v[72:75], a[192:195], a[100:103]
ds_read_b64_tr_b16 a[168:169], v47 offset:49152
v_cvt_pk_bf16_f32 v217, v218, v219
v_cvt_pk_bf16_f32 v218, v220, v221
v_mfma_f32_16x16x32_bf16 a[104:107], v[80:83], a[192:195], a[104:107]
ds_read_b64_tr_b16 a[170:171], v47 offset:53248
v_cvt_pk_bf16_f32 v219, v222, v223
v_accvgpr_read_b32 v224, a32
v_accvgpr_read_b32 v225, a33
v_mfma_f32_16x16x32_bf16 a[104:107], v[84:87], a[196:199], a[104:107]
v_accvgpr_read_b32 v226, a34
v_accvgpr_read_b32 v227, a35
v_mfma_f32_16x16x32_bf16 a[108:111], v[92:95], a[196:199], a[108:111]
ds_read_b64_tr_b16 a[172:173], v47 offset:57344
ds_write2st64_b64 v1, v[216:217], v[218:219] offset1:1
v_accvgpr_read_b32 v228, a48
v_accvgpr_read_b32 v229, a49
v_accvgpr_read_b32 v230, a50
v_mfma_f32_16x16x32_bf16 a[108:111], v[88:91], a[192:195], a[108:111]
ds_read_b64_tr_b16 a[174:175], v47 offset:61440
ds_read_b64_tr_b16 v[60:61], v6 offset:0
v_accvgpr_read_b32 v231, a51
v_mul_f32 v224, v224, v16
v_mfma_f32_16x16x32_bf16 a[124:127], v[88:91], a[200:203], a[124:127]
s_waitcnt lgkmcnt(7)
ds_read_b64_tr_b16 v[62:63], v6 offset:512
buffer_store_dwordx4 v[56:59], v7, s[16:19], s40 offen offset:2048 sc1
v_mul_f32 v225, v225, v17
v_mul_f32 v226, v226, v18
v_mul_f32 v227, v227, v19
v_mfma_f32_16x16x32_bf16 a[124:127], v[92:95], a[204:207], a[124:127]
v_mul_f32 v228, v228, v16
v_mul_f32 v229, v229, v17
v_mfma_f32_16x16x32_bf16 a[120:123], v[84:87], a[204:207], a[120:123]
v_mul_f32 v230, v230, v18
v_mul_f32 v231, v231, v19
v_cvt_pk_bf16_f32 v224, v224, v225
v_mfma_f32_16x16x32_bf16 a[120:123], v[80:83], a[200:203], a[120:123]
v_cvt_pk_bf16_f32 v225, v226, v227
v_cvt_pk_bf16_f32 v226, v228, v229
v_mfma_f32_16x16x32_bf16 a[116:119], v[72:75], a[200:203], a[116:119]
v_cvt_pk_bf16_f32 v227, v230, v231
v_accvgpr_read_b32 v232, a36
v_accvgpr_read_b32 v233, a37
v_mfma_f32_16x16x32_bf16 a[116:119], v[76:79], a[204:207], a[116:119]
v_accvgpr_read_b32 v234, a38
v_accvgpr_read_b32 v235, a39
v_mfma_f32_16x16x32_bf16 a[112:115], v[68:71], a[204:207], a[112:115]
v_accvgpr_read_b32 v236, a52
v_accvgpr_read_b32 v237, a53
v_accvgpr_read_b32 v238, a54
v_mfma_f32_16x16x32_bf16 a[112:115], v[64:67], a[200:203], a[112:115]
s_waitcnt vmcnt(11) lgkmcnt(2)
s_barrier
v_accvgpr_read_b32 v239, a55
v_mul_f32 v232, v232, v36
v_mfma_f32_16x16x32_bf16 a[64:67], v[96:99], a[144:147], a[64:67]
s_waitcnt lgkmcnt(0)
buffer_store_dwordx4 v[60:63], v7, s[16:19], s40 offen offset:3072 sc1
v_mul_f32 v233, v233, v37
v_mul_f32 v234, v234, v38
v_mul_f32 v235, v235, v39
v_mfma_f32_16x16x32_bf16 a[64:67], v[100:103], a[148:151], a[64:67]
v_mul_f32 v236, v236, v36
v_mul_f32 v237, v237, v37
v_mfma_f32_16x16x32_bf16 a[68:71], v[108:111], a[148:151], a[68:71]
ds_write2st64_b64 v1, v[224:225], v[226:227] offset1:1
v_mul_f32 v238, v238, v38
v_mul_f32 v239, v239, v39
v_cvt_pk_bf16_f32 v232, v232, v233
v_mfma_f32_16x16x32_bf16 a[68:71], v[104:107], a[144:147], a[68:71]
ds_read_b32 v26, v26
ds_read_b64_tr_b16 v[64:65], v6 offset:0
v_cvt_pk_bf16_f32 v233, v234, v235
v_cvt_pk_bf16_f32 v234, v236, v237
v_mfma_f32_16x16x32_bf16 a[72:75], v[112:115], a[144:147], a[72:75]
ds_read_b64_tr_b16 a[176:177], v8 offset:0
ds_read_b64_tr_b16 v[66:67], v6 offset:512
v_cvt_pk_bf16_f32 v235, v238, v239
v_accvgpr_read_b32 v240, a40
v_accvgpr_read_b32 v241, a41
v_mfma_f32_16x16x32_bf16 a[72:75], v[116:119], a[148:151], a[72:75]
ds_read_b64_tr_b16 a[178:179], v8 offset:4096
v_accvgpr_read_b32 v242, a42
v_accvgpr_read_b32 v243, a43
v_mfma_f32_16x16x32_bf16 a[76:79], v[124:127], a[148:151], a[76:79]
ds_read_b64_tr_b16 a[180:181], v9 offset:0
ds_write2st64_b64 v1, v[232:233], v[234:235] offset1:1
v_accvgpr_read_b32 v244, a56
v_accvgpr_read_b32 v245, a57
v_accvgpr_read_b32 v246, a58
v_mfma_f32_16x16x32_bf16 a[76:79], v[120:123], a[144:147], a[76:79]
ds_read_b64_tr_b16 v[68:69], v6 offset:0
v_accvgpr_read_b32 v247, a59
v_mul_f32 v240, v240, v2
v_mfma_f32_16x16x32_bf16 a[92:95], v[120:123], a[152:155], a[92:95]
ds_read_b64_tr_b16 a[182:183], v9 offset:4096
ds_read_b64_tr_b16 v[70:71], v6 offset:512
v_mul_f32 v241, v241, v3
v_mul_f32 v242, v242, v4
v_mul_f32 v243, v243, v5
v_mfma_f32_16x16x32_bf16 a[92:95], v[124:127], a[156:159], a[92:95]
ds_read_b64_tr_b16 a[184:185], v10 offset:0
v_mul_f32 v244, v244, v2
v_mul_f32 v245, v245, v3
v_mfma_f32_16x16x32_bf16 a[88:91], v[116:119], a[156:159], a[88:91]
ds_read_b64_tr_b16 a[186:187], v10 offset:4096
v_mul_f32 v246, v246, v4
v_mul_f32 v247, v247, v5
v_cvt_pk_bf16_f32 v240, v240, v241
v_mfma_f32_16x16x32_bf16 a[88:91], v[112:115], a[152:155], a[88:91]
ds_read_b64_tr_b16 a[188:189], v11 offset:0
v_cvt_pk_bf16_f32 v241, v242, v243
v_cvt_pk_bf16_f32 v242, v244, v245
v_mfma_f32_16x16x32_bf16 a[84:87], v[104:107], a[152:155], a[84:87]
s_waitcnt lgkmcnt(9)
s_add_u32 s40, s53, 16384
buffer_store_dwordx4 v[64:67], v7, s[16:19], s40 offen offset:0 sc1
v_cvt_pk_bf16_f32 v243, v246, v247
v_accvgpr_read_b32 v248, a44
v_accvgpr_read_b32 v249, a45
v_mfma_f32_16x16x32_bf16 a[84:87], v[108:111], a[156:159], a[84:87]
ds_read_b64_tr_b16 a[190:191], v11 offset:4096
v_accvgpr_read_b32 v250, a46
v_accvgpr_read_b32 v251, a47
v_mfma_f32_16x16x32_bf16 a[80:83], v[100:103], a[156:159], a[80:83]
ds_read_b64_tr_b16 a[192:193], v12 offset:0
ds_write2st64_b64 v1, v[240:241], v[242:243] offset1:1
v_accvgpr_read_b32 v252, a60
v_accvgpr_read_b32 v253, a61
v_accvgpr_read_b32 v254, a62
v_mfma_f32_16x16x32_bf16 a[80:83], v[96:99], a[152:155], a[80:83]
ds_read_b64_tr_b16 a[194:195], v12 offset:4096
ds_read_b64_tr_b16 v[72:73], v6 offset:0
v_accvgpr_read_b32 v255, a63
v_mul_f32 v248, v248, v28
v_mfma_f32_16x16x32_bf16 a[96:99], v[96:99], a[160:163], a[96:99]
s_waitcnt lgkmcnt(8)
ds_read_b64_tr_b16 a[196:197], v13 offset:0
ds_read_b64_tr_b16 v[74:75], v6 offset:512
buffer_store_dwordx4 v[68:71], v7, s[16:19], s40 offen offset:1024 sc1
v_mul_f32 v249, v249, v29
v_mul_f32 v250, v250, v30
v_mul_f32 v251, v251, v31
v_mfma_f32_16x16x32_bf16 a[96:99], v[100:103], a[164:167], a[96:99]
v_mul_f32 v252, v252, v28
v_mul_f32 v253, v253, v29
v_mfma_f32_16x16x32_bf16 a[100:103], v[108:111], a[164:167], a[100:103]
ds_read_b64_tr_b16 a[198:199], v13 offset:4096
v_mul_f32 v254, v254, v30
v_mul_f32 v255, v255, v31
v_cvt_pk_bf16_f32 v248, v248, v249
v_mfma_f32_16x16x32_bf16 a[100:103], v[104:107], a[160:163], a[100:103]
ds_read_b64_tr_b16 a[200:201], v14 offset:0
v_cvt_pk_bf16_f32 v249, v250, v251
v_cvt_pk_bf16_f32 v250, v252, v253
v_mfma_f32_16x16x32_bf16 a[104:107], v[112:115], a[160:163], a[104:107]
ds_read_b64_tr_b16 a[202:203], v14 offset:4096
v_cvt_pk_bf16_f32 v251, v254, v255
v_mfma_f32_16x16x32_bf16 a[104:107], v[116:119], a[164:167], a[104:107]
ds_read_b64_tr_b16 a[204:205], v15 offset:0
ds_write2st64_b64 v1, v[248:249], v[250:251] offset1:1
v_mfma_f32_16x16x32_bf16 a[108:111], v[124:127], a[164:167], a[108:111]
s_waitcnt lgkmcnt(5)
ds_read_b64_tr_b16 a[206:207], v15 offset:4096
ds_read_b64_tr_b16 v[76:77], v6 offset:0
v_mfma_f32_16x16x32_bf16 a[108:111], v[120:123], a[160:163], a[108:111]
ds_read_b64_tr_b16 a[128:129], v20 offset:0
ds_read_b64_tr_b16 v[78:79], v6 offset:512
v_mfma_f32_16x16x32_bf16 a[124:127], v[120:123], a[168:171], a[124:127]
buffer_store_dwordx4 v[72:75], v7, s[16:19], s40 offen offset:2048 sc1
v_mfma_f32_16x16x32_bf16 a[124:127], v[124:127], a[172:175], a[124:127]
ds_read_b64_tr_b16 a[130:131], v20 offset:512
v_mfma_f32_16x16x32_bf16 a[120:123], v[116:119], a[172:175], a[120:123]
v_mfma_f32_16x16x32_bf16 a[120:123], v[112:115], a[168:171], a[120:123]
v_mfma_f32_16x16x32_bf16 a[116:119], v[104:107], a[168:171], a[116:119]
v_mfma_f32_16x16x32_bf16 a[116:119], v[108:111], a[172:175], a[116:119]
s_waitcnt lgkmcnt(1)
buffer_store_dwordx4 v[76:79], v7, s[16:19], s40 offen offset:3072 sc1
v_mfma_f32_16x16x32_bf16 a[112:115], v[100:103], a[172:175], a[112:115]
v_mfma_f32_16x16x32_bf16 a[112:115], v[96:99], a[168:171], a[112:115]
s_waitcnt lgkmcnt(15)
v_cmp_lt_u32 vcc, s50, v26
s_cmp_lg_u32 vcc_lo, 0
s_cbranch_scc1 M_fallback
v_mov_b32 v34, 2
v_bfe_u32 v35, v0, 2, 1
v_xor_b32 v35, 1, v35
s_cmp_lg_u32 s54, 1
s_cbranch_scc1 M_p3s
s_waitcnt lgkmcnt(0)
v_mfma_f32_16x16x32_bf16 v[112:115], a[176:179], v[48:51], 0
v_accvgpr_read_b32 v96, a64
v_accvgpr_read_b32 v97, a65
v_mfma_f32_16x16x32_bf16 v[128:131], a[180:183], v[48:51], 0
v_accvgpr_read_b32 v98, a66
v_accvgpr_read_b32 v99, a67
v_mfma_f32_16x16x32_bf16 v[144:147], a[184:187], v[48:51], 0
v_accvgpr_read_b32 v100, a80
v_accvgpr_read_b32 v101, a81
v_mfma_f32_16x16x32_bf16 v[160:163], a[188:191], v[48:51], 0
v_accvgpr_read_b32 v102, a82
v_accvgpr_read_b32 v103, a83
v_mfma_f32_16x16x32_bf16 v[176:179], a[192:195], v[48:51], 0
v_mul_f32 v96, v96, v16
v_mul_f32 v97, v97, v17
v_mfma_f32_16x16x32_bf16 v[192:195], a[196:199], v[48:51], 0
v_mul_f32 v98, v98, v18
v_mul_f32 v99, v99, v19
v_mfma_f32_16x16x32_bf16 v[208:211], a[200:203], v[48:51], 0
v_mul_f32 v100, v100, v16
v_mul_f32 v101, v101, v17
v_mfma_f32_16x16x32_bf16 v[224:227], a[204:207], v[48:51], 0
v_mul_f32 v102, v102, v18
v_mul_f32 v103, v103, v19
v_mfma_f32_16x16x32_bf16 v[240:243], a[128:131], v[48:51], 0
v_cvt_pk_bf16_f32 v96, v96, v97
v_cvt_pk_bf16_f32 v97, v98, v99
v_mfma_f32_16x16x32_bf16 v[116:119], a[176:179], v[52:55], 0
v_cvt_pk_bf16_f32 v98, v100, v101
v_cvt_pk_bf16_f32 v99, v102, v103
v_mfma_f32_16x16x32_bf16 v[132:135], a[180:183], v[52:55], 0
ds_write2st64_b64 v1, v[96:97], v[98:99] offset1:1
v_accvgpr_read_b32 v104, a68
v_mfma_f32_16x16x32_bf16 v[148:151], a[184:187], v[52:55], 0
v_accvgpr_read_b32 v105, a69
v_accvgpr_read_b32 v106, a70
v_mfma_f32_16x16x32_bf16 v[164:167], a[188:191], v[52:55], 0
ds_read_b64_tr_b16 v[80:81], v6 offset:0
v_accvgpr_read_b32 v107, a71
v_mfma_f32_16x16x32_bf16 v[180:183], a[192:195], v[52:55], 0
v_accvgpr_read_b32 v108, a84
v_accvgpr_read_b32 v109, a85
v_mfma_f32_16x16x32_bf16 v[196:199], a[196:199], v[52:55], 0
ds_read_b64_tr_b16 v[82:83], v6 offset:512
v_accvgpr_read_b32 v110, a86
v_mfma_f32_16x16x32_bf16 v[212:215], a[200:203], v[52:55], 0
v_accvgpr_read_b32 v111, a87
v_mul_f32 v104, v104, v36
v_mfma_f32_16x16x32_bf16 v[228:231], a[204:207], v[52:55], 0
v_mul_f32 v105, v105, v37
v_mul_f32 v106, v106, v38
v_mfma_f32_16x16x32_bf16 v[244:247], a[128:131], v[52:55], 0
v_mul_f32 v107, v107, v39
v_mul_f32 v108, v108, v36
v_mfma_f32_16x16x32_bf16 v[120:123], a[176:179], v[56:59], 0
v_mul_f32 v109, v109, v37
v_mul_f32 v110, v110, v38
v_mfma_f32_16x16x32_bf16 v[136:139], a[180:183], v[56:59], 0
v_mul_f32 v111, v111, v39
v_cvt_pk_bf16_f32 v104, v104, v105
v_mfma_f32_16x16x32_bf16 v[152:155], a[184:187], v[56:59], 0
s_waitcnt lgkmcnt(0)
v_cvt_pk_bf16_f32 v105, v106, v107
v_cvt_pk_bf16_f32 v106, v108, v109
v_mfma_f32_16x16x32_bf16 v[168:171], a[188:191], v[56:59], 0
ds_read_b64_tr_b16 a[132:133], v8 offset:8192
v_cvt_pk_bf16_f32 v107, v110, v111
v_mfma_f32_16x16x32_bf16 v[184:187], a[192:195], v[56:59], 0
ds_read_b64_tr_b16 a[134:135], v8 offset:12288
ds_read_b64_tr_b16 a[136:137], v9 offset:8192
v_mfma_f32_16x16x32_bf16 v[200:203], a[196:199], v[56:59], 0
ds_read_b64_tr_b16 a[138:139], v9 offset:12288
ds_read_b64_tr_b16 a[140:141], v10 offset:8192
v_mfma_f32_16x16x32_bf16 v[216:219], a[200:203], v[56:59], 0
ds_read_b64_tr_b16 a[142:143], v10 offset:12288
ds_read_b64_tr_b16 a[144:145], v11 offset:8192
v_mfma_f32_16x16x32_bf16 v[232:235], a[204:207], v[56:59], 0
ds_read_b64_tr_b16 a[146:147], v11 offset:12288
ds_read_b64_tr_b16 a[148:149], v12 offset:8192
v_mfma_f32_16x16x32_bf16 v[248:251], a[128:131], v[56:59], 0
ds_read_b64_tr_b16 a[150:151], v12 offset:12288
ds_read_b64_tr_b16 a[152:153], v13 offset:8192
v_mfma_f32_16x16x32_bf16 v[124:127], a[176:179], v[60:63], 0
ds_read_b64_tr_b16 a[154:155], v13 offset:12288
ds_read_b64_tr_b16 a[156:157], v14 offset:8192
v_mfma_f32_16x16x32_bf16 v[140:143], a[180:183], v[60:63], 0
ds_read_b64_tr_b16 a[158:159], v14 offset:12288
ds_read_b64_tr_b16 a[160:161], v15 offset:8192
v_mfma_f32_16x16x32_bf16 v[156:159], a[184:187], v[60:63], 0
ds_read_b64_tr_b16 a[162:163], v15 offset:12288
ds_read_b64_tr_b16 a[164:165], v20 offset:1024
ds_read_b64_tr_b16 a[166:167], v20 offset:1536
v_mfma_f32_16x16x32_bf16 v[172:175], a[188:191], v[60:63], 0
v_accvgpr_read_b32 v96, a72
v_accvgpr_read_b32 v97, a73
v_mfma_f32_16x16x32_bf16 v[188:191], a[192:195], v[60:63], 0
ds_write2st64_b64 v1, v[104:105], v[106:107] offset1:1
v_accvgpr_read_b32 v98, a74
v_mfma_f32_16x16x32_bf16 v[204:207], a[196:199], v[60:63], 0
ds_read_b64_tr_b16 v[84:85], v6 offset:0
v_accvgpr_read_b32 v99, a75
v_mfma_f32_16x16x32_bf16 v[220:223], a[200:203], v[60:63], 0
v_accvgpr_read_b32 v100, a88
v_accvgpr_read_b32 v101, a89
v_mfma_f32_16x16x32_bf16 v[236:239], a[204:207], v[60:63], 0
ds_read_b64_tr_b16 v[86:87], v6 offset:512
v_accvgpr_read_b32 v102, a90
v_mfma_f32_16x16x32_bf16 v[252:255], a[128:131], v[60:63], 0
s_waitcnt lgkmcnt(3)
v_accvgpr_read_b32 v103, a91
v_mul_f32 v96, v96, v2
v_mfma_f32_16x16x32_bf16 v[112:115], a[132:135], v[64:67], v[112:115]
v_mul_f32 v97, v97, v3
v_mul_f32 v98, v98, v4
v_mfma_f32_16x16x32_bf16 v[128:131], a[136:139], v[64:67], v[128:131]
v_mul_f32 v99, v99, v5
v_mul_f32 v100, v100, v2
v_mfma_f32_16x16x32_bf16 v[144:147], a[140:143], v[64:67], v[144:147]
v_mul_f32 v101, v101, v3
v_mul_f32 v102, v102, v4
v_mfma_f32_16x16x32_bf16 v[160:163], a[144:147], v[64:67], v[160:163]
v_mul_f32 v103, v103, v5
v_cvt_pk_bf16_f32 v96, v96, v97
v_mfma_f32_16x16x32_bf16 v[176:179], a[148:151], v[64:67], v[176:179]
s_waitcnt lgkmcnt(0)
buffer_load_dword v26, v33, s[16:19], s5 offen sc1
v_mfma_f32_16x16x32_bf16 v[192:195], a[152:155], v[64:67], v[192:195]
v_cvt_pk_bf16_f32 v97, v98, v99
v_cvt_pk_bf16_f32 v98, v100, v101
v_mfma_f32_16x16x32_bf16 v[208:211], a[156:159], v[64:67], v[208:211]
v_cvt_pk_bf16_f32 v99, v102, v103
v_accvgpr_read_b32 v104, a76
v_mfma_f32_16x16x32_bf16 v[224:227], a[160:163], v[64:67], v[224:227]
ds_write2st64_b64 v1, v[96:97], v[98:99] offset1:1
v_accvgpr_read_b32 v105, a77
v_mfma_f32_16x16x32_bf16 v[240:243], a[164:167], v[64:67], v[240:243]
v_accvgpr_read_b32 v106, a78
v_accvgpr_read_b32 v107, a79
v_mfma_f32_16x16x32_bf16 v[116:119], a[132:135], v[68:71], v[116:119]
ds_read_b64_tr_b16 v[88:89], v6 offset:0
v_accvgpr_read_b32 v108, a92
v_mfma_f32_16x16x32_bf16 v[132:135], a[136:139], v[68:71], v[132:135]
ds_read_b64_tr_b16 v[90:91], v6 offset:512
v_accvgpr_read_b32 v109, a93
v_mfma_f32_16x16x32_bf16 v[148:151], a[140:143], v[68:71], v[148:151]
v_accvgpr_read_b32 v110, a94
v_accvgpr_read_b32 v111, a95
v_mfma_f32_16x16x32_bf16 v[164:167], a[144:147], v[68:71], v[164:167]
v_mul_f32 v104, v104, v28
v_mul_f32 v105, v105, v29
v_mfma_f32_16x16x32_bf16 v[180:183], a[148:151], v[68:71], v[180:183]
v_mul_f32 v106, v106, v30
v_mul_f32 v107, v107, v31
v_mfma_f32_16x16x32_bf16 v[196:199], a[152:155], v[68:71], v[196:199]
v_mul_f32 v108, v108, v28
v_mul_f32 v109, v109, v29
v_mfma_f32_16x16x32_bf16 v[212:215], a[156:159], v[68:71], v[212:215]
v_mul_f32 v110, v110, v30
v_mul_f32 v111, v111, v31
v_mfma_f32_16x16x32_bf16 v[228:231], a[160:163], v[68:71], v[228:231]
s_waitcnt vmcnt(13) lgkmcnt(0)
s_barrier
v_cvt_pk_bf16_f32 v104, v104, v105
v_mfma_f32_16x16x32_bf16 v[244:247], a[164:167], v[68:71], v[244:247]
s_waitcnt lgkmcnt(0)
v_cvt_pk_bf16_f32 v105, v106, v107
v_cvt_pk_bf16_f32 v106, v108, v109
v_mfma_f32_16x16x32_bf16 v[120:123], a[132:135], v[72:75], v[120:123]
s_xor_b32 s36, s25, 7
v_cvt_pk_bf16_f32 v107, v110, v111
v_accvgpr_read_b32 v96, a96
v_mfma_f32_16x16x32_bf16 v[136:139], a[136:139], v[72:75], v[136:139]
s_mul_i32 s36, s36, 147456
ds_write2st64_b64 v1, v[104:105], v[106:107] offset1:1
v_accvgpr_read_b32 v97, a97
v_mfma_f32_16x16x32_bf16 v[152:155], a[140:143], v[72:75], v[152:155]
s_add_u32 m0, s24, 65536
v_accvgpr_read_b32 v98, a98
v_accvgpr_read_b32 v99, a99
v_mfma_f32_16x16x32_bf16 v[168:171], a[144:147], v[72:75], v[168:171]
buffer_load_dwordx4 v21, s[44:47], s36 offen offset:0 lds
v_mfma_f32_16x16x32_bf16 v[184:187], a[148:151], v[72:75], v[184:187]
ds_read_b64_tr_b16 v[92:93], v6 offset:0
v_accvgpr_read_b32 v100, a112
v_mfma_f32_16x16x32_bf16 v[200:203], a[152:155], v[72:75], v[200:203]
ds_read_b64_tr_b16 a[168:169], v8 offset:16384
v_accvgpr_read_b32 v101, a113
v_mfma_f32_16x16x32_bf16 v[216:219], a[156:159], v[72:75], v[216:219]
ds_read_b64_tr_b16 a[170:171], v8 offset:20480
ds_read_b64_tr_b16 a[172:173], v9 offset:16384
v_mfma_f32_16x16x32_bf16 v[232:235], a[160:163], v[72:75], v[232:235]
buffer_load_dwordx4 v22, s[44:47], s36 offen offset:1024 lds
v_mfma_f32_16x16x32_bf16 v[248:251], a[164:167], v[72:75], v[248:251]
ds_read_b64_tr_b16 a[174:175], v9 offset:20480
ds_read_b64_tr_b16 a[176:177], v10 offset:16384
v_mfma_f32_16x16x32_bf16 v[124:127], a[132:135], v[76:79], v[124:127]
ds_read_b64_tr_b16 a[178:179], v10 offset:20480
ds_read_b64_tr_b16 a[180:181], v11 offset:16384
v_mfma_f32_16x16x32_bf16 v[140:143], a[136:139], v[76:79], v[140:143]
ds_read_b64_tr_b16 a[182:183], v11 offset:20480
ds_read_b64_tr_b16 a[184:185], v12 offset:16384
v_mfma_f32_16x16x32_bf16 v[156:159], a[140:143], v[76:79], v[156:159]
ds_read_b64_tr_b16 a[186:187], v12 offset:20480
ds_read_b64_tr_b16 a[188:189], v13 offset:16384
ds_read_b64_tr_b16 a[190:191], v13 offset:20480
ds_read_b64_tr_b16 a[192:193], v14 offset:16384
ds_read_b64_tr_b16 a[194:195], v14 offset:20480
ds_read_b64_tr_b16 a[196:197], v15 offset:16384
ds_read_b64_tr_b16 a[198:199], v15 offset:20480
ds_read_b64_tr_b16 a[200:201], v20 offset:2048
ds_read_b64_tr_b16 a[202:203], v20 offset:2560
ds_read_b64_tr_b16 v[94:95], v6 offset:512
v_accvgpr_read_b32 v102, a114
v_mfma_f32_16x16x32_bf16 v[172:175], a[144:147], v[76:79], v[172:175]
buffer_load_dwordx4 v23, s[44:47], s36 offen offset:2048 lds
v_accvgpr_read_b32 v103, a115
v_mul_f32 v96, v96, v16
v_mfma_f32_16x16x32_bf16 v[188:191], a[148:151], v[76:79], v[188:191]
v_mul_f32 v97, v97, v17
v_mul_f32 v98, v98, v18
v_mfma_f32_16x16x32_bf16 v[204:207], a[152:155], v[76:79], v[204:207]
v_mul_f32 v99, v99, v19
v_mul_f32 v100, v100, v16
v_mfma_f32_16x16x32_bf16 v[220:223], a[156:159], v[76:79], v[220:223]
v_mul_f32 v101, v101, v17
v_mul_f32 v102, v102, v18
v_mfma_f32_16x16x32_bf16 v[236:239], a[160:163], v[76:79], v[236:239]
v_mul_f32 v103, v103, v19
v_cvt_pk_bf16_f32 v96, v96, v97
v_mfma_f32_16x16x32_bf16 v[252:255], a[164:167], v[76:79], v[252:255]
s_waitcnt lgkmcnt(1)
buffer_load_dwordx4 v24, s[44:47], s36 offen offset:3072 lds
v_mfma_f32_16x16x32_bf16 v[112:115], a[168:171], v[80:83], v[112:115]
s_waitcnt vmcnt(4)
v_cvt_pk_bf16_f32 v97, v98, v99
v_cvt_pk_bf16_f32 v98, v100, v101
v_mfma_f32_16x16x32_bf16 v[128:131], a[172:175], v[80:83], v[128:131]
s_waitcnt lgkmcnt(0)
v_cvt_pk_bf16_f32 v99, v102, v103
v_accvgpr_read_b32 v104, a100
v_mfma_f32_16x16x32_bf16 v[144:147], a[176:179], v[80:83], v[144:147]
v_cmp_le_u32 vcc, v35, v26
s_cmp_eq_u64 vcc, exec
s_cbranch_scc0 M_sp1
M_sp1_b:
v_mfma_f32_16x16x32_bf16 v[160:163], a[180:183], v[80:83], v[160:163]
s_xor_b32 s37, s25, 4
s_mul_i32 s37, s37, 65536
s_add_u32 s37, s37, s48
buffer_load_dwordx4 a[208:211], v7, s[16:19], s37 offen offset:0 sc1
buffer_load_dwordx4 a[212:215], v7, s[16:19], s37 offen offset:1024 sc1
buffer_load_dwordx4 a[216:219], v7, s[16:19], s37 offen offset:2048 sc1
v_mfma_f32_16x16x32_bf16 v[176:179], a[184:187], v[80:83], v[176:179]
ds_write2st64_b64 v1, v[96:97], v[98:99] offset1:1
buffer_load_dwordx4 a[220:223], v7, s[16:19], s37 offen offset:3072 sc1
v_mfma_f32_16x16x32_bf16 v[192:195], a[188:191], v[80:83], v[192:195]
s_add_u32 s38, s37, 16384
v_accvgpr_read_b32 v105, a101
v_accvgpr_read_b32 v106, a102
v_mfma_f32_16x16x32_bf16 v[208:211], a[192:195], v[80:83], v[208:211]
s_xor_b32 s36, s25, 4
ds_read_b64_tr_b16 v[48:49], v6 offset:0
v_accvgpr_read_b32 v107, a103
v_mfma_f32_16x16x32_bf16 v[224:227], a[196:199], v[80:83], v[224:227]
s_mul_i32 s36, s36, 147456
v_accvgpr_read_b32 v108, a116
v_accvgpr_read_b32 v109, a117
v_mfma_f32_16x16x32_bf16 v[240:243], a[200:203], v[80:83], v[240:243]
s_add_u32 s36, s36, 73728
s_add_u32 m0, s24, 98304
ds_read_b64_tr_b16 v[50:51], v6 offset:512
v_accvgpr_read_b32 v110, a118
v_mfma_f32_16x16x32_bf16 v[116:119], a[168:171], v[84:87], v[116:119]
v_accvgpr_read_b32 v111, a119
v_mul_f32 v104, v104, v36
v_mfma_f32_16x16x32_bf16 v[132:135], a[172:175], v[84:87], v[132:135]
s_add_u32 s40, s53, 32768
buffer_load_dwordx4 a[224:227], v7, s[16:19], s38 offen offset:0 sc1
v_mul_f32 v105, v105, v37
v_mfma_f32_16x16x32_bf16 v[148:151], a[176:179], v[84:87], v[148:151]
v_mul_f32 v106, v106, v38
v_mul_f32 v107, v107, v39
v_mfma_f32_16x16x32_bf16 v[164:167], a[180:183], v[84:87], v[164:167]
v_mul_f32 v108, v108, v36
v_mul_f32 v109, v109, v37
v_mfma_f32_16x16x32_bf16 v[180:183], a[184:187], v[84:87], v[180:183]
buffer_load_dwordx4 a[228:231], v7, s[16:19], s38 offen offset:1024 sc1
v_mfma_f32_16x16x32_bf16 v[196:199], a[188:191], v[84:87], v[196:199]
s_waitcnt lgkmcnt(0)
v_mul_f32 v110, v110, v38
v_mul_f32 v111, v111, v39
v_mfma_f32_16x16x32_bf16 v[212:215], a[192:195], v[84:87], v[212:215]
v_cvt_pk_bf16_f32 v104, v104, v105
v_cvt_pk_bf16_f32 v105, v106, v107
v_mfma_f32_16x16x32_bf16 v[228:231], a[196:199], v[84:87], v[228:231]
buffer_load_dwordx4 a[232:235], v7, s[16:19], s38 offen offset:2048 sc1
v_cvt_pk_bf16_f32 v106, v108, v109
v_mfma_f32_16x16x32_bf16 v[244:247], a[200:203], v[84:87], v[244:247]
v_cvt_pk_bf16_f32 v107, v110, v111
v_accvgpr_read_b32 v96, a104
v_mfma_f32_16x16x32_bf16 v[120:123], a[168:171], v[88:91], v[120:123]
buffer_store_dwordx4 v[80:83], v7, s[16:19], s40 offen offset:0 sc1
v_mfma_f32_16x16x32_bf16 v[136:139], a[172:175], v[88:91], v[136:139]
buffer_load_dwordx4 a[236:239], v7, s[16:19], s38 offen offset:3072 sc1
v_mfma_f32_16x16x32_bf16 v[152:155], a[176:179], v[88:91], v[152:155]
s_xor_b32 s37, s25, 5
ds_write2st64_b64 v1, v[104:105], v[106:107] offset1:1
v_accvgpr_read_b32 v97, a105
v_mfma_f32_16x16x32_bf16 v[168:171], a[180:183], v[88:91], v[168:171]
s_mul_i32 s37, s37, 65536
ds_read_b64_tr_b16 v[52:53], v6 offset:0
v_accvgpr_read_b32 v98, a106
v_mfma_f32_16x16x32_bf16 v[184:187], a[184:187], v[88:91], v[184:187]
s_add_u32 s37, s37, s48
v_accvgpr_read_b32 v99, a107
v_accvgpr_read_b32 v100, a120
v_mfma_f32_16x16x32_bf16 v[200:203], a[188:191], v[88:91], v[200:203]
ds_read_b64_tr_b16 v[54:55], v6 offset:512
v_accvgpr_read_b32 v101, a121
v_mfma_f32_16x16x32_bf16 v[216:219], a[192:195], v[88:91], v[216:219]
v_accvgpr_read_b32 v102, a122
v_accvgpr_read_b32 v103, a123
v_mfma_f32_16x16x32_bf16 v[232:235], a[196:199], v[88:91], v[232:235]
v_mul_f32 v96, v96, v2
v_mul_f32 v97, v97, v3
v_mfma_f32_16x16x32_bf16 v[248:251], a[200:203], v[88:91], v[248:251]
v_mul_f32 v98, v98, v4
v_mul_f32 v99, v99, v5
v_mfma_f32_16x16x32_bf16 v[124:127], a[168:171], v[92:95], v[124:127]
v_mul_f32 v100, v100, v2
v_mul_f32 v101, v101, v3
v_mfma_f32_16x16x32_bf16 v[140:143], a[172:175], v[92:95], v[140:143]
ds_read_b64_tr_b16 a[204:205], v8 offset:24576
ds_read_b64_tr_b16 a[206:207], v8 offset:28672
v_mfma_f32_16x16x32_bf16 v[156:159], a[176:179], v[92:95], v[156:159]
ds_read_b64_tr_b16 a[128:129], v9 offset:24576
ds_read_b64_tr_b16 a[130:131], v9 offset:28672
ds_read_b64_tr_b16 a[132:133], v10 offset:24576
ds_read_b64_tr_b16 a[134:135], v10 offset:28672
ds_read_b64_tr_b16 a[136:137], v11 offset:24576
ds_read_b64_tr_b16 a[138:139], v11 offset:28672
ds_read_b64_tr_b16 a[140:141], v12 offset:24576
ds_read_b64_tr_b16 a[142:143], v12 offset:28672
ds_read_b64_tr_b16 a[144:145], v13 offset:24576
ds_read_b64_tr_b16 a[146:147], v13 offset:28672
ds_read_b64_tr_b16 a[148:149], v14 offset:24576
ds_read_b64_tr_b16 a[150:151], v14 offset:28672
ds_read_b64_tr_b16 a[152:153], v15 offset:24576
ds_read_b64_tr_b16 a[154:155], v15 offset:28672
ds_read_b64_tr_b16 a[156:157], v20 offset:3072
ds_read_b64_tr_b16 a[158:159], v20 offset:3584
v_mul_f32 v102, v102, v4
v_mfma_f32_16x16x32_bf16 v[172:175], a[180:183], v[92:95], v[172:175]
s_waitcnt lgkmcnt(15)
v_mul_f32 v103, v103, v5
v_cvt_pk_bf16_f32 v96, v96, v97
v_mfma_f32_16x16x32_bf16 v[188:191], a[184:187], v[92:95], v[188:191]
v_cvt_pk_bf16_f32 v97, v98, v99
v_cvt_pk_bf16_f32 v98, v100, v101
v_mfma_f32_16x16x32_bf16 v[204:207], a[188:191], v[92:95], v[204:207]
v_cvt_pk_bf16_f32 v99, v102, v103
v_accvgpr_read_b32 v104, a108
v_mfma_f32_16x16x32_bf16 v[220:223], a[192:195], v[92:95], v[220:223]
ds_write2st64_b64 v1, v[96:97], v[98:99] offset1:1
v_accvgpr_read_b32 v105, a109
v_mfma_f32_16x16x32_bf16 v[236:239], a[196:199], v[92:95], v[236:239]
buffer_load_dwordx4 a[0:3], v7, s[16:19], s37 offen offset:0 sc1
v_mfma_f32_16x16x32_bf16 v[252:255], a[200:203], v[92:95], v[252:255]
s_waitcnt lgkmcnt(1)
v_accvgpr_read_b32 v106, a110
v_accvgpr_read_b32 v107, a111
v_mfma_f32_16x16x32_bf16 v[112:115], a[204:207], v[48:51], v[112:115]
ds_read_b64_tr_b16 v[56:57], v6 offset:0
v_accvgpr_read_b32 v108, a124
v_mfma_f32_16x16x32_bf16 v[128:131], a[128:131], v[48:51], v[128:131]
ds_read_b64_tr_b16 v[58:59], v6 offset:512
v_accvgpr_read_b32 v109, a125
v_mfma_f32_16x16x32_bf16 v[144:147], a[132:135], v[48:51], v[144:147]
v_accvgpr_read_b32 v110, a126
v_accvgpr_read_b32 v111, a127
v_mfma_f32_16x16x32_bf16 v[160:163], a[136:139], v[48:51], v[160:163]
buffer_load_dwordx4 a[4:7], v7, s[16:19], s37 offen offset:1024 sc1
v_mfma_f32_16x16x32_bf16 v[176:179], a[140:143], v[48:51], v[176:179]
v_mul_f32 v104, v104, v28
v_mul_f32 v105, v105, v29
v_mfma_f32_16x16x32_bf16 v[192:195], a[144:147], v[48:51], v[192:195]
v_mul_f32 v106, v106, v30
v_mul_f32 v107, v107, v31
v_mfma_f32_16x16x32_bf16 v[208:211], a[148:151], v[48:51], v[208:211]
v_mul_f32 v108, v108, v28
v_mul_f32 v109, v109, v29
v_mfma_f32_16x16x32_bf16 v[224:227], a[152:155], v[48:51], v[224:227]
s_waitcnt lgkmcnt(0)
buffer_load_dwordx4 a[8:11], v7, s[16:19], s37 offen offset:2048 sc1
v_mfma_f32_16x16x32_bf16 v[240:243], a[156:159], v[48:51], v[240:243]
buffer_store_dwordx4 v[84:87], v7, s[16:19], s40 offen offset:1024 sc1
v_mul_f32 v110, v110, v30
v_mfma_f32_16x16x32_bf16 v[116:119], a[204:207], v[52:55], v[116:119]
v_mul_f32 v111, v111, v31
v_cvt_pk_bf16_f32 v104, v104, v105
v_mfma_f32_16x16x32_bf16 v[132:135], a[128:131], v[52:55], v[132:135]
buffer_load_dwordx4 a[12:15], v7, s[16:19], s37 offen offset:3072 sc1
v_cvt_pk_bf16_f32 v105, v106, v107
v_mfma_f32_16x16x32_bf16 v[148:151], a[132:135], v[52:55], v[148:151]
s_add_u32 s38, s37, 16384
v_cvt_pk_bf16_f32 v106, v108, v109
v_cvt_pk_bf16_f32 v107, v110, v111
v_mfma_f32_16x16x32_bf16 v[164:167], a[136:139], v[52:55], v[164:167]
ds_write2st64_b64 v1, v[104:105], v[106:107] offset1:1
ds_read_b64_tr_b16 v[60:61], v6 offset:0
v_mfma_f32_16x16x32_bf16 v[180:183], a[140:143], v[52:55], v[180:183]
ds_read_b64_tr_b16 v[62:63], v6 offset:512
v_mfma_f32_16x16x32_bf16 v[196:199], a[144:147], v[52:55], v[196:199]
v_mfma_f32_16x16x32_bf16 v[212:215], a[148:151], v[52:55], v[212:215]
v_mfma_f32_16x16x32_bf16 v[228:231], a[152:155], v[52:55], v[228:231]
buffer_load_dwordx4 a[16:19], v7, s[16:19], s38 offen offset:0 sc1
v_mfma_f32_16x16x32_bf16 v[244:247], a[156:159], v[52:55], v[244:247]
v_mfma_f32_16x16x32_bf16 v[120:123], a[204:207], v[56:59], v[120:123]
v_mfma_f32_16x16x32_bf16 v[136:139], a[128:131], v[56:59], v[136:139]
s_waitcnt lgkmcnt(0)
buffer_load_dwordx4 a[20:23], v7, s[16:19], s38 offen offset:1024 sc1
v_mfma_f32_16x16x32_bf16 v[152:155], a[132:135], v[56:59], v[152:155]
v_mfma_f32_16x16x32_bf16 v[168:171], a[136:139], v[56:59], v[168:171]
v_mfma_f32_16x16x32_bf16 v[184:187], a[140:143], v[56:59], v[184:187]
buffer_load_dwordx4 a[24:27], v7, s[16:19], s38 offen offset:2048 sc1
v_mfma_f32_16x16x32_bf16 v[200:203], a[144:147], v[56:59], v[200:203]
s_waitcnt vmcnt(58) lgkmcnt(0)
s_barrier
ds_read_b64_tr_b16 a[176:177], v8 offset:32768
v_mfma_f32_16x16x32_bf16 v[216:219], a[148:151], v[56:59], v[216:219]
ds_read_b64_tr_b16 a[178:179], v8 offset:36864
ds_read_b64_tr_b16 a[180:181], v8 offset:40960
v_mfma_f32_16x16x32_bf16 v[232:235], a[152:155], v[56:59], v[232:235]
buffer_load_dwordx4 a[28:31], v7, s[16:19], s38 offen offset:3072 sc1
v_mfma_f32_16x16x32_bf16 v[248:251], a[156:159], v[56:59], v[248:251]
s_xor_b32 s37, s25, 6
s_mul_i32 s37, s37, 65536
ds_read_b64_tr_b16 a[182:183], v8 offset:45056
v_mfma_f32_16x16x32_bf16 v[124:127], a[204:207], v[60:63], v[124:127]
s_add_u32 s37, s37, s48
v_mfma_f32_16x16x32_bf16 v[140:143], a[128:131], v[60:63], v[140:143]
v_mfma_f32_16x16x32_bf16 v[156:159], a[132:135], v[60:63], v[156:159]
v_mfma_f32_16x16x32_bf16 v[172:175], a[136:139], v[60:63], v[172:175]
v_mfma_f32_16x16x32_bf16 v[188:191], a[140:143], v[60:63], v[188:191]
ds_read_b64_tr_b16 a[184:185], v9 offset:32768
ds_read_b64_tr_b16 a[186:187], v9 offset:36864
v_mfma_f32_16x16x32_bf16 v[204:207], a[144:147], v[60:63], v[204:207]
ds_read_b64_tr_b16 a[188:189], v9 offset:40960
ds_read_b64_tr_b16 a[190:191], v9 offset:45056
v_mfma_f32_16x16x32_bf16 v[220:223], a[148:151], v[60:63], v[220:223]
v_mfma_f32_16x16x32_bf16 v[236:239], a[152:155], v[60:63], v[236:239]
v_mfma_f32_16x16x32_bf16 v[252:255], a[156:159], v[60:63], v[252:255]
s_waitcnt lgkmcnt(4) vmcnt(9)
buffer_store_dwordx4 v[88:91], v7, s[16:19], s40 offen offset:2048 sc1
v_mfma_f32_16x16x32_bf16 v[112:115], a[176:179], a[208:211], v[112:115]
v_mfma_f32_16x16x32_bf16 v[112:115], a[180:183], a[224:227], v[112:115]
v_mfma_f32_16x16x32_bf16 v[116:119], a[180:183], a[228:231], v[116:119]
v_mfma_f32_16x16x32_bf16 v[116:119], a[176:179], a[212:215], v[116:119]
ds_read_b64_tr_b16 a[192:193], v10 offset:32768
ds_read_b64_tr_b16 a[194:195], v10 offset:36864
v_mfma_f32_16x16x32_bf16 v[120:123], a[176:179], a[216:219], v[120:123]
ds_read_b64_tr_b16 a[196:197], v10 offset:40960
ds_read_b64_tr_b16 a[198:199], v10 offset:45056
v_mfma_f32_16x16x32_bf16 v[120:123], a[180:183], a[232:235], v[120:123]
v_mfma_f32_16x16x32_bf16 v[124:127], a[180:183], a[236:239], v[124:127]
v_mfma_f32_16x16x32_bf16 v[124:127], a[176:179], a[220:223], v[124:127]
s_waitcnt lgkmcnt(4)
v_mfma_f32_16x16x32_bf16 v[140:143], a[184:187], a[220:223], v[140:143]
v_mfma_f32_16x16x32_bf16 v[140:143], a[188:191], a[236:239], v[140:143]
v_mfma_f32_16x16x32_bf16 v[136:139], a[188:191], a[232:235], v[136:139]
v_mfma_f32_16x16x32_bf16 v[136:139], a[184:187], a[216:219], v[136:139]
ds_read_b64_tr_b16 a[200:201], v11 offset:32768
ds_read_b64_tr_b16 a[202:203], v11 offset:36864
v_mfma_f32_16x16x32_bf16 v[132:135], a[184:187], a[212:215], v[132:135]
ds_read_b64_tr_b16 a[204:205], v11 offset:40960
ds_read_b64_tr_b16 a[206:207], v11 offset:45056
v_mfma_f32_16x16x32_bf16 v[132:135], a[188:191], a[228:231], v[132:135]
v_mfma_f32_16x16x32_bf16 v[128:131], a[188:191], a[224:227], v[128:131]
buffer_load_dwordx4 a[32:35], v7, s[16:19], s37 offen offset:0 sc1
v_mfma_f32_16x16x32_bf16 v[128:131], a[184:187], a[208:211], v[128:131]
s_waitcnt lgkmcnt(4)
v_mfma_f32_16x16x32_bf16 v[144:147], a[192:195], a[208:211], v[144:147]
v_mfma_f32_16x16x32_bf16 v[144:147], a[196:199], a[224:227], v[144:147]
v_mfma_f32_16x16x32_bf16 v[148:151], a[196:199], a[228:231], v[148:151]
v_mfma_f32_16x16x32_bf16 v[148:151], a[192:195], a[212:215], v[148:151]
buffer_store_dwordx4 v[92:95], v7, s[16:19], s40 offen offset:3072 sc1
v_mfma_f32_16x16x32_bf16 v[152:155], a[192:195], a[216:219], v[152:155]
ds_read_b64_tr_b16 a[176:177], v12 offset:32768
ds_read_b64_tr_b16 a[178:179], v12 offset:36864
v_mfma_f32_16x16x32_bf16 v[152:155], a[196:199], a[232:235], v[152:155]
ds_read_b64_tr_b16 a[180:181], v12 offset:40960
ds_read_b64_tr_b16 a[182:183], v12 offset:45056
v_mfma_f32_16x16x32_bf16 v[156:159], a[196:199], a[236:239], v[156:159]
v_mfma_f32_16x16x32_bf16 v[156:159], a[192:195], a[220:223], v[156:159]
s_waitcnt lgkmcnt(4)
v_mfma_f32_16x16x32_bf16 v[172:175], a[200:203], a[220:223], v[172:175]
v_mfma_f32_16x16x32_bf16 v[172:175], a[204:207], a[236:239], v[172:175]
v_mfma_f32_16x16x32_bf16 v[168:171], a[204:207], a[232:235], v[168:171]
v_mfma_f32_16x16x32_bf16 v[168:171], a[200:203], a[216:219], v[168:171]
ds_read_b64_tr_b16 a[184:185], v13 offset:32768
ds_read_b64_tr_b16 a[186:187], v13 offset:36864
v_mfma_f32_16x16x32_bf16 v[164:167], a[200:203], a[212:215], v[164:167]
ds_read_b64_tr_b16 a[188:189], v13 offset:40960
ds_read_b64_tr_b16 a[190:191], v13 offset:45056
v_mfma_f32_16x16x32_bf16 v[164:167], a[204:207], a[228:231], v[164:167]
buffer_load_dwordx4 a[36:39], v7, s[16:19], s37 offen offset:1024 sc1
v_mfma_f32_16x16x32_bf16 v[160:163], a[204:207], a[224:227], v[160:163]
v_mfma_f32_16x16x32_bf16 v[160:163], a[200:203], a[208:211], v[160:163]
s_waitcnt lgkmcnt(4)
v_mfma_f32_16x16x32_bf16 v[176:179], a[176:179], a[208:211], v[176:179]
v_mfma_f32_16x16x32_bf16 v[176:179], a[180:183], a[224:227], v[176:179]
v_mfma_f32_16x16x32_bf16 v[180:183], a[180:183], a[228:231], v[180:183]
buffer_load_dwordx4 a[40:43], v7, s[16:19], s37 offen offset:2048 sc1
v_mfma_f32_16x16x32_bf16 v[180:183], a[176:179], a[212:215], v[180:183]
ds_read_b64_tr_b16 a[192:193], v14 offset:32768
ds_read_b64_tr_b16 a[194:195], v14 offset:36864
v_mfma_f32_16x16x32_bf16 v[184:187], a[176:179], a[216:219], v[184:187]
ds_read_b64_tr_b16 a[196:197], v14 offset:40960
ds_read_b64_tr_b16 a[198:199], v14 offset:45056
v_mfma_f32_16x16x32_bf16 v[184:187], a[180:183], a[232:235], v[184:187]
v_mfma_f32_16x16x32_bf16 v[188:191], a[180:183], a[236:239], v[188:191]
v_mfma_f32_16x16x32_bf16 v[188:191], a[176:179], a[220:223], v[188:191]
s_waitcnt lgkmcnt(4)
buffer_load_dwordx4 a[44:47], v7, s[16:19], s37 offen offset:3072 sc1
v_mfma_f32_16x16x32_bf16 v[204:207], a[184:187], a[220:223], v[204:207]
s_add_u32 s38, s37, 16384
v_mfma_f32_16x16x32_bf16 v[204:207], a[188:191], a[236:239], v[204:207]
v_mfma_f32_16x16x32_bf16 v[200:203], a[188:191], a[232:235], v[200:203]
v_mfma_f32_16x16x32_bf16 v[200:203], a[184:187], a[216:219], v[200:203]
ds_read_b64_tr_b16 a[200:201], v15 offset:32768
ds_read_b64_tr_b16 a[202:203], v15 offset:36864
v_mfma_f32_16x16x32_bf16 v[196:199], a[184:187], a[212:215], v[196:199]
s_add_u32 s40, s53, 49152
buffer_store_dwordx4 v[48:51], v7, s[16:19], s40 offen offset:0 sc1
v_mfma_f32_16x16x32_bf16 v[196:199], a[188:191], a[228:231], v[196:199]
ds_read_b64_tr_b16 a[204:205], v15 offset:40960
ds_read_b64_tr_b16 a[206:207], v15 offset:45056
v_mfma_f32_16x16x32_bf16 v[192:195], a[188:191], a[224:227], v[192:195]
v_mfma_f32_16x16x32_bf16 v[192:195], a[184:187], a[208:211], v[192:195]
s_waitcnt lgkmcnt(4)
v_mfma_f32_16x16x32_bf16 v[208:211], a[192:195], a[208:211], v[208:211]
v_mfma_f32_16x16x32_bf16 v[208:211], a[196:199], a[224:227], v[208:211]
v_mfma_f32_16x16x32_bf16 v[212:215], a[196:199], a[228:231], v[212:215]
v_mfma_f32_16x16x32_bf16 v[212:215], a[192:195], a[212:215], v[212:215]
ds_read_b64_tr_b16 a[176:177], v20 offset:16384
ds_read_b64_tr_b16 a[178:179], v20 offset:16896
v_mfma_f32_16x16x32_bf16 v[216:219], a[192:195], a[216:219], v[216:219]
buffer_load_dwordx4 a[48:51], v7, s[16:19], s38 offen offset:0 sc1
v_mfma_f32_16x16x32_bf16 v[216:219], a[196:199], a[232:235], v[216:219]
ds_read_b64_tr_b16 a[180:181], v20 offset:17408
ds_read_b64_tr_b16 a[182:183], v20 offset:17920
v_mfma_f32_16x16x32_bf16 v[220:223], a[196:199], a[236:239], v[220:223]
v_mfma_f32_16x16x32_bf16 v[220:223], a[192:195], a[220:223], v[220:223]
s_waitcnt lgkmcnt(4)
buffer_load_dwordx4 a[52:55], v7, s[16:19], s38 offen offset:1024 sc1
v_mfma_f32_16x16x32_bf16 v[236:239], a[200:203], a[220:223], v[236:239]
v_mfma_f32_16x16x32_bf16 v[236:239], a[204:207], a[236:239], v[236:239]
v_mfma_f32_16x16x32_bf16 v[232:235], a[204:207], a[232:235], v[232:235]
buffer_load_dwordx4 a[56:59], v7, s[16:19], s38 offen offset:2048 sc1
v_mfma_f32_16x16x32_bf16 v[232:235], a[200:203], a[216:219], v[232:235]
s_waitcnt vmcnt(63) lgkmcnt(0)
s_barrier
ds_read_b64_tr_b16 a[184:185], v40 offset:16384
v_mfma_f32_16x16x32_bf16 v[228:231], a[200:203], a[212:215], v[228:231]
ds_read_b64_tr_b16 a[186:187], v40 offset:20480
ds_read_b64_tr_b16 a[188:189], v40 offset:24576
v_mfma_f32_16x16x32_bf16 v[228:231], a[204:207], a[228:231], v[228:231]
buffer_load_dwordx4 a[60:63], v7, s[16:19], s38 offen offset:3072 sc1
v_mfma_f32_16x16x32_bf16 v[224:227], a[204:207], a[224:227], v[224:227]
s_xor_b32 s37, s25, 7
s_mul_i32 s37, s37, 65536
ds_read_b64_tr_b16 a[190:191], v40 offset:28672
v_mfma_f32_16x16x32_bf16 v[224:227], a[200:203], a[208:211], v[224:227]
s_waitcnt lgkmcnt(4)
s_add_u32 s37, s37, s48
v_mfma_f32_16x16x32_bf16 v[240:243], a[176:179], a[208:211], v[240:243]
v_mfma_f32_16x16x32_bf16 v[240:243], a[180:183], a[224:227], v[240:243]
v_mfma_f32_16x16x32_bf16 v[244:247], a[180:183], a[228:231], v[244:247]
v_mfma_f32_16x16x32_bf16 v[244:247], a[176:179], a[212:215], v[244:247]
ds_read_b64_tr_b16 a[192:193], v41 offset:16384
ds_read_b64_tr_b16 a[194:195], v41 offset:20480
v_mfma_f32_16x16x32_bf16 v[248:251], a[176:179], a[216:219], v[248:251]
ds_read_b64_tr_b16 a[196:197], v41 offset:24576
ds_read_b64_tr_b16 a[198:199], v41 offset:28672
v_mfma_f32_16x16x32_bf16 v[248:251], a[180:183], a[232:235], v[248:251]
v_mfma_f32_16x16x32_bf16 v[252:255], a[180:183], a[236:239], v[252:255]
v_mfma_f32_16x16x32_bf16 v[252:255], a[176:179], a[220:223], v[252:255]
s_waitcnt lgkmcnt(4) vmcnt(11)
v_mfma_f32_16x16x32_bf16 v[112:115], a[184:187], a[0:3], v[112:115]
v_mfma_f32_16x16x32_bf16 v[112:115], a[188:191], a[16:19], v[112:115]
v_mfma_f32_16x16x32_bf16 v[116:119], a[188:191], a[20:23], v[116:119]
buffer_load_dword v26, v33, s[16:19], s5 offen sc1
v_mfma_f32_16x16x32_bf16 v[116:119], a[184:187], a[4:7], v[116:119]
ds_read_b64_tr_b16 a[200:201], v42 offset:16384
ds_read_b64_tr_b16 a[202:203], v42 offset:20480
v_mfma_f32_16x16x32_bf16 v[120:123], a[184:187], a[8:11], v[120:123]
buffer_store_dwordx4 v[52:55], v7, s[16:19], s40 offen offset:1024 sc1
v_mfma_f32_16x16x32_bf16 v[120:123], a[188:191], a[24:27], v[120:123]
ds_read_b64_tr_b16 a[204:205], v42 offset:24576
ds_read_b64_tr_b16 a[206:207], v42 offset:28672
v_mfma_f32_16x16x32_bf16 v[124:127], a[188:191], a[28:31], v[124:127]
v_mfma_f32_16x16x32_bf16 v[124:127], a[184:187], a[12:15], v[124:127]
s_waitcnt lgkmcnt(4)
v_mfma_f32_16x16x32_bf16 v[140:143], a[192:195], a[12:15], v[140:143]
v_mfma_f32_16x16x32_bf16 v[140:143], a[196:199], a[28:31], v[140:143]
v_mfma_f32_16x16x32_bf16 v[136:139], a[196:199], a[24:27], v[136:139]
v_mfma_f32_16x16x32_bf16 v[136:139], a[192:195], a[8:11], v[136:139]
ds_read_b64_tr_b16 a[176:177], v43 offset:16384
ds_read_b64_tr_b16 a[178:179], v43 offset:20480
v_mfma_f32_16x16x32_bf16 v[132:135], a[192:195], a[4:7], v[132:135]
ds_read_b64_tr_b16 a[180:181], v43 offset:24576
ds_read_b64_tr_b16 a[182:183], v43 offset:28672
v_mfma_f32_16x16x32_bf16 v[132:135], a[196:199], a[20:23], v[132:135]
v_mfma_f32_16x16x32_bf16 v[128:131], a[196:199], a[16:19], v[128:131]
buffer_load_dwordx4 a[64:67], v7, s[16:19], s37 offen offset:0 sc1
v_mfma_f32_16x16x32_bf16 v[128:131], a[192:195], a[0:3], v[128:131]
s_waitcnt lgkmcnt(4)
v_mfma_f32_16x16x32_bf16 v[144:147], a[200:203], a[0:3], v[144:147]
v_mfma_f32_16x16x32_bf16 v[144:147], a[204:207], a[16:19], v[144:147]
v_mfma_f32_16x16x32_bf16 v[148:151], a[204:207], a[20:23], v[148:151]
v_mfma_f32_16x16x32_bf16 v[148:151], a[200:203], a[4:7], v[148:151]
buffer_load_dwordx4 a[68:71], v7, s[16:19], s37 offen offset:1024 sc1
v_mfma_f32_16x16x32_bf16 v[152:155], a[200:203], a[8:11], v[152:155]
ds_read_b64_tr_b16 a[184:185], v44 offset:16384
ds_read_b64_tr_b16 a[186:187], v44 offset:20480
v_mfma_f32_16x16x32_bf16 v[152:155], a[204:207], a[24:27], v[152:155]
ds_read_b64_tr_b16 a[188:189], v44 offset:24576
ds_read_b64_tr_b16 a[190:191], v44 offset:28672
v_mfma_f32_16x16x32_bf16 v[156:159], a[204:207], a[28:31], v[156:159]
v_mfma_f32_16x16x32_bf16 v[156:159], a[200:203], a[12:15], v[156:159]
s_waitcnt lgkmcnt(4)
v_mfma_f32_16x16x32_bf16 v[172:175], a[176:179], a[12:15], v[172:175]
buffer_load_dwordx4 a[72:75], v7, s[16:19], s37 offen offset:2048 sc1
v_mfma_f32_16x16x32_bf16 v[172:175], a[180:183], a[28:31], v[172:175]
v_mfma_f32_16x16x32_bf16 v[168:171], a[180:183], a[24:27], v[168:171]
v_mfma_f32_16x16x32_bf16 v[168:171], a[176:179], a[8:11], v[168:171]
ds_read_b64_tr_b16 a[192:193], v45 offset:16384
ds_read_b64_tr_b16 a[194:195], v45 offset:20480
v_mfma_f32_16x16x32_bf16 v[164:167], a[176:179], a[4:7], v[164:167]
ds_read_b64_tr_b16 a[196:197], v45 offset:24576
ds_read_b64_tr_b16 a[198:199], v45 offset:28672
v_mfma_f32_16x16x32_bf16 v[164:167], a[180:183], a[20:23], v[164:167]
buffer_store_dwordx4 v[56:59], v7, s[16:19], s40 offen offset:2048 sc1
v_mfma_f32_16x16x32_bf16 v[160:163], a[180:183], a[16:19], v[160:163]
v_mfma_f32_16x16x32_bf16 v[160:163], a[176:179], a[0:3], v[160:163]
s_waitcnt lgkmcnt(4)
v_mfma_f32_16x16x32_bf16 v[176:179], a[184:187], a[0:3], v[176:179]
v_mfma_f32_16x16x32_bf16 v[176:179], a[188:191], a[16:19], v[176:179]
v_mfma_f32_16x16x32_bf16 v[180:183], a[188:191], a[20:23], v[180:183]
v_mfma_f32_16x16x32_bf16 v[180:183], a[184:187], a[4:7], v[180:183]
ds_read_b64_tr_b16 a[200:201], v46 offset:16384
ds_read_b64_tr_b16 a[202:203], v46 offset:20480
v_mfma_f32_16x16x32_bf16 v[184:187], a[184:187], a[8:11], v[184:187]
s_waitcnt vmcnt(5)
ds_read_b64_tr_b16 a[204:205], v46 offset:24576
ds_read_b64_tr_b16 a[206:207], v46 offset:28672
v_mfma_f32_16x16x32_bf16 v[184:187], a[188:191], a[24:27], v[184:187]
v_lshrrev_b32 v26, 1, v26
v_cmp_le_u32 vcc, v35, v26
s_cmp_eq_u64 vcc, exec
s_cbranch_scc0 M_sp2
M_sp2_b:
v_mfma_f32_16x16x32_bf16 v[188:191], a[188:191], a[28:31], v[188:191]
v_mfma_f32_16x16x32_bf16 v[188:191], a[184:187], a[12:15], v[188:191]
s_waitcnt lgkmcnt(4)
buffer_load_dwordx4 a[76:79], v7, s[16:19], s37 offen offset:3072 sc1
v_mfma_f32_16x16x32_bf16 v[204:207], a[192:195], a[12:15], v[204:207]
s_add_u32 s38, s37, 16384
v_mfma_f32_16x16x32_bf16 v[204:207], a[196:199], a[28:31], v[204:207]
v_mfma_f32_16x16x32_bf16 v[200:203], a[196:199], a[24:27], v[200:203]
v_mfma_f32_16x16x32_bf16 v[200:203], a[192:195], a[8:11], v[200:203]
ds_read_b64_tr_b16 a[176:177], v47 offset:16384
ds_read_b64_tr_b16 a[178:179], v47 offset:20480
v_mfma_f32_16x16x32_bf16 v[196:199], a[192:195], a[4:7], v[196:199]
buffer_load_dwordx4 a[80:83], v7, s[16:19], s38 offen offset:0 sc1
v_mfma_f32_16x16x32_bf16 v[196:199], a[196:199], a[20:23], v[196:199]
ds_read_b64_tr_b16 a[180:181], v47 offset:24576
ds_read_b64_tr_b16 a[182:183], v47 offset:28672
v_mfma_f32_16x16x32_bf16 v[192:195], a[196:199], a[16:19], v[192:195]
v_mfma_f32_16x16x32_bf16 v[192:195], a[192:195], a[0:3], v[192:195]
s_waitcnt lgkmcnt(4)
v_mfma_f32_16x16x32_bf16 v[208:211], a[200:203], a[0:3], v[208:211]
v_mfma_f32_16x16x32_bf16 v[208:211], a[204:207], a[16:19], v[208:211]
buffer_load_dwordx4 a[84:87], v7, s[16:19], s38 offen offset:1024 sc1
v_mfma_f32_16x16x32_bf16 v[212:215], a[204:207], a[20:23], v[212:215]
v_mfma_f32_16x16x32_bf16 v[212:215], a[200:203], a[4:7], v[212:215]
ds_read_b64_tr_b16 a[184:185], v20 offset:20480
ds_read_b64_tr_b16 a[186:187], v20 offset:20992
v_mfma_f32_16x16x32_bf16 v[216:219], a[200:203], a[8:11], v[216:219]
ds_read_b64_tr_b16 a[188:189], v20 offset:21504
ds_read_b64_tr_b16 a[190:191], v20 offset:22016
v_mfma_f32_16x16x32_bf16 v[216:219], a[204:207], a[24:27], v[216:219]
v_mfma_f32_16x16x32_bf16 v[220:223], a[204:207], a[28:31], v[220:223]
buffer_load_dwordx4 a[88:91], v7, s[16:19], s38 offen offset:2048 sc1
v_mfma_f32_16x16x32_bf16 v[220:223], a[200:203], a[12:15], v[220:223]
s_waitcnt lgkmcnt(4)
v_mfma_f32_16x16x32_bf16 v[236:239], a[176:179], a[12:15], v[236:239]
v_mfma_f32_16x16x32_bf16 v[236:239], a[180:183], a[28:31], v[236:239]
v_mfma_f32_16x16x32_bf16 v[232:235], a[180:183], a[24:27], v[232:235]
v_mfma_f32_16x16x32_bf16 v[232:235], a[176:179], a[8:11], v[232:235]
s_waitcnt vmcnt(52) lgkmcnt(0)
s_barrier
buffer_store_dwordx4 v[60:63], v7, s[16:19], s40 offen offset:3072 sc1
v_mfma_f32_16x16x32_bf16 v[228:231], a[176:179], a[4:7], v[228:231]
ds_read_b64_tr_b16 a[192:193], v8 offset:49152
ds_read_b64_tr_b16 a[194:195], v8 offset:53248
v_mfma_f32_16x16x32_bf16 v[228:231], a[180:183], a[20:23], v[228:231]
buffer_load_dwordx4 a[92:95], v7, s[16:19], s38 offen offset:3072 sc1
v_mfma_f32_16x16x32_bf16 v[224:227], a[180:183], a[16:19], v[224:227]
s_xor_b32 s37, s25, 4
ds_read_b64_tr_b16 a[196:197], v8 offset:57344
ds_read_b64_tr_b16 a[198:199], v8 offset:61440
v_mfma_f32_16x16x32_bf16 v[224:227], a[176:179], a[0:3], v[224:227]
s_waitcnt lgkmcnt(4)
s_mul_i32 s37, s37, 65536
s_add_u32 s37, s37, s48
v_mfma_f32_16x16x32_bf16 v[240:243], a[184:187], a[0:3], v[240:243]
s_add_u32 s37, s37, 32768
v_mfma_f32_16x16x32_bf16 v[240:243], a[188:191], a[16:19], v[240:243]
v_mfma_f32_16x16x32_bf16 v[244:247], a[188:191], a[20:23], v[244:247]
v_mfma_f32_16x16x32_bf16 v[244:247], a[184:187], a[4:7], v[244:247]
ds_read_b64_tr_b16 a[200:201], v9 offset:49152
ds_read_b64_tr_b16 a[202:203], v9 offset:53248
v_mfma_f32_16x16x32_bf16 v[248:251], a[184:187], a[8:11], v[248:251]
ds_read_b64_tr_b16 a[204:205], v9 offset:57344
ds_read_b64_tr_b16 a[206:207], v9 offset:61440
v_mfma_f32_16x16x32_bf16 v[248:251], a[188:191], a[24:27], v[248:251]
v_mfma_f32_16x16x32_bf16 v[252:255], a[188:191], a[28:31], v[252:255]
v_mfma_f32_16x16x32_bf16 v[252:255], a[184:187], a[12:15], v[252:255]
s_waitcnt lgkmcnt(4) vmcnt(12)
v_mfma_f32_16x16x32_bf16 v[112:115], a[192:195], a[32:35], v[112:115]
v_mfma_f32_16x16x32_bf16 v[112:115], a[196:199], a[48:51], v[112:115]
v_mfma_f32_16x16x32_bf16 v[116:119], a[196:199], a[52:55], v[116:119]
buffer_load_dwordx4 a[96:99], v7, s[16:19], s37 offen offset:0 sc1
v_mfma_f32_16x16x32_bf16 v[116:119], a[192:195], a[36:39], v[116:119]
ds_read_b64_tr_b16 a[176:177], v10 offset:49152
ds_read_b64_tr_b16 a[178:179], v10 offset:53248
v_mfma_f32_16x16x32_bf16 v[120:123], a[192:195], a[40:43], v[120:123]
ds_read_b64_tr_b16 a[180:181], v10 offset:57344
ds_read_b64_tr_b16 a[182:183], v10 offset:61440
v_mfma_f32_16x16x32_bf16 v[120:123], a[196:199], a[56:59], v[120:123]
v_mfma_f32_16x16x32_bf16 v[124:127], a[196:199], a[60:63], v[124:127]
v_mfma_f32_16x16x32_bf16 v[124:127], a[192:195], a[44:47], v[124:127]
s_waitcnt lgkmcnt(4)
buffer_load_dwordx4 a[100:103], v7, s[16:19], s37 offen offset:1024 sc1
v_mfma_f32_16x16x32_bf16 v[140:143], a[200:203], a[44:47], v[140:143]
v_mfma_f32_16x16x32_bf16 v[140:143], a[204:207], a[60:63], v[140:143]
v_mfma_f32_16x16x32_bf16 v[136:139], a[204:207], a[56:59], v[136:139]
v_mfma_f32_16x16x32_bf16 v[136:139], a[200:203], a[40:43], v[136:139]
ds_read_b64_tr_b16 a[184:185], v11 offset:49152
ds_read_b64_tr_b16 a[186:187], v11 offset:53248
v_mfma_f32_16x16x32_bf16 v[132:135], a[200:203], a[36:39], v[132:135]
buffer_load_dwordx4 a[104:107], v7, s[16:19], s37 offen offset:2048 sc1
v_mfma_f32_16x16x32_bf16 v[132:135], a[204:207], a[52:55], v[132:135]
ds_read_b64_tr_b16 a[188:189], v11 offset:57344
ds_read_b64_tr_b16 a[190:191], v11 offset:61440
v_mfma_f32_16x16x32_bf16 v[128:131], a[204:207], a[48:51], v[128:131]
v_mfma_f32_16x16x32_bf16 v[128:131], a[200:203], a[32:35], v[128:131]
s_waitcnt lgkmcnt(4)
v_mfma_f32_16x16x32_bf16 v[144:147], a[176:179], a[32:35], v[144:147]
v_mfma_f32_16x16x32_bf16 v[144:147], a[180:183], a[48:51], v[144:147]
buffer_load_dwordx4 a[108:111], v7, s[16:19], s37 offen offset:3072 sc1
v_mfma_f32_16x16x32_bf16 v[148:151], a[180:183], a[52:55], v[148:151]
s_add_u32 s38, s37, 16384
v_mfma_f32_16x16x32_bf16 v[148:151], a[176:179], a[36:39], v[148:151]
ds_read_b64_tr_b16 a[192:193], v12 offset:49152
ds_read_b64_tr_b16 a[194:195], v12 offset:53248
v_mfma_f32_16x16x32_bf16 v[152:155], a[176:179], a[40:43], v[152:155]
ds_read_b64_tr_b16 a[196:197], v12 offset:57344
ds_read_b64_tr_b16 a[198:199], v12 offset:61440
v_mfma_f32_16x16x32_bf16 v[152:155], a[180:183], a[56:59], v[152:155]
v_mfma_f32_16x16x32_bf16 v[156:159], a[180:183], a[60:63], v[156:159]
buffer_load_dwordx4 v21, s[44:47], s36 offen offset:0 lds
v_mfma_f32_16x16x32_bf16 v[156:159], a[176:179], a[44:47], v[156:159]
s_waitcnt lgkmcnt(4)
v_mfma_f32_16x16x32_bf16 v[172:175], a[184:187], a[44:47], v[172:175]
v_mfma_f32_16x16x32_bf16 v[172:175], a[188:191], a[60:63], v[172:175]
v_mfma_f32_16x16x32_bf16 v[168:171], a[188:191], a[56:59], v[168:171]
v_mfma_f32_16x16x32_bf16 v[168:171], a[184:187], a[40:43], v[168:171]
buffer_load_dwordx4 a[112:115], v7, s[16:19], s38 offen offset:0 sc1
v_mfma_f32_16x16x32_bf16 v[164:167], a[184:187], a[36:39], v[164:167]
ds_read_b64_tr_b16 a[200:201], v13 offset:49152
ds_read_b64_tr_b16 a[202:203], v13 offset:53248
v_mfma_f32_16x16x32_bf16 v[164:167], a[188:191], a[52:55], v[164:167]
ds_read_b64_tr_b16 a[204:205], v13 offset:57344
ds_read_b64_tr_b16 a[206:207], v13 offset:61440
v_mfma_f32_16x16x32_bf16 v[160:163], a[188:191], a[48:51], v[160:163]
v_mfma_f32_16x16x32_bf16 v[160:163], a[184:187], a[32:35], v[160:163]
s_waitcnt lgkmcnt(4)
v_mfma_f32_16x16x32_bf16 v[176:179], a[192:195], a[32:35], v[176:179]
buffer_load_dwordx4 v22, s[44:47], s36 offen offset:1024 lds
v_mfma_f32_16x16x32_bf16 v[176:179], a[196:199], a[48:51], v[176:179]
v_mfma_f32_16x16x32_bf16 v[180:183], a[196:199], a[52:55], v[180:183]
v_mfma_f32_16x16x32_bf16 v[180:183], a[192:195], a[36:39], v[180:183]
ds_read_b64_tr_b16 a[176:177], v14 offset:49152
ds_read_b64_tr_b16 a[178:179], v14 offset:53248
v_mfma_f32_16x16x32_bf16 v[184:187], a[192:195], a[40:43], v[184:187]
s_waitcnt vmcnt(8)
ds_read_b64_tr_b16 a[180:181], v14 offset:57344
ds_read_b64_tr_b16 a[182:183], v14 offset:61440
v_mfma_f32_16x16x32_bf16 v[184:187], a[196:199], a[56:59], v[184:187]
buffer_store_dword v34, v32, s[16:19], s4 offen sc1
v_mfma_f32_16x16x32_bf16 v[188:191], a[196:199], a[60:63], v[188:191]
v_mfma_f32_16x16x32_bf16 v[188:191], a[192:195], a[44:47], v[188:191]
s_waitcnt lgkmcnt(4)
buffer_load_dwordx4 a[116:119], v7, s[16:19], s38 offen offset:1024 sc1
v_mfma_f32_16x16x32_bf16 v[204:207], a[200:203], a[44:47], v[204:207]
v_mfma_f32_16x16x32_bf16 v[204:207], a[204:207], a[60:63], v[204:207]
v_mfma_f32_16x16x32_bf16 v[200:203], a[204:207], a[56:59], v[200:203]
v_mfma_f32_16x16x32_bf16 v[200:203], a[200:203], a[40:43], v[200:203]
ds_read_b64_tr_b16 a[184:185], v15 offset:49152
ds_read_b64_tr_b16 a[186:187], v15 offset:53248
v_mfma_f32_16x16x32_bf16 v[196:199], a[200:203], a[36:39], v[196:199]
buffer_load_dwordx4 v23, s[44:47], s36 offen offset:2048 lds
v_mfma_f32_16x16x32_bf16 v[196:199], a[204:207], a[52:55], v[196:199]
ds_read_b64_tr_b16 a[188:189], v15 offset:57344
ds_read_b64_tr_b16 a[190:191], v15 offset:61440
v_mfma_f32_16x16x32_bf16 v[192:195], a[204:207], a[48:51], v[192:195]
v_mfma_f32_16x16x32_bf16 v[192:195], a[200:203], a[32:35], v[192:195]
s_waitcnt lgkmcnt(4)
v_mfma_f32_16x16x32_bf16 v[208:211], a[176:179], a[32:35], v[208:211]
v_mfma_f32_16x16x32_bf16 v[208:211], a[180:183], a[48:51], v[208:211]
buffer_load_dwordx4 a[120:123], v7, s[16:19], s38 offen offset:2048 sc1
v_mfma_f32_16x16x32_bf16 v[212:215], a[180:183], a[52:55], v[212:215]
v_mfma_f32_16x16x32_bf16 v[212:215], a[176:179], a[36:39], v[212:215]
ds_read_b64_tr_b16 a[192:193], v20 offset:24576
ds_read_b64_tr_b16 a[194:195], v20 offset:25088
v_mfma_f32_16x16x32_bf16 v[216:219], a[176:179], a[40:43], v[216:219]
ds_read_b64_tr_b16 a[196:197], v20 offset:25600
ds_read_b64_tr_b16 a[198:199], v20 offset:26112
v_mfma_f32_16x16x32_bf16 v[216:219], a[180:183], a[56:59], v[216:219]
v_mfma_f32_16x16x32_bf16 v[220:223], a[180:183], a[60:63], v[220:223]
buffer_load_dwordx4 v24, s[44:47], s36 offen offset:3072 lds
v_mfma_f32_16x16x32_bf16 v[220:223], a[176:179], a[44:47], v[220:223]
s_waitcnt lgkmcnt(4)
s_xor_b32 s36, s25, 5
s_mul_i32 s36, s36, 147456
v_mfma_f32_16x16x32_bf16 v[236:239], a[184:187], a[44:47], v[236:239]
s_add_u32 s36, s36, 73728
s_add_u32 m0, s24, 114688
v_mfma_f32_16x16x32_bf16 v[236:239], a[188:191], a[60:63], v[236:239]
v_mfma_f32_16x16x32_bf16 v[232:235], a[188:191], a[56:59], v[232:235]
v_mfma_f32_16x16x32_bf16 v[232:235], a[184:187], a[40:43], v[232:235]
s_waitcnt vmcnt(53) lgkmcnt(0)
s_barrier
buffer_load_dwordx4 a[124:127], v7, s[16:19], s38 offen offset:3072 sc1
v_mfma_f32_16x16x32_bf16 v[228:231], a[184:187], a[36:39], v[228:231]
s_xor_b32 s37, s25, 5
ds_read_b64_tr_b16 a[200:201], v40 offset:0
ds_read_b64_tr_b16 a[202:203], v40 offset:4096
v_mfma_f32_16x16x32_bf16 v[228:231], a[188:191], a[52:55], v[228:231]
s_mul_i32 s37, s37, 65536
ds_read_b64_tr_b16 a[204:205], v40 offset:8192
ds_read_b64_tr_b16 a[206:207], v40 offset:12288
v_mfma_f32_16x16x32_bf16 v[224:227], a[188:191], a[48:51], v[224:227]
s_add_u32 s37, s37, s48
s_add_u32 s37, s37, 32768
v_mfma_f32_16x16x32_bf16 v[224:227], a[184:187], a[32:35], v[224:227]
s_waitcnt lgkmcnt(4)
v_mfma_f32_16x16x32_bf16 v[240:243], a[192:195], a[32:35], v[240:243]
buffer_load_dwordx4 a[144:147], v7, s[16:19], s37 offen offset:0 sc1
v_mfma_f32_16x16x32_bf16 v[240:243], a[196:199], a[48:51], v[240:243]
v_mfma_f32_16x16x32_bf16 v[244:247], a[196:199], a[52:55], v[244:247]
v_mfma_f32_16x16x32_bf16 v[244:247], a[192:195], a[36:39], v[244:247]
ds_read_b64_tr_b16 a[176:177], v41 offset:0
ds_read_b64_tr_b16 a[178:179], v41 offset:4096
v_mfma_f32_16x16x32_bf16 v[248:251], a[192:195], a[40:43], v[248:251]
ds_read_b64_tr_b16 a[180:181], v41 offset:8192
ds_read_b64_tr_b16 a[182:183], v41 offset:12288
v_mfma_f32_16x16x32_bf16 v[248:251], a[196:199], a[56:59], v[248:251]
buffer_load_dwordx4 a[148:151], v7, s[16:19], s37 offen offset:1024 sc1
v_mfma_f32_16x16x32_bf16 v[252:255], a[196:199], a[60:63], v[252:255]
v_mfma_f32_16x16x32_bf16 v[252:255], a[192:195], a[44:47], v[252:255]
s_waitcnt lgkmcnt(4) vmcnt(15)
v_mfma_f32_16x16x32_bf16 v[112:115], a[200:203], a[64:67], v[112:115]
v_mfma_f32_16x16x32_bf16 v[112:115], a[204:207], a[80:83], v[112:115]
v_mfma_f32_16x16x32_bf16 v[116:119], a[204:207], a[84:87], v[116:119]
buffer_load_dwordx4 a[152:155], v7, s[16:19], s37 offen offset:2048 sc1
v_mfma_f32_16x16x32_bf16 v[116:119], a[200:203], a[68:71], v[116:119]
ds_read_b64_tr_b16 a[184:185], v42 offset:0
ds_read_b64_tr_b16 a[186:187], v42 offset:4096
v_mfma_f32_16x16x32_bf16 v[120:123], a[200:203], a[72:75], v[120:123]
ds_read_b64_tr_b16 a[188:189], v42 offset:8192
ds_read_b64_tr_b16 a[190:191], v42 offset:12288
v_mfma_f32_16x16x32_bf16 v[120:123], a[204:207], a[88:91], v[120:123]
v_mfma_f32_16x16x32_bf16 v[124:127], a[204:207], a[92:95], v[124:127]
v_mfma_f32_16x16x32_bf16 v[124:127], a[200:203], a[76:79], v[124:127]
s_waitcnt lgkmcnt(4)
buffer_load_dwordx4 a[156:159], v7, s[16:19], s37 offen offset:3072 sc1
v_mfma_f32_16x16x32_bf16 v[140:143], a[176:179], a[76:79], v[140:143]
s_add_u32 s38, s37, 16384
v_mfma_f32_16x16x32_bf16 v[140:143], a[180:183], a[92:95], v[140:143]
v_mfma_f32_16x16x32_bf16 v[136:139], a[180:183], a[88:91], v[136:139]
v_mfma_f32_16x16x32_bf16 v[136:139], a[176:179], a[72:75], v[136:139]
ds_read_b64_tr_b16 a[192:193], v43 offset:0
ds_read_b64_tr_b16 a[194:195], v43 offset:4096
v_mfma_f32_16x16x32_bf16 v[132:135], a[176:179], a[68:71], v[132:135]
buffer_load_dwordx4 v21, s[44:47], s36 offen offset:0 lds
v_mfma_f32_16x16x32_bf16 v[132:135], a[180:183], a[84:87], v[132:135]
ds_read_b64_tr_b16 a[196:197], v43 offset:8192
ds_read_b64_tr_b16 a[198:199], v43 offset:12288
v_mfma_f32_16x16x32_bf16 v[128:131], a[180:183], a[80:83], v[128:131]
v_mfma_f32_16x16x32_bf16 v[128:131], a[176:179], a[64:67], v[128:131]
s_waitcnt lgkmcnt(4)
v_mfma_f32_16x16x32_bf16 v[144:147], a[184:187], a[64:67], v[144:147]
v_mfma_f32_16x16x32_bf16 v[144:147], a[188:191], a[80:83], v[144:147]
buffer_load_dwordx4 a[160:163], v7, s[16:19], s38 offen offset:0 sc1
v_mfma_f32_16x16x32_bf16 v[148:151], a[188:191], a[84:87], v[148:151]
v_mfma_f32_16x16x32_bf16 v[148:151], a[184:187], a[68:71], v[148:151]
ds_read_b64_tr_b16 a[200:201], v44 offset:0
ds_read_b64_tr_b16 a[202:203], v44 offset:4096
v_mfma_f32_16x16x32_bf16 v[152:155], a[184:187], a[72:75], v[152:155]
ds_read_b64_tr_b16 a[204:205], v44 offset:8192
ds_read_b64_tr_b16 a[206:207], v44 offset:12288
v_mfma_f32_16x16x32_bf16 v[152:155], a[188:191], a[88:91], v[152:155]
v_mfma_f32_16x16x32_bf16 v[156:159], a[188:191], a[92:95], v[156:159]
buffer_load_dword v26, v33, s[16:19], s5 offen sc1
v_mfma_f32_16x16x32_bf16 v[156:159], a[184:187], a[76:79], v[156:159]
s_waitcnt lgkmcnt(4)
v_mfma_f32_16x16x32_bf16 v[172:175], a[192:195], a[76:79], v[172:175]
buffer_load_dwordx4 v22, s[44:47], s36 offen offset:1024 lds
v_mfma_f32_16x16x32_bf16 v[172:175], a[196:199], a[92:95], v[172:175]
v_mfma_f32_16x16x32_bf16 v[168:171], a[196:199], a[88:91], v[168:171]
v_mfma_f32_16x16x32_bf16 v[168:171], a[192:195], a[72:75], v[168:171]
ds_read_b64_tr_b16 a[176:177], v45 offset:0
ds_read_b64_tr_b16 a[178:179], v45 offset:4096
v_mfma_f32_16x16x32_bf16 v[164:167], a[192:195], a[68:71], v[164:167]
ds_read_b64_tr_b16 a[180:181], v45 offset:8192
ds_read_b64_tr_b16 a[182:183], v45 offset:12288
v_mfma_f32_16x16x32_bf16 v[164:167], a[196:199], a[84:87], v[164:167]
buffer_load_dwordx4 a[164:167], v7, s[16:19], s38 offen offset:1024 sc1
v_mfma_f32_16x16x32_bf16 v[160:163], a[196:199], a[80:83], v[160:163]
v_mfma_f32_16x16x32_bf16 v[160:163], a[192:195], a[64:67], v[160:163]
s_waitcnt lgkmcnt(4)
v_mfma_f32_16x16x32_bf16 v[176:179], a[200:203], a[64:67], v[176:179]
v_mfma_f32_16x16x32_bf16 v[176:179], a[204:207], a[80:83], v[176:179]
v_mfma_f32_16x16x32_bf16 v[180:183], a[204:207], a[84:87], v[180:183]
buffer_load_dwordx4 v23, s[44:47], s36 offen offset:2048 lds
v_mfma_f32_16x16x32_bf16 v[180:183], a[200:203], a[68:71], v[180:183]
ds_read_b64_tr_b16 a[184:185], v46 offset:0
ds_read_b64_tr_b16 a[186:187], v46 offset:4096
v_mfma_f32_16x16x32_bf16 v[184:187], a[200:203], a[72:75], v[184:187]
ds_read_b64_tr_b16 a[188:189], v46 offset:8192
ds_read_b64_tr_b16 a[190:191], v46 offset:12288
v_mfma_f32_16x16x32_bf16 v[184:187], a[204:207], a[88:91], v[184:187]
v_mfma_f32_16x16x32_bf16 v[188:191], a[204:207], a[92:95], v[188:191]
v_mfma_f32_16x16x32_bf16 v[188:191], a[200:203], a[76:79], v[188:191]
s_waitcnt lgkmcnt(4)
buffer_load_dwordx4 a[168:171], v7, s[16:19], s38 offen offset:2048 sc1
v_mfma_f32_16x16x32_bf16 v[204:207], a[176:179], a[76:79], v[204:207]
v_mfma_f32_16x16x32_bf16 v[204:207], a[180:183], a[92:95], v[204:207]
v_mfma_f32_16x16x32_bf16 v[200:203], a[180:183], a[88:91], v[200:203]
v_mfma_f32_16x16x32_bf16 v[200:203], a[176:179], a[72:75], v[200:203]
ds_read_b64_tr_b16 a[192:193], v47 offset:0
ds_read_b64_tr_b16 a[194:195], v47 offset:4096
v_mfma_f32_16x16x32_bf16 v[196:199], a[176:179], a[68:71], v[196:199]
buffer_load_dwordx4 v24, s[44:47], s36 offen offset:3072 lds
v_mfma_f32_16x16x32_bf16 v[196:199], a[180:183], a[84:87], v[196:199]
s_xor_b32 s36, s25, 6
ds_read_b64_tr_b16 a[196:197], v47 offset:8192
ds_read_b64_tr_b16 a[198:199], v47 offset:12288
v_mfma_f32_16x16x32_bf16 v[192:195], a[180:183], a[80:83], v[192:195]
s_mul_i32 s36, s36, 147456
s_add_u32 s36, s36, 73728
s_add_u32 m0, s24, 0
v_mfma_f32_16x16x32_bf16 v[192:195], a[176:179], a[64:67], v[192:195]
s_waitcnt lgkmcnt(4)
v_mfma_f32_16x16x32_bf16 v[208:211], a[184:187], a[64:67], v[208:211]
v_mfma_f32_16x16x32_bf16 v[208:211], a[188:191], a[80:83], v[208:211]
buffer_load_dwordx4 a[172:175], v7, s[16:19], s38 offen offset:3072 sc1
v_mfma_f32_16x16x32_bf16 v[212:215], a[188:191], a[84:87], v[212:215]
s_xor_b32 s37, s25, 6
s_mul_i32 s37, s37, 65536
s_add_u32 s37, s37, s48
v_mfma_f32_16x16x32_bf16 v[212:215], a[184:187], a[68:71], v[212:215]
s_add_u32 s37, s37, 32768
ds_read_b64_tr_b16 a[200:201], v20 offset:28672
ds_read_b64_tr_b16 a[202:203], v20 offset:29184
v_mfma_f32_16x16x32_bf16 v[216:219], a[184:187], a[72:75], v[216:219]
ds_read_b64_tr_b16 a[204:205], v20 offset:29696
ds_read_b64_tr_b16 a[206:207], v20 offset:30208
v_mfma_f32_16x16x32_bf16 v[216:219], a[188:191], a[88:91], v[216:219]
v_mfma_f32_16x16x32_bf16 v[220:223], a[188:191], a[92:95], v[220:223]
buffer_load_dwordx4 a[240:243], v7, s[16:19], s37 offen offset:0 sc1
v_mfma_f32_16x16x32_bf16 v[220:223], a[184:187], a[76:79], v[220:223]
s_waitcnt lgkmcnt(4)
v_mfma_f32_16x16x32_bf16 v[236:239], a[192:195], a[76:79], v[236:239]
v_mfma_f32_16x16x32_bf16 v[236:239], a[196:199], a[92:95], v[236:239]
s_waitcnt vmcnt(7)
v_mfma_f32_16x16x32_bf16 v[232:235], a[196:199], a[88:91], v[232:235]
v_cmp_le_u32 vcc, 2, v26
s_cmp_eq_u64 vcc, exec
s_cbranch_scc0 M_sp3
M_sp3_b:
v_mfma_f32_16x16x32_bf16 v[232:235], a[192:195], a[72:75], v[232:235]
s_waitcnt vmcnt(15) lgkmcnt(0)
s_barrier
buffer_load_dwordx4 a[244:247], v7, s[16:19], s37 offen offset:1024 sc1
v_mfma_f32_16x16x32_bf16 v[228:231], a[192:195], a[68:71], v[228:231]
ds_read_b64_tr_b16 a[176:177], v40 offset:32768
ds_read_b64_tr_b16 a[178:179], v40 offset:36864
v_mfma_f32_16x16x32_bf16 v[228:231], a[196:199], a[84:87], v[228:231]
ds_read_b64_tr_b16 a[180:181], v40 offset:40960
ds_read_b64_tr_b16 a[182:183], v40 offset:45056
v_mfma_f32_16x16x32_bf16 v[224:227], a[196:199], a[80:83], v[224:227]
v_mfma_f32_16x16x32_bf16 v[224:227], a[192:195], a[64:67], v[224:227]
s_waitcnt lgkmcnt(4)
v_mfma_f32_16x16x32_bf16 v[240:243], a[200:203], a[64:67], v[240:243]
buffer_load_dwordx4 a[248:251], v7, s[16:19], s37 offen offset:2048 sc1
v_mfma_f32_16x16x32_bf16 v[240:243], a[204:207], a[80:83], v[240:243]
v_mfma_f32_16x16x32_bf16 v[244:247], a[204:207], a[84:87], v[244:247]
v_mfma_f32_16x16x32_bf16 v[244:247], a[200:203], a[68:71], v[244:247]
ds_read_b64_tr_b16 a[184:185], v41 offset:32768
ds_read_b64_tr_b16 a[186:187], v41 offset:36864
v_mfma_f32_16x16x32_bf16 v[248:251], a[200:203], a[72:75], v[248:251]
ds_read_b64_tr_b16 a[188:189], v41 offset:40960
ds_read_b64_tr_b16 a[190:191], v41 offset:45056
v_mfma_f32_16x16x32_bf16 v[248:251], a[204:207], a[88:91], v[248:251]
buffer_load_dwordx4 a[252:255], v7, s[16:19], s37 offen offset:3072 sc1
v_mfma_f32_16x16x32_bf16 v[252:255], a[204:207], a[92:95], v[252:255]
s_add_u32 s38, s37, 16384
v_mfma_f32_16x16x32_bf16 v[252:255], a[200:203], a[76:79], v[252:255]
s_waitcnt lgkmcnt(4) vmcnt(17)
v_mfma_f32_16x16x32_bf16 v[112:115], a[176:179], a[96:99], v[112:115]
v_mfma_f32_16x16x32_bf16 v[112:115], a[180:183], a[112:115], v[112:115]
v_mfma_f32_16x16x32_bf16 v[116:119], a[180:183], a[116:119], v[116:119]
buffer_load_dwordx4 v21, s[44:47], s36 offen offset:0 lds
v_mfma_f32_16x16x32_bf16 v[116:119], a[176:179], a[100:103], v[116:119]
ds_read_b64_tr_b16 a[192:193], v42 offset:32768
ds_read_b64_tr_b16 a[194:195], v42 offset:36864
v_mfma_f32_16x16x32_bf16 v[120:123], a[176:179], a[104:107], v[120:123]
ds_read_b64_tr_b16 a[196:197], v42 offset:40960
ds_read_b64_tr_b16 a[198:199], v42 offset:45056
v_mfma_f32_16x16x32_bf16 v[120:123], a[180:183], a[120:123], v[120:123]
v_mfma_f32_16x16x32_bf16 v[124:127], a[180:183], a[124:127], v[124:127]
v_mfma_f32_16x16x32_bf16 v[124:127], a[176:179], a[108:111], v[124:127]
s_waitcnt lgkmcnt(4)
buffer_load_dwordx4 a[128:131], v7, s[16:19], s38 offen offset:0 sc1
v_mfma_f32_16x16x32_bf16 v[140:143], a[184:187], a[108:111], v[140:143]
v_mfma_f32_16x16x32_bf16 v[140:143], a[188:191], a[124:127], v[140:143]
v_mfma_f32_16x16x32_bf16 v[136:139], a[188:191], a[120:123], v[136:139]
v_mfma_f32_16x16x32_bf16 v[136:139], a[184:187], a[104:107], v[136:139]
ds_read_b64_tr_b16 a[200:201], v43 offset:32768
ds_read_b64_tr_b16 a[202:203], v43 offset:36864
v_mfma_f32_16x16x32_bf16 v[132:135], a[184:187], a[100:103], v[132:135]
buffer_load_dwordx4 v22, s[44:47], s36 offen offset:1024 lds
v_mfma_f32_16x16x32_bf16 v[132:135], a[188:191], a[116:119], v[132:135]
ds_read_b64_tr_b16 a[204:205], v43 offset:40960
ds_read_b64_tr_b16 a[206:207], v43 offset:45056
v_mfma_f32_16x16x32_bf16 v[128:131], a[188:191], a[112:115], v[128:131]
v_mfma_f32_16x16x32_bf16 v[128:131], a[184:187], a[96:99], v[128:131]
s_waitcnt lgkmcnt(4)
v_mfma_f32_16x16x32_bf16 v[144:147], a[192:195], a[96:99], v[144:147]
v_mfma_f32_16x16x32_bf16 v[144:147], a[196:199], a[112:115], v[144:147]
buffer_load_dwordx4 a[132:135], v7, s[16:19], s38 offen offset:1024 sc1
v_mfma_f32_16x16x32_bf16 v[148:151], a[196:199], a[116:119], v[148:151]
v_mfma_f32_16x16x32_bf16 v[148:151], a[192:195], a[100:103], v[148:151]
ds_read_b64_tr_b16 a[176:177], v44 offset:32768
ds_read_b64_tr_b16 a[178:179], v44 offset:36864
v_mfma_f32_16x16x32_bf16 v[152:155], a[192:195], a[104:107], v[152:155]
ds_read_b64_tr_b16 a[180:181], v44 offset:40960
ds_read_b64_tr_b16 a[182:183], v44 offset:45056
v_mfma_f32_16x16x32_bf16 v[152:155], a[196:199], a[120:123], v[152:155]
v_mfma_f32_16x16x32_bf16 v[156:159], a[196:199], a[124:127], v[156:159]
buffer_load_dwordx4 v23, s[44:47], s36 offen offset:2048 lds
v_mfma_f32_16x16x32_bf16 v[156:159], a[192:195], a[108:111], v[156:159]
s_waitcnt lgkmcnt(4)
v_mfma_f32_16x16x32_bf16 v[172:175], a[200:203], a[108:111], v[172:175]
v_mfma_f32_16x16x32_bf16 v[172:175], a[204:207], a[124:127], v[172:175]
v_mfma_f32_16x16x32_bf16 v[168:171], a[204:207], a[120:123], v[168:171]
v_mfma_f32_16x16x32_bf16 v[168:171], a[200:203], a[104:107], v[168:171]
buffer_load_dwordx4 a[136:139], v7, s[16:19], s38 offen offset:2048 sc1
v_mfma_f32_16x16x32_bf16 v[164:167], a[200:203], a[100:103], v[164:167]
ds_read_b64_tr_b16 a[184:185], v45 offset:32768
ds_read_b64_tr_b16 a[186:187], v45 offset:36864
v_mfma_f32_16x16x32_bf16 v[164:167], a[204:207], a[116:119], v[164:167]
ds_read_b64_tr_b16 a[188:189], v45 offset:40960
ds_read_b64_tr_b16 a[190:191], v45 offset:45056
v_mfma_f32_16x16x32_bf16 v[160:163], a[204:207], a[112:115], v[160:163]
v_mfma_f32_16x16x32_bf16 v[160:163], a[200:203], a[96:99], v[160:163]
s_waitcnt lgkmcnt(4)
v_mfma_f32_16x16x32_bf16 v[176:179], a[176:179], a[96:99], v[176:179]
buffer_load_dwordx4 v24, s[44:47], s36 offen offset:3072 lds
v_mfma_f32_16x16x32_bf16 v[176:179], a[180:183], a[112:115], v[176:179]
s_xor_b32 s36, s25, 7
s_mul_i32 s36, s36, 147456
s_add_u32 s36, s36, 73728
v_mfma_f32_16x16x32_bf16 v[180:183], a[180:183], a[116:119], v[180:183]
s_add_u32 m0, s24, 16384
v_mfma_f32_16x16x32_bf16 v[180:183], a[176:179], a[100:103], v[180:183]
ds_read_b64_tr_b16 a[192:193], v46 offset:32768
ds_read_b64_tr_b16 a[194:195], v46 offset:36864
v_mfma_f32_16x16x32_bf16 v[184:187], a[176:179], a[104:107], v[184:187]
ds_read_b64_tr_b16 a[196:197], v46 offset:40960
ds_read_b64_tr_b16 a[198:199], v46 offset:45056
v_mfma_f32_16x16x32_bf16 v[184:187], a[180:183], a[120:123], v[184:187]
buffer_load_dwordx4 a[140:143], v7, s[16:19], s38 offen offset:3072 sc1
v_mfma_f32_16x16x32_bf16 v[188:191], a[180:183], a[124:127], v[188:191]
s_xor_b32 s37, s25, 7
s_mul_i32 s37, s37, 65536
s_add_u32 s37, s37, s48
v_mfma_f32_16x16x32_bf16 v[188:191], a[176:179], a[108:111], v[188:191]
s_waitcnt lgkmcnt(4)
s_add_u32 s37, s37, 32768
v_mfma_f32_16x16x32_bf16 v[204:207], a[184:187], a[108:111], v[204:207]
v_mfma_f32_16x16x32_bf16 v[204:207], a[188:191], a[124:127], v[204:207]
v_mfma_f32_16x16x32_bf16 v[200:203], a[188:191], a[120:123], v[200:203]
buffer_load_dwordx4 a[208:211], v7, s[16:19], s37 offen offset:0 sc1
v_mfma_f32_16x16x32_bf16 v[200:203], a[184:187], a[104:107], v[200:203]
ds_read_b64_tr_b16 a[200:201], v47 offset:32768
ds_read_b64_tr_b16 a[202:203], v47 offset:36864
v_mfma_f32_16x16x32_bf16 v[196:199], a[184:187], a[100:103], v[196:199]
ds_read_b64_tr_b16 a[204:205], v47 offset:40960
ds_read_b64_tr_b16 a[206:207], v47 offset:45056
v_mfma_f32_16x16x32_bf16 v[196:199], a[188:191], a[116:119], v[196:199]
v_mfma_f32_16x16x32_bf16 v[192:195], a[188:191], a[112:115], v[192:195]
v_mfma_f32_16x16x32_bf16 v[192:195], a[184:187], a[96:99], v[192:195]
s_waitcnt lgkmcnt(4)
buffer_load_dwordx4 a[212:215], v7, s[16:19], s37 offen offset:1024 sc1
v_mfma_f32_16x16x32_bf16 v[208:211], a[192:195], a[96:99], v[208:211]
v_mfma_f32_16x16x32_bf16 v[208:211], a[196:199], a[112:115], v[208:211]
v_mfma_f32_16x16x32_bf16 v[212:215], a[196:199], a[116:119], v[212:215]
v_mfma_f32_16x16x32_bf16 v[212:215], a[192:195], a[100:103], v[212:215]
ds_read_b64_tr_b16 a[176:177], v20 offset:18432
ds_read_b64_tr_b16 a[178:179], v20 offset:18944
v_mfma_f32_16x16x32_bf16 v[216:219], a[192:195], a[104:107], v[216:219]
buffer_load_dwordx4 a[216:219], v7, s[16:19], s37 offen offset:2048 sc1
v_mfma_f32_16x16x32_bf16 v[216:219], a[196:199], a[120:123], v[216:219]
ds_read_b64_tr_b16 a[180:181], v20 offset:19456
ds_read_b64_tr_b16 a[182:183], v20 offset:19968
v_mfma_f32_16x16x32_bf16 v[220:223], a[196:199], a[124:127], v[220:223]
v_mfma_f32_16x16x32_bf16 v[220:223], a[192:195], a[108:111], v[220:223]
s_waitcnt lgkmcnt(4)
v_mfma_f32_16x16x32_bf16 v[236:239], a[200:203], a[108:111], v[236:239]
v_mfma_f32_16x16x32_bf16 v[236:239], a[204:207], a[124:127], v[236:239]
buffer_load_dwordx4 a[220:223], v7, s[16:19], s37 offen offset:3072 sc1
v_mfma_f32_16x16x32_bf16 v[232:235], a[204:207], a[120:123], v[232:235]
s_add_u32 s38, s37, 16384
v_mfma_f32_16x16x32_bf16 v[232:235], a[200:203], a[104:107], v[232:235]
s_waitcnt vmcnt(17) lgkmcnt(0)
s_barrier
ds_read_b64_tr_b16 a[184:185], v40 offset:49152
v_mfma_f32_16x16x32_bf16 v[228:231], a[200:203], a[100:103], v[228:231]
ds_read_b64_tr_b16 a[186:187], v40 offset:53248
ds_read_b64_tr_b16 a[188:189], v40 offset:57344
v_mfma_f32_16x16x32_bf16 v[228:231], a[204:207], a[116:119], v[228:231]
ds_read_b64_tr_b16 a[190:191], v40 offset:61440
v_mfma_f32_16x16x32_bf16 v[224:227], a[204:207], a[112:115], v[224:227]
buffer_load_dwordx4 v21, s[44:47], s36 offen offset:0 lds
v_mfma_f32_16x16x32_bf16 v[224:227], a[200:203], a[96:99], v[224:227]
s_waitcnt lgkmcnt(4)
v_mfma_f32_16x16x32_bf16 v[240:243], a[176:179], a[96:99], v[240:243]
v_mfma_f32_16x16x32_bf16 v[240:243], a[180:183], a[112:115], v[240:243]
v_mfma_f32_16x16x32_bf16 v[244:247], a[180:183], a[116:119], v[244:247]
v_mfma_f32_16x16x32_bf16 v[244:247], a[176:179], a[100:103], v[244:247]
buffer_load_dwordx4 a[224:227], v7, s[16:19], s38 offen offset:0 sc1
v_mfma_f32_16x16x32_bf16 v[248:251], a[176:179], a[104:107], v[248:251]
ds_read_b64_tr_b16 a[192:193], v41 offset:49152
ds_read_b64_tr_b16 a[194:195], v41 offset:53248
v_mfma_f32_16x16x32_bf16 v[248:251], a[180:183], a[120:123], v[248:251]
ds_read_b64_tr_b16 a[196:197], v41 offset:57344
ds_read_b64_tr_b16 a[198:199], v41 offset:61440
v_mfma_f32_16x16x32_bf16 v[252:255], a[180:183], a[124:127], v[252:255]
v_mfma_f32_16x16x32_bf16 v[252:255], a[176:179], a[108:111], v[252:255]
s_waitcnt lgkmcnt(4) vmcnt(18)
v_mfma_f32_16x16x32_bf16 v[112:115], a[184:187], a[144:147], v[112:115]
buffer_load_dwordx4 v22, s[44:47], s36 offen offset:1024 lds
v_mfma_f32_16x16x32_bf16 v[112:115], a[188:191], a[160:163], v[112:115]
v_mfma_f32_16x16x32_bf16 v[116:119], a[188:191], a[164:167], v[116:119]
v_mfma_f32_16x16x32_bf16 v[116:119], a[184:187], a[148:151], v[116:119]
ds_read_b64_tr_b16 a[200:201], v42 offset:49152
ds_read_b64_tr_b16 a[202:203], v42 offset:53248
v_mfma_f32_16x16x32_bf16 v[120:123], a[184:187], a[152:155], v[120:123]
ds_read_b64_tr_b16 a[204:205], v42 offset:57344
ds_read_b64_tr_b16 a[206:207], v42 offset:61440
v_mfma_f32_16x16x32_bf16 v[120:123], a[188:191], a[168:171], v[120:123]
buffer_load_dwordx4 a[228:231], v7, s[16:19], s38 offen offset:1024 sc1
v_mfma_f32_16x16x32_bf16 v[124:127], a[188:191], a[172:175], v[124:127]
v_mfma_f32_16x16x32_bf16 v[124:127], a[184:187], a[156:159], v[124:127]
s_waitcnt lgkmcnt(4)
v_mfma_f32_16x16x32_bf16 v[140:143], a[192:195], a[156:159], v[140:143]
v_mfma_f32_16x16x32_bf16 v[140:143], a[196:199], a[172:175], v[140:143]
v_mfma_f32_16x16x32_bf16 v[136:139], a[196:199], a[168:171], v[136:139]
buffer_load_dwordx4 v23, s[44:47], s36 offen offset:2048 lds
v_mfma_f32_16x16x32_bf16 v[136:139], a[192:195], a[152:155], v[136:139]
ds_read_b64_tr_b16 a[176:177], v43 offset:49152
ds_read_b64_tr_b16 a[178:179], v43 offset:53248
v_mfma_f32_16x16x32_bf16 v[132:135], a[192:195], a[148:151], v[132:135]
ds_read_b64_tr_b16 a[180:181], v43 offset:57344
ds_read_b64_tr_b16 a[182:183], v43 offset:61440
v_mfma_f32_16x16x32_bf16 v[132:135], a[196:199], a[164:167], v[132:135]
v_mfma_f32_16x16x32_bf16 v[128:131], a[196:199], a[160:163], v[128:131]
v_mfma_f32_16x16x32_bf16 v[128:131], a[192:195], a[144:147], v[128:131]
s_waitcnt lgkmcnt(4)
buffer_load_dwordx4 a[232:235], v7, s[16:19], s38 offen offset:2048 sc1
v_mfma_f32_16x16x32_bf16 v[144:147], a[200:203], a[144:147], v[144:147]
v_mfma_f32_16x16x32_bf16 v[144:147], a[204:207], a[160:163], v[144:147]
v_mfma_f32_16x16x32_bf16 v[148:151], a[204:207], a[164:167], v[148:151]
v_mfma_f32_16x16x32_bf16 v[148:151], a[200:203], a[148:151], v[148:151]
ds_read_b64_tr_b16 a[184:185], v44 offset:49152
ds_read_b64_tr_b16 a[186:187], v44 offset:53248
v_mfma_f32_16x16x32_bf16 v[152:155], a[200:203], a[152:155], v[152:155]
buffer_load_dwordx4 v24, s[44:47], s36 offen offset:3072 lds
v_mfma_f32_16x16x32_bf16 v[152:155], a[204:207], a[168:171], v[152:155]
s_xor_b32 s36, s25, 1
ds_read_b64_tr_b16 a[188:189], v44 offset:57344
ds_read_b64_tr_b16 a[190:191], v44 offset:61440
v_mfma_f32_16x16x32_bf16 v[156:159], a[204:207], a[172:175], v[156:159]
s_mul_i32 s36, s36, 147456
s_add_u32 m0, s24, 32768
v_mfma_f32_16x16x32_bf16 v[156:159], a[200:203], a[156:159], v[156:159]
s_waitcnt lgkmcnt(4)
v_mfma_f32_16x16x32_bf16 v[172:175], a[176:179], a[156:159], v[172:175]
v_mfma_f32_16x16x32_bf16 v[172:175], a[180:183], a[172:175], v[172:175]
buffer_load_dwordx4 a[236:239], v7, s[16:19], s38 offen offset:3072 sc1
v_mfma_f32_16x16x32_bf16 v[168:171], a[180:183], a[168:171], v[168:171]
s_xor_b32 s37, s25, 1
s_mul_i32 s37, s37, 65536
s_add_u32 s37, s37, s48
v_mfma_f32_16x16x32_bf16 v[168:171], a[176:179], a[152:155], v[168:171]
ds_read_b64_tr_b16 a[192:193], v45 offset:49152
ds_read_b64_tr_b16 a[194:195], v45 offset:53248
v_mfma_f32_16x16x32_bf16 v[164:167], a[176:179], a[148:151], v[164:167]
ds_read_b64_tr_b16 a[196:197], v45 offset:57344
ds_read_b64_tr_b16 a[198:199], v45 offset:61440
v_mfma_f32_16x16x32_bf16 v[164:167], a[180:183], a[164:167], v[164:167]
v_mfma_f32_16x16x32_bf16 v[160:163], a[180:183], a[160:163], v[160:163]
buffer_load_dwordx4 a[0:3], v7, s[16:19], s37 offen offset:0 sc1
v_mfma_f32_16x16x32_bf16 v[160:163], a[176:179], a[144:147], v[160:163]
s_waitcnt lgkmcnt(4)
v_mfma_f32_16x16x32_bf16 v[176:179], a[184:187], a[144:147], v[176:179]
v_mfma_f32_16x16x32_bf16 v[176:179], a[188:191], a[160:163], v[176:179]
v_mfma_f32_16x16x32_bf16 v[180:183], a[188:191], a[164:167], v[180:183]
v_mfma_f32_16x16x32_bf16 v[180:183], a[184:187], a[148:151], v[180:183]
buffer_load_dwordx4 a[4:7], v7, s[16:19], s37 offen offset:1024 sc1
v_mfma_f32_16x16x32_bf16 v[184:187], a[184:187], a[152:155], v[184:187]
ds_read_b64_tr_b16 a[200:201], v46 offset:49152
ds_read_b64_tr_b16 a[202:203], v46 offset:53248
v_mfma_f32_16x16x32_bf16 v[184:187], a[188:191], a[168:171], v[184:187]
ds_read_b64_tr_b16 a[204:205], v46 offset:57344
ds_read_b64_tr_b16 a[206:207], v46 offset:61440
v_mfma_f32_16x16x32_bf16 v[188:191], a[188:191], a[172:175], v[188:191]
v_mfma_f32_16x16x32_bf16 v[188:191], a[184:187], a[156:159], v[188:191]
s_waitcnt lgkmcnt(4)
v_mfma_f32_16x16x32_bf16 v[204:207], a[192:195], a[156:159], v[204:207]
buffer_load_dwordx4 a[8:11], v7, s[16:19], s37 offen offset:2048 sc1
v_mfma_f32_16x16x32_bf16 v[204:207], a[196:199], a[172:175], v[204:207]
v_mfma_f32_16x16x32_bf16 v[200:203], a[196:199], a[168:171], v[200:203]
v_mfma_f32_16x16x32_bf16 v[200:203], a[192:195], a[152:155], v[200:203]
ds_read_b64_tr_b16 a[176:177], v47 offset:49152
ds_read_b64_tr_b16 a[178:179], v47 offset:53248
v_mfma_f32_16x16x32_bf16 v[196:199], a[192:195], a[148:151], v[196:199]
ds_read_b64_tr_b16 a[180:181], v47 offset:57344
ds_read_b64_tr_b16 a[182:183], v47 offset:61440
v_mfma_f32_16x16x32_bf16 v[196:199], a[196:199], a[164:167], v[196:199]
buffer_load_dwordx4 a[12:15], v7, s[16:19], s37 offen offset:3072 sc1
v_mfma_f32_16x16x32_bf16 v[192:195], a[196:199], a[160:163], v[192:195]
s_add_u32 s38, s37, 16384
v_mfma_f32_16x16x32_bf16 v[192:195], a[192:195], a[144:147], v[192:195]
s_waitcnt lgkmcnt(4)
v_mfma_f32_16x16x32_bf16 v[208:211], a[200:203], a[144:147], v[208:211]
v_mfma_f32_16x16x32_bf16 v[208:211], a[204:207], a[160:163], v[208:211]
v_mfma_f32_16x16x32_bf16 v[212:215], a[204:207], a[164:167], v[212:215]
buffer_load_dwordx4 v21, s[44:47], s36 offen offset:0 lds
v_mfma_f32_16x16x32_bf16 v[212:215], a[200:203], a[148:151], v[212:215]
ds_read_b64_tr_b16 a[184:185], v20 offset:22528
ds_read_b64_tr_b16 a[186:187], v20 offset:23040
v_mfma_f32_16x16x32_bf16 v[216:219], a[200:203], a[152:155], v[216:219]
ds_read_b64_tr_b16 a[188:189], v20 offset:23552
ds_read_b64_tr_b16 a[190:191], v20 offset:24064
v_mfma_f32_16x16x32_bf16 v[216:219], a[204:207], a[168:171], v[216:219]
v_mfma_f32_16x16x32_bf16 v[220:223], a[204:207], a[172:175], v[220:223]
v_mfma_f32_16x16x32_bf16 v[220:223], a[200:203], a[156:159], v[220:223]
s_waitcnt lgkmcnt(4)
buffer_load_dwordx4 a[16:19], v7, s[16:19], s38 offen offset:0 sc1
v_mfma_f32_16x16x32_bf16 v[236:239], a[176:179], a[156:159], v[236:239]
v_mfma_f32_16x16x32_bf16 v[236:239], a[180:183], a[172:175], v[236:239]
v_mfma_f32_16x16x32_bf16 v[232:235], a[180:183], a[168:171], v[232:235]
v_mfma_f32_16x16x32_bf16 v[232:235], a[176:179], a[152:155], v[232:235]
s_waitcnt vmcnt(19) lgkmcnt(0)
s_barrier
ds_read_b64_tr_b16 a[192:193], v8 offset:0
v_mfma_f32_16x16x32_bf16 v[228:231], a[176:179], a[148:151], v[228:231]
buffer_load_dwordx4 v22, s[44:47], s36 offen offset:1024 lds
v_mfma_f32_16x16x32_bf16 v[228:231], a[180:183], a[164:167], v[228:231]
ds_read_b64_tr_b16 a[194:195], v8 offset:4096
ds_read_b64_tr_b16 a[196:197], v8 offset:8192
v_mfma_f32_16x16x32_bf16 v[224:227], a[180:183], a[160:163], v[224:227]
ds_read_b64_tr_b16 a[198:199], v8 offset:12288
v_mfma_f32_16x16x32_bf16 v[224:227], a[176:179], a[144:147], v[224:227]
s_waitcnt lgkmcnt(4)
v_mfma_f32_16x16x32_bf16 v[240:243], a[184:187], a[144:147], v[240:243]
v_mfma_f32_16x16x32_bf16 v[240:243], a[188:191], a[160:163], v[240:243]
buffer_load_dwordx4 a[20:23], v7, s[16:19], s38 offen offset:1024 sc1
v_mfma_f32_16x16x32_bf16 v[244:247], a[188:191], a[164:167], v[244:247]
v_mfma_f32_16x16x32_bf16 v[244:247], a[184:187], a[148:151], v[244:247]
ds_read_b64_tr_b16 a[200:201], v9 offset:0
ds_read_b64_tr_b16 a[202:203], v9 offset:4096
v_mfma_f32_16x16x32_bf16 v[248:251], a[184:187], a[152:155], v[248:251]
ds_read_b64_tr_b16 a[204:205], v9 offset:8192
ds_read_b64_tr_b16 a[206:207], v9 offset:12288
v_mfma_f32_16x16x32_bf16 v[248:251], a[188:191], a[168:171], v[248:251]
v_mfma_f32_16x16x32_bf16 v[252:255], a[188:191], a[172:175], v[252:255]
buffer_load_dwordx4 v23, s[44:47], s36 offen offset:2048 lds
v_mfma_f32_16x16x32_bf16 v[252:255], a[184:187], a[156:159], v[252:255]
s_waitcnt lgkmcnt(4) vmcnt(21)
v_mfma_f32_16x16x32_bf16 v[112:115], a[192:195], a[240:243], v[112:115]
v_mfma_f32_16x16x32_bf16 v[112:115], a[196:199], a[128:131], v[112:115]
v_mfma_f32_16x16x32_bf16 v[116:119], a[196:199], a[132:135], v[116:119]
v_mfma_f32_16x16x32_bf16 v[116:119], a[192:195], a[244:247], v[116:119]
buffer_load_dwordx4 a[24:27], v7, s[16:19], s38 offen offset:2048 sc1
v_mfma_f32_16x16x32_bf16 v[120:123], a[192:195], a[248:251], v[120:123]
ds_read_b64_tr_b16 a[176:177], v10 offset:0
ds_read_b64_tr_b16 a[178:179], v10 offset:4096
v_mfma_f32_16x16x32_bf16 v[120:123], a[196:199], a[136:139], v[120:123]
ds_read_b64_tr_b16 a[180:181], v10 offset:8192
ds_read_b64_tr_b16 a[182:183], v10 offset:12288
v_mfma_f32_16x16x32_bf16 v[124:127], a[196:199], a[140:143], v[124:127]
v_mfma_f32_16x16x32_bf16 v[124:127], a[192:195], a[252:255], v[124:127]
s_waitcnt lgkmcnt(4)
v_mfma_f32_16x16x32_bf16 v[140:143], a[200:203], a[252:255], v[140:143]
buffer_load_dwordx4 v24, s[44:47], s36 offen offset:3072 lds
v_mfma_f32_16x16x32_bf16 v[140:143], a[204:207], a[140:143], v[140:143]
s_xor_b32 s36, s25, 1
s_mul_i32 s36, s36, 147456
s_add_u32 s36, s36, 73728
v_mfma_f32_16x16x32_bf16 v[136:139], a[204:207], a[136:139], v[136:139]
s_add_u32 m0, s24, 81920
v_mfma_f32_16x16x32_bf16 v[136:139], a[200:203], a[248:251], v[136:139]
ds_read_b64_tr_b16 a[184:185], v11 offset:0
ds_read_b64_tr_b16 a[186:187], v11 offset:4096
v_mfma_f32_16x16x32_bf16 v[132:135], a[200:203], a[244:247], v[132:135]
ds_read_b64_tr_b16 a[188:189], v11 offset:8192
ds_read_b64_tr_b16 a[190:191], v11 offset:12288
v_mfma_f32_16x16x32_bf16 v[132:135], a[204:207], a[132:135], v[132:135]
buffer_load_dwordx4 a[28:31], v7, s[16:19], s38 offen offset:3072 sc1
v_mfma_f32_16x16x32_bf16 v[128:131], a[204:207], a[128:131], v[128:131]
s_xor_b32 s37, s25, 1
s_mul_i32 s37, s37, 65536
s_add_u32 s37, s37, s48
v_mfma_f32_16x16x32_bf16 v[128:131], a[200:203], a[240:243], v[128:131]
s_waitcnt lgkmcnt(4)
s_add_u32 s37, s37, 32768
v_mfma_f32_16x16x32_bf16 v[144:147], a[176:179], a[240:243], v[144:147]
v_mfma_f32_16x16x32_bf16 v[144:147], a[180:183], a[128:131], v[144:147]
v_mfma_f32_16x16x32_bf16 v[148:151], a[180:183], a[132:135], v[148:151]
buffer_load_dwordx4 a[32:35], v7, s[16:19], s37 offen offset:0 sc1
v_mfma_f32_16x16x32_bf16 v[148:151], a[176:179], a[244:247], v[148:151]
ds_read_b64_tr_b16 a[192:193], v12 offset:0
ds_read_b64_tr_b16 a[194:195], v12 offset:4096
v_mfma_f32_16x16x32_bf16 v[152:155], a[176:179], a[248:251], v[152:155]
ds_read_b64_tr_b16 a[196:197], v12 offset:8192
ds_read_b64_tr_b16 a[198:199], v12 offset:12288
v_mfma_f32_16x16x32_bf16 v[152:155], a[180:183], a[136:139], v[152:155]
v_mfma_f32_16x16x32_bf16 v[156:159], a[180:183], a[140:143], v[156:159]
v_mfma_f32_16x16x32_bf16 v[156:159], a[176:179], a[252:255], v[156:159]
s_waitcnt lgkmcnt(4)
buffer_load_dwordx4 a[36:39], v7, s[16:19], s37 offen offset:1024 sc1
v_mfma_f32_16x16x32_bf16 v[172:175], a[184:187], a[252:255], v[172:175]
v_mfma_f32_16x16x32_bf16 v[172:175], a[188:191], a[140:143], v[172:175]
v_mfma_f32_16x16x32_bf16 v[168:171], a[188:191], a[136:139], v[168:171]
v_mfma_f32_16x16x32_bf16 v[168:171], a[184:187], a[248:251], v[168:171]
ds_read_b64_tr_b16 a[200:201], v13 offset:0
ds_read_b64_tr_b16 a[202:203], v13 offset:4096
v_mfma_f32_16x16x32_bf16 v[164:167], a[184:187], a[244:247], v[164:167]
buffer_load_dwordx4 a[40:43], v7, s[16:19], s37 offen offset:2048 sc1
v_mfma_f32_16x16x32_bf16 v[164:167], a[188:191], a[132:135], v[164:167]
ds_read_b64_tr_b16 a[204:205], v13 offset:8192
ds_read_b64_tr_b16 a[206:207], v13 offset:12288
v_mfma_f32_16x16x32_bf16 v[160:163], a[188:191], a[128:131], v[160:163]
v_mfma_f32_16x16x32_bf16 v[160:163], a[184:187], a[240:243], v[160:163]
s_waitcnt lgkmcnt(4)
v_mfma_f32_16x16x32_bf16 v[176:179], a[192:195], a[240:243], v[176:179]
v_mfma_f32_16x16x32_bf16 v[176:179], a[196:199], a[128:131], v[176:179]
buffer_load_dwordx4 a[44:47], v7, s[16:19], s37 offen offset:3072 sc1
v_mfma_f32_16x16x32_bf16 v[180:183], a[196:199], a[132:135], v[180:183]
s_add_u32 s38, s37, 16384
v_mfma_f32_16x16x32_bf16 v[180:183], a[192:195], a[244:247], v[180:183]
ds_read_b64_tr_b16 a[176:177], v14 offset:0
ds_read_b64_tr_b16 a[178:179], v14 offset:4096
v_mfma_f32_16x16x32_bf16 v[184:187], a[192:195], a[248:251], v[184:187]
ds_read_b64_tr_b16 a[180:181], v14 offset:8192
ds_read_b64_tr_b16 a[182:183], v14 offset:12288
v_mfma_f32_16x16x32_bf16 v[184:187], a[196:199], a[136:139], v[184:187]
v_mfma_f32_16x16x32_bf16 v[188:191], a[196:199], a[140:143], v[188:191]
buffer_load_dwordx4 v21, s[44:47], s36 offen offset:0 lds
v_mfma_f32_16x16x32_bf16 v[188:191], a[192:195], a[252:255], v[188:191]
s_waitcnt lgkmcnt(4)
v_mfma_f32_16x16x32_bf16 v[204:207], a[200:203], a[252:255], v[204:207]
v_mfma_f32_16x16x32_bf16 v[204:207], a[204:207], a[140:143], v[204:207]
v_mfma_f32_16x16x32_bf16 v[200:203], a[204:207], a[136:139], v[200:203]
v_mfma_f32_16x16x32_bf16 v[200:203], a[200:203], a[248:251], v[200:203]
buffer_load_dwordx4 a[48:51], v7, s[16:19], s38 offen offset:0 sc1
v_mfma_f32_16x16x32_bf16 v[196:199], a[200:203], a[244:247], v[196:199]
ds_read_b64_tr_b16 a[184:185], v15 offset:0
ds_read_b64_tr_b16 a[186:187], v15 offset:4096
v_mfma_f32_16x16x32_bf16 v[196:199], a[204:207], a[132:135], v[196:199]
ds_read_b64_tr_b16 a[188:189], v15 offset:8192
ds_read_b64_tr_b16 a[190:191], v15 offset:12288
v_mfma_f32_16x16x32_bf16 v[192:195], a[204:207], a[128:131], v[192:195]
v_mfma_f32_16x16x32_bf16 v[192:195], a[200:203], a[240:243], v[192:195]
s_waitcnt lgkmcnt(4)
v_mfma_f32_16x16x32_bf16 v[208:211], a[176:179], a[240:243], v[208:211]
buffer_load_dwordx4 v22, s[44:47], s36 offen offset:1024 lds
v_mfma_f32_16x16x32_bf16 v[208:211], a[180:183], a[128:131], v[208:211]
v_mfma_f32_16x16x32_bf16 v[212:215], a[180:183], a[132:135], v[212:215]
v_mfma_f32_16x16x32_bf16 v[212:215], a[176:179], a[244:247], v[212:215]
ds_read_b64_tr_b16 a[192:193], v20 offset:26624
ds_read_b64_tr_b16 a[194:195], v20 offset:27136
v_mfma_f32_16x16x32_bf16 v[216:219], a[176:179], a[248:251], v[216:219]
ds_read_b64_tr_b16 a[196:197], v20 offset:27648
ds_read_b64_tr_b16 a[198:199], v20 offset:28160
v_mfma_f32_16x16x32_bf16 v[216:219], a[180:183], a[136:139], v[216:219]
buffer_load_dwordx4 a[52:55], v7, s[16:19], s38 offen offset:1024 sc1
v_mfma_f32_16x16x32_bf16 v[220:223], a[180:183], a[140:143], v[220:223]
v_mfma_f32_16x16x32_bf16 v[220:223], a[176:179], a[252:255], v[220:223]
s_waitcnt lgkmcnt(4)
v_mfma_f32_16x16x32_bf16 v[236:239], a[184:187], a[252:255], v[236:239]
v_mfma_f32_16x16x32_bf16 v[236:239], a[188:191], a[140:143], v[236:239]
v_mfma_f32_16x16x32_bf16 v[232:235], a[188:191], a[136:139], v[232:235]
buffer_load_dwordx4 v23, s[44:47], s36 offen offset:2048 lds
v_mfma_f32_16x16x32_bf16 v[232:235], a[184:187], a[248:251], v[232:235]
s_waitcnt vmcnt(22) lgkmcnt(0)
s_barrier
ds_read_b64_tr_b16 a[200:201], v8 offset:16384
v_mfma_f32_16x16x32_bf16 v[228:231], a[184:187], a[244:247], v[228:231]
ds_read_b64_tr_b16 a[202:203], v8 offset:20480
ds_read_b64_tr_b16 a[204:205], v8 offset:24576
v_mfma_f32_16x16x32_bf16 v[228:231], a[188:191], a[132:135], v[228:231]
ds_read_b64_tr_b16 a[206:207], v8 offset:28672
v_mfma_f32_16x16x32_bf16 v[224:227], a[188:191], a[128:131], v[224:227]
v_mfma_f32_16x16x32_bf16 v[224:227], a[184:187], a[240:243], v[224:227]
s_waitcnt lgkmcnt(4)
buffer_load_dwordx4 a[56:59], v7, s[16:19], s38 offen offset:2048 sc1
v_mfma_f32_16x16x32_bf16 v[240:243], a[192:195], a[240:243], v[240:243]
v_mfma_f32_16x16x32_bf16 v[240:243], a[196:199], a[128:131], v[240:243]
v_mfma_f32_16x16x32_bf16 v[244:247], a[196:199], a[132:135], v[244:247]
v_mfma_f32_16x16x32_bf16 v[244:247], a[192:195], a[244:247], v[244:247]
ds_read_b64_tr_b16 a[176:177], v9 offset:16384
ds_read_b64_tr_b16 a[178:179], v9 offset:20480
v_mfma_f32_16x16x32_bf16 v[248:251], a[192:195], a[248:251], v[248:251]
buffer_load_dwordx4 v24, s[44:47], s36 offen offset:3072 lds
v_mfma_f32_16x16x32_bf16 v[248:251], a[196:199], a[136:139], v[248:251]
s_xor_b32 s36, s25, 2
ds_read_b64_tr_b16 a[180:181], v9 offset:24576
ds_read_b64_tr_b16 a[182:183], v9 offset:28672
v_mfma_f32_16x16x32_bf16 v[252:255], a[196:199], a[140:143], v[252:255]
s_mul_i32 s36, s36, 147456
s_add_u32 m0, s24, 49152
v_mfma_f32_16x16x32_bf16 v[252:255], a[192:195], a[252:255], v[252:255]
s_waitcnt lgkmcnt(4) vmcnt(23)
v_mfma_f32_16x16x32_bf16 v[112:115], a[200:203], a[208:211], v[112:115]
v_mfma_f32_16x16x32_bf16 v[112:115], a[204:207], a[224:227], v[112:115]
buffer_load_dwordx4 a[60:63], v7, s[16:19], s38 offen offset:3072 sc1
v_mfma_f32_16x16x32_bf16 v[116:119], a[204:207], a[228:231], v[116:119]
s_xor_b32 s37, s25, 2
s_mul_i32 s37, s37, 65536
s_add_u32 s37, s37, s48
v_mfma_f32_16x16x32_bf16 v[116:119], a[200:203], a[212:215], v[116:119]
ds_read_b64_tr_b16 a[184:185], v10 offset:16384
ds_read_b64_tr_b16 a[186:187], v10 offset:20480
v_mfma_f32_16x16x32_bf16 v[120:123], a[200:203], a[216:219], v[120:123]
ds_read_b64_tr_b16 a[188:189], v10 offset:24576
ds_read_b64_tr_b16 a[190:191], v10 offset:28672
v_mfma_f32_16x16x32_bf16 v[120:123], a[204:207], a[232:235], v[120:123]
v_mfma_f32_16x16x32_bf16 v[124:127], a[204:207], a[236:239], v[124:127]
buffer_load_dwordx4 a[64:67], v7, s[16:19], s37 offen offset:0 sc1
v_mfma_f32_16x16x32_bf16 v[124:127], a[200:203], a[220:223], v[124:127]
s_waitcnt lgkmcnt(4)
v_mfma_f32_16x16x32_bf16 v[140:143], a[176:179], a[220:223], v[140:143]
v_mfma_f32_16x16x32_bf16 v[140:143], a[180:183], a[236:239], v[140:143]
v_mfma_f32_16x16x32_bf16 v[136:139], a[180:183], a[232:235], v[136:139]
v_mfma_f32_16x16x32_bf16 v[136:139], a[176:179], a[216:219], v[136:139]
buffer_load_dwordx4 a[68:71], v7, s[16:19], s37 offen offset:1024 sc1
v_mfma_f32_16x16x32_bf16 v[132:135], a[176:179], a[212:215], v[132:135]
ds_read_b64_tr_b16 a[192:193], v11 offset:16384
ds_read_b64_tr_b16 a[194:195], v11 offset:20480
v_mfma_f32_16x16x32_bf16 v[132:135], a[180:183], a[228:231], v[132:135]
ds_read_b64_tr_b16 a[196:197], v11 offset:24576
ds_read_b64_tr_b16 a[198:199], v11 offset:28672
v_mfma_f32_16x16x32_bf16 v[128:131], a[180:183], a[224:227], v[128:131]
v_mfma_f32_16x16x32_bf16 v[128:131], a[176:179], a[208:211], v[128:131]
s_waitcnt lgkmcnt(4)
v_mfma_f32_16x16x32_bf16 v[144:147], a[184:187], a[208:211], v[144:147]
buffer_load_dwordx4 a[72:75], v7, s[16:19], s37 offen offset:2048 sc1
v_mfma_f32_16x16x32_bf16 v[144:147], a[188:191], a[224:227], v[144:147]
v_mfma_f32_16x16x32_bf16 v[148:151], a[188:191], a[228:231], v[148:151]
v_mfma_f32_16x16x32_bf16 v[148:151], a[184:187], a[212:215], v[148:151]
ds_read_b64_tr_b16 a[200:201], v12 offset:16384
ds_read_b64_tr_b16 a[202:203], v12 offset:20480
v_mfma_f32_16x16x32_bf16 v[152:155], a[184:187], a[216:219], v[152:155]
ds_read_b64_tr_b16 a[204:205], v12 offset:24576
ds_read_b64_tr_b16 a[206:207], v12 offset:28672
v_mfma_f32_16x16x32_bf16 v[152:155], a[188:191], a[232:235], v[152:155]
buffer_load_dwordx4 a[76:79], v7, s[16:19], s37 offen offset:3072 sc1
v_mfma_f32_16x16x32_bf16 v[156:159], a[188:191], a[236:239], v[156:159]
s_add_u32 s38, s37, 16384
v_mfma_f32_16x16x32_bf16 v[156:159], a[184:187], a[220:223], v[156:159]
s_waitcnt lgkmcnt(4)
v_mfma_f32_16x16x32_bf16 v[172:175], a[192:195], a[220:223], v[172:175]
v_mfma_f32_16x16x32_bf16 v[172:175], a[196:199], a[236:239], v[172:175]
v_mfma_f32_16x16x32_bf16 v[168:171], a[196:199], a[232:235], v[168:171]
buffer_load_dwordx4 a[80:83], v7, s[16:19], s38 offen offset:0 sc1
v_mfma_f32_16x16x32_bf16 v[168:171], a[192:195], a[216:219], v[168:171]
ds_read_b64_tr_b16 a[176:177], v13 offset:16384
ds_read_b64_tr_b16 a[178:179], v13 offset:20480
v_mfma_f32_16x16x32_bf16 v[164:167], a[192:195], a[212:215], v[164:167]
ds_read_b64_tr_b16 a[180:181], v13 offset:24576
ds_read_b64_tr_b16 a[182:183], v13 offset:28672
v_mfma_f32_16x16x32_bf16 v[164:167], a[196:199], a[228:231], v[164:167]
v_mfma_f32_16x16x32_bf16 v[160:163], a[196:199], a[224:227], v[160:163]
v_mfma_f32_16x16x32_bf16 v[160:163], a[192:195], a[208:211], v[160:163]
s_waitcnt lgkmcnt(4)
buffer_load_dwordx4 a[84:87], v7, s[16:19], s38 offen offset:1024 sc1
v_mfma_f32_16x16x32_bf16 v[176:179], a[200:203], a[208:211], v[176:179]
v_mfma_f32_16x16x32_bf16 v[176:179], a[204:207], a[224:227], v[176:179]
v_mfma_f32_16x16x32_bf16 v[180:183], a[204:207], a[228:231], v[180:183]
v_mfma_f32_16x16x32_bf16 v[180:183], a[200:203], a[212:215], v[180:183]
ds_read_b64_tr_b16 a[184:185], v14 offset:16384
ds_read_b64_tr_b16 a[186:187], v14 offset:20480
v_mfma_f32_16x16x32_bf16 v[184:187], a[200:203], a[216:219], v[184:187]
buffer_load_dwordx4 a[88:91], v7, s[16:19], s38 offen offset:2048 sc1
v_mfma_f32_16x16x32_bf16 v[184:187], a[204:207], a[232:235], v[184:187]
ds_read_b64_tr_b16 a[188:189], v14 offset:24576
ds_read_b64_tr_b16 a[190:191], v14 offset:28672
v_mfma_f32_16x16x32_bf16 v[188:191], a[204:207], a[236:239], v[188:191]
v_mfma_f32_16x16x32_bf16 v[188:191], a[200:203], a[220:223], v[188:191]
s_waitcnt lgkmcnt(4)
v_mfma_f32_16x16x32_bf16 v[204:207], a[176:179], a[220:223], v[204:207]
v_mfma_f32_16x16x32_bf16 v[204:207], a[180:183], a[236:239], v[204:207]
buffer_load_dwordx4 a[92:95], v7, s[16:19], s38 offen offset:3072 sc1
v_mfma_f32_16x16x32_bf16 v[200:203], a[180:183], a[232:235], v[200:203]
s_xor_b32 s37, s25, 2
s_mul_i32 s37, s37, 65536
s_add_u32 s37, s37, s48
v_mfma_f32_16x16x32_bf16 v[200:203], a[176:179], a[216:219], v[200:203]
s_add_u32 s37, s37, 32768
ds_read_b64_tr_b16 a[192:193], v15 offset:16384
ds_read_b64_tr_b16 a[194:195], v15 offset:20480
v_mfma_f32_16x16x32_bf16 v[196:199], a[176:179], a[212:215], v[196:199]
ds_read_b64_tr_b16 a[196:197], v15 offset:24576
ds_read_b64_tr_b16 a[198:199], v15 offset:28672
v_mfma_f32_16x16x32_bf16 v[196:199], a[180:183], a[228:231], v[196:199]
v_mfma_f32_16x16x32_bf16 v[192:195], a[180:183], a[224:227], v[192:195]
buffer_load_dwordx4 a[96:99], v7, s[16:19], s37 offen offset:0 sc1
v_mfma_f32_16x16x32_bf16 v[192:195], a[176:179], a[208:211], v[192:195]
s_waitcnt lgkmcnt(4)
v_mfma_f32_16x16x32_bf16 v[208:211], a[184:187], a[208:211], v[208:211]
v_mfma_f32_16x16x32_bf16 v[208:211], a[188:191], a[224:227], v[208:211]
v_mfma_f32_16x16x32_bf16 v[212:215], a[188:191], a[228:231], v[212:215]
v_mfma_f32_16x16x32_bf16 v[212:215], a[184:187], a[212:215], v[212:215]
buffer_load_dwordx4 a[100:103], v7, s[16:19], s37 offen offset:1024 sc1
v_mfma_f32_16x16x32_bf16 v[216:219], a[184:187], a[216:219], v[216:219]
ds_read_b64_tr_b16 a[200:201], v20 offset:30720
ds_read_b64_tr_b16 a[202:203], v20 offset:31232
v_mfma_f32_16x16x32_bf16 v[216:219], a[188:191], a[232:235], v[216:219]
ds_read_b64_tr_b16 a[204:205], v20 offset:31744
ds_read_b64_tr_b16 a[206:207], v20 offset:32256
v_mfma_f32_16x16x32_bf16 v[220:223], a[188:191], a[236:239], v[220:223]
v_mfma_f32_16x16x32_bf16 v[220:223], a[184:187], a[220:223], v[220:223]
s_waitcnt lgkmcnt(4)
v_mfma_f32_16x16x32_bf16 v[236:239], a[192:195], a[220:223], v[236:239]
buffer_load_dwordx4 a[104:107], v7, s[16:19], s37 offen offset:2048 sc1
v_mfma_f32_16x16x32_bf16 v[236:239], a[196:199], a[236:239], v[236:239]
v_mfma_f32_16x16x32_bf16 v[232:235], a[196:199], a[232:235], v[232:235]
v_mfma_f32_16x16x32_bf16 v[232:235], a[192:195], a[216:219], v[232:235]
s_waitcnt vmcnt(24) lgkmcnt(0)
s_barrier
ds_read_b64_tr_b16 a[176:177], v8 offset:32768
v_mfma_f32_16x16x32_bf16 v[228:231], a[192:195], a[212:215], v[228:231]
ds_read_b64_tr_b16 a[178:179], v8 offset:36864
ds_read_b64_tr_b16 a[180:181], v8 offset:40960
v_mfma_f32_16x16x32_bf16 v[228:231], a[196:199], a[228:231], v[228:231]
buffer_load_dwordx4 v21, s[44:47], s36 offen offset:0 lds
v_mfma_f32_16x16x32_bf16 v[224:227], a[196:199], a[224:227], v[224:227]
ds_read_b64_tr_b16 a[182:183], v8 offset:45056
v_mfma_f32_16x16x32_bf16 v[224:227], a[192:195], a[208:211], v[224:227]
s_waitcnt lgkmcnt(4)
v_mfma_f32_16x16x32_bf16 v[240:243], a[200:203], a[208:211], v[240:243]
v_mfma_f32_16x16x32_bf16 v[240:243], a[204:207], a[224:227], v[240:243]
v_mfma_f32_16x16x32_bf16 v[244:247], a[204:207], a[228:231], v[244:247]
buffer_load_dwordx4 a[108:111], v7, s[16:19], s37 offen offset:3072 sc1
v_mfma_f32_16x16x32_bf16 v[244:247], a[200:203], a[212:215], v[244:247]
s_add_u32 s38, s37, 16384
ds_read_b64_tr_b16 a[184:185], v9 offset:32768
ds_read_b64_tr_b16 a[186:187], v9 offset:36864
v_mfma_f32_16x16x32_bf16 v[248:251], a[200:203], a[216:219], v[248:251]
ds_read_b64_tr_b16 a[188:189], v9 offset:40960
ds_read_b64_tr_b16 a[190:191], v9 offset:45056
v_mfma_f32_16x16x32_bf16 v[248:251], a[204:207], a[232:235], v[248:251]
v_mfma_f32_16x16x32_bf16 v[252:255], a[204:207], a[236:239], v[252:255]
v_mfma_f32_16x16x32_bf16 v[252:255], a[200:203], a[220:223], v[252:255]
s_waitcnt lgkmcnt(4) vmcnt(25)
buffer_load_dwordx4 v22, s[44:47], s36 offen offset:1024 lds
v_mfma_f32_16x16x32_bf16 v[112:115], a[176:179], a[0:3], v[112:115]
v_mfma_f32_16x16x32_bf16 v[112:115], a[180:183], a[16:19], v[112:115]
v_mfma_f32_16x16x32_bf16 v[116:119], a[180:183], a[20:23], v[116:119]
v_mfma_f32_16x16x32_bf16 v[116:119], a[176:179], a[4:7], v[116:119]
ds_read_b64_tr_b16 a[192:193], v10 offset:32768
ds_read_b64_tr_b16 a[194:195], v10 offset:36864
v_mfma_f32_16x16x32_bf16 v[120:123], a[176:179], a[8:11], v[120:123]
buffer_load_dwordx4 v23, s[44:47], s36 offen offset:2048 lds
v_mfma_f32_16x16x32_bf16 v[120:123], a[180:183], a[24:27], v[120:123]
ds_read_b64_tr_b16 a[196:197], v10 offset:40960
ds_read_b64_tr_b16 a[198:199], v10 offset:45056
v_mfma_f32_16x16x32_bf16 v[124:127], a[180:183], a[28:31], v[124:127]
v_mfma_f32_16x16x32_bf16 v[124:127], a[176:179], a[12:15], v[124:127]
s_waitcnt lgkmcnt(4)
v_mfma_f32_16x16x32_bf16 v[140:143], a[184:187], a[12:15], v[140:143]
v_mfma_f32_16x16x32_bf16 v[140:143], a[188:191], a[28:31], v[140:143]
buffer_load_dwordx4 a[112:115], v7, s[16:19], s38 offen offset:0 sc1
v_mfma_f32_16x16x32_bf16 v[136:139], a[188:191], a[24:27], v[136:139]
v_mfma_f32_16x16x32_bf16 v[136:139], a[184:187], a[8:11], v[136:139]
ds_read_b64_tr_b16 a[200:201], v11 offset:32768
ds_read_b64_tr_b16 a[202:203], v11 offset:36864
v_mfma_f32_16x16x32_bf16 v[132:135], a[184:187], a[4:7], v[132:135]
ds_read_b64_tr_b16 a[204:205], v11 offset:40960
ds_read_b64_tr_b16 a[206:207], v11 offset:45056
v_mfma_f32_16x16x32_bf16 v[132:135], a[188:191], a[20:23], v[132:135]
v_mfma_f32_16x16x32_bf16 v[128:131], a[188:191], a[16:19], v[128:131]
buffer_load_dwordx4 v24, s[44:47], s36 offen offset:3072 lds
v_mfma_f32_16x16x32_bf16 v[128:131], a[184:187], a[0:3], v[128:131]
s_waitcnt lgkmcnt(4)
s_xor_b32 s36, s25, 3
s_mul_i32 s36, s36, 147456
v_mfma_f32_16x16x32_bf16 v[144:147], a[192:195], a[0:3], v[144:147]
s_add_u32 m0, s39, 143360
s_lshl_b32 s27, s55, 3
v_mfma_f32_16x16x32_bf16 v[144:147], a[196:199], a[16:19], v[144:147]
v_mfma_f32_16x16x32_bf16 v[148:151], a[196:199], a[20:23], v[148:151]
v_mfma_f32_16x16x32_bf16 v[148:151], a[192:195], a[4:7], v[148:151]
s_lshl_b32 s22, s23, 1
buffer_load_dwordx4 a[116:119], v7, s[16:19], s38 offen offset:1024 sc1
v_mfma_f32_16x16x32_bf16 v[152:155], a[192:195], a[8:11], v[152:155]
ds_read_b64_tr_b16 a[176:177], v12 offset:32768
ds_read_b64_tr_b16 a[178:179], v12 offset:36864
v_mfma_f32_16x16x32_bf16 v[152:155], a[196:199], a[24:27], v[152:155]
ds_read_b64_tr_b16 a[180:181], v12 offset:40960
ds_read_b64_tr_b16 a[182:183], v12 offset:45056
v_mfma_f32_16x16x32_bf16 v[156:159], a[196:199], a[28:31], v[156:159]
s_add_u32 s27, s27, s22
v_mfma_f32_16x16x32_bf16 v[156:159], a[192:195], a[12:15], v[156:159]
s_waitcnt lgkmcnt(4)
v_mfma_f32_16x16x32_bf16 v[172:175], a[200:203], a[12:15], v[172:175]
buffer_load_dwordx4 a[120:123], v7, s[16:19], s38 offen offset:2048 sc1
v_mfma_f32_16x16x32_bf16 v[172:175], a[204:207], a[28:31], v[172:175]
v_mfma_f32_16x16x32_bf16 v[168:171], a[204:207], a[24:27], v[168:171]
s_lshl_b32 s27, s27, 3
v_mfma_f32_16x16x32_bf16 v[168:171], a[200:203], a[8:11], v[168:171]
ds_read_b64_tr_b16 a[184:185], v13 offset:32768
ds_read_b64_tr_b16 a[186:187], v13 offset:36864
v_mfma_f32_16x16x32_bf16 v[164:167], a[200:203], a[4:7], v[164:167]
ds_read_b64_tr_b16 a[188:189], v13 offset:40960
ds_read_b64_tr_b16 a[190:191], v13 offset:45056
v_mfma_f32_16x16x32_bf16 v[164:167], a[204:207], a[20:23], v[164:167]
s_add_u32 s27, s27, s51
buffer_load_dwordx4 a[124:127], v7, s[16:19], s38 offen offset:3072 sc1
v_mfma_f32_16x16x32_bf16 v[160:163], a[204:207], a[16:19], v[160:163]
s_xor_b32 s37, s25, 3
s_mul_i32 s37, s37, 65536
s_add_u32 s37, s37, s48
v_mfma_f32_16x16x32_bf16 v[160:163], a[200:203], a[0:3], v[160:163]
s_waitcnt lgkmcnt(4)
v_mfma_f32_16x16x32_bf16 v[176:179], a[176:179], a[0:3], v[176:179]
s_mul_i32 s27, s27, 9216
v_mfma_f32_16x16x32_bf16 v[176:179], a[180:183], a[16:19], v[176:179]
v_mfma_f32_16x16x32_bf16 v[180:183], a[180:183], a[20:23], v[180:183]
buffer_load_dwordx4 v25, s[44:47], s36 offen lds
v_mfma_f32_16x16x32_bf16 v[180:183], a[176:179], a[4:7], v[180:183]
s_xor_b32 s36, s25, 2
ds_read_b64_tr_b16 a[192:193], v14 offset:32768
ds_read_b64_tr_b16 a[194:195], v14 offset:36864
v_mfma_f32_16x16x32_bf16 v[184:187], a[176:179], a[8:11], v[184:187]
s_add_u32 s21, s27, 4194304
ds_read_b64_tr_b16 a[196:197], v14 offset:40960
ds_read_b64_tr_b16 a[198:199], v14 offset:45056
v_mfma_f32_16x16x32_bf16 v[184:187], a[180:183], a[24:27], v[184:187]
s_mul_i32 s36, s36, 147456
s_add_u32 s36, s36, 73728
s_add_u32 m0, s24, 65536
v_mfma_f32_16x16x32_bf16 v[188:191], a[180:183], a[28:31], v[188:191]
v_mfma_f32_16x16x32_bf16 v[188:191], a[176:179], a[12:15], v[188:191]
s_waitcnt lgkmcnt(4)
buffer_load_dwordx4 a[144:147], v7, s[16:19], s37 offen offset:0 sc1
v_mfma_f32_16x16x32_bf16 v[204:207], a[184:187], a[12:15], v[204:207]
s_cmp_eq_u32 s22, s51
s_cselect_b32 s28, s18, s21
s_cselect_b64 s[30:31], -1, 0
v_mfma_f32_16x16x32_bf16 v[204:207], a[188:191], a[28:31], v[204:207]
v_mfma_f32_16x16x32_bf16 v[200:203], a[188:191], a[24:27], v[200:203]
v_mfma_f32_16x16x32_bf16 v[200:203], a[184:187], a[8:11], v[200:203]
s_add_u32 s29, s21, 73728
ds_read_b64_tr_b16 a[200:201], v15 offset:32768
ds_read_b64_tr_b16 a[202:203], v15 offset:36864
v_mfma_f32_16x16x32_bf16 v[196:199], a[184:187], a[4:7], v[196:199]
buffer_load_dwordx4 a[148:151], v7, s[16:19], s37 offen offset:1024 sc1
v_mfma_f32_16x16x32_bf16 v[196:199], a[188:191], a[20:23], v[196:199]
ds_read_b64_tr_b16 a[204:205], v15 offset:40960
ds_read_b64_tr_b16 a[206:207], v15 offset:45056
v_mfma_f32_16x16x32_bf16 v[192:195], a[188:191], a[16:19], v[192:195]
s_add_u32 s27, s22, 1
v_mfma_f32_16x16x32_bf16 v[192:195], a[184:187], a[0:3], v[192:195]
s_waitcnt lgkmcnt(4)
v_mfma_f32_16x16x32_bf16 v[208:211], a[192:195], a[0:3], v[208:211]
v_mfma_f32_16x16x32_bf16 v[208:211], a[196:199], a[16:19], v[208:211]
buffer_load_dwordx4 a[152:155], v7, s[16:19], s37 offen offset:2048 sc1
v_mfma_f32_16x16x32_bf16 v[212:215], a[196:199], a[20:23], v[212:215]
s_cmp_eq_u32 s27, s51
s_cselect_b32 s29, s18, s29
s_cselect_b64 s[32:33], -1, 0
v_mfma_f32_16x16x32_bf16 v[212:215], a[192:195], a[4:7], v[212:215]
ds_read_b64_tr_b16 a[176:177], v20 offset:4096
ds_read_b64_tr_b16 a[178:179], v20 offset:4608
v_mfma_f32_16x16x32_bf16 v[216:219], a[192:195], a[8:11], v[216:219]
ds_read_b64_tr_b16 a[180:181], v20 offset:5120
ds_read_b64_tr_b16 a[182:183], v20 offset:5632
v_mfma_f32_16x16x32_bf16 v[216:219], a[196:199], a[24:27], v[216:219]
s_lshl_b32 s34, 1, s51
v_mfma_f32_16x16x32_bf16 v[220:223], a[196:199], a[28:31], v[220:223]
buffer_load_dwordx4 a[156:159], v7, s[16:19], s37 offen offset:3072 sc1
v_mfma_f32_16x16x32_bf16 v[220:223], a[192:195], a[12:15], v[220:223]
s_waitcnt lgkmcnt(4)
s_add_u32 s38, s37, 16384
v_mfma_f32_16x16x32_bf16 v[236:239], a[200:203], a[12:15], v[236:239]
s_lshl_b32 s27, s55, 2
v_mfma_f32_16x16x32_bf16 v[236:239], a[204:207], a[28:31], v[236:239]
v_mfma_f32_16x16x32_bf16 v[232:235], a[204:207], a[24:27], v[232:235]
v_mfma_f32_16x16x32_bf16 v[232:235], a[200:203], a[8:11], v[232:235]
s_waitcnt vmcnt(26) lgkmcnt(0)
s_barrier
buffer_load_dwordx4 v21, s[44:47], s36 offen offset:0 lds
v_mfma_f32_16x16x32_bf16 v[228:231], a[200:203], a[4:7], v[228:231]
s_lshr_b32 s56, s51, 1
ds_read_b64_tr_b16 a[184:185], v40 offset:16384
ds_read_b64_tr_b16 a[186:187], v40 offset:20480
v_mfma_f32_16x16x32_bf16 v[228:231], a[204:207], a[20:23], v[228:231]
ds_read_b64_tr_b16 a[188:189], v40 offset:24576
ds_read_b64_tr_b16 a[190:191], v40 offset:28672
v_mfma_f32_16x16x32_bf16 v[224:227], a[204:207], a[16:19], v[224:227]
v_mfma_f32_16x16x32_bf16 v[224:227], a[200:203], a[0:3], v[224:227]
s_waitcnt lgkmcnt(4)
s_add_u32 s56, s56, s27
v_mfma_f32_16x16x32_bf16 v[240:243], a[176:179], a[0:3], v[240:243]
buffer_load_dwordx4 v22, s[44:47], s36 offen offset:1024 lds
v_mfma_f32_16x16x32_bf16 v[240:243], a[180:183], a[16:19], v[240:243]
v_mfma_f32_16x16x32_bf16 v[244:247], a[180:183], a[20:23], v[244:247]
s_lshl_b32 s56, s56, 10
v_mfma_f32_16x16x32_bf16 v[244:247], a[176:179], a[4:7], v[244:247]
ds_read_b64_tr_b16 a[192:193], v41 offset:16384
ds_read_b64_tr_b16 a[194:195], v41 offset:20480
v_mfma_f32_16x16x32_bf16 v[248:251], a[176:179], a[8:11], v[248:251]
ds_read_b64_tr_b16 a[196:197], v41 offset:24576
ds_read_b64_tr_b16 a[198:199], v41 offset:28672
v_mfma_f32_16x16x32_bf16 v[248:251], a[180:183], a[24:27], v[248:251]
buffer_load_dwordx4 a[160:163], v7, s[16:19], s38 offen offset:0 sc1
v_mfma_f32_16x16x32_bf16 v[252:255], a[180:183], a[28:31], v[252:255]
s_add_u32 s56, s56, 2752512
v_mfma_f32_16x16x32_bf16 v[252:255], a[176:179], a[12:15], v[252:255]
s_waitcnt lgkmcnt(4) vmcnt(28)
v_mfma_f32_16x16x32_bf16 v[112:115], a[184:187], a[32:35], v[112:115]
v_mfma_f32_16x16x32_bf16 v[112:115], a[188:191], a[48:51], v[112:115]
s_mov_b32 s10, 2359296
v_mfma_f32_16x16x32_bf16 v[116:119], a[188:191], a[52:55], v[116:119]
buffer_load_dwordx4 v23, s[44:47], s36 offen offset:2048 lds
v_mfma_f32_16x16x32_bf16 v[116:119], a[184:187], a[36:39], v[116:119]
ds_read_b64_tr_b16 a[200:201], v42 offset:16384
ds_read_b64_tr_b16 a[202:203], v42 offset:20480
v_mfma_f32_16x16x32_bf16 v[120:123], a[184:187], a[40:43], v[120:123]
ds_read_b64_tr_b16 a[204:205], v42 offset:24576
ds_read_b64_tr_b16 a[206:207], v42 offset:28672
v_mfma_f32_16x16x32_bf16 v[120:123], a[188:191], a[56:59], v[120:123]
s_mov_b32 s14, 2359296
v_mfma_f32_16x16x32_bf16 v[124:127], a[188:191], a[60:63], v[124:127]
v_mfma_f32_16x16x32_bf16 v[124:127], a[184:187], a[44:47], v[124:127]
s_waitcnt lgkmcnt(4)
buffer_load_dwordx4 a[164:167], v7, s[16:19], s38 offen offset:1024 sc1
v_mfma_f32_16x16x32_bf16 v[140:143], a[192:195], a[44:47], v[140:143]
s_mov_b64 s[8:9], s[60:61]
v_mfma_f32_16x16x32_bf16 v[140:143], a[196:199], a[60:63], v[140:143]
v_mfma_f32_16x16x32_bf16 v[136:139], a[196:199], a[56:59], v[136:139]
v_mfma_f32_16x16x32_bf16 v[136:139], a[192:195], a[40:43], v[136:139]
s_mov_b64 s[12:13], s[62:63]
ds_read_b64_tr_b16 a[176:177], v43 offset:16384
ds_read_b64_tr_b16 a[178:179], v43 offset:20480
v_mfma_f32_16x16x32_bf16 v[132:135], a[192:195], a[36:39], v[132:135]
buffer_load_dwordx4 v24, s[44:47], s36 offen offset:3072 lds
v_mfma_f32_16x16x32_bf16 v[132:135], a[196:199], a[52:55], v[132:135]
s_xor_b32 s36, s25, 3
ds_read_b64_tr_b16 a[180:181], v43 offset:24576
ds_read_b64_tr_b16 a[182:183], v43 offset:28672
v_mfma_f32_16x16x32_bf16 v[128:131], a[196:199], a[48:51], v[128:131]
s_mul_i32 s36, s36, 147456
s_add_u32 m0, s24, 98304
v_mfma_f32_16x16x32_bf16 v[128:131], a[192:195], a[32:35], v[128:131]
s_waitcnt lgkmcnt(4)
s_lshl_b32 s27, s26, 3
v_mfma_f32_16x16x32_bf16 v[144:147], a[200:203], a[32:35], v[144:147]
v_mfma_f32_16x16x32_bf16 v[144:147], a[204:207], a[48:51], v[144:147]
buffer_load_dwordx4 a[168:171], v7, s[16:19], s38 offen offset:2048 sc1
v_mfma_f32_16x16x32_bf16 v[148:151], a[204:207], a[52:55], v[148:151]
s_add_u32 s27, s27, s51
v_mfma_f32_16x16x32_bf16 v[148:151], a[200:203], a[36:39], v[148:151]
ds_read_b64_tr_b16 a[184:185], v44 offset:16384
ds_read_b64_tr_b16 a[186:187], v44 offset:20480
v_mfma_f32_16x16x32_bf16 v[152:155], a[200:203], a[40:43], v[152:155]
ds_read_b64_tr_b16 a[188:189], v44 offset:24576
ds_read_b64_tr_b16 a[190:191], v44 offset:28672
v_mfma_f32_16x16x32_bf16 v[152:155], a[204:207], a[56:59], v[152:155]
buffer_load_dwordx4 a[172:175], v7, s[16:19], s38 offen offset:3072 sc1
s_xor_b32 s37, s25, 3
v_mfma_f32_16x16x32_bf16 v[156:159], a[204:207], a[60:63], v[156:159]
s_mul_i32 s37, s37, 65536
s_add_u32 s37, s37, s48
s_add_u32 s37, s37, 32768
v_mfma_f32_16x16x32_bf16 v[156:159], a[200:203], a[44:47], v[156:159]
s_waitcnt lgkmcnt(4)
s_mul_i32 s27, s27, 36864
v_mfma_f32_16x16x32_bf16 v[172:175], a[176:179], a[44:47], v[172:175]
v_mfma_f32_16x16x32_bf16 v[172:175], a[180:183], a[60:63], v[172:175]
s_lshl_b32 s20, s52, 8
v_mfma_f32_16x16x32_bf16 v[168:171], a[180:183], a[56:59], v[168:171]
v_mfma_f32_16x16x32_bf16 v[168:171], a[176:179], a[40:43], v[168:171]
buffer_load_dwordx4 v21, s[44:47], s36 offen offset:0 lds
v_mfma_f32_16x16x32_bf16 v[164:167], a[176:179], a[36:39], v[164:167]
s_add_u32 s20, s20, s27
ds_read_b64_tr_b16 a[192:193], v45 offset:16384
ds_read_b64_tr_b16 a[194:195], v45 offset:20480
v_mfma_f32_16x16x32_bf16 v[164:167], a[180:183], a[52:55], v[164:167]
ds_read_b64_tr_b16 a[196:197], v45 offset:24576
ds_read_b64_tr_b16 a[198:199], v45 offset:28672
v_mfma_f32_16x16x32_bf16 v[160:163], a[180:183], a[48:51], v[160:163]
v_mfma_f32_16x16x32_bf16 v[160:163], a[176:179], a[32:35], v[160:163]
s_waitcnt lgkmcnt(4)
buffer_load_dwordx4 v22, s[44:47], s36 offen offset:1024 lds
v_mfma_f32_16x16x32_bf16 v[176:179], a[184:187], a[32:35], v[176:179]
s_lshl_b32 s41, s23, 5
v_mfma_f32_16x16x32_bf16 v[176:179], a[188:191], a[48:51], v[176:179]
buffer_load_dwordx4 a[208:211], v7, s[16:19], s37 offen offset:0 sc1
v_mfma_f32_16x16x32_bf16 v[180:183], a[188:191], a[52:55], v[180:183]
buffer_load_dwordx4 v23, s[44:47], s36 offen offset:2048 lds
v_mfma_f32_16x16x32_bf16 v[180:183], a[184:187], a[36:39], v[180:183]
s_add_u32 s41, s41, s20
ds_read_b64_tr_b16 a[200:201], v46 offset:16384
ds_read_b64_tr_b16 a[202:203], v46 offset:20480
v_mfma_f32_16x16x32_bf16 v[184:187], a[184:187], a[40:43], v[184:187]
buffer_load_dwordx4 v24, s[44:47], s36 offen offset:3072 lds
s_xor_b32 s36, s25, 3
buffer_load_dwordx4 a[212:215], v7, s[16:19], s37 offen offset:1024 sc1
v_mfma_f32_16x16x32_bf16 v[184:187], a[188:191], a[56:59], v[184:187]
s_mul_i32 s36, s36, 147456
s_add_u32 s36, s36, 73728
s_add_u32 m0, s24, 114688
v_mfma_f32_16x16x32_bf16 v[188:191], a[188:191], a[60:63], v[188:191]
ds_read_b64_tr_b16 a[204:205], v46 offset:24576
ds_read_b64_tr_b16 a[206:207], v46 offset:28672
v_mfma_f32_16x16x32_bf16 v[188:191], a[184:187], a[44:47], v[188:191]
s_waitcnt lgkmcnt(4)
buffer_load_dwordx4 a[216:219], v7, s[16:19], s37 offen offset:2048 sc1
v_mfma_f32_16x16x32_bf16 v[204:207], a[192:195], a[44:47], v[204:207]
s_lshl_b32 s20, s52, 5
v_mfma_f32_16x16x32_bf16 v[204:207], a[196:199], a[60:63], v[204:207]
v_mfma_f32_16x16x32_bf16 v[200:203], a[196:199], a[56:59], v[200:203]
s_add_u32 s20, s20, 1024
buffer_load_dwordx4 a[220:223], v7, s[16:19], s37 offen offset:3072 sc1
v_mfma_f32_16x16x32_bf16 v[200:203], a[192:195], a[40:43], v[200:203]
s_add_u32 s38, s37, 16384
ds_read_b64_tr_b16 a[176:177], v47 offset:16384
ds_read_b64_tr_b16 a[178:179], v47 offset:20480
v_mfma_f32_16x16x32_bf16 v[196:199], a[192:195], a[36:39], v[196:199]
ds_read_b64_tr_b16 a[180:181], v47 offset:24576
ds_read_b64_tr_b16 a[182:183], v47 offset:28672
v_mfma_f32_16x16x32_bf16 v[196:199], a[196:199], a[52:55], v[196:199]
s_add_u32 s43, s20, s27
v_mfma_f32_16x16x32_bf16 v[192:195], a[196:199], a[48:51], v[192:195]
v_mfma_f32_16x16x32_bf16 v[192:195], a[192:195], a[32:35], v[192:195]
s_waitcnt lgkmcnt(4)
v_mfma_f32_16x16x32_bf16 v[208:211], a[200:203], a[32:35], v[208:211]
buffer_load_dwordx4 v21, s[44:47], s36 offen offset:0 lds
buffer_load_dwordx4 a[224:227], v7, s[16:19], s38 offen offset:0 sc1
v_mfma_f32_16x16x32_bf16 v[208:211], a[204:207], a[48:51], v[208:211]
v_and_b32 v2, 15, v0
v_mfma_f32_16x16x32_bf16 v[212:215], a[204:207], a[52:55], v[212:215]
v_mfma_f32_16x16x32_bf16 v[212:215], a[200:203], a[36:39], v[212:215]
buffer_load_dwordx4 v22, s[44:47], s36 offen offset:1024 lds
buffer_load_dwordx4 a[228:231], v7, s[16:19], s38 offen offset:1024 sc1
v_mfma_f32_16x16x32_bf16 v[216:219], a[200:203], a[40:43], v[216:219]
ds_read_b64_tr_b16 a[184:185], v20 offset:6144
ds_read_b64_tr_b16 a[186:187], v20 offset:6656
v_mfma_f32_16x16x32_bf16 v[216:219], a[204:207], a[56:59], v[216:219]
ds_read_b64_tr_b16 a[188:189], v20 offset:7168
ds_read_b64_tr_b16 a[190:191], v20 offset:7680
v_mfma_f32_16x16x32_bf16 v[220:223], a[204:207], a[60:63], v[220:223]
buffer_load_dwordx4 v23, s[44:47], s36 offen offset:2048 lds
buffer_load_dwordx4 a[232:235], v7, s[16:19], s38 offen offset:2048 sc1
v_mfma_f32_16x16x32_bf16 v[220:223], a[200:203], a[44:47], v[220:223]
s_waitcnt lgkmcnt(4)
v_lshrrev_b32 v3, 4, v0
v_mov_b32 v16, 0
v_mfma_f32_16x16x32_bf16 v[236:239], a[176:179], a[44:47], v[236:239]
v_mfma_f32_16x16x32_bf16 v[236:239], a[180:183], a[60:63], v[236:239]
buffer_load_dwordx4 v24, s[44:47], s36 offen offset:3072 lds
buffer_load_dwordx4 a[236:239], v7, s[16:19], s38 offen offset:3072 sc1
v_mfma_f32_16x16x32_bf16 v[232:235], a[180:183], a[56:59], v[232:235]
v_mfma_f32_16x16x32_bf16 v[232:235], a[176:179], a[40:43], v[232:235]
s_waitcnt vmcnt(32) lgkmcnt(0)
s_barrier
ds_read_b64_tr_b16 a[192:193], v8 offset:49152
v_mfma_f32_16x16x32_bf16 v[228:231], a[176:179], a[36:39], v[228:231]
ds_read_b64_tr_b16 a[194:195], v8 offset:53248
ds_read_b64_tr_b16 a[196:197], v8 offset:57344
v_mfma_f32_16x16x32_bf16 v[228:231], a[180:183], a[52:55], v[228:231]
ds_read_b64_tr_b16 a[198:199], v8 offset:61440
v_mov_b32 v17, 0
v_mfma_f32_16x16x32_bf16 v[224:227], a[180:183], a[48:51], v[224:227]
v_bfe_u32 v4, v0, 2, 2
v_mfma_f32_16x16x32_bf16 v[224:227], a[176:179], a[32:35], v[224:227]
s_waitcnt lgkmcnt(4)
v_mfma_f32_16x16x32_bf16 v[240:243], a[184:187], a[32:35], v[240:243]
v_mfma_f32_16x16x32_bf16 v[240:243], a[188:191], a[48:51], v[240:243]
v_mfma_f32_16x16x32_bf16 v[244:247], a[188:191], a[52:55], v[244:247]
v_and_b32 v5, 1, v0
v_mfma_f32_16x16x32_bf16 v[244:247], a[184:187], a[36:39], v[244:247]
ds_read_b64_tr_b16 a[200:201], v9 offset:49152
ds_read_b64_tr_b16 a[202:203], v9 offset:53248
v_mfma_f32_16x16x32_bf16 v[248:251], a[184:187], a[40:43], v[248:251]
ds_read_b64_tr_b16 a[204:205], v9 offset:57344
ds_read_b64_tr_b16 a[206:207], v9 offset:61440
v_mfma_f32_16x16x32_bf16 v[248:251], a[188:191], a[56:59], v[248:251]
v_lshlrev_b32 v5, 4, v5
v_mfma_f32_16x16x32_bf16 v[252:255], a[188:191], a[60:63], v[252:255]
v_mfma_f32_16x16x32_bf16 v[252:255], a[184:187], a[44:47], v[252:255]
s_waitcnt lgkmcnt(4) vmcnt(41)
v_mfma_f32_16x16x32_bf16 v[112:115], a[192:195], a[64:67], v[112:115]
v_mov_b32 v6, 0x3f80
v_mfma_f32_16x16x32_bf16 v[112:115], a[196:199], a[80:83], v[112:115]
v_mfma_f32_16x16x32_bf16 v[116:119], a[196:199], a[84:87], v[116:119]
v_mfma_f32_16x16x32_bf16 v[116:119], a[192:195], a[68:71], v[116:119]
ds_read_b64_tr_b16 a[176:177], v10 offset:49152
ds_read_b64_tr_b16 a[178:179], v10 offset:53248
v_mfma_f32_16x16x32_bf16 v[120:123], a[192:195], a[72:75], v[120:123]
ds_read_b64_tr_b16 a[180:181], v10 offset:57344
ds_read_b64_tr_b16 a[182:183], v10 offset:61440
v_mfma_f32_16x16x32_bf16 v[120:123], a[196:199], a[88:91], v[120:123]
v_lshlrev_b32 v5, v5, v6
v_mfma_f32_16x16x32_bf16 v[124:127], a[196:199], a[92:95], v[124:127]
v_mfma_f32_16x16x32_bf16 v[124:127], a[192:195], a[76:79], v[124:127]
s_waitcnt lgkmcnt(4)
v_mfma_f32_16x16x32_bf16 v[140:143], a[200:203], a[76:79], v[140:143]
v_cmp_eq_u32 vcc, v4, v3
s_nop 1
v_cndmask_b32 v5, 0, v5, vcc
v_mfma_f32_16x16x32_bf16 v[140:143], a[204:207], a[92:95], v[140:143]
v_mfma_f32_16x16x32_bf16 v[136:139], a[204:207], a[88:91], v[136:139]
v_mfma_f32_16x16x32_bf16 v[136:139], a[200:203], a[72:75], v[136:139]
ds_read_b64_tr_b16 a[184:185], v11 offset:49152
ds_read_b64_tr_b16 a[186:187], v11 offset:53248
v_mfma_f32_16x16x32_bf16 v[132:135], a[200:203], a[68:71], v[132:135]
ds_read_b64_tr_b16 a[188:189], v11 offset:57344
ds_read_b64_tr_b16 a[190:191], v11 offset:61440
v_mfma_f32_16x16x32_bf16 v[132:135], a[204:207], a[84:87], v[132:135]
v_and_b32 v4, 2, v0
v_mfma_f32_16x16x32_bf16 v[128:131], a[204:207], a[80:83], v[128:131]
v_cmp_eq_u32 vcc, 0, v4
s_nop 1
v_cndmask_b32 v18, 0, v5, vcc
v_cndmask_b32 v19, v5, v16, vcc
v_mfma_f32_16x16x32_bf16 v[128:131], a[200:203], a[64:67], v[128:131]
s_waitcnt lgkmcnt(4)
v_mfma_f32_16x16x32_bf16 v[144:147], a[176:179], a[64:67], v[144:147]
v_mfma_f32_16x16x32_bf16 v[144:147], a[180:183], a[80:83], v[144:147]
v_mul_u32_u24 v2, 1152, v2
v_mfma_f32_16x16x32_bf16 v[148:151], a[180:183], a[84:87], v[148:151]
v_mfma_f32_16x16x32_bf16 v[148:151], a[176:179], a[68:71], v[148:151]
ds_read_b64_tr_b16 a[192:193], v12 offset:49152
ds_read_b64_tr_b16 a[194:195], v12 offset:53248
v_mfma_f32_16x16x32_bf16 v[152:155], a[176:179], a[72:75], v[152:155]
ds_read_b64_tr_b16 a[196:197], v12 offset:57344
ds_read_b64_tr_b16 a[198:199], v12 offset:61440
v_mfma_f32_16x16x32_bf16 v[152:155], a[180:183], a[88:91], v[152:155]
v_lshl_add_u32 v2, v3, 3, v2
v_mfma_f32_16x16x32_bf16 v[156:159], a[180:183], a[92:95], v[156:159]
v_mfma_f32_16x16x32_bf16 v[156:159], a[176:179], a[76:79], v[156:159]
s_waitcnt lgkmcnt(4)
v_mfma_f32_16x16x32_bf16 v[172:175], a[184:187], a[76:79], v[172:175]
v_add_u32 v3, 18432, v2
v_mfma_f32_16x16x32_bf16 v[172:175], a[188:191], a[92:95], v[172:175]
v_mfma_f32_16x16x32_bf16 v[168:171], a[188:191], a[88:91], v[168:171]
v_mfma_f32_16x16x32_bf16 v[168:171], a[184:187], a[72:75], v[168:171]
ds_read_b64_tr_b16 a[200:201], v13 offset:49152
ds_read_b64_tr_b16 a[202:203], v13 offset:53248
v_mfma_f32_16x16x32_bf16 v[164:167], a[184:187], a[68:71], v[164:167]
s_lshl_b32 s26, s55, 3
ds_read_b64_tr_b16 a[204:205], v13 offset:57344
ds_read_b64_tr_b16 a[206:207], v13 offset:61440
v_mfma_f32_16x16x32_bf16 v[164:167], a[188:191], a[84:87], v[164:167]
v_mfma_f32_16x16x32_bf16 v[160:163], a[188:191], a[80:83], v[160:163]
v_mfma_f32_16x16x32_bf16 v[160:163], a[184:187], a[64:67], v[160:163]
s_waitcnt lgkmcnt(4)
s_add_u32 s26, s26, s51
v_mfma_f32_16x16x32_bf16 v[176:179], a[192:195], a[64:67], v[176:179]
v_mfma_f32_16x16x32_bf16 v[176:179], a[196:199], a[80:83], v[176:179]
v_mfma_f32_16x16x32_bf16 v[180:183], a[196:199], a[84:87], v[180:183]
s_mul_i32 s26, s26, 73728
v_mfma_f32_16x16x32_bf16 v[180:183], a[192:195], a[68:71], v[180:183]
ds_read_b64_tr_b16 a[176:177], v14 offset:49152
ds_read_b64_tr_b16 a[178:179], v14 offset:53248
v_mfma_f32_16x16x32_bf16 v[184:187], a[192:195], a[72:75], v[184:187]
ds_read_b64_tr_b16 a[180:181], v14 offset:57344
ds_read_b64_tr_b16 a[182:183], v14 offset:61440
v_mfma_f32_16x16x32_bf16 v[184:187], a[196:199], a[88:91], v[184:187]
v_mfma_f32_16x16x32_bf16 v[188:191], a[196:199], a[92:95], v[188:191]
v_add_u32 v1, s39, v7
v_mfma_f32_16x16x32_bf16 v[188:191], a[192:195], a[76:79], v[188:191]
s_waitcnt lgkmcnt(4)
v_mfma_f32_16x16x32_bf16 v[204:207], a[200:203], a[76:79], v[204:207]
v_mfma_f32_16x16x32_bf16 v[204:207], a[204:207], a[92:95], v[204:207]
v_add_u32 v35, 4096, v7
v_mfma_f32_16x16x32_bf16 v[200:203], a[204:207], a[88:91], v[200:203]
v_mfma_f32_16x16x32_bf16 v[200:203], a[200:203], a[72:75], v[200:203]
ds_read_b64_tr_b16 a[184:185], v15 offset:49152
ds_read_b64_tr_b16 a[186:187], v15 offset:53248
v_mfma_f32_16x16x32_bf16 v[196:199], a[200:203], a[68:71], v[196:199]
ds_read_b64_tr_b16 a[188:189], v15 offset:57344
ds_read_b64_tr_b16 a[190:191], v15 offset:61440
v_mfma_f32_16x16x32_bf16 v[196:199], a[204:207], a[84:87], v[196:199]
s_add_u32 s26, s26, s39
v_mfma_f32_16x16x32_bf16 v[192:195], a[204:207], a[80:83], v[192:195]
v_mfma_f32_16x16x32_bf16 v[192:195], a[200:203], a[64:67], v[192:195]
s_waitcnt lgkmcnt(4)
v_mfma_f32_16x16x32_bf16 v[208:211], a[176:179], a[64:67], v[208:211]
s_add_u32 s26, s26, 4194304
v_mfma_f32_16x16x32_bf16 v[208:211], a[180:183], a[80:83], v[208:211]
v_mfma_f32_16x16x32_bf16 v[212:215], a[180:183], a[84:87], v[212:215]
v_mfma_f32_16x16x32_bf16 v[212:215], a[176:179], a[68:71], v[212:215]
s_add_u32 s27, s26, 8192
ds_read_b64_tr_b16 a[192:193], v20 offset:8192
ds_read_b64_tr_b16 a[194:195], v20 offset:8704
v_mfma_f32_16x16x32_bf16 v[216:219], a[176:179], a[72:75], v[216:219]
ds_read_b64_tr_b16 a[196:197], v20 offset:9216
ds_read_b64_tr_b16 a[198:199], v20 offset:9728
v_mfma_f32_16x16x32_bf16 v[216:219], a[180:183], a[88:91], v[216:219]
v_mfma_f32_16x16x32_bf16 v[220:223], a[180:183], a[92:95], v[220:223]
v_mfma_f32_16x16x32_bf16 v[220:223], a[176:179], a[76:79], v[220:223]
s_waitcnt lgkmcnt(4)
s_waitcnt vmcnt(1) lgkmcnt(0)
s_barrier
v_mfma_f32_16x16x32_bf16 v[236:239], a[184:187], a[76:79], v[236:239]
ds_read_b64_tr_b16 v[48:49], v40 offset:0
ds_read_b64_tr_b16 v[50:51], v40 offset:4096
v_mfma_f32_16x16x32_bf16 v[236:239], a[188:191], a[92:95], v[236:239]
ds_read_b64_tr_b16 v[52:53], v40 offset:8192
ds_read_b64_tr_b16 v[54:55], v40 offset:12288
v_mfma_f32_16x16x32_bf16 v[232:235], a[188:191], a[88:91], v[232:235]
ds_read_b64_tr_b16 v[56:57], v40 offset:32768
ds_read_b64_tr_b16 v[58:59], v40 offset:36864
v_mfma_f32_16x16x32_bf16 v[232:235], a[184:187], a[72:75], v[232:235]
ds_read_b64_tr_b16 v[60:61], v40 offset:40960
ds_read_b64_tr_b16 v[62:63], v40 offset:45056
v_mfma_f32_16x16x32_bf16 v[228:231], a[184:187], a[68:71], v[228:231]
ds_read_b64_tr_b16 v[96:97], v40 offset:49152
ds_read_b64_tr_b16 v[98:99], v40 offset:53248
v_mfma_f32_16x16x32_bf16 v[228:231], a[188:191], a[84:87], v[228:231]
ds_read_b64_tr_b16 v[100:101], v40 offset:57344
ds_read_b64_tr_b16 v[102:103], v40 offset:61440
v_mfma_f32_16x16x32_bf16 v[224:227], a[188:191], a[80:83], v[224:227]
s_cmp_eq_u32 s23, 0
s_cselect_b32 s27, s27, s18
s_mov_b32 s57, 0xbfb8aa3b
v_mfma_f32_16x16x32_bf16 v[224:227], a[184:187], a[64:67], v[224:227]
s_waitcnt lgkmcnt(12)
v_mfma_f32_16x16x32_bf16 v[240:243], a[192:195], a[64:67], v[240:243]
v_mfma_f32_16x16x32_bf16 v[240:243], a[196:199], a[80:83], v[240:243]
v_mfma_f32_16x16x32_bf16 v[244:247], a[196:199], a[84:87], v[244:247]
v_mfma_f32_16x16x32_bf16 v[244:247], a[192:195], a[68:71], v[244:247]
v_mfma_f32_16x16x32_bf16 v[248:251], a[192:195], a[72:75], v[248:251]
v_mfma_f32_16x16x32_bf16 v[248:251], a[196:199], a[88:91], v[248:251]
v_mfma_f32_16x16x32_bf16 v[252:255], a[196:199], a[92:95], v[252:255]
v_mfma_f32_16x16x32_bf16 v[252:255], a[192:195], a[76:79], v[252:255]
s_waitcnt lgkmcnt(0) vmcnt(0)
v_mfma_f32_16x16x32_bf16 v[112:115], v[48:51], a[96:99], v[112:115]
buffer_load_dwordx2 a[240:241], v2, s[8:11], s41 offen offset:0
v_mfma_f32_16x16x32_bf16 v[112:115], v[52:55], a[112:115], v[112:115]
v_mfma_f32_16x16x32_bf16 v[112:115], v[56:59], a[144:147], v[112:115]
v_mfma_f32_16x16x32_bf16 v[112:115], v[60:63], a[160:163], v[112:115]
v_mfma_f32_16x16x32_bf16 v[112:115], v[96:99], a[208:211], v[112:115]
buffer_load_dwordx2 a[242:243], v3, s[8:11], s41 offen offset:0
v_mfma_f32_16x16x32_bf16 v[112:115], v[100:103], a[224:227], v[112:115]
v_mfma_f32_16x16x32_bf16 v[116:119], v[100:103], a[228:231], v[116:119]
v_mfma_f32_16x16x32_bf16 v[116:119], v[96:99], a[212:215], v[116:119]
ds_read_b64_tr_b16 v[104:105], v41 offset:0
ds_read_b64_tr_b16 v[106:107], v41 offset:4096
v_mfma_f32_16x16x32_bf16 v[116:119], v[60:63], a[164:167], v[116:119]
ds_read_b64_tr_b16 v[108:109], v41 offset:8192
ds_read_b64_tr_b16 v[110:111], v41 offset:12288
v_mfma_f32_16x16x32_bf16 v[116:119], v[56:59], a[148:151], v[116:119]
buffer_load_dwordx2 a[244:245], v2, s[8:11], s41 offen offset:128
v_mfma_f32_16x16x32_bf16 v[116:119], v[52:55], a[116:119], v[116:119]
ds_read_b64_tr_b16 a[176:177], v41 offset:32768
ds_read_b64_tr_b16 a[178:179], v41 offset:36864
v_mfma_f32_16x16x32_bf16 v[116:119], v[48:51], a[100:103], v[116:119]
ds_read_b64_tr_b16 a[180:181], v41 offset:40960
ds_read_b64_tr_b16 a[182:183], v41 offset:45056
v_mfma_f32_16x16x32_bf16 v[120:123], v[48:51], a[104:107], v[120:123]
ds_read_b64_tr_b16 a[184:185], v41 offset:49152
ds_read_b64_tr_b16 a[186:187], v41 offset:53248
v_mfma_f32_16x16x32_bf16 v[120:123], v[52:55], a[120:123], v[120:123]
ds_read_b64_tr_b16 a[188:189], v41 offset:57344
ds_read_b64_tr_b16 a[190:191], v41 offset:61440
v_mfma_f32_16x16x32_bf16 v[120:123], v[56:59], a[152:155], v[120:123]
buffer_load_dwordx2 a[246:247], v3, s[8:11], s41 offen offset:128
v_mfma_f32_16x16x32_bf16 v[120:123], v[60:63], a[168:171], v[120:123]
v_mfma_f32_16x16x32_bf16 v[120:123], v[96:99], a[216:219], v[120:123]
v_mfma_f32_16x16x32_bf16 v[120:123], v[100:103], a[232:235], v[120:123]
v_mfma_f32_16x16x32_bf16 v[124:127], v[100:103], a[236:239], v[124:127]
v_mfma_f32_16x16x32_bf16 v[124:127], v[96:99], a[220:223], v[124:127]
buffer_load_dwordx2 a[248:249], v2, s[8:11], s43 offen offset:0
v_mfma_f32_16x16x32_bf16 v[124:127], v[60:63], a[172:175], v[124:127]
v_mfma_f32_16x16x32_bf16 v[124:127], v[56:59], a[156:159], v[124:127]
v_mfma_f32_16x16x32_bf16 v[124:127], v[52:55], a[124:127], v[124:127]
v_mfma_f32_16x16x32_bf16 v[124:127], v[48:51], a[108:111], v[124:127]
s_waitcnt lgkmcnt(0)
v_mfma_f32_16x16x32_bf16 v[140:143], v[104:107], a[108:111], v[140:143]
buffer_load_dwordx2 a[250:251], v3, s[8:11], s43 offen offset:0
v_mfma_f32_16x16x32_bf16 v[140:143], v[108:111], a[124:127], v[140:143]
v_mfma_f32_16x16x32_bf16 v[140:143], a[176:179], a[156:159], v[140:143]
v_mfma_f32_16x16x32_bf16 v[140:143], a[180:183], a[172:175], v[140:143]
v_mfma_f32_16x16x32_bf16 v[140:143], a[184:187], a[220:223], v[140:143]
v_mfma_f32_16x16x32_bf16 v[140:143], a[188:191], a[236:239], v[140:143]
v_mfma_f32_16x16x32_bf16 v[136:139], a[188:191], a[232:235], v[136:139]
v_cvt_pk_bf16_f32 v64, v112, v113
v_cvt_pk_bf16_f32 v65, v114, v115
v_mfma_f32_16x16x32_bf16 v[136:139], a[184:187], a[216:219], v[136:139]
v_cvt_pk_bf16_f32 v66, v116, v117
v_cvt_pk_bf16_f32 v67, v118, v119
v_mfma_f32_16x16x32_bf16 v[136:139], a[180:183], a[168:171], v[136:139]
s_add_u32 s40, s28, 0
buffer_store_dwordx4 v[64:67], v7, s[16:19], s40 offen sc1
v_mfma_f32_16x16x32_bf16 v[136:139], a[176:179], a[152:155], v[136:139]
s_mov_b64 exec, s[30:31]
ds_write_b128 v7, v[64:67] offset:32768
s_mov_b64 exec, -1
v_mfma_f32_16x16x32_bf16 v[136:139], v[108:111], a[120:123], v[136:139]
ds_read_b64_tr_b16 a[192:193], v42 offset:0
ds_read_b64_tr_b16 a[194:195], v42 offset:4096
v_mfma_f32_16x16x32_bf16 v[136:139], v[104:107], a[104:107], v[136:139]
ds_read_b64_tr_b16 a[196:197], v42 offset:8192
ds_read_b64_tr_b16 a[198:199], v42 offset:12288
v_mfma_f32_16x16x32_bf16 v[132:135], v[104:107], a[100:103], v[132:135]
ds_read_b64_tr_b16 a[200:201], v42 offset:32768
ds_read_b64_tr_b16 a[202:203], v42 offset:36864
v_mfma_f32_16x16x32_bf16 v[132:135], v[108:111], a[116:119], v[132:135]
ds_read_b64_tr_b16 a[204:205], v42 offset:40960
ds_read_b64_tr_b16 a[206:207], v42 offset:45056
v_mfma_f32_16x16x32_bf16 v[132:135], a[176:179], a[148:151], v[132:135]
ds_read_b64_tr_b16 v[48:49], v42 offset:49152
ds_read_b64_tr_b16 v[50:51], v42 offset:53248
v_mfma_f32_16x16x32_bf16 v[132:135], a[180:183], a[164:167], v[132:135]
ds_read_b64_tr_b16 v[52:53], v42 offset:57344
ds_read_b64_tr_b16 v[54:55], v42 offset:61440
v_mfma_f32_16x16x32_bf16 v[132:135], a[184:187], a[212:215], v[132:135]
v_cvt_pk_bf16_f32 v68, v120, v121
v_cvt_pk_bf16_f32 v69, v122, v123
v_mfma_f32_16x16x32_bf16 v[132:135], a[188:191], a[228:231], v[132:135]
v_cvt_pk_bf16_f32 v70, v124, v125
v_cvt_pk_bf16_f32 v71, v126, v127
v_mfma_f32_16x16x32_bf16 v[128:131], a[188:191], a[224:227], v[128:131]
s_add_u32 s40, s29, 0
buffer_store_dwordx4 v[68:71], v7, s[16:19], s40 offen sc1
v_mfma_f32_16x16x32_bf16 v[128:131], a[184:187], a[208:211], v[128:131]
s_mov_b64 exec, s[32:33]
ds_write_b128 v7, v[68:71] offset:32768
s_mov_b64 exec, -1
v_mfma_f32_16x16x32_bf16 v[128:131], a[180:183], a[160:163], v[128:131]
v_mfma_f32_16x16x32_bf16 v[128:131], a[176:179], a[144:147], v[128:131]
v_mfma_f32_16x16x32_bf16 v[128:131], v[108:111], a[112:115], v[128:131]
v_mfma_f32_16x16x32_bf16 v[128:131], v[104:107], a[96:99], v[128:131]
s_waitcnt lgkmcnt(0)
v_mfma_f32_16x16x32_bf16 v[144:147], a[192:195], a[96:99], v[144:147]
v_mfma_f32_16x16x32_bf16 v[144:147], a[196:199], a[112:115], v[144:147]
v_mfma_f32_16x16x32_bf16 v[144:147], a[200:203], a[144:147], v[144:147]
v_mfma_f32_16x16x32_bf16 v[144:147], a[204:207], a[160:163], v[144:147]
v_mfma_f32_16x16x32_bf16 v[144:147], v[48:51], a[208:211], v[144:147]
v_mfma_f32_16x16x32_bf16 v[144:147], v[52:55], a[224:227], v[144:147]
v_mfma_f32_16x16x32_bf16 v[148:151], v[52:55], a[228:231], v[148:151]
v_cvt_pk_bf16_f32 v72, v128, v129
v_cvt_pk_bf16_f32 v73, v130, v131
v_mfma_f32_16x16x32_bf16 v[148:151], v[48:51], a[212:215], v[148:151]
v_cvt_pk_bf16_f32 v74, v132, v133
v_cvt_pk_bf16_f32 v75, v134, v135
v_mfma_f32_16x16x32_bf16 v[148:151], a[204:207], a[164:167], v[148:151]
s_add_u32 s40, s28, 1024
buffer_store_dwordx4 v[72:75], v7, s[16:19], s40 offen sc1
v_mfma_f32_16x16x32_bf16 v[148:151], a[200:203], a[148:151], v[148:151]
s_mov_b64 exec, s[30:31]
ds_write_b128 v7, v[72:75] offset:33792
s_mov_b64 exec, -1
v_mfma_f32_16x16x32_bf16 v[148:151], a[196:199], a[116:119], v[148:151]
ds_read_b64_tr_b16 v[56:57], v43 offset:0
ds_read_b64_tr_b16 v[58:59], v43 offset:4096
v_mfma_f32_16x16x32_bf16 v[148:151], a[192:195], a[100:103], v[148:151]
ds_read_b64_tr_b16 v[60:61], v43 offset:8192
ds_read_b64_tr_b16 v[62:63], v43 offset:12288
v_mfma_f32_16x16x32_bf16 v[152:155], a[192:195], a[104:107], v[152:155]
ds_read_b64_tr_b16 v[96:97], v43 offset:32768
ds_read_b64_tr_b16 v[98:99], v43 offset:36864
v_mfma_f32_16x16x32_bf16 v[152:155], a[196:199], a[120:123], v[152:155]
ds_read_b64_tr_b16 v[100:101], v43 offset:40960
ds_read_b64_tr_b16 v[102:103], v43 offset:45056
v_mfma_f32_16x16x32_bf16 v[152:155], a[200:203], a[152:155], v[152:155]
ds_read_b64_tr_b16 v[104:105], v43 offset:49152
ds_read_b64_tr_b16 v[106:107], v43 offset:53248
v_mfma_f32_16x16x32_bf16 v[152:155], a[204:207], a[168:171], v[152:155]
ds_read_b64_tr_b16 v[108:109], v43 offset:57344
ds_read_b64_tr_b16 v[110:111], v43 offset:61440
v_mfma_f32_16x16x32_bf16 v[152:155], v[48:51], a[216:219], v[152:155]
v_cvt_pk_bf16_f32 v76, v136, v137
v_cvt_pk_bf16_f32 v77, v138, v139
v_mfma_f32_16x16x32_bf16 v[152:155], v[52:55], a[232:235], v[152:155]
v_cvt_pk_bf16_f32 v78, v140, v141
v_cvt_pk_bf16_f32 v79, v142, v143
v_mfma_f32_16x16x32_bf16 v[156:159], v[52:55], a[236:239], v[156:159]
s_add_u32 s40, s29, 1024
buffer_store_dwordx4 v[76:79], v7, s[16:19], s40 offen sc1
v_mfma_f32_16x16x32_bf16 v[156:159], v[48:51], a[220:223], v[156:159]
s_mov_b64 exec, s[32:33]
ds_write_b128 v7, v[76:79] offset:33792
s_mov_b64 exec, -1
v_mfma_f32_16x16x32_bf16 v[156:159], a[204:207], a[172:175], v[156:159]
v_mfma_f32_16x16x32_bf16 v[156:159], a[200:203], a[156:159], v[156:159]
v_mfma_f32_16x16x32_bf16 v[156:159], a[196:199], a[124:127], v[156:159]
v_mfma_f32_16x16x32_bf16 v[156:159], a[192:195], a[108:111], v[156:159]
s_waitcnt lgkmcnt(0)
v_mfma_f32_16x16x32_bf16 v[172:175], v[56:59], a[108:111], v[172:175]
v_mfma_f32_16x16x32_bf16 v[172:175], v[60:63], a[124:127], v[172:175]
v_mfma_f32_16x16x32_bf16 v[172:175], v[96:99], a[156:159], v[172:175]
v_mfma_f32_16x16x32_bf16 v[172:175], v[100:103], a[172:175], v[172:175]
v_mfma_f32_16x16x32_bf16 v[172:175], v[104:107], a[220:223], v[172:175]
v_mfma_f32_16x16x32_bf16 v[172:175], v[108:111], a[236:239], v[172:175]
v_mfma_f32_16x16x32_bf16 v[168:171], v[108:111], a[232:235], v[168:171]
v_cvt_pk_bf16_f32 v80, v144, v145
v_cvt_pk_bf16_f32 v81, v146, v147
v_mfma_f32_16x16x32_bf16 v[168:171], v[104:107], a[216:219], v[168:171]
v_cvt_pk_bf16_f32 v82, v148, v149
v_cvt_pk_bf16_f32 v83, v150, v151
v_mfma_f32_16x16x32_bf16 v[168:171], v[100:103], a[168:171], v[168:171]
s_add_u32 s40, s28, 2048
buffer_store_dwordx4 v[80:83], v7, s[16:19], s40 offen sc1
v_mfma_f32_16x16x32_bf16 v[168:171], v[96:99], a[152:155], v[168:171]
s_mov_b64 exec, s[30:31]
ds_write_b128 v7, v[80:83] offset:34816
s_mov_b64 exec, -1
v_mfma_f32_16x16x32_bf16 v[168:171], v[60:63], a[120:123], v[168:171]
ds_read_b64_tr_b16 a[176:177], v44 offset:0
ds_read_b64_tr_b16 a[178:179], v44 offset:4096
v_mfma_f32_16x16x32_bf16 v[168:171], v[56:59], a[104:107], v[168:171]
ds_read_b64_tr_b16 a[180:181], v44 offset:8192
ds_read_b64_tr_b16 a[182:183], v44 offset:12288
v_mfma_f32_16x16x32_bf16 v[164:167], v[56:59], a[100:103], v[164:167]
ds_read_b64_tr_b16 a[184:185], v44 offset:32768
ds_read_b64_tr_b16 a[186:187], v44 offset:36864
v_mfma_f32_16x16x32_bf16 v[164:167], v[60:63], a[116:119], v[164:167]
ds_read_b64_tr_b16 a[188:189], v44 offset:40960
ds_read_b64_tr_b16 a[190:191], v44 offset:45056
v_mfma_f32_16x16x32_bf16 v[164:167], v[96:99], a[148:151], v[164:167]
ds_read_b64_tr_b16 a[192:193], v44 offset:49152
ds_read_b64_tr_b16 a[194:195], v44 offset:53248
v_mfma_f32_16x16x32_bf16 v[164:167], v[100:103], a[164:167], v[164:167]
ds_read_b64_tr_b16 a[196:197], v44 offset:57344
ds_read_b64_tr_b16 a[198:199], v44 offset:61440
v_mfma_f32_16x16x32_bf16 v[164:167], v[104:107], a[212:215], v[164:167]
v_cvt_pk_bf16_f32 v84, v152, v153
v_cvt_pk_bf16_f32 v85, v154, v155
v_mfma_f32_16x16x32_bf16 v[164:167], v[108:111], a[228:231], v[164:167]
v_cvt_pk_bf16_f32 v86, v156, v157
v_cvt_pk_bf16_f32 v87, v158, v159
v_mfma_f32_16x16x32_bf16 v[160:163], v[108:111], a[224:227], v[160:163]
s_add_u32 s40, s29, 2048
buffer_store_dwordx4 v[84:87], v7, s[16:19], s40 offen sc1
v_mfma_f32_16x16x32_bf16 v[160:163], v[104:107], a[208:211], v[160:163]
s_mov_b64 exec, s[32:33]
ds_write_b128 v7, v[84:87] offset:34816
s_mov_b64 exec, -1
v_mfma_f32_16x16x32_bf16 v[160:163], v[100:103], a[160:163], v[160:163]
v_mfma_f32_16x16x32_bf16 v[160:163], v[96:99], a[144:147], v[160:163]
v_mfma_f32_16x16x32_bf16 v[160:163], v[60:63], a[112:115], v[160:163]
v_mfma_f32_16x16x32_bf16 v[160:163], v[56:59], a[96:99], v[160:163]
s_waitcnt lgkmcnt(0)
v_mfma_f32_16x16x32_bf16 v[176:179], a[176:179], a[96:99], v[176:179]
v_mfma_f32_16x16x32_bf16 v[176:179], a[180:183], a[112:115], v[176:179]
v_mfma_f32_16x16x32_bf16 v[176:179], a[184:187], a[144:147], v[176:179]
v_mfma_f32_16x16x32_bf16 v[176:179], a[188:191], a[160:163], v[176:179]
v_mfma_f32_16x16x32_bf16 v[176:179], a[192:195], a[208:211], v[176:179]
v_mfma_f32_16x16x32_bf16 v[176:179], a[196:199], a[224:227], v[176:179]
v_mfma_f32_16x16x32_bf16 v[180:183], a[196:199], a[228:231], v[180:183]
v_cvt_pk_bf16_f32 v88, v160, v161
v_cvt_pk_bf16_f32 v89, v162, v163
v_mfma_f32_16x16x32_bf16 v[180:183], a[192:195], a[212:215], v[180:183]
v_cvt_pk_bf16_f32 v90, v164, v165
v_cvt_pk_bf16_f32 v91, v166, v167
v_mfma_f32_16x16x32_bf16 v[180:183], a[188:191], a[164:167], v[180:183]
s_add_u32 s40, s28, 3072
buffer_store_dwordx4 v[88:91], v7, s[16:19], s40 offen sc1
v_mfma_f32_16x16x32_bf16 v[180:183], a[184:187], a[148:151], v[180:183]
s_mov_b64 exec, s[30:31]
ds_write_b128 v7, v[88:91] offset:35840
s_mov_b64 exec, -1
v_mfma_f32_16x16x32_bf16 v[180:183], a[180:183], a[116:119], v[180:183]
ds_read_b64_tr_b16 a[200:201], v45 offset:0
ds_read_b64_tr_b16 a[202:203], v45 offset:4096
v_mfma_f32_16x16x32_bf16 v[180:183], a[176:179], a[100:103], v[180:183]
ds_read_b64_tr_b16 a[204:205], v45 offset:8192
ds_read_b64_tr_b16 a[206:207], v45 offset:12288
v_mfma_f32_16x16x32_bf16 v[184:187], a[176:179], a[104:107], v[184:187]
ds_read_b64_tr_b16 v[48:49], v45 offset:32768
ds_read_b64_tr_b16 v[50:51], v45 offset:36864
v_mfma_f32_16x16x32_bf16 v[184:187], a[180:183], a[120:123], v[184:187]
ds_read_b64_tr_b16 v[52:53], v45 offset:40960
ds_read_b64_tr_b16 v[54:55], v45 offset:45056
v_mfma_f32_16x16x32_bf16 v[184:187], a[184:187], a[152:155], v[184:187]
ds_read_b64_tr_b16 v[56:57], v45 offset:49152
ds_read_b64_tr_b16 v[58:59], v45 offset:53248
v_mfma_f32_16x16x32_bf16 v[184:187], a[188:191], a[168:171], v[184:187]
ds_read_b64_tr_b16 v[60:61], v45 offset:57344
ds_read_b64_tr_b16 v[62:63], v45 offset:61440
v_mfma_f32_16x16x32_bf16 v[184:187], a[192:195], a[216:219], v[184:187]
v_cvt_pk_bf16_f32 v92, v168, v169
v_cvt_pk_bf16_f32 v93, v170, v171
v_mfma_f32_16x16x32_bf16 v[184:187], a[196:199], a[232:235], v[184:187]
v_cvt_pk_bf16_f32 v94, v172, v173
v_cvt_pk_bf16_f32 v95, v174, v175
v_mfma_f32_16x16x32_bf16 v[188:191], a[196:199], a[236:239], v[188:191]
s_add_u32 s40, s29, 3072
buffer_store_dwordx4 v[92:95], v7, s[16:19], s40 offen sc1
v_mfma_f32_16x16x32_bf16 v[188:191], a[192:195], a[220:223], v[188:191]
s_mov_b64 exec, s[32:33]
ds_write_b128 v7, v[92:95] offset:35840
s_mov_b64 exec, -1
v_mfma_f32_16x16x32_bf16 v[188:191], a[188:191], a[172:175], v[188:191]
v_mfma_f32_16x16x32_bf16 v[188:191], a[184:187], a[156:159], v[188:191]
v_mfma_f32_16x16x32_bf16 v[188:191], a[180:183], a[124:127], v[188:191]
v_mfma_f32_16x16x32_bf16 v[188:191], a[176:179], a[108:111], v[188:191]
s_waitcnt lgkmcnt(0)
v_mfma_f32_16x16x32_bf16 v[204:207], a[200:203], a[108:111], v[204:207]
v_mfma_f32_16x16x32_bf16 v[204:207], a[204:207], a[124:127], v[204:207]
v_mfma_f32_16x16x32_bf16 v[204:207], v[48:51], a[156:159], v[204:207]
v_mfma_f32_16x16x32_bf16 v[204:207], v[52:55], a[172:175], v[204:207]
v_mfma_f32_16x16x32_bf16 v[204:207], v[56:59], a[220:223], v[204:207]
v_mfma_f32_16x16x32_bf16 v[204:207], v[60:63], a[236:239], v[204:207]
v_mfma_f32_16x16x32_bf16 v[200:203], v[60:63], a[232:235], v[200:203]
v_cvt_pk_bf16_f32 v64, v176, v177
v_cvt_pk_bf16_f32 v65, v178, v179
v_mfma_f32_16x16x32_bf16 v[200:203], v[56:59], a[216:219], v[200:203]
v_cvt_pk_bf16_f32 v66, v180, v181
v_cvt_pk_bf16_f32 v67, v182, v183
v_mfma_f32_16x16x32_bf16 v[200:203], v[52:55], a[168:171], v[200:203]
s_add_u32 s40, s28, 4096
buffer_store_dwordx4 v[64:67], v7, s[16:19], s40 offen sc1
v_mfma_f32_16x16x32_bf16 v[200:203], v[48:51], a[152:155], v[200:203]
s_mov_b64 exec, s[30:31]
ds_write_b128 v7, v[64:67] offset:36864
s_mov_b64 exec, -1
v_mfma_f32_16x16x32_bf16 v[200:203], a[204:207], a[120:123], v[200:203]
ds_read_b64_tr_b16 v[96:97], v46 offset:0
ds_read_b64_tr_b16 v[98:99], v46 offset:4096
v_mfma_f32_16x16x32_bf16 v[200:203], a[200:203], a[104:107], v[200:203]
ds_read_b64_tr_b16 v[100:101], v46 offset:8192
ds_read_b64_tr_b16 v[102:103], v46 offset:12288
v_mfma_f32_16x16x32_bf16 v[196:199], a[200:203], a[100:103], v[196:199]
ds_read_b64_tr_b16 v[104:105], v46 offset:32768
ds_read_b64_tr_b16 v[106:107], v46 offset:36864
v_mfma_f32_16x16x32_bf16 v[196:199], a[204:207], a[116:119], v[196:199]
ds_read_b64_tr_b16 v[108:109], v46 offset:40960
ds_read_b64_tr_b16 v[110:111], v46 offset:45056
v_mfma_f32_16x16x32_bf16 v[196:199], v[48:51], a[148:151], v[196:199]
ds_read_b64_tr_b16 a[176:177], v46 offset:49152
ds_read_b64_tr_b16 a[178:179], v46 offset:53248
v_mfma_f32_16x16x32_bf16 v[196:199], v[52:55], a[164:167], v[196:199]
ds_read_b64_tr_b16 a[180:181], v46 offset:57344
ds_read_b64_tr_b16 a[182:183], v46 offset:61440
v_mfma_f32_16x16x32_bf16 v[196:199], v[56:59], a[212:215], v[196:199]
v_cvt_pk_bf16_f32 v68, v184, v185
v_cvt_pk_bf16_f32 v69, v186, v187
v_mfma_f32_16x16x32_bf16 v[196:199], v[60:63], a[228:231], v[196:199]
v_cvt_pk_bf16_f32 v70, v188, v189
v_cvt_pk_bf16_f32 v71, v190, v191
v_mfma_f32_16x16x32_bf16 v[192:195], v[60:63], a[224:227], v[192:195]
s_add_u32 s40, s29, 4096
buffer_store_dwordx4 v[68:71], v7, s[16:19], s40 offen sc1
v_mfma_f32_16x16x32_bf16 v[192:195], v[56:59], a[208:211], v[192:195]
s_mov_b64 exec, s[32:33]
ds_write_b128 v7, v[68:71] offset:36864
s_mov_b64 exec, -1
v_mfma_f32_16x16x32_bf16 v[192:195], v[52:55], a[160:163], v[192:195]
v_mfma_f32_16x16x32_bf16 v[192:195], v[48:51], a[144:147], v[192:195]
v_mfma_f32_16x16x32_bf16 v[192:195], a[204:207], a[112:115], v[192:195]
v_mfma_f32_16x16x32_bf16 v[192:195], a[200:203], a[96:99], v[192:195]
s_waitcnt lgkmcnt(0)
v_mfma_f32_16x16x32_bf16 v[208:211], v[96:99], a[96:99], v[208:211]
v_mfma_f32_16x16x32_bf16 v[208:211], v[100:103], a[112:115], v[208:211]
v_mfma_f32_16x16x32_bf16 v[208:211], v[104:107], a[144:147], v[208:211]
v_mfma_f32_16x16x32_bf16 v[208:211], v[108:111], a[160:163], v[208:211]
v_mfma_f32_16x16x32_bf16 v[208:211], a[176:179], a[208:211], v[208:211]
v_mfma_f32_16x16x32_bf16 v[208:211], a[180:183], a[224:227], v[208:211]
v_mfma_f32_16x16x32_bf16 v[212:215], a[180:183], a[228:231], v[212:215]
v_cvt_pk_bf16_f32 v72, v192, v193
v_cvt_pk_bf16_f32 v73, v194, v195
v_mfma_f32_16x16x32_bf16 v[212:215], a[176:179], a[212:215], v[212:215]
v_cvt_pk_bf16_f32 v74, v196, v197
v_cvt_pk_bf16_f32 v75, v198, v199
v_mfma_f32_16x16x32_bf16 v[212:215], v[108:111], a[164:167], v[212:215]
s_add_u32 s40, s28, 5120
buffer_store_dwordx4 v[72:75], v7, s[16:19], s40 offen sc1
v_mfma_f32_16x16x32_bf16 v[212:215], v[104:107], a[148:151], v[212:215]
s_mov_b64 exec, s[30:31]
ds_write_b128 v7, v[72:75] offset:37888
s_mov_b64 exec, -1
v_mfma_f32_16x16x32_bf16 v[212:215], v[100:103], a[116:119], v[212:215]
ds_read_b64_tr_b16 a[184:185], v47 offset:0
ds_read_b64_tr_b16 a[186:187], v47 offset:4096
v_mfma_f32_16x16x32_bf16 v[212:215], v[96:99], a[100:103], v[212:215]
ds_read_b64_tr_b16 a[188:189], v47 offset:8192
ds_read_b64_tr_b16 a[190:191], v47 offset:12288
v_mfma_f32_16x16x32_bf16 v[216:219], v[96:99], a[104:107], v[216:219]
ds_read_b64_tr_b16 a[192:193], v47 offset:32768
ds_read_b64_tr_b16 a[194:195], v47 offset:36864
v_mfma_f32_16x16x32_bf16 v[216:219], v[100:103], a[120:123], v[216:219]
ds_read_b64_tr_b16 a[196:197], v47 offset:40960
ds_read_b64_tr_b16 a[198:199], v47 offset:45056
v_mfma_f32_16x16x32_bf16 v[216:219], v[104:107], a[152:155], v[216:219]
ds_read_b64_tr_b16 a[200:201], v47 offset:49152
ds_read_b64_tr_b16 a[202:203], v47 offset:53248
v_mfma_f32_16x16x32_bf16 v[216:219], v[108:111], a[168:171], v[216:219]
ds_read_b64_tr_b16 a[204:205], v47 offset:57344
ds_read_b64_tr_b16 a[206:207], v47 offset:61440
v_mfma_f32_16x16x32_bf16 v[216:219], a[176:179], a[216:219], v[216:219]
v_cvt_pk_bf16_f32 v76, v200, v201
v_cvt_pk_bf16_f32 v77, v202, v203
v_mfma_f32_16x16x32_bf16 v[216:219], a[180:183], a[232:235], v[216:219]
v_cvt_pk_bf16_f32 v78, v204, v205
v_cvt_pk_bf16_f32 v79, v206, v207
v_mfma_f32_16x16x32_bf16 v[220:223], a[180:183], a[236:239], v[220:223]
s_add_u32 s40, s29, 5120
buffer_store_dwordx4 v[76:79], v7, s[16:19], s40 offen sc1
v_mfma_f32_16x16x32_bf16 v[220:223], a[176:179], a[220:223], v[220:223]
s_mov_b64 exec, s[32:33]
ds_write_b128 v7, v[76:79] offset:37888
s_mov_b64 exec, -1
v_mfma_f32_16x16x32_bf16 v[220:223], v[108:111], a[172:175], v[220:223]
v_mfma_f32_16x16x32_bf16 v[220:223], v[104:107], a[156:159], v[220:223]
v_mfma_f32_16x16x32_bf16 v[220:223], v[100:103], a[124:127], v[220:223]
v_mfma_f32_16x16x32_bf16 v[220:223], v[96:99], a[108:111], v[220:223]
s_waitcnt lgkmcnt(0)
v_mfma_f32_16x16x32_bf16 v[236:239], a[184:187], a[108:111], v[236:239]
v_mfma_f32_16x16x32_bf16 v[236:239], a[188:191], a[124:127], v[236:239]
v_mfma_f32_16x16x32_bf16 v[236:239], a[192:195], a[156:159], v[236:239]
v_mfma_f32_16x16x32_bf16 v[236:239], a[196:199], a[172:175], v[236:239]
v_mfma_f32_16x16x32_bf16 v[236:239], a[200:203], a[220:223], v[236:239]
v_mfma_f32_16x16x32_bf16 v[236:239], a[204:207], a[236:239], v[236:239]
v_mfma_f32_16x16x32_bf16 v[232:235], a[204:207], a[232:235], v[232:235]
v_cvt_pk_bf16_f32 v80, v208, v209
v_cvt_pk_bf16_f32 v81, v210, v211
v_mfma_f32_16x16x32_bf16 v[232:235], a[200:203], a[216:219], v[232:235]
v_cvt_pk_bf16_f32 v82, v212, v213
v_cvt_pk_bf16_f32 v83, v214, v215
v_mfma_f32_16x16x32_bf16 v[232:235], a[196:199], a[168:171], v[232:235]
s_add_u32 s40, s28, 6144
buffer_store_dwordx4 v[80:83], v7, s[16:19], s40 offen sc1
v_mfma_f32_16x16x32_bf16 v[232:235], a[192:195], a[152:155], v[232:235]
s_mov_b64 exec, s[30:31]
ds_write_b128 v7, v[80:83] offset:38912
s_mov_b64 exec, -1
v_mfma_f32_16x16x32_bf16 v[232:235], a[188:191], a[120:123], v[232:235]
ds_read_b64_tr_b16 v[48:49], v20 offset:10240
ds_read_b64_tr_b16 v[50:51], v20 offset:10752
v_mfma_f32_16x16x32_bf16 v[232:235], a[184:187], a[104:107], v[232:235]
ds_read_b64_tr_b16 v[52:53], v20 offset:11264
ds_read_b64_tr_b16 v[54:55], v20 offset:11776
v_mfma_f32_16x16x32_bf16 v[228:231], a[184:187], a[100:103], v[228:231]
ds_read_b64_tr_b16 v[56:57], v20 offset:12288
ds_read_b64_tr_b16 v[58:59], v20 offset:12800
v_mfma_f32_16x16x32_bf16 v[228:231], a[188:191], a[116:119], v[228:231]
ds_read_b64_tr_b16 v[60:61], v20 offset:13312
ds_read_b64_tr_b16 v[62:63], v20 offset:13824
v_mfma_f32_16x16x32_bf16 v[228:231], a[192:195], a[148:151], v[228:231]
ds_read_b64_tr_b16 v[96:97], v20 offset:14336
ds_read_b64_tr_b16 v[98:99], v20 offset:14848
v_mfma_f32_16x16x32_bf16 v[228:231], a[196:199], a[164:167], v[228:231]
ds_read_b64_tr_b16 v[100:101], v20 offset:15360
ds_read_b64_tr_b16 v[102:103], v20 offset:15872
v_mfma_f32_16x16x32_bf16 v[228:231], a[200:203], a[212:215], v[228:231]
v_cvt_pk_bf16_f32 v84, v216, v217
v_cvt_pk_bf16_f32 v85, v218, v219
v_mfma_f32_16x16x32_bf16 v[228:231], a[204:207], a[228:231], v[228:231]
v_cvt_pk_bf16_f32 v86, v220, v221
v_cvt_pk_bf16_f32 v87, v222, v223
v_mfma_f32_16x16x32_bf16 v[224:227], a[204:207], a[224:227], v[224:227]
s_add_u32 s40, s29, 6144
buffer_load_dword v26, v33, s[16:19], s56 offen sc1
v_mfma_f32_16x16x32_bf16 v[224:227], a[200:203], a[208:211], v[224:227]
buffer_store_dwordx4 v[84:87], v7, s[16:19], s40 offen sc1
v_mfma_f32_16x16x32_bf16 v[224:227], a[196:199], a[160:163], v[224:227]
s_mov_b64 exec, s[32:33]
ds_write_b128 v7, v[84:87] offset:38912
s_mov_b64 exec, -1
v_mfma_f32_16x16x32_bf16 v[224:227], a[192:195], a[144:147], v[224:227]
v_mfma_f32_16x16x32_bf16 v[224:227], a[188:191], a[112:115], v[224:227]
v_mfma_f32_16x16x32_bf16 v[224:227], a[184:187], a[96:99], v[224:227]
s_waitcnt lgkmcnt(0)
v_mfma_f32_16x16x32_bf16 v[240:243], v[48:51], a[96:99], v[240:243]
v_mfma_f32_16x16x32_bf16 v[240:243], v[52:55], a[112:115], v[240:243]
v_mfma_f32_16x16x32_bf16 v[240:243], v[56:59], a[144:147], v[240:243]
v_mfma_f32_16x16x32_bf16 v[240:243], v[60:63], a[160:163], v[240:243]
v_mfma_f32_16x16x32_bf16 v[240:243], v[96:99], a[208:211], v[240:243]
v_mfma_f32_16x16x32_bf16 v[240:243], v[100:103], a[224:227], v[240:243]
v_mfma_f32_16x16x32_bf16 v[244:247], v[100:103], a[228:231], v[244:247]
v_cvt_pk_bf16_f32 v88, v224, v225
v_cvt_pk_bf16_f32 v89, v226, v227
v_mfma_f32_16x16x32_bf16 v[244:247], v[96:99], a[212:215], v[244:247]
v_cvt_pk_bf16_f32 v90, v228, v229
v_cvt_pk_bf16_f32 v91, v230, v231
v_mfma_f32_16x16x32_bf16 v[244:247], v[60:63], a[164:167], v[244:247]
s_add_u32 s40, s28, 7168
buffer_store_dwordx4 v[88:91], v7, s[16:19], s40 offen sc1
v_mfma_f32_16x16x32_bf16 v[244:247], v[56:59], a[148:151], v[244:247]
s_mov_b64 exec, s[30:31]
ds_write_b128 v7, v[88:91] offset:39936
s_mov_b64 exec, -1
v_mfma_f32_16x16x32_bf16 v[244:247], v[52:55], a[116:119], v[244:247]
v_cvt_pk_bf16_f32 v92, v232, v233
v_cvt_pk_bf16_f32 v93, v234, v235
v_mfma_f32_16x16x32_bf16 v[244:247], v[48:51], a[100:103], v[244:247]
v_cvt_pk_bf16_f32 v94, v236, v237
v_cvt_pk_bf16_f32 v95, v238, v239
v_mfma_f32_16x16x32_bf16 v[248:251], v[48:51], a[104:107], v[248:251]
s_add_u32 s40, s29, 7168
v_mfma_f32_16x16x32_bf16 v[248:251], v[52:55], a[120:123], v[248:251]
v_mfma_f32_16x16x32_bf16 v[248:251], v[56:59], a[152:155], v[248:251]
v_mfma_f32_16x16x32_bf16 v[248:251], v[60:63], a[168:171], v[248:251]
v_mfma_f32_16x16x32_bf16 v[248:251], v[96:99], a[216:219], v[248:251]
v_mfma_f32_16x16x32_bf16 v[248:251], v[100:103], a[232:235], v[248:251]
buffer_store_dwordx4 v[92:95], v7, s[16:19], s40 offen sc1
v_mfma_f32_16x16x32_bf16 v[252:255], v[100:103], a[236:239], v[252:255]
s_mov_b64 exec, s[32:33]
ds_write_b128 v7, v[92:95] offset:39936
s_mov_b64 exec, -1
v_mfma_f32_16x16x32_bf16 v[252:255], v[96:99], a[220:223], v[252:255]
v_mfma_f32_16x16x32_bf16 v[252:255], v[60:63], a[172:175], v[252:255]
v_mfma_f32_16x16x32_bf16 v[252:255], v[56:59], a[156:159], v[252:255]
v_mfma_f32_16x16x32_bf16 v[252:255], v[52:55], a[124:127], v[252:255]
v_mfma_f32_16x16x32_bf16 v[252:255], v[48:51], a[108:111], v[252:255]
v_cvt_pk_bf16_f32 v64, v240, v241
v_cvt_pk_bf16_f32 v65, v242, v243
v_cvt_pk_bf16_f32 v66, v244, v245
v_cvt_pk_bf16_f32 v67, v246, v247
s_add_u32 s40, s28, 8192
buffer_store_dwordx4 v[64:67], v7, s[16:19], s40 offen sc1
s_mov_b64 exec, s[30:31]
ds_write_b128 v7, v[64:67] offset:40960
s_mov_b64 exec, -1
v_cvt_pk_bf16_f32 v68, v248, v249
v_cvt_pk_bf16_f32 v69, v250, v251
v_cvt_pk_bf16_f32 v70, v252, v253
v_cvt_pk_bf16_f32 v71, v254, v255
s_add_u32 s40, s29, 8192
buffer_store_dwordx4 v[68:71], v7, s[16:19], s40 offen sc1
s_mov_b64 exec, s[32:33]
ds_write_b128 v7, v[68:71] offset:40960
s_mov_b64 exec, -1
v_mov_b32 v20, 0
v_mov_b32 v21, 0
s_waitcnt lgkmcnt(0)
s_barrier
ds_read_b128 a[96:99], v1 offset:32768
ds_read_b128 a[100:103], v1 offset:36864
ds_read_b128 a[104:107], v7 offset:40960
v_mov_b32 v112, 0
v_mov_b32 v113, 0
v_mov_b32 v114, 0
v_mov_b32 v115, 0
v_mov_b32 v116, 0
v_mov_b32 v117, 0
v_mov_b32 v118, 0
v_mov_b32 v119, 0
v_mov_b32 v128, 0
v_mov_b32 v129, 0
v_mov_b32 v130, 0
v_mov_b32 v131, 0
v_mov_b32 v132, 0
v_mov_b32 v133, 0
v_mov_b32 v134, 0
v_mov_b32 v135, 0
v_mov_b32 v144, 0
v_mov_b32 v145, 0
v_mov_b32 v146, 0
v_mov_b32 v147, 0
v_mov_b32 v148, 0
v_mov_b32 v149, 0
v_mov_b32 v150, 0
v_mov_b32 v151, 0
s_waitcnt lgkmcnt(0)
v_mfma_f32_16x16x32_bf16 v[120:123], v[18:21], a[96:99], 0
v_mfma_f32_16x16x32_bf16 v[124:127], v[16:19], a[96:99], 0
v_mfma_f32_16x16x32_bf16 v[136:139], v[18:21], a[100:103], 0
v_mfma_f32_16x16x32_bf16 v[140:143], v[16:19], a[100:103], 0
v_mfma_f32_16x16x32_bf16 v[152:155], v[18:21], a[104:107], 0
v_mfma_f32_16x16x32_bf16 v[156:159], v[16:19], a[104:107], 0
s_waitcnt vmcnt(19)
v_accvgpr_read_b32 v36, a240
v_accvgpr_read_b32 v37, a241
v_accvgpr_read_b32 v38, a242
v_accvgpr_read_b32 v39, a243
v_accvgpr_read_b32 v40, a244
v_accvgpr_read_b32 v41, a245
v_accvgpr_read_b32 v42, a246
v_accvgpr_read_b32 v43, a247
v_accvgpr_read_b32 v44, a248
v_accvgpr_read_b32 v45, a249
v_accvgpr_read_b32 v46, a250
v_accvgpr_read_b32 v47, a251
v_lshlrev_b32 v192, 16, v36
v_and_b32 v193, 0xffff0000, v36
v_lshlrev_b32 v194, 16, v37
v_and_b32 v195, 0xffff0000, v37
v_lshlrev_b32 v196, 16, v38
v_and_b32 v197, 0xffff0000, v38
v_lshlrev_b32 v198, 16, v39
v_and_b32 v199, 0xffff0000, v39
v_lshlrev_b32 v200, 16, v40
v_and_b32 v201, 0xffff0000, v40
v_lshlrev_b32 v202, 16, v41
v_and_b32 v203, 0xffff0000, v41
v_lshlrev_b32 v204, 16, v42
v_and_b32 v205, 0xffff0000, v42
v_lshlrev_b32 v206, 16, v43
v_and_b32 v207, 0xffff0000, v43
v_lshlrev_b32 v208, 16, v44
v_and_b32 v209, 0xffff0000, v44
v_lshlrev_b32 v210, 16, v45
v_and_b32 v211, 0xffff0000, v45
v_lshlrev_b32 v212, 16, v46
v_and_b32 v213, 0xffff0000, v46
v_lshlrev_b32 v214, 16, v47
v_and_b32 v215, 0xffff0000, v47
s_waitcnt vmcnt(0)
buffer_store_dword v34, v32, s[16:19], s6 offen sc1
s_branch M_p3e
M_p3s:
s_waitcnt lgkmcnt(0)
v_mfma_f32_16x16x32_bf16 v[112:115], a[176:179], a[208:211], 0
s_add_u32 s38, s37, 16384
buffer_load_dwordx4 v[80:83], v7, s[16:19], s38 offen offset:0 sc1
v_mfma_f32_16x16x32_bf16 v[128:131], a[180:183], a[208:211], 0
v_accvgpr_read_b32 v96, a64
v_accvgpr_read_b32 v97, a65
v_mfma_f32_16x16x32_bf16 v[144:147], a[184:187], a[208:211], 0
v_accvgpr_read_b32 v98, a66
v_accvgpr_read_b32 v99, a67
v_mfma_f32_16x16x32_bf16 v[160:163], a[188:191], a[208:211], 0
v_accvgpr_read_b32 v100, a80
v_accvgpr_read_b32 v101, a81
v_mfma_f32_16x16x32_bf16 v[176:179], a[192:195], a[208:211], 0
v_accvgpr_read_b32 v102, a82
v_accvgpr_read_b32 v103, a83
v_mfma_f32_16x16x32_bf16 v[192:195], a[196:199], a[208:211], 0
buffer_load_dwordx4 v[84:87], v7, s[16:19], s38 offen offset:1024 sc1
v_mfma_f32_16x16x32_bf16 v[208:211], a[200:203], a[208:211], 0
v_mul_f32 v96, v96, v16
v_mul_f32 v97, v97, v17
v_mfma_f32_16x16x32_bf16 v[224:227], a[204:207], a[208:211], 0
v_mul_f32 v98, v98, v18
v_mul_f32 v99, v99, v19
v_mfma_f32_16x16x32_bf16 v[240:243], a[128:131], a[208:211], 0
v_mul_f32 v100, v100, v16
v_mul_f32 v101, v101, v17
v_mfma_f32_16x16x32_bf16 v[116:119], a[176:179], a[212:215], 0
v_mul_f32 v102, v102, v18
v_mul_f32 v103, v103, v19
v_mfma_f32_16x16x32_bf16 v[132:135], a[180:183], a[212:215], 0
buffer_load_dwordx4 v[88:91], v7, s[16:19], s38 offen offset:2048 sc1
v_mfma_f32_16x16x32_bf16 v[148:151], a[184:187], a[212:215], 0
v_cvt_pk_bf16_f32 v96, v96, v97
v_cvt_pk_bf16_f32 v97, v98, v99
v_mfma_f32_16x16x32_bf16 v[164:167], a[188:191], a[212:215], 0
v_cvt_pk_bf16_f32 v98, v100, v101
v_cvt_pk_bf16_f32 v99, v102, v103
v_mfma_f32_16x16x32_bf16 v[180:183], a[192:195], a[212:215], 0
ds_write2st64_b64 v1, v[96:97], v[98:99] offset1:1
v_accvgpr_read_b32 v104, a68
v_mfma_f32_16x16x32_bf16 v[196:199], a[196:199], a[212:215], 0
ds_read_b64_tr_b16 v[48:49], v6 offset:0
v_accvgpr_read_b32 v105, a69
v_mfma_f32_16x16x32_bf16 v[212:215], a[200:203], a[212:215], 0
buffer_load_dwordx4 v[92:95], v7, s[16:19], s38 offen offset:3072 sc1
v_mfma_f32_16x16x32_bf16 v[228:231], a[204:207], a[212:215], 0
s_xor_b32 s37, s25, 4
ds_read_b64_tr_b16 a[132:133], v8 offset:8192
ds_read_b64_tr_b16 a[134:135], v8 offset:12288
v_mfma_f32_16x16x32_bf16 v[244:247], a[128:131], a[212:215], 0
s_mul_i32 s37, s37, 65536
ds_read_b64_tr_b16 a[136:137], v9 offset:8192
ds_read_b64_tr_b16 a[138:139], v9 offset:12288
v_mfma_f32_16x16x32_bf16 v[120:123], a[176:179], a[216:219], 0
s_add_u32 s37, s37, s48
ds_read_b64_tr_b16 a[140:141], v10 offset:8192
ds_read_b64_tr_b16 a[142:143], v10 offset:12288
v_mfma_f32_16x16x32_bf16 v[136:139], a[180:183], a[216:219], 0
ds_read_b64_tr_b16 a[144:145], v11 offset:8192
ds_read_b64_tr_b16 a[146:147], v11 offset:12288
v_mfma_f32_16x16x32_bf16 v[152:155], a[184:187], a[216:219], 0
buffer_load_dwordx4 a[0:3], v7, s[16:19], s37 offen offset:0 sc1
v_mfma_f32_16x16x32_bf16 v[168:171], a[188:191], a[216:219], 0
ds_read_b64_tr_b16 a[148:149], v12 offset:8192
ds_read_b64_tr_b16 a[150:151], v12 offset:12288
v_mfma_f32_16x16x32_bf16 v[184:187], a[192:195], a[216:219], 0
ds_read_b64_tr_b16 a[152:153], v13 offset:8192
ds_read_b64_tr_b16 a[154:155], v13 offset:12288
v_mfma_f32_16x16x32_bf16 v[200:203], a[196:199], a[216:219], 0
ds_read_b64_tr_b16 a[156:157], v14 offset:8192
ds_read_b64_tr_b16 a[158:159], v14 offset:12288
v_mfma_f32_16x16x32_bf16 v[216:219], a[200:203], a[216:219], 0
ds_read_b64_tr_b16 a[160:161], v15 offset:8192
ds_read_b64_tr_b16 a[162:163], v15 offset:12288
v_mfma_f32_16x16x32_bf16 v[232:235], a[204:207], a[216:219], 0
buffer_load_dwordx4 a[4:7], v7, s[16:19], s37 offen offset:1024 sc1
v_mfma_f32_16x16x32_bf16 v[248:251], a[128:131], a[216:219], 0
ds_read_b64_tr_b16 a[164:165], v20 offset:1024
ds_read_b64_tr_b16 a[166:167], v20 offset:1536
v_mfma_f32_16x16x32_bf16 v[124:127], a[176:179], a[220:223], 0
ds_read_b64_tr_b16 v[50:51], v6 offset:512
v_accvgpr_read_b32 v106, a70
v_mfma_f32_16x16x32_bf16 v[140:143], a[180:183], a[220:223], 0
v_accvgpr_read_b32 v107, a71
v_accvgpr_read_b32 v108, a84
v_mfma_f32_16x16x32_bf16 v[156:159], a[184:187], a[220:223], 0
v_accvgpr_read_b32 v109, a85
v_accvgpr_read_b32 v110, a86
v_mfma_f32_16x16x32_bf16 v[172:175], a[188:191], a[220:223], 0
buffer_load_dwordx4 a[8:11], v7, s[16:19], s37 offen offset:2048 sc1
v_mfma_f32_16x16x32_bf16 v[188:191], a[192:195], a[220:223], 0
v_accvgpr_read_b32 v111, a87
v_mul_f32 v104, v104, v36
v_mfma_f32_16x16x32_bf16 v[204:207], a[196:199], a[220:223], 0
v_mul_f32 v105, v105, v37
v_mul_f32 v106, v106, v38
v_mfma_f32_16x16x32_bf16 v[220:223], a[200:203], a[220:223], 0
s_waitcnt lgkmcnt(0)
v_mul_f32 v107, v107, v39
v_mul_f32 v108, v108, v36
v_mfma_f32_16x16x32_bf16 v[236:239], a[204:207], a[220:223], 0
s_add_u32 s40, s53, 32768
v_mul_f32 v109, v109, v37
v_mul_f32 v110, v110, v38
v_mfma_f32_16x16x32_bf16 v[252:255], a[128:131], a[220:223], 0
s_waitcnt lgkmcnt(1)
buffer_store_dwordx4 v[48:51], v7, s[16:19], s40 offen offset:0 sc1
v_mfma_f32_16x16x32_bf16 v[112:115], a[132:135], a[224:227], v[112:115]
s_waitcnt vmcnt(8)
v_mul_f32 v111, v111, v39
v_cvt_pk_bf16_f32 v104, v104, v105
v_mfma_f32_16x16x32_bf16 v[128:131], a[136:139], a[224:227], v[128:131]
v_cvt_pk_bf16_f32 v105, v106, v107
v_cvt_pk_bf16_f32 v106, v108, v109
v_mfma_f32_16x16x32_bf16 v[144:147], a[140:143], a[224:227], v[144:147]
v_cvt_pk_bf16_f32 v107, v110, v111
v_accvgpr_read_b32 v96, a72
v_mfma_f32_16x16x32_bf16 v[160:163], a[144:147], a[224:227], v[160:163]
buffer_store_dword v27, v32, s[16:19], s4 offen sc1
v_mfma_f32_16x16x32_bf16 v[176:179], a[148:151], a[224:227], v[176:179]
ds_write2st64_b64 v1, v[104:105], v[106:107] offset1:1
ds_read_b64_tr_b16 v[52:53], v6 offset:0
v_mfma_f32_16x16x32_bf16 v[192:195], a[152:155], a[224:227], v[192:195]
ds_read_b64_tr_b16 v[54:55], v6 offset:512
v_accvgpr_read_b32 v97, a73
v_mfma_f32_16x16x32_bf16 v[208:211], a[156:159], a[224:227], v[208:211]
v_accvgpr_read_b32 v98, a74
v_accvgpr_read_b32 v99, a75
v_mfma_f32_16x16x32_bf16 v[224:227], a[160:163], a[224:227], v[224:227]
v_accvgpr_read_b32 v100, a88
v_accvgpr_read_b32 v101, a89
v_mfma_f32_16x16x32_bf16 v[240:243], a[164:167], a[224:227], v[240:243]
v_accvgpr_read_b32 v102, a90
v_accvgpr_read_b32 v103, a91
v_mfma_f32_16x16x32_bf16 v[116:119], a[132:135], a[228:231], v[116:119]
buffer_load_dwordx4 a[12:15], v7, s[16:19], s37 offen offset:3072 sc1
v_mfma_f32_16x16x32_bf16 v[132:135], a[136:139], a[228:231], v[132:135]
s_add_u32 s38, s37, 16384
v_mul_f32 v96, v96, v2
v_mul_f32 v97, v97, v3
v_mfma_f32_16x16x32_bf16 v[148:151], a[140:143], a[228:231], v[148:151]
s_waitcnt lgkmcnt(0)
v_mul_f32 v98, v98, v4
v_mul_f32 v99, v99, v5
v_mfma_f32_16x16x32_bf16 v[164:167], a[144:147], a[228:231], v[164:167]
v_mul_f32 v100, v100, v2
v_mul_f32 v101, v101, v3
v_mfma_f32_16x16x32_bf16 v[180:183], a[148:151], a[228:231], v[180:183]
v_mul_f32 v102, v102, v4
v_mul_f32 v103, v103, v5
v_mfma_f32_16x16x32_bf16 v[196:199], a[152:155], a[228:231], v[196:199]
buffer_load_dwordx4 a[16:19], v7, s[16:19], s38 offen offset:0 sc1
v_mfma_f32_16x16x32_bf16 v[212:215], a[156:159], a[228:231], v[212:215]
v_cvt_pk_bf16_f32 v96, v96, v97
v_cvt_pk_bf16_f32 v97, v98, v99
v_mfma_f32_16x16x32_bf16 v[228:231], a[160:163], a[228:231], v[228:231]
s_waitcnt vmcnt(23) lgkmcnt(0)
s_barrier
ds_read_b64_tr_b16 a[168:169], v8 offset:16384
v_mfma_f32_16x16x32_bf16 v[244:247], a[164:167], a[228:231], v[244:247]
s_xor_b32 s36, s25, 7
ds_read_b64_tr_b16 a[170:171], v8 offset:20480
ds_read_b64_tr_b16 a[172:173], v9 offset:16384
v_mfma_f32_16x16x32_bf16 v[120:123], a[132:135], a[232:235], v[120:123]
s_mul_i32 s36, s36, 147456
ds_read_b64_tr_b16 a[174:175], v9 offset:20480
ds_read_b64_tr_b16 a[176:177], v10 offset:16384
v_mfma_f32_16x16x32_bf16 v[136:139], a[136:139], a[232:235], v[136:139]
s_add_u32 m0, s24, 65536
buffer_load_dwordx4 a[20:23], v7, s[16:19], s38 offen offset:1024 sc1
v_mfma_f32_16x16x32_bf16 v[152:155], a[140:143], a[232:235], v[152:155]
ds_read_b64_tr_b16 a[178:179], v10 offset:20480
ds_read_b64_tr_b16 a[180:181], v11 offset:16384
v_mfma_f32_16x16x32_bf16 v[168:171], a[144:147], a[232:235], v[168:171]
ds_read_b64_tr_b16 a[182:183], v11 offset:20480
ds_read_b64_tr_b16 a[184:185], v12 offset:16384
v_mfma_f32_16x16x32_bf16 v[184:187], a[148:151], a[232:235], v[184:187]
buffer_load_dwordx4 a[24:27], v7, s[16:19], s38 offen offset:2048 sc1
v_mfma_f32_16x16x32_bf16 v[200:203], a[152:155], a[232:235], v[200:203]
ds_read_b64_tr_b16 a[186:187], v12 offset:20480
ds_read_b64_tr_b16 a[188:189], v13 offset:16384
v_mfma_f32_16x16x32_bf16 v[216:219], a[156:159], a[232:235], v[216:219]
ds_read_b64_tr_b16 a[190:191], v13 offset:20480
ds_read_b64_tr_b16 a[192:193], v14 offset:16384
v_mfma_f32_16x16x32_bf16 v[232:235], a[160:163], a[232:235], v[232:235]
buffer_load_dwordx4 a[28:31], v7, s[16:19], s38 offen offset:3072 sc1
v_mfma_f32_16x16x32_bf16 v[248:251], a[164:167], a[232:235], v[248:251]
s_xor_b32 s37, s25, 5
ds_read_b64_tr_b16 a[194:195], v14 offset:20480
ds_read_b64_tr_b16 a[196:197], v15 offset:16384
v_mfma_f32_16x16x32_bf16 v[124:127], a[132:135], a[236:239], v[124:127]
s_mul_i32 s37, s37, 65536
ds_read_b64_tr_b16 a[198:199], v15 offset:20480
ds_read_b64_tr_b16 a[200:201], v20 offset:2048
v_mfma_f32_16x16x32_bf16 v[140:143], a[136:139], a[236:239], v[140:143]
s_add_u32 s37, s37, s48
ds_read_b64_tr_b16 a[202:203], v20 offset:2560
v_cvt_pk_bf16_f32 v98, v100, v101
v_mfma_f32_16x16x32_bf16 v[156:159], a[140:143], a[236:239], v[156:159]
v_cvt_pk_bf16_f32 v99, v102, v103
v_accvgpr_read_b32 v104, a76
v_mfma_f32_16x16x32_bf16 v[172:175], a[144:147], a[236:239], v[172:175]
ds_write2st64_b64 v1, v[96:97], v[98:99] offset1:1
v_accvgpr_read_b32 v105, a77
v_mfma_f32_16x16x32_bf16 v[188:191], a[148:151], a[236:239], v[188:191]
ds_read_b64_tr_b16 v[56:57], v6 offset:0
ds_read_b64_tr_b16 v[58:59], v6 offset:512
v_mfma_f32_16x16x32_bf16 v[204:207], a[152:155], a[236:239], v[204:207]
v_accvgpr_read_b32 v106, a78
v_accvgpr_read_b32 v107, a79
v_mfma_f32_16x16x32_bf16 v[220:223], a[156:159], a[236:239], v[220:223]
v_accvgpr_read_b32 v108, a92
v_accvgpr_read_b32 v109, a93
v_mfma_f32_16x16x32_bf16 v[236:239], a[160:163], a[236:239], v[236:239]
buffer_store_dwordx4 v[52:55], v7, s[16:19], s40 offen offset:1024 sc1
v_mfma_f32_16x16x32_bf16 v[252:255], a[164:167], a[236:239], v[252:255]
s_waitcnt lgkmcnt(3) vmcnt(35)
v_accvgpr_read_b32 v110, a94
v_accvgpr_read_b32 v111, a95
v_mfma_f32_16x16x32_bf16 v[112:115], a[168:171], a[240:243], v[112:115]
v_mul_f32 v104, v104, v28
v_mul_f32 v105, v105, v29
v_mfma_f32_16x16x32_bf16 v[128:131], a[172:175], a[240:243], v[128:131]
s_waitcnt lgkmcnt(0)
v_mul_f32 v106, v106, v30
v_mul_f32 v107, v107, v31
v_mfma_f32_16x16x32_bf16 v[144:147], a[176:179], a[240:243], v[144:147]
v_mul_f32 v108, v108, v28
v_mul_f32 v109, v109, v29
v_mfma_f32_16x16x32_bf16 v[160:163], a[180:183], a[240:243], v[160:163]
v_mul_f32 v110, v110, v30
v_mul_f32 v111, v111, v31
v_mfma_f32_16x16x32_bf16 v[176:179], a[184:187], a[240:243], v[176:179]
v_cvt_pk_bf16_f32 v104, v104, v105
v_cvt_pk_bf16_f32 v105, v106, v107
v_mfma_f32_16x16x32_bf16 v[192:195], a[188:191], a[240:243], v[192:195]
v_cvt_pk_bf16_f32 v106, v108, v109
v_cvt_pk_bf16_f32 v107, v110, v111
v_mfma_f32_16x16x32_bf16 v[208:211], a[192:195], a[240:243], v[208:211]
ds_write2st64_b64 v1, v[104:105], v[106:107] offset1:1
v_accvgpr_read_b32 v96, a96
v_mfma_f32_16x16x32_bf16 v[224:227], a[196:199], a[240:243], v[224:227]
ds_read_b64_tr_b16 v[60:61], v6 offset:0
v_accvgpr_read_b32 v97, a97
v_mfma_f32_16x16x32_bf16 v[240:243], a[200:203], a[240:243], v[240:243]
buffer_store_dwordx4 v[56:59], v7, s[16:19], s40 offen offset:2048 sc1
v_mfma_f32_16x16x32_bf16 v[116:119], a[168:171], a[244:247], v[116:119]
ds_read_b64_tr_b16 v[62:63], v6 offset:512
v_accvgpr_read_b32 v98, a98
v_mfma_f32_16x16x32_bf16 v[132:135], a[172:175], a[244:247], v[132:135]
v_accvgpr_read_b32 v99, a99
v_accvgpr_read_b32 v100, a112
v_mfma_f32_16x16x32_bf16 v[148:151], a[176:179], a[244:247], v[148:151]
v_accvgpr_read_b32 v101, a113
v_accvgpr_read_b32 v102, a114
v_mfma_f32_16x16x32_bf16 v[164:167], a[180:183], a[244:247], v[164:167]
v_accvgpr_read_b32 v103, a115
v_mul_f32 v96, v96, v16
v_mfma_f32_16x16x32_bf16 v[180:183], a[184:187], a[244:247], v[180:183]
v_mul_f32 v97, v97, v17
v_mul_f32 v98, v98, v18
v_mfma_f32_16x16x32_bf16 v[196:199], a[188:191], a[244:247], v[196:199]
v_mul_f32 v99, v99, v19
v_mul_f32 v100, v100, v16
v_mfma_f32_16x16x32_bf16 v[212:215], a[192:195], a[244:247], v[212:215]
s_waitcnt lgkmcnt(0)
v_mul_f32 v101, v101, v17
v_mul_f32 v102, v102, v18
v_mfma_f32_16x16x32_bf16 v[228:231], a[196:199], a[244:247], v[228:231]
ds_read_b64_tr_b16 a[204:205], v8 offset:24576
ds_read_b64_tr_b16 a[206:207], v8 offset:28672
v_mfma_f32_16x16x32_bf16 v[244:247], a[200:203], a[244:247], v[244:247]
ds_read_b64_tr_b16 a[128:129], v9 offset:24576
ds_read_b64_tr_b16 a[130:131], v9 offset:28672
v_mfma_f32_16x16x32_bf16 v[120:123], a[168:171], a[248:251], v[120:123]
buffer_load_dwordx4 a[32:35], v7, s[16:19], s37 offen offset:0 sc1
v_mfma_f32_16x16x32_bf16 v[136:139], a[172:175], a[248:251], v[136:139]
ds_read_b64_tr_b16 a[132:133], v10 offset:24576
ds_read_b64_tr_b16 a[134:135], v10 offset:28672
v_mfma_f32_16x16x32_bf16 v[152:155], a[176:179], a[248:251], v[152:155]
ds_read_b64_tr_b16 a[136:137], v11 offset:24576
ds_read_b64_tr_b16 a[138:139], v11 offset:28672
v_mfma_f32_16x16x32_bf16 v[168:171], a[180:183], a[248:251], v[168:171]
ds_read_b64_tr_b16 a[140:141], v12 offset:24576
ds_read_b64_tr_b16 a[142:143], v12 offset:28672
v_mfma_f32_16x16x32_bf16 v[184:187], a[184:187], a[248:251], v[184:187]
ds_read_b64_tr_b16 a[144:145], v13 offset:24576
ds_read_b64_tr_b16 a[146:147], v13 offset:28672
v_mfma_f32_16x16x32_bf16 v[200:203], a[188:191], a[248:251], v[200:203]
buffer_load_dwordx4 a[36:39], v7, s[16:19], s37 offen offset:1024 sc1
v_mfma_f32_16x16x32_bf16 v[216:219], a[192:195], a[248:251], v[216:219]
ds_read_b64_tr_b16 a[148:149], v14 offset:24576
ds_read_b64_tr_b16 a[150:151], v14 offset:28672
v_mfma_f32_16x16x32_bf16 v[232:235], a[196:199], a[248:251], v[232:235]
ds_read_b64_tr_b16 a[152:153], v15 offset:24576
ds_read_b64_tr_b16 a[154:155], v15 offset:28672
v_mfma_f32_16x16x32_bf16 v[248:251], a[200:203], a[248:251], v[248:251]
ds_read_b64_tr_b16 a[156:157], v20 offset:3072
ds_read_b64_tr_b16 a[158:159], v20 offset:3584
v_mfma_f32_16x16x32_bf16 v[124:127], a[168:171], a[252:255], v[124:127]
v_mul_f32 v103, v103, v19
v_cvt_pk_bf16_f32 v96, v96, v97
v_mfma_f32_16x16x32_bf16 v[140:143], a[172:175], a[252:255], v[140:143]
buffer_load_dwordx4 a[40:43], v7, s[16:19], s37 offen offset:2048 sc1
v_mfma_f32_16x16x32_bf16 v[156:159], a[176:179], a[252:255], v[156:159]
v_cvt_pk_bf16_f32 v97, v98, v99
v_cvt_pk_bf16_f32 v98, v100, v101
v_mfma_f32_16x16x32_bf16 v[172:175], a[180:183], a[252:255], v[172:175]
v_cvt_pk_bf16_f32 v99, v102, v103
v_accvgpr_read_b32 v104, a100
v_mfma_f32_16x16x32_bf16 v[188:191], a[184:187], a[252:255], v[188:191]
ds_write2st64_b64 v1, v[96:97], v[98:99] offset1:1
ds_read_b64_tr_b16 v[64:65], v6 offset:0
v_mfma_f32_16x16x32_bf16 v[204:207], a[188:191], a[252:255], v[204:207]
ds_read_b64_tr_b16 v[66:67], v6 offset:512
v_accvgpr_read_b32 v105, a101
v_mfma_f32_16x16x32_bf16 v[220:223], a[192:195], a[252:255], v[220:223]
buffer_load_dwordx4 a[44:47], v7, s[16:19], s37 offen offset:3072 sc1
v_mfma_f32_16x16x32_bf16 v[236:239], a[196:199], a[252:255], v[236:239]
s_add_u32 s38, s37, 16384
v_accvgpr_read_b32 v106, a102
v_accvgpr_read_b32 v107, a103
v_mfma_f32_16x16x32_bf16 v[252:255], a[200:203], a[252:255], v[252:255]
s_waitcnt lgkmcnt(3) vmcnt(16)
v_accvgpr_read_b32 v108, a116
v_accvgpr_read_b32 v109, a117
v_mfma_f32_16x16x32_bf16 v[112:115], a[204:207], v[80:83], v[112:115]
v_accvgpr_read_b32 v110, a118
v_accvgpr_read_b32 v111, a119
v_mfma_f32_16x16x32_bf16 v[128:131], a[128:131], v[80:83], v[128:131]
v_mul_f32 v104, v104, v36
v_mul_f32 v105, v105, v37
v_mfma_f32_16x16x32_bf16 v[144:147], a[132:135], v[80:83], v[144:147]
s_waitcnt lgkmcnt(0)
buffer_load_dwordx4 a[48:51], v7, s[16:19], s38 offen offset:0 sc1
v_mfma_f32_16x16x32_bf16 v[160:163], a[136:139], v[80:83], v[160:163]
v_mul_f32 v106, v106, v38
v_mul_f32 v107, v107, v39
v_mfma_f32_16x16x32_bf16 v[176:179], a[140:143], v[80:83], v[176:179]
v_mul_f32 v108, v108, v36
v_mul_f32 v109, v109, v37
v_mfma_f32_16x16x32_bf16 v[192:195], a[144:147], v[80:83], v[192:195]
v_mul_f32 v110, v110, v38
v_mul_f32 v111, v111, v39
v_mfma_f32_16x16x32_bf16 v[208:211], a[148:151], v[80:83], v[208:211]
v_cvt_pk_bf16_f32 v104, v104, v105
v_cvt_pk_bf16_f32 v105, v106, v107
v_mfma_f32_16x16x32_bf16 v[224:227], a[152:155], v[80:83], v[224:227]
buffer_load_dwordx4 a[52:55], v7, s[16:19], s38 offen offset:1024 sc1
v_mfma_f32_16x16x32_bf16 v[240:243], a[156:159], v[80:83], v[240:243]
v_cvt_pk_bf16_f32 v106, v108, v109
v_cvt_pk_bf16_f32 v107, v110, v111
v_mfma_f32_16x16x32_bf16 v[116:119], a[204:207], v[84:87], v[116:119]
ds_write2st64_b64 v1, v[104:105], v[106:107] offset1:1
v_accvgpr_read_b32 v96, a104
v_mfma_f32_16x16x32_bf16 v[132:135], a[128:131], v[84:87], v[132:135]
ds_read_b64_tr_b16 v[68:69], v6 offset:0
v_accvgpr_read_b32 v97, a105
v_mfma_f32_16x16x32_bf16 v[148:151], a[132:135], v[84:87], v[148:151]
ds_read_b64_tr_b16 v[70:71], v6 offset:512
v_accvgpr_read_b32 v98, a106
v_mfma_f32_16x16x32_bf16 v[164:167], a[136:139], v[84:87], v[164:167]
buffer_load_dwordx4 a[56:59], v7, s[16:19], s38 offen offset:2048 sc1
v_mfma_f32_16x16x32_bf16 v[180:183], a[140:143], v[84:87], v[180:183]
v_accvgpr_read_b32 v99, a107
v_accvgpr_read_b32 v100, a120
v_mfma_f32_16x16x32_bf16 v[196:199], a[144:147], v[84:87], v[196:199]
v_accvgpr_read_b32 v101, a121
v_accvgpr_read_b32 v102, a122
v_mfma_f32_16x16x32_bf16 v[212:215], a[148:151], v[84:87], v[212:215]
v_accvgpr_read_b32 v103, a123
v_mul_f32 v96, v96, v2
v_mfma_f32_16x16x32_bf16 v[228:231], a[152:155], v[84:87], v[228:231]
v_mul_f32 v97, v97, v3
v_mul_f32 v98, v98, v4
v_mfma_f32_16x16x32_bf16 v[244:247], a[156:159], v[84:87], v[244:247]
s_waitcnt lgkmcnt(0)
buffer_store_dwordx4 v[60:63], v7, s[16:19], s40 offen offset:3072 sc1
v_mfma_f32_16x16x32_bf16 v[120:123], a[204:207], v[88:91], v[120:123]
s_add_u32 s40, s53, 49152
v_mul_f32 v99, v99, v5
v_mul_f32 v100, v100, v2
v_mfma_f32_16x16x32_bf16 v[136:139], a[128:131], v[88:91], v[136:139]
v_mul_f32 v101, v101, v3
v_mul_f32 v102, v102, v4
v_mfma_f32_16x16x32_bf16 v[152:155], a[132:135], v[88:91], v[152:155]
v_mul_f32 v103, v103, v5
v_cvt_pk_bf16_f32 v96, v96, v97
v_mfma_f32_16x16x32_bf16 v[168:171], a[136:139], v[88:91], v[168:171]
v_cvt_pk_bf16_f32 v97, v98, v99
v_cvt_pk_bf16_f32 v98, v100, v101
v_mfma_f32_16x16x32_bf16 v[184:187], a[140:143], v[88:91], v[184:187]
v_cvt_pk_bf16_f32 v99, v102, v103
v_accvgpr_read_b32 v104, a108
v_mfma_f32_16x16x32_bf16 v[200:203], a[144:147], v[88:91], v[200:203]
s_waitcnt vmcnt(60) lgkmcnt(0)
s_barrier
ds_read_b64_tr_b16 a[176:177], v8 offset:32768
v_mfma_f32_16x16x32_bf16 v[216:219], a[148:151], v[88:91], v[216:219]
ds_read_b64_tr_b16 a[178:179], v8 offset:36864
ds_read_b64_tr_b16 a[180:181], v8 offset:40960
v_mfma_f32_16x16x32_bf16 v[232:235], a[152:155], v[88:91], v[232:235]
buffer_load_dwordx4 a[60:63], v7, s[16:19], s38 offen offset:3072 sc1
v_mfma_f32_16x16x32_bf16 v[248:251], a[156:159], v[88:91], v[248:251]
s_xor_b32 s37, s25, 6
s_mul_i32 s37, s37, 65536
ds_read_b64_tr_b16 a[182:183], v8 offset:45056
v_mfma_f32_16x16x32_bf16 v[124:127], a[204:207], v[92:95], v[124:127]
s_add_u32 s37, s37, s48
ds_write2st64_b64 v1, v[96:97], v[98:99] offset1:1
v_accvgpr_read_b32 v105, a109
v_mfma_f32_16x16x32_bf16 v[140:143], a[128:131], v[92:95], v[140:143]
ds_read_b64_tr_b16 v[72:73], v6 offset:0
ds_read_b64_tr_b16 v[74:75], v6 offset:512
v_mfma_f32_16x16x32_bf16 v[156:159], a[132:135], v[92:95], v[156:159]
v_accvgpr_read_b32 v106, a110
v_accvgpr_read_b32 v107, a111
v_mfma_f32_16x16x32_bf16 v[172:175], a[136:139], v[92:95], v[172:175]
v_accvgpr_read_b32 v108, a124
v_accvgpr_read_b32 v109, a125
v_mfma_f32_16x16x32_bf16 v[188:191], a[140:143], v[92:95], v[188:191]
ds_read_b64_tr_b16 a[184:185], v9 offset:32768
ds_read_b64_tr_b16 a[186:187], v9 offset:36864
v_mfma_f32_16x16x32_bf16 v[204:207], a[144:147], v[92:95], v[204:207]
buffer_store_dwordx4 v[64:67], v7, s[16:19], s40 offen offset:0 sc1
v_mfma_f32_16x16x32_bf16 v[220:223], a[148:151], v[92:95], v[220:223]
ds_read_b64_tr_b16 a[188:189], v9 offset:40960
ds_read_b64_tr_b16 a[190:191], v9 offset:45056
v_mfma_f32_16x16x32_bf16 v[236:239], a[152:155], v[92:95], v[236:239]
s_waitcnt lgkmcnt(4)
v_accvgpr_read_b32 v110, a126
v_accvgpr_read_b32 v111, a127
v_mfma_f32_16x16x32_bf16 v[252:255], a[156:159], v[92:95], v[252:255]
s_waitcnt lgkmcnt(7) vmcnt(12)
v_mul_f32 v104, v104, v28
v_mul_f32 v105, v105, v29
v_mfma_f32_16x16x32_bf16 v[112:115], a[176:179], a[0:3], v[112:115]
v_mul_f32 v106, v106, v30
v_mul_f32 v107, v107, v31
v_mfma_f32_16x16x32_bf16 v[112:115], a[180:183], a[16:19], v[112:115]
v_mul_f32 v108, v108, v28
v_mul_f32 v109, v109, v29
v_mfma_f32_16x16x32_bf16 v[116:119], a[180:183], a[20:23], v[116:119]
v_mul_f32 v110, v110, v30
v_mul_f32 v111, v111, v31
v_mfma_f32_16x16x32_bf16 v[116:119], a[176:179], a[4:7], v[116:119]
ds_read_b64_tr_b16 a[192:193], v10 offset:32768
ds_read_b64_tr_b16 a[194:195], v10 offset:36864
v_mfma_f32_16x16x32_bf16 v[120:123], a[176:179], a[8:11], v[120:123]
ds_read_b64_tr_b16 a[196:197], v10 offset:40960
ds_read_b64_tr_b16 a[198:199], v10 offset:45056
v_mfma_f32_16x16x32_bf16 v[120:123], a[180:183], a[24:27], v[120:123]
v_cvt_pk_bf16_f32 v104, v104, v105
v_cvt_pk_bf16_f32 v105, v106, v107
v_mfma_f32_16x16x32_bf16 v[124:127], a[180:183], a[28:31], v[124:127]
buffer_load_dwordx4 a[208:211], v7, s[16:19], s37 offen offset:0 sc1
v_mfma_f32_16x16x32_bf16 v[124:127], a[176:179], a[12:15], v[124:127]
s_waitcnt lgkmcnt(4)
v_cvt_pk_bf16_f32 v106, v108, v109
v_cvt_pk_bf16_f32 v107, v110, v111
v_mfma_f32_16x16x32_bf16 v[140:143], a[184:187], a[12:15], v[140:143]
ds_write2st64_b64 v1, v[104:105], v[106:107] offset1:1
ds_read_b64_tr_b16 v[76:77], v6 offset:0
v_mfma_f32_16x16x32_bf16 v[140:143], a[188:191], a[28:31], v[140:143]
ds_read_b64_tr_b16 v[78:79], v6 offset:512
v_mfma_f32_16x16x32_bf16 v[136:139], a[188:191], a[24:27], v[136:139]
v_mfma_f32_16x16x32_bf16 v[136:139], a[184:187], a[8:11], v[136:139]
buffer_load_dwordx4 a[212:215], v7, s[16:19], s37 offen offset:1024 sc1
v_mfma_f32_16x16x32_bf16 v[132:135], a[184:187], a[4:7], v[132:135]
ds_read_b64_tr_b16 a[200:201], v11 offset:32768
ds_read_b64_tr_b16 a[202:203], v11 offset:36864
v_mfma_f32_16x16x32_bf16 v[132:135], a[188:191], a[20:23], v[132:135]
ds_read_b64_tr_b16 a[204:205], v11 offset:40960
ds_read_b64_tr_b16 a[206:207], v11 offset:45056
v_mfma_f32_16x16x32_bf16 v[128:131], a[188:191], a[16:19], v[128:131]
v_mfma_f32_16x16x32_bf16 v[128:131], a[184:187], a[0:3], v[128:131]
s_waitcnt lgkmcnt(7)
s_waitcnt lgkmcnt(4)
v_mfma_f32_16x16x32_bf16 v[144:147], a[192:195], a[0:3], v[144:147]
buffer_load_dwordx4 a[216:219], v7, s[16:19], s37 offen offset:2048 sc1
v_mfma_f32_16x16x32_bf16 v[144:147], a[196:199], a[16:19], v[144:147]
v_mfma_f32_16x16x32_bf16 v[148:151], a[196:199], a[20:23], v[148:151]
v_mfma_f32_16x16x32_bf16 v[148:151], a[192:195], a[4:7], v[148:151]
ds_read_b64_tr_b16 a[176:177], v12 offset:32768
ds_read_b64_tr_b16 a[178:179], v12 offset:36864
v_mfma_f32_16x16x32_bf16 v[152:155], a[192:195], a[8:11], v[152:155]
ds_read_b64_tr_b16 a[180:181], v12 offset:40960
ds_read_b64_tr_b16 a[182:183], v12 offset:45056
v_mfma_f32_16x16x32_bf16 v[152:155], a[196:199], a[24:27], v[152:155]
buffer_store_dwordx4 v[68:71], v7, s[16:19], s40 offen offset:1024 sc1
v_mfma_f32_16x16x32_bf16 v[156:159], a[196:199], a[28:31], v[156:159]
v_mfma_f32_16x16x32_bf16 v[156:159], a[192:195], a[12:15], v[156:159]
s_waitcnt lgkmcnt(4)
v_mfma_f32_16x16x32_bf16 v[172:175], a[200:203], a[12:15], v[172:175]
v_mfma_f32_16x16x32_bf16 v[172:175], a[204:207], a[28:31], v[172:175]
v_mfma_f32_16x16x32_bf16 v[168:171], a[204:207], a[24:27], v[168:171]
v_mfma_f32_16x16x32_bf16 v[168:171], a[200:203], a[8:11], v[168:171]
ds_read_b64_tr_b16 a[184:185], v13 offset:32768
ds_read_b64_tr_b16 a[186:187], v13 offset:36864
v_mfma_f32_16x16x32_bf16 v[164:167], a[200:203], a[4:7], v[164:167]
ds_read_b64_tr_b16 a[188:189], v13 offset:40960
ds_read_b64_tr_b16 a[190:191], v13 offset:45056
v_mfma_f32_16x16x32_bf16 v[164:167], a[204:207], a[20:23], v[164:167]
v_mfma_f32_16x16x32_bf16 v[160:163], a[204:207], a[16:19], v[160:163]
v_mfma_f32_16x16x32_bf16 v[160:163], a[200:203], a[0:3], v[160:163]
s_waitcnt lgkmcnt(4)
buffer_load_dwordx4 a[220:223], v7, s[16:19], s37 offen offset:3072 sc1
v_mfma_f32_16x16x32_bf16 v[176:179], a[176:179], a[0:3], v[176:179]
s_add_u32 s38, s37, 16384
v_mfma_f32_16x16x32_bf16 v[176:179], a[180:183], a[16:19], v[176:179]
v_mfma_f32_16x16x32_bf16 v[180:183], a[180:183], a[20:23], v[180:183]
v_mfma_f32_16x16x32_bf16 v[180:183], a[176:179], a[4:7], v[180:183]
ds_read_b64_tr_b16 a[192:193], v14 offset:32768
ds_read_b64_tr_b16 a[194:195], v14 offset:36864
v_mfma_f32_16x16x32_bf16 v[184:187], a[176:179], a[8:11], v[184:187]
buffer_load_dwordx4 a[224:227], v7, s[16:19], s38 offen offset:0 sc1
v_mfma_f32_16x16x32_bf16 v[184:187], a[180:183], a[24:27], v[184:187]
ds_read_b64_tr_b16 a[196:197], v14 offset:40960
ds_read_b64_tr_b16 a[198:199], v14 offset:45056
v_mfma_f32_16x16x32_bf16 v[188:191], a[180:183], a[28:31], v[188:191]
v_mfma_f32_16x16x32_bf16 v[188:191], a[176:179], a[12:15], v[188:191]
s_waitcnt lgkmcnt(4)
v_mfma_f32_16x16x32_bf16 v[204:207], a[184:187], a[12:15], v[204:207]
v_mfma_f32_16x16x32_bf16 v[204:207], a[188:191], a[28:31], v[204:207]
buffer_load_dwordx4 a[228:231], v7, s[16:19], s38 offen offset:1024 sc1
v_mfma_f32_16x16x32_bf16 v[200:203], a[188:191], a[24:27], v[200:203]
v_mfma_f32_16x16x32_bf16 v[200:203], a[184:187], a[8:11], v[200:203]
ds_read_b64_tr_b16 a[200:201], v15 offset:32768
ds_read_b64_tr_b16 a[202:203], v15 offset:36864
v_mfma_f32_16x16x32_bf16 v[196:199], a[184:187], a[4:7], v[196:199]
ds_read_b64_tr_b16 a[204:205], v15 offset:40960
ds_read_b64_tr_b16 a[206:207], v15 offset:45056
v_mfma_f32_16x16x32_bf16 v[196:199], a[188:191], a[20:23], v[196:199]
v_mfma_f32_16x16x32_bf16 v[192:195], a[188:191], a[16:19], v[192:195]
buffer_load_dwordx4 a[232:235], v7, s[16:19], s38 offen offset:2048 sc1
v_mfma_f32_16x16x32_bf16 v[192:195], a[184:187], a[0:3], v[192:195]
s_waitcnt lgkmcnt(4)
v_mfma_f32_16x16x32_bf16 v[208:211], a[192:195], a[0:3], v[208:211]
v_mfma_f32_16x16x32_bf16 v[208:211], a[196:199], a[16:19], v[208:211]
v_mfma_f32_16x16x32_bf16 v[212:215], a[196:199], a[20:23], v[212:215]
v_mfma_f32_16x16x32_bf16 v[212:215], a[192:195], a[4:7], v[212:215]
buffer_load_dwordx4 a[236:239], v7, s[16:19], s38 offen offset:3072 sc1
v_mfma_f32_16x16x32_bf16 v[216:219], a[192:195], a[8:11], v[216:219]
s_xor_b32 s37, s25, 7
ds_read_b64_tr_b16 a[176:177], v20 offset:16384
ds_read_b64_tr_b16 a[178:179], v20 offset:16896
v_mfma_f32_16x16x32_bf16 v[216:219], a[196:199], a[24:27], v[216:219]
s_mul_i32 s37, s37, 65536
ds_read_b64_tr_b16 a[180:181], v20 offset:17408
ds_read_b64_tr_b16 a[182:183], v20 offset:17920
v_mfma_f32_16x16x32_bf16 v[220:223], a[196:199], a[28:31], v[220:223]
s_add_u32 s37, s37, s48
v_mfma_f32_16x16x32_bf16 v[220:223], a[192:195], a[12:15], v[220:223]
s_waitcnt lgkmcnt(4)
v_mfma_f32_16x16x32_bf16 v[236:239], a[200:203], a[12:15], v[236:239]
buffer_store_dwordx4 v[72:75], v7, s[16:19], s40 offen offset:2048 sc1
v_mfma_f32_16x16x32_bf16 v[236:239], a[204:207], a[28:31], v[236:239]
v_mfma_f32_16x16x32_bf16 v[232:235], a[204:207], a[24:27], v[232:235]
v_mfma_f32_16x16x32_bf16 v[232:235], a[200:203], a[8:11], v[232:235]
s_waitcnt vmcnt(63) lgkmcnt(0)
s_barrier
ds_read_b64_tr_b16 a[184:185], v40 offset:16384
v_mfma_f32_16x16x32_bf16 v[228:231], a[200:203], a[4:7], v[228:231]
ds_read_b64_tr_b16 a[186:187], v40 offset:20480
ds_read_b64_tr_b16 a[188:189], v40 offset:24576
v_mfma_f32_16x16x32_bf16 v[228:231], a[204:207], a[20:23], v[228:231]
ds_read_b64_tr_b16 a[190:191], v40 offset:28672
v_mfma_f32_16x16x32_bf16 v[224:227], a[204:207], a[16:19], v[224:227]
v_mfma_f32_16x16x32_bf16 v[224:227], a[200:203], a[0:3], v[224:227]
s_waitcnt lgkmcnt(4)
v_mfma_f32_16x16x32_bf16 v[240:243], a[176:179], a[0:3], v[240:243]
v_mfma_f32_16x16x32_bf16 v[240:243], a[180:183], a[16:19], v[240:243]
v_mfma_f32_16x16x32_bf16 v[244:247], a[180:183], a[20:23], v[244:247]
buffer_store_dwordx4 v[76:79], v7, s[16:19], s40 offen offset:3072 sc1
v_mfma_f32_16x16x32_bf16 v[244:247], a[176:179], a[4:7], v[244:247]
ds_read_b64_tr_b16 a[192:193], v41 offset:16384
ds_read_b64_tr_b16 a[194:195], v41 offset:20480
v_mfma_f32_16x16x32_bf16 v[248:251], a[176:179], a[8:11], v[248:251]
ds_read_b64_tr_b16 a[196:197], v41 offset:24576
ds_read_b64_tr_b16 a[198:199], v41 offset:28672
v_mfma_f32_16x16x32_bf16 v[248:251], a[180:183], a[24:27], v[248:251]
v_mfma_f32_16x16x32_bf16 v[252:255], a[180:183], a[28:31], v[252:255]
v_mfma_f32_16x16x32_bf16 v[252:255], a[176:179], a[12:15], v[252:255]
s_waitcnt lgkmcnt(4) vmcnt(12)
v_mfma_f32_16x16x32_bf16 v[112:115], a[184:187], a[32:35], v[112:115]
v_mfma_f32_16x16x32_bf16 v[112:115], a[188:191], a[48:51], v[112:115]
v_mfma_f32_16x16x32_bf16 v[116:119], a[188:191], a[52:55], v[116:119]
v_mfma_f32_16x16x32_bf16 v[116:119], a[184:187], a[36:39], v[116:119]
ds_read_b64_tr_b16 a[200:201], v42 offset:16384
ds_read_b64_tr_b16 a[202:203], v42 offset:20480
v_mfma_f32_16x16x32_bf16 v[120:123], a[184:187], a[40:43], v[120:123]
buffer_load_dwordx4 a[144:147], v7, s[16:19], s37 offen offset:0 sc1
v_mfma_f32_16x16x32_bf16 v[120:123], a[188:191], a[56:59], v[120:123]
ds_read_b64_tr_b16 a[204:205], v42 offset:24576
ds_read_b64_tr_b16 a[206:207], v42 offset:28672
v_mfma_f32_16x16x32_bf16 v[124:127], a[188:191], a[60:63], v[124:127]
v_mfma_f32_16x16x32_bf16 v[124:127], a[184:187], a[44:47], v[124:127]
s_waitcnt lgkmcnt(4)
v_mfma_f32_16x16x32_bf16 v[140:143], a[192:195], a[44:47], v[140:143]
v_mfma_f32_16x16x32_bf16 v[140:143], a[196:199], a[60:63], v[140:143]
buffer_load_dwordx4 a[148:151], v7, s[16:19], s37 offen offset:1024 sc1
v_mfma_f32_16x16x32_bf16 v[136:139], a[196:199], a[56:59], v[136:139]
v_mfma_f32_16x16x32_bf16 v[136:139], a[192:195], a[40:43], v[136:139]
ds_read_b64_tr_b16 a[176:177], v43 offset:16384
ds_read_b64_tr_b16 a[178:179], v43 offset:20480
v_mfma_f32_16x16x32_bf16 v[132:135], a[192:195], a[36:39], v[132:135]
ds_read_b64_tr_b16 a[180:181], v43 offset:24576
ds_read_b64_tr_b16 a[182:183], v43 offset:28672
v_mfma_f32_16x16x32_bf16 v[132:135], a[196:199], a[52:55], v[132:135]
v_mfma_f32_16x16x32_bf16 v[128:131], a[196:199], a[48:51], v[128:131]
buffer_load_dwordx4 a[152:155], v7, s[16:19], s37 offen offset:2048 sc1
v_mfma_f32_16x16x32_bf16 v[128:131], a[192:195], a[32:35], v[128:131]
s_waitcnt lgkmcnt(4)
v_mfma_f32_16x16x32_bf16 v[144:147], a[200:203], a[32:35], v[144:147]
v_mfma_f32_16x16x32_bf16 v[144:147], a[204:207], a[48:51], v[144:147]
v_mfma_f32_16x16x32_bf16 v[148:151], a[204:207], a[52:55], v[148:151]
v_mfma_f32_16x16x32_bf16 v[148:151], a[200:203], a[36:39], v[148:151]
buffer_load_dwordx4 a[156:159], v7, s[16:19], s37 offen offset:3072 sc1
v_mfma_f32_16x16x32_bf16 v[152:155], a[200:203], a[40:43], v[152:155]
s_add_u32 s38, s37, 16384
ds_read_b64_tr_b16 a[184:185], v44 offset:16384
ds_read_b64_tr_b16 a[186:187], v44 offset:20480
v_mfma_f32_16x16x32_bf16 v[152:155], a[204:207], a[56:59], v[152:155]
ds_read_b64_tr_b16 a[188:189], v44 offset:24576
ds_read_b64_tr_b16 a[190:191], v44 offset:28672
v_mfma_f32_16x16x32_bf16 v[156:159], a[204:207], a[60:63], v[156:159]
v_mfma_f32_16x16x32_bf16 v[156:159], a[200:203], a[44:47], v[156:159]
s_waitcnt lgkmcnt(4)
v_mfma_f32_16x16x32_bf16 v[172:175], a[176:179], a[44:47], v[172:175]
buffer_load_dwordx4 v21, s[44:47], s36 offen offset:0 lds
v_mfma_f32_16x16x32_bf16 v[172:175], a[180:183], a[60:63], v[172:175]
v_mfma_f32_16x16x32_bf16 v[168:171], a[180:183], a[56:59], v[168:171]
v_mfma_f32_16x16x32_bf16 v[168:171], a[176:179], a[40:43], v[168:171]
ds_read_b64_tr_b16 a[192:193], v45 offset:16384
ds_read_b64_tr_b16 a[194:195], v45 offset:20480
v_mfma_f32_16x16x32_bf16 v[164:167], a[176:179], a[36:39], v[164:167]
ds_read_b64_tr_b16 a[196:197], v45 offset:24576
ds_read_b64_tr_b16 a[198:199], v45 offset:28672
v_mfma_f32_16x16x32_bf16 v[164:167], a[180:183], a[52:55], v[164:167]
buffer_load_dwordx4 a[160:163], v7, s[16:19], s38 offen offset:0 sc1
v_mfma_f32_16x16x32_bf16 v[160:163], a[180:183], a[48:51], v[160:163]
v_mfma_f32_16x16x32_bf16 v[160:163], a[176:179], a[32:35], v[160:163]
s_waitcnt lgkmcnt(4)
v_mfma_f32_16x16x32_bf16 v[176:179], a[184:187], a[32:35], v[176:179]
v_mfma_f32_16x16x32_bf16 v[176:179], a[188:191], a[48:51], v[176:179]
v_mfma_f32_16x16x32_bf16 v[180:183], a[188:191], a[52:55], v[180:183]
buffer_load_dwordx4 v22, s[44:47], s36 offen offset:1024 lds
v_mfma_f32_16x16x32_bf16 v[180:183], a[184:187], a[36:39], v[180:183]
ds_read_b64_tr_b16 a[200:201], v46 offset:16384
ds_read_b64_tr_b16 a[202:203], v46 offset:20480
v_mfma_f32_16x16x32_bf16 v[184:187], a[184:187], a[40:43], v[184:187]
ds_read_b64_tr_b16 a[204:205], v46 offset:24576
ds_read_b64_tr_b16 a[206:207], v46 offset:28672
v_mfma_f32_16x16x32_bf16 v[184:187], a[188:191], a[56:59], v[184:187]
v_mfma_f32_16x16x32_bf16 v[188:191], a[188:191], a[60:63], v[188:191]
v_mfma_f32_16x16x32_bf16 v[188:191], a[184:187], a[44:47], v[188:191]
s_waitcnt lgkmcnt(4)
buffer_load_dwordx4 a[164:167], v7, s[16:19], s38 offen offset:1024 sc1
v_mfma_f32_16x16x32_bf16 v[204:207], a[192:195], a[44:47], v[204:207]
v_mfma_f32_16x16x32_bf16 v[204:207], a[196:199], a[60:63], v[204:207]
v_mfma_f32_16x16x32_bf16 v[200:203], a[196:199], a[56:59], v[200:203]
v_mfma_f32_16x16x32_bf16 v[200:203], a[192:195], a[40:43], v[200:203]
ds_read_b64_tr_b16 a[176:177], v47 offset:16384
ds_read_b64_tr_b16 a[178:179], v47 offset:20480
v_mfma_f32_16x16x32_bf16 v[196:199], a[192:195], a[36:39], v[196:199]
buffer_load_dwordx4 v23, s[44:47], s36 offen offset:2048 lds
v_mfma_f32_16x16x32_bf16 v[196:199], a[196:199], a[52:55], v[196:199]
ds_read_b64_tr_b16 a[180:181], v47 offset:24576
ds_read_b64_tr_b16 a[182:183], v47 offset:28672
v_mfma_f32_16x16x32_bf16 v[192:195], a[196:199], a[48:51], v[192:195]
v_mfma_f32_16x16x32_bf16 v[192:195], a[192:195], a[32:35], v[192:195]
s_waitcnt lgkmcnt(4)
v_mfma_f32_16x16x32_bf16 v[208:211], a[200:203], a[32:35], v[208:211]
v_mfma_f32_16x16x32_bf16 v[208:211], a[204:207], a[48:51], v[208:211]
buffer_load_dwordx4 a[168:171], v7, s[16:19], s38 offen offset:2048 sc1
v_mfma_f32_16x16x32_bf16 v[212:215], a[204:207], a[52:55], v[212:215]
v_mfma_f32_16x16x32_bf16 v[212:215], a[200:203], a[36:39], v[212:215]
ds_read_b64_tr_b16 a[184:185], v20 offset:20480
ds_read_b64_tr_b16 a[186:187], v20 offset:20992
v_mfma_f32_16x16x32_bf16 v[216:219], a[200:203], a[40:43], v[216:219]
ds_read_b64_tr_b16 a[188:189], v20 offset:21504
ds_read_b64_tr_b16 a[190:191], v20 offset:22016
v_mfma_f32_16x16x32_bf16 v[216:219], a[204:207], a[56:59], v[216:219]
v_mfma_f32_16x16x32_bf16 v[220:223], a[204:207], a[60:63], v[220:223]
buffer_load_dwordx4 v24, s[44:47], s36 offen offset:3072 lds
v_mfma_f32_16x16x32_bf16 v[220:223], a[200:203], a[44:47], v[220:223]
s_waitcnt lgkmcnt(4)
s_xor_b32 s36, s25, 4
s_mul_i32 s36, s36, 147456
v_mfma_f32_16x16x32_bf16 v[236:239], a[176:179], a[44:47], v[236:239]
s_add_u32 s36, s36, 73728
s_add_u32 m0, s24, 98304
v_mfma_f32_16x16x32_bf16 v[236:239], a[180:183], a[60:63], v[236:239]
v_mfma_f32_16x16x32_bf16 v[232:235], a[180:183], a[56:59], v[232:235]
v_mfma_f32_16x16x32_bf16 v[232:235], a[176:179], a[40:43], v[232:235]
s_waitcnt vmcnt(56) lgkmcnt(0)
s_barrier
buffer_load_dwordx4 a[172:175], v7, s[16:19], s38 offen offset:3072 sc1
v_mfma_f32_16x16x32_bf16 v[228:231], a[176:179], a[36:39], v[228:231]
s_xor_b32 s37, s25, 4
ds_read_b64_tr_b16 a[192:193], v8 offset:49152
ds_read_b64_tr_b16 a[194:195], v8 offset:53248
v_mfma_f32_16x16x32_bf16 v[228:231], a[180:183], a[52:55], v[228:231]
s_mul_i32 s37, s37, 65536
ds_read_b64_tr_b16 a[196:197], v8 offset:57344
ds_read_b64_tr_b16 a[198:199], v8 offset:61440
v_mfma_f32_16x16x32_bf16 v[224:227], a[180:183], a[48:51], v[224:227]
s_add_u32 s37, s37, s48
s_add_u32 s37, s37, 32768
v_mfma_f32_16x16x32_bf16 v[224:227], a[176:179], a[32:35], v[224:227]
s_waitcnt lgkmcnt(4)
v_mfma_f32_16x16x32_bf16 v[240:243], a[184:187], a[32:35], v[240:243]
s_waitcnt vmcnt(12)
buffer_load_dwordx4 a[64:67], v7, s[16:19], s37 offen offset:0 sc1
v_mfma_f32_16x16x32_bf16 v[240:243], a[188:191], a[48:51], v[240:243]
v_mfma_f32_16x16x32_bf16 v[244:247], a[188:191], a[52:55], v[244:247]
v_mfma_f32_16x16x32_bf16 v[244:247], a[184:187], a[36:39], v[244:247]
buffer_store_dword v34, v32, s[16:19], s4 offen sc1
v_mfma_f32_16x16x32_bf16 v[248:251], a[184:187], a[40:43], v[248:251]
ds_read_b64_tr_b16 a[200:201], v9 offset:49152
ds_read_b64_tr_b16 a[202:203], v9 offset:53248
v_mfma_f32_16x16x32_bf16 v[248:251], a[188:191], a[56:59], v[248:251]
ds_read_b64_tr_b16 a[204:205], v9 offset:57344
ds_read_b64_tr_b16 a[206:207], v9 offset:61440
v_mfma_f32_16x16x32_bf16 v[252:255], a[188:191], a[60:63], v[252:255]
v_mfma_f32_16x16x32_bf16 v[252:255], a[184:187], a[44:47], v[252:255]
s_waitcnt lgkmcnt(4) vmcnt(16)
buffer_load_dwordx4 a[68:71], v7, s[16:19], s37 offen offset:1024 sc1
v_mfma_f32_16x16x32_bf16 v[112:115], a[192:195], a[208:211], v[112:115]
v_mfma_f32_16x16x32_bf16 v[112:115], a[196:199], a[224:227], v[112:115]
v_mfma_f32_16x16x32_bf16 v[116:119], a[196:199], a[228:231], v[116:119]
v_mfma_f32_16x16x32_bf16 v[116:119], a[192:195], a[212:215], v[116:119]
ds_read_b64_tr_b16 a[176:177], v10 offset:49152
ds_read_b64_tr_b16 a[178:179], v10 offset:53248
v_mfma_f32_16x16x32_bf16 v[120:123], a[192:195], a[216:219], v[120:123]
buffer_load_dwordx4 a[72:75], v7, s[16:19], s37 offen offset:2048 sc1
v_mfma_f32_16x16x32_bf16 v[120:123], a[196:199], a[232:235], v[120:123]
ds_read_b64_tr_b16 a[180:181], v10 offset:57344
ds_read_b64_tr_b16 a[182:183], v10 offset:61440
v_mfma_f32_16x16x32_bf16 v[124:127], a[196:199], a[236:239], v[124:127]
v_mfma_f32_16x16x32_bf16 v[124:127], a[192:195], a[220:223], v[124:127]
s_waitcnt lgkmcnt(4)
v_mfma_f32_16x16x32_bf16 v[140:143], a[200:203], a[220:223], v[140:143]
v_mfma_f32_16x16x32_bf16 v[140:143], a[204:207], a[236:239], v[140:143]
buffer_load_dwordx4 a[76:79], v7, s[16:19], s37 offen offset:3072 sc1
v_mfma_f32_16x16x32_bf16 v[136:139], a[204:207], a[232:235], v[136:139]
s_add_u32 s38, s37, 16384
v_mfma_f32_16x16x32_bf16 v[136:139], a[200:203], a[216:219], v[136:139]
ds_read_b64_tr_b16 a[184:185], v11 offset:49152
ds_read_b64_tr_b16 a[186:187], v11 offset:53248
v_mfma_f32_16x16x32_bf16 v[132:135], a[200:203], a[212:215], v[132:135]
ds_read_b64_tr_b16 a[188:189], v11 offset:57344
ds_read_b64_tr_b16 a[190:191], v11 offset:61440
v_mfma_f32_16x16x32_bf16 v[132:135], a[204:207], a[228:231], v[132:135]
v_mfma_f32_16x16x32_bf16 v[128:131], a[204:207], a[224:227], v[128:131]
buffer_load_dwordx4 v21, s[44:47], s36 offen offset:0 lds
v_mfma_f32_16x16x32_bf16 v[128:131], a[200:203], a[208:211], v[128:131]
s_waitcnt lgkmcnt(4)
v_mfma_f32_16x16x32_bf16 v[144:147], a[176:179], a[208:211], v[144:147]
v_mfma_f32_16x16x32_bf16 v[144:147], a[180:183], a[224:227], v[144:147]
v_mfma_f32_16x16x32_bf16 v[148:151], a[180:183], a[228:231], v[148:151]
v_mfma_f32_16x16x32_bf16 v[148:151], a[176:179], a[212:215], v[148:151]
buffer_load_dwordx4 a[80:83], v7, s[16:19], s38 offen offset:0 sc1
v_mfma_f32_16x16x32_bf16 v[152:155], a[176:179], a[216:219], v[152:155]
ds_read_b64_tr_b16 a[192:193], v12 offset:49152
ds_read_b64_tr_b16 a[194:195], v12 offset:53248
v_mfma_f32_16x16x32_bf16 v[152:155], a[180:183], a[232:235], v[152:155]
ds_read_b64_tr_b16 a[196:197], v12 offset:57344
ds_read_b64_tr_b16 a[198:199], v12 offset:61440
v_mfma_f32_16x16x32_bf16 v[156:159], a[180:183], a[236:239], v[156:159]
v_mfma_f32_16x16x32_bf16 v[156:159], a[176:179], a[220:223], v[156:159]
s_waitcnt lgkmcnt(4)
v_mfma_f32_16x16x32_bf16 v[172:175], a[184:187], a[220:223], v[172:175]
buffer_load_dwordx4 v22, s[44:47], s36 offen offset:1024 lds
v_mfma_f32_16x16x32_bf16 v[172:175], a[188:191], a[236:239], v[172:175]
v_mfma_f32_16x16x32_bf16 v[168:171], a[188:191], a[232:235], v[168:171]
v_mfma_f32_16x16x32_bf16 v[168:171], a[184:187], a[216:219], v[168:171]
ds_read_b64_tr_b16 a[200:201], v13 offset:49152
ds_read_b64_tr_b16 a[202:203], v13 offset:53248
v_mfma_f32_16x16x32_bf16 v[164:167], a[184:187], a[212:215], v[164:167]
ds_read_b64_tr_b16 a[204:205], v13 offset:57344
ds_read_b64_tr_b16 a[206:207], v13 offset:61440
v_mfma_f32_16x16x32_bf16 v[164:167], a[188:191], a[228:231], v[164:167]
buffer_load_dwordx4 a[84:87], v7, s[16:19], s38 offen offset:1024 sc1
v_mfma_f32_16x16x32_bf16 v[160:163], a[188:191], a[224:227], v[160:163]
v_mfma_f32_16x16x32_bf16 v[160:163], a[184:187], a[208:211], v[160:163]
s_waitcnt lgkmcnt(4)
v_mfma_f32_16x16x32_bf16 v[176:179], a[192:195], a[208:211], v[176:179]
v_mfma_f32_16x16x32_bf16 v[176:179], a[196:199], a[224:227], v[176:179]
v_mfma_f32_16x16x32_bf16 v[180:183], a[196:199], a[228:231], v[180:183]
buffer_load_dwordx4 v23, s[44:47], s36 offen offset:2048 lds
v_mfma_f32_16x16x32_bf16 v[180:183], a[192:195], a[212:215], v[180:183]
ds_read_b64_tr_b16 a[176:177], v14 offset:49152
ds_read_b64_tr_b16 a[178:179], v14 offset:53248
v_mfma_f32_16x16x32_bf16 v[184:187], a[192:195], a[216:219], v[184:187]
ds_read_b64_tr_b16 a[180:181], v14 offset:57344
ds_read_b64_tr_b16 a[182:183], v14 offset:61440
v_mfma_f32_16x16x32_bf16 v[184:187], a[196:199], a[232:235], v[184:187]
v_mfma_f32_16x16x32_bf16 v[188:191], a[196:199], a[236:239], v[188:191]
v_mfma_f32_16x16x32_bf16 v[188:191], a[192:195], a[220:223], v[188:191]
s_waitcnt lgkmcnt(4)
buffer_load_dwordx4 a[88:91], v7, s[16:19], s38 offen offset:2048 sc1
v_mfma_f32_16x16x32_bf16 v[204:207], a[200:203], a[220:223], v[204:207]
v_mfma_f32_16x16x32_bf16 v[204:207], a[204:207], a[236:239], v[204:207]
v_mfma_f32_16x16x32_bf16 v[200:203], a[204:207], a[232:235], v[200:203]
v_mfma_f32_16x16x32_bf16 v[200:203], a[200:203], a[216:219], v[200:203]
ds_read_b64_tr_b16 a[184:185], v15 offset:49152
ds_read_b64_tr_b16 a[186:187], v15 offset:53248
v_mfma_f32_16x16x32_bf16 v[196:199], a[200:203], a[212:215], v[196:199]
buffer_load_dwordx4 v24, s[44:47], s36 offen offset:3072 lds
v_mfma_f32_16x16x32_bf16 v[196:199], a[204:207], a[228:231], v[196:199]
s_xor_b32 s36, s25, 5
ds_read_b64_tr_b16 a[188:189], v15 offset:57344
ds_read_b64_tr_b16 a[190:191], v15 offset:61440
v_mfma_f32_16x16x32_bf16 v[192:195], a[204:207], a[224:227], v[192:195]
s_mul_i32 s36, s36, 147456
s_add_u32 s36, s36, 73728
s_add_u32 m0, s24, 114688
v_mfma_f32_16x16x32_bf16 v[192:195], a[200:203], a[208:211], v[192:195]
s_waitcnt lgkmcnt(4)
v_mfma_f32_16x16x32_bf16 v[208:211], a[176:179], a[208:211], v[208:211]
v_mfma_f32_16x16x32_bf16 v[208:211], a[180:183], a[224:227], v[208:211]
buffer_load_dwordx4 a[92:95], v7, s[16:19], s38 offen offset:3072 sc1
v_mfma_f32_16x16x32_bf16 v[212:215], a[180:183], a[228:231], v[212:215]
s_xor_b32 s37, s25, 5
s_mul_i32 s37, s37, 65536
s_add_u32 s37, s37, s48
v_mfma_f32_16x16x32_bf16 v[212:215], a[176:179], a[212:215], v[212:215]
s_add_u32 s37, s37, 32768
ds_read_b64_tr_b16 a[192:193], v20 offset:24576
ds_read_b64_tr_b16 a[194:195], v20 offset:25088
v_mfma_f32_16x16x32_bf16 v[216:219], a[176:179], a[216:219], v[216:219]
ds_read_b64_tr_b16 a[196:197], v20 offset:25600
ds_read_b64_tr_b16 a[198:199], v20 offset:26112
v_mfma_f32_16x16x32_bf16 v[216:219], a[180:183], a[232:235], v[216:219]
v_mfma_f32_16x16x32_bf16 v[220:223], a[180:183], a[236:239], v[220:223]
buffer_load_dwordx4 a[240:243], v7, s[16:19], s37 offen offset:0 sc1
v_mfma_f32_16x16x32_bf16 v[220:223], a[176:179], a[220:223], v[220:223]
s_waitcnt lgkmcnt(4)
v_mfma_f32_16x16x32_bf16 v[236:239], a[184:187], a[220:223], v[236:239]
v_mfma_f32_16x16x32_bf16 v[236:239], a[188:191], a[236:239], v[236:239]
v_mfma_f32_16x16x32_bf16 v[232:235], a[188:191], a[232:235], v[232:235]
v_mfma_f32_16x16x32_bf16 v[232:235], a[184:187], a[216:219], v[232:235]
s_waitcnt vmcnt(15) lgkmcnt(0)
s_barrier
buffer_load_dwordx4 a[244:247], v7, s[16:19], s37 offen offset:1024 sc1
v_mfma_f32_16x16x32_bf16 v[228:231], a[184:187], a[212:215], v[228:231]
ds_read_b64_tr_b16 a[200:201], v40 offset:0
ds_read_b64_tr_b16 a[202:203], v40 offset:4096
v_mfma_f32_16x16x32_bf16 v[228:231], a[188:191], a[228:231], v[228:231]
ds_read_b64_tr_b16 a[204:205], v40 offset:8192
ds_read_b64_tr_b16 a[206:207], v40 offset:12288
v_mfma_f32_16x16x32_bf16 v[224:227], a[188:191], a[224:227], v[224:227]
v_mfma_f32_16x16x32_bf16 v[224:227], a[184:187], a[208:211], v[224:227]
s_waitcnt lgkmcnt(4)
v_mfma_f32_16x16x32_bf16 v[240:243], a[192:195], a[208:211], v[240:243]
buffer_load_dwordx4 a[248:251], v7, s[16:19], s37 offen offset:2048 sc1
v_mfma_f32_16x16x32_bf16 v[240:243], a[196:199], a[224:227], v[240:243]
v_mfma_f32_16x16x32_bf16 v[244:247], a[196:199], a[228:231], v[244:247]
v_mfma_f32_16x16x32_bf16 v[244:247], a[192:195], a[212:215], v[244:247]
ds_read_b64_tr_b16 a[176:177], v41 offset:0
ds_read_b64_tr_b16 a[178:179], v41 offset:4096
v_mfma_f32_16x16x32_bf16 v[248:251], a[192:195], a[216:219], v[248:251]
ds_read_b64_tr_b16 a[180:181], v41 offset:8192
ds_read_b64_tr_b16 a[182:183], v41 offset:12288
v_mfma_f32_16x16x32_bf16 v[248:251], a[196:199], a[232:235], v[248:251]
buffer_load_dwordx4 a[252:255], v7, s[16:19], s37 offen offset:3072 sc1
v_mfma_f32_16x16x32_bf16 v[252:255], a[196:199], a[236:239], v[252:255]
s_add_u32 s38, s37, 16384
v_mfma_f32_16x16x32_bf16 v[252:255], a[192:195], a[220:223], v[252:255]
s_waitcnt lgkmcnt(4) vmcnt(17)
v_mfma_f32_16x16x32_bf16 v[112:115], a[200:203], a[144:147], v[112:115]
v_mfma_f32_16x16x32_bf16 v[112:115], a[204:207], a[160:163], v[112:115]
v_mfma_f32_16x16x32_bf16 v[116:119], a[204:207], a[164:167], v[116:119]
buffer_load_dwordx4 v21, s[44:47], s36 offen offset:0 lds
v_mfma_f32_16x16x32_bf16 v[116:119], a[200:203], a[148:151], v[116:119]
ds_read_b64_tr_b16 a[184:185], v42 offset:0
ds_read_b64_tr_b16 a[186:187], v42 offset:4096
v_mfma_f32_16x16x32_bf16 v[120:123], a[200:203], a[152:155], v[120:123]
ds_read_b64_tr_b16 a[188:189], v42 offset:8192
ds_read_b64_tr_b16 a[190:191], v42 offset:12288
v_mfma_f32_16x16x32_bf16 v[120:123], a[204:207], a[168:171], v[120:123]
v_mfma_f32_16x16x32_bf16 v[124:127], a[204:207], a[172:175], v[124:127]
v_mfma_f32_16x16x32_bf16 v[124:127], a[200:203], a[156:159], v[124:127]
s_waitcnt lgkmcnt(4)
buffer_load_dwordx4 a[128:131], v7, s[16:19], s38 offen offset:0 sc1
v_mfma_f32_16x16x32_bf16 v[140:143], a[176:179], a[156:159], v[140:143]
v_mfma_f32_16x16x32_bf16 v[140:143], a[180:183], a[172:175], v[140:143]
v_mfma_f32_16x16x32_bf16 v[136:139], a[180:183], a[168:171], v[136:139]
v_mfma_f32_16x16x32_bf16 v[136:139], a[176:179], a[152:155], v[136:139]
ds_read_b64_tr_b16 a[192:193], v43 offset:0
ds_read_b64_tr_b16 a[194:195], v43 offset:4096
v_mfma_f32_16x16x32_bf16 v[132:135], a[176:179], a[148:151], v[132:135]
buffer_load_dwordx4 v22, s[44:47], s36 offen offset:1024 lds
v_mfma_f32_16x16x32_bf16 v[132:135], a[180:183], a[164:167], v[132:135]
ds_read_b64_tr_b16 a[196:197], v43 offset:8192
ds_read_b64_tr_b16 a[198:199], v43 offset:12288
v_mfma_f32_16x16x32_bf16 v[128:131], a[180:183], a[160:163], v[128:131]
v_mfma_f32_16x16x32_bf16 v[128:131], a[176:179], a[144:147], v[128:131]
s_waitcnt lgkmcnt(4)
v_mfma_f32_16x16x32_bf16 v[144:147], a[184:187], a[144:147], v[144:147]
v_mfma_f32_16x16x32_bf16 v[144:147], a[188:191], a[160:163], v[144:147]
buffer_load_dwordx4 a[132:135], v7, s[16:19], s38 offen offset:1024 sc1
v_mfma_f32_16x16x32_bf16 v[148:151], a[188:191], a[164:167], v[148:151]
v_mfma_f32_16x16x32_bf16 v[148:151], a[184:187], a[148:151], v[148:151]
ds_read_b64_tr_b16 a[200:201], v44 offset:0
ds_read_b64_tr_b16 a[202:203], v44 offset:4096
v_mfma_f32_16x16x32_bf16 v[152:155], a[184:187], a[152:155], v[152:155]
ds_read_b64_tr_b16 a[204:205], v44 offset:8192
ds_read_b64_tr_b16 a[206:207], v44 offset:12288
v_mfma_f32_16x16x32_bf16 v[152:155], a[188:191], a[168:171], v[152:155]
v_mfma_f32_16x16x32_bf16 v[156:159], a[188:191], a[172:175], v[156:159]
buffer_load_dwordx4 v23, s[44:47], s36 offen offset:2048 lds
v_mfma_f32_16x16x32_bf16 v[156:159], a[184:187], a[156:159], v[156:159]
s_waitcnt lgkmcnt(4)
v_mfma_f32_16x16x32_bf16 v[172:175], a[192:195], a[156:159], v[172:175]
v_mfma_f32_16x16x32_bf16 v[172:175], a[196:199], a[172:175], v[172:175]
v_mfma_f32_16x16x32_bf16 v[168:171], a[196:199], a[168:171], v[168:171]
v_mfma_f32_16x16x32_bf16 v[168:171], a[192:195], a[152:155], v[168:171]
buffer_load_dwordx4 a[136:139], v7, s[16:19], s38 offen offset:2048 sc1
v_mfma_f32_16x16x32_bf16 v[164:167], a[192:195], a[148:151], v[164:167]
ds_read_b64_tr_b16 a[176:177], v45 offset:0
ds_read_b64_tr_b16 a[178:179], v45 offset:4096
v_mfma_f32_16x16x32_bf16 v[164:167], a[196:199], a[164:167], v[164:167]
ds_read_b64_tr_b16 a[180:181], v45 offset:8192
ds_read_b64_tr_b16 a[182:183], v45 offset:12288
v_mfma_f32_16x16x32_bf16 v[160:163], a[196:199], a[160:163], v[160:163]
v_mfma_f32_16x16x32_bf16 v[160:163], a[192:195], a[144:147], v[160:163]
s_waitcnt lgkmcnt(4)
v_mfma_f32_16x16x32_bf16 v[176:179], a[200:203], a[144:147], v[176:179]
buffer_load_dwordx4 v24, s[44:47], s36 offen offset:3072 lds
v_mfma_f32_16x16x32_bf16 v[176:179], a[204:207], a[160:163], v[176:179]
s_xor_b32 s36, s25, 6
s_mul_i32 s36, s36, 147456
s_add_u32 s36, s36, 73728
v_mfma_f32_16x16x32_bf16 v[180:183], a[204:207], a[164:167], v[180:183]
s_add_u32 m0, s24, 0
v_mfma_f32_16x16x32_bf16 v[180:183], a[200:203], a[148:151], v[180:183]
ds_read_b64_tr_b16 a[184:185], v46 offset:0
ds_read_b64_tr_b16 a[186:187], v46 offset:4096
v_mfma_f32_16x16x32_bf16 v[184:187], a[200:203], a[152:155], v[184:187]
ds_read_b64_tr_b16 a[188:189], v46 offset:8192
ds_read_b64_tr_b16 a[190:191], v46 offset:12288
v_mfma_f32_16x16x32_bf16 v[184:187], a[204:207], a[168:171], v[184:187]
buffer_load_dwordx4 a[140:143], v7, s[16:19], s38 offen offset:3072 sc1
v_mfma_f32_16x16x32_bf16 v[188:191], a[204:207], a[172:175], v[188:191]
s_xor_b32 s37, s25, 6
s_mul_i32 s37, s37, 65536
s_add_u32 s37, s37, s48
v_mfma_f32_16x16x32_bf16 v[188:191], a[200:203], a[156:159], v[188:191]
s_waitcnt lgkmcnt(4)
s_add_u32 s37, s37, 32768
v_mfma_f32_16x16x32_bf16 v[204:207], a[176:179], a[156:159], v[204:207]
v_mfma_f32_16x16x32_bf16 v[204:207], a[180:183], a[172:175], v[204:207]
v_mfma_f32_16x16x32_bf16 v[200:203], a[180:183], a[168:171], v[200:203]
buffer_load_dwordx4 a[96:99], v7, s[16:19], s37 offen offset:0 sc1
v_mfma_f32_16x16x32_bf16 v[200:203], a[176:179], a[152:155], v[200:203]
ds_read_b64_tr_b16 a[192:193], v47 offset:0
ds_read_b64_tr_b16 a[194:195], v47 offset:4096
v_mfma_f32_16x16x32_bf16 v[196:199], a[176:179], a[148:151], v[196:199]
ds_read_b64_tr_b16 a[196:197], v47 offset:8192
ds_read_b64_tr_b16 a[198:199], v47 offset:12288
v_mfma_f32_16x16x32_bf16 v[196:199], a[180:183], a[164:167], v[196:199]
v_mfma_f32_16x16x32_bf16 v[192:195], a[180:183], a[160:163], v[192:195]
v_mfma_f32_16x16x32_bf16 v[192:195], a[176:179], a[144:147], v[192:195]
s_waitcnt lgkmcnt(4)
buffer_load_dwordx4 a[100:103], v7, s[16:19], s37 offen offset:1024 sc1
v_mfma_f32_16x16x32_bf16 v[208:211], a[184:187], a[144:147], v[208:211]
v_mfma_f32_16x16x32_bf16 v[208:211], a[188:191], a[160:163], v[208:211]
v_mfma_f32_16x16x32_bf16 v[212:215], a[188:191], a[164:167], v[212:215]
v_mfma_f32_16x16x32_bf16 v[212:215], a[184:187], a[148:151], v[212:215]
ds_read_b64_tr_b16 a[200:201], v20 offset:28672
ds_read_b64_tr_b16 a[202:203], v20 offset:29184
v_mfma_f32_16x16x32_bf16 v[216:219], a[184:187], a[152:155], v[216:219]
buffer_load_dwordx4 a[104:107], v7, s[16:19], s37 offen offset:2048 sc1
v_mfma_f32_16x16x32_bf16 v[216:219], a[188:191], a[168:171], v[216:219]
ds_read_b64_tr_b16 a[204:205], v20 offset:29696
ds_read_b64_tr_b16 a[206:207], v20 offset:30208
v_mfma_f32_16x16x32_bf16 v[220:223], a[188:191], a[172:175], v[220:223]
v_mfma_f32_16x16x32_bf16 v[220:223], a[184:187], a[156:159], v[220:223]
s_waitcnt lgkmcnt(4)
v_mfma_f32_16x16x32_bf16 v[236:239], a[192:195], a[156:159], v[236:239]
v_mfma_f32_16x16x32_bf16 v[236:239], a[196:199], a[172:175], v[236:239]
buffer_load_dwordx4 a[108:111], v7, s[16:19], s37 offen offset:3072 sc1
v_mfma_f32_16x16x32_bf16 v[232:235], a[196:199], a[168:171], v[232:235]
s_add_u32 s38, s37, 16384
v_mfma_f32_16x16x32_bf16 v[232:235], a[192:195], a[152:155], v[232:235]
s_waitcnt vmcnt(17) lgkmcnt(0)
s_barrier
ds_read_b64_tr_b16 a[176:177], v40 offset:32768
v_mfma_f32_16x16x32_bf16 v[228:231], a[192:195], a[148:151], v[228:231]
ds_read_b64_tr_b16 a[178:179], v40 offset:36864
ds_read_b64_tr_b16 a[180:181], v40 offset:40960
v_mfma_f32_16x16x32_bf16 v[228:231], a[196:199], a[164:167], v[228:231]
ds_read_b64_tr_b16 a[182:183], v40 offset:45056
v_mfma_f32_16x16x32_bf16 v[224:227], a[196:199], a[160:163], v[224:227]
buffer_load_dwordx4 v21, s[44:47], s36 offen offset:0 lds
v_mfma_f32_16x16x32_bf16 v[224:227], a[192:195], a[144:147], v[224:227]
s_waitcnt lgkmcnt(4)
v_mfma_f32_16x16x32_bf16 v[240:243], a[200:203], a[144:147], v[240:243]
v_mfma_f32_16x16x32_bf16 v[240:243], a[204:207], a[160:163], v[240:243]
v_mfma_f32_16x16x32_bf16 v[244:247], a[204:207], a[164:167], v[244:247]
v_mfma_f32_16x16x32_bf16 v[244:247], a[200:203], a[148:151], v[244:247]
buffer_load_dwordx4 a[112:115], v7, s[16:19], s38 offen offset:0 sc1
v_mfma_f32_16x16x32_bf16 v[248:251], a[200:203], a[152:155], v[248:251]
ds_read_b64_tr_b16 a[184:185], v41 offset:32768
ds_read_b64_tr_b16 a[186:187], v41 offset:36864
v_mfma_f32_16x16x32_bf16 v[248:251], a[204:207], a[168:171], v[248:251]
ds_read_b64_tr_b16 a[188:189], v41 offset:40960
ds_read_b64_tr_b16 a[190:191], v41 offset:45056
v_mfma_f32_16x16x32_bf16 v[252:255], a[204:207], a[172:175], v[252:255]
v_mfma_f32_16x16x32_bf16 v[252:255], a[200:203], a[156:159], v[252:255]
s_waitcnt lgkmcnt(4) vmcnt(18)
v_mfma_f32_16x16x32_bf16 v[112:115], a[176:179], a[64:67], v[112:115]
buffer_load_dwordx4 v22, s[44:47], s36 offen offset:1024 lds
v_mfma_f32_16x16x32_bf16 v[112:115], a[180:183], a[80:83], v[112:115]
v_mfma_f32_16x16x32_bf16 v[116:119], a[180:183], a[84:87], v[116:119]
v_mfma_f32_16x16x32_bf16 v[116:119], a[176:179], a[68:71], v[116:119]
ds_read_b64_tr_b16 a[192:193], v42 offset:32768
ds_read_b64_tr_b16 a[194:195], v42 offset:36864
v_mfma_f32_16x16x32_bf16 v[120:123], a[176:179], a[72:75], v[120:123]
ds_read_b64_tr_b16 a[196:197], v42 offset:40960
ds_read_b64_tr_b16 a[198:199], v42 offset:45056
v_mfma_f32_16x16x32_bf16 v[120:123], a[180:183], a[88:91], v[120:123]
buffer_load_dwordx4 a[116:119], v7, s[16:19], s38 offen offset:1024 sc1
v_mfma_f32_16x16x32_bf16 v[124:127], a[180:183], a[92:95], v[124:127]
v_mfma_f32_16x16x32_bf16 v[124:127], a[176:179], a[76:79], v[124:127]
s_waitcnt lgkmcnt(4)
v_mfma_f32_16x16x32_bf16 v[140:143], a[184:187], a[76:79], v[140:143]
v_mfma_f32_16x16x32_bf16 v[140:143], a[188:191], a[92:95], v[140:143]
v_mfma_f32_16x16x32_bf16 v[136:139], a[188:191], a[88:91], v[136:139]
buffer_load_dwordx4 v23, s[44:47], s36 offen offset:2048 lds
v_mfma_f32_16x16x32_bf16 v[136:139], a[184:187], a[72:75], v[136:139]
ds_read_b64_tr_b16 a[200:201], v43 offset:32768
ds_read_b64_tr_b16 a[202:203], v43 offset:36864
v_mfma_f32_16x16x32_bf16 v[132:135], a[184:187], a[68:71], v[132:135]
ds_read_b64_tr_b16 a[204:205], v43 offset:40960
ds_read_b64_tr_b16 a[206:207], v43 offset:45056
v_mfma_f32_16x16x32_bf16 v[132:135], a[188:191], a[84:87], v[132:135]
v_mfma_f32_16x16x32_bf16 v[128:131], a[188:191], a[80:83], v[128:131]
v_mfma_f32_16x16x32_bf16 v[128:131], a[184:187], a[64:67], v[128:131]
s_waitcnt lgkmcnt(4)
buffer_load_dwordx4 a[120:123], v7, s[16:19], s38 offen offset:2048 sc1
v_mfma_f32_16x16x32_bf16 v[144:147], a[192:195], a[64:67], v[144:147]
v_mfma_f32_16x16x32_bf16 v[144:147], a[196:199], a[80:83], v[144:147]
v_mfma_f32_16x16x32_bf16 v[148:151], a[196:199], a[84:87], v[148:151]
v_mfma_f32_16x16x32_bf16 v[148:151], a[192:195], a[68:71], v[148:151]
ds_read_b64_tr_b16 a[176:177], v44 offset:32768
ds_read_b64_tr_b16 a[178:179], v44 offset:36864
v_mfma_f32_16x16x32_bf16 v[152:155], a[192:195], a[72:75], v[152:155]
buffer_load_dwordx4 v24, s[44:47], s36 offen offset:3072 lds
v_mfma_f32_16x16x32_bf16 v[152:155], a[196:199], a[88:91], v[152:155]
s_xor_b32 s36, s25, 7
ds_read_b64_tr_b16 a[180:181], v44 offset:40960
ds_read_b64_tr_b16 a[182:183], v44 offset:45056
v_mfma_f32_16x16x32_bf16 v[156:159], a[196:199], a[92:95], v[156:159]
s_mul_i32 s36, s36, 147456
s_add_u32 s36, s36, 73728
s_add_u32 m0, s24, 16384
v_mfma_f32_16x16x32_bf16 v[156:159], a[192:195], a[76:79], v[156:159]
s_waitcnt lgkmcnt(4)
v_mfma_f32_16x16x32_bf16 v[172:175], a[200:203], a[76:79], v[172:175]
v_mfma_f32_16x16x32_bf16 v[172:175], a[204:207], a[92:95], v[172:175]
buffer_load_dwordx4 a[124:127], v7, s[16:19], s38 offen offset:3072 sc1
v_mfma_f32_16x16x32_bf16 v[168:171], a[204:207], a[88:91], v[168:171]
s_xor_b32 s37, s25, 7
s_mul_i32 s37, s37, 65536
s_add_u32 s37, s37, s48
v_mfma_f32_16x16x32_bf16 v[168:171], a[200:203], a[72:75], v[168:171]
s_add_u32 s37, s37, 32768
ds_read_b64_tr_b16 a[184:185], v45 offset:32768
ds_read_b64_tr_b16 a[186:187], v45 offset:36864
v_mfma_f32_16x16x32_bf16 v[164:167], a[200:203], a[68:71], v[164:167]
ds_read_b64_tr_b16 a[188:189], v45 offset:40960
ds_read_b64_tr_b16 a[190:191], v45 offset:45056
v_mfma_f32_16x16x32_bf16 v[164:167], a[204:207], a[84:87], v[164:167]
v_mfma_f32_16x16x32_bf16 v[160:163], a[204:207], a[80:83], v[160:163]
buffer_load_dwordx4 a[144:147], v7, s[16:19], s37 offen offset:0 sc1
v_mfma_f32_16x16x32_bf16 v[160:163], a[200:203], a[64:67], v[160:163]
s_waitcnt lgkmcnt(4)
v_mfma_f32_16x16x32_bf16 v[176:179], a[176:179], a[64:67], v[176:179]
v_mfma_f32_16x16x32_bf16 v[176:179], a[180:183], a[80:83], v[176:179]
v_mfma_f32_16x16x32_bf16 v[180:183], a[180:183], a[84:87], v[180:183]
v_mfma_f32_16x16x32_bf16 v[180:183], a[176:179], a[68:71], v[180:183]
buffer_load_dwordx4 a[148:151], v7, s[16:19], s37 offen offset:1024 sc1
v_mfma_f32_16x16x32_bf16 v[184:187], a[176:179], a[72:75], v[184:187]
ds_read_b64_tr_b16 a[192:193], v46 offset:32768
ds_read_b64_tr_b16 a[194:195], v46 offset:36864
v_mfma_f32_16x16x32_bf16 v[184:187], a[180:183], a[88:91], v[184:187]
ds_read_b64_tr_b16 a[196:197], v46 offset:40960
ds_read_b64_tr_b16 a[198:199], v46 offset:45056
v_mfma_f32_16x16x32_bf16 v[188:191], a[180:183], a[92:95], v[188:191]
v_mfma_f32_16x16x32_bf16 v[188:191], a[176:179], a[76:79], v[188:191]
s_waitcnt lgkmcnt(4)
v_mfma_f32_16x16x32_bf16 v[204:207], a[184:187], a[76:79], v[204:207]
buffer_load_dwordx4 a[152:155], v7, s[16:19], s37 offen offset:2048 sc1
v_mfma_f32_16x16x32_bf16 v[204:207], a[188:191], a[92:95], v[204:207]
v_mfma_f32_16x16x32_bf16 v[200:203], a[188:191], a[88:91], v[200:203]
v_mfma_f32_16x16x32_bf16 v[200:203], a[184:187], a[72:75], v[200:203]
ds_read_b64_tr_b16 a[200:201], v47 offset:32768
ds_read_b64_tr_b16 a[202:203], v47 offset:36864
v_mfma_f32_16x16x32_bf16 v[196:199], a[184:187], a[68:71], v[196:199]
ds_read_b64_tr_b16 a[204:205], v47 offset:40960
ds_read_b64_tr_b16 a[206:207], v47 offset:45056
v_mfma_f32_16x16x32_bf16 v[196:199], a[188:191], a[84:87], v[196:199]
buffer_load_dwordx4 a[156:159], v7, s[16:19], s37 offen offset:3072 sc1
v_mfma_f32_16x16x32_bf16 v[192:195], a[188:191], a[80:83], v[192:195]
s_add_u32 s38, s37, 16384
v_mfma_f32_16x16x32_bf16 v[192:195], a[184:187], a[64:67], v[192:195]
s_waitcnt lgkmcnt(4)
v_mfma_f32_16x16x32_bf16 v[208:211], a[192:195], a[64:67], v[208:211]
v_mfma_f32_16x16x32_bf16 v[208:211], a[196:199], a[80:83], v[208:211]
v_mfma_f32_16x16x32_bf16 v[212:215], a[196:199], a[84:87], v[212:215]
buffer_load_dwordx4 v21, s[44:47], s36 offen offset:0 lds
v_mfma_f32_16x16x32_bf16 v[212:215], a[192:195], a[68:71], v[212:215]
ds_read_b64_tr_b16 a[176:177], v20 offset:18432
ds_read_b64_tr_b16 a[178:179], v20 offset:18944
v_mfma_f32_16x16x32_bf16 v[216:219], a[192:195], a[72:75], v[216:219]
ds_read_b64_tr_b16 a[180:181], v20 offset:19456
ds_read_b64_tr_b16 a[182:183], v20 offset:19968
v_mfma_f32_16x16x32_bf16 v[216:219], a[196:199], a[88:91], v[216:219]
v_mfma_f32_16x16x32_bf16 v[220:223], a[196:199], a[92:95], v[220:223]
v_mfma_f32_16x16x32_bf16 v[220:223], a[192:195], a[76:79], v[220:223]
s_waitcnt lgkmcnt(4)
buffer_load_dwordx4 a[160:163], v7, s[16:19], s38 offen offset:0 sc1
v_mfma_f32_16x16x32_bf16 v[236:239], a[200:203], a[76:79], v[236:239]
v_mfma_f32_16x16x32_bf16 v[236:239], a[204:207], a[92:95], v[236:239]
v_mfma_f32_16x16x32_bf16 v[232:235], a[204:207], a[88:91], v[232:235]
v_mfma_f32_16x16x32_bf16 v[232:235], a[200:203], a[72:75], v[232:235]
s_waitcnt vmcnt(19) lgkmcnt(0)
s_barrier
ds_read_b64_tr_b16 a[184:185], v40 offset:49152
v_mfma_f32_16x16x32_bf16 v[228:231], a[200:203], a[68:71], v[228:231]
buffer_load_dwordx4 v22, s[44:47], s36 offen offset:1024 lds
v_mfma_f32_16x16x32_bf16 v[228:231], a[204:207], a[84:87], v[228:231]
ds_read_b64_tr_b16 a[186:187], v40 offset:53248
ds_read_b64_tr_b16 a[188:189], v40 offset:57344
v_mfma_f32_16x16x32_bf16 v[224:227], a[204:207], a[80:83], v[224:227]
ds_read_b64_tr_b16 a[190:191], v40 offset:61440
v_mfma_f32_16x16x32_bf16 v[224:227], a[200:203], a[64:67], v[224:227]
s_waitcnt lgkmcnt(4)
v_mfma_f32_16x16x32_bf16 v[240:243], a[176:179], a[64:67], v[240:243]
v_mfma_f32_16x16x32_bf16 v[240:243], a[180:183], a[80:83], v[240:243]
buffer_load_dwordx4 a[164:167], v7, s[16:19], s38 offen offset:1024 sc1
v_mfma_f32_16x16x32_bf16 v[244:247], a[180:183], a[84:87], v[244:247]
v_mfma_f32_16x16x32_bf16 v[244:247], a[176:179], a[68:71], v[244:247]
ds_read_b64_tr_b16 a[192:193], v41 offset:49152
ds_read_b64_tr_b16 a[194:195], v41 offset:53248
v_mfma_f32_16x16x32_bf16 v[248:251], a[176:179], a[72:75], v[248:251]
ds_read_b64_tr_b16 a[196:197], v41 offset:57344
ds_read_b64_tr_b16 a[198:199], v41 offset:61440
v_mfma_f32_16x16x32_bf16 v[248:251], a[180:183], a[88:91], v[248:251]
v_mfma_f32_16x16x32_bf16 v[252:255], a[180:183], a[92:95], v[252:255]
buffer_load_dwordx4 v23, s[44:47], s36 offen offset:2048 lds
v_mfma_f32_16x16x32_bf16 v[252:255], a[176:179], a[76:79], v[252:255]
s_waitcnt lgkmcnt(4) vmcnt(21)
v_mfma_f32_16x16x32_bf16 v[112:115], a[184:187], a[240:243], v[112:115]
v_mfma_f32_16x16x32_bf16 v[112:115], a[188:191], a[128:131], v[112:115]
v_mfma_f32_16x16x32_bf16 v[116:119], a[188:191], a[132:135], v[116:119]
v_mfma_f32_16x16x32_bf16 v[116:119], a[184:187], a[244:247], v[116:119]
buffer_load_dwordx4 a[168:171], v7, s[16:19], s38 offen offset:2048 sc1
v_mfma_f32_16x16x32_bf16 v[120:123], a[184:187], a[248:251], v[120:123]
ds_read_b64_tr_b16 a[200:201], v42 offset:49152
ds_read_b64_tr_b16 a[202:203], v42 offset:53248
v_mfma_f32_16x16x32_bf16 v[120:123], a[188:191], a[136:139], v[120:123]
ds_read_b64_tr_b16 a[204:205], v42 offset:57344
ds_read_b64_tr_b16 a[206:207], v42 offset:61440
v_mfma_f32_16x16x32_bf16 v[124:127], a[188:191], a[140:143], v[124:127]
v_mfma_f32_16x16x32_bf16 v[124:127], a[184:187], a[252:255], v[124:127]
s_waitcnt lgkmcnt(4)
v_mfma_f32_16x16x32_bf16 v[140:143], a[192:195], a[252:255], v[140:143]
buffer_load_dwordx4 v24, s[44:47], s36 offen offset:3072 lds
v_mfma_f32_16x16x32_bf16 v[140:143], a[196:199], a[140:143], v[140:143]
s_xor_b32 s36, s25, 1
s_mul_i32 s36, s36, 147456
s_add_u32 m0, s24, 32768
v_mfma_f32_16x16x32_bf16 v[136:139], a[196:199], a[136:139], v[136:139]
v_mfma_f32_16x16x32_bf16 v[136:139], a[192:195], a[248:251], v[136:139]
ds_read_b64_tr_b16 a[176:177], v43 offset:49152
ds_read_b64_tr_b16 a[178:179], v43 offset:53248
v_mfma_f32_16x16x32_bf16 v[132:135], a[192:195], a[244:247], v[132:135]
ds_read_b64_tr_b16 a[180:181], v43 offset:57344
ds_read_b64_tr_b16 a[182:183], v43 offset:61440
v_mfma_f32_16x16x32_bf16 v[132:135], a[196:199], a[132:135], v[132:135]
buffer_load_dwordx4 a[172:175], v7, s[16:19], s38 offen offset:3072 sc1
v_mfma_f32_16x16x32_bf16 v[128:131], a[196:199], a[128:131], v[128:131]
s_xor_b32 s37, s25, 1
s_mul_i32 s37, s37, 65536
s_add_u32 s37, s37, s48
v_mfma_f32_16x16x32_bf16 v[128:131], a[192:195], a[240:243], v[128:131]
s_waitcnt lgkmcnt(4)
v_mfma_f32_16x16x32_bf16 v[144:147], a[200:203], a[240:243], v[144:147]
v_mfma_f32_16x16x32_bf16 v[144:147], a[204:207], a[128:131], v[144:147]
v_mfma_f32_16x16x32_bf16 v[148:151], a[204:207], a[132:135], v[148:151]
buffer_load_dwordx4 a[208:211], v7, s[16:19], s37 offen offset:0 sc1
v_mfma_f32_16x16x32_bf16 v[148:151], a[200:203], a[244:247], v[148:151]
ds_read_b64_tr_b16 a[184:185], v44 offset:49152
ds_read_b64_tr_b16 a[186:187], v44 offset:53248
v_mfma_f32_16x16x32_bf16 v[152:155], a[200:203], a[248:251], v[152:155]
ds_read_b64_tr_b16 a[188:189], v44 offset:57344
ds_read_b64_tr_b16 a[190:191], v44 offset:61440
v_mfma_f32_16x16x32_bf16 v[152:155], a[204:207], a[136:139], v[152:155]
v_mfma_f32_16x16x32_bf16 v[156:159], a[204:207], a[140:143], v[156:159]
v_mfma_f32_16x16x32_bf16 v[156:159], a[200:203], a[252:255], v[156:159]
s_waitcnt lgkmcnt(4)
buffer_load_dwordx4 v21, s[44:47], s36 offen offset:0 lds
v_mfma_f32_16x16x32_bf16 v[172:175], a[176:179], a[252:255], v[172:175]
v_mfma_f32_16x16x32_bf16 v[172:175], a[180:183], a[140:143], v[172:175]
v_mfma_f32_16x16x32_bf16 v[168:171], a[180:183], a[136:139], v[168:171]
v_mfma_f32_16x16x32_bf16 v[168:171], a[176:179], a[248:251], v[168:171]
ds_read_b64_tr_b16 a[192:193], v45 offset:49152
ds_read_b64_tr_b16 a[194:195], v45 offset:53248
v_mfma_f32_16x16x32_bf16 v[164:167], a[176:179], a[244:247], v[164:167]
buffer_load_dwordx4 a[212:215], v7, s[16:19], s37 offen offset:1024 sc1
v_mfma_f32_16x16x32_bf16 v[164:167], a[180:183], a[132:135], v[164:167]
ds_read_b64_tr_b16 a[196:197], v45 offset:57344
ds_read_b64_tr_b16 a[198:199], v45 offset:61440
v_mfma_f32_16x16x32_bf16 v[160:163], a[180:183], a[128:131], v[160:163]
v_mfma_f32_16x16x32_bf16 v[160:163], a[176:179], a[240:243], v[160:163]
s_waitcnt lgkmcnt(4)
v_mfma_f32_16x16x32_bf16 v[176:179], a[184:187], a[240:243], v[176:179]
v_mfma_f32_16x16x32_bf16 v[176:179], a[188:191], a[128:131], v[176:179]
buffer_load_dwordx4 v22, s[44:47], s36 offen offset:1024 lds
v_mfma_f32_16x16x32_bf16 v[180:183], a[188:191], a[132:135], v[180:183]
v_mfma_f32_16x16x32_bf16 v[180:183], a[184:187], a[244:247], v[180:183]
ds_read_b64_tr_b16 a[200:201], v46 offset:49152
ds_read_b64_tr_b16 a[202:203], v46 offset:53248
v_mfma_f32_16x16x32_bf16 v[184:187], a[184:187], a[248:251], v[184:187]
ds_read_b64_tr_b16 a[204:205], v46 offset:57344
ds_read_b64_tr_b16 a[206:207], v46 offset:61440
v_mfma_f32_16x16x32_bf16 v[184:187], a[188:191], a[136:139], v[184:187]
v_mfma_f32_16x16x32_bf16 v[188:191], a[188:191], a[140:143], v[188:191]
buffer_load_dwordx4 a[216:219], v7, s[16:19], s37 offen offset:2048 sc1
v_mfma_f32_16x16x32_bf16 v[188:191], a[184:187], a[252:255], v[188:191]
s_waitcnt lgkmcnt(4)
v_mfma_f32_16x16x32_bf16 v[204:207], a[192:195], a[252:255], v[204:207]
v_mfma_f32_16x16x32_bf16 v[204:207], a[196:199], a[140:143], v[204:207]
v_mfma_f32_16x16x32_bf16 v[200:203], a[196:199], a[136:139], v[200:203]
v_mfma_f32_16x16x32_bf16 v[200:203], a[192:195], a[248:251], v[200:203]
buffer_load_dwordx4 v23, s[44:47], s36 offen offset:2048 lds
v_mfma_f32_16x16x32_bf16 v[196:199], a[192:195], a[244:247], v[196:199]
ds_read_b64_tr_b16 a[176:177], v47 offset:49152
ds_read_b64_tr_b16 a[178:179], v47 offset:53248
v_mfma_f32_16x16x32_bf16 v[196:199], a[196:199], a[132:135], v[196:199]
ds_read_b64_tr_b16 a[180:181], v47 offset:57344
ds_read_b64_tr_b16 a[182:183], v47 offset:61440
v_mfma_f32_16x16x32_bf16 v[192:195], a[196:199], a[128:131], v[192:195]
v_mfma_f32_16x16x32_bf16 v[192:195], a[192:195], a[240:243], v[192:195]
s_waitcnt lgkmcnt(4)
v_mfma_f32_16x16x32_bf16 v[208:211], a[200:203], a[240:243], v[208:211]
buffer_load_dwordx4 a[220:223], v7, s[16:19], s37 offen offset:3072 sc1
v_mfma_f32_16x16x32_bf16 v[208:211], a[204:207], a[128:131], v[208:211]
s_add_u32 s38, s37, 16384
v_mfma_f32_16x16x32_bf16 v[212:215], a[204:207], a[132:135], v[212:215]
v_mfma_f32_16x16x32_bf16 v[212:215], a[200:203], a[244:247], v[212:215]
ds_read_b64_tr_b16 a[184:185], v20 offset:22528
ds_read_b64_tr_b16 a[186:187], v20 offset:23040
v_mfma_f32_16x16x32_bf16 v[216:219], a[200:203], a[248:251], v[216:219]
ds_read_b64_tr_b16 a[188:189], v20 offset:23552
ds_read_b64_tr_b16 a[190:191], v20 offset:24064
v_mfma_f32_16x16x32_bf16 v[216:219], a[204:207], a[136:139], v[216:219]
buffer_load_dwordx4 v24, s[44:47], s36 offen offset:3072 lds
v_mfma_f32_16x16x32_bf16 v[220:223], a[204:207], a[140:143], v[220:223]
s_mov_b32 s36, s42
s_mul_i32 s36, s36, 147456
s_add_u32 m0, s39, 131072
v_mfma_f32_16x16x32_bf16 v[220:223], a[200:203], a[252:255], v[220:223]
s_waitcnt lgkmcnt(4)
v_mfma_f32_16x16x32_bf16 v[236:239], a[176:179], a[252:255], v[236:239]
v_mfma_f32_16x16x32_bf16 v[236:239], a[180:183], a[140:143], v[236:239]
v_mfma_f32_16x16x32_bf16 v[232:235], a[180:183], a[136:139], v[232:235]
buffer_load_dwordx4 a[224:227], v7, s[16:19], s38 offen offset:0 sc1
v_mfma_f32_16x16x32_bf16 v[232:235], a[176:179], a[248:251], v[232:235]
s_waitcnt vmcnt(22) lgkmcnt(0)
s_barrier
ds_read_b64_tr_b16 a[192:193], v8 offset:0
v_mfma_f32_16x16x32_bf16 v[228:231], a[176:179], a[244:247], v[228:231]
ds_read_b64_tr_b16 a[194:195], v8 offset:4096
ds_read_b64_tr_b16 a[196:197], v8 offset:8192
v_mfma_f32_16x16x32_bf16 v[228:231], a[180:183], a[132:135], v[228:231]
ds_read_b64_tr_b16 a[198:199], v8 offset:12288
v_mfma_f32_16x16x32_bf16 v[224:227], a[180:183], a[128:131], v[224:227]
v_mfma_f32_16x16x32_bf16 v[224:227], a[176:179], a[240:243], v[224:227]
s_waitcnt lgkmcnt(4)
buffer_load_dwordx4 a[228:231], v7, s[16:19], s38 offen offset:1024 sc1
v_mfma_f32_16x16x32_bf16 v[240:243], a[184:187], a[240:243], v[240:243]
v_mfma_f32_16x16x32_bf16 v[240:243], a[188:191], a[128:131], v[240:243]
v_mfma_f32_16x16x32_bf16 v[244:247], a[188:191], a[132:135], v[244:247]
v_mfma_f32_16x16x32_bf16 v[244:247], a[184:187], a[244:247], v[244:247]
ds_read_b64_tr_b16 a[200:201], v9 offset:0
ds_read_b64_tr_b16 a[202:203], v9 offset:4096
v_mfma_f32_16x16x32_bf16 v[248:251], a[184:187], a[248:251], v[248:251]
buffer_load_dwordx4 a[232:235], v7, s[16:19], s38 offen offset:2048 sc1
v_mfma_f32_16x16x32_bf16 v[248:251], a[188:191], a[136:139], v[248:251]
ds_read_b64_tr_b16 a[204:205], v9 offset:8192
ds_read_b64_tr_b16 a[206:207], v9 offset:12288
v_mfma_f32_16x16x32_bf16 v[252:255], a[188:191], a[140:143], v[252:255]
v_mfma_f32_16x16x32_bf16 v[252:255], a[184:187], a[252:255], v[252:255]
s_waitcnt lgkmcnt(4) vmcnt(23)
v_mfma_f32_16x16x32_bf16 v[112:115], a[192:195], a[96:99], v[112:115]
v_mfma_f32_16x16x32_bf16 v[112:115], a[196:199], a[112:115], v[112:115]
buffer_load_dwordx4 v25, s[44:47], s36 offen lds
v_mfma_f32_16x16x32_bf16 v[116:119], a[196:199], a[116:119], v[116:119]
s_xor_b32 s36, s25, 1
s_mul_i32 s36, s36, 147456
s_add_u32 s36, s36, 73728
v_mfma_f32_16x16x32_bf16 v[116:119], a[192:195], a[100:103], v[116:119]
s_add_u32 m0, s24, 81920
ds_read_b64_tr_b16 a[176:177], v10 offset:0
ds_read_b64_tr_b16 a[178:179], v10 offset:4096
v_mfma_f32_16x16x32_bf16 v[120:123], a[192:195], a[104:107], v[120:123]
ds_read_b64_tr_b16 a[180:181], v10 offset:8192
ds_read_b64_tr_b16 a[182:183], v10 offset:12288
v_mfma_f32_16x16x32_bf16 v[120:123], a[196:199], a[120:123], v[120:123]
v_mfma_f32_16x16x32_bf16 v[124:127], a[196:199], a[124:127], v[124:127]
buffer_load_dwordx4 a[236:239], v7, s[16:19], s38 offen offset:3072 sc1
v_mfma_f32_16x16x32_bf16 v[124:127], a[192:195], a[108:111], v[124:127]
s_waitcnt lgkmcnt(4)
s_xor_b32 s37, s25, 1
s_mul_i32 s37, s37, 65536
v_mfma_f32_16x16x32_bf16 v[140:143], a[200:203], a[108:111], v[140:143]
s_add_u32 s37, s37, s48
s_add_u32 s37, s37, 32768
v_mfma_f32_16x16x32_bf16 v[140:143], a[204:207], a[124:127], v[140:143]
v_mfma_f32_16x16x32_bf16 v[136:139], a[204:207], a[120:123], v[136:139]
v_mfma_f32_16x16x32_bf16 v[136:139], a[200:203], a[104:107], v[136:139]
buffer_load_dwordx4 a[0:3], v7, s[16:19], s37 offen offset:0 sc1
v_mfma_f32_16x16x32_bf16 v[132:135], a[200:203], a[100:103], v[132:135]
ds_read_b64_tr_b16 a[184:185], v11 offset:0
ds_read_b64_tr_b16 a[186:187], v11 offset:4096
v_mfma_f32_16x16x32_bf16 v[132:135], a[204:207], a[116:119], v[132:135]
ds_read_b64_tr_b16 a[188:189], v11 offset:8192
ds_read_b64_tr_b16 a[190:191], v11 offset:12288
v_mfma_f32_16x16x32_bf16 v[128:131], a[204:207], a[112:115], v[128:131]
v_mfma_f32_16x16x32_bf16 v[128:131], a[200:203], a[96:99], v[128:131]
s_waitcnt lgkmcnt(4)
v_mfma_f32_16x16x32_bf16 v[144:147], a[176:179], a[96:99], v[144:147]
buffer_load_dwordx4 a[4:7], v7, s[16:19], s37 offen offset:1024 sc1
v_mfma_f32_16x16x32_bf16 v[144:147], a[180:183], a[112:115], v[144:147]
v_mfma_f32_16x16x32_bf16 v[148:151], a[180:183], a[116:119], v[148:151]
v_mfma_f32_16x16x32_bf16 v[148:151], a[176:179], a[100:103], v[148:151]
ds_read_b64_tr_b16 a[192:193], v12 offset:0
ds_read_b64_tr_b16 a[194:195], v12 offset:4096
v_mfma_f32_16x16x32_bf16 v[152:155], a[176:179], a[104:107], v[152:155]
ds_read_b64_tr_b16 a[196:197], v12 offset:8192
ds_read_b64_tr_b16 a[198:199], v12 offset:12288
v_mfma_f32_16x16x32_bf16 v[152:155], a[180:183], a[120:123], v[152:155]
buffer_load_dwordx4 a[8:11], v7, s[16:19], s37 offen offset:2048 sc1
v_mfma_f32_16x16x32_bf16 v[156:159], a[180:183], a[124:127], v[156:159]
v_mfma_f32_16x16x32_bf16 v[156:159], a[176:179], a[108:111], v[156:159]
s_waitcnt lgkmcnt(4)
v_mfma_f32_16x16x32_bf16 v[172:175], a[184:187], a[108:111], v[172:175]
v_mfma_f32_16x16x32_bf16 v[172:175], a[188:191], a[124:127], v[172:175]
v_mfma_f32_16x16x32_bf16 v[168:171], a[188:191], a[120:123], v[168:171]
buffer_load_dwordx4 a[12:15], v7, s[16:19], s37 offen offset:3072 sc1
v_mfma_f32_16x16x32_bf16 v[168:171], a[184:187], a[104:107], v[168:171]
s_add_u32 s38, s37, 16384
ds_read_b64_tr_b16 a[200:201], v13 offset:0
ds_read_b64_tr_b16 a[202:203], v13 offset:4096
v_mfma_f32_16x16x32_bf16 v[164:167], a[184:187], a[100:103], v[164:167]
ds_read_b64_tr_b16 a[204:205], v13 offset:8192
ds_read_b64_tr_b16 a[206:207], v13 offset:12288
v_mfma_f32_16x16x32_bf16 v[164:167], a[188:191], a[116:119], v[164:167]
v_mfma_f32_16x16x32_bf16 v[160:163], a[188:191], a[112:115], v[160:163]
v_mfma_f32_16x16x32_bf16 v[160:163], a[184:187], a[96:99], v[160:163]
s_waitcnt lgkmcnt(4)
buffer_load_dwordx4 v21, s[44:47], s36 offen offset:0 lds
v_mfma_f32_16x16x32_bf16 v[176:179], a[192:195], a[96:99], v[176:179]
v_mfma_f32_16x16x32_bf16 v[176:179], a[196:199], a[112:115], v[176:179]
v_mfma_f32_16x16x32_bf16 v[180:183], a[196:199], a[116:119], v[180:183]
v_mfma_f32_16x16x32_bf16 v[180:183], a[192:195], a[100:103], v[180:183]
ds_read_b64_tr_b16 a[176:177], v14 offset:0
ds_read_b64_tr_b16 a[178:179], v14 offset:4096
v_mfma_f32_16x16x32_bf16 v[184:187], a[192:195], a[104:107], v[184:187]
buffer_load_dwordx4 a[16:19], v7, s[16:19], s38 offen offset:0 sc1
v_mfma_f32_16x16x32_bf16 v[184:187], a[196:199], a[120:123], v[184:187]
ds_read_b64_tr_b16 a[180:181], v14 offset:8192
ds_read_b64_tr_b16 a[182:183], v14 offset:12288
v_mfma_f32_16x16x32_bf16 v[188:191], a[196:199], a[124:127], v[188:191]
v_mfma_f32_16x16x32_bf16 v[188:191], a[192:195], a[108:111], v[188:191]
s_waitcnt lgkmcnt(4)
v_mfma_f32_16x16x32_bf16 v[204:207], a[200:203], a[108:111], v[204:207]
v_mfma_f32_16x16x32_bf16 v[204:207], a[204:207], a[124:127], v[204:207]
buffer_load_dwordx4 v22, s[44:47], s36 offen offset:1024 lds
v_mfma_f32_16x16x32_bf16 v[200:203], a[204:207], a[120:123], v[200:203]
v_mfma_f32_16x16x32_bf16 v[200:203], a[200:203], a[104:107], v[200:203]
ds_read_b64_tr_b16 a[184:185], v15 offset:0
ds_read_b64_tr_b16 a[186:187], v15 offset:4096
v_mfma_f32_16x16x32_bf16 v[196:199], a[200:203], a[100:103], v[196:199]
ds_read_b64_tr_b16 a[188:189], v15 offset:8192
ds_read_b64_tr_b16 a[190:191], v15 offset:12288
v_mfma_f32_16x16x32_bf16 v[196:199], a[204:207], a[116:119], v[196:199]
v_mfma_f32_16x16x32_bf16 v[192:195], a[204:207], a[112:115], v[192:195]
buffer_load_dwordx4 a[20:23], v7, s[16:19], s38 offen offset:1024 sc1
v_mfma_f32_16x16x32_bf16 v[192:195], a[200:203], a[96:99], v[192:195]
s_waitcnt lgkmcnt(4)
v_mfma_f32_16x16x32_bf16 v[208:211], a[176:179], a[96:99], v[208:211]
v_mfma_f32_16x16x32_bf16 v[208:211], a[180:183], a[112:115], v[208:211]
v_mfma_f32_16x16x32_bf16 v[212:215], a[180:183], a[116:119], v[212:215]
v_mfma_f32_16x16x32_bf16 v[212:215], a[176:179], a[100:103], v[212:215]
buffer_load_dwordx4 v23, s[44:47], s36 offen offset:2048 lds
v_mfma_f32_16x16x32_bf16 v[216:219], a[176:179], a[104:107], v[216:219]
ds_read_b64_tr_b16 a[192:193], v20 offset:26624
ds_read_b64_tr_b16 a[194:195], v20 offset:27136
v_mfma_f32_16x16x32_bf16 v[216:219], a[180:183], a[120:123], v[216:219]
ds_read_b64_tr_b16 a[196:197], v20 offset:27648
ds_read_b64_tr_b16 a[198:199], v20 offset:28160
v_mfma_f32_16x16x32_bf16 v[220:223], a[180:183], a[124:127], v[220:223]
v_mfma_f32_16x16x32_bf16 v[220:223], a[176:179], a[108:111], v[220:223]
s_waitcnt lgkmcnt(4)
v_mfma_f32_16x16x32_bf16 v[236:239], a[184:187], a[108:111], v[236:239]
buffer_load_dwordx4 a[24:27], v7, s[16:19], s38 offen offset:2048 sc1
v_mfma_f32_16x16x32_bf16 v[236:239], a[188:191], a[124:127], v[236:239]
v_mfma_f32_16x16x32_bf16 v[232:235], a[188:191], a[120:123], v[232:235]
v_mfma_f32_16x16x32_bf16 v[232:235], a[184:187], a[104:107], v[232:235]
s_waitcnt vmcnt(24) lgkmcnt(0)
s_barrier
ds_read_b64_tr_b16 a[200:201], v8 offset:16384
v_mfma_f32_16x16x32_bf16 v[228:231], a[184:187], a[100:103], v[228:231]
ds_read_b64_tr_b16 a[202:203], v8 offset:20480
ds_read_b64_tr_b16 a[204:205], v8 offset:24576
v_mfma_f32_16x16x32_bf16 v[228:231], a[188:191], a[116:119], v[228:231]
buffer_load_dwordx4 v24, s[44:47], s36 offen offset:3072 lds
v_mfma_f32_16x16x32_bf16 v[224:227], a[188:191], a[112:115], v[224:227]
s_xor_b32 s36, s25, 2
s_mul_i32 s36, s36, 147456
ds_read_b64_tr_b16 a[206:207], v8 offset:28672
v_mfma_f32_16x16x32_bf16 v[224:227], a[184:187], a[96:99], v[224:227]
s_waitcnt lgkmcnt(4)
s_add_u32 m0, s24, 49152
v_mfma_f32_16x16x32_bf16 v[240:243], a[192:195], a[96:99], v[240:243]
v_mfma_f32_16x16x32_bf16 v[240:243], a[196:199], a[112:115], v[240:243]
v_mfma_f32_16x16x32_bf16 v[244:247], a[196:199], a[116:119], v[244:247]
buffer_load_dwordx4 a[28:31], v7, s[16:19], s38 offen offset:3072 sc1
v_mfma_f32_16x16x32_bf16 v[244:247], a[192:195], a[100:103], v[244:247]
s_xor_b32 s37, s25, 2
ds_read_b64_tr_b16 a[176:177], v9 offset:16384
ds_read_b64_tr_b16 a[178:179], v9 offset:20480
v_mfma_f32_16x16x32_bf16 v[248:251], a[192:195], a[104:107], v[248:251]
s_mul_i32 s37, s37, 65536
ds_read_b64_tr_b16 a[180:181], v9 offset:24576
ds_read_b64_tr_b16 a[182:183], v9 offset:28672
v_mfma_f32_16x16x32_bf16 v[248:251], a[196:199], a[120:123], v[248:251]
s_add_u32 s37, s37, s48
v_mfma_f32_16x16x32_bf16 v[252:255], a[196:199], a[124:127], v[252:255]
v_mfma_f32_16x16x32_bf16 v[252:255], a[192:195], a[108:111], v[252:255]
s_waitcnt lgkmcnt(4) vmcnt(25)
buffer_load_dwordx4 a[32:35], v7, s[16:19], s37 offen offset:0 sc1
v_mfma_f32_16x16x32_bf16 v[112:115], a[200:203], a[144:147], v[112:115]
v_mfma_f32_16x16x32_bf16 v[112:115], a[204:207], a[160:163], v[112:115]
v_mfma_f32_16x16x32_bf16 v[116:119], a[204:207], a[164:167], v[116:119]
v_mfma_f32_16x16x32_bf16 v[116:119], a[200:203], a[148:151], v[116:119]
ds_read_b64_tr_b16 a[184:185], v10 offset:16384
ds_read_b64_tr_b16 a[186:187], v10 offset:20480
v_mfma_f32_16x16x32_bf16 v[120:123], a[200:203], a[152:155], v[120:123]
buffer_load_dwordx4 v21, s[44:47], s36 offen offset:0 lds
v_mfma_f32_16x16x32_bf16 v[120:123], a[204:207], a[168:171], v[120:123]
ds_read_b64_tr_b16 a[188:189], v10 offset:24576
ds_read_b64_tr_b16 a[190:191], v10 offset:28672
v_mfma_f32_16x16x32_bf16 v[124:127], a[204:207], a[172:175], v[124:127]
v_mfma_f32_16x16x32_bf16 v[124:127], a[200:203], a[156:159], v[124:127]
s_waitcnt lgkmcnt(4)
v_mfma_f32_16x16x32_bf16 v[140:143], a[176:179], a[156:159], v[140:143]
v_mfma_f32_16x16x32_bf16 v[140:143], a[180:183], a[172:175], v[140:143]
buffer_load_dwordx4 a[36:39], v7, s[16:19], s37 offen offset:1024 sc1
v_mfma_f32_16x16x32_bf16 v[136:139], a[180:183], a[168:171], v[136:139]
v_mfma_f32_16x16x32_bf16 v[136:139], a[176:179], a[152:155], v[136:139]
ds_read_b64_tr_b16 a[192:193], v11 offset:16384
ds_read_b64_tr_b16 a[194:195], v11 offset:20480
v_mfma_f32_16x16x32_bf16 v[132:135], a[176:179], a[148:151], v[132:135]
ds_read_b64_tr_b16 a[196:197], v11 offset:24576
ds_read_b64_tr_b16 a[198:199], v11 offset:28672
v_mfma_f32_16x16x32_bf16 v[132:135], a[180:183], a[164:167], v[132:135]
v_mfma_f32_16x16x32_bf16 v[128:131], a[180:183], a[160:163], v[128:131]
buffer_load_dwordx4 v22, s[44:47], s36 offen offset:1024 lds
v_mfma_f32_16x16x32_bf16 v[128:131], a[176:179], a[144:147], v[128:131]
s_waitcnt lgkmcnt(4)
v_mfma_f32_16x16x32_bf16 v[144:147], a[184:187], a[144:147], v[144:147]
v_mfma_f32_16x16x32_bf16 v[144:147], a[188:191], a[160:163], v[144:147]
v_mfma_f32_16x16x32_bf16 v[148:151], a[188:191], a[164:167], v[148:151]
v_mfma_f32_16x16x32_bf16 v[148:151], a[184:187], a[148:151], v[148:151]
buffer_load_dwordx4 a[40:43], v7, s[16:19], s37 offen offset:2048 sc1
v_mfma_f32_16x16x32_bf16 v[152:155], a[184:187], a[152:155], v[152:155]
ds_read_b64_tr_b16 a[200:201], v12 offset:16384
ds_read_b64_tr_b16 a[202:203], v12 offset:20480
v_mfma_f32_16x16x32_bf16 v[152:155], a[188:191], a[168:171], v[152:155]
ds_read_b64_tr_b16 a[204:205], v12 offset:24576
ds_read_b64_tr_b16 a[206:207], v12 offset:28672
v_mfma_f32_16x16x32_bf16 v[156:159], a[188:191], a[172:175], v[156:159]
v_mfma_f32_16x16x32_bf16 v[156:159], a[184:187], a[156:159], v[156:159]
s_waitcnt lgkmcnt(4)
v_mfma_f32_16x16x32_bf16 v[172:175], a[192:195], a[156:159], v[172:175]
buffer_load_dwordx4 v23, s[44:47], s36 offen offset:2048 lds
v_mfma_f32_16x16x32_bf16 v[172:175], a[196:199], a[172:175], v[172:175]
v_mfma_f32_16x16x32_bf16 v[168:171], a[196:199], a[168:171], v[168:171]
v_mfma_f32_16x16x32_bf16 v[168:171], a[192:195], a[152:155], v[168:171]
ds_read_b64_tr_b16 a[176:177], v13 offset:16384
ds_read_b64_tr_b16 a[178:179], v13 offset:20480
v_mfma_f32_16x16x32_bf16 v[164:167], a[192:195], a[148:151], v[164:167]
ds_read_b64_tr_b16 a[180:181], v13 offset:24576
ds_read_b64_tr_b16 a[182:183], v13 offset:28672
v_mfma_f32_16x16x32_bf16 v[164:167], a[196:199], a[164:167], v[164:167]
buffer_load_dwordx4 a[44:47], v7, s[16:19], s37 offen offset:3072 sc1
v_mfma_f32_16x16x32_bf16 v[160:163], a[196:199], a[160:163], v[160:163]
s_add_u32 s38, s37, 16384
v_mfma_f32_16x16x32_bf16 v[160:163], a[192:195], a[144:147], v[160:163]
s_waitcnt lgkmcnt(4)
v_mfma_f32_16x16x32_bf16 v[176:179], a[200:203], a[144:147], v[176:179]
v_mfma_f32_16x16x32_bf16 v[176:179], a[204:207], a[160:163], v[176:179]
v_mfma_f32_16x16x32_bf16 v[180:183], a[204:207], a[164:167], v[180:183]
buffer_load_dwordx4 v24, s[44:47], s36 offen offset:3072 lds
v_mfma_f32_16x16x32_bf16 v[180:183], a[200:203], a[148:151], v[180:183]
s_xor_b32 s36, s25, 3
ds_read_b64_tr_b16 a[184:185], v14 offset:16384
ds_read_b64_tr_b16 a[186:187], v14 offset:20480
v_mfma_f32_16x16x32_bf16 v[184:187], a[200:203], a[152:155], v[184:187]
s_mul_i32 s36, s36, 147456
ds_read_b64_tr_b16 a[188:189], v14 offset:24576
ds_read_b64_tr_b16 a[190:191], v14 offset:28672
v_mfma_f32_16x16x32_bf16 v[184:187], a[204:207], a[168:171], v[184:187]
s_add_u32 m0, s39, 143360
v_mfma_f32_16x16x32_bf16 v[188:191], a[204:207], a[172:175], v[188:191]
v_mfma_f32_16x16x32_bf16 v[188:191], a[200:203], a[156:159], v[188:191]
s_waitcnt lgkmcnt(4)
buffer_load_dwordx4 a[48:51], v7, s[16:19], s38 offen offset:0 sc1
v_mfma_f32_16x16x32_bf16 v[204:207], a[176:179], a[156:159], v[204:207]
v_mfma_f32_16x16x32_bf16 v[204:207], a[180:183], a[172:175], v[204:207]
v_mfma_f32_16x16x32_bf16 v[200:203], a[180:183], a[168:171], v[200:203]
v_mfma_f32_16x16x32_bf16 v[200:203], a[176:179], a[152:155], v[200:203]
ds_read_b64_tr_b16 a[192:193], v15 offset:16384
ds_read_b64_tr_b16 a[194:195], v15 offset:20480
v_mfma_f32_16x16x32_bf16 v[196:199], a[176:179], a[148:151], v[196:199]
buffer_load_dwordx4 a[52:55], v7, s[16:19], s38 offen offset:1024 sc1
v_mfma_f32_16x16x32_bf16 v[196:199], a[180:183], a[164:167], v[196:199]
ds_read_b64_tr_b16 a[196:197], v15 offset:24576
ds_read_b64_tr_b16 a[198:199], v15 offset:28672
v_mfma_f32_16x16x32_bf16 v[192:195], a[180:183], a[160:163], v[192:195]
v_mfma_f32_16x16x32_bf16 v[192:195], a[176:179], a[144:147], v[192:195]
s_waitcnt lgkmcnt(4)
v_mfma_f32_16x16x32_bf16 v[208:211], a[184:187], a[144:147], v[208:211]
v_mfma_f32_16x16x32_bf16 v[208:211], a[188:191], a[160:163], v[208:211]
buffer_load_dwordx4 a[56:59], v7, s[16:19], s38 offen offset:2048 sc1
v_mfma_f32_16x16x32_bf16 v[212:215], a[188:191], a[164:167], v[212:215]
v_mfma_f32_16x16x32_bf16 v[212:215], a[184:187], a[148:151], v[212:215]
ds_read_b64_tr_b16 a[200:201], v20 offset:30720
ds_read_b64_tr_b16 a[202:203], v20 offset:31232
v_mfma_f32_16x16x32_bf16 v[216:219], a[184:187], a[152:155], v[216:219]
ds_read_b64_tr_b16 a[204:205], v20 offset:31744
ds_read_b64_tr_b16 a[206:207], v20 offset:32256
v_mfma_f32_16x16x32_bf16 v[216:219], a[188:191], a[168:171], v[216:219]
v_mfma_f32_16x16x32_bf16 v[220:223], a[188:191], a[172:175], v[220:223]
buffer_load_dwordx4 v25, s[44:47], s36 offen lds
v_mfma_f32_16x16x32_bf16 v[220:223], a[184:187], a[156:159], v[220:223]
s_waitcnt lgkmcnt(4)
s_xor_b32 s36, s25, 2
s_mul_i32 s36, s36, 147456
v_mfma_f32_16x16x32_bf16 v[236:239], a[192:195], a[156:159], v[236:239]
s_add_u32 s36, s36, 73728
s_add_u32 m0, s24, 65536
v_mfma_f32_16x16x32_bf16 v[236:239], a[196:199], a[172:175], v[236:239]
v_mfma_f32_16x16x32_bf16 v[232:235], a[196:199], a[168:171], v[232:235]
v_mfma_f32_16x16x32_bf16 v[232:235], a[192:195], a[152:155], v[232:235]
s_waitcnt vmcnt(29) lgkmcnt(0)
s_barrier
buffer_load_dwordx4 a[60:63], v7, s[16:19], s38 offen offset:3072 sc1
v_mfma_f32_16x16x32_bf16 v[228:231], a[192:195], a[148:151], v[228:231]
s_xor_b32 s37, s25, 2
ds_read_b64_tr_b16 a[176:177], v8 offset:32768
ds_read_b64_tr_b16 a[178:179], v8 offset:36864
v_mfma_f32_16x16x32_bf16 v[228:231], a[196:199], a[164:167], v[228:231]
s_mul_i32 s37, s37, 65536
ds_read_b64_tr_b16 a[180:181], v8 offset:40960
ds_read_b64_tr_b16 a[182:183], v8 offset:45056
v_mfma_f32_16x16x32_bf16 v[224:227], a[196:199], a[160:163], v[224:227]
s_add_u32 s37, s37, s48
s_add_u32 s37, s37, 32768
v_mfma_f32_16x16x32_bf16 v[224:227], a[192:195], a[144:147], v[224:227]
s_waitcnt lgkmcnt(4)
v_mfma_f32_16x16x32_bf16 v[240:243], a[200:203], a[144:147], v[240:243]
buffer_load_dwordx4 a[64:67], v7, s[16:19], s37 offen offset:0 sc1
v_mfma_f32_16x16x32_bf16 v[240:243], a[204:207], a[160:163], v[240:243]
v_mfma_f32_16x16x32_bf16 v[244:247], a[204:207], a[164:167], v[244:247]
v_mfma_f32_16x16x32_bf16 v[244:247], a[200:203], a[148:151], v[244:247]
ds_read_b64_tr_b16 a[184:185], v9 offset:32768
ds_read_b64_tr_b16 a[186:187], v9 offset:36864
v_mfma_f32_16x16x32_bf16 v[248:251], a[200:203], a[152:155], v[248:251]
ds_read_b64_tr_b16 a[188:189], v9 offset:40960
ds_read_b64_tr_b16 a[190:191], v9 offset:45056
v_mfma_f32_16x16x32_bf16 v[248:251], a[204:207], a[168:171], v[248:251]
buffer_load_dwordx4 a[68:71], v7, s[16:19], s37 offen offset:1024 sc1
v_mfma_f32_16x16x32_bf16 v[252:255], a[204:207], a[172:175], v[252:255]
v_mfma_f32_16x16x32_bf16 v[252:255], a[200:203], a[156:159], v[252:255]
s_waitcnt lgkmcnt(4) vmcnt(27)
v_mfma_f32_16x16x32_bf16 v[112:115], a[176:179], a[208:211], v[112:115]
v_mfma_f32_16x16x32_bf16 v[112:115], a[180:183], a[224:227], v[112:115]
v_mfma_f32_16x16x32_bf16 v[116:119], a[180:183], a[228:231], v[116:119]
buffer_load_dwordx4 a[72:75], v7, s[16:19], s37 offen offset:2048 sc1
v_mfma_f32_16x16x32_bf16 v[116:119], a[176:179], a[212:215], v[116:119]
ds_read_b64_tr_b16 a[192:193], v10 offset:32768
ds_read_b64_tr_b16 a[194:195], v10 offset:36864
v_mfma_f32_16x16x32_bf16 v[120:123], a[176:179], a[216:219], v[120:123]
ds_read_b64_tr_b16 a[196:197], v10 offset:40960
ds_read_b64_tr_b16 a[198:199], v10 offset:45056
v_mfma_f32_16x16x32_bf16 v[120:123], a[180:183], a[232:235], v[120:123]
v_mfma_f32_16x16x32_bf16 v[124:127], a[180:183], a[236:239], v[124:127]
v_mfma_f32_16x16x32_bf16 v[124:127], a[176:179], a[220:223], v[124:127]
s_waitcnt lgkmcnt(4)
buffer_load_dwordx4 a[76:79], v7, s[16:19], s37 offen offset:3072 sc1
v_mfma_f32_16x16x32_bf16 v[140:143], a[184:187], a[220:223], v[140:143]
s_add_u32 s38, s37, 16384
v_mfma_f32_16x16x32_bf16 v[140:143], a[188:191], a[236:239], v[140:143]
v_mfma_f32_16x16x32_bf16 v[136:139], a[188:191], a[232:235], v[136:139]
v_mfma_f32_16x16x32_bf16 v[136:139], a[184:187], a[216:219], v[136:139]
ds_read_b64_tr_b16 a[200:201], v11 offset:32768
ds_read_b64_tr_b16 a[202:203], v11 offset:36864
v_mfma_f32_16x16x32_bf16 v[132:135], a[184:187], a[212:215], v[132:135]
buffer_load_dwordx4 v21, s[44:47], s36 offen offset:0 lds
v_mfma_f32_16x16x32_bf16 v[132:135], a[188:191], a[228:231], v[132:135]
ds_read_b64_tr_b16 a[204:205], v11 offset:40960
ds_read_b64_tr_b16 a[206:207], v11 offset:45056
v_mfma_f32_16x16x32_bf16 v[128:131], a[188:191], a[224:227], v[128:131]
v_mfma_f32_16x16x32_bf16 v[128:131], a[184:187], a[208:211], v[128:131]
s_waitcnt lgkmcnt(4)
v_mfma_f32_16x16x32_bf16 v[144:147], a[192:195], a[208:211], v[144:147]
v_mfma_f32_16x16x32_bf16 v[144:147], a[196:199], a[224:227], v[144:147]
buffer_load_dwordx4 a[80:83], v7, s[16:19], s38 offen offset:0 sc1
v_mfma_f32_16x16x32_bf16 v[148:151], a[196:199], a[228:231], v[148:151]
v_mfma_f32_16x16x32_bf16 v[148:151], a[192:195], a[212:215], v[148:151]
ds_read_b64_tr_b16 a[176:177], v12 offset:32768
ds_read_b64_tr_b16 a[178:179], v12 offset:36864
v_mfma_f32_16x16x32_bf16 v[152:155], a[192:195], a[216:219], v[152:155]
ds_read_b64_tr_b16 a[180:181], v12 offset:40960
ds_read_b64_tr_b16 a[182:183], v12 offset:45056
v_mfma_f32_16x16x32_bf16 v[152:155], a[196:199], a[232:235], v[152:155]
v_mfma_f32_16x16x32_bf16 v[156:159], a[196:199], a[236:239], v[156:159]
buffer_load_dwordx4 v22, s[44:47], s36 offen offset:1024 lds
v_mfma_f32_16x16x32_bf16 v[156:159], a[192:195], a[220:223], v[156:159]
s_waitcnt lgkmcnt(4)
v_mfma_f32_16x16x32_bf16 v[172:175], a[200:203], a[220:223], v[172:175]
v_mfma_f32_16x16x32_bf16 v[172:175], a[204:207], a[236:239], v[172:175]
v_mfma_f32_16x16x32_bf16 v[168:171], a[204:207], a[232:235], v[168:171]
v_mfma_f32_16x16x32_bf16 v[168:171], a[200:203], a[216:219], v[168:171]
buffer_load_dwordx4 a[84:87], v7, s[16:19], s38 offen offset:1024 sc1
v_mfma_f32_16x16x32_bf16 v[164:167], a[200:203], a[212:215], v[164:167]
ds_read_b64_tr_b16 a[184:185], v13 offset:32768
ds_read_b64_tr_b16 a[186:187], v13 offset:36864
v_mfma_f32_16x16x32_bf16 v[164:167], a[204:207], a[228:231], v[164:167]
ds_read_b64_tr_b16 a[188:189], v13 offset:40960
ds_read_b64_tr_b16 a[190:191], v13 offset:45056
v_mfma_f32_16x16x32_bf16 v[160:163], a[204:207], a[224:227], v[160:163]
v_mfma_f32_16x16x32_bf16 v[160:163], a[200:203], a[208:211], v[160:163]
s_waitcnt lgkmcnt(4)
v_mfma_f32_16x16x32_bf16 v[176:179], a[176:179], a[208:211], v[176:179]
buffer_load_dwordx4 v23, s[44:47], s36 offen offset:2048 lds
v_mfma_f32_16x16x32_bf16 v[176:179], a[180:183], a[224:227], v[176:179]
v_mfma_f32_16x16x32_bf16 v[180:183], a[180:183], a[228:231], v[180:183]
v_mfma_f32_16x16x32_bf16 v[180:183], a[176:179], a[212:215], v[180:183]
ds_read_b64_tr_b16 a[192:193], v14 offset:32768
ds_read_b64_tr_b16 a[194:195], v14 offset:36864
v_mfma_f32_16x16x32_bf16 v[184:187], a[176:179], a[216:219], v[184:187]
ds_read_b64_tr_b16 a[196:197], v14 offset:40960
ds_read_b64_tr_b16 a[198:199], v14 offset:45056
v_mfma_f32_16x16x32_bf16 v[184:187], a[180:183], a[232:235], v[184:187]
buffer_load_dwordx4 a[88:91], v7, s[16:19], s38 offen offset:2048 sc1
v_mfma_f32_16x16x32_bf16 v[188:191], a[180:183], a[236:239], v[188:191]
v_mfma_f32_16x16x32_bf16 v[188:191], a[176:179], a[220:223], v[188:191]
s_waitcnt lgkmcnt(4)
v_mfma_f32_16x16x32_bf16 v[204:207], a[184:187], a[220:223], v[204:207]
v_mfma_f32_16x16x32_bf16 v[204:207], a[188:191], a[236:239], v[204:207]
v_mfma_f32_16x16x32_bf16 v[200:203], a[188:191], a[232:235], v[200:203]
buffer_load_dwordx4 v24, s[44:47], s36 offen offset:3072 lds
v_mfma_f32_16x16x32_bf16 v[200:203], a[184:187], a[216:219], v[200:203]
s_xor_b32 s36, s25, 3
ds_read_b64_tr_b16 a[200:201], v15 offset:32768
ds_read_b64_tr_b16 a[202:203], v15 offset:36864
v_mfma_f32_16x16x32_bf16 v[196:199], a[184:187], a[212:215], v[196:199]
s_mul_i32 s36, s36, 147456
ds_read_b64_tr_b16 a[204:205], v15 offset:40960
ds_read_b64_tr_b16 a[206:207], v15 offset:45056
v_mfma_f32_16x16x32_bf16 v[196:199], a[188:191], a[228:231], v[196:199]
s_add_u32 m0, s24, 98304
v_mfma_f32_16x16x32_bf16 v[192:195], a[188:191], a[224:227], v[192:195]
v_mfma_f32_16x16x32_bf16 v[192:195], a[184:187], a[208:211], v[192:195]
s_waitcnt lgkmcnt(4)
buffer_load_dwordx4 a[92:95], v7, s[16:19], s38 offen offset:3072 sc1
v_mfma_f32_16x16x32_bf16 v[208:211], a[192:195], a[208:211], v[208:211]
s_xor_b32 s37, s25, 3
s_mul_i32 s37, s37, 65536
s_add_u32 s37, s37, s48
v_mfma_f32_16x16x32_bf16 v[208:211], a[196:199], a[224:227], v[208:211]
v_mfma_f32_16x16x32_bf16 v[212:215], a[196:199], a[228:231], v[212:215]
v_mfma_f32_16x16x32_bf16 v[212:215], a[192:195], a[212:215], v[212:215]
ds_read_b64_tr_b16 a[176:177], v20 offset:4096
ds_read_b64_tr_b16 a[178:179], v20 offset:4608
v_mfma_f32_16x16x32_bf16 v[216:219], a[192:195], a[216:219], v[216:219]
buffer_load_dwordx4 a[240:243], v7, s[16:19], s37 offen offset:0 sc1
v_mfma_f32_16x16x32_bf16 v[216:219], a[196:199], a[232:235], v[216:219]
ds_read_b64_tr_b16 a[180:181], v20 offset:5120
ds_read_b64_tr_b16 a[182:183], v20 offset:5632
v_mfma_f32_16x16x32_bf16 v[220:223], a[196:199], a[236:239], v[220:223]
v_mfma_f32_16x16x32_bf16 v[220:223], a[192:195], a[220:223], v[220:223]
s_waitcnt lgkmcnt(4)
v_mfma_f32_16x16x32_bf16 v[236:239], a[200:203], a[220:223], v[236:239]
v_mfma_f32_16x16x32_bf16 v[236:239], a[204:207], a[236:239], v[236:239]
buffer_load_dwordx4 a[244:247], v7, s[16:19], s37 offen offset:1024 sc1
v_mfma_f32_16x16x32_bf16 v[232:235], a[204:207], a[232:235], v[232:235]
v_mfma_f32_16x16x32_bf16 v[232:235], a[200:203], a[216:219], v[232:235]
s_waitcnt vmcnt(28) lgkmcnt(0)
s_barrier
ds_read_b64_tr_b16 a[184:185], v40 offset:16384
v_mfma_f32_16x16x32_bf16 v[228:231], a[200:203], a[212:215], v[228:231]
ds_read_b64_tr_b16 a[186:187], v40 offset:20480
ds_read_b64_tr_b16 a[188:189], v40 offset:24576
v_mfma_f32_16x16x32_bf16 v[228:231], a[204:207], a[228:231], v[228:231]
ds_read_b64_tr_b16 a[190:191], v40 offset:28672
v_mfma_f32_16x16x32_bf16 v[224:227], a[204:207], a[224:227], v[224:227]
buffer_load_dwordx4 a[248:251], v7, s[16:19], s37 offen offset:2048 sc1
v_mfma_f32_16x16x32_bf16 v[224:227], a[200:203], a[208:211], v[224:227]
s_waitcnt lgkmcnt(4)
v_mfma_f32_16x16x32_bf16 v[240:243], a[176:179], a[208:211], v[240:243]
v_mfma_f32_16x16x32_bf16 v[240:243], a[180:183], a[224:227], v[240:243]
v_mfma_f32_16x16x32_bf16 v[244:247], a[180:183], a[228:231], v[244:247]
v_mfma_f32_16x16x32_bf16 v[244:247], a[176:179], a[212:215], v[244:247]
buffer_load_dwordx4 a[252:255], v7, s[16:19], s37 offen offset:3072 sc1
v_mfma_f32_16x16x32_bf16 v[248:251], a[176:179], a[216:219], v[248:251]
s_add_u32 s38, s37, 16384
ds_read_b64_tr_b16 a[192:193], v41 offset:16384
ds_read_b64_tr_b16 a[194:195], v41 offset:20480
v_mfma_f32_16x16x32_bf16 v[248:251], a[180:183], a[232:235], v[248:251]
ds_read_b64_tr_b16 a[196:197], v41 offset:24576
ds_read_b64_tr_b16 a[198:199], v41 offset:28672
v_mfma_f32_16x16x32_bf16 v[252:255], a[180:183], a[236:239], v[252:255]
v_mfma_f32_16x16x32_bf16 v[252:255], a[176:179], a[220:223], v[252:255]
s_waitcnt lgkmcnt(4) vmcnt(29)
v_mfma_f32_16x16x32_bf16 v[112:115], a[184:187], a[0:3], v[112:115]
buffer_load_dwordx4 a[128:131], v7, s[16:19], s38 offen offset:0 sc1
v_mfma_f32_16x16x32_bf16 v[112:115], a[188:191], a[16:19], v[112:115]
v_mfma_f32_16x16x32_bf16 v[116:119], a[188:191], a[20:23], v[116:119]
v_mfma_f32_16x16x32_bf16 v[116:119], a[184:187], a[4:7], v[116:119]
ds_read_b64_tr_b16 a[200:201], v42 offset:16384
ds_read_b64_tr_b16 a[202:203], v42 offset:20480
v_mfma_f32_16x16x32_bf16 v[120:123], a[184:187], a[8:11], v[120:123]
ds_read_b64_tr_b16 a[204:205], v42 offset:24576
ds_read_b64_tr_b16 a[206:207], v42 offset:28672
v_mfma_f32_16x16x32_bf16 v[120:123], a[188:191], a[24:27], v[120:123]
buffer_load_dwordx4 a[132:135], v7, s[16:19], s38 offen offset:1024 sc1
v_mfma_f32_16x16x32_bf16 v[124:127], a[188:191], a[28:31], v[124:127]
v_mfma_f32_16x16x32_bf16 v[124:127], a[184:187], a[12:15], v[124:127]
s_waitcnt lgkmcnt(4)
v_mfma_f32_16x16x32_bf16 v[140:143], a[192:195], a[12:15], v[140:143]
v_mfma_f32_16x16x32_bf16 v[140:143], a[196:199], a[28:31], v[140:143]
v_mfma_f32_16x16x32_bf16 v[136:139], a[196:199], a[24:27], v[136:139]
buffer_load_dwordx4 a[136:139], v7, s[16:19], s38 offen offset:2048 sc1
v_mfma_f32_16x16x32_bf16 v[136:139], a[192:195], a[8:11], v[136:139]
ds_read_b64_tr_b16 a[176:177], v43 offset:16384
ds_read_b64_tr_b16 a[178:179], v43 offset:20480
v_mfma_f32_16x16x32_bf16 v[132:135], a[192:195], a[4:7], v[132:135]
ds_read_b64_tr_b16 a[180:181], v43 offset:24576
ds_read_b64_tr_b16 a[182:183], v43 offset:28672
v_mfma_f32_16x16x32_bf16 v[132:135], a[196:199], a[20:23], v[132:135]
v_mfma_f32_16x16x32_bf16 v[128:131], a[196:199], a[16:19], v[128:131]
v_mfma_f32_16x16x32_bf16 v[128:131], a[192:195], a[0:3], v[128:131]
s_waitcnt lgkmcnt(4)
buffer_load_dwordx4 a[140:143], v7, s[16:19], s38 offen offset:3072 sc1
v_mfma_f32_16x16x32_bf16 v[144:147], a[200:203], a[0:3], v[144:147]
s_xor_b32 s37, s25, 3
s_mul_i32 s37, s37, 65536
s_add_u32 s37, s37, s48
v_mfma_f32_16x16x32_bf16 v[144:147], a[204:207], a[16:19], v[144:147]
s_add_u32 s37, s37, 32768
v_mfma_f32_16x16x32_bf16 v[148:151], a[204:207], a[20:23], v[148:151]
v_mfma_f32_16x16x32_bf16 v[148:151], a[200:203], a[4:7], v[148:151]
ds_read_b64_tr_b16 a[184:185], v44 offset:16384
ds_read_b64_tr_b16 a[186:187], v44 offset:20480
v_mfma_f32_16x16x32_bf16 v[152:155], a[200:203], a[8:11], v[152:155]
buffer_load_dwordx4 a[96:99], v7, s[16:19], s37 offen offset:0 sc1
v_mfma_f32_16x16x32_bf16 v[152:155], a[204:207], a[24:27], v[152:155]
ds_read_b64_tr_b16 a[188:189], v44 offset:24576
ds_read_b64_tr_b16 a[190:191], v44 offset:28672
v_mfma_f32_16x16x32_bf16 v[156:159], a[204:207], a[28:31], v[156:159]
v_mfma_f32_16x16x32_bf16 v[156:159], a[200:203], a[12:15], v[156:159]
s_waitcnt lgkmcnt(4)
v_mfma_f32_16x16x32_bf16 v[172:175], a[176:179], a[12:15], v[172:175]
v_mfma_f32_16x16x32_bf16 v[172:175], a[180:183], a[28:31], v[172:175]
buffer_load_dwordx4 a[100:103], v7, s[16:19], s37 offen offset:1024 sc1
v_mfma_f32_16x16x32_bf16 v[168:171], a[180:183], a[24:27], v[168:171]
v_mfma_f32_16x16x32_bf16 v[168:171], a[176:179], a[8:11], v[168:171]
ds_read_b64_tr_b16 a[192:193], v45 offset:16384
ds_read_b64_tr_b16 a[194:195], v45 offset:20480
v_mfma_f32_16x16x32_bf16 v[164:167], a[176:179], a[4:7], v[164:167]
ds_read_b64_tr_b16 a[196:197], v45 offset:24576
ds_read_b64_tr_b16 a[198:199], v45 offset:28672
v_mfma_f32_16x16x32_bf16 v[164:167], a[180:183], a[20:23], v[164:167]
v_mfma_f32_16x16x32_bf16 v[160:163], a[180:183], a[16:19], v[160:163]
buffer_load_dwordx4 a[104:107], v7, s[16:19], s37 offen offset:2048 sc1
v_mfma_f32_16x16x32_bf16 v[160:163], a[176:179], a[0:3], v[160:163]
s_waitcnt lgkmcnt(4)
v_mfma_f32_16x16x32_bf16 v[176:179], a[184:187], a[0:3], v[176:179]
v_mfma_f32_16x16x32_bf16 v[176:179], a[188:191], a[16:19], v[176:179]
v_mfma_f32_16x16x32_bf16 v[180:183], a[188:191], a[20:23], v[180:183]
v_mfma_f32_16x16x32_bf16 v[180:183], a[184:187], a[4:7], v[180:183]
buffer_load_dwordx4 a[108:111], v7, s[16:19], s37 offen offset:3072 sc1
v_mfma_f32_16x16x32_bf16 v[184:187], a[184:187], a[8:11], v[184:187]
s_add_u32 s38, s37, 16384
ds_read_b64_tr_b16 a[200:201], v46 offset:16384
ds_read_b64_tr_b16 a[202:203], v46 offset:20480
v_mfma_f32_16x16x32_bf16 v[184:187], a[188:191], a[24:27], v[184:187]
ds_read_b64_tr_b16 a[204:205], v46 offset:24576
ds_read_b64_tr_b16 a[206:207], v46 offset:28672
v_mfma_f32_16x16x32_bf16 v[188:191], a[188:191], a[28:31], v[188:191]
v_mfma_f32_16x16x32_bf16 v[188:191], a[184:187], a[12:15], v[188:191]
s_waitcnt lgkmcnt(4)
v_mfma_f32_16x16x32_bf16 v[204:207], a[192:195], a[12:15], v[204:207]
buffer_load_dwordx4 a[112:115], v7, s[16:19], s38 offen offset:0 sc1
v_mfma_f32_16x16x32_bf16 v[204:207], a[196:199], a[28:31], v[204:207]
v_mfma_f32_16x16x32_bf16 v[200:203], a[196:199], a[24:27], v[200:203]
v_mfma_f32_16x16x32_bf16 v[200:203], a[192:195], a[8:11], v[200:203]
ds_read_b64_tr_b16 a[176:177], v47 offset:16384
ds_read_b64_tr_b16 a[178:179], v47 offset:20480
v_mfma_f32_16x16x32_bf16 v[196:199], a[192:195], a[4:7], v[196:199]
ds_read_b64_tr_b16 a[180:181], v47 offset:24576
ds_read_b64_tr_b16 a[182:183], v47 offset:28672
v_mfma_f32_16x16x32_bf16 v[196:199], a[196:199], a[20:23], v[196:199]
buffer_load_dwordx4 a[116:119], v7, s[16:19], s38 offen offset:1024 sc1
v_mfma_f32_16x16x32_bf16 v[192:195], a[196:199], a[16:19], v[192:195]
v_mfma_f32_16x16x32_bf16 v[192:195], a[192:195], a[0:3], v[192:195]
s_waitcnt lgkmcnt(4)
v_mfma_f32_16x16x32_bf16 v[208:211], a[200:203], a[0:3], v[208:211]
v_mfma_f32_16x16x32_bf16 v[208:211], a[204:207], a[16:19], v[208:211]
v_mfma_f32_16x16x32_bf16 v[212:215], a[204:207], a[20:23], v[212:215]
buffer_load_dwordx4 v21, s[44:47], s36 offen offset:0 lds
v_mfma_f32_16x16x32_bf16 v[212:215], a[200:203], a[4:7], v[212:215]
ds_read_b64_tr_b16 a[184:185], v20 offset:6144
ds_read_b64_tr_b16 a[186:187], v20 offset:6656
v_mfma_f32_16x16x32_bf16 v[216:219], a[200:203], a[8:11], v[216:219]
ds_read_b64_tr_b16 a[188:189], v20 offset:7168
ds_read_b64_tr_b16 a[190:191], v20 offset:7680
v_mfma_f32_16x16x32_bf16 v[216:219], a[204:207], a[24:27], v[216:219]
v_mfma_f32_16x16x32_bf16 v[220:223], a[204:207], a[28:31], v[220:223]
v_mfma_f32_16x16x32_bf16 v[220:223], a[200:203], a[12:15], v[220:223]
s_waitcnt lgkmcnt(4)
buffer_load_dwordx4 a[120:123], v7, s[16:19], s38 offen offset:2048 sc1
v_mfma_f32_16x16x32_bf16 v[236:239], a[176:179], a[12:15], v[236:239]
v_mfma_f32_16x16x32_bf16 v[236:239], a[180:183], a[28:31], v[236:239]
v_mfma_f32_16x16x32_bf16 v[232:235], a[180:183], a[24:27], v[232:235]
v_mfma_f32_16x16x32_bf16 v[232:235], a[176:179], a[8:11], v[232:235]
s_waitcnt vmcnt(33) lgkmcnt(0)
s_barrier
ds_read_b64_tr_b16 a[192:193], v8 offset:49152
v_mfma_f32_16x16x32_bf16 v[228:231], a[176:179], a[4:7], v[228:231]
buffer_load_dwordx4 v22, s[44:47], s36 offen offset:1024 lds
v_mfma_f32_16x16x32_bf16 v[228:231], a[180:183], a[20:23], v[228:231]
ds_read_b64_tr_b16 a[194:195], v8 offset:53248
ds_read_b64_tr_b16 a[196:197], v8 offset:57344
v_mfma_f32_16x16x32_bf16 v[224:227], a[180:183], a[16:19], v[224:227]
ds_read_b64_tr_b16 a[198:199], v8 offset:61440
v_mfma_f32_16x16x32_bf16 v[224:227], a[176:179], a[0:3], v[224:227]
s_waitcnt lgkmcnt(4)
v_mfma_f32_16x16x32_bf16 v[240:243], a[184:187], a[0:3], v[240:243]
v_mfma_f32_16x16x32_bf16 v[240:243], a[188:191], a[16:19], v[240:243]
buffer_load_dwordx4 a[124:127], v7, s[16:19], s38 offen offset:3072 sc1
v_mfma_f32_16x16x32_bf16 v[244:247], a[188:191], a[20:23], v[244:247]
s_mov_b32 s37, s42
s_mul_i32 s37, s37, 65536
s_add_u32 s37, s37, s48
v_mfma_f32_16x16x32_bf16 v[244:247], a[184:187], a[4:7], v[244:247]
ds_read_b64_tr_b16 a[200:201], v9 offset:49152
ds_read_b64_tr_b16 a[202:203], v9 offset:53248
v_mfma_f32_16x16x32_bf16 v[248:251], a[184:187], a[8:11], v[248:251]
ds_read_b64_tr_b16 a[204:205], v9 offset:57344
ds_read_b64_tr_b16 a[206:207], v9 offset:61440
v_mfma_f32_16x16x32_bf16 v[248:251], a[188:191], a[24:27], v[248:251]
v_mfma_f32_16x16x32_bf16 v[252:255], a[188:191], a[28:31], v[252:255]
buffer_load_dwordx4 v23, s[44:47], s36 offen offset:2048 lds
v_mfma_f32_16x16x32_bf16 v[252:255], a[184:187], a[12:15], v[252:255]
s_waitcnt lgkmcnt(4) vmcnt(31)
v_mfma_f32_16x16x32_bf16 v[112:115], a[192:195], a[32:35], v[112:115]
v_mfma_f32_16x16x32_bf16 v[112:115], a[196:199], a[48:51], v[112:115]
v_mfma_f32_16x16x32_bf16 v[116:119], a[196:199], a[52:55], v[116:119]
v_mfma_f32_16x16x32_bf16 v[116:119], a[192:195], a[36:39], v[116:119]
buffer_load_dwordx4 v24, s[44:47], s36 offen offset:3072 lds
v_mfma_f32_16x16x32_bf16 v[120:123], a[192:195], a[40:43], v[120:123]
s_xor_b32 s36, s25, 3
ds_read_b64_tr_b16 a[176:177], v10 offset:49152
ds_read_b64_tr_b16 a[178:179], v10 offset:53248
v_mfma_f32_16x16x32_bf16 v[120:123], a[196:199], a[56:59], v[120:123]
s_mul_i32 s36, s36, 147456
ds_read_b64_tr_b16 a[180:181], v10 offset:57344
ds_read_b64_tr_b16 a[182:183], v10 offset:61440
v_mfma_f32_16x16x32_bf16 v[124:127], a[196:199], a[60:63], v[124:127]
s_add_u32 s36, s36, 73728
s_add_u32 m0, s24, 114688
v_mfma_f32_16x16x32_bf16 v[124:127], a[192:195], a[44:47], v[124:127]
s_waitcnt lgkmcnt(4)
v_mfma_f32_16x16x32_bf16 v[140:143], a[200:203], a[44:47], v[140:143]
buffer_load_dwordx4 a[144:147], v7, s[16:19], s37 offen offset:0 sc1
v_mfma_f32_16x16x32_bf16 v[140:143], a[204:207], a[60:63], v[140:143]
v_mfma_f32_16x16x32_bf16 v[136:139], a[204:207], a[56:59], v[136:139]
v_mfma_f32_16x16x32_bf16 v[136:139], a[200:203], a[40:43], v[136:139]
ds_read_b64_tr_b16 a[184:185], v11 offset:49152
ds_read_b64_tr_b16 a[186:187], v11 offset:53248
v_mfma_f32_16x16x32_bf16 v[132:135], a[200:203], a[36:39], v[132:135]
ds_read_b64_tr_b16 a[188:189], v11 offset:57344
ds_read_b64_tr_b16 a[190:191], v11 offset:61440
v_mfma_f32_16x16x32_bf16 v[132:135], a[204:207], a[52:55], v[132:135]
buffer_load_dwordx4 a[148:151], v7, s[16:19], s37 offen offset:1024 sc1
v_mfma_f32_16x16x32_bf16 v[128:131], a[204:207], a[48:51], v[128:131]
v_mfma_f32_16x16x32_bf16 v[128:131], a[200:203], a[32:35], v[128:131]
s_waitcnt lgkmcnt(4)
v_mfma_f32_16x16x32_bf16 v[144:147], a[176:179], a[32:35], v[144:147]
s_lshl_b32 s27, s55, 3
v_mfma_f32_16x16x32_bf16 v[144:147], a[180:183], a[48:51], v[144:147]
v_mfma_f32_16x16x32_bf16 v[148:151], a[180:183], a[52:55], v[148:151]
buffer_load_dwordx4 a[152:155], v7, s[16:19], s37 offen offset:2048 sc1
v_mfma_f32_16x16x32_bf16 v[148:151], a[176:179], a[36:39], v[148:151]
s_lshl_b32 s22, s23, 1
ds_read_b64_tr_b16 a[192:193], v12 offset:49152
ds_read_b64_tr_b16 a[194:195], v12 offset:53248
v_mfma_f32_16x16x32_bf16 v[152:155], a[176:179], a[40:43], v[152:155]
ds_read_b64_tr_b16 a[196:197], v12 offset:57344
ds_read_b64_tr_b16 a[198:199], v12 offset:61440
v_mfma_f32_16x16x32_bf16 v[152:155], a[180:183], a[56:59], v[152:155]
v_mfma_f32_16x16x32_bf16 v[156:159], a[180:183], a[60:63], v[156:159]
s_add_u32 s27, s27, s22
v_mfma_f32_16x16x32_bf16 v[156:159], a[176:179], a[44:47], v[156:159]
s_waitcnt lgkmcnt(4)
buffer_load_dwordx4 a[156:159], v7, s[16:19], s37 offen offset:3072 sc1
v_mfma_f32_16x16x32_bf16 v[172:175], a[184:187], a[44:47], v[172:175]
s_add_u32 s38, s37, 16384
v_mfma_f32_16x16x32_bf16 v[172:175], a[188:191], a[60:63], v[172:175]
v_mfma_f32_16x16x32_bf16 v[168:171], a[188:191], a[56:59], v[168:171]
s_lshl_b32 s27, s27, 3
v_mfma_f32_16x16x32_bf16 v[168:171], a[184:187], a[40:43], v[168:171]
ds_read_b64_tr_b16 a[200:201], v13 offset:49152
ds_read_b64_tr_b16 a[202:203], v13 offset:53248
v_mfma_f32_16x16x32_bf16 v[164:167], a[184:187], a[36:39], v[164:167]
buffer_load_dwordx4 v21, s[44:47], s36 offen offset:0 lds
v_mfma_f32_16x16x32_bf16 v[164:167], a[188:191], a[52:55], v[164:167]
s_add_u32 s27, s27, s51
ds_read_b64_tr_b16 a[204:205], v13 offset:57344
ds_read_b64_tr_b16 a[206:207], v13 offset:61440
v_mfma_f32_16x16x32_bf16 v[160:163], a[188:191], a[48:51], v[160:163]
v_mfma_f32_16x16x32_bf16 v[160:163], a[184:187], a[32:35], v[160:163]
s_waitcnt lgkmcnt(4)
v_mfma_f32_16x16x32_bf16 v[176:179], a[192:195], a[32:35], v[176:179]
s_mul_i32 s27, s27, 9216
v_mfma_f32_16x16x32_bf16 v[176:179], a[196:199], a[48:51], v[176:179]
buffer_load_dwordx4 v22, s[44:47], s36 offen offset:1024 lds
v_mfma_f32_16x16x32_bf16 v[180:183], a[196:199], a[52:55], v[180:183]
v_mfma_f32_16x16x32_bf16 v[180:183], a[192:195], a[36:39], v[180:183]
ds_read_b64_tr_b16 a[176:177], v14 offset:49152
ds_read_b64_tr_b16 a[178:179], v14 offset:53248
v_mfma_f32_16x16x32_bf16 v[184:187], a[192:195], a[40:43], v[184:187]
s_add_u32 s21, s27, 4194304
ds_read_b64_tr_b16 a[180:181], v14 offset:57344
ds_read_b64_tr_b16 a[182:183], v14 offset:61440
v_mfma_f32_16x16x32_bf16 v[184:187], a[196:199], a[56:59], v[184:187]
v_mfma_f32_16x16x32_bf16 v[188:191], a[196:199], a[60:63], v[188:191]
buffer_load_dwordx4 a[160:163], v7, s[16:19], s38 offen offset:0 sc1
v_mfma_f32_16x16x32_bf16 v[188:191], a[192:195], a[44:47], v[188:191]
s_waitcnt lgkmcnt(4)
v_mfma_f32_16x16x32_bf16 v[204:207], a[200:203], a[44:47], v[204:207]
s_cmp_eq_u32 s22, s51
s_cselect_b32 s28, s18, s21
s_cselect_b64 s[30:31], -1, 0
v_mfma_f32_16x16x32_bf16 v[204:207], a[204:207], a[60:63], v[204:207]
v_mfma_f32_16x16x32_bf16 v[200:203], a[204:207], a[56:59], v[200:203]
v_mfma_f32_16x16x32_bf16 v[200:203], a[200:203], a[40:43], v[200:203]
s_add_u32 s29, s21, 73728
buffer_load_dwordx4 v23, s[44:47], s36 offen offset:2048 lds
v_mfma_f32_16x16x32_bf16 v[196:199], a[200:203], a[36:39], v[196:199]
ds_read_b64_tr_b16 a[184:185], v15 offset:49152
ds_read_b64_tr_b16 a[186:187], v15 offset:53248
v_mfma_f32_16x16x32_bf16 v[196:199], a[204:207], a[52:55], v[196:199]
ds_read_b64_tr_b16 a[188:189], v15 offset:57344
ds_read_b64_tr_b16 a[190:191], v15 offset:61440
v_mfma_f32_16x16x32_bf16 v[192:195], a[204:207], a[48:51], v[192:195]
s_add_u32 s27, s22, 1
v_mfma_f32_16x16x32_bf16 v[192:195], a[200:203], a[32:35], v[192:195]
s_waitcnt lgkmcnt(4)
v_mfma_f32_16x16x32_bf16 v[208:211], a[176:179], a[32:35], v[208:211]
buffer_load_dwordx4 a[164:167], v7, s[16:19], s38 offen offset:1024 sc1
v_mfma_f32_16x16x32_bf16 v[208:211], a[180:183], a[48:51], v[208:211]
s_cmp_eq_u32 s27, s51
s_cselect_b32 s29, s18, s29
s_cselect_b64 s[32:33], -1, 0
v_mfma_f32_16x16x32_bf16 v[212:215], a[180:183], a[52:55], v[212:215]
v_mfma_f32_16x16x32_bf16 v[212:215], a[176:179], a[36:39], v[212:215]
ds_read_b64_tr_b16 a[192:193], v20 offset:8192
ds_read_b64_tr_b16 a[194:195], v20 offset:8704
v_mfma_f32_16x16x32_bf16 v[216:219], a[176:179], a[40:43], v[216:219]
ds_read_b64_tr_b16 a[196:197], v20 offset:9216
ds_read_b64_tr_b16 a[198:199], v20 offset:9728
v_mfma_f32_16x16x32_bf16 v[216:219], a[180:183], a[56:59], v[216:219]
s_lshl_b32 s34, 1, s51
buffer_load_dwordx4 v24, s[44:47], s36 offen offset:3072 lds
v_mfma_f32_16x16x32_bf16 v[220:223], a[180:183], a[60:63], v[220:223]
s_mov_b32 s36, s42
s_mul_i32 s36, s36, 147456
s_add_u32 m0, s24, 0
v_mfma_f32_16x16x32_bf16 v[220:223], a[176:179], a[44:47], v[220:223]
s_waitcnt lgkmcnt(4)
v_mfma_f32_16x16x32_bf16 v[236:239], a[184:187], a[44:47], v[236:239]
s_lshl_b32 s27, s55, 2
v_mfma_f32_16x16x32_bf16 v[236:239], a[188:191], a[60:63], v[236:239]
v_mfma_f32_16x16x32_bf16 v[232:235], a[188:191], a[56:59], v[232:235]
buffer_load_dwordx4 a[168:171], v7, s[16:19], s38 offen offset:2048 sc1
v_mfma_f32_16x16x32_bf16 v[232:235], a[184:187], a[40:43], v[232:235]
s_waitcnt vmcnt(32) lgkmcnt(0)
s_barrier
ds_read_b64_tr_b16 a[200:201], v40 offset:0
v_mfma_f32_16x16x32_bf16 v[228:231], a[184:187], a[36:39], v[228:231]
s_lshr_b32 s56, s51, 1
ds_read_b64_tr_b16 a[202:203], v40 offset:4096
ds_read_b64_tr_b16 a[204:205], v40 offset:8192
v_mfma_f32_16x16x32_bf16 v[228:231], a[188:191], a[52:55], v[228:231]
ds_read_b64_tr_b16 a[206:207], v40 offset:12288
v_mfma_f32_16x16x32_bf16 v[224:227], a[188:191], a[48:51], v[224:227]
v_mfma_f32_16x16x32_bf16 v[224:227], a[184:187], a[32:35], v[224:227]
s_waitcnt lgkmcnt(4)
buffer_load_dwordx4 a[172:175], v7, s[16:19], s38 offen offset:3072 sc1
v_mfma_f32_16x16x32_bf16 v[240:243], a[192:195], a[32:35], v[240:243]
s_add_u32 s56, s56, s27
s_mov_b32 s37, s42
s_mul_i32 s37, s37, 65536
v_mfma_f32_16x16x32_bf16 v[240:243], a[196:199], a[48:51], v[240:243]
s_add_u32 s37, s37, s48
s_add_u32 s37, s37, 32768
v_mfma_f32_16x16x32_bf16 v[244:247], a[196:199], a[52:55], v[244:247]
s_lshl_b32 s56, s56, 10
v_mfma_f32_16x16x32_bf16 v[244:247], a[192:195], a[36:39], v[244:247]
ds_read_b64_tr_b16 a[176:177], v41 offset:0
ds_read_b64_tr_b16 a[178:179], v41 offset:4096
v_mfma_f32_16x16x32_bf16 v[248:251], a[192:195], a[40:43], v[248:251]
buffer_load_dwordx4 v21, s[44:47], s36 offen offset:0 lds
v_mfma_f32_16x16x32_bf16 v[248:251], a[196:199], a[56:59], v[248:251]
ds_read_b64_tr_b16 a[180:181], v41 offset:8192
ds_read_b64_tr_b16 a[182:183], v41 offset:12288
v_mfma_f32_16x16x32_bf16 v[252:255], a[196:199], a[60:63], v[252:255]
s_add_u32 s56, s56, 2752512
v_mfma_f32_16x16x32_bf16 v[252:255], a[192:195], a[44:47], v[252:255]
s_waitcnt lgkmcnt(4) vmcnt(33)
v_mfma_f32_16x16x32_bf16 v[112:115], a[200:203], a[64:67], v[112:115]
v_mfma_f32_16x16x32_bf16 v[112:115], a[204:207], a[80:83], v[112:115]
s_mov_b32 s10, 2359296
buffer_load_dwordx4 v22, s[44:47], s36 offen offset:1024 lds
v_mfma_f32_16x16x32_bf16 v[116:119], a[204:207], a[84:87], v[116:119]
v_mfma_f32_16x16x32_bf16 v[116:119], a[200:203], a[68:71], v[116:119]
ds_read_b64_tr_b16 a[184:185], v42 offset:0
ds_read_b64_tr_b16 a[186:187], v42 offset:4096
v_mfma_f32_16x16x32_bf16 v[120:123], a[200:203], a[72:75], v[120:123]
ds_read_b64_tr_b16 a[188:189], v42 offset:8192
ds_read_b64_tr_b16 a[190:191], v42 offset:12288
v_mfma_f32_16x16x32_bf16 v[120:123], a[204:207], a[88:91], v[120:123]
s_mov_b32 s14, 2359296
v_mfma_f32_16x16x32_bf16 v[124:127], a[204:207], a[92:95], v[124:127]
buffer_load_dwordx4 a[208:211], v7, s[16:19], s37 offen offset:0 sc1
v_mfma_f32_16x16x32_bf16 v[124:127], a[200:203], a[76:79], v[124:127]
s_waitcnt lgkmcnt(4)
v_mfma_f32_16x16x32_bf16 v[140:143], a[176:179], a[76:79], v[140:143]
s_mov_b64 s[8:9], s[60:61]
v_mfma_f32_16x16x32_bf16 v[140:143], a[180:183], a[92:95], v[140:143]
v_mfma_f32_16x16x32_bf16 v[136:139], a[180:183], a[88:91], v[136:139]
v_mfma_f32_16x16x32_bf16 v[136:139], a[176:179], a[72:75], v[136:139]
s_mov_b64 s[12:13], s[62:63]
buffer_load_dwordx4 v23, s[44:47], s36 offen offset:2048 lds
v_mfma_f32_16x16x32_bf16 v[132:135], a[176:179], a[68:71], v[132:135]
ds_read_b64_tr_b16 a[192:193], v43 offset:0
ds_read_b64_tr_b16 a[194:195], v43 offset:4096
v_mfma_f32_16x16x32_bf16 v[132:135], a[180:183], a[84:87], v[132:135]
ds_read_b64_tr_b16 a[196:197], v43 offset:8192
ds_read_b64_tr_b16 a[198:199], v43 offset:12288
v_mfma_f32_16x16x32_bf16 v[128:131], a[180:183], a[80:83], v[128:131]
v_mfma_f32_16x16x32_bf16 v[128:131], a[176:179], a[64:67], v[128:131]
s_waitcnt lgkmcnt(4)
s_lshl_b32 s27, s26, 3
v_mfma_f32_16x16x32_bf16 v[144:147], a[184:187], a[64:67], v[144:147]
buffer_load_dwordx4 v24, s[44:47], s36 offen offset:3072 lds
v_mfma_f32_16x16x32_bf16 v[144:147], a[188:191], a[80:83], v[144:147]
s_mov_b32 s36, s42
s_mul_i32 s36, s36, 147456
s_add_u32 s36, s36, 73728
v_mfma_f32_16x16x32_bf16 v[148:151], a[188:191], a[84:87], v[148:151]
s_add_u32 m0, s24, 16384
s_add_u32 s27, s27, s51
v_mfma_f32_16x16x32_bf16 v[148:151], a[184:187], a[68:71], v[148:151]
ds_read_b64_tr_b16 a[200:201], v44 offset:0
ds_read_b64_tr_b16 a[202:203], v44 offset:4096
v_mfma_f32_16x16x32_bf16 v[152:155], a[184:187], a[72:75], v[152:155]
ds_read_b64_tr_b16 a[204:205], v44 offset:8192
ds_read_b64_tr_b16 a[206:207], v44 offset:12288
v_mfma_f32_16x16x32_bf16 v[152:155], a[188:191], a[88:91], v[152:155]
buffer_load_dwordx4 a[212:215], v7, s[16:19], s37 offen offset:1024 sc1
v_mfma_f32_16x16x32_bf16 v[156:159], a[188:191], a[92:95], v[156:159]
s_mul_i32 s27, s27, 36864
v_mfma_f32_16x16x32_bf16 v[156:159], a[184:187], a[76:79], v[156:159]
s_waitcnt lgkmcnt(4)
v_mfma_f32_16x16x32_bf16 v[172:175], a[192:195], a[76:79], v[172:175]
v_mfma_f32_16x16x32_bf16 v[172:175], a[196:199], a[92:95], v[172:175]
s_lshl_b32 s20, s52, 8
v_mfma_f32_16x16x32_bf16 v[168:171], a[196:199], a[88:91], v[168:171]
buffer_load_dwordx4 a[216:219], v7, s[16:19], s37 offen offset:2048 sc1
v_mfma_f32_16x16x32_bf16 v[168:171], a[192:195], a[72:75], v[168:171]
ds_read_b64_tr_b16 a[176:177], v45 offset:0
ds_read_b64_tr_b16 a[178:179], v45 offset:4096
v_mfma_f32_16x16x32_bf16 v[164:167], a[192:195], a[68:71], v[164:167]
s_add_u32 s20, s20, s27
ds_read_b64_tr_b16 a[180:181], v45 offset:8192
ds_read_b64_tr_b16 a[182:183], v45 offset:12288
v_mfma_f32_16x16x32_bf16 v[164:167], a[196:199], a[84:87], v[164:167]
v_mfma_f32_16x16x32_bf16 v[160:163], a[196:199], a[80:83], v[160:163]
v_mfma_f32_16x16x32_bf16 v[160:163], a[192:195], a[64:67], v[160:163]
s_waitcnt lgkmcnt(4)
buffer_load_dwordx4 a[220:223], v7, s[16:19], s37 offen offset:3072 sc1
v_mfma_f32_16x16x32_bf16 v[176:179], a[200:203], a[64:67], v[176:179]
s_add_u32 s38, s37, 16384
s_lshl_b32 s41, s23, 5
v_mfma_f32_16x16x32_bf16 v[176:179], a[204:207], a[80:83], v[176:179]
v_mfma_f32_16x16x32_bf16 v[180:183], a[204:207], a[84:87], v[180:183]
v_mfma_f32_16x16x32_bf16 v[180:183], a[200:203], a[68:71], v[180:183]
s_add_u32 s41, s41, s20
ds_read_b64_tr_b16 a[184:185], v46 offset:0
ds_read_b64_tr_b16 a[186:187], v46 offset:4096
v_mfma_f32_16x16x32_bf16 v[184:187], a[200:203], a[72:75], v[184:187]
buffer_load_dwordx4 v21, s[44:47], s36 offen offset:0 lds
v_mfma_f32_16x16x32_bf16 v[184:187], a[204:207], a[88:91], v[184:187]
ds_read_b64_tr_b16 a[188:189], v46 offset:8192
ds_read_b64_tr_b16 a[190:191], v46 offset:12288
v_mfma_f32_16x16x32_bf16 v[188:191], a[204:207], a[92:95], v[188:191]
v_mfma_f32_16x16x32_bf16 v[188:191], a[200:203], a[76:79], v[188:191]
s_waitcnt lgkmcnt(4)
s_lshl_b32 s20, s52, 5
v_mfma_f32_16x16x32_bf16 v[204:207], a[176:179], a[76:79], v[204:207]
v_mfma_f32_16x16x32_bf16 v[204:207], a[180:183], a[92:95], v[204:207]
buffer_load_dwordx4 a[224:227], v7, s[16:19], s38 offen offset:0 sc1
v_mfma_f32_16x16x32_bf16 v[200:203], a[180:183], a[88:91], v[200:203]
s_add_u32 s20, s20, 1024
v_mfma_f32_16x16x32_bf16 v[200:203], a[176:179], a[72:75], v[200:203]
ds_read_b64_tr_b16 a[192:193], v47 offset:0
ds_read_b64_tr_b16 a[194:195], v47 offset:4096
v_mfma_f32_16x16x32_bf16 v[196:199], a[176:179], a[68:71], v[196:199]
ds_read_b64_tr_b16 a[196:197], v47 offset:8192
ds_read_b64_tr_b16 a[198:199], v47 offset:12288
v_mfma_f32_16x16x32_bf16 v[196:199], a[180:183], a[84:87], v[196:199]
s_add_u32 s43, s20, s27
v_mfma_f32_16x16x32_bf16 v[192:195], a[180:183], a[80:83], v[192:195]
buffer_load_dwordx4 v22, s[44:47], s36 offen offset:1024 lds
v_mfma_f32_16x16x32_bf16 v[192:195], a[176:179], a[64:67], v[192:195]
s_waitcnt lgkmcnt(4)
v_mfma_f32_16x16x32_bf16 v[208:211], a[184:187], a[64:67], v[208:211]
v_mfma_f32_16x16x32_bf16 v[208:211], a[188:191], a[80:83], v[208:211]
v_and_b32 v2, 15, v0
v_mfma_f32_16x16x32_bf16 v[212:215], a[188:191], a[84:87], v[212:215]
v_mfma_f32_16x16x32_bf16 v[212:215], a[184:187], a[68:71], v[212:215]
buffer_load_dwordx4 a[228:231], v7, s[16:19], s38 offen offset:1024 sc1
v_mfma_f32_16x16x32_bf16 v[216:219], a[184:187], a[72:75], v[216:219]
ds_read_b64_tr_b16 a[200:201], v20 offset:10240
ds_read_b64_tr_b16 a[202:203], v20 offset:10752
v_mfma_f32_16x16x32_bf16 v[216:219], a[188:191], a[88:91], v[216:219]
ds_read_b64_tr_b16 a[204:205], v20 offset:11264
ds_read_b64_tr_b16 a[206:207], v20 offset:11776
v_mfma_f32_16x16x32_bf16 v[220:223], a[188:191], a[92:95], v[220:223]
buffer_load_dwordx4 v23, s[44:47], s36 offen offset:2048 lds
buffer_load_dwordx4 a[232:235], v7, s[16:19], s38 offen offset:2048 sc1
v_mfma_f32_16x16x32_bf16 v[220:223], a[184:187], a[76:79], v[220:223]
s_waitcnt lgkmcnt(4)
v_lshrrev_b32 v3, 4, v0
v_mov_b32 v16, 0
v_mfma_f32_16x16x32_bf16 v[236:239], a[192:195], a[76:79], v[236:239]
v_mfma_f32_16x16x32_bf16 v[236:239], a[196:199], a[92:95], v[236:239]
buffer_load_dwordx4 v24, s[44:47], s36 offen offset:3072 lds
buffer_load_dwordx4 a[236:239], v7, s[16:19], s38 offen offset:3072 sc1
v_mfma_f32_16x16x32_bf16 v[232:235], a[196:199], a[88:91], v[232:235]
v_mfma_f32_16x16x32_bf16 v[232:235], a[192:195], a[72:75], v[232:235]
s_waitcnt vmcnt(28) lgkmcnt(0)
s_barrier
ds_read_b64_tr_b16 a[176:177], v40 offset:32768
v_mfma_f32_16x16x32_bf16 v[228:231], a[192:195], a[68:71], v[228:231]
ds_read_b64_tr_b16 a[178:179], v40 offset:36864
ds_read_b64_tr_b16 a[180:181], v40 offset:40960
v_mfma_f32_16x16x32_bf16 v[228:231], a[196:199], a[84:87], v[228:231]
ds_read_b64_tr_b16 a[182:183], v40 offset:45056
v_mov_b32 v17, 0
v_mfma_f32_16x16x32_bf16 v[224:227], a[196:199], a[80:83], v[224:227]
v_bfe_u32 v4, v0, 2, 2
v_mfma_f32_16x16x32_bf16 v[224:227], a[192:195], a[64:67], v[224:227]
s_waitcnt lgkmcnt(4)
v_mfma_f32_16x16x32_bf16 v[240:243], a[200:203], a[64:67], v[240:243]
v_mfma_f32_16x16x32_bf16 v[240:243], a[204:207], a[80:83], v[240:243]
v_mfma_f32_16x16x32_bf16 v[244:247], a[204:207], a[84:87], v[244:247]
v_and_b32 v5, 1, v0
v_mfma_f32_16x16x32_bf16 v[244:247], a[200:203], a[68:71], v[244:247]
ds_read_b64_tr_b16 a[184:185], v41 offset:32768
ds_read_b64_tr_b16 a[186:187], v41 offset:36864
v_mfma_f32_16x16x32_bf16 v[248:251], a[200:203], a[72:75], v[248:251]
ds_read_b64_tr_b16 a[188:189], v41 offset:40960
ds_read_b64_tr_b16 a[190:191], v41 offset:45056
v_mfma_f32_16x16x32_bf16 v[248:251], a[204:207], a[88:91], v[248:251]
v_lshlrev_b32 v5, 4, v5
v_mfma_f32_16x16x32_bf16 v[252:255], a[204:207], a[92:95], v[252:255]
v_mfma_f32_16x16x32_bf16 v[252:255], a[200:203], a[76:79], v[252:255]
s_waitcnt lgkmcnt(4) vmcnt(40)
v_mfma_f32_16x16x32_bf16 v[112:115], a[176:179], a[240:243], v[112:115]
v_mov_b32 v6, 0x3f80
v_mfma_f32_16x16x32_bf16 v[112:115], a[180:183], a[128:131], v[112:115]
v_mfma_f32_16x16x32_bf16 v[116:119], a[180:183], a[132:135], v[116:119]
v_mfma_f32_16x16x32_bf16 v[116:119], a[176:179], a[244:247], v[116:119]
ds_read_b64_tr_b16 a[192:193], v42 offset:32768
ds_read_b64_tr_b16 a[194:195], v42 offset:36864
v_mfma_f32_16x16x32_bf16 v[120:123], a[176:179], a[248:251], v[120:123]
ds_read_b64_tr_b16 a[196:197], v42 offset:40960
ds_read_b64_tr_b16 a[198:199], v42 offset:45056
v_mfma_f32_16x16x32_bf16 v[120:123], a[180:183], a[136:139], v[120:123]
v_lshlrev_b32 v5, v5, v6
v_mfma_f32_16x16x32_bf16 v[124:127], a[180:183], a[140:143], v[124:127]
v_mfma_f32_16x16x32_bf16 v[124:127], a[176:179], a[252:255], v[124:127]
s_waitcnt lgkmcnt(4)
v_mfma_f32_16x16x32_bf16 v[140:143], a[184:187], a[252:255], v[140:143]
v_cmp_eq_u32 vcc, v4, v3
s_nop 1
v_cndmask_b32 v5, 0, v5, vcc
v_mfma_f32_16x16x32_bf16 v[140:143], a[188:191], a[140:143], v[140:143]
v_mfma_f32_16x16x32_bf16 v[136:139], a[188:191], a[136:139], v[136:139]
v_mfma_f32_16x16x32_bf16 v[136:139], a[184:187], a[248:251], v[136:139]
ds_read_b64_tr_b16 a[200:201], v43 offset:32768
ds_read_b64_tr_b16 a[202:203], v43 offset:36864
v_mfma_f32_16x16x32_bf16 v[132:135], a[184:187], a[244:247], v[132:135]
ds_read_b64_tr_b16 a[204:205], v43 offset:40960
ds_read_b64_tr_b16 a[206:207], v43 offset:45056
v_mfma_f32_16x16x32_bf16 v[132:135], a[188:191], a[132:135], v[132:135]
v_and_b32 v4, 2, v0
v_mfma_f32_16x16x32_bf16 v[128:131], a[188:191], a[128:131], v[128:131]
v_cmp_eq_u32 vcc, 0, v4
s_nop 1
v_cndmask_b32 v18, 0, v5, vcc
v_cndmask_b32 v19, v5, v16, vcc
v_mfma_f32_16x16x32_bf16 v[128:131], a[184:187], a[240:243], v[128:131]
s_waitcnt lgkmcnt(4)
v_mfma_f32_16x16x32_bf16 v[144:147], a[192:195], a[240:243], v[144:147]
v_mfma_f32_16x16x32_bf16 v[144:147], a[196:199], a[128:131], v[144:147]
v_mul_u32_u24 v2, 1152, v2
v_mfma_f32_16x16x32_bf16 v[148:151], a[196:199], a[132:135], v[148:151]
v_mfma_f32_16x16x32_bf16 v[148:151], a[192:195], a[244:247], v[148:151]
ds_read_b64_tr_b16 a[176:177], v44 offset:32768
ds_read_b64_tr_b16 a[178:179], v44 offset:36864
v_mfma_f32_16x16x32_bf16 v[152:155], a[192:195], a[248:251], v[152:155]
ds_read_b64_tr_b16 a[180:181], v44 offset:40960
ds_read_b64_tr_b16 a[182:183], v44 offset:45056
v_mfma_f32_16x16x32_bf16 v[152:155], a[196:199], a[136:139], v[152:155]
v_lshl_add_u32 v2, v3, 3, v2
v_mfma_f32_16x16x32_bf16 v[156:159], a[196:199], a[140:143], v[156:159]
v_mfma_f32_16x16x32_bf16 v[156:159], a[192:195], a[252:255], v[156:159]
s_waitcnt lgkmcnt(4)
v_mfma_f32_16x16x32_bf16 v[172:175], a[200:203], a[252:255], v[172:175]
v_add_u32 v3, 18432, v2
v_mfma_f32_16x16x32_bf16 v[172:175], a[204:207], a[140:143], v[172:175]
v_mfma_f32_16x16x32_bf16 v[168:171], a[204:207], a[136:139], v[168:171]
v_mfma_f32_16x16x32_bf16 v[168:171], a[200:203], a[248:251], v[168:171]
ds_read_b64_tr_b16 a[184:185], v45 offset:32768
ds_read_b64_tr_b16 a[186:187], v45 offset:36864
v_mfma_f32_16x16x32_bf16 v[164:167], a[200:203], a[244:247], v[164:167]
s_lshl_b32 s26, s55, 3
ds_read_b64_tr_b16 a[188:189], v45 offset:40960
ds_read_b64_tr_b16 a[190:191], v45 offset:45056
v_mfma_f32_16x16x32_bf16 v[164:167], a[204:207], a[132:135], v[164:167]
v_mfma_f32_16x16x32_bf16 v[160:163], a[204:207], a[128:131], v[160:163]
v_mfma_f32_16x16x32_bf16 v[160:163], a[200:203], a[240:243], v[160:163]
s_waitcnt lgkmcnt(4)
s_add_u32 s26, s26, s51
v_mfma_f32_16x16x32_bf16 v[176:179], a[176:179], a[240:243], v[176:179]
v_mfma_f32_16x16x32_bf16 v[176:179], a[180:183], a[128:131], v[176:179]
v_mfma_f32_16x16x32_bf16 v[180:183], a[180:183], a[132:135], v[180:183]
s_mul_i32 s26, s26, 73728
v_mfma_f32_16x16x32_bf16 v[180:183], a[176:179], a[244:247], v[180:183]
ds_read_b64_tr_b16 a[192:193], v46 offset:32768
ds_read_b64_tr_b16 a[194:195], v46 offset:36864
v_mfma_f32_16x16x32_bf16 v[184:187], a[176:179], a[248:251], v[184:187]
ds_read_b64_tr_b16 a[196:197], v46 offset:40960
ds_read_b64_tr_b16 a[198:199], v46 offset:45056
v_mfma_f32_16x16x32_bf16 v[184:187], a[180:183], a[136:139], v[184:187]
v_mfma_f32_16x16x32_bf16 v[188:191], a[180:183], a[140:143], v[188:191]
v_add_u32 v1, s39, v7
v_mfma_f32_16x16x32_bf16 v[188:191], a[176:179], a[252:255], v[188:191]
s_waitcnt lgkmcnt(4)
v_mfma_f32_16x16x32_bf16 v[204:207], a[184:187], a[252:255], v[204:207]
v_mfma_f32_16x16x32_bf16 v[204:207], a[188:191], a[140:143], v[204:207]
v_add_u32 v35, 4096, v7
v_mfma_f32_16x16x32_bf16 v[200:203], a[188:191], a[136:139], v[200:203]
v_mfma_f32_16x16x32_bf16 v[200:203], a[184:187], a[248:251], v[200:203]
ds_read_b64_tr_b16 a[200:201], v47 offset:32768
ds_read_b64_tr_b16 a[202:203], v47 offset:36864
v_mfma_f32_16x16x32_bf16 v[196:199], a[184:187], a[244:247], v[196:199]
ds_read_b64_tr_b16 a[204:205], v47 offset:40960
ds_read_b64_tr_b16 a[206:207], v47 offset:45056
v_mfma_f32_16x16x32_bf16 v[196:199], a[188:191], a[132:135], v[196:199]
s_add_u32 s26, s26, s39
v_mfma_f32_16x16x32_bf16 v[192:195], a[188:191], a[128:131], v[192:195]
v_mfma_f32_16x16x32_bf16 v[192:195], a[184:187], a[240:243], v[192:195]
s_waitcnt lgkmcnt(4)
v_mfma_f32_16x16x32_bf16 v[208:211], a[192:195], a[240:243], v[208:211]
s_add_u32 s26, s26, 4194304
v_mfma_f32_16x16x32_bf16 v[208:211], a[196:199], a[128:131], v[208:211]
v_mfma_f32_16x16x32_bf16 v[212:215], a[196:199], a[132:135], v[212:215]
v_mfma_f32_16x16x32_bf16 v[212:215], a[192:195], a[244:247], v[212:215]
s_add_u32 s27, s26, 8192
ds_read_b64_tr_b16 a[176:177], v20 offset:12288
ds_read_b64_tr_b16 a[178:179], v20 offset:12800
v_mfma_f32_16x16x32_bf16 v[216:219], a[192:195], a[248:251], v[216:219]
ds_read_b64_tr_b16 a[180:181], v20 offset:13312
ds_read_b64_tr_b16 a[182:183], v20 offset:13824
v_mfma_f32_16x16x32_bf16 v[216:219], a[196:199], a[136:139], v[216:219]
v_mfma_f32_16x16x32_bf16 v[220:223], a[196:199], a[140:143], v[220:223]
v_mfma_f32_16x16x32_bf16 v[220:223], a[192:195], a[252:255], v[220:223]
s_waitcnt lgkmcnt(4)
s_waitcnt vmcnt(1) lgkmcnt(0)
s_barrier
v_mfma_f32_16x16x32_bf16 v[236:239], a[200:203], a[252:255], v[236:239]
ds_read_b64_tr_b16 v[48:49], v40 offset:49152
ds_read_b64_tr_b16 v[50:51], v40 offset:53248
v_mfma_f32_16x16x32_bf16 v[236:239], a[204:207], a[140:143], v[236:239]
ds_read_b64_tr_b16 v[52:53], v40 offset:57344
ds_read_b64_tr_b16 v[54:55], v40 offset:61440
v_mfma_f32_16x16x32_bf16 v[232:235], a[204:207], a[136:139], v[232:235]
ds_read_b64_tr_b16 v[56:57], v8 offset:0
ds_read_b64_tr_b16 v[58:59], v8 offset:4096
v_mfma_f32_16x16x32_bf16 v[232:235], a[200:203], a[248:251], v[232:235]
ds_read_b64_tr_b16 v[60:61], v8 offset:8192
ds_read_b64_tr_b16 v[62:63], v8 offset:12288
v_mfma_f32_16x16x32_bf16 v[228:231], a[200:203], a[244:247], v[228:231]
ds_read_b64_tr_b16 v[96:97], v8 offset:16384
ds_read_b64_tr_b16 v[98:99], v8 offset:20480
v_mfma_f32_16x16x32_bf16 v[228:231], a[204:207], a[132:135], v[228:231]
ds_read_b64_tr_b16 v[100:101], v8 offset:24576
ds_read_b64_tr_b16 v[102:103], v8 offset:28672
v_mfma_f32_16x16x32_bf16 v[224:227], a[204:207], a[128:131], v[224:227]
s_cmp_eq_u32 s23, 0
s_cselect_b32 s27, s27, s18
s_mov_b32 s57, 0xbfb8aa3b
v_mfma_f32_16x16x32_bf16 v[224:227], a[200:203], a[240:243], v[224:227]
s_waitcnt lgkmcnt(12)
v_mfma_f32_16x16x32_bf16 v[240:243], a[176:179], a[240:243], v[240:243]
v_mfma_f32_16x16x32_bf16 v[240:243], a[180:183], a[128:131], v[240:243]
v_mfma_f32_16x16x32_bf16 v[244:247], a[180:183], a[132:135], v[244:247]
v_mfma_f32_16x16x32_bf16 v[244:247], a[176:179], a[244:247], v[244:247]
v_mfma_f32_16x16x32_bf16 v[248:251], a[176:179], a[248:251], v[248:251]
v_mfma_f32_16x16x32_bf16 v[248:251], a[180:183], a[136:139], v[248:251]
v_mfma_f32_16x16x32_bf16 v[252:255], a[180:183], a[140:143], v[252:255]
v_mfma_f32_16x16x32_bf16 v[252:255], a[176:179], a[252:255], v[252:255]
s_waitcnt lgkmcnt(0) vmcnt(0)
v_mfma_f32_16x16x32_bf16 v[112:115], v[48:51], a[96:99], v[112:115]
buffer_load_dwordx2 a[240:241], v2, s[8:11], s41 offen offset:0
v_mfma_f32_16x16x32_bf16 v[112:115], v[52:55], a[112:115], v[112:115]
v_mfma_f32_16x16x32_bf16 v[112:115], v[56:59], a[144:147], v[112:115]
v_mfma_f32_16x16x32_bf16 v[112:115], v[60:63], a[160:163], v[112:115]
v_mfma_f32_16x16x32_bf16 v[112:115], v[96:99], a[208:211], v[112:115]
buffer_load_dwordx2 a[242:243], v3, s[8:11], s41 offen offset:0
v_mfma_f32_16x16x32_bf16 v[112:115], v[100:103], a[224:227], v[112:115]
v_mfma_f32_16x16x32_bf16 v[116:119], v[100:103], a[228:231], v[116:119]
v_mfma_f32_16x16x32_bf16 v[116:119], v[96:99], a[212:215], v[116:119]
ds_read_b64_tr_b16 v[104:105], v41 offset:49152
ds_read_b64_tr_b16 v[106:107], v41 offset:53248
v_mfma_f32_16x16x32_bf16 v[116:119], v[60:63], a[164:167], v[116:119]
ds_read_b64_tr_b16 v[108:109], v41 offset:57344
ds_read_b64_tr_b16 v[110:111], v41 offset:61440
v_mfma_f32_16x16x32_bf16 v[116:119], v[56:59], a[148:151], v[116:119]
buffer_load_dwordx2 a[244:245], v2, s[8:11], s41 offen offset:128
v_mfma_f32_16x16x32_bf16 v[116:119], v[52:55], a[116:119], v[116:119]
ds_read_b64_tr_b16 a[176:177], v9 offset:0
ds_read_b64_tr_b16 a[178:179], v9 offset:4096
v_mfma_f32_16x16x32_bf16 v[116:119], v[48:51], a[100:103], v[116:119]
ds_read_b64_tr_b16 a[180:181], v9 offset:8192
ds_read_b64_tr_b16 a[182:183], v9 offset:12288
v_mfma_f32_16x16x32_bf16 v[120:123], v[48:51], a[104:107], v[120:123]
ds_read_b64_tr_b16 a[184:185], v9 offset:16384
ds_read_b64_tr_b16 a[186:187], v9 offset:20480
v_mfma_f32_16x16x32_bf16 v[120:123], v[52:55], a[120:123], v[120:123]
ds_read_b64_tr_b16 a[188:189], v9 offset:24576
ds_read_b64_tr_b16 a[190:191], v9 offset:28672
v_mfma_f32_16x16x32_bf16 v[120:123], v[56:59], a[152:155], v[120:123]
buffer_load_dwordx2 a[246:247], v3, s[8:11], s41 offen offset:128
v_mfma_f32_16x16x32_bf16 v[120:123], v[60:63], a[168:171], v[120:123]
v_mfma_f32_16x16x32_bf16 v[120:123], v[96:99], a[216:219], v[120:123]
v_mfma_f32_16x16x32_bf16 v[120:123], v[100:103], a[232:235], v[120:123]
v_mfma_f32_16x16x32_bf16 v[124:127], v[100:103], a[236:239], v[124:127]
v_mfma_f32_16x16x32_bf16 v[124:127], v[96:99], a[220:223], v[124:127]
buffer_load_dwordx2 a[248:249], v2, s[8:11], s43 offen offset:0
v_mfma_f32_16x16x32_bf16 v[124:127], v[60:63], a[172:175], v[124:127]
v_mfma_f32_16x16x32_bf16 v[124:127], v[56:59], a[156:159], v[124:127]
v_mfma_f32_16x16x32_bf16 v[124:127], v[52:55], a[124:127], v[124:127]
v_mfma_f32_16x16x32_bf16 v[124:127], v[48:51], a[108:111], v[124:127]
s_waitcnt lgkmcnt(0)
v_mfma_f32_16x16x32_bf16 v[140:143], v[104:107], a[108:111], v[140:143]
buffer_load_dwordx2 a[250:251], v3, s[8:11], s43 offen offset:0
v_mfma_f32_16x16x32_bf16 v[140:143], v[108:111], a[124:127], v[140:143]
v_mfma_f32_16x16x32_bf16 v[140:143], a[176:179], a[156:159], v[140:143]
v_mfma_f32_16x16x32_bf16 v[140:143], a[180:183], a[172:175], v[140:143]
v_mfma_f32_16x16x32_bf16 v[140:143], a[184:187], a[220:223], v[140:143]
v_mfma_f32_16x16x32_bf16 v[140:143], a[188:191], a[236:239], v[140:143]
v_mfma_f32_16x16x32_bf16 v[136:139], a[188:191], a[232:235], v[136:139]
v_cvt_pk_bf16_f32 v64, v112, v113
v_cvt_pk_bf16_f32 v65, v114, v115
v_mfma_f32_16x16x32_bf16 v[136:139], a[184:187], a[216:219], v[136:139]
v_cvt_pk_bf16_f32 v66, v116, v117
v_cvt_pk_bf16_f32 v67, v118, v119
v_mfma_f32_16x16x32_bf16 v[136:139], a[180:183], a[168:171], v[136:139]
s_add_u32 s40, s28, 0
buffer_store_dwordx4 v[64:67], v7, s[16:19], s40 offen sc1
v_mfma_f32_16x16x32_bf16 v[136:139], a[176:179], a[152:155], v[136:139]
s_mov_b64 exec, s[30:31]
ds_write_b128 v7, v[64:67] offset:32768
s_mov_b64 exec, -1
v_mfma_f32_16x16x32_bf16 v[136:139], v[108:111], a[120:123], v[136:139]
ds_read_b64_tr_b16 a[192:193], v42 offset:49152
ds_read_b64_tr_b16 a[194:195], v42 offset:53248
v_mfma_f32_16x16x32_bf16 v[136:139], v[104:107], a[104:107], v[136:139]
ds_read_b64_tr_b16 a[196:197], v42 offset:57344
ds_read_b64_tr_b16 a[198:199], v42 offset:61440
v_mfma_f32_16x16x32_bf16 v[132:135], v[104:107], a[100:103], v[132:135]
ds_read_b64_tr_b16 a[200:201], v10 offset:0
ds_read_b64_tr_b16 a[202:203], v10 offset:4096
v_mfma_f32_16x16x32_bf16 v[132:135], v[108:111], a[116:119], v[132:135]
ds_read_b64_tr_b16 a[204:205], v10 offset:8192
ds_read_b64_tr_b16 a[206:207], v10 offset:12288
v_mfma_f32_16x16x32_bf16 v[132:135], a[176:179], a[148:151], v[132:135]
ds_read_b64_tr_b16 v[48:49], v10 offset:16384
ds_read_b64_tr_b16 v[50:51], v10 offset:20480
v_mfma_f32_16x16x32_bf16 v[132:135], a[180:183], a[164:167], v[132:135]
ds_read_b64_tr_b16 v[52:53], v10 offset:24576
ds_read_b64_tr_b16 v[54:55], v10 offset:28672
v_mfma_f32_16x16x32_bf16 v[132:135], a[184:187], a[212:215], v[132:135]
v_cvt_pk_bf16_f32 v68, v120, v121
v_cvt_pk_bf16_f32 v69, v122, v123
v_mfma_f32_16x16x32_bf16 v[132:135], a[188:191], a[228:231], v[132:135]
v_cvt_pk_bf16_f32 v70, v124, v125
v_cvt_pk_bf16_f32 v71, v126, v127
v_mfma_f32_16x16x32_bf16 v[128:131], a[188:191], a[224:227], v[128:131]
s_add_u32 s40, s29, 0
buffer_store_dwordx4 v[68:71], v7, s[16:19], s40 offen sc1
v_mfma_f32_16x16x32_bf16 v[128:131], a[184:187], a[208:211], v[128:131]
s_mov_b64 exec, s[32:33]
ds_write_b128 v7, v[68:71] offset:32768
s_mov_b64 exec, -1
v_mfma_f32_16x16x32_bf16 v[128:131], a[180:183], a[160:163], v[128:131]
v_mfma_f32_16x16x32_bf16 v[128:131], a[176:179], a[144:147], v[128:131]
v_mfma_f32_16x16x32_bf16 v[128:131], v[108:111], a[112:115], v[128:131]
v_mfma_f32_16x16x32_bf16 v[128:131], v[104:107], a[96:99], v[128:131]
s_waitcnt lgkmcnt(0)
v_mfma_f32_16x16x32_bf16 v[144:147], a[192:195], a[96:99], v[144:147]
v_mfma_f32_16x16x32_bf16 v[144:147], a[196:199], a[112:115], v[144:147]
v_mfma_f32_16x16x32_bf16 v[144:147], a[200:203], a[144:147], v[144:147]
v_mfma_f32_16x16x32_bf16 v[144:147], a[204:207], a[160:163], v[144:147]
v_mfma_f32_16x16x32_bf16 v[144:147], v[48:51], a[208:211], v[144:147]
v_mfma_f32_16x16x32_bf16 v[144:147], v[52:55], a[224:227], v[144:147]
v_mfma_f32_16x16x32_bf16 v[148:151], v[52:55], a[228:231], v[148:151]
v_cvt_pk_bf16_f32 v72, v128, v129
v_cvt_pk_bf16_f32 v73, v130, v131
v_mfma_f32_16x16x32_bf16 v[148:151], v[48:51], a[212:215], v[148:151]
v_cvt_pk_bf16_f32 v74, v132, v133
v_cvt_pk_bf16_f32 v75, v134, v135
v_mfma_f32_16x16x32_bf16 v[148:151], a[204:207], a[164:167], v[148:151]
s_add_u32 s40, s28, 1024
buffer_store_dwordx4 v[72:75], v7, s[16:19], s40 offen sc1
v_mfma_f32_16x16x32_bf16 v[148:151], a[200:203], a[148:151], v[148:151]
s_mov_b64 exec, s[30:31]
ds_write_b128 v7, v[72:75] offset:33792
s_mov_b64 exec, -1
v_mfma_f32_16x16x32_bf16 v[148:151], a[196:199], a[116:119], v[148:151]
ds_read_b64_tr_b16 v[56:57], v43 offset:49152
ds_read_b64_tr_b16 v[58:59], v43 offset:53248
v_mfma_f32_16x16x32_bf16 v[148:151], a[192:195], a[100:103], v[148:151]
ds_read_b64_tr_b16 v[60:61], v43 offset:57344
ds_read_b64_tr_b16 v[62:63], v43 offset:61440
v_mfma_f32_16x16x32_bf16 v[152:155], a[192:195], a[104:107], v[152:155]
ds_read_b64_tr_b16 v[96:97], v11 offset:0
ds_read_b64_tr_b16 v[98:99], v11 offset:4096
v_mfma_f32_16x16x32_bf16 v[152:155], a[196:199], a[120:123], v[152:155]
ds_read_b64_tr_b16 v[100:101], v11 offset:8192
ds_read_b64_tr_b16 v[102:103], v11 offset:12288
v_mfma_f32_16x16x32_bf16 v[152:155], a[200:203], a[152:155], v[152:155]
ds_read_b64_tr_b16 v[104:105], v11 offset:16384
ds_read_b64_tr_b16 v[106:107], v11 offset:20480
v_mfma_f32_16x16x32_bf16 v[152:155], a[204:207], a[168:171], v[152:155]
ds_read_b64_tr_b16 v[108:109], v11 offset:24576
ds_read_b64_tr_b16 v[110:111], v11 offset:28672
v_mfma_f32_16x16x32_bf16 v[152:155], v[48:51], a[216:219], v[152:155]
v_cvt_pk_bf16_f32 v76, v136, v137
v_cvt_pk_bf16_f32 v77, v138, v139
v_mfma_f32_16x16x32_bf16 v[152:155], v[52:55], a[232:235], v[152:155]
v_cvt_pk_bf16_f32 v78, v140, v141
v_cvt_pk_bf16_f32 v79, v142, v143
v_mfma_f32_16x16x32_bf16 v[156:159], v[52:55], a[236:239], v[156:159]
s_add_u32 s40, s29, 1024
buffer_store_dwordx4 v[76:79], v7, s[16:19], s40 offen sc1
v_mfma_f32_16x16x32_bf16 v[156:159], v[48:51], a[220:223], v[156:159]
s_mov_b64 exec, s[32:33]
ds_write_b128 v7, v[76:79] offset:33792
s_mov_b64 exec, -1
v_mfma_f32_16x16x32_bf16 v[156:159], a[204:207], a[172:175], v[156:159]
v_mfma_f32_16x16x32_bf16 v[156:159], a[200:203], a[156:159], v[156:159]
v_mfma_f32_16x16x32_bf16 v[156:159], a[196:199], a[124:127], v[156:159]
v_mfma_f32_16x16x32_bf16 v[156:159], a[192:195], a[108:111], v[156:159]
s_waitcnt lgkmcnt(0)
v_mfma_f32_16x16x32_bf16 v[172:175], v[56:59], a[108:111], v[172:175]
v_mfma_f32_16x16x32_bf16 v[172:175], v[60:63], a[124:127], v[172:175]
v_mfma_f32_16x16x32_bf16 v[172:175], v[96:99], a[156:159], v[172:175]
v_mfma_f32_16x16x32_bf16 v[172:175], v[100:103], a[172:175], v[172:175]
v_mfma_f32_16x16x32_bf16 v[172:175], v[104:107], a[220:223], v[172:175]
v_mfma_f32_16x16x32_bf16 v[172:175], v[108:111], a[236:239], v[172:175]
v_mfma_f32_16x16x32_bf16 v[168:171], v[108:111], a[232:235], v[168:171]
v_cvt_pk_bf16_f32 v80, v144, v145
v_cvt_pk_bf16_f32 v81, v146, v147
v_mfma_f32_16x16x32_bf16 v[168:171], v[104:107], a[216:219], v[168:171]
v_cvt_pk_bf16_f32 v82, v148, v149
v_cvt_pk_bf16_f32 v83, v150, v151
v_mfma_f32_16x16x32_bf16 v[168:171], v[100:103], a[168:171], v[168:171]
s_add_u32 s40, s28, 2048
buffer_store_dwordx4 v[80:83], v7, s[16:19], s40 offen sc1
v_mfma_f32_16x16x32_bf16 v[168:171], v[96:99], a[152:155], v[168:171]
s_mov_b64 exec, s[30:31]
ds_write_b128 v7, v[80:83] offset:34816
s_mov_b64 exec, -1
v_mfma_f32_16x16x32_bf16 v[168:171], v[60:63], a[120:123], v[168:171]
ds_read_b64_tr_b16 a[176:177], v44 offset:49152
ds_read_b64_tr_b16 a[178:179], v44 offset:53248
v_mfma_f32_16x16x32_bf16 v[168:171], v[56:59], a[104:107], v[168:171]
ds_read_b64_tr_b16 a[180:181], v44 offset:57344
ds_read_b64_tr_b16 a[182:183], v44 offset:61440
v_mfma_f32_16x16x32_bf16 v[164:167], v[56:59], a[100:103], v[164:167]
ds_read_b64_tr_b16 a[184:185], v12 offset:0
ds_read_b64_tr_b16 a[186:187], v12 offset:4096
v_mfma_f32_16x16x32_bf16 v[164:167], v[60:63], a[116:119], v[164:167]
ds_read_b64_tr_b16 a[188:189], v12 offset:8192
ds_read_b64_tr_b16 a[190:191], v12 offset:12288
v_mfma_f32_16x16x32_bf16 v[164:167], v[96:99], a[148:151], v[164:167]
ds_read_b64_tr_b16 a[192:193], v12 offset:16384
ds_read_b64_tr_b16 a[194:195], v12 offset:20480
v_mfma_f32_16x16x32_bf16 v[164:167], v[100:103], a[164:167], v[164:167]
ds_read_b64_tr_b16 a[196:197], v12 offset:24576
ds_read_b64_tr_b16 a[198:199], v12 offset:28672
v_mfma_f32_16x16x32_bf16 v[164:167], v[104:107], a[212:215], v[164:167]
v_cvt_pk_bf16_f32 v84, v152, v153
v_cvt_pk_bf16_f32 v85, v154, v155
v_mfma_f32_16x16x32_bf16 v[164:167], v[108:111], a[228:231], v[164:167]
v_cvt_pk_bf16_f32 v86, v156, v157
v_cvt_pk_bf16_f32 v87, v158, v159
v_mfma_f32_16x16x32_bf16 v[160:163], v[108:111], a[224:227], v[160:163]
s_add_u32 s40, s29, 2048
buffer_store_dwordx4 v[84:87], v7, s[16:19], s40 offen sc1
v_mfma_f32_16x16x32_bf16 v[160:163], v[104:107], a[208:211], v[160:163]
s_mov_b64 exec, s[32:33]
ds_write_b128 v7, v[84:87] offset:34816
s_mov_b64 exec, -1
v_mfma_f32_16x16x32_bf16 v[160:163], v[100:103], a[160:163], v[160:163]
v_mfma_f32_16x16x32_bf16 v[160:163], v[96:99], a[144:147], v[160:163]
v_mfma_f32_16x16x32_bf16 v[160:163], v[60:63], a[112:115], v[160:163]
v_mfma_f32_16x16x32_bf16 v[160:163], v[56:59], a[96:99], v[160:163]
s_waitcnt lgkmcnt(0)
v_mfma_f32_16x16x32_bf16 v[176:179], a[176:179], a[96:99], v[176:179]
v_mfma_f32_16x16x32_bf16 v[176:179], a[180:183], a[112:115], v[176:179]
v_mfma_f32_16x16x32_bf16 v[176:179], a[184:187], a[144:147], v[176:179]
v_mfma_f32_16x16x32_bf16 v[176:179], a[188:191], a[160:163], v[176:179]
v_mfma_f32_16x16x32_bf16 v[176:179], a[192:195], a[208:211], v[176:179]
v_mfma_f32_16x16x32_bf16 v[176:179], a[196:199], a[224:227], v[176:179]
v_mfma_f32_16x16x32_bf16 v[180:183], a[196:199], a[228:231], v[180:183]
v_cvt_pk_bf16_f32 v88, v160, v161
v_cvt_pk_bf16_f32 v89, v162, v163
v_mfma_f32_16x16x32_bf16 v[180:183], a[192:195], a[212:215], v[180:183]
v_cvt_pk_bf16_f32 v90, v164, v165
v_cvt_pk_bf16_f32 v91, v166, v167
v_mfma_f32_16x16x32_bf16 v[180:183], a[188:191], a[164:167], v[180:183]
s_add_u32 s40, s28, 3072
buffer_store_dwordx4 v[88:91], v7, s[16:19], s40 offen sc1
v_mfma_f32_16x16x32_bf16 v[180:183], a[184:187], a[148:151], v[180:183]
s_mov_b64 exec, s[30:31]
ds_write_b128 v7, v[88:91] offset:35840
s_mov_b64 exec, -1
v_mfma_f32_16x16x32_bf16 v[180:183], a[180:183], a[116:119], v[180:183]
ds_read_b64_tr_b16 a[200:201], v45 offset:49152
ds_read_b64_tr_b16 a[202:203], v45 offset:53248
v_mfma_f32_16x16x32_bf16 v[180:183], a[176:179], a[100:103], v[180:183]
ds_read_b64_tr_b16 a[204:205], v45 offset:57344
ds_read_b64_tr_b16 a[206:207], v45 offset:61440
v_mfma_f32_16x16x32_bf16 v[184:187], a[176:179], a[104:107], v[184:187]
ds_read_b64_tr_b16 v[48:49], v13 offset:0
ds_read_b64_tr_b16 v[50:51], v13 offset:4096
v_mfma_f32_16x16x32_bf16 v[184:187], a[180:183], a[120:123], v[184:187]
ds_read_b64_tr_b16 v[52:53], v13 offset:8192
ds_read_b64_tr_b16 v[54:55], v13 offset:12288
v_mfma_f32_16x16x32_bf16 v[184:187], a[184:187], a[152:155], v[184:187]
ds_read_b64_tr_b16 v[56:57], v13 offset:16384
ds_read_b64_tr_b16 v[58:59], v13 offset:20480
v_mfma_f32_16x16x32_bf16 v[184:187], a[188:191], a[168:171], v[184:187]
ds_read_b64_tr_b16 v[60:61], v13 offset:24576
ds_read_b64_tr_b16 v[62:63], v13 offset:28672
v_mfma_f32_16x16x32_bf16 v[184:187], a[192:195], a[216:219], v[184:187]
v_cvt_pk_bf16_f32 v92, v168, v169
v_cvt_pk_bf16_f32 v93, v170, v171
v_mfma_f32_16x16x32_bf16 v[184:187], a[196:199], a[232:235], v[184:187]
v_cvt_pk_bf16_f32 v94, v172, v173
v_cvt_pk_bf16_f32 v95, v174, v175
v_mfma_f32_16x16x32_bf16 v[188:191], a[196:199], a[236:239], v[188:191]
s_add_u32 s40, s29, 3072
buffer_store_dwordx4 v[92:95], v7, s[16:19], s40 offen sc1
v_mfma_f32_16x16x32_bf16 v[188:191], a[192:195], a[220:223], v[188:191]
s_mov_b64 exec, s[32:33]
ds_write_b128 v7, v[92:95] offset:35840
s_mov_b64 exec, -1
v_mfma_f32_16x16x32_bf16 v[188:191], a[188:191], a[172:175], v[188:191]
v_mfma_f32_16x16x32_bf16 v[188:191], a[184:187], a[156:159], v[188:191]
v_mfma_f32_16x16x32_bf16 v[188:191], a[180:183], a[124:127], v[188:191]
v_mfma_f32_16x16x32_bf16 v[188:191], a[176:179], a[108:111], v[188:191]
s_waitcnt lgkmcnt(0)
v_mfma_f32_16x16x32_bf16 v[204:207], a[200:203], a[108:111], v[204:207]
v_mfma_f32_16x16x32_bf16 v[204:207], a[204:207], a[124:127], v[204:207]
v_mfma_f32_16x16x32_bf16 v[204:207], v[48:51], a[156:159], v[204:207]
v_mfma_f32_16x16x32_bf16 v[204:207], v[52:55], a[172:175], v[204:207]
v_mfma_f32_16x16x32_bf16 v[204:207], v[56:59], a[220:223], v[204:207]
v_mfma_f32_16x16x32_bf16 v[204:207], v[60:63], a[236:239], v[204:207]
v_mfma_f32_16x16x32_bf16 v[200:203], v[60:63], a[232:235], v[200:203]
v_cvt_pk_bf16_f32 v64, v176, v177
v_cvt_pk_bf16_f32 v65, v178, v179
v_mfma_f32_16x16x32_bf16 v[200:203], v[56:59], a[216:219], v[200:203]
v_cvt_pk_bf16_f32 v66, v180, v181
v_cvt_pk_bf16_f32 v67, v182, v183
v_mfma_f32_16x16x32_bf16 v[200:203], v[52:55], a[168:171], v[200:203]
s_add_u32 s40, s28, 4096
buffer_store_dwordx4 v[64:67], v7, s[16:19], s40 offen sc1
v_mfma_f32_16x16x32_bf16 v[200:203], v[48:51], a[152:155], v[200:203]
s_mov_b64 exec, s[30:31]
ds_write_b128 v7, v[64:67] offset:36864
s_mov_b64 exec, -1
v_mfma_f32_16x16x32_bf16 v[200:203], a[204:207], a[120:123], v[200:203]
ds_read_b64_tr_b16 v[96:97], v46 offset:49152
ds_read_b64_tr_b16 v[98:99], v46 offset:53248
v_mfma_f32_16x16x32_bf16 v[200:203], a[200:203], a[104:107], v[200:203]
ds_read_b64_tr_b16 v[100:101], v46 offset:57344
ds_read_b64_tr_b16 v[102:103], v46 offset:61440
v_mfma_f32_16x16x32_bf16 v[196:199], a[200:203], a[100:103], v[196:199]
ds_read_b64_tr_b16 v[104:105], v14 offset:0
ds_read_b64_tr_b16 v[106:107], v14 offset:4096
v_mfma_f32_16x16x32_bf16 v[196:199], a[204:207], a[116:119], v[196:199]
ds_read_b64_tr_b16 v[108:109], v14 offset:8192
ds_read_b64_tr_b16 v[110:111], v14 offset:12288
v_mfma_f32_16x16x32_bf16 v[196:199], v[48:51], a[148:151], v[196:199]
ds_read_b64_tr_b16 a[176:177], v14 offset:16384
ds_read_b64_tr_b16 a[178:179], v14 offset:20480
v_mfma_f32_16x16x32_bf16 v[196:199], v[52:55], a[164:167], v[196:199]
ds_read_b64_tr_b16 a[180:181], v14 offset:24576
ds_read_b64_tr_b16 a[182:183], v14 offset:28672
v_mfma_f32_16x16x32_bf16 v[196:199], v[56:59], a[212:215], v[196:199]
v_cvt_pk_bf16_f32 v68, v184, v185
v_cvt_pk_bf16_f32 v69, v186, v187
v_mfma_f32_16x16x32_bf16 v[196:199], v[60:63], a[228:231], v[196:199]
v_cvt_pk_bf16_f32 v70, v188, v189
v_cvt_pk_bf16_f32 v71, v190, v191
v_mfma_f32_16x16x32_bf16 v[192:195], v[60:63], a[224:227], v[192:195]
s_add_u32 s40, s29, 4096
buffer_store_dwordx4 v[68:71], v7, s[16:19], s40 offen sc1
v_mfma_f32_16x16x32_bf16 v[192:195], v[56:59], a[208:211], v[192:195]
s_mov_b64 exec, s[32:33]
ds_write_b128 v7, v[68:71] offset:36864
s_mov_b64 exec, -1
v_mfma_f32_16x16x32_bf16 v[192:195], v[52:55], a[160:163], v[192:195]
v_mfma_f32_16x16x32_bf16 v[192:195], v[48:51], a[144:147], v[192:195]
v_mfma_f32_16x16x32_bf16 v[192:195], a[204:207], a[112:115], v[192:195]
v_mfma_f32_16x16x32_bf16 v[192:195], a[200:203], a[96:99], v[192:195]
s_waitcnt lgkmcnt(0)
v_mfma_f32_16x16x32_bf16 v[208:211], v[96:99], a[96:99], v[208:211]
v_mfma_f32_16x16x32_bf16 v[208:211], v[100:103], a[112:115], v[208:211]
v_mfma_f32_16x16x32_bf16 v[208:211], v[104:107], a[144:147], v[208:211]
v_mfma_f32_16x16x32_bf16 v[208:211], v[108:111], a[160:163], v[208:211]
v_mfma_f32_16x16x32_bf16 v[208:211], a[176:179], a[208:211], v[208:211]
v_mfma_f32_16x16x32_bf16 v[208:211], a[180:183], a[224:227], v[208:211]
v_mfma_f32_16x16x32_bf16 v[212:215], a[180:183], a[228:231], v[212:215]
v_cvt_pk_bf16_f32 v72, v192, v193
v_cvt_pk_bf16_f32 v73, v194, v195
v_mfma_f32_16x16x32_bf16 v[212:215], a[176:179], a[212:215], v[212:215]
v_cvt_pk_bf16_f32 v74, v196, v197
v_cvt_pk_bf16_f32 v75, v198, v199
v_mfma_f32_16x16x32_bf16 v[212:215], v[108:111], a[164:167], v[212:215]
s_add_u32 s40, s28, 5120
buffer_store_dwordx4 v[72:75], v7, s[16:19], s40 offen sc1
v_mfma_f32_16x16x32_bf16 v[212:215], v[104:107], a[148:151], v[212:215]
s_mov_b64 exec, s[30:31]
ds_write_b128 v7, v[72:75] offset:37888
s_mov_b64 exec, -1
v_mfma_f32_16x16x32_bf16 v[212:215], v[100:103], a[116:119], v[212:215]
ds_read_b64_tr_b16 a[184:185], v47 offset:49152
ds_read_b64_tr_b16 a[186:187], v47 offset:53248
v_mfma_f32_16x16x32_bf16 v[212:215], v[96:99], a[100:103], v[212:215]
ds_read_b64_tr_b16 a[188:189], v47 offset:57344
ds_read_b64_tr_b16 a[190:191], v47 offset:61440
v_mfma_f32_16x16x32_bf16 v[216:219], v[96:99], a[104:107], v[216:219]
ds_read_b64_tr_b16 a[192:193], v15 offset:0
ds_read_b64_tr_b16 a[194:195], v15 offset:4096
v_mfma_f32_16x16x32_bf16 v[216:219], v[100:103], a[120:123], v[216:219]
ds_read_b64_tr_b16 a[196:197], v15 offset:8192
ds_read_b64_tr_b16 a[198:199], v15 offset:12288
v_mfma_f32_16x16x32_bf16 v[216:219], v[104:107], a[152:155], v[216:219]
ds_read_b64_tr_b16 a[200:201], v15 offset:16384
ds_read_b64_tr_b16 a[202:203], v15 offset:20480
v_mfma_f32_16x16x32_bf16 v[216:219], v[108:111], a[168:171], v[216:219]
ds_read_b64_tr_b16 a[204:205], v15 offset:24576
ds_read_b64_tr_b16 a[206:207], v15 offset:28672
v_mfma_f32_16x16x32_bf16 v[216:219], a[176:179], a[216:219], v[216:219]
v_cvt_pk_bf16_f32 v76, v200, v201
v_cvt_pk_bf16_f32 v77, v202, v203
v_mfma_f32_16x16x32_bf16 v[216:219], a[180:183], a[232:235], v[216:219]
v_cvt_pk_bf16_f32 v78, v204, v205
v_cvt_pk_bf16_f32 v79, v206, v207
v_mfma_f32_16x16x32_bf16 v[220:223], a[180:183], a[236:239], v[220:223]
s_add_u32 s40, s29, 5120
buffer_store_dwordx4 v[76:79], v7, s[16:19], s40 offen sc1
v_mfma_f32_16x16x32_bf16 v[220:223], a[176:179], a[220:223], v[220:223]
s_mov_b64 exec, s[32:33]
ds_write_b128 v7, v[76:79] offset:37888
s_mov_b64 exec, -1
v_mfma_f32_16x16x32_bf16 v[220:223], v[108:111], a[172:175], v[220:223]
v_mfma_f32_16x16x32_bf16 v[220:223], v[104:107], a[156:159], v[220:223]
v_mfma_f32_16x16x32_bf16 v[220:223], v[100:103], a[124:127], v[220:223]
v_mfma_f32_16x16x32_bf16 v[220:223], v[96:99], a[108:111], v[220:223]
s_waitcnt lgkmcnt(0)
v_mfma_f32_16x16x32_bf16 v[236:239], a[184:187], a[108:111], v[236:239]
v_mfma_f32_16x16x32_bf16 v[236:239], a[188:191], a[124:127], v[236:239]
v_mfma_f32_16x16x32_bf16 v[236:239], a[192:195], a[156:159], v[236:239]
v_mfma_f32_16x16x32_bf16 v[236:239], a[196:199], a[172:175], v[236:239]
v_mfma_f32_16x16x32_bf16 v[236:239], a[200:203], a[220:223], v[236:239]
v_mfma_f32_16x16x32_bf16 v[236:239], a[204:207], a[236:239], v[236:239]
v_mfma_f32_16x16x32_bf16 v[232:235], a[204:207], a[232:235], v[232:235]
v_cvt_pk_bf16_f32 v80, v208, v209
v_cvt_pk_bf16_f32 v81, v210, v211
v_mfma_f32_16x16x32_bf16 v[232:235], a[200:203], a[216:219], v[232:235]
v_cvt_pk_bf16_f32 v82, v212, v213
v_cvt_pk_bf16_f32 v83, v214, v215
v_mfma_f32_16x16x32_bf16 v[232:235], a[196:199], a[168:171], v[232:235]
s_add_u32 s40, s28, 6144
buffer_store_dwordx4 v[80:83], v7, s[16:19], s40 offen sc1
v_mfma_f32_16x16x32_bf16 v[232:235], a[192:195], a[152:155], v[232:235]
s_mov_b64 exec, s[30:31]
ds_write_b128 v7, v[80:83] offset:38912
s_mov_b64 exec, -1
v_mfma_f32_16x16x32_bf16 v[232:235], a[188:191], a[120:123], v[232:235]
ds_read_b64_tr_b16 v[48:49], v20 offset:14336
ds_read_b64_tr_b16 v[50:51], v20 offset:14848
v_mfma_f32_16x16x32_bf16 v[232:235], a[184:187], a[104:107], v[232:235]
ds_read_b64_tr_b16 v[52:53], v20 offset:15360
ds_read_b64_tr_b16 v[54:55], v20 offset:15872
v_mfma_f32_16x16x32_bf16 v[228:231], a[184:187], a[100:103], v[228:231]
ds_read_b64_tr_b16 v[56:57], v20 offset:0
ds_read_b64_tr_b16 v[58:59], v20 offset:512
v_mfma_f32_16x16x32_bf16 v[228:231], a[188:191], a[116:119], v[228:231]
ds_read_b64_tr_b16 v[60:61], v20 offset:1024
ds_read_b64_tr_b16 v[62:63], v20 offset:1536
v_mfma_f32_16x16x32_bf16 v[228:231], a[192:195], a[148:151], v[228:231]
ds_read_b64_tr_b16 v[96:97], v20 offset:2048
ds_read_b64_tr_b16 v[98:99], v20 offset:2560
v_mfma_f32_16x16x32_bf16 v[228:231], a[196:199], a[164:167], v[228:231]
ds_read_b64_tr_b16 v[100:101], v20 offset:3072
ds_read_b64_tr_b16 v[102:103], v20 offset:3584
v_mfma_f32_16x16x32_bf16 v[228:231], a[200:203], a[212:215], v[228:231]
v_cvt_pk_bf16_f32 v84, v216, v217
v_cvt_pk_bf16_f32 v85, v218, v219
v_mfma_f32_16x16x32_bf16 v[228:231], a[204:207], a[228:231], v[228:231]
v_cvt_pk_bf16_f32 v86, v220, v221
v_cvt_pk_bf16_f32 v87, v222, v223
v_mfma_f32_16x16x32_bf16 v[224:227], a[204:207], a[224:227], v[224:227]
s_add_u32 s40, s29, 6144
buffer_load_dword v26, v33, s[16:19], s56 offen sc1
v_mfma_f32_16x16x32_bf16 v[224:227], a[200:203], a[208:211], v[224:227]
buffer_store_dwordx4 v[84:87], v7, s[16:19], s40 offen sc1
v_mfma_f32_16x16x32_bf16 v[224:227], a[196:199], a[160:163], v[224:227]
s_mov_b64 exec, s[32:33]
ds_write_b128 v7, v[84:87] offset:38912
s_mov_b64 exec, -1
v_mfma_f32_16x16x32_bf16 v[224:227], a[192:195], a[144:147], v[224:227]
v_mfma_f32_16x16x32_bf16 v[224:227], a[188:191], a[112:115], v[224:227]
v_mfma_f32_16x16x32_bf16 v[224:227], a[184:187], a[96:99], v[224:227]
s_waitcnt lgkmcnt(0)
v_mfma_f32_16x16x32_bf16 v[240:243], v[48:51], a[96:99], v[240:243]
v_mfma_f32_16x16x32_bf16 v[240:243], v[52:55], a[112:115], v[240:243]
v_mfma_f32_16x16x32_bf16 v[240:243], v[56:59], a[144:147], v[240:243]
v_mfma_f32_16x16x32_bf16 v[240:243], v[60:63], a[160:163], v[240:243]
v_mfma_f32_16x16x32_bf16 v[240:243], v[96:99], a[208:211], v[240:243]
v_mfma_f32_16x16x32_bf16 v[240:243], v[100:103], a[224:227], v[240:243]
v_mfma_f32_16x16x32_bf16 v[244:247], v[100:103], a[228:231], v[244:247]
v_cvt_pk_bf16_f32 v88, v224, v225
v_cvt_pk_bf16_f32 v89, v226, v227
v_mfma_f32_16x16x32_bf16 v[244:247], v[96:99], a[212:215], v[244:247]
v_cvt_pk_bf16_f32 v90, v228, v229
v_cvt_pk_bf16_f32 v91, v230, v231
v_mfma_f32_16x16x32_bf16 v[244:247], v[60:63], a[164:167], v[244:247]
s_add_u32 s40, s28, 7168
buffer_store_dwordx4 v[88:91], v7, s[16:19], s40 offen sc1
v_mfma_f32_16x16x32_bf16 v[244:247], v[56:59], a[148:151], v[244:247]
s_mov_b64 exec, s[30:31]
ds_write_b128 v7, v[88:91] offset:39936
s_mov_b64 exec, -1
v_mfma_f32_16x16x32_bf16 v[244:247], v[52:55], a[116:119], v[244:247]
v_cvt_pk_bf16_f32 v92, v232, v233
v_cvt_pk_bf16_f32 v93, v234, v235
v_mfma_f32_16x16x32_bf16 v[244:247], v[48:51], a[100:103], v[244:247]
v_cvt_pk_bf16_f32 v94, v236, v237
v_cvt_pk_bf16_f32 v95, v238, v239
v_mfma_f32_16x16x32_bf16 v[248:251], v[48:51], a[104:107], v[248:251]
s_add_u32 s40, s29, 7168
v_mfma_f32_16x16x32_bf16 v[248:251], v[52:55], a[120:123], v[248:251]
v_mfma_f32_16x16x32_bf16 v[248:251], v[56:59], a[152:155], v[248:251]
v_mfma_f32_16x16x32_bf16 v[248:251], v[60:63], a[168:171], v[248:251]
v_mfma_f32_16x16x32_bf16 v[248:251], v[96:99], a[216:219], v[248:251]
v_mfma_f32_16x16x32_bf16 v[248:251], v[100:103], a[232:235], v[248:251]
buffer_store_dwordx4 v[92:95], v7, s[16:19], s40 offen sc1
v_mfma_f32_16x16x32_bf16 v[252:255], v[100:103], a[236:239], v[252:255]
s_mov_b64 exec, s[32:33]
ds_write_b128 v7, v[92:95] offset:39936
s_mov_b64 exec, -1
v_mfma_f32_16x16x32_bf16 v[252:255], v[96:99], a[220:223], v[252:255]
v_mfma_f32_16x16x32_bf16 v[252:255], v[60:63], a[172:175], v[252:255]
v_mfma_f32_16x16x32_bf16 v[252:255], v[56:59], a[156:159], v[252:255]
v_mfma_f32_16x16x32_bf16 v[252:255], v[52:55], a[124:127], v[252:255]
v_mfma_f32_16x16x32_bf16 v[252:255], v[48:51], a[108:111], v[252:255]
v_cvt_pk_bf16_f32 v64, v240, v241
v_cvt_pk_bf16_f32 v65, v242, v243
v_cvt_pk_bf16_f32 v66, v244, v245
v_cvt_pk_bf16_f32 v67, v246, v247
s_add_u32 s40, s28, 8192
buffer_store_dwordx4 v[64:67], v7, s[16:19], s40 offen sc1
s_mov_b64 exec, s[30:31]
ds_write_b128 v7, v[64:67] offset:40960
s_mov_b64 exec, -1
v_cvt_pk_bf16_f32 v68, v248, v249
v_cvt_pk_bf16_f32 v69, v250, v251
v_cvt_pk_bf16_f32 v70, v252, v253
v_cvt_pk_bf16_f32 v71, v254, v255
s_add_u32 s40, s29, 8192
buffer_store_dwordx4 v[68:71], v7, s[16:19], s40 offen sc1
s_mov_b64 exec, s[32:33]
ds_write_b128 v7, v[68:71] offset:40960
s_mov_b64 exec, -1
v_mov_b32 v20, 0
v_mov_b32 v21, 0
s_waitcnt lgkmcnt(0)
s_barrier
ds_read_b128 a[96:99], v1 offset:32768
ds_read_b128 a[100:103], v1 offset:36864
ds_read_b128 a[104:107], v7 offset:40960
v_mov_b32 v120, 0
v_mov_b32 v121, 0
v_mov_b32 v122, 0
v_mov_b32 v123, 0
v_mov_b32 v124, 0
v_mov_b32 v125, 0
v_mov_b32 v126, 0
v_mov_b32 v127, 0
v_mov_b32 v136, 0
v_mov_b32 v137, 0
v_mov_b32 v138, 0
v_mov_b32 v139, 0
v_mov_b32 v140, 0
v_mov_b32 v141, 0
v_mov_b32 v142, 0
v_mov_b32 v143, 0
v_mov_b32 v152, 0
v_mov_b32 v153, 0
v_mov_b32 v154, 0
v_mov_b32 v155, 0
v_mov_b32 v156, 0
v_mov_b32 v157, 0
v_mov_b32 v158, 0
v_mov_b32 v159, 0
s_waitcnt lgkmcnt(0)
v_mfma_f32_16x16x32_bf16 v[112:115], v[18:21], a[96:99], 0
v_mfma_f32_16x16x32_bf16 v[116:119], v[16:19], a[96:99], 0
v_mfma_f32_16x16x32_bf16 v[128:131], v[18:21], a[100:103], 0
v_mfma_f32_16x16x32_bf16 v[132:135], v[16:19], a[100:103], 0
v_mfma_f32_16x16x32_bf16 v[144:147], v[18:21], a[104:107], 0
v_mfma_f32_16x16x32_bf16 v[148:151], v[16:19], a[104:107], 0
s_waitcnt vmcnt(19)
v_accvgpr_read_b32 v36, a240
v_accvgpr_read_b32 v37, a241
v_accvgpr_read_b32 v38, a242
v_accvgpr_read_b32 v39, a243
v_accvgpr_read_b32 v40, a244
v_accvgpr_read_b32 v41, a245
v_accvgpr_read_b32 v42, a246
v_accvgpr_read_b32 v43, a247
v_accvgpr_read_b32 v44, a248
v_accvgpr_read_b32 v45, a249
v_accvgpr_read_b32 v46, a250
v_accvgpr_read_b32 v47, a251
v_lshlrev_b32 v192, 16, v36
v_and_b32 v193, 0xffff0000, v36
v_lshlrev_b32 v194, 16, v37
v_and_b32 v195, 0xffff0000, v37
v_lshlrev_b32 v196, 16, v38
v_and_b32 v197, 0xffff0000, v38
v_lshlrev_b32 v198, 16, v39
v_and_b32 v199, 0xffff0000, v39
v_lshlrev_b32 v200, 16, v40
v_and_b32 v201, 0xffff0000, v40
v_lshlrev_b32 v202, 16, v41
v_and_b32 v203, 0xffff0000, v41
v_lshlrev_b32 v204, 16, v42
v_and_b32 v205, 0xffff0000, v42
v_lshlrev_b32 v206, 16, v43
v_and_b32 v207, 0xffff0000, v43
v_lshlrev_b32 v208, 16, v44
v_and_b32 v209, 0xffff0000, v44
v_lshlrev_b32 v210, 16, v45
v_and_b32 v211, 0xffff0000, v45
v_lshlrev_b32 v212, 16, v46
v_and_b32 v213, 0xffff0000, v46
v_lshlrev_b32 v214, 16, v47
v_and_b32 v215, 0xffff0000, v47
s_waitcnt vmcnt(0)
buffer_store_dword v34, v32, s[16:19], s6 offen sc1
M_p3e:
s_mov_b32 s58, s57
s_mov_b32 s59, s57
s_mov_b32 s50, s34
s_mov_b32 s37, 0
s_mov_b32 s3, 0x80000
s_branch M_eval
M_poll:
buffer_load_dword v26, v33, s[16:19], s56 offen sc1
s_waitcnt vmcnt(0)
M_eval:
v_cmp_lt_u32 vcc, 1, v26
s_sub_u32 s3, s3, 1
s_cselect_b32 s38, 255, vcc_lo
s_and_b32 s38, s38, 255
s_andn2_b32 s38, s38, s50
s_cbranch_scc0 M_sum
s_bitcmp1_b32 s38, 0
s_cbranch_scc0 M_l0
s_add_u32 s40, s26, 0
s_add_u32 s36, s27, 0
buffer_load_dwordx4 a[32:35], v35, s[16:19], s40 offen sc1
buffer_load_dwordx4 a[64:67], v7, s[16:19], s36 offen sc1
buffer_load_dwordx4 a[0:3], v7, s[16:19], s40 offen sc1
M_l0:
s_bitcmp1_b32 s38, 1
s_cbranch_scc0 M_l1
s_add_u32 s40, s26, 9216
s_add_u32 s36, s27, 9216
buffer_load_dwordx4 a[36:39], v35, s[16:19], s40 offen sc1
buffer_load_dwordx4 a[68:71], v7, s[16:19], s36 offen sc1
buffer_load_dwordx4 a[4:7], v7, s[16:19], s40 offen sc1
M_l1:
s_bitcmp1_b32 s38, 2
s_cbranch_scc0 M_l2
s_add_u32 s40, s26, 18432
s_add_u32 s36, s27, 18432
buffer_load_dwordx4 a[40:43], v35, s[16:19], s40 offen sc1
buffer_load_dwordx4 a[72:75], v7, s[16:19], s36 offen sc1
buffer_load_dwordx4 a[8:11], v7, s[16:19], s40 offen sc1
M_l2:
s_bitcmp1_b32 s38, 3
s_cbranch_scc0 M_l3
s_add_u32 s40, s26, 27648
s_add_u32 s36, s27, 27648
buffer_load_dwordx4 a[44:47], v35, s[16:19], s40 offen sc1
buffer_load_dwordx4 a[76:79], v7, s[16:19], s36 offen sc1
buffer_load_dwordx4 a[12:15], v7, s[16:19], s40 offen sc1
M_l3:
s_bitcmp1_b32 s38, 4
s_cbranch_scc0 M_l4
s_add_u32 s40, s26, 36864
s_add_u32 s36, s27, 36864
buffer_load_dwordx4 a[48:51], v35, s[16:19], s40 offen sc1
buffer_load_dwordx4 a[80:83], v7, s[16:19], s36 offen sc1
buffer_load_dwordx4 a[16:19], v7, s[16:19], s40 offen sc1
M_l4:
s_bitcmp1_b32 s38, 5
s_cbranch_scc0 M_l5
s_add_u32 s40, s26, 46080
s_add_u32 s36, s27, 46080
buffer_load_dwordx4 a[52:55], v35, s[16:19], s40 offen sc1
buffer_load_dwordx4 a[84:87], v7, s[16:19], s36 offen sc1
buffer_load_dwordx4 a[20:23], v7, s[16:19], s40 offen sc1
M_l5:
s_bitcmp1_b32 s38, 6
s_cbranch_scc0 M_l6
s_add_u32 s40, s26, 55296
s_add_u32 s36, s27, 55296
buffer_load_dwordx4 a[56:59], v35, s[16:19], s40 offen sc1
buffer_load_dwordx4 a[88:91], v7, s[16:19], s36 offen sc1
buffer_load_dwordx4 a[24:27], v7, s[16:19], s40 offen sc1
M_l6:
s_bitcmp1_b32 s38, 7
s_cbranch_scc0 M_l7
s_add_u32 s40, s26, 64512
s_add_u32 s36, s27, 64512
buffer_load_dwordx4 a[60:63], v35, s[16:19], s40 offen sc1
buffer_load_dwordx4 a[92:95], v7, s[16:19], s36 offen sc1
buffer_load_dwordx4 a[28:31], v7, s[16:19], s40 offen sc1
M_l7:
M_sum:
s_cmp_eq_u32 s37, 0
s_cbranch_scc1 M_nos
s_bitcmp1_b32 s37, 0
s_cbranch_scc0 M_s0
v_mfma_f32_16x16x32_bf16 v[112:115], v[18:21], a[0:3], v[112:115]
v_mfma_f32_16x16x32_bf16 v[116:119], v[16:19], a[0:3], v[116:119]
v_mfma_f32_16x16x32_bf16 v[128:131], v[18:21], a[32:35], v[128:131]
v_mfma_f32_16x16x32_bf16 v[132:135], v[16:19], a[32:35], v[132:135]
v_mfma_f32_16x16x32_bf16 v[144:147], v[18:21], a[64:67], v[144:147]
v_mfma_f32_16x16x32_bf16 v[148:151], v[16:19], a[64:67], v[148:151]
M_s0:
s_bitcmp1_b32 s37, 1
s_cbranch_scc0 M_s1
v_mfma_f32_16x16x32_bf16 v[112:115], v[18:21], a[4:7], v[112:115]
v_mfma_f32_16x16x32_bf16 v[116:119], v[16:19], a[4:7], v[116:119]
v_mfma_f32_16x16x32_bf16 v[128:131], v[18:21], a[36:39], v[128:131]
v_mfma_f32_16x16x32_bf16 v[132:135], v[16:19], a[36:39], v[132:135]
v_mfma_f32_16x16x32_bf16 v[144:147], v[18:21], a[68:71], v[144:147]
v_mfma_f32_16x16x32_bf16 v[148:151], v[16:19], a[68:71], v[148:151]
M_s1:
s_bitcmp1_b32 s37, 2
s_cbranch_scc0 M_s2
v_mfma_f32_16x16x32_bf16 v[112:115], v[18:21], a[8:11], v[112:115]
v_mfma_f32_16x16x32_bf16 v[116:119], v[16:19], a[8:11], v[116:119]
v_mfma_f32_16x16x32_bf16 v[128:131], v[18:21], a[40:43], v[128:131]
v_mfma_f32_16x16x32_bf16 v[132:135], v[16:19], a[40:43], v[132:135]
v_mfma_f32_16x16x32_bf16 v[144:147], v[18:21], a[72:75], v[144:147]
v_mfma_f32_16x16x32_bf16 v[148:151], v[16:19], a[72:75], v[148:151]
M_s2:
s_bitcmp1_b32 s37, 3
s_cbranch_scc0 M_s3
v_mfma_f32_16x16x32_bf16 v[112:115], v[18:21], a[12:15], v[112:115]
v_mfma_f32_16x16x32_bf16 v[116:119], v[16:19], a[12:15], v[116:119]
v_mfma_f32_16x16x32_bf16 v[128:131], v[18:21], a[44:47], v[128:131]
v_mfma_f32_16x16x32_bf16 v[132:135], v[16:19], a[44:47], v[132:135]
v_mfma_f32_16x16x32_bf16 v[144:147], v[18:21], a[76:79], v[144:147]
v_mfma_f32_16x16x32_bf16 v[148:151], v[16:19], a[76:79], v[148:151]
M_s3:
s_bitcmp1_b32 s37, 4
s_cbranch_scc0 M_s4
v_mfma_f32_16x16x32_bf16 v[120:123], v[18:21], a[16:19], v[120:123]
v_mfma_f32_16x16x32_bf16 v[124:127], v[16:19], a[16:19], v[124:127]
v_mfma_f32_16x16x32_bf16 v[136:139], v[18:21], a[48:51], v[136:139]
v_mfma_f32_16x16x32_bf16 v[140:143], v[16:19], a[48:51], v[140:143]
v_mfma_f32_16x16x32_bf16 v[152:155], v[18:21], a[80:83], v[152:155]
v_mfma_f32_16x16x32_bf16 v[156:159], v[16:19], a[80:83], v[156:159]
M_s4:
s_bitcmp1_b32 s37, 5
s_cbranch_scc0 M_s5
v_mfma_f32_16x16x32_bf16 v[120:123], v[18:21], a[20:23], v[120:123]
v_mfma_f32_16x16x32_bf16 v[124:127], v[16:19], a[20:23], v[124:127]
v_mfma_f32_16x16x32_bf16 v[136:139], v[18:21], a[52:55], v[136:139]
v_mfma_f32_16x16x32_bf16 v[140:143], v[16:19], a[52:55], v[140:143]
v_mfma_f32_16x16x32_bf16 v[152:155], v[18:21], a[84:87], v[152:155]
v_mfma_f32_16x16x32_bf16 v[156:159], v[16:19], a[84:87], v[156:159]
M_s5:
s_bitcmp1_b32 s37, 6
s_cbranch_scc0 M_s6
v_mfma_f32_16x16x32_bf16 v[120:123], v[18:21], a[24:27], v[120:123]
v_mfma_f32_16x16x32_bf16 v[124:127], v[16:19], a[24:27], v[124:127]
v_mfma_f32_16x16x32_bf16 v[136:139], v[18:21], a[56:59], v[136:139]
v_mfma_f32_16x16x32_bf16 v[140:143], v[16:19], a[56:59], v[140:143]
v_mfma_f32_16x16x32_bf16 v[152:155], v[18:21], a[88:91], v[152:155]
v_mfma_f32_16x16x32_bf16 v[156:159], v[16:19], a[88:91], v[156:159]
M_s6:
s_bitcmp1_b32 s37, 7
s_cbranch_scc0 M_s7
v_mfma_f32_16x16x32_bf16 v[120:123], v[18:21], a[28:31], v[120:123]
v_mfma_f32_16x16x32_bf16 v[124:127], v[16:19], a[28:31], v[124:127]
v_mfma_f32_16x16x32_bf16 v[136:139], v[18:21], a[60:63], v[136:139]
v_mfma_f32_16x16x32_bf16 v[140:143], v[16:19], a[60:63], v[140:143]
v_mfma_f32_16x16x32_bf16 v[152:155], v[18:21], a[92:95], v[152:155]
v_mfma_f32_16x16x32_bf16 v[156:159], v[16:19], a[92:95], v[156:159]
M_s7:
M_nos:
s_cmp_eq_u32 s50, 255
s_cbranch_scc1 M_go
s_mov_b32 s37, s38
s_or_b32 s50, s50, s38
s_cmp_eq_u32 s50, 255
s_cbranch_scc1 M_last
s_branch M_poll
M_last:
s_waitcnt vmcnt(0)
s_branch M_sum
M_go:
s_nop 5
v_pk_mul_f32 v[176:177], v[112:113], s[58:59]
v_pk_mul_f32 v[178:179], v[114:115], s[58:59]
v_pk_mul_f32 v[180:181], v[116:117], s[58:59]
v_pk_mul_f32 v[182:183], v[118:119], s[58:59]
v_exp_f32 v176, v176
v_exp_f32 v177, v177
v_exp_f32 v178, v178
v_exp_f32 v179, v179
v_exp_f32 v180, v180
v_exp_f32 v181, v181
v_exp_f32 v182, v182
v_exp_f32 v183, v183
v_pk_add_f32 v[176:177], v[176:177], 1.0 op_sel_hi:[1,0]
v_pk_add_f32 v[178:179], v[178:179], 1.0 op_sel_hi:[1,0]
v_pk_add_f32 v[180:181], v[180:181], 1.0 op_sel_hi:[1,0]
v_pk_add_f32 v[182:183], v[182:183], 1.0 op_sel_hi:[1,0]
v_rcp_f32 v176, v176
v_rcp_f32 v177, v177
v_rcp_f32 v178, v178
v_rcp_f32 v179, v179
v_rcp_f32 v180, v180
v_rcp_f32 v181, v181
v_rcp_f32 v182, v182
v_rcp_f32 v183, v183
v_pk_mul_f32 v[176:177], v[176:177], v[112:113]
v_pk_mul_f32 v[178:179], v[178:179], v[114:115]
v_pk_mul_f32 v[180:181], v[180:181], v[116:117]
v_pk_mul_f32 v[182:183], v[182:183], v[118:119]
v_pk_fma_f32 v[120:121], v[120:121], v[176:177], v[192:193]
v_pk_fma_f32 v[122:123], v[122:123], v[178:179], v[194:195]
v_pk_fma_f32 v[124:125], v[124:125], v[180:181], v[196:197]
v_pk_fma_f32 v[126:127], v[126:127], v[182:183], v[198:199]
v_cvt_pk_bf16_f32 v36, v120, v121
v_cvt_pk_bf16_f32 v37, v122, v123
v_cvt_pk_bf16_f32 v38, v124, v125
v_cvt_pk_bf16_f32 v39, v126, v127
buffer_store_dwordx2 v[36:37], v2, s[12:15], s41 offen offset:0
buffer_store_dwordx2 v[38:39], v3, s[12:15], s41 offen offset:0
v_pk_mul_f32 v[176:177], v[128:129], s[58:59]
v_pk_mul_f32 v[178:179], v[130:131], s[58:59]
v_pk_mul_f32 v[180:181], v[132:133], s[58:59]
v_pk_mul_f32 v[182:183], v[134:135], s[58:59]
v_exp_f32 v176, v176
v_exp_f32 v177, v177
v_exp_f32 v178, v178
v_exp_f32 v179, v179
v_exp_f32 v180, v180
v_exp_f32 v181, v181
v_exp_f32 v182, v182
v_exp_f32 v183, v183
v_pk_add_f32 v[176:177], v[176:177], 1.0 op_sel_hi:[1,0]
v_pk_add_f32 v[178:179], v[178:179], 1.0 op_sel_hi:[1,0]
v_pk_add_f32 v[180:181], v[180:181], 1.0 op_sel_hi:[1,0]
v_pk_add_f32 v[182:183], v[182:183], 1.0 op_sel_hi:[1,0]
v_rcp_f32 v176, v176
v_rcp_f32 v177, v177
v_rcp_f32 v178, v178
v_rcp_f32 v179, v179
v_rcp_f32 v180, v180
v_rcp_f32 v181, v181
v_rcp_f32 v182, v182
v_rcp_f32 v183, v183
v_pk_mul_f32 v[176:177], v[176:177], v[128:129]
v_pk_mul_f32 v[178:179], v[178:179], v[130:131]
v_pk_mul_f32 v[180:181], v[180:181], v[132:133]
v_pk_mul_f32 v[182:183], v[182:183], v[134:135]
v_pk_fma_f32 v[136:137], v[136:137], v[176:177], v[200:201]
v_pk_fma_f32 v[138:139], v[138:139], v[178:179], v[202:203]
v_pk_fma_f32 v[140:141], v[140:141], v[180:181], v[204:205]
v_pk_fma_f32 v[142:143], v[142:143], v[182:183], v[206:207]
v_cvt_pk_bf16_f32 v40, v136, v137
v_cvt_pk_bf16_f32 v41, v138, v139
v_cvt_pk_bf16_f32 v42, v140, v141
v_cvt_pk_bf16_f32 v43, v142, v143
buffer_store_dwordx2 v[40:41], v2, s[12:15], s41 offen offset:128
buffer_store_dwordx2 v[42:43], v3, s[12:15], s41 offen offset:128
s_cmp_lg_u32 s23, 0
s_cbranch_scc1 M_fin
v_pk_mul_f32 v[176:177], v[144:145], s[58:59]
v_pk_mul_f32 v[178:179], v[146:147], s[58:59]
v_pk_mul_f32 v[180:181], v[148:149], s[58:59]
v_pk_mul_f32 v[182:183], v[150:151], s[58:59]
v_exp_f32 v176, v176
v_exp_f32 v177, v177
v_exp_f32 v178, v178
v_exp_f32 v179, v179
v_exp_f32 v180, v180
v_exp_f32 v181, v181
v_exp_f32 v182, v182
v_exp_f32 v183, v183
v_pk_add_f32 v[176:177], v[176:177], 1.0 op_sel_hi:[1,0]
v_pk_add_f32 v[178:179], v[178:179], 1.0 op_sel_hi:[1,0]
v_pk_add_f32 v[180:181], v[180:181], 1.0 op_sel_hi:[1,0]
v_pk_add_f32 v[182:183], v[182:183], 1.0 op_sel_hi:[1,0]
v_rcp_f32 v176, v176
v_rcp_f32 v177, v177
v_rcp_f32 v178, v178
v_rcp_f32 v179, v179
v_rcp_f32 v180, v180
v_rcp_f32 v181, v181
v_rcp_f32 v182, v182
v_rcp_f32 v183, v183
v_pk_mul_f32 v[176:177], v[176:177], v[144:145]
v_pk_mul_f32 v[178:179], v[178:179], v[146:147]
v_pk_mul_f32 v[180:181], v[180:181], v[148:149]
v_pk_mul_f32 v[182:183], v[182:183], v[150:151]
v_pk_fma_f32 v[152:153], v[152:153], v[176:177], v[208:209]
v_pk_fma_f32 v[154:155], v[154:155], v[178:179], v[210:211]
v_pk_fma_f32 v[156:157], v[156:157], v[180:181], v[212:213]
v_pk_fma_f32 v[158:159], v[158:159], v[182:183], v[214:215]
v_cvt_pk_bf16_f32 v44, v152, v153
v_cvt_pk_bf16_f32 v45, v154, v155
v_cvt_pk_bf16_f32 v46, v156, v157
v_cvt_pk_bf16_f32 v47, v158, v159
buffer_store_dwordx2 v[44:45], v2, s[12:15], s43 offen offset:0
buffer_store_dwordx2 v[46:47], v3, s[12:15], s43 offen offset:0
M_fin:
M_done:
s_endpgm
M_sps:
s_mov_b32 s3, 0x80000
M_sps_l:
buffer_load_dwordx2 v[4:5], v29, s[16:19], s38 offen sc1
s_waitcnt vmcnt(0)
v_cmp_eq_u64 vcc, s[66:67], v[4:5]
s_sub_u32 s3, s3, 1
s_cbranch_scc1 M_sps_b
s_cmp_eq_u64 vcc, exec
s_cbranch_scc0 M_sps_l
s_branch M_sps_b
M_sp1:
s_mov_b32 s3, 0x80000
M_sp1_l:
buffer_load_dword v26, v33, s[16:19], s5 offen sc1
s_waitcnt vmcnt(0)
v_cmp_le_u32 vcc, v35, v26
s_sub_u32 s3, s3, 1
s_cbranch_scc1 M_sp1_b
s_cmp_eq_u64 vcc, exec
s_cbranch_scc0 M_sp1_l
s_branch M_sp1_b
M_sp2:
s_mov_b32 s3, 0x80000
M_sp2_l:
buffer_load_dword v26, v33, s[16:19], s5 offen sc1
s_waitcnt vmcnt(0)
v_lshrrev_b32 v26, 1, v26
v_cmp_le_u32 vcc, v35, v26
s_sub_u32 s3, s3, 1
s_cbranch_scc1 M_sp2_b
s_cmp_eq_u64 vcc, exec
s_cbranch_scc0 M_sp2_l
s_branch M_sp2_b
M_sp3:
s_mov_b32 s3, 0x80000
M_sp3_l:
buffer_load_dword v26, v33, s[16:19], s5 offen sc1
s_waitcnt vmcnt(0)
v_cmp_le_u32 vcc, 2, v26
s_sub_u32 s3, s3, 1
s_cbranch_scc1 M_sp3_b
s_cmp_eq_u64 vcc, exec
s_cbranch_scc0 M_sp3_l
s_branch M_sp3_b
M_fallback:
s_mov_b32 s50, 1
s_mov_b32 s20, 0
s_mov_b32 s22, 32
s_waitcnt vmcnt(0) lgkmcnt(0)
v_and_b32 v2, 15, v0
v_lshrrev_b32 v3, 4, v0
v_add_u32 v4, 0, v3
v_xor_b32 v4, v4, v2
v_lshlrev_b32 v4, 4, v4
v_lshl_add_u32 v30, v3, 8, v4
v_add_u32 v30, s24, v30
v_lshl_add_u32 v36, v2, 8, v4
v_add_u32 v4, 4, v3
v_xor_b32 v4, v4, v2
v_lshlrev_b32 v4, 4, v4
v_lshl_add_u32 v31, v3, 8, v4
v_add_u32 v31, s24, v31
v_lshl_add_u32 v37, v2, 8, v4
v_add_u32 v4, 8, v3
v_xor_b32 v4, v4, v2
v_lshlrev_b32 v4, 4, v4
v_lshl_add_u32 v32, v3, 8, v4
v_add_u32 v32, s24, v32
v_lshl_add_u32 v38, v2, 8, v4
v_add_u32 v4, 12, v3
v_xor_b32 v4, v4, v2
v_lshlrev_b32 v4, 4, v4
v_lshl_add_u32 v33, v3, 8, v4
v_add_u32 v33, s24, v33
v_lshl_add_u32 v39, v2, 8, v4
v_mov_b32 v21, 0xff800000
v_mov_b32 v22, 0xff800000
v_mov_b32 v23, 0xff800000
v_mov_b32 v24, 0xff800000
M_fbloop:
s_barrier
s_add_u32 m0, s24, 0
s_nop 0
buffer_load_dwordx4 v30, s[8:11], s20 offen offset:0 lds
buffer_load_dwordx4 v31, s[8:11], s20 offen offset:1024 lds
buffer_load_dwordx4 v32, s[8:11], s20 offen offset:2048 lds
buffer_load_dwordx4 v33, s[8:11], s20 offen offset:3072 lds
s_add_u32 s20, s20, 16384
s_waitcnt vmcnt(0)
s_barrier
ds_read_b128 a[144:147], v36 offset:0
ds_read_b128 a[148:151], v37 offset:0
ds_read_b128 a[152:155], v38 offset:0
ds_read_b128 a[156:159], v39 offset:0
ds_read_b128 a[160:163], v36 offset:4096
ds_read_b128 a[164:167], v37 offset:4096
ds_read_b128 a[168:171], v38 offset:4096
ds_read_b128 a[172:175], v39 offset:4096
s_waitcnt lgkmcnt(0)
v_mfma_f32_16x16x32_bf16 v[192:195], a[144:147], v[128:131], 0
v_mfma_f32_16x16x32_bf16 v[192:195], a[148:151], v[144:147], v[192:195]
v_mfma_f32_16x16x32_bf16 v[192:195], a[152:155], v[160:163], v[192:195]
v_mfma_f32_16x16x32_bf16 v[192:195], a[156:159], v[176:179], v[192:195]
v_mfma_f32_16x16x32_bf16 v[200:203], a[156:159], v[180:183], 0
v_mfma_f32_16x16x32_bf16 v[200:203], a[152:155], v[164:167], v[200:203]
v_mfma_f32_16x16x32_bf16 v[200:203], a[148:151], v[148:151], v[200:203]
v_mfma_f32_16x16x32_bf16 v[200:203], a[144:147], v[132:135], v[200:203]
v_mfma_f32_16x16x32_bf16 v[208:211], a[144:147], v[136:139], 0
v_mfma_f32_16x16x32_bf16 v[208:211], a[148:151], v[152:155], v[208:211]
v_mfma_f32_16x16x32_bf16 v[208:211], a[152:155], v[168:171], v[208:211]
v_mfma_f32_16x16x32_bf16 v[208:211], a[156:159], v[184:187], v[208:211]
v_mfma_f32_16x16x32_bf16 v[216:219], a[156:159], v[188:191], 0
v_mfma_f32_16x16x32_bf16 v[216:219], a[152:155], v[172:175], v[216:219]
v_mfma_f32_16x16x32_bf16 v[216:219], a[148:151], v[156:159], v[216:219]
v_mfma_f32_16x16x32_bf16 v[216:219], a[144:147], v[140:143], v[216:219]
v_mfma_f32_16x16x32_bf16 v[220:223], a[160:163], v[140:143], 0
v_mfma_f32_16x16x32_bf16 v[220:223], a[164:167], v[156:159], v[220:223]
v_mfma_f32_16x16x32_bf16 v[220:223], a[168:171], v[172:175], v[220:223]
v_mfma_f32_16x16x32_bf16 v[220:223], a[172:175], v[188:191], v[220:223]
v_mfma_f32_16x16x32_bf16 v[212:215], a[172:175], v[184:187], 0
v_mfma_f32_16x16x32_bf16 v[212:215], a[168:171], v[168:171], v[212:215]
v_mfma_f32_16x16x32_bf16 v[212:215], a[164:167], v[152:155], v[212:215]
v_mfma_f32_16x16x32_bf16 v[212:215], a[160:163], v[136:139], v[212:215]
v_mfma_f32_16x16x32_bf16 v[204:207], a[160:163], v[132:135], 0
v_mfma_f32_16x16x32_bf16 v[204:207], a[164:167], v[148:151], v[204:207]
v_mfma_f32_16x16x32_bf16 v[204:207], a[168:171], v[164:167], v[204:207]
v_mfma_f32_16x16x32_bf16 v[204:207], a[172:175], v[180:183], v[204:207]
v_mfma_f32_16x16x32_bf16 v[196:199], a[172:175], v[176:179], 0
v_mfma_f32_16x16x32_bf16 v[196:199], a[168:171], v[160:163], v[196:199]
v_mfma_f32_16x16x32_bf16 v[196:199], a[164:167], v[144:147], v[196:199]
v_mfma_f32_16x16x32_bf16 v[196:199], a[160:163], v[128:131], v[196:199]
v_max3_f32 v21, v21, v192, v193
v_max3_f32 v22, v22, v200, v201
v_max3_f32 v23, v23, v208, v209
v_max3_f32 v24, v24, v216, v217
v_max3_f32 v21, v21, v194, v195
v_max3_f32 v22, v22, v202, v203
v_max3_f32 v23, v23, v210, v211
v_max3_f32 v24, v24, v218, v219
v_max3_f32 v21, v21, v196, v197
v_max3_f32 v22, v22, v204, v205
v_max3_f32 v23, v23, v212, v213
v_max3_f32 v24, v24, v220, v221
v_max3_f32 v21, v21, v198, v199
v_max3_f32 v22, v22, v206, v207
v_max3_f32 v23, v23, v214, v215
v_max3_f32 v24, v24, v222, v223
ds_read_b128 a[144:147], v36 offset:8192
ds_read_b128 a[148:151], v37 offset:8192
ds_read_b128 a[152:155], v38 offset:8192
ds_read_b128 a[156:159], v39 offset:8192
ds_read_b128 a[160:163], v36 offset:12288
ds_read_b128 a[164:167], v37 offset:12288
ds_read_b128 a[168:171], v38 offset:12288
ds_read_b128 a[172:175], v39 offset:12288
s_waitcnt lgkmcnt(0)
v_mfma_f32_16x16x32_bf16 v[192:195], a[144:147], v[128:131], 0
v_mfma_f32_16x16x32_bf16 v[192:195], a[148:151], v[144:147], v[192:195]
v_mfma_f32_16x16x32_bf16 v[192:195], a[152:155], v[160:163], v[192:195]
v_mfma_f32_16x16x32_bf16 v[192:195], a[156:159], v[176:179], v[192:195]
v_mfma_f32_16x16x32_bf16 v[200:203], a[156:159], v[180:183], 0
v_mfma_f32_16x16x32_bf16 v[200:203], a[152:155], v[164:167], v[200:203]
v_mfma_f32_16x16x32_bf16 v[200:203], a[148:151], v[148:151], v[200:203]
v_mfma_f32_16x16x32_bf16 v[200:203], a[144:147], v[132:135], v[200:203]
v_mfma_f32_16x16x32_bf16 v[208:211], a[144:147], v[136:139], 0
v_mfma_f32_16x16x32_bf16 v[208:211], a[148:151], v[152:155], v[208:211]
v_mfma_f32_16x16x32_bf16 v[208:211], a[152:155], v[168:171], v[208:211]
v_mfma_f32_16x16x32_bf16 v[208:211], a[156:159], v[184:187], v[208:211]
v_mfma_f32_16x16x32_bf16 v[216:219], a[156:159], v[188:191], 0
v_mfma_f32_16x16x32_bf16 v[216:219], a[152:155], v[172:175], v[216:219]
v_mfma_f32_16x16x32_bf16 v[216:219], a[148:151], v[156:159], v[216:219]
v_mfma_f32_16x16x32_bf16 v[216:219], a[144:147], v[140:143], v[216:219]
v_mfma_f32_16x16x32_bf16 v[220:223], a[160:163], v[140:143], 0
v_mfma_f32_16x16x32_bf16 v[220:223], a[164:167], v[156:159], v[220:223]
v_mfma_f32_16x16x32_bf16 v[220:223], a[168:171], v[172:175], v[220:223]
v_mfma_f32_16x16x32_bf16 v[220:223], a[172:175], v[188:191], v[220:223]
v_mfma_f32_16x16x32_bf16 v[212:215], a[172:175], v[184:187], 0
v_mfma_f32_16x16x32_bf16 v[212:215], a[168:171], v[168:171], v[212:215]
v_mfma_f32_16x16x32_bf16 v[212:215], a[164:167], v[152:155], v[212:215]
v_mfma_f32_16x16x32_bf16 v[212:215], a[160:163], v[136:139], v[212:215]
v_mfma_f32_16x16x32_bf16 v[204:207], a[160:163], v[132:135], 0
v_mfma_f32_16x16x32_bf16 v[204:207], a[164:167], v[148:151], v[204:207]
v_mfma_f32_16x16x32_bf16 v[204:207], a[168:171], v[164:167], v[204:207]
v_mfma_f32_16x16x32_bf16 v[204:207], a[172:175], v[180:183], v[204:207]
v_mfma_f32_16x16x32_bf16 v[196:199], a[172:175], v[176:179], 0
v_mfma_f32_16x16x32_bf16 v[196:199], a[168:171], v[160:163], v[196:199]
v_mfma_f32_16x16x32_bf16 v[196:199], a[164:167], v[144:147], v[196:199]
v_mfma_f32_16x16x32_bf16 v[196:199], a[160:163], v[128:131], v[196:199]
v_max3_f32 v21, v21, v192, v193
v_max3_f32 v22, v22, v200, v201
v_max3_f32 v23, v23, v208, v209
v_max3_f32 v24, v24, v216, v217
v_max3_f32 v21, v21, v194, v195
v_max3_f32 v22, v22, v202, v203
v_max3_f32 v23, v23, v210, v211
v_max3_f32 v24, v24, v218, v219
v_max3_f32 v21, v21, v196, v197
v_max3_f32 v22, v22, v204, v205
v_max3_f32 v23, v23, v212, v213
v_max3_f32 v24, v24, v220, v221
v_max3_f32 v21, v21, v198, v199
v_max3_f32 v22, v22, v206, v207
v_max3_f32 v23, v23, v214, v215
v_max3_f32 v24, v24, v222, v223
s_sub_u32 s22, s22, 1
s_cmp_lg_u32 s22, 0
s_cbranch_scc1 M_fbloop
v_mov_b32 v25, v21
v_mov_b32 v26, v22
v_mov_b32 v27, v23
v_mov_b32 v28, v24
v_permlane32_swap_b32 v21, v25
v_permlane32_swap_b32 v22, v26
v_permlane32_swap_b32 v23, v27
v_permlane32_swap_b32 v24, v28
v_max_f32 v21, v21, v25
v_max_f32 v22, v22, v26
v_max_f32 v23, v23, v27
v_max_f32 v24, v24, v28
v_mov_b32 v25, v21
v_mov_b32 v26, v22
v_mov_b32 v27, v23
v_mov_b32 v28, v24
v_permlane16_swap_b32 v21, v25
v_permlane16_swap_b32 v22, v26
v_permlane16_swap_b32 v23, v27
v_permlane16_swap_b32 v24, v28
v_max_f32 v21, v21, v25
v_max_f32 v22, v22, v26
v_max_f32 v23, v23, v27
v_max_f32 v24, v24, v28
v_sub_f32 v48, 0x0, v21
v_sub_f32 v49, 0x0, v21
v_sub_f32 v50, 0x0, v21
v_sub_f32 v51, 0x0, v21
v_sub_f32 v52, 0x0, v22
v_sub_f32 v53, 0x0, v22
v_sub_f32 v54, 0x0, v22
v_sub_f32 v55, 0x0, v22
v_sub_f32 v56, 0x0, v23
v_sub_f32 v57, 0x0, v23
v_sub_f32 v58, 0x0, v23
v_sub_f32 v59, 0x0, v23
v_sub_f32 v60, 0x0, v24
v_sub_f32 v61, 0x0, v24
v_sub_f32 v62, 0x0, v24
v_sub_f32 v63, 0x0, v24
s_barrier
s_mov_b32 s20, 0
s_mov_b32 s21, 0
s_add_u32 m0, s24, 0
s_nop 0
buffer_load_dwordx4 v30, s[8:11], s20 offen offset:0 lds
buffer_load_dwordx4 v31, s[8:11], s20 offen offset:1024 lds
buffer_load_dwordx4 v32, s[8:11], s20 offen offset:2048 lds
buffer_load_dwordx4 v33, s[8:11], s20 offen offset:3072 lds
s_add_u32 s20, s20, 16384
s_add_u32 m0, s24, 16384
s_nop 0
buffer_load_dwordx4 v30, s[8:11], s20 offen offset:0 lds
buffer_load_dwordx4 v31, s[8:11], s20 offen offset:1024 lds
buffer_load_dwordx4 v32, s[8:11], s20 offen offset:2048 lds
buffer_load_dwordx4 v33, s[8:11], s20 offen offset:3072 lds
s_add_u32 s20, s20, 16384
s_add_u32 m0, s24, 81920
s_nop 0
buffer_load_dwordx4 v34, s[12:15], s21 offen offset:0 lds
buffer_load_dwordx4 v35, s[12:15], s21 offen offset:1024 lds
buffer_load_dwordx4 v34, s[12:15], s21 offen offset:2048 lds
buffer_load_dwordx4 v35, s[12:15], s21 offen offset:3072 lds
s_add_u32 s21, s21, 16384
s_add_u32 m0, s24, 32768
s_nop 0
buffer_load_dwordx4 v30, s[8:11], s20 offen offset:0 lds
buffer_load_dwordx4 v31, s[8:11], s20 offen offset:1024 lds
buffer_load_dwordx4 v32, s[8:11], s20 offen offset:2048 lds
buffer_load_dwordx4 v33, s[8:11], s20 offen offset:3072 lds
s_add_u32 s20, s20, 16384
s_add_u32 m0, s24, 65536
s_nop 0
buffer_load_dwordx4 v34, s[12:15], s21 offen offset:0 lds
buffer_load_dwordx4 v35, s[12:15], s21 offen offset:1024 lds
buffer_load_dwordx4 v34, s[12:15], s21 offen offset:2048 lds
buffer_load_dwordx4 v35, s[12:15], s21 offen offset:3072 lds
s_add_u32 s21, s21, 16384
s_add_u32 m0, s24, 49152
s_nop 0
buffer_load_dwordx4 v30, s[8:11], s20 offen offset:0 lds
buffer_load_dwordx4 v31, s[8:11], s20 offen offset:1024 lds
buffer_load_dwordx4 v32, s[8:11], s20 offen offset:2048 lds
buffer_load_dwordx4 v33, s[8:11], s20 offen offset:3072 lds
s_add_u32 s20, s20, 16384
s_waitcnt vmcnt(0)
s_barrier
ds_read_b128 a[144:147], v36 offset:0
ds_read_b128 a[148:151], v37 offset:0
ds_read_b128 a[152:155], v38 offset:0
ds_read_b128 a[156:159], v39 offset:0
ds_read_b128 a[160:163], v36 offset:4096
ds_read_b128 a[164:167], v37 offset:4096
ds_read_b128 a[168:171], v38 offset:4096
ds_read_b128 a[172:175], v39 offset:4096
s_waitcnt lgkmcnt(0)
v_mfma_f32_16x16x32_bf16 v[192:195], a[144:147], v[128:131], v[48:51]
v_mfma_f32_16x16x32_bf16 v[192:195], a[148:151], v[144:147], v[192:195]
v_mfma_f32_16x16x32_bf16 v[192:195], a[152:155], v[160:163], v[192:195]
v_mfma_f32_16x16x32_bf16 v[192:195], a[156:159], v[176:179], v[192:195]
v_mfma_f32_16x16x32_bf16 v[200:203], a[156:159], v[180:183], v[52:55]
v_mfma_f32_16x16x32_bf16 v[200:203], a[152:155], v[164:167], v[200:203]
v_mfma_f32_16x16x32_bf16 v[200:203], a[148:151], v[148:151], v[200:203]
v_mfma_f32_16x16x32_bf16 v[200:203], a[144:147], v[132:135], v[200:203]
v_mfma_f32_16x16x32_bf16 v[208:211], a[144:147], v[136:139], v[56:59]
v_mfma_f32_16x16x32_bf16 v[208:211], a[148:151], v[152:155], v[208:211]
v_mfma_f32_16x16x32_bf16 v[208:211], a[152:155], v[168:171], v[208:211]
v_mfma_f32_16x16x32_bf16 v[208:211], a[156:159], v[184:187], v[208:211]
v_mfma_f32_16x16x32_bf16 v[216:219], a[156:159], v[188:191], v[60:63]
v_mfma_f32_16x16x32_bf16 v[216:219], a[152:155], v[172:175], v[216:219]
v_mfma_f32_16x16x32_bf16 v[216:219], a[148:151], v[156:159], v[216:219]
v_mfma_f32_16x16x32_bf16 v[216:219], a[144:147], v[140:143], v[216:219]
v_mfma_f32_16x16x32_bf16 v[220:223], a[160:163], v[140:143], v[60:63]
v_mfma_f32_16x16x32_bf16 v[220:223], a[164:167], v[156:159], v[220:223]
v_mfma_f32_16x16x32_bf16 v[220:223], a[168:171], v[172:175], v[220:223]
v_mfma_f32_16x16x32_bf16 v[220:223], a[172:175], v[188:191], v[220:223]
v_mfma_f32_16x16x32_bf16 v[212:215], a[172:175], v[184:187], v[56:59]
v_mfma_f32_16x16x32_bf16 v[212:215], a[168:171], v[168:171], v[212:215]
v_mfma_f32_16x16x32_bf16 v[212:215], a[164:167], v[152:155], v[212:215]
v_mfma_f32_16x16x32_bf16 v[212:215], a[160:163], v[136:139], v[212:215]
v_mfma_f32_16x16x32_bf16 v[204:207], a[160:163], v[132:135], v[52:55]
v_mfma_f32_16x16x32_bf16 v[204:207], a[164:167], v[148:151], v[204:207]
v_mfma_f32_16x16x32_bf16 v[204:207], a[168:171], v[164:167], v[204:207]
v_mfma_f32_16x16x32_bf16 v[204:207], a[172:175], v[180:183], v[204:207]
v_mfma_f32_16x16x32_bf16 v[196:199], a[172:175], v[176:179], v[48:51]
v_mfma_f32_16x16x32_bf16 v[196:199], a[168:171], v[160:163], v[196:199]
v_mfma_f32_16x16x32_bf16 v[196:199], a[164:167], v[144:147], v[196:199]
v_mfma_f32_16x16x32_bf16 v[196:199], a[160:163], v[128:131], v[196:199]
ds_read_b128 a[144:147], v36 offset:8192
ds_read_b128 a[148:151], v37 offset:8192
ds_read_b128 a[152:155], v38 offset:8192
ds_read_b128 a[156:159], v39 offset:8192
ds_read_b128 a[160:163], v36 offset:12288
ds_read_b128 a[164:167], v37 offset:12288
ds_read_b128 a[168:171], v38 offset:12288
ds_read_b128 a[172:175], v39 offset:12288
s_waitcnt lgkmcnt(0)
s_barrier
v_mfma_f32_16x16x32_bf16 v[224:227], a[144:147], v[128:131], v[48:51]
ds_read_b128 a[176:179], v36 offset:16384
v_mfma_f32_16x16x32_bf16 v[224:227], a[148:151], v[144:147], v[224:227]
s_add_u32 m0, s24, 0
v_exp_f32 v192, v192
v_mfma_f32_16x16x32_bf16 v[224:227], a[152:155], v[160:163], v[224:227]
v_exp_f32 v193, v193
v_mfma_f32_16x16x32_bf16 v[224:227], a[156:159], v[176:179], v[224:227]
v_exp_f32 v194, v194
v_mfma_f32_16x16x32_bf16 v[232:235], a[156:159], v[180:183], v[52:55]
v_exp_f32 v195, v195
v_mfma_f32_16x16x32_bf16 v[232:235], a[152:155], v[164:167], v[232:235]
ds_read_b128 a[180:183], v37 offset:16384
v_cvt_pk_bf16_f32 v64, v192, v193
v_mfma_f32_16x16x32_bf16 v[232:235], a[148:151], v[148:151], v[232:235]
v_exp_f32 v196, v196
v_mfma_f32_16x16x32_bf16 v[232:235], a[144:147], v[132:135], v[232:235]
v_exp_f32 v197, v197
v_mfma_f32_16x16x32_bf16 v[240:243], a[144:147], v[136:139], v[56:59]
ds_read_b128 a[184:187], v38 offset:16384
buffer_load_dwordx4 v30, s[8:11], s20 offen offset:0 lds
v_exp_f32 v198, v198
v_mfma_f32_16x16x32_bf16 v[240:243], a[148:151], v[152:155], v[240:243]
v_exp_f32 v199, v199
v_cvt_pk_bf16_f32 v65, v194, v195
v_mfma_f32_16x16x32_bf16 v[240:243], a[152:155], v[168:171], v[240:243]
v_exp_f32 v200, v200
v_mfma_f32_16x16x32_bf16 v[240:243], a[156:159], v[184:187], v[240:243]
ds_read_b128 a[188:191], v39 offset:16384
v_exp_f32 v201, v201
v_cvt_pk_bf16_f32 v66, v196, v197
v_mfma_f32_16x16x32_bf16 v[248:251], a[156:159], v[188:191], v[60:63]
buffer_load_dwordx4 v31, s[8:11], s20 offen offset:1024 lds
v_exp_f32 v202, v202
v_mfma_f32_16x16x32_bf16 v[248:251], a[152:155], v[172:175], v[248:251]
v_exp_f32 v203, v203
v_cvt_pk_bf16_f32 v67, v198, v199
v_mfma_f32_16x16x32_bf16 v[248:251], a[148:151], v[156:159], v[248:251]
ds_read_b128 a[192:195], v36 offset:20480
v_exp_f32 v204, v204
v_mfma_f32_16x16x32_bf16 v[248:251], a[144:147], v[140:143], v[248:251]
v_exp_f32 v205, v205
v_cvt_pk_bf16_f32 v72, v200, v201
v_mfma_f32_16x16x32_bf16 v[252:255], a[160:163], v[140:143], v[60:63]
v_exp_f32 v206, v206
v_mfma_f32_16x16x32_bf16 v[252:255], a[164:167], v[156:159], v[252:255]
ds_read_b128 a[196:199], v37 offset:20480
buffer_load_dwordx4 v32, s[8:11], s20 offen offset:2048 lds
v_exp_f32 v207, v207
v_cvt_pk_bf16_f32 v73, v202, v203
v_mfma_f32_16x16x32_bf16 v[252:255], a[168:171], v[172:175], v[252:255]
v_exp_f32 v208, v208
v_exp_f32 v209, v209
v_mfma_f32_16x16x32_bf16 v[252:255], a[172:175], v[188:191], v[252:255]
v_exp_f32 v210, v210
v_cvt_pk_bf16_f32 v74, v204, v205
v_mfma_f32_16x16x32_bf16 v[244:247], a[172:175], v[184:187], v[56:59]
ds_read_b128 a[200:203], v38 offset:20480
v_exp_f32 v211, v211
v_mfma_f32_16x16x32_bf16 v[244:247], a[168:171], v[168:171], v[244:247]
buffer_load_dwordx4 v33, s[8:11], s20 offen offset:3072 lds
v_exp_f32 v212, v212
v_cvt_pk_bf16_f32 v75, v206, v207
v_mfma_f32_16x16x32_bf16 v[244:247], a[164:167], v[152:155], v[244:247]
v_exp_f32 v213, v213
v_cvt_pk_bf16_f32 v80, v208, v209
v_mfma_f32_16x16x32_bf16 v[244:247], a[160:163], v[136:139], v[244:247]
ds_read_b128 a[204:207], v39 offset:20480
v_exp_f32 v214, v214
v_mfma_f32_16x16x32_bf16 v[236:239], a[160:163], v[132:135], v[52:55]
v_exp_f32 v215, v215
v_cvt_pk_bf16_f32 v81, v210, v211
v_mfma_f32_16x16x32_bf16 v[236:239], a[164:167], v[148:151], v[236:239]
s_add_u32 s20, s20, 16384
v_exp_f32 v216, v216
v_mfma_f32_16x16x32_bf16 v[236:239], a[168:171], v[164:167], v[236:239]
v_exp_f32 v217, v217
v_cvt_pk_bf16_f32 v82, v212, v213
v_mfma_f32_16x16x32_bf16 v[236:239], a[172:175], v[180:183], v[236:239]
v_exp_f32 v218, v218
v_mfma_f32_16x16x32_bf16 v[228:231], a[172:175], v[176:179], v[48:51]
v_exp_f32 v219, v219
v_cvt_pk_bf16_f32 v83, v214, v215
v_mfma_f32_16x16x32_bf16 v[228:231], a[168:171], v[160:163], v[228:231]
v_exp_f32 v220, v220
v_mfma_f32_16x16x32_bf16 v[228:231], a[164:167], v[144:147], v[228:231]
v_exp_f32 v221, v221
v_cvt_pk_bf16_f32 v88, v216, v217
v_mfma_f32_16x16x32_bf16 v[228:231], a[160:163], v[128:131], v[228:231]
v_exp_f32 v222, v222
v_cvt_pk_bf16_f32 v89, v218, v219
v_cvt_pk_bf16_f32 v90, v220, v221
v_exp_f32 v223, v223
s_nop 0
v_cvt_pk_bf16_f32 v91, v222, v223
s_waitcnt lgkmcnt(0)
v_mfma_f32_16x16x32_bf16 v[192:195], a[176:179], v[128:131], v[48:51]
ds_read_b128 a[144:147], v36 offset:24576
v_mfma_f32_16x16x32_bf16 v[192:195], a[180:183], v[144:147], v[192:195]
s_add_u32 m0, s24, 98304
v_exp_f32 v224, v224
v_mfma_f32_16x16x32_bf16 v[192:195], a[184:187], v[160:163], v[192:195]
v_exp_f32 v225, v225
v_mfma_f32_16x16x32_bf16 v[192:195], a[188:191], v[176:179], v[192:195]
v_exp_f32 v226, v226
v_mfma_f32_16x16x32_bf16 v[200:203], a[188:191], v[180:183], v[52:55]
v_exp_f32 v227, v227
v_mfma_f32_16x16x32_bf16 v[200:203], a[184:187], v[164:167], v[200:203]
ds_read_b128 a[148:151], v37 offset:24576
v_cvt_pk_bf16_f32 v68, v224, v225
v_mfma_f32_16x16x32_bf16 v[200:203], a[180:183], v[148:151], v[200:203]
v_exp_f32 v232, v232
v_mfma_f32_16x16x32_bf16 v[200:203], a[176:179], v[132:135], v[200:203]
v_exp_f32 v233, v233
v_mfma_f32_16x16x32_bf16 v[208:211], a[176:179], v[136:139], v[56:59]
ds_read_b128 a[152:155], v38 offset:24576
buffer_load_dwordx4 v34, s[12:15], s21 offen offset:0 lds
v_exp_f32 v234, v234
v_mfma_f32_16x16x32_bf16 v[208:211], a[180:183], v[152:155], v[208:211]
v_exp_f32 v235, v235
v_cvt_pk_bf16_f32 v69, v226, v227
v_mfma_f32_16x16x32_bf16 v[208:211], a[184:187], v[168:171], v[208:211]
v_exp_f32 v240, v240
v_mfma_f32_16x16x32_bf16 v[208:211], a[188:191], v[184:187], v[208:211]
ds_read_b128 a[156:159], v39 offset:24576
v_exp_f32 v241, v241
v_cvt_pk_bf16_f32 v76, v232, v233
v_mfma_f32_16x16x32_bf16 v[216:219], a[188:191], v[188:191], v[60:63]
buffer_load_dwordx4 v35, s[12:15], s21 offen offset:1024 lds
v_exp_f32 v242, v242
v_mfma_f32_16x16x32_bf16 v[216:219], a[184:187], v[172:175], v[216:219]
v_exp_f32 v243, v243
v_cvt_pk_bf16_f32 v77, v234, v235
v_mfma_f32_16x16x32_bf16 v[216:219], a[180:183], v[156:159], v[216:219]
ds_read_b128 a[160:163], v36 offset:28672
v_exp_f32 v248, v248
v_mfma_f32_16x16x32_bf16 v[216:219], a[176:179], v[140:143], v[216:219]
v_exp_f32 v249, v249
v_cvt_pk_bf16_f32 v84, v240, v241
v_mfma_f32_16x16x32_bf16 v[220:223], a[192:195], v[140:143], v[60:63]
v_exp_f32 v250, v250
v_mfma_f32_16x16x32_bf16 v[220:223], a[196:199], v[156:159], v[220:223]
ds_read_b128 a[164:167], v37 offset:28672
buffer_load_dwordx4 v34, s[12:15], s21 offen offset:2048 lds
v_exp_f32 v251, v251
v_cvt_pk_bf16_f32 v85, v242, v243
v_mfma_f32_16x16x32_bf16 v[220:223], a[200:203], v[172:175], v[220:223]
v_exp_f32 v228, v228
v_exp_f32 v229, v229
v_mfma_f32_16x16x32_bf16 v[220:223], a[204:207], v[188:191], v[220:223]
v_exp_f32 v230, v230
v_cvt_pk_bf16_f32 v92, v248, v249
v_mfma_f32_16x16x32_bf16 v[212:215], a[204:207], v[184:187], v[56:59]
ds_read_b128 a[168:171], v38 offset:28672
v_exp_f32 v231, v231
v_mfma_f32_16x16x32_bf16 v[212:215], a[200:203], v[168:171], v[212:215]
buffer_load_dwordx4 v35, s[12:15], s21 offen offset:3072 lds
v_exp_f32 v236, v236
v_cvt_pk_bf16_f32 v93, v250, v251
v_mfma_f32_16x16x32_bf16 v[212:215], a[196:199], v[152:155], v[212:215]
v_exp_f32 v237, v237
v_cvt_pk_bf16_f32 v70, v228, v229
v_mfma_f32_16x16x32_bf16 v[212:215], a[192:195], v[136:139], v[212:215]
ds_read_b128 a[172:175], v39 offset:28672
v_exp_f32 v238, v238
v_mfma_f32_16x16x32_bf16 v[204:207], a[192:195], v[132:135], v[52:55]
v_exp_f32 v239, v239
v_cvt_pk_bf16_f32 v71, v230, v231
v_mfma_f32_16x16x32_bf16 v[204:207], a[196:199], v[148:151], v[204:207]
s_add_u32 s21, s21, 16384
v_exp_f32 v244, v244
v_mfma_f32_16x16x32_bf16 v[204:207], a[200:203], v[164:167], v[204:207]
v_exp_f32 v245, v245
v_cvt_pk_bf16_f32 v78, v236, v237
v_mfma_f32_16x16x32_bf16 v[204:207], a[204:207], v[180:183], v[204:207]
v_exp_f32 v246, v246
v_mfma_f32_16x16x32_bf16 v[196:199], a[204:207], v[176:179], v[48:51]
v_exp_f32 v247, v247
v_cvt_pk_bf16_f32 v79, v238, v239
v_mfma_f32_16x16x32_bf16 v[196:199], a[200:203], v[160:163], v[196:199]
v_exp_f32 v252, v252
v_mfma_f32_16x16x32_bf16 v[196:199], a[196:199], v[144:147], v[196:199]
v_exp_f32 v253, v253
v_cvt_pk_bf16_f32 v86, v244, v245
v_mfma_f32_16x16x32_bf16 v[196:199], a[192:195], v[128:131], v[196:199]
v_exp_f32 v254, v254
v_cvt_pk_bf16_f32 v87, v246, v247
v_cvt_pk_bf16_f32 v94, v252, v253
v_exp_f32 v255, v255
s_nop 0
v_cvt_pk_bf16_f32 v95, v254, v255
s_waitcnt vmcnt(16) lgkmcnt(0)
s_barrier
v_mfma_f32_16x16x32_bf16 v[224:227], a[144:147], v[128:131], v[48:51]
ds_read_b64_tr_b16 a[176:177], v40 offset:16384
v_bfe_u32 v16, v0, 1, 1
v_mfma_f32_16x16x32_bf16 v[224:227], a[148:151], v[144:147], v[224:227]
s_add_u32 m0, s24, 16384
v_exp_f32 v192, v192
v_mfma_f32_16x16x32_bf16 v[224:227], a[152:155], v[160:163], v[224:227]
ds_read_b64_tr_b16 a[178:179], v40 offset:20480
v_add_u32 v16, -1, v16
v_mfma_f32_16x16x32_bf16 v[224:227], a[156:159], v[176:179], v[224:227]
v_exp_f32 v193, v193
v_mfma_f32_16x16x32_bf16 v[232:235], a[156:159], v[180:183], v[52:55]
ds_read_b64_tr_b16 a[180:181], v40 offset:24576
ds_read_b64_tr_b16 a[182:183], v40 offset:28672
v_mfma_f32_16x16x32_bf16 v[232:235], a[152:155], v[164:167], v[232:235]
v_exp_f32 v194, v194
v_mfma_f32_16x16x32_bf16 v[232:235], a[148:151], v[148:151], v[232:235]
ds_read_b64_tr_b16 a[184:185], v41 offset:16384
v_cvt_pk_bf16_f32 v96, v192, v193
v_mfma_f32_16x16x32_bf16 v[232:235], a[144:147], v[132:135], v[232:235]
v_exp_f32 v195, v195
v_mfma_f32_16x16x32_bf16 v[240:243], a[144:147], v[136:139], v[56:59]
ds_read_b64_tr_b16 a[186:187], v41 offset:20480
v_cvt_pk_bf16_f32 v97, v194, v195
v_mfma_f32_16x16x32_bf16 v[240:243], a[148:151], v[152:155], v[240:243]
v_exp_f32 v196, v196
v_mfma_f32_16x16x32_bf16 v[240:243], a[152:155], v[168:171], v[240:243]
ds_read_b64_tr_b16 a[188:189], v41 offset:24576
ds_read_b64_tr_b16 a[190:191], v41 offset:28672
v_mfma_f32_16x16x32_bf16 v[240:243], a[156:159], v[184:187], v[240:243]
v_exp_f32 v197, v197
v_mfma_f32_16x16x32_bf16 v[248:251], a[156:159], v[188:191], v[60:63]
ds_read_b64_tr_b16 a[192:193], v42 offset:16384
v_cvt_pk_bf16_f32 v98, v196, v197
v_mfma_f32_16x16x32_bf16 v[248:251], a[152:155], v[172:175], v[248:251]
buffer_load_dwordx4 v30, s[8:11], s20 offen offset:0 lds
v_mfma_f32_16x16x32_bf16 v[248:251], a[148:151], v[156:159], v[248:251]
v_exp_f32 v198, v198
v_mfma_f32_16x16x32_bf16 v[248:251], a[144:147], v[140:143], v[248:251]
ds_read_b64_tr_b16 a[194:195], v42 offset:20480
ds_read_b64_tr_b16 a[196:197], v42 offset:24576
v_mfma_f32_16x16x32_bf16 v[252:255], a[160:163], v[140:143], v[60:63]
v_exp_f32 v199, v199
v_mfma_f32_16x16x32_bf16 v[252:255], a[164:167], v[156:159], v[252:255]
ds_read_b64_tr_b16 a[198:199], v42 offset:28672
v_cvt_pk_bf16_f32 v99, v198, v199
v_mfma_f32_16x16x32_bf16 v[252:255], a[168:171], v[172:175], v[252:255]
v_exp_f32 v200, v200
v_mfma_f32_16x16x32_bf16 v[252:255], a[172:175], v[188:191], v[252:255]
ds_read_b64_tr_b16 a[200:201], v43 offset:16384
ds_read_b64_tr_b16 a[202:203], v43 offset:20480
v_mfma_f32_16x16x32_bf16 v[244:247], a[172:175], v[184:187], v[56:59]
v_exp_f32 v201, v201
v_mfma_f32_16x16x32_bf16 v[244:247], a[168:171], v[168:171], v[244:247]
v_exp_f32 v202, v202
v_mfma_f32_16x16x32_bf16 v[244:247], a[164:167], v[152:155], v[244:247]
ds_read_b64_tr_b16 a[204:205], v43 offset:24576
ds_read_b64_tr_b16 a[206:207], v43 offset:28672
v_mfma_f32_16x16x32_bf16 v[244:247], a[160:163], v[136:139], v[244:247]
buffer_load_dwordx4 v31, s[8:11], s20 offen offset:1024 lds
v_mfma_f32_16x16x32_bf16 v[236:239], a[160:163], v[132:135], v[52:55]
v_exp_f32 v203, v203
v_mfma_f32_16x16x32_bf16 v[236:239], a[164:167], v[148:151], v[236:239]
v_cvt_pk_bf16_f32 v104, v200, v201
v_cvt_pk_bf16_f32 v105, v202, v203
v_mfma_f32_16x16x32_bf16 v[236:239], a[168:171], v[164:167], v[236:239]
v_exp_f32 v204, v204
v_mfma_f32_16x16x32_bf16 v[236:239], a[172:175], v[180:183], v[236:239]
v_exp_f32 v205, v205
v_mfma_f32_16x16x32_bf16 v[228:231], a[172:175], v[176:179], v[48:51]
v_exp_f32 v206, v206
v_mfma_f32_16x16x32_bf16 v[228:231], a[168:171], v[160:163], v[228:231]
v_cvt_pk_bf16_f32 v106, v204, v205
v_and_b32 v16, 0x3f803f80, v16
v_mfma_f32_16x16x32_bf16 v[228:231], a[164:167], v[144:147], v[228:231]
v_exp_f32 v207, v207
v_mfma_f32_16x16x32_bf16 v[228:231], a[160:163], v[128:131], v[228:231]
s_waitcnt lgkmcnt(0)
buffer_load_dwordx4 v32, s[8:11], s20 offen offset:2048 lds
v_mfma_f32_16x16x32_bf16 a[0:3], v[64:67], a[176:179], 0
ds_read_b128 a[144:147], v36 offset:32768
v_cvt_pk_bf16_f32 v107, v206, v207
v_mfma_f32_16x16x32_bf16 a[0:3], v[68:71], a[180:183], a[0:3]
v_exp_f32 v208, v208
v_mfma_f32_16x16x32_bf16 a[4:7], v[76:79], a[180:183], 0
v_exp_f32 v209, v209
v_mfma_f32_16x16x32_bf16 a[4:7], v[72:75], a[176:179], a[4:7]
ds_read_b128 a[148:151], v37 offset:32768
v_cvt_pk_bf16_f32 v112, v208, v209
v_mfma_f32_16x16x32_bf16 a[8:11], v[80:83], a[176:179], 0
v_exp_f32 v210, v210
v_mfma_f32_16x16x32_bf16 a[8:11], v[84:87], a[180:183], a[8:11]
v_mov_b32 v17, v16
v_mov_b32 v18, v16
v_mfma_f32_16x16x32_bf16 a[12:15], v[92:95], a[180:183], 0
ds_read_b128 a[152:155], v38 offset:32768
v_mov_b32 v19, v16
v_mfma_f32_16x16x32_bf16 a[12:15], v[88:91], a[176:179], a[12:15]
v_exp_f32 v211, v211
v_mfma_f32_16x16x32_bf16 a[28:31], v[88:91], a[184:187], 0
v_exp_f32 v212, v212
v_mfma_f32_16x16x32_bf16 a[28:31], v[92:95], a[188:191], a[28:31]
ds_read_b128 a[156:159], v39 offset:32768
v_cvt_pk_bf16_f32 v113, v210, v211
v_mfma_f32_16x16x32_bf16 a[24:27], v[84:87], a[188:191], 0
buffer_load_dwordx4 v33, s[8:11], s20 offen offset:3072 lds
v_mfma_f32_16x16x32_bf16 a[24:27], v[80:83], a[184:187], a[24:27]
v_exp_f32 v213, v213
v_mfma_f32_16x16x32_bf16 a[20:23], v[72:75], a[184:187], 0
v_exp_f32 v214, v214
v_mfma_f32_16x16x32_bf16 a[20:23], v[76:79], a[188:191], a[20:23]
ds_read_b128 a[160:163], v36 offset:36864
v_cvt_pk_bf16_f32 v114, v212, v213
v_mfma_f32_16x16x32_bf16 a[16:19], v[68:71], a[188:191], 0
v_exp_f32 v215, v215
v_mfma_f32_16x16x32_bf16 a[16:19], v[64:67], a[184:187], a[16:19]
v_cvt_pk_bf16_f32 v115, v214, v215
v_bfe_i32 v26, v0, 0, 1
v_mfma_f32_16x16x32_bf16 a[32:35], v[64:67], a[192:195], 0
ds_read_b128 a[164:167], v37 offset:36864
v_and_b32 v26, 0xaaaaaaaa, v26
v_mfma_f32_16x16x32_bf16 a[32:35], v[68:71], a[196:199], a[32:35]
v_exp_f32 v216, v216
v_mfma_f32_16x16x32_bf16 a[36:39], v[76:79], a[196:199], 0
v_exp_f32 v217, v217
v_mfma_f32_16x16x32_bf16 a[36:39], v[72:75], a[192:195], a[36:39]
s_add_u32 s20, s20, 16384
ds_read_b128 a[168:171], v38 offset:36864
v_cvt_pk_bf16_f32 v120, v216, v217
v_mfma_f32_16x16x32_bf16 a[40:43], v[80:83], a[192:195], 0
v_exp_f32 v218, v218
v_mfma_f32_16x16x32_bf16 a[40:43], v[84:87], a[196:199], a[40:43]
v_or_b32 v26, 0x44444444, v26
v_accvgpr_write_b32 a128, 0
v_mfma_f32_16x16x32_bf16 a[44:47], v[92:95], a[196:199], 0
ds_read_b128 a[172:175], v39 offset:36864
v_accvgpr_write_b32 a129, 0
v_mfma_f32_16x16x32_bf16 a[44:47], v[88:91], a[192:195], a[44:47]
v_exp_f32 v219, v219
v_mfma_f32_16x16x32_bf16 a[60:63], v[88:91], a[200:203], 0
v_accvgpr_write_b32 a132, 0
v_accvgpr_write_b32 a133, 0
v_mfma_f32_16x16x32_bf16 a[60:63], v[92:95], a[204:207], a[60:63]
v_accvgpr_write_b32 a136, 0
v_accvgpr_write_b32 a137, 0
v_mfma_f32_16x16x32_bf16 a[56:59], v[84:87], a[204:207], 0
v_accvgpr_write_b32 a140, 0
v_accvgpr_write_b32 a141, 0
v_mfma_f32_16x16x32_bf16 a[56:59], v[80:83], a[200:203], a[56:59]
v_exp_f32 v220, v220
v_mfma_f32_16x16x32_bf16 a[52:55], v[72:75], a[200:203], 0
v_exp_f32 v221, v221
v_mfma_f32_16x16x32_bf16 a[52:55], v[76:79], a[204:207], a[52:55]
v_cvt_pk_bf16_f32 v121, v218, v219
v_cvt_pk_bf16_f32 v122, v220, v221
v_mfma_f32_16x16x32_bf16 a[48:51], v[68:71], a[204:207], 0
v_exp_f32 v222, v222
v_mfma_f32_16x16x32_bf16 a[48:51], v[64:67], a[200:203], a[48:51]
v_exp_f32 v223, v223
v_smfmac_f32_16x16x64_bf16 a[128:131], v[16:19], v[64:71], v26
v_cvt_pk_bf16_f32 v123, v222, v223
v_smfmac_f32_16x16x64_bf16 a[132:135], v[16:19], v[72:79], v26
s_waitcnt lgkmcnt(0)
s_branch M_main
M_end:
s_endpgm
.section .rodata,"a"
.p2align 6
.amdhsa_kernel recurrent_scan__mha_block_cached__dense_activation_relu__prompt_kernel
  .amdhsa_next_free_vgpr 512
  .amdhsa_next_free_sgpr 102
  .amdhsa_accum_offset 256
  .amdhsa_group_segment_fixed_size 0
  .amdhsa_kernarg_size 88
  .amdhsa_user_sgpr_count 2
  .amdhsa_user_sgpr_kernarg_segment_ptr 1
  .amdhsa_system_sgpr_workgroup_id_x 1
  .amdhsa_float_denorm_mode_32 3
.end_amdhsa_kernel
.text
```
